```python
import torch

def _softmax(x, axis=-1):
    return torch.softmax(x, dim=axis)
def _gelu(x):
    return torch.nn.functional.gelu(x, approximate="tanh")
def _silu(x):
    return torch.nn.functional.silu(x)
def _sigmoid(x):
    return torch.sigmoid(x)
def _layernorm(x, axis=-1, eps=1e-5):
    m = x.mean(dim=axis, keepdim=True)
    v = x.var(dim=axis, keepdim=True, unbiased=False)
    return (x - m) / torch.sqrt(v + eps)
def _scatter_add(tgt, idx, src, axis=0):
    return tgt.clone().index_add_(axis, idx, src)
def _segment_sum(src, seg, n):
    out = torch.zeros((n,) + src.shape[1:], dtype=src.dtype)
    return out.index_add_(0, seg, src)
def _pad(x, pw):
    flat = tuple(v for pair in reversed(pw) for v in pair)
    return torch.nn.functional.pad(x, flat)

kernel_name = 'recurrent_scan__sliding_block_cached__geglu_ffn__prompt'

def setup_inputs():

    _w = (lambda a: (lambda t: t.to(torch.bfloat16) if t.is_floating_point() else t)(torch.as_tensor(a)))
    def _A_setup():
        B, Sq, D = 1, 2048, 576
        Hq, Hkv, Sk, Dh = 32, 16, 2048, 128
        assert Hq % Hkv == 0, (Hq, Hkv)
        return {
            "x": _w((lambda *s: torch.randn(*s, dtype=torch.bfloat16) * 0.05)(B, Sq, D)),
            "k_cache": _w((lambda *s: torch.randn(*s, dtype=torch.bfloat16) * 0.8)(B, Hkv, Sk, Dh)),
            "v_cache": _w((lambda *s: torch.randn(*s, dtype=torch.bfloat16) * 0.2)(B, Hkv, Sk, Dh)),
            "wq": _w((lambda *s: torch.randn(*s, dtype=torch.bfloat16) * 0.8)(D, Hq * Dh) * (D ** -0.5)),
            "wo": _w((lambda *s: torch.randn(*s, dtype=torch.bfloat16) * 0.2)(Hq * Dh, D) * ((Hq * Dh) ** -0.5)),
        }
    _A_in = _A_setup()

    def _B_setup():
        B, S, D, F = 1, 2048, 576, 4608
        return {
            "x": _w((lambda *s: torch.randn(*s, dtype=torch.bfloat16) * 0.05)(B, S, D)),
            "w_gate": _w((lambda *s: torch.randn(*s, dtype=torch.bfloat16) * 0.1)(D, F)),
            "w_up": _w((lambda *s: torch.randn(*s, dtype=torch.bfloat16) * 0.1)(D, F)),
            "w_down": _w((lambda *s: torch.randn(*s, dtype=torch.bfloat16) * 0.1)(F, D)),
        }
    _B_in = _B_setup()

    return {
        "A_x": _A_in["x"],
        "A_k_cache": _A_in["k_cache"],
        "A_v_cache": _A_in["v_cache"],
        "A_wq": _A_in["wq"],
        "A_wo": _A_in["wo"],
        "B_x": _B_in["x"],
        "B_w_gate": _B_in["w_gate"],
        "B_w_up": _B_in["w_up"],
        "B_w_down": _B_in["w_down"],
    }

def reference(A_x, A_k_cache, A_v_cache, A_wq, A_wo, B_x, B_w_gate, B_w_up, B_w_down):
    def _A_ref(x, k_cache, v_cache, wq, wo):
        B, Sq, D = x.shape
        Hq, Dh = 32, 128
        Hkv, Sk = k_cache.shape[1], k_cache.shape[2]
        W = min(4096, max(256, Sk // 4))
        rep = Hq // Hkv
        q = (lambda x, *d: x.permute(*d))((x @ wq).reshape(B, Sq, Hq, Dh), 0, 2, 1, 3)
        k = (lambda x, n, axis: torch.repeat_interleave(x, n, dim=axis))(k_cache[:, :, Sk - W:, :], rep, axis=1)
        v = (lambda x, n, axis: torch.repeat_interleave(x, n, dim=axis))(v_cache[:, :, Sk - W:, :], rep, axis=1)
        scores = torch.einsum("bhqd,bhkd->bhqk", q, k) * (Dh ** -0.5)
        p = _softmax(scores, axis=-1)
        o = torch.einsum("bhqk,bhkd->bhqd", p, v)
        return (lambda x, *d: x.permute(*d))(o, 0, 2, 1, 3).reshape(B, Sq, Hq * Dh) @ wo

    def _B_ref(x, w_gate, w_up, w_down):
        return (_gelu(x @ w_gate) * (x @ w_up)) @ w_down

    x = A_x
    xn = _layernorm(x, axis=-1)
    s = _A_ref(xn, A_k_cache, A_v_cache, A_wq, A_wo)
    g = _silu(_B_ref(xn, B_w_gate, B_w_up, B_w_down))
    return x + s * g
```

```asm
; @launch grid=(256,1,1) block=(256,1,1) lds=163840
.amdgcn_target "amdgcn-amd-amdhsa--gfx950"
.text
.globl recurrent_scan__sliding_block_cached__geglu_ffn__prompt_kernel
.p2align 8
.type recurrent_scan__sliding_block_cached__geglu_ffn__prompt_kernel,@function
recurrent_scan__sliding_block_cached__geglu_ffn__prompt_kernel:
s_cmp_ge_u32 s2, 256
s_cbranch_scc1 mk_end
s_load_dwordx2 s[52:53], s[0:1], 0
v_lshlrev_b32 v28, 7, v0
v_lshrrev_b32 v1, 6, v0
v_and_b32 v0, 63, v0
v_readfirstlane_b32 s28, v1
s_lshr_b32 s73, s2, 3
s_and_b32 s72, s2, 7
s_lshr_b32 s29, s73, 2
s_and_b32 s68, s73, 3
s_lshl_b32 s30, s72, 2
s_add_u32 s30, s30, s68
s_lshl_b32 s72, s29, 8
s_lshl_b32 s73, s30, 3
s_add_u32 s72, s72, s73
s_lshl_b32 s73, s28, 2
s_add_u32 s72, s72, s73
v_lshrrev_b32 v156, 4, v0
v_add_u32 v157, s72, v156
v_mul_u32_u24 v157, 1152, v157
v_and_b32 v158, 15, v0
v_lshl_add_u32 v157, v158, 3, v157
s_mov_b32 s54, 2359296
s_mov_b32 s55, 0x20000
s_cmp_ge_u32 s28, 2
s_waitcnt lgkmcnt(0)
s_cbranch_scc1 mk_lnskip1
buffer_load_dwordx2 v[100:101], v157, s[52:55], 0 offen offset:0
buffer_load_dwordx2 v[102:103], v157, s[52:55], 0 offen offset:128
buffer_load_dwordx2 v[104:105], v157, s[52:55], 0 offen offset:256
buffer_load_dwordx2 v[106:107], v157, s[52:55], 0 offen offset:384
buffer_load_dwordx2 v[108:109], v157, s[52:55], 0 offen offset:512
buffer_load_dwordx2 v[110:111], v157, s[52:55], 0 offen offset:640
buffer_load_dwordx2 v[112:113], v157, s[52:55], 0 offen offset:768
buffer_load_dwordx2 v[114:115], v157, s[52:55], 0 offen offset:896
buffer_load_dwordx2 v[116:117], v157, s[52:55], 0 offen offset:1024
mk_lnskip1:
s_load_dwordx2 s[8:9], s[0:1], 88
s_load_dwordx2 s[6:7], s[0:1], 80
s_load_dwordx4 s[40:43], s[0:1], 48
s_load_dwordx2 s[16:17], s[0:1], 24
s_load_dwordx2 s[20:21], s[0:1], 8
s_load_dwordx2 s[24:25], s[0:1], 16
s_load_dwordx2 s[44:45], s[0:1], 32
s_load_dwordx2 s[46:47], s[0:1], 64
s_getpc_b64 s[4:5]
mk_pc:
v_min_u32 v29, mk_fin-mk_pc, v28
global_load_dword v8, v29, s[4:5]
v_add_u32 v28, 32768, v28
v_min_u32 v28, mk_fin-mk_pc, v28
global_load_dword v15, v28, s[4:5]
s_and_b32 s72, s2, 7
s_and_b32 s70, s72, 1
s_xor_b32 s70, s70, 1
s_and_b32 s3, s30, 7
s_lshr_b32 s69, s72, 1
v_mov_b32 v96, 0
s_waitcnt lgkmcnt(0)
s_xor_b32 s72, s28, 2
s_or_b32 s72, s72, s2
s_cmp_lg_u32 s72, 0
s_cbranch_scc1 mk_nonon
s_memrealtime s[72:73]
s_waitcnt lgkmcnt(0)
s_or_b32 s72, s72, 1
v_mov_b32 v97, s72
global_store_dword v96, v97, s[6:7] sc1
mk_nonon:
s_mov_b32 s10, 268435456
s_mov_b32 s11, 0x20000
s_mov_b32 s18, 4718592
s_mov_b32 s19, 0x20000
s_mov_b32 s22, 8388608
s_mov_b32 s23, 0x20000
s_mov_b32 s26, 8388608
s_mov_b32 s27, 0x20000
s_mov_b32 s56, s40
s_mov_b32 s57, s41
s_mov_b32 s58, 5308416
s_mov_b32 s59, 0x20000
s_cmp_ge_u32 s28, 2
s_cselect_b32 s12, s42, s40
s_cselect_b32 s13, s43, s41
s_mov_b32 s14, 5308416
s_mov_b32 s15, 0x20000
s_cmp_eq_u32 s70, 1
s_cselect_b32 s48, s46, s44
s_cselect_b32 s49, s47, s45
s_mov_b32 s50, 4718592
s_cselect_b32 s50, 5308416, s50
s_mov_b32 s51, 0x20000
s_lshl_b32 s31, s28, 10
s_lshl_b32 s46, s28, 11
s_mul_i32 s47, s28, 9216
s_and_b32 s40, s28, 1
s_mul_i32 s32, s40, 147456
s_lshl_b32 s41, s30, 8
s_add_u32 s32, s32, s41
s_mul_i32 s33, s40, 294912
s_lshl_b32 s42, s30, 5
s_add_u32 s33, s33, s42
s_add_u32 s33, s33, 8192
s_mul_i32 s34, s28, 65536
s_add_u32 s34, s34, s41
s_lshr_b32 s42, s30, 1
s_lshl_b32 s35, s42, 19
s_add_u32 s35, s35, s46
s_add_u32 s35, s35, 393216
s_lshl_b32 s43, s29, 2
s_add_u32 s43, s43, s28
s_mul_i32 s36, s43, 73728
s_add_u32 s36, s36, 0
s_mul_i32 s37, s43, 589824
s_add_u32 s37, s37, 4194304
s_lshl_b32 s40, s42, 12
s_add_u32 s39, s37, s40
s_add_u32 s39, s39, 524288
s_and_b32 s40, s30, 1
s_lshl_b32 s40, s40, 3
s_add_u32 s39, s39, s40
s_mul_i32 s38, s43, 524288
s_add_u32 s38, s38, 25165824
s_cmp_eq_u32 s70, 1
s_cselect_b32 s61, s37, s38
s_lshl_b32 s40, s69, 17
s_lshl_b32 s41, s69, 14
s_add_u32 s74, s37, s41
s_add_u32 s74, s74, 524288
s_add_u32 s61, s61, s40
s_lshl_b32 s40, s30, 14
s_add_u32 s37, s37, s40
s_add_u32 s38, s38, s40
s_mul_i32 s60, s28, 36864
s_mul_i32 s40, s68, 288
s_add_u32 s60, s60, s40
s_mul_i32 s40, s69, 147456
s_add_u32 s75, s60, s40
s_add_u32 s75, s75, 4718592
s_mul_i32 s40, s69, 1179648
s_add_u32 s60, s60, s40
s_lshr_b32 s40, s30, 3
s_lshl_b32 s41, s43, 2
s_add_u32 s40, s40, s41
s_lshl_b32 s40, s40, 7
s_and_b32 s42, s30, 7
s_lshl_b32 s42, s42, 2
s_add_u32 s40, s40, s42
s_add_u32 s63, s40, 3145728
s_add_u32 s64, s40, 3162112
s_add_u32 s41, s41, s69
s_lshl_b32 s41, s41, 7
s_cmp_eq_u32 s70, 1
s_mov_b32 s42, 3162112
s_cselect_b32 s42, 3145728, s42
s_add_u32 s66, s41, s42
s_lshl_b32 s40, s29, 2
s_add_u32 s40, s40, s68
s_and_b32 s72, s2, 7
s_lshl_b32 s41, s40, 2
s_add_u32 s42, s41, s28
s_lshl_b32 s42, s42, 7
s_lshl_b32 s73, s70, 2
s_add_u32 s73, s73, s69
s_lshl_b32 s73, s73, 2
s_add_u32 s65, s42, s73
s_add_u32 s65, s65, 3178496
s_add_u32 s42, s69, s41
s_lshl_b32 s42, s42, 7
s_add_u32 s67, s42, 3178496
s_lshl_b32 s42, s70, 2
s_add_u32 s42, s42, s69
s_lshl_b32 s42, s42, 5
s_add_u32 s42, s42, s40
s_lshl_b32 s42, s42, 2
s_add_u32 s42, s42, s28
s_mul_i32 s62, s42, 18432
s_add_u32 s62, s62, 50331648
s_mov_b32 s44, 0xc0135761
s_mov_b32 s45, 0x3e0293ee
v_mov_b32 v12, 0xbdd2d3e8
v_lshlrev_b32 v9, 4, v0
v_lshrrev_b32 v20, 4, v0
v_and_b32 v21, 15, v0
v_lshrrev_b32 v22, 2, v21
v_and_b32 v23, 3, v21
v_and_b32 v24, 1, v20
s_movk_i32 s40, 9216
v_lshrrev_b32 v25, 2, v0
v_mul_lo_u32 v25, v25, s40
v_and_b32 v26, 3, v0
v_lshlrev_b32 v27, 1, v24
v_xor_b32 v26, v26, v27
v_lshl_add_u32 v1, v26, 4, v25
v_lshrrev_b32 v25, 1, v0
v_mul_lo_u32 v25, v25, s40
v_and_b32 v26, 1, v0
v_lshl_add_u32 v2, v26, 4, v25
v_lshrrev_b32 v25, 3, v0
v_lshlrev_b32 v25, 13, v25
v_and_b32 v26, 7, v0
v_lshlrev_b32 v27, 2, v24
v_xor_b32 v26, v26, v27
v_lshl_add_u32 v3, v26, 4, v25
v_lshlrev_b32 v25, 1, v20
v_xor_b32 v26, v21, v25
v_lshlrev_b32 v26, 4, v26
v_lshl_add_u32 v10, v20, 8, v26
v_xor_b32 v11, 128, v10
v_lshl_add_u32 v25, v20, 2, v22
v_lshrrev_b32 v26, 1, v23
v_lshlrev_b32 v27, 1, v24
v_xor_b32 v26, v26, v27
v_lshlrev_b32 v26, 4, v26
v_and_b32 v27, 1, v23
v_lshl_add_u32 v26, v27, 3, v26
v_lshl_add_u32 v4, v25, 6, v26
v_xor_b32 v5, 32, v4
v_lshlrev_b32 v26, 3, v23
v_lshl_add_u32 v6, v25, 5, v26
v_lshrrev_b32 v26, 1, v22
v_lshlrev_b32 v26, 2, v26
v_xor_b32 v26, v26, v23
v_lshlrev_b32 v26, 4, v26
v_lshl_add_u32 v13, v25, 7, v26
v_xor_b32 v14, 64, v13
v_bfe_u32 v26, v25, 1, 2
v_lshlrev_b32 v26, 1, v26
v_lshrrev_b32 v27, 1, v23
v_xor_b32 v26, v26, v27
v_lshlrev_b32 v26, 4, v26
v_and_b32 v27, 1, v23
v_lshl_add_u32 v26, v27, 3, v26
v_lshl_add_u32 v184, v25, 7, v26
v_xor_b32 v185, 32, v184
v_lshrrev_b32 v26, 3, v0
v_mul_lo_u32 v26, v26, s40
v_bfe_u32 v27, v0, 4, 2
v_lshlrev_b32 v27, 1, v27
v_and_b32 v25, 7, v0
v_xor_b32 v25, v25, v27
v_lshl_add_u32 v181, v25, 4, v26
s_cmp_ge_u32 s28, 2
s_cbranch_scc1 mk_w23
s_lshr_b32 s40, s30, 3
s_lshl_b32 s41, s29, 2
s_add_u32 s40, s40, s41
s_mul_i32 s41, s40, 73728
s_lshr_b32 s42, s30, 1
s_and_b32 s42, s42, 3
s_lshl_b32 s42, s42, 10
s_add_u32 s41, s41, s42
s_add_u32 s41, s41, 0
s_lshl_b32 s40, s40, 7
s_and_b32 s42, s30, 7
s_lshl_b32 s42, s42, 1
s_add_u32 s42, s42, s28
s_lshl_b32 s42, s42, 2
s_add_u32 s40, s40, s42
s_add_u32 s101, s40, 3194880
s_and_b32 s40, s30, 1
s_lshl_b32 s40, s40, 3
s_lshl_b32 s42, s28, 2
s_add_u32 s40, s40, s42
v_lshrrev_b32 v159, 3, v158
v_lshlrev_b32 v159, 12, v159
v_and_b32 v160, 3, v158
v_lshl_add_u32 v159, v160, 8, v159
v_add_u32 v160, s40, v156
v_lshl_add_u32 v159, v160, 4, v159
v_bfe_u32 v160, v158, 2, 1
v_lshl_add_u32 v159, v160, 3, v159
s_waitcnt vmcnt(2)
v_lshlrev_b32 v120, 16, v100
v_and_b32 v121, 0xffff0000, v100
v_lshlrev_b32 v122, 16, v101
v_and_b32 v123, 0xffff0000, v101
v_lshlrev_b32 v124, 16, v102
v_and_b32 v125, 0xffff0000, v102
v_lshlrev_b32 v126, 16, v103
v_and_b32 v127, 0xffff0000, v103
v_lshlrev_b32 v128, 16, v104
v_and_b32 v129, 0xffff0000, v104
v_lshlrev_b32 v130, 16, v105
v_and_b32 v131, 0xffff0000, v105
v_lshlrev_b32 v132, 16, v106
v_and_b32 v133, 0xffff0000, v106
v_lshlrev_b32 v134, 16, v107
v_and_b32 v135, 0xffff0000, v107
v_lshlrev_b32 v136, 16, v108
v_and_b32 v137, 0xffff0000, v108
v_lshlrev_b32 v138, 16, v109
v_and_b32 v139, 0xffff0000, v109
v_lshlrev_b32 v140, 16, v110
v_and_b32 v141, 0xffff0000, v110
v_lshlrev_b32 v142, 16, v111
v_and_b32 v143, 0xffff0000, v111
v_lshlrev_b32 v144, 16, v112
v_and_b32 v145, 0xffff0000, v112
v_lshlrev_b32 v146, 16, v113
v_and_b32 v147, 0xffff0000, v113
v_lshlrev_b32 v148, 16, v114
v_and_b32 v149, 0xffff0000, v114
v_lshlrev_b32 v150, 16, v115
v_and_b32 v151, 0xffff0000, v115
v_lshlrev_b32 v152, 16, v116
v_and_b32 v153, 0xffff0000, v116
v_lshlrev_b32 v154, 16, v117
v_and_b32 v155, 0xffff0000, v117
v_add_f32 v161, v120, v121
v_add_f32 v162, v122, v123
v_add_f32 v161, v161, v124
v_add_f32 v162, v162, v125
v_add_f32 v161, v161, v126
v_add_f32 v162, v162, v127
v_add_f32 v161, v161, v128
v_add_f32 v162, v162, v129
v_add_f32 v161, v161, v130
v_add_f32 v162, v162, v131
v_add_f32 v161, v161, v132
v_add_f32 v162, v162, v133
v_add_f32 v161, v161, v134
v_add_f32 v162, v162, v135
v_add_f32 v161, v161, v136
v_add_f32 v162, v162, v137
v_add_f32 v161, v161, v138
v_add_f32 v162, v162, v139
v_add_f32 v161, v161, v140
v_add_f32 v162, v162, v141
v_add_f32 v161, v161, v142
v_add_f32 v162, v162, v143
v_add_f32 v161, v161, v144
v_add_f32 v162, v162, v145
v_add_f32 v161, v161, v146
v_add_f32 v162, v162, v147
v_add_f32 v161, v161, v148
v_add_f32 v162, v162, v149
v_add_f32 v161, v161, v150
v_add_f32 v162, v162, v151
v_add_f32 v161, v161, v152
v_add_f32 v162, v162, v153
v_add_f32 v161, v161, v154
v_add_f32 v162, v162, v155
v_add_f32 v161, v161, v162
s_nop 1
v_add_f32_dpp v161, v161, v161 row_ror:8 row_mask:0xf bank_mask:0xf
s_nop 1
v_add_f32_dpp v161, v161, v161 row_ror:4 row_mask:0xf bank_mask:0xf
s_nop 1
v_add_f32_dpp v161, v161, v161 row_ror:2 row_mask:0xf bank_mask:0xf
s_nop 1
v_add_f32_dpp v161, v161, v161 row_ror:1 row_mask:0xf bank_mask:0xf
v_mul_f32 v161, 0x3ae38e39, v161
v_sub_f32 v120, v120, v161
v_sub_f32 v121, v121, v161
v_sub_f32 v122, v122, v161
v_sub_f32 v123, v123, v161
v_sub_f32 v124, v124, v161
v_sub_f32 v125, v125, v161
v_sub_f32 v126, v126, v161
v_sub_f32 v127, v127, v161
v_sub_f32 v128, v128, v161
v_sub_f32 v129, v129, v161
v_sub_f32 v130, v130, v161
v_sub_f32 v131, v131, v161
v_sub_f32 v132, v132, v161
v_sub_f32 v133, v133, v161
v_sub_f32 v134, v134, v161
v_sub_f32 v135, v135, v161
v_sub_f32 v136, v136, v161
v_sub_f32 v137, v137, v161
v_sub_f32 v138, v138, v161
v_sub_f32 v139, v139, v161
v_sub_f32 v140, v140, v161
v_sub_f32 v141, v141, v161
v_sub_f32 v142, v142, v161
v_sub_f32 v143, v143, v161
v_sub_f32 v144, v144, v161
v_sub_f32 v145, v145, v161
v_sub_f32 v146, v146, v161
v_sub_f32 v147, v147, v161
v_sub_f32 v148, v148, v161
v_sub_f32 v149, v149, v161
v_sub_f32 v150, v150, v161
v_sub_f32 v151, v151, v161
v_sub_f32 v152, v152, v161
v_sub_f32 v153, v153, v161
v_sub_f32 v154, v154, v161
v_sub_f32 v155, v155, v161
v_mul_f32 v162, v120, v120
v_mul_f32 v163, v121, v121
v_fmac_f32 v162, v122, v122
v_fmac_f32 v163, v123, v123
v_fmac_f32 v162, v124, v124
v_fmac_f32 v163, v125, v125
v_fmac_f32 v162, v126, v126
v_fmac_f32 v163, v127, v127
v_fmac_f32 v162, v128, v128
v_fmac_f32 v163, v129, v129
v_fmac_f32 v162, v130, v130
v_fmac_f32 v163, v131, v131
v_fmac_f32 v162, v132, v132
v_fmac_f32 v163, v133, v133
v_fmac_f32 v162, v134, v134
v_fmac_f32 v163, v135, v135
v_fmac_f32 v162, v136, v136
v_fmac_f32 v163, v137, v137
v_fmac_f32 v162, v138, v138
v_fmac_f32 v163, v139, v139
v_fmac_f32 v162, v140, v140
v_fmac_f32 v163, v141, v141
v_fmac_f32 v162, v142, v142
v_fmac_f32 v163, v143, v143
v_fmac_f32 v162, v144, v144
v_fmac_f32 v163, v145, v145
v_fmac_f32 v162, v146, v146
v_fmac_f32 v163, v147, v147
v_fmac_f32 v162, v148, v148
v_fmac_f32 v163, v149, v149
v_fmac_f32 v162, v150, v150
v_fmac_f32 v163, v151, v151
v_fmac_f32 v162, v152, v152
v_fmac_f32 v163, v153, v153
v_fmac_f32 v162, v154, v154
v_fmac_f32 v163, v155, v155
v_add_f32 v162, v162, v163
s_nop 1
v_add_f32_dpp v162, v162, v162 row_ror:8 row_mask:0xf bank_mask:0xf
s_nop 1
v_add_f32_dpp v162, v162, v162 row_ror:4 row_mask:0xf bank_mask:0xf
s_nop 1
v_add_f32_dpp v162, v162, v162 row_ror:2 row_mask:0xf bank_mask:0xf
s_nop 1
v_add_f32_dpp v162, v162, v162 row_ror:1 row_mask:0xf bank_mask:0xf
v_mov_b32 v163, 0x3727c5ac
v_fmac_f32 v163, 0x3ae38e39, v162
v_rsq_f32 v163, v163
s_nop 0
v_mul_f32 v120, v120, v163
v_mul_f32 v121, v121, v163
v_mul_f32 v122, v122, v163
v_mul_f32 v123, v123, v163
v_mul_f32 v124, v124, v163
v_mul_f32 v125, v125, v163
v_mul_f32 v126, v126, v163
v_mul_f32 v127, v127, v163
v_mul_f32 v128, v128, v163
v_mul_f32 v129, v129, v163
v_mul_f32 v130, v130, v163
v_mul_f32 v131, v131, v163
v_mul_f32 v132, v132, v163
v_mul_f32 v133, v133, v163
v_mul_f32 v134, v134, v163
v_mul_f32 v135, v135, v163
v_mul_f32 v136, v136, v163
v_mul_f32 v137, v137, v163
v_mul_f32 v138, v138, v163
v_mul_f32 v139, v139, v163
v_mul_f32 v140, v140, v163
v_mul_f32 v141, v141, v163
v_mul_f32 v142, v142, v163
v_mul_f32 v143, v143, v163
v_mul_f32 v144, v144, v163
v_mul_f32 v145, v145, v163
v_mul_f32 v146, v146, v163
v_mul_f32 v147, v147, v163
v_mul_f32 v148, v148, v163
v_mul_f32 v149, v149, v163
v_mul_f32 v150, v150, v163
v_mul_f32 v151, v151, v163
v_mul_f32 v152, v152, v163
v_mul_f32 v153, v153, v163
v_mul_f32 v154, v154, v163
v_mul_f32 v155, v155, v163
v_cvt_pk_bf16_f32 v100, v120, v121
v_cvt_pk_bf16_f32 v101, v122, v123
v_cvt_pk_bf16_f32 v102, v124, v125
v_cvt_pk_bf16_f32 v103, v126, v127
v_cvt_pk_bf16_f32 v104, v128, v129
v_cvt_pk_bf16_f32 v105, v130, v131
v_cvt_pk_bf16_f32 v106, v132, v133
v_cvt_pk_bf16_f32 v107, v134, v135
v_cvt_pk_bf16_f32 v108, v136, v137
v_cvt_pk_bf16_f32 v109, v138, v139
v_cvt_pk_bf16_f32 v110, v140, v141
v_cvt_pk_bf16_f32 v111, v142, v143
v_cvt_pk_bf16_f32 v112, v144, v145
v_cvt_pk_bf16_f32 v113, v146, v147
v_cvt_pk_bf16_f32 v114, v148, v149
v_cvt_pk_bf16_f32 v115, v150, v151
v_cvt_pk_bf16_f32 v116, v152, v153
v_cvt_pk_bf16_f32 v117, v154, v155
s_add_u32 s42, s41, 0
buffer_store_dwordx2 v[100:101], v159, s[8:11], s42 offen sc1
s_add_u32 s42, s41, 8192
buffer_store_dwordx2 v[102:103], v159, s[8:11], s42 offen sc1
s_add_u32 s42, s41, 16384
buffer_store_dwordx2 v[104:105], v159, s[8:11], s42 offen sc1
s_add_u32 s42, s41, 24576
buffer_store_dwordx2 v[106:107], v159, s[8:11], s42 offen sc1
s_add_u32 s42, s41, 32768
buffer_store_dwordx2 v[108:109], v159, s[8:11], s42 offen sc1
s_add_u32 s42, s41, 40960
buffer_store_dwordx2 v[110:111], v159, s[8:11], s42 offen sc1
s_add_u32 s42, s41, 49152
buffer_store_dwordx2 v[112:113], v159, s[8:11], s42 offen sc1
s_add_u32 s42, s41, 57344
buffer_store_dwordx2 v[114:115], v159, s[8:11], s42 offen sc1
s_add_u32 s42, s41, 65536
buffer_store_dwordx2 v[116:117], v159, s[8:11], s42 offen sc1
s_barrier
global_load_dword v97, v96, s[6:7] sc1
s_waitcnt vmcnt(0)
v_readfirstlane_b32 s100, v97
s_nop 3
s_cmp_lg_u32 s100, 0
s_cbranch_scc0 mk_slowN
mk_backN:
v_mov_b32 v99, 268435456
v_cmp_eq_u32 vcc, 0, v0
s_nop 1
v_cndmask_b32 v98, v99, 0, vcc
v_lshlrev_b32 v97, 2, v0
v_cmp_gt_u32 vcc, 8, v0
s_nop 1
v_cndmask_b32 v97, v99, v97, vcc
v_mov_b32 v99, s100
buffer_store_dword v99, v98, s[8:11], s101 offen sc1
mk_join:
v_lshlrev_b32 v97, 2, v0
v_mov_b32 v96, 268435456
v_cmp_gt_u32 vcc, 16, v0
s_nop 1
v_cndmask_b32 v97, v96, v97, vcc
s_lshl_b32 s40, s29, 2
s_add_u32 s40, s40, s28
s_lshl_b32 s40, s40, 7
s_add_u32 s101, s40, 3194880
s_mov_b32 s71, 0x20000
buffer_load_dword v96, v97, s[8:11], s101 offen sc1
s_sleep 3
buffer_load_dword v164, v97, s[8:11], s101 offen sc1
s_sleep 3
buffer_load_dword v165, v97, s[8:11], s101 offen sc1
mk_poll_L:
s_waitcnt vmcnt(2)
v_cmp_eq_u32 vcc, s100, v96
s_sub_u32 s71, s71, 1
s_cbranch_scc1 mk_pollx_L
s_nop 1
s_and_b32 s43, vcc_lo, 65535
s_cmp_eq_u32 s43, 65535
s_cbranch_scc1 mk_pollx_L
buffer_load_dword v96, v97, s[8:11], s101 offen sc1
s_sleep 3
s_waitcnt vmcnt(2)
v_cmp_eq_u32 vcc, s100, v164
s_sub_u32 s71, s71, 1
s_cbranch_scc1 mk_pollx_L
s_nop 1
s_and_b32 s43, vcc_lo, 65535
s_cmp_eq_u32 s43, 65535
s_cbranch_scc1 mk_pollx_L
buffer_load_dword v164, v97, s[8:11], s101 offen sc1
s_sleep 3
s_waitcnt vmcnt(2)
v_cmp_eq_u32 vcc, s100, v165
s_sub_u32 s71, s71, 1
s_cbranch_scc1 mk_pollx_L
s_nop 1
s_and_b32 s43, vcc_lo, 65535
s_cmp_eq_u32 s43, 65535
s_cbranch_scc1 mk_pollx_L
buffer_load_dword v165, v97, s[8:11], s101 offen sc1
s_sleep 3
s_branch mk_poll_L
mk_pollx_L:
s_add_u32 s41, s36, 0
buffer_load_dwordx4 a[0:3], v9, s[8:11], s41 offen offset:0 sc1
buffer_load_dwordx4 a[4:7], v9, s[8:11], s41 offen offset:1024 sc1
buffer_load_dwordx4 a[8:11], v9, s[8:11], s41 offen offset:2048 sc1
buffer_load_dwordx4 a[12:15], v9, s[8:11], s41 offen offset:3072 sc1
s_add_u32 s41, s36, 4096
buffer_load_dwordx4 a[16:19], v9, s[8:11], s41 offen offset:0 sc1
buffer_load_dwordx4 a[20:23], v9, s[8:11], s41 offen offset:1024 sc1
buffer_load_dwordx4 a[24:27], v9, s[8:11], s41 offen offset:2048 sc1
buffer_load_dwordx4 a[28:31], v9, s[8:11], s41 offen offset:3072 sc1
s_add_u32 s41, s36, 8192
buffer_load_dwordx4 a[32:35], v9, s[8:11], s41 offen offset:0 sc1
buffer_load_dwordx4 a[36:39], v9, s[8:11], s41 offen offset:1024 sc1
buffer_load_dwordx4 a[40:43], v9, s[8:11], s41 offen offset:2048 sc1
buffer_load_dwordx4 a[44:47], v9, s[8:11], s41 offen offset:3072 sc1
v_add_u32 v184, 0x18000, v184
v_add_u32 v185, 0x18000, v185
s_barrier
ds_read_b64_tr_b16 v[16:17], v184 offset:0
ds_read_b64_tr_b16 v[18:19], v184 offset:2048
ds_read_b64_tr_b16 v[20:21], v185 offset:0
ds_read_b64_tr_b16 v[22:23], v185 offset:2048
ds_read_b64_tr_b16 v[24:25], v184 offset:4096
ds_read_b64_tr_b16 v[26:27], v184 offset:6144
s_add_u32 m0, s46, 122880
s_waitcnt lgkmcnt(2)
s_waitcnt vmcnt(8)
v_mfma_f32_16x16x32_bf16 v[32:35], v[16:19], a[0:3], 0
ds_read_b64_tr_b16 v[28:29], v185 offset:4096
s_add_u32 s40, s32, 884736
v_mfma_f32_16x16x32_bf16 v[36:39], v[16:19], a[4:7], 0
ds_read_b64_tr_b16 v[30:31], v185 offset:6144
v_mfma_f32_16x16x32_bf16 v[40:43], v[16:19], a[8:11], 0
buffer_load_dwordx4 v181, s[12:15], s40 offen lds
s_add_u32 m0, s46, 123904
s_add_u32 s40, s32, 958464
v_mfma_f32_16x16x32_bf16 v[44:47], v[16:19], a[12:15], 0
buffer_load_dwordx4 v181, s[12:15], s40 offen lds
s_add_u32 m0, s46, 131072
s_add_u32 s40, s32, 1179648
v_mfma_f32_16x16x32_bf16 v[48:51], v[20:23], a[0:3], 0
ds_read_b64_tr_b16 v[16:17], v184 offset:8192
v_mfma_f32_16x16x32_bf16 v[52:55], v[20:23], a[4:7], 0
ds_read_b64_tr_b16 v[18:19], v184 offset:10240
v_mfma_f32_16x16x32_bf16 v[56:59], v[20:23], a[8:11], 0
buffer_load_dwordx4 v181, s[12:15], s40 offen lds
s_add_u32 m0, s46, 132096
s_add_u32 s40, s32, 1253376
v_mfma_f32_16x16x32_bf16 v[60:63], v[20:23], a[12:15], 0
buffer_load_dwordx4 v181, s[12:15], s40 offen lds
s_add_u32 m0, s46, 139264
s_waitcnt lgkmcnt(2)
v_mfma_f32_16x16x32_bf16 v[64:67], v[24:27], a[0:3], 0
ds_read_b64_tr_b16 v[20:21], v185 offset:8192
s_add_u32 s40, s32, 1474560
v_mfma_f32_16x16x32_bf16 v[68:71], v[24:27], a[4:7], 0
ds_read_b64_tr_b16 v[22:23], v185 offset:10240
v_mfma_f32_16x16x32_bf16 v[72:75], v[24:27], a[8:11], 0
buffer_load_dwordx4 v181, s[12:15], s40 offen lds
s_add_u32 m0, s46, 140288
s_add_u32 s40, s32, 1548288
v_mfma_f32_16x16x32_bf16 v[76:79], v[24:27], a[12:15], 0
buffer_load_dwordx4 v181, s[12:15], s40 offen lds
s_add_u32 m0, s46, 0
s_add_u32 s40, s32, 1769472
v_mfma_f32_16x16x32_bf16 v[80:83], v[28:31], a[0:3], 0
ds_read_b64_tr_b16 v[24:25], v184 offset:12288
v_mfma_f32_16x16x32_bf16 v[84:87], v[28:31], a[4:7], 0
ds_read_b64_tr_b16 v[26:27], v184 offset:14336
v_mfma_f32_16x16x32_bf16 v[88:91], v[28:31], a[8:11], 0
buffer_load_dwordx4 v181, s[12:15], s40 offen lds
s_add_u32 m0, s46, 1024
s_add_u32 s40, s32, 1843200
v_mfma_f32_16x16x32_bf16 v[92:95], v[28:31], a[12:15], 0
buffer_load_dwordx4 v181, s[12:15], s40 offen lds
s_waitcnt lgkmcnt(2)
s_waitcnt vmcnt(12)
v_mfma_f32_16x16x32_bf16 v[32:35], v[16:19], a[16:19], v[32:35]
ds_read_b64_tr_b16 v[28:29], v185 offset:12288
s_add_u32 m0, s46, 8192
s_add_u32 s40, s32, 2064384
v_mfma_f32_16x16x32_bf16 v[36:39], v[16:19], a[20:23], v[36:39]
ds_read_b64_tr_b16 v[30:31], v185 offset:14336
v_mfma_f32_16x16x32_bf16 v[40:43], v[16:19], a[24:27], v[40:43]
buffer_load_dwordx4 v181, s[12:15], s40 offen lds
s_add_u32 m0, s46, 9216
s_add_u32 s40, s32, 2138112
v_mfma_f32_16x16x32_bf16 v[44:47], v[16:19], a[28:31], v[44:47]
buffer_load_dwordx4 v181, s[12:15], s40 offen lds
s_add_u32 m0, s46, 16384
s_add_u32 s40, s32, 2359296
v_mfma_f32_16x16x32_bf16 v[48:51], v[20:23], a[16:19], v[48:51]
ds_read_b64_tr_b16 v[16:17], v184 offset:16384
v_mfma_f32_16x16x32_bf16 v[52:55], v[20:23], a[20:23], v[52:55]
ds_read_b64_tr_b16 v[18:19], v184 offset:18432
v_mfma_f32_16x16x32_bf16 v[56:59], v[20:23], a[24:27], v[56:59]
buffer_load_dwordx4 v181, s[12:15], s40 offen lds
s_add_u32 m0, s46, 17408
s_add_u32 s40, s32, 2433024
v_mfma_f32_16x16x32_bf16 v[60:63], v[20:23], a[28:31], v[60:63]
buffer_load_dwordx4 v181, s[12:15], s40 offen lds
s_add_u32 s41, s36, 12288
s_waitcnt lgkmcnt(2)
v_mfma_f32_16x16x32_bf16 v[64:67], v[24:27], a[16:19], v[64:67]
ds_read_b64_tr_b16 v[20:21], v185 offset:16384
s_lshl_b32 s72, s28, 13
s_add_u32 s72, s72, mk_L_GU1-mk_pc
v_mfma_f32_16x16x32_bf16 v[68:71], v[24:27], a[20:23], v[68:71]
ds_read_b64_tr_b16 v[22:23], v185 offset:18432
v_lshl_add_u32 v179, v0, 7, s72
v_mfma_f32_16x16x32_bf16 v[72:75], v[24:27], a[24:27], v[72:75]
buffer_load_dwordx4 a[48:51], v9, s[8:11], s41 offen offset:0 sc1
v_mfma_f32_16x16x32_bf16 v[76:79], v[24:27], a[28:31], v[76:79]
buffer_load_dwordx4 a[52:55], v9, s[8:11], s41 offen offset:1024 sc1
v_mfma_f32_16x16x32_bf16 v[80:83], v[28:31], a[16:19], v[80:83]
ds_read_b64_tr_b16 v[24:25], v184 offset:20480
v_min_u32 v179, mk_fin-mk_pc, v179
v_mfma_f32_16x16x32_bf16 v[84:87], v[28:31], a[20:23], v[84:87]
ds_read_b64_tr_b16 v[26:27], v184 offset:22528
buffer_load_dwordx4 a[56:59], v9, s[8:11], s41 offen offset:2048 sc1
v_mfma_f32_16x16x32_bf16 v[88:91], v[28:31], a[24:27], v[88:91]
buffer_load_dwordx4 a[60:63], v9, s[8:11], s41 offen offset:3072 sc1
s_add_u32 s41, s36, 16384
v_mfma_f32_16x16x32_bf16 v[92:95], v[28:31], a[28:31], v[92:95]
buffer_load_dwordx4 a[64:67], v9, s[8:11], s41 offen offset:0 sc1
s_waitcnt lgkmcnt(2)
s_waitcnt vmcnt(17)
v_mfma_f32_16x16x32_bf16 v[32:35], v[16:19], a[32:35], v[32:35]
ds_read_b64_tr_b16 v[28:29], v185 offset:20480
v_mfma_f32_16x16x32_bf16 v[36:39], v[16:19], a[36:39], v[36:39]
ds_read_b64_tr_b16 v[30:31], v185 offset:22528
v_mfma_f32_16x16x32_bf16 v[40:43], v[16:19], a[40:43], v[40:43]
buffer_load_dwordx4 a[68:71], v9, s[8:11], s41 offen offset:1024 sc1
s_add_u32 m0, s46, 24576
s_add_u32 s40, s32, 2654208
v_mfma_f32_16x16x32_bf16 v[44:47], v[16:19], a[44:47], v[44:47]
v_add_u32 v184, 0x6000, v184
v_add_u32 v185, 0x6000, v185
v_mfma_f32_16x16x32_bf16 v[48:51], v[20:23], a[32:35], v[48:51]
s_waitcnt vmcnt(12)
s_barrier
ds_read_b64_tr_b16 v[16:17], v184 offset:0
v_mfma_f32_16x16x32_bf16 v[52:55], v[20:23], a[36:39], v[52:55]
ds_read_b64_tr_b16 v[18:19], v184 offset:2048
buffer_load_dwordx4 a[72:75], v9, s[8:11], s41 offen offset:2048 sc1
v_mfma_f32_16x16x32_bf16 v[56:59], v[20:23], a[40:43], v[56:59]
buffer_load_dwordx4 a[76:79], v9, s[8:11], s41 offen offset:3072 sc1
v_mfma_f32_16x16x32_bf16 v[60:63], v[20:23], a[44:47], v[60:63]
buffer_load_dwordx4 v181, s[12:15], s40 offen lds
s_add_u32 m0, s46, 25600
s_waitcnt lgkmcnt(2)
v_mfma_f32_16x16x32_bf16 v[64:67], v[24:27], a[32:35], v[64:67]
ds_read_b64_tr_b16 v[20:21], v185 offset:0
s_add_u32 s40, s32, 2727936
v_mfma_f32_16x16x32_bf16 v[68:71], v[24:27], a[36:39], v[68:71]
ds_read_b64_tr_b16 v[22:23], v185 offset:2048
v_mfma_f32_16x16x32_bf16 v[72:75], v[24:27], a[40:43], v[72:75]
buffer_load_dwordx4 v181, s[12:15], s40 offen lds
s_add_u32 m0, s46, 32768
s_add_u32 s40, s32, 2949120
v_mfma_f32_16x16x32_bf16 v[76:79], v[24:27], a[44:47], v[76:79]
buffer_load_dwordx4 v181, s[12:15], s40 offen lds
s_add_u32 m0, s46, 33792
s_add_u32 s40, s32, 3022848
v_mfma_f32_16x16x32_bf16 v[80:83], v[28:31], a[32:35], v[80:83]
ds_read_b64_tr_b16 v[24:25], v184 offset:4096
v_mfma_f32_16x16x32_bf16 v[84:87], v[28:31], a[36:39], v[84:87]
ds_read_b64_tr_b16 v[26:27], v184 offset:6144
buffer_load_dwordx4 v181, s[12:15], s40 offen lds
v_mfma_f32_16x16x32_bf16 v[88:91], v[28:31], a[40:43], v[88:91]
s_add_u32 m0, s46, 40960
s_add_u32 s40, s32, 3244032
buffer_load_dwordx4 v181, s[12:15], s40 offen lds
v_mfma_f32_16x16x32_bf16 v[92:95], v[28:31], a[44:47], v[92:95]
global_load_dword v8, v179, s[4:5]
s_waitcnt lgkmcnt(2)
s_waitcnt vmcnt(10)
v_mfma_f32_16x16x32_bf16 v[32:35], v[16:19], a[48:51], v[32:35]
ds_read_b64_tr_b16 v[28:29], v185 offset:4096
s_add_u32 m0, s46, 41984
s_add_u32 s40, s32, 3317760
v_mfma_f32_16x16x32_bf16 v[36:39], v[16:19], a[52:55], v[36:39]
ds_read_b64_tr_b16 v[30:31], v185 offset:6144
s_add_u32 s41, s36, 20480
buffer_load_dwordx4 v181, s[12:15], s40 offen lds
v_mfma_f32_16x16x32_bf16 v[40:43], v[16:19], a[56:59], v[40:43]
buffer_load_dwordx4 a[80:83], v9, s[8:11], s41 offen offset:0 sc1
v_mfma_f32_16x16x32_bf16 v[44:47], v[16:19], a[60:63], v[44:47]
buffer_load_dwordx4 a[84:87], v9, s[8:11], s41 offen offset:1024 sc1
v_mfma_f32_16x16x32_bf16 v[48:51], v[20:23], a[48:51], v[48:51]
ds_read_b64_tr_b16 v[16:17], v184 offset:8192
v_mfma_f32_16x16x32_bf16 v[52:55], v[20:23], a[52:55], v[52:55]
ds_read_b64_tr_b16 v[18:19], v184 offset:10240
v_mfma_f32_16x16x32_bf16 v[56:59], v[20:23], a[56:59], v[56:59]
buffer_load_dwordx4 a[88:91], v9, s[8:11], s41 offen offset:2048 sc1
v_mfma_f32_16x16x32_bf16 v[60:63], v[20:23], a[60:63], v[60:63]
buffer_load_dwordx4 a[92:95], v9, s[8:11], s41 offen offset:3072 sc1
s_add_u32 s41, s36, 24576
s_waitcnt lgkmcnt(2)
v_mfma_f32_16x16x32_bf16 v[64:67], v[24:27], a[48:51], v[64:67]
ds_read_b64_tr_b16 v[20:21], v185 offset:8192
v_mfma_f32_16x16x32_bf16 v[68:71], v[24:27], a[52:55], v[68:71]
ds_read_b64_tr_b16 v[22:23], v185 offset:10240
v_mfma_f32_16x16x32_bf16 v[72:75], v[24:27], a[56:59], v[72:75]
buffer_load_dwordx4 a[96:99], v9, s[8:11], s41 offen offset:0 sc1
v_mfma_f32_16x16x32_bf16 v[76:79], v[24:27], a[60:63], v[76:79]
buffer_load_dwordx4 a[100:103], v9, s[8:11], s41 offen offset:1024 sc1
v_mfma_f32_16x16x32_bf16 v[80:83], v[28:31], a[48:51], v[80:83]
ds_read_b64_tr_b16 v[24:25], v184 offset:12288
v_mfma_f32_16x16x32_bf16 v[84:87], v[28:31], a[52:55], v[84:87]
ds_read_b64_tr_b16 v[26:27], v184 offset:14336
buffer_load_dwordx4 a[104:107], v9, s[8:11], s41 offen offset:2048 sc1
v_mfma_f32_16x16x32_bf16 v[88:91], v[28:31], a[56:59], v[88:91]
buffer_load_dwordx4 a[108:111], v9, s[8:11], s41 offen offset:3072 sc1
s_add_u32 s41, s36, 28672
v_mfma_f32_16x16x32_bf16 v[92:95], v[28:31], a[60:63], v[92:95]
buffer_load_dwordx4 a[112:115], v9, s[8:11], s41 offen offset:0 sc1
s_waitcnt lgkmcnt(2)
s_waitcnt vmcnt(16)
v_mfma_f32_16x16x32_bf16 v[32:35], v[16:19], a[64:67], v[32:35]
ds_read_b64_tr_b16 v[28:29], v185 offset:12288
v_mfma_f32_16x16x32_bf16 v[36:39], v[16:19], a[68:71], v[36:39]
ds_read_b64_tr_b16 v[30:31], v185 offset:14336
v_mfma_f32_16x16x32_bf16 v[40:43], v[16:19], a[72:75], v[40:43]
buffer_load_dwordx4 a[116:119], v9, s[8:11], s41 offen offset:1024 sc1
s_add_u32 m0, s46, 49152
s_add_u32 s40, s32, 3538944
v_mfma_f32_16x16x32_bf16 v[44:47], v[16:19], a[76:79], v[44:47]
buffer_load_dwordx4 a[120:123], v9, s[8:11], s41 offen offset:2048 sc1
v_mfma_f32_16x16x32_bf16 v[48:51], v[20:23], a[64:67], v[48:51]
ds_read_b64_tr_b16 v[16:17], v184 offset:16384
v_mfma_f32_16x16x32_bf16 v[52:55], v[20:23], a[68:71], v[52:55]
ds_read_b64_tr_b16 v[18:19], v184 offset:18432
v_mfma_f32_16x16x32_bf16 v[56:59], v[20:23], a[72:75], v[56:59]
buffer_load_dwordx4 a[124:127], v9, s[8:11], s41 offen offset:3072 sc1
v_mfma_f32_16x16x32_bf16 v[60:63], v[20:23], a[76:79], v[60:63]
buffer_load_dwordx4 v181, s[12:15], s40 offen lds
s_add_u32 m0, s46, 50176
s_waitcnt lgkmcnt(2)
v_mfma_f32_16x16x32_bf16 v[64:67], v[24:27], a[64:67], v[64:67]
ds_read_b64_tr_b16 v[20:21], v185 offset:16384
s_add_u32 s40, s32, 3612672
v_mfma_f32_16x16x32_bf16 v[68:71], v[24:27], a[68:71], v[68:71]
ds_read_b64_tr_b16 v[22:23], v185 offset:18432
v_mfma_f32_16x16x32_bf16 v[72:75], v[24:27], a[72:75], v[72:75]
buffer_load_dwordx4 v181, s[12:15], s40 offen lds
s_add_u32 m0, s46, 57344
s_add_u32 s40, s32, 3833856
v_mfma_f32_16x16x32_bf16 v[76:79], v[24:27], a[76:79], v[76:79]
buffer_load_dwordx4 v181, s[12:15], s40 offen lds
s_add_u32 m0, s46, 58368
s_add_u32 s40, s32, 3907584
v_mfma_f32_16x16x32_bf16 v[80:83], v[28:31], a[64:67], v[80:83]
ds_read_b64_tr_b16 v[24:25], v184 offset:20480
v_mfma_f32_16x16x32_bf16 v[84:87], v[28:31], a[68:71], v[84:87]
ds_read_b64_tr_b16 v[26:27], v184 offset:22528
buffer_load_dwordx4 v181, s[12:15], s40 offen lds
v_mfma_f32_16x16x32_bf16 v[88:91], v[28:31], a[72:75], v[88:91]
s_add_u32 m0, s46, 65536
s_add_u32 s40, s32, 4128768
buffer_load_dwordx4 v181, s[12:15], s40 offen lds
v_mfma_f32_16x16x32_bf16 v[92:95], v[28:31], a[76:79], v[92:95]
s_add_u32 m0, s46, 66560
s_waitcnt lgkmcnt(2)
s_waitcnt vmcnt(13)
v_mfma_f32_16x16x32_bf16 v[32:35], v[16:19], a[80:83], v[32:35]
ds_read_b64_tr_b16 v[28:29], v185 offset:20480
s_add_u32 s40, s32, 4202496
s_add_u32 s41, s36, 32768
v_mfma_f32_16x16x32_bf16 v[36:39], v[16:19], a[84:87], v[36:39]
ds_read_b64_tr_b16 v[30:31], v185 offset:22528
buffer_load_dwordx4 v181, s[12:15], s40 offen lds
v_mfma_f32_16x16x32_bf16 v[40:43], v[16:19], a[88:91], v[40:43]
buffer_load_dwordx4 a[128:131], v9, s[8:11], s41 offen offset:0 sc1
v_mfma_f32_16x16x32_bf16 v[44:47], v[16:19], a[92:95], v[44:47]
v_add_u32 v184, 0xfffe2000, v184
v_add_u32 v185, 0xfffe2000, v185
v_mfma_f32_16x16x32_bf16 v[48:51], v[20:23], a[80:83], v[48:51]
s_barrier
ds_read_b64_tr_b16 v[16:17], v184 offset:0
v_mfma_f32_16x16x32_bf16 v[52:55], v[20:23], a[84:87], v[52:55]
ds_read_b64_tr_b16 v[18:19], v184 offset:2048
buffer_load_dwordx4 a[132:135], v9, s[8:11], s41 offen offset:1024 sc1
v_mfma_f32_16x16x32_bf16 v[56:59], v[20:23], a[88:91], v[56:59]
buffer_load_dwordx4 a[136:139], v9, s[8:11], s41 offen offset:2048 sc1
v_mfma_f32_16x16x32_bf16 v[60:63], v[20:23], a[92:95], v[60:63]
buffer_load_dwordx4 a[140:143], v9, s[8:11], s41 offen offset:3072 sc1
s_add_u32 s41, s36, 36864
s_waitcnt lgkmcnt(2)
v_mfma_f32_16x16x32_bf16 v[64:67], v[24:27], a[80:83], v[64:67]
ds_read_b64_tr_b16 v[20:21], v185 offset:0
v_mfma_f32_16x16x32_bf16 v[68:71], v[24:27], a[84:87], v[68:71]
ds_read_b64_tr_b16 v[22:23], v185 offset:2048
v_mfma_f32_16x16x32_bf16 v[72:75], v[24:27], a[88:91], v[72:75]
buffer_load_dwordx4 a[144:147], v9, s[8:11], s41 offen offset:0 sc1
v_mfma_f32_16x16x32_bf16 v[76:79], v[24:27], a[92:95], v[76:79]
buffer_load_dwordx4 a[148:151], v9, s[8:11], s41 offen offset:1024 sc1
v_mfma_f32_16x16x32_bf16 v[80:83], v[28:31], a[80:83], v[80:83]
ds_read_b64_tr_b16 v[24:25], v184 offset:4096
v_mfma_f32_16x16x32_bf16 v[84:87], v[28:31], a[84:87], v[84:87]
ds_read_b64_tr_b16 v[26:27], v184 offset:6144
buffer_load_dwordx4 a[152:155], v9, s[8:11], s41 offen offset:2048 sc1
v_mfma_f32_16x16x32_bf16 v[88:91], v[28:31], a[88:91], v[88:91]
buffer_load_dwordx4 a[156:159], v9, s[8:11], s41 offen offset:3072 sc1
s_add_u32 s41, s36, 40960
v_mfma_f32_16x16x32_bf16 v[92:95], v[28:31], a[92:95], v[92:95]
buffer_load_dwordx4 a[160:163], v9, s[8:11], s41 offen offset:0 sc1
s_waitcnt lgkmcnt(2)
s_waitcnt vmcnt(19)
v_mfma_f32_16x16x32_bf16 v[32:35], v[16:19], a[96:99], v[32:35]
ds_read_b64_tr_b16 v[28:29], v185 offset:4096
v_mfma_f32_16x16x32_bf16 v[36:39], v[16:19], a[100:103], v[36:39]
ds_read_b64_tr_b16 v[30:31], v185 offset:6144
v_mfma_f32_16x16x32_bf16 v[40:43], v[16:19], a[104:107], v[40:43]
buffer_load_dwordx4 a[164:167], v9, s[8:11], s41 offen offset:1024 sc1
s_add_u32 m0, s46, 73728
s_add_u32 s40, s32, 4423680
v_mfma_f32_16x16x32_bf16 v[44:47], v[16:19], a[108:111], v[44:47]
buffer_load_dwordx4 a[168:171], v9, s[8:11], s41 offen offset:2048 sc1
v_mfma_f32_16x16x32_bf16 v[48:51], v[20:23], a[96:99], v[48:51]
ds_read_b64_tr_b16 v[16:17], v184 offset:8192
v_mfma_f32_16x16x32_bf16 v[52:55], v[20:23], a[100:103], v[52:55]
ds_read_b64_tr_b16 v[18:19], v184 offset:10240
v_mfma_f32_16x16x32_bf16 v[56:59], v[20:23], a[104:107], v[56:59]
buffer_load_dwordx4 a[172:175], v9, s[8:11], s41 offen offset:3072 sc1
v_mfma_f32_16x16x32_bf16 v[60:63], v[20:23], a[108:111], v[60:63]
buffer_load_dwordx4 v181, s[12:15], s40 offen lds
s_add_u32 m0, s46, 74752
s_waitcnt lgkmcnt(2)
v_mfma_f32_16x16x32_bf16 v[64:67], v[24:27], a[96:99], v[64:67]
ds_read_b64_tr_b16 v[20:21], v185 offset:8192
s_add_u32 s40, s32, 4497408
v_mfma_f32_16x16x32_bf16 v[68:71], v[24:27], a[100:103], v[68:71]
ds_read_b64_tr_b16 v[22:23], v185 offset:10240
v_mfma_f32_16x16x32_bf16 v[72:75], v[24:27], a[104:107], v[72:75]
buffer_load_dwordx4 v181, s[12:15], s40 offen lds
s_add_u32 m0, s46, 81920
s_add_u32 s40, s32, 4718592
v_mfma_f32_16x16x32_bf16 v[76:79], v[24:27], a[108:111], v[76:79]
buffer_load_dwordx4 v181, s[12:15], s40 offen lds
s_add_u32 m0, s46, 82944
s_add_u32 s40, s32, 4792320
v_mfma_f32_16x16x32_bf16 v[80:83], v[28:31], a[96:99], v[80:83]
ds_read_b64_tr_b16 v[24:25], v184 offset:12288
v_mfma_f32_16x16x32_bf16 v[84:87], v[28:31], a[100:103], v[84:87]
ds_read_b64_tr_b16 v[26:27], v184 offset:14336
buffer_load_dwordx4 v181, s[12:15], s40 offen lds
v_mfma_f32_16x16x32_bf16 v[88:91], v[28:31], a[104:107], v[88:91]
s_add_u32 m0, s46, 90112
s_add_u32 s40, s32, 5013504
buffer_load_dwordx4 v181, s[12:15], s40 offen lds
v_mfma_f32_16x16x32_bf16 v[92:95], v[28:31], a[108:111], v[92:95]
s_add_u32 m0, s46, 91136
s_waitcnt lgkmcnt(2)
s_waitcnt vmcnt(23)
v_mfma_f32_16x16x32_bf16 v[32:35], v[16:19], a[112:115], v[32:35]
ds_read_b64_tr_b16 v[28:29], v185 offset:12288
s_add_u32 s40, s32, 5087232
s_add_u32 s41, s36, 45056
v_mfma_f32_16x16x32_bf16 v[36:39], v[16:19], a[116:119], v[36:39]
ds_read_b64_tr_b16 v[30:31], v185 offset:14336
buffer_load_dwordx4 v181, s[12:15], s40 offen lds
v_mfma_f32_16x16x32_bf16 v[40:43], v[16:19], a[120:123], v[40:43]
buffer_load_dwordx4 a[176:179], v9, s[8:11], s41 offen offset:0 sc1
v_mfma_f32_16x16x32_bf16 v[44:47], v[16:19], a[124:127], v[44:47]
buffer_load_dwordx4 a[180:183], v9, s[8:11], s41 offen offset:1024 sc1
v_mfma_f32_16x16x32_bf16 v[48:51], v[20:23], a[112:115], v[48:51]
ds_read_b64_tr_b16 v[16:17], v184 offset:16384
v_mfma_f32_16x16x32_bf16 v[52:55], v[20:23], a[116:119], v[52:55]
ds_read_b64_tr_b16 v[18:19], v184 offset:18432
v_mfma_f32_16x16x32_bf16 v[56:59], v[20:23], a[120:123], v[56:59]
buffer_load_dwordx4 a[184:187], v9, s[8:11], s41 offen offset:2048 sc1
v_mfma_f32_16x16x32_bf16 v[60:63], v[20:23], a[124:127], v[60:63]
buffer_load_dwordx4 a[188:191], v9, s[8:11], s41 offen offset:3072 sc1
s_add_u32 s41, s36, 49152
s_waitcnt lgkmcnt(2)
v_mfma_f32_16x16x32_bf16 v[64:67], v[24:27], a[112:115], v[64:67]
ds_read_b64_tr_b16 v[20:21], v185 offset:16384
v_mfma_f32_16x16x32_bf16 v[68:71], v[24:27], a[116:119], v[68:71]
ds_read_b64_tr_b16 v[22:23], v185 offset:18432
v_mfma_f32_16x16x32_bf16 v[72:75], v[24:27], a[120:123], v[72:75]
buffer_load_dwordx4 a[192:195], v9, s[8:11], s41 offen offset:0 sc1
v_mfma_f32_16x16x32_bf16 v[76:79], v[24:27], a[124:127], v[76:79]
buffer_load_dwordx4 a[196:199], v9, s[8:11], s41 offen offset:1024 sc1
v_mfma_f32_16x16x32_bf16 v[80:83], v[28:31], a[112:115], v[80:83]
ds_read_b64_tr_b16 v[24:25], v184 offset:20480
v_mfma_f32_16x16x32_bf16 v[84:87], v[28:31], a[116:119], v[84:87]
ds_read_b64_tr_b16 v[26:27], v184 offset:22528
buffer_load_dwordx4 a[200:203], v9, s[8:11], s41 offen offset:2048 sc1
v_mfma_f32_16x16x32_bf16 v[88:91], v[28:31], a[120:123], v[88:91]
buffer_load_dwordx4 a[204:207], v9, s[8:11], s41 offen offset:3072 sc1
s_add_u32 s41, s36, 53248
v_mfma_f32_16x16x32_bf16 v[92:95], v[28:31], a[124:127], v[92:95]
buffer_load_dwordx4 a[208:211], v9, s[8:11], s41 offen offset:0 sc1
s_waitcnt lgkmcnt(2)
s_waitcnt vmcnt(23)
v_mfma_f32_16x16x32_bf16 v[32:35], v[16:19], a[128:131], v[32:35]
ds_read_b64_tr_b16 v[28:29], v185 offset:20480
v_mfma_f32_16x16x32_bf16 v[36:39], v[16:19], a[132:135], v[36:39]
ds_read_b64_tr_b16 v[30:31], v185 offset:22528
v_mfma_f32_16x16x32_bf16 v[40:43], v[16:19], a[136:139], v[40:43]
buffer_load_dwordx4 a[212:215], v9, s[8:11], s41 offen offset:1024 sc1
v_mfma_f32_16x16x32_bf16 v[44:47], v[16:19], a[140:143], v[44:47]
v_add_u32 v184, 0x6000, v184
v_add_u32 v185, 0x6000, v185
v_mfma_f32_16x16x32_bf16 v[48:51], v[20:23], a[128:131], v[48:51]
s_barrier
ds_read_b64_tr_b16 v[16:17], v184 offset:0
v_mfma_f32_16x16x32_bf16 v[52:55], v[20:23], a[132:135], v[52:55]
ds_read_b64_tr_b16 v[18:19], v184 offset:2048
buffer_load_dwordx4 a[216:219], v9, s[8:11], s41 offen offset:2048 sc1
v_mfma_f32_16x16x32_bf16 v[56:59], v[20:23], a[136:139], v[56:59]
buffer_load_dwordx4 a[220:223], v9, s[8:11], s41 offen offset:3072 sc1
s_add_u32 s41, s36, 57344
v_mfma_f32_16x16x32_bf16 v[60:63], v[20:23], a[140:143], v[60:63]
buffer_load_dwordx4 a[224:227], v9, s[8:11], s41 offen offset:0 sc1
s_waitcnt lgkmcnt(2)
v_mfma_f32_16x16x32_bf16 v[64:67], v[24:27], a[128:131], v[64:67]
ds_read_b64_tr_b16 v[20:21], v185 offset:0
v_mfma_f32_16x16x32_bf16 v[68:71], v[24:27], a[132:135], v[68:71]
ds_read_b64_tr_b16 v[22:23], v185 offset:2048
v_mfma_f32_16x16x32_bf16 v[72:75], v[24:27], a[136:139], v[72:75]
buffer_load_dwordx4 a[228:231], v9, s[8:11], s41 offen offset:1024 sc1
v_mfma_f32_16x16x32_bf16 v[76:79], v[24:27], a[140:143], v[76:79]
buffer_load_dwordx4 a[232:235], v9, s[8:11], s41 offen offset:2048 sc1
v_mfma_f32_16x16x32_bf16 v[80:83], v[28:31], a[128:131], v[80:83]
ds_read_b64_tr_b16 v[24:25], v184 offset:4096
v_mfma_f32_16x16x32_bf16 v[84:87], v[28:31], a[132:135], v[84:87]
ds_read_b64_tr_b16 v[26:27], v184 offset:6144
buffer_load_dwordx4 a[236:239], v9, s[8:11], s41 offen offset:3072 sc1
v_mfma_f32_16x16x32_bf16 v[88:91], v[28:31], a[136:139], v[88:91]
s_add_u32 s41, s36, 61440
buffer_load_dwordx4 a[240:243], v9, s[8:11], s41 offen offset:0 sc1
v_mfma_f32_16x16x32_bf16 v[92:95], v[28:31], a[140:143], v[92:95]
buffer_load_dwordx4 a[244:247], v9, s[8:11], s41 offen offset:1024 sc1
s_waitcnt lgkmcnt(2)
s_waitcnt vmcnt(28)
v_mfma_f32_16x16x32_bf16 v[32:35], v[16:19], a[144:147], v[32:35]
ds_read_b64_tr_b16 v[28:29], v185 offset:4096
v_mfma_f32_16x16x32_bf16 v[36:39], v[16:19], a[148:151], v[36:39]
ds_read_b64_tr_b16 v[30:31], v185 offset:6144
v_mfma_f32_16x16x32_bf16 v[40:43], v[16:19], a[152:155], v[40:43]
buffer_load_dwordx4 a[248:251], v9, s[8:11], s41 offen offset:2048 sc1
v_mfma_f32_16x16x32_bf16 v[44:47], v[16:19], a[156:159], v[44:47]
buffer_load_dwordx4 a[252:255], v9, s[8:11], s41 offen offset:3072 sc1
s_add_u32 s41, s36, 65536
v_mfma_f32_16x16x32_bf16 v[48:51], v[20:23], a[144:147], v[48:51]
ds_read_b64_tr_b16 v[16:17], v184 offset:8192
v_mfma_f32_16x16x32_bf16 v[52:55], v[20:23], a[148:151], v[52:55]
ds_read_b64_tr_b16 v[18:19], v184 offset:10240
v_mfma_f32_16x16x32_bf16 v[56:59], v[20:23], a[152:155], v[56:59]
buffer_load_dwordx4 v[224:227], v9, s[8:11], s41 offen offset:0 sc1
v_mfma_f32_16x16x32_bf16 v[60:63], v[20:23], a[156:159], v[60:63]
buffer_load_dwordx4 v[228:231], v9, s[8:11], s41 offen offset:1024 sc1
s_waitcnt lgkmcnt(2)
v_mfma_f32_16x16x32_bf16 v[64:67], v[24:27], a[144:147], v[64:67]
ds_read_b64_tr_b16 v[20:21], v185 offset:8192
v_mfma_f32_16x16x32_bf16 v[68:71], v[24:27], a[148:151], v[68:71]
ds_read_b64_tr_b16 v[22:23], v185 offset:10240
v_mfma_f32_16x16x32_bf16 v[72:75], v[24:27], a[152:155], v[72:75]
buffer_load_dwordx4 v[232:235], v9, s[8:11], s41 offen offset:2048 sc1
v_mfma_f32_16x16x32_bf16 v[76:79], v[24:27], a[156:159], v[76:79]
buffer_load_dwordx4 v[236:239], v9, s[8:11], s41 offen offset:3072 sc1
s_add_u32 s41, s36, 69632
v_mfma_f32_16x16x32_bf16 v[80:83], v[28:31], a[144:147], v[80:83]
ds_read_b64_tr_b16 v[24:25], v184 offset:12288
v_mfma_f32_16x16x32_bf16 v[84:87], v[28:31], a[148:151], v[84:87]
ds_read_b64_tr_b16 v[26:27], v184 offset:14336
buffer_load_dwordx4 v[240:243], v9, s[8:11], s41 offen offset:0 sc1
v_mfma_f32_16x16x32_bf16 v[88:91], v[28:31], a[152:155], v[88:91]
buffer_load_dwordx4 v[244:247], v9, s[8:11], s41 offen offset:1024 sc1
v_mfma_f32_16x16x32_bf16 v[92:95], v[28:31], a[156:159], v[92:95]
buffer_load_dwordx4 v[248:251], v9, s[8:11], s41 offen offset:2048 sc1
s_waitcnt lgkmcnt(2)
s_waitcnt vmcnt(33)
v_mfma_f32_16x16x32_bf16 v[32:35], v[16:19], a[160:163], v[32:35]
ds_read_b64_tr_b16 v[28:29], v185 offset:12288
v_mfma_f32_16x16x32_bf16 v[36:39], v[16:19], a[164:167], v[36:39]
ds_read_b64_tr_b16 v[30:31], v185 offset:14336
v_mfma_f32_16x16x32_bf16 v[40:43], v[16:19], a[168:171], v[40:43]
buffer_load_dwordx4 v[252:255], v9, s[8:11], s41 offen offset:3072 sc1
v_mfma_f32_16x16x32_bf16 v[44:47], v[16:19], a[172:175], v[44:47]
v_mfma_f32_16x16x32_bf16 v[48:51], v[20:23], a[160:163], v[48:51]
ds_read_b64_tr_b16 v[16:17], v184 offset:16384
v_mfma_f32_16x16x32_bf16 v[52:55], v[20:23], a[164:167], v[52:55]
ds_read_b64_tr_b16 v[18:19], v184 offset:18432
s_movk_i32 s72, 9216
v_mul_lo_u32 v176, v0, s72
v_mfma_f32_16x16x32_bf16 v[56:59], v[20:23], a[168:171], v[56:59]
s_mul_i32 s43, s29, 72
s_and_b32 s72, s28, 1
s_mul_i32 s72, s72, 36
v_mfma_f32_16x16x32_bf16 v[60:63], v[20:23], a[172:175], v[60:63]
s_add_u32 s43, s43, s72
s_mul_i32 s43, s43, 9216
s_waitcnt lgkmcnt(2)
v_mfma_f32_16x16x32_bf16 v[64:67], v[24:27], a[160:163], v[64:67]
ds_read_b64_tr_b16 v[20:21], v185 offset:16384
s_lshl_b32 s72, s30, 8
s_add_u32 s43, s43, s72
v_mfma_f32_16x16x32_bf16 v[68:71], v[24:27], a[164:167], v[68:71]
ds_read_b64_tr_b16 v[22:23], v185 offset:18432
s_add_u32 s43, s43, 128
v_mfma_f32_16x16x32_bf16 v[72:75], v[24:27], a[168:171], v[72:75]
buffer_load_dword v8, v176, s[12:15], s43 offen
v_mfma_f32_16x16x32_bf16 v[76:79], v[24:27], a[172:175], v[76:79]
v_mfma_f32_16x16x32_bf16 v[80:83], v[28:31], a[160:163], v[80:83]
ds_read_b64_tr_b16 v[24:25], v184 offset:20480
v_mfma_f32_16x16x32_bf16 v[84:87], v[28:31], a[164:167], v[84:87]
ds_read_b64_tr_b16 v[26:27], v184 offset:22528
v_mfma_f32_16x16x32_bf16 v[88:91], v[28:31], a[168:171], v[88:91]
v_mfma_f32_16x16x32_bf16 v[92:95], v[28:31], a[172:175], v[92:95]
s_waitcnt lgkmcnt(2)
s_waitcnt vmcnt(25)
v_mfma_f32_16x16x32_bf16 v[32:35], v[16:19], a[176:179], v[32:35]
ds_read_b64_tr_b16 v[28:29], v185 offset:20480
v_mfma_f32_16x16x32_bf16 v[36:39], v[16:19], a[180:183], v[36:39]
ds_read_b64_tr_b16 v[30:31], v185 offset:22528
v_mfma_f32_16x16x32_bf16 v[40:43], v[16:19], a[184:187], v[40:43]
v_mfma_f32_16x16x32_bf16 v[44:47], v[16:19], a[188:191], v[44:47]
v_add_u32 v184, 0x6000, v184
v_add_u32 v185, 0x6000, v185
v_mfma_f32_16x16x32_bf16 v[48:51], v[20:23], a[176:179], v[48:51]
s_barrier
ds_read_b64_tr_b16 v[16:17], v184 offset:0
v_mfma_f32_16x16x32_bf16 v[52:55], v[20:23], a[180:183], v[52:55]
ds_read_b64_tr_b16 v[18:19], v184 offset:2048
v_mfma_f32_16x16x32_bf16 v[56:59], v[20:23], a[184:187], v[56:59]
v_mfma_f32_16x16x32_bf16 v[60:63], v[20:23], a[188:191], v[60:63]
s_waitcnt lgkmcnt(2)
v_mfma_f32_16x16x32_bf16 v[64:67], v[24:27], a[176:179], v[64:67]
ds_read_b64_tr_b16 v[20:21], v185 offset:0
v_mfma_f32_16x16x32_bf16 v[68:71], v[24:27], a[180:183], v[68:71]
ds_read_b64_tr_b16 v[22:23], v185 offset:2048
v_mfma_f32_16x16x32_bf16 v[72:75], v[24:27], a[184:187], v[72:75]
v_mfma_f32_16x16x32_bf16 v[76:79], v[24:27], a[188:191], v[76:79]
v_mfma_f32_16x16x32_bf16 v[80:83], v[28:31], a[176:179], v[80:83]
ds_read_b64_tr_b16 v[24:25], v184 offset:4096
v_mfma_f32_16x16x32_bf16 v[84:87], v[28:31], a[180:183], v[84:87]
ds_read_b64_tr_b16 v[26:27], v184 offset:6144
v_mfma_f32_16x16x32_bf16 v[88:91], v[28:31], a[184:187], v[88:91]
v_mfma_f32_16x16x32_bf16 v[92:95], v[28:31], a[188:191], v[92:95]
s_waitcnt lgkmcnt(2)
s_waitcnt vmcnt(21)
v_mfma_f32_16x16x32_bf16 v[32:35], v[16:19], a[192:195], v[32:35]
ds_read_b64_tr_b16 v[28:29], v185 offset:4096
v_mfma_f32_16x16x32_bf16 v[36:39], v[16:19], a[196:199], v[36:39]
ds_read_b64_tr_b16 v[30:31], v185 offset:6144
v_mfma_f32_16x16x32_bf16 v[40:43], v[16:19], a[200:203], v[40:43]
v_mfma_f32_16x16x32_bf16 v[44:47], v[16:19], a[204:207], v[44:47]
v_lshrrev_b32 v177, 1, v0
v_lshlrev_b32 v177, 13, v177
s_min_u32 s73, s28, 2
v_mfma_f32_16x16x32_bf16 v[48:51], v[20:23], a[192:195], v[48:51]
ds_read_b64_tr_b16 v[16:17], v184 offset:8192
v_and_b32 v178, 1, v0
s_lshl_b32 s73, s73, 5
v_mfma_f32_16x16x32_bf16 v[52:55], v[20:23], a[196:199], v[52:55]
ds_read_b64_tr_b16 v[18:19], v184 offset:10240
v_lshl_add_u32 v177, v178, 7, v177
s_mul_i32 s43, s29, 72
v_mfma_f32_16x16x32_bf16 v[56:59], v[20:23], a[200:203], v[56:59]
s_add_u32 s43, s43, s73
s_lshl_b32 s43, s43, 13
s_lshl_b32 s73, s30, 8
v_mfma_f32_16x16x32_bf16 v[60:63], v[20:23], a[204:207], v[60:63]
s_add_u32 s43, s43, s73
buffer_load_dword v15, v177, s[16:19], s43 offen
s_waitcnt lgkmcnt(2)
v_mfma_f32_16x16x32_bf16 v[64:67], v[24:27], a[192:195], v[64:67]
ds_read_b64_tr_b16 v[20:21], v185 offset:8192
v_mfma_f32_16x16x32_bf16 v[68:71], v[24:27], a[196:199], v[68:71]
ds_read_b64_tr_b16 v[22:23], v185 offset:10240
v_mfma_f32_16x16x32_bf16 v[72:75], v[24:27], a[200:203], v[72:75]
v_mfma_f32_16x16x32_bf16 v[76:79], v[24:27], a[204:207], v[76:79]
v_mfma_f32_16x16x32_bf16 v[80:83], v[28:31], a[192:195], v[80:83]
ds_read_b64_tr_b16 v[24:25], v184 offset:12288
v_mfma_f32_16x16x32_bf16 v[84:87], v[28:31], a[196:199], v[84:87]
ds_read_b64_tr_b16 v[26:27], v184 offset:14336
v_mfma_f32_16x16x32_bf16 v[88:91], v[28:31], a[200:203], v[88:91]
v_mfma_f32_16x16x32_bf16 v[92:95], v[28:31], a[204:207], v[92:95]
s_waitcnt lgkmcnt(2)
s_waitcnt vmcnt(18)
v_mfma_f32_16x16x32_bf16 v[32:35], v[16:19], a[208:211], v[32:35]
ds_read_b64_tr_b16 v[28:29], v185 offset:12288
v_mfma_f32_16x16x32_bf16 v[36:39], v[16:19], a[212:215], v[36:39]
ds_read_b64_tr_b16 v[30:31], v185 offset:14336
v_mfma_f32_16x16x32_bf16 v[40:43], v[16:19], a[216:219], v[40:43]
v_mfma_f32_16x16x32_bf16 v[44:47], v[16:19], a[220:223], v[44:47]
v_mfma_f32_16x16x32_bf16 v[48:51], v[20:23], a[208:211], v[48:51]
ds_read_b64_tr_b16 v[16:17], v184 offset:16384
v_mfma_f32_16x16x32_bf16 v[52:55], v[20:23], a[212:215], v[52:55]
ds_read_b64_tr_b16 v[18:19], v184 offset:18432
v_mfma_f32_16x16x32_bf16 v[56:59], v[20:23], a[216:219], v[56:59]
v_mfma_f32_16x16x32_bf16 v[60:63], v[20:23], a[220:223], v[60:63]
s_waitcnt lgkmcnt(2)
v_mfma_f32_16x16x32_bf16 v[64:67], v[24:27], a[208:211], v[64:67]
ds_read_b64_tr_b16 v[20:21], v185 offset:16384
v_mfma_f32_16x16x32_bf16 v[68:71], v[24:27], a[212:215], v[68:71]
ds_read_b64_tr_b16 v[22:23], v185 offset:18432
v_mfma_f32_16x16x32_bf16 v[72:75], v[24:27], a[216:219], v[72:75]
v_mfma_f32_16x16x32_bf16 v[76:79], v[24:27], a[220:223], v[76:79]
v_mfma_f32_16x16x32_bf16 v[80:83], v[28:31], a[208:211], v[80:83]
ds_read_b64_tr_b16 v[24:25], v184 offset:20480
v_mfma_f32_16x16x32_bf16 v[84:87], v[28:31], a[212:215], v[84:87]
ds_read_b64_tr_b16 v[26:27], v184 offset:22528
v_mfma_f32_16x16x32_bf16 v[88:91], v[28:31], a[216:219], v[88:91]
v_mfma_f32_16x16x32_bf16 v[92:95], v[28:31], a[220:223], v[92:95]
s_waitcnt lgkmcnt(2)
s_waitcnt vmcnt(14)
v_mfma_f32_16x16x32_bf16 v[32:35], v[16:19], a[224:227], v[32:35]
ds_read_b64_tr_b16 v[28:29], v185 offset:20480
v_mfma_f32_16x16x32_bf16 v[36:39], v[16:19], a[228:231], v[36:39]
ds_read_b64_tr_b16 v[30:31], v185 offset:22528
s_movk_i32 s72, 9216
v_mul_lo_u32 v176, v0, s72
v_mfma_f32_16x16x32_bf16 v[40:43], v[16:19], a[232:235], v[40:43]
s_lshr_b32 s43, s2, 3
s_mul_i32 s43, s43, 165888
s_and_b32 s73, s2, 7
v_mfma_f32_16x16x32_bf16 v[44:47], v[16:19], a[236:239], v[44:47]
v_add_u32 v184, 0x6000, v184
v_add_u32 v185, 0x6000, v185
s_lshl_b32 s73, s73, 7
v_mfma_f32_16x16x32_bf16 v[48:51], v[20:23], a[224:227], v[48:51]
s_barrier
ds_read_b64_tr_b16 v[16:17], v184 offset:0
v_mfma_f32_16x16x32_bf16 v[52:55], v[20:23], a[228:231], v[52:55]
ds_read_b64_tr_b16 v[18:19], v184 offset:2048
s_add_u32 s43, s43, s73
s_add_u32 s43, s43, 8192
v_mfma_f32_16x16x32_bf16 v[56:59], v[20:23], a[232:235], v[56:59]
buffer_load_dword v8, v176, s[12:15], s43 offen
v_mfma_f32_16x16x32_bf16 v[60:63], v[20:23], a[236:239], v[60:63]
s_waitcnt lgkmcnt(2)
v_mfma_f32_16x16x32_bf16 v[64:67], v[24:27], a[224:227], v[64:67]
ds_read_b64_tr_b16 v[20:21], v185 offset:0
v_mfma_f32_16x16x32_bf16 v[68:71], v[24:27], a[228:231], v[68:71]
ds_read_b64_tr_b16 v[22:23], v185 offset:2048
v_mfma_f32_16x16x32_bf16 v[72:75], v[24:27], a[232:235], v[72:75]
v_mfma_f32_16x16x32_bf16 v[76:79], v[24:27], a[236:239], v[76:79]
v_mfma_f32_16x16x32_bf16 v[80:83], v[28:31], a[224:227], v[80:83]
ds_read_b64_tr_b16 v[24:25], v184 offset:4096
v_mfma_f32_16x16x32_bf16 v[84:87], v[28:31], a[228:231], v[84:87]
ds_read_b64_tr_b16 v[26:27], v184 offset:6144
v_mfma_f32_16x16x32_bf16 v[88:91], v[28:31], a[232:235], v[88:91]
v_mfma_f32_16x16x32_bf16 v[92:95], v[28:31], a[236:239], v[92:95]
s_waitcnt lgkmcnt(2)
s_waitcnt vmcnt(11)
v_mfma_f32_16x16x32_bf16 v[32:35], v[16:19], a[240:243], v[32:35]
ds_read_b64_tr_b16 v[28:29], v185 offset:4096
v_mfma_f32_16x16x32_bf16 v[36:39], v[16:19], a[244:247], v[36:39]
ds_read_b64_tr_b16 v[30:31], v185 offset:6144
v_mfma_f32_16x16x32_bf16 v[40:43], v[16:19], a[248:251], v[40:43]
v_mfma_f32_16x16x32_bf16 v[44:47], v[16:19], a[252:255], v[44:47]
v_mfma_f32_16x16x32_bf16 v[48:51], v[20:23], a[240:243], v[48:51]
ds_read_b64_tr_b16 v[16:17], v184 offset:8192
v_mfma_f32_16x16x32_bf16 v[52:55], v[20:23], a[244:247], v[52:55]
ds_read_b64_tr_b16 v[18:19], v184 offset:10240
v_mfma_f32_16x16x32_bf16 v[56:59], v[20:23], a[248:251], v[56:59]
v_mfma_f32_16x16x32_bf16 v[60:63], v[20:23], a[252:255], v[60:63]
s_waitcnt lgkmcnt(2)
v_mfma_f32_16x16x32_bf16 v[64:67], v[24:27], a[240:243], v[64:67]
ds_read_b64_tr_b16 v[20:21], v185 offset:8192
v_mfma_f32_16x16x32_bf16 v[68:71], v[24:27], a[244:247], v[68:71]
ds_read_b64_tr_b16 v[22:23], v185 offset:10240
v_mfma_f32_16x16x32_bf16 v[72:75], v[24:27], a[248:251], v[72:75]
v_mfma_f32_16x16x32_bf16 v[76:79], v[24:27], a[252:255], v[76:79]
v_mfma_f32_16x16x32_bf16 v[80:83], v[28:31], a[240:243], v[80:83]
ds_read_b64_tr_b16 v[24:25], v184 offset:12288
v_mfma_f32_16x16x32_bf16 v[84:87], v[28:31], a[244:247], v[84:87]
ds_read_b64_tr_b16 v[26:27], v184 offset:14336
v_mfma_f32_16x16x32_bf16 v[88:91], v[28:31], a[248:251], v[88:91]
v_mfma_f32_16x16x32_bf16 v[92:95], v[28:31], a[252:255], v[92:95]
s_waitcnt lgkmcnt(2)
s_waitcnt vmcnt(7)
v_mfma_f32_16x16x32_bf16 v[32:35], v[16:19], v[224:227], v[32:35]
ds_read_b64_tr_b16 v[28:29], v185 offset:12288
v_mfma_f32_16x16x32_bf16 v[36:39], v[16:19], v[228:231], v[36:39]
ds_read_b64_tr_b16 v[30:31], v185 offset:14336
v_mfma_f32_16x16x32_bf16 v[40:43], v[16:19], v[232:235], v[40:43]
v_mfma_f32_16x16x32_bf16 v[44:47], v[16:19], v[236:239], v[44:47]
v_mfma_f32_16x16x32_bf16 v[48:51], v[20:23], v[224:227], v[48:51]
ds_read_b64_tr_b16 v[16:17], v184 offset:16384
v_mfma_f32_16x16x32_bf16 v[52:55], v[20:23], v[228:231], v[52:55]
ds_read_b64_tr_b16 v[18:19], v184 offset:18432
v_mfma_f32_16x16x32_bf16 v[56:59], v[20:23], v[232:235], v[56:59]
v_mfma_f32_16x16x32_bf16 v[60:63], v[20:23], v[236:239], v[60:63]
s_waitcnt lgkmcnt(2)
v_mfma_f32_16x16x32_bf16 v[64:67], v[24:27], v[224:227], v[64:67]
ds_read_b64_tr_b16 v[20:21], v185 offset:16384
v_mfma_f32_16x16x32_bf16 v[68:71], v[24:27], v[228:231], v[68:71]
ds_read_b64_tr_b16 v[22:23], v185 offset:18432
v_mfma_f32_16x16x32_bf16 v[72:75], v[24:27], v[232:235], v[72:75]
v_mfma_f32_16x16x32_bf16 v[76:79], v[24:27], v[236:239], v[76:79]
v_mfma_f32_16x16x32_bf16 v[80:83], v[28:31], v[224:227], v[80:83]
ds_read_b64_tr_b16 v[24:25], v184 offset:20480
v_mfma_f32_16x16x32_bf16 v[84:87], v[28:31], v[228:231], v[84:87]
ds_read_b64_tr_b16 v[26:27], v184 offset:22528
v_mfma_f32_16x16x32_bf16 v[88:91], v[28:31], v[232:235], v[88:91]
v_mfma_f32_16x16x32_bf16 v[92:95], v[28:31], v[236:239], v[92:95]
s_waitcnt lgkmcnt(2)
s_waitcnt vmcnt(3)
v_mfma_f32_16x16x32_bf16 v[32:35], v[16:19], v[240:243], v[32:35]
ds_read_b64_tr_b16 v[28:29], v185 offset:20480
v_mfma_f32_16x16x32_bf16 v[36:39], v[16:19], v[244:247], v[36:39]
ds_read_b64_tr_b16 v[30:31], v185 offset:22528
v_mfma_f32_16x16x32_bf16 v[40:43], v[16:19], v[248:251], v[40:43]
v_mfma_f32_16x16x32_bf16 v[44:47], v[16:19], v[252:255], v[44:47]
v_add_u32 v184, 0x6000, v184
v_add_u32 v185, 0x6000, v185
v_xor_b32 v184, 64, v184
v_xor_b32 v185, 64, v185
v_mfma_f32_16x16x32_bf16 v[48:51], v[20:23], v[240:243], v[48:51]
s_barrier
ds_read_b64_tr_b16 v[16:17], v184 offset:0
v_mfma_f32_16x16x32_bf16 v[52:55], v[20:23], v[244:247], v[52:55]
ds_read_b64_tr_b16 v[18:19], v184 offset:2048
v_mfma_f32_16x16x32_bf16 v[56:59], v[20:23], v[248:251], v[56:59]
v_mfma_f32_16x16x32_bf16 v[60:63], v[20:23], v[252:255], v[60:63]
s_waitcnt lgkmcnt(2)
v_mfma_f32_16x16x32_bf16 v[64:67], v[24:27], v[240:243], v[64:67]
ds_read_b64_tr_b16 v[20:21], v185 offset:0
v_mfma_f32_16x16x32_bf16 v[68:71], v[24:27], v[244:247], v[68:71]
ds_read_b64_tr_b16 v[22:23], v185 offset:2048
v_mfma_f32_16x16x32_bf16 v[72:75], v[24:27], v[248:251], v[72:75]
v_mfma_f32_16x16x32_bf16 v[76:79], v[24:27], v[252:255], v[76:79]
v_mfma_f32_16x16x32_bf16 v[80:83], v[28:31], v[240:243], v[80:83]
ds_read_b64_tr_b16 v[24:25], v184 offset:4096
v_mfma_f32_16x16x32_bf16 v[84:87], v[28:31], v[244:247], v[84:87]
ds_read_b64_tr_b16 v[26:27], v184 offset:6144
v_mfma_f32_16x16x32_bf16 v[88:91], v[28:31], v[248:251], v[88:91]
v_mfma_f32_16x16x32_bf16 v[92:95], v[28:31], v[252:255], v[92:95]
mk_L_GU1:
s_waitcnt lgkmcnt(2)
v_mfma_f32_16x16x32_bf16 v[96:99], v[16:19], a[0:3], 0
ds_read_b64_tr_b16 v[28:29], v185 offset:4096
v_mfma_f32_16x16x32_bf16 v[100:103], v[16:19], a[4:7], 0
ds_read_b64_tr_b16 v[30:31], v185 offset:6144
v_mfma_f32_16x16x32_bf16 v[104:107], v[16:19], a[8:11], 0
v_mfma_f32_16x16x32_bf16 v[108:111], v[16:19], a[12:15], 0
v_mfma_f32_16x16x32_bf16 v[112:115], v[20:23], a[0:3], 0
ds_read_b64_tr_b16 v[16:17], v184 offset:8192
v_mfma_f32_16x16x32_bf16 v[116:119], v[20:23], a[4:7], 0
ds_read_b64_tr_b16 v[18:19], v184 offset:10240
v_mfma_f32_16x16x32_bf16 v[120:123], v[20:23], a[8:11], 0
v_mfma_f32_16x16x32_bf16 v[124:127], v[20:23], a[12:15], 0
s_waitcnt lgkmcnt(2)
v_mfma_f32_16x16x32_bf16 v[128:131], v[24:27], a[0:3], 0
ds_read_b64_tr_b16 v[20:21], v185 offset:8192
v_mul_f32 v160, v32, v32
v_mfma_f32_16x16x32_bf16 v[132:135], v[24:27], a[4:7], 0
ds_read_b64_tr_b16 v[22:23], v185 offset:10240
v_mul_f32 v161, v33, v33
v_mfma_f32_16x16x32_bf16 v[136:139], v[24:27], a[8:11], 0
v_mul_f32 v162, v34, v34
v_mul_f32 v163, v35, v35
v_mfma_f32_16x16x32_bf16 v[140:143], v[24:27], a[12:15], 0
v_fma_f32 v160, v160, v12, s44
v_fma_f32 v161, v161, v12, s44
v_mfma_f32_16x16x32_bf16 v[144:147], v[28:31], a[0:3], 0
ds_read_b64_tr_b16 v[24:25], v184 offset:12288
v_fma_f32 v162, v162, v12, s44
v_mfma_f32_16x16x32_bf16 v[148:151], v[28:31], a[4:7], 0
ds_read_b64_tr_b16 v[26:27], v184 offset:14336
v_fma_f32 v163, v163, v12, s44
v_mfma_f32_16x16x32_bf16 v[152:155], v[28:31], a[8:11], 0
v_mul_f32 v160, v32, v160
v_mul_f32 v161, v33, v161
v_mfma_f32_16x16x32_bf16 v[156:159], v[28:31], a[12:15], 0
v_exp_f32 v160, v160
s_waitcnt lgkmcnt(2)
v_mfma_f32_16x16x32_bf16 v[96:99], v[16:19], a[16:19], v[96:99]
ds_read_b64_tr_b16 v[28:29], v185 offset:12288
v_mul_f32 v162, v34, v162
v_mfma_f32_16x16x32_bf16 v[100:103], v[16:19], a[20:23], v[100:103]
ds_read_b64_tr_b16 v[30:31], v185 offset:14336
v_mul_f32 v163, v35, v163
v_mfma_f32_16x16x32_bf16 v[104:107], v[16:19], a[24:27], v[104:107]
v_exp_f32 v161, v161
v_mfma_f32_16x16x32_bf16 v[108:111], v[16:19], a[28:31], v[108:111]
v_exp_f32 v162, v162
v_mfma_f32_16x16x32_bf16 v[112:115], v[20:23], a[16:19], v[112:115]
ds_read_b64_tr_b16 v[16:17], v184 offset:16384
v_mul_f32 v64, v32, v64
v_mfma_f32_16x16x32_bf16 v[116:119], v[20:23], a[20:23], v[116:119]
ds_read_b64_tr_b16 v[18:19], v184 offset:18432
v_mul_f32 v65, v33, v65
v_mfma_f32_16x16x32_bf16 v[120:123], v[20:23], a[24:27], v[120:123]
v_exp_f32 v163, v163
v_mfma_f32_16x16x32_bf16 v[124:127], v[20:23], a[28:31], v[124:127]
v_mul_f32 v66, v34, v66
v_mul_f32 v67, v35, v67
s_waitcnt lgkmcnt(2)
v_mfma_f32_16x16x32_bf16 v[128:131], v[24:27], a[16:19], v[128:131]
ds_read_b64_tr_b16 v[20:21], v185 offset:16384
v_add_f32 v160, 1.0, v160
v_mfma_f32_16x16x32_bf16 v[132:135], v[24:27], a[20:23], v[132:135]
ds_read_b64_tr_b16 v[22:23], v185 offset:18432
v_add_f32 v161, 1.0, v161
v_mfma_f32_16x16x32_bf16 v[136:139], v[24:27], a[24:27], v[136:139]
v_rcp_f32 v160, v160
v_mfma_f32_16x16x32_bf16 v[140:143], v[24:27], a[28:31], v[140:143]
v_rcp_f32 v161, v161
v_mfma_f32_16x16x32_bf16 v[144:147], v[28:31], a[16:19], v[144:147]
ds_read_b64_tr_b16 v[24:25], v184 offset:20480
v_add_f32 v162, 1.0, v162
v_mfma_f32_16x16x32_bf16 v[148:151], v[28:31], a[20:23], v[148:151]
ds_read_b64_tr_b16 v[26:27], v184 offset:22528
v_add_f32 v163, 1.0, v163
v_mfma_f32_16x16x32_bf16 v[152:155], v[28:31], a[24:27], v[152:155]
v_rcp_f32 v162, v162
v_mfma_f32_16x16x32_bf16 v[156:159], v[28:31], a[28:31], v[156:159]
v_rcp_f32 v163, v163
s_waitcnt lgkmcnt(2)
v_mfma_f32_16x16x32_bf16 v[96:99], v[16:19], a[32:35], v[96:99]
ds_read_b64_tr_b16 v[28:29], v185 offset:20480
v_mul_f32 v64, v64, v160
s_add_u32 s42, s37, 0
v_mfma_f32_16x16x32_bf16 v[100:103], v[16:19], a[36:39], v[100:103]
ds_read_b64_tr_b16 v[30:31], v185 offset:22528
v_mul_f32 v65, v65, v161
v_mfma_f32_16x16x32_bf16 v[104:107], v[16:19], a[40:43], v[104:107]
v_mul_f32 v66, v66, v162
v_mul_f32 v67, v67, v163
v_mfma_f32_16x16x32_bf16 v[108:111], v[16:19], a[44:47], v[108:111]
v_add_u32 v184, 0x6000, v184
v_add_u32 v185, 0x6000, v185
v_mfma_f32_16x16x32_bf16 v[112:115], v[20:23], a[32:35], v[112:115]
s_barrier
ds_read_b64_tr_b16 v[16:17], v184 offset:0
v_mfma_f32_16x16x32_bf16 v[116:119], v[20:23], a[36:39], v[116:119]
ds_read_b64_tr_b16 v[18:19], v184 offset:2048
v_cvt_pk_bf16_f32 v168, v64, v65
v_mfma_f32_16x16x32_bf16 v[120:123], v[20:23], a[40:43], v[120:123]
v_cvt_pk_bf16_f32 v169, v66, v67
v_mul_f32 v164, v48, v48
v_mfma_f32_16x16x32_bf16 v[124:127], v[20:23], a[44:47], v[124:127]
v_mul_f32 v165, v49, v49
v_mul_f32 v166, v50, v50
s_waitcnt lgkmcnt(2)
v_mfma_f32_16x16x32_bf16 v[128:131], v[24:27], a[32:35], v[128:131]
ds_read_b64_tr_b16 v[20:21], v185 offset:0
v_mul_f32 v167, v51, v51
v_mfma_f32_16x16x32_bf16 v[132:135], v[24:27], a[36:39], v[132:135]
ds_read_b64_tr_b16 v[22:23], v185 offset:2048
v_fma_f32 v164, v164, v12, s44
v_mfma_f32_16x16x32_bf16 v[136:139], v[24:27], a[40:43], v[136:139]
v_fma_f32 v165, v165, v12, s44
v_fma_f32 v166, v166, v12, s44
v_mfma_f32_16x16x32_bf16 v[140:143], v[24:27], a[44:47], v[140:143]
v_fma_f32 v167, v167, v12, s44
v_mul_f32 v164, v48, v164
v_mfma_f32_16x16x32_bf16 v[144:147], v[28:31], a[32:35], v[144:147]
ds_read_b64_tr_b16 v[24:25], v184 offset:4096
v_mul_f32 v165, v49, v165
v_mfma_f32_16x16x32_bf16 v[148:151], v[28:31], a[36:39], v[148:151]
ds_read_b64_tr_b16 v[26:27], v184 offset:6144
v_mul_f32 v166, v50, v166
v_mfma_f32_16x16x32_bf16 v[152:155], v[28:31], a[40:43], v[152:155]
v_exp_f32 v164, v164
v_mfma_f32_16x16x32_bf16 v[156:159], v[28:31], a[44:47], v[156:159]
v_exp_f32 v165, v165
s_waitcnt lgkmcnt(2)
v_mfma_f32_16x16x32_bf16 v[96:99], v[16:19], a[48:51], v[96:99]
ds_read_b64_tr_b16 v[28:29], v185 offset:4096
v_mul_f32 v167, v51, v167
v_mfma_f32_16x16x32_bf16 v[100:103], v[16:19], a[52:55], v[100:103]
ds_read_b64_tr_b16 v[30:31], v185 offset:6144
v_mul_f32 v80, v48, v80
v_mfma_f32_16x16x32_bf16 v[104:107], v[16:19], a[56:59], v[104:107]
v_exp_f32 v166, v166
v_mfma_f32_16x16x32_bf16 v[108:111], v[16:19], a[60:63], v[108:111]
v_exp_f32 v167, v167
v_mfma_f32_16x16x32_bf16 v[112:115], v[20:23], a[48:51], v[112:115]
ds_read_b64_tr_b16 v[16:17], v184 offset:8192
v_mul_f32 v81, v49, v81
v_mfma_f32_16x16x32_bf16 v[116:119], v[20:23], a[52:55], v[116:119]
ds_read_b64_tr_b16 v[18:19], v184 offset:10240
v_mul_f32 v82, v50, v82
v_mfma_f32_16x16x32_bf16 v[120:123], v[20:23], a[56:59], v[120:123]
v_mul_f32 v83, v51, v83
v_add_f32 v164, 1.0, v164
v_mfma_f32_16x16x32_bf16 v[124:127], v[20:23], a[60:63], v[124:127]
v_rcp_f32 v164, v164
s_waitcnt lgkmcnt(2)
v_mfma_f32_16x16x32_bf16 v[128:131], v[24:27], a[48:51], v[128:131]
ds_read_b64_tr_b16 v[20:21], v185 offset:8192
v_add_f32 v165, 1.0, v165
v_mfma_f32_16x16x32_bf16 v[132:135], v[24:27], a[52:55], v[132:135]
ds_read_b64_tr_b16 v[22:23], v185 offset:10240
v_add_f32 v166, 1.0, v166
v_mfma_f32_16x16x32_bf16 v[136:139], v[24:27], a[56:59], v[136:139]
v_rcp_f32 v165, v165
v_mfma_f32_16x16x32_bf16 v[140:143], v[24:27], a[60:63], v[140:143]
v_rcp_f32 v166, v166
v_mfma_f32_16x16x32_bf16 v[144:147], v[28:31], a[48:51], v[144:147]
ds_read_b64_tr_b16 v[24:25], v184 offset:12288
v_add_f32 v167, 1.0, v167
v_mfma_f32_16x16x32_bf16 v[148:151], v[28:31], a[52:55], v[148:151]
ds_read_b64_tr_b16 v[26:27], v184 offset:14336
v_mul_f32 v80, v80, v164
v_mfma_f32_16x16x32_bf16 v[152:155], v[28:31], a[56:59], v[152:155]
v_rcp_f32 v167, v167
v_mfma_f32_16x16x32_bf16 v[156:159], v[28:31], a[60:63], v[156:159]
v_mul_f32 v81, v81, v165
v_mul_f32 v82, v82, v166
s_waitcnt lgkmcnt(2)
v_mfma_f32_16x16x32_bf16 v[96:99], v[16:19], a[64:67], v[96:99]
ds_read_b64_tr_b16 v[28:29], v185 offset:12288
v_mul_f32 v83, v83, v167
v_mfma_f32_16x16x32_bf16 v[100:103], v[16:19], a[68:71], v[100:103]
ds_read_b64_tr_b16 v[30:31], v185 offset:14336
v_cvt_pk_bf16_f32 v170, v80, v81
v_mfma_f32_16x16x32_bf16 v[104:107], v[16:19], a[72:75], v[104:107]
v_cvt_pk_bf16_f32 v171, v82, v83
v_mul_f32 v160, v36, v36
v_mfma_f32_16x16x32_bf16 v[108:111], v[16:19], a[76:79], v[108:111]
buffer_store_dwordx4 v[168:171], v9, s[8:11], s42 offen offset:0 sc1
v_mfma_f32_16x16x32_bf16 v[112:115], v[20:23], a[64:67], v[112:115]
ds_read_b64_tr_b16 v[16:17], v184 offset:16384
v_mul_f32 v161, v37, v37
v_mfma_f32_16x16x32_bf16 v[116:119], v[20:23], a[68:71], v[116:119]
ds_read_b64_tr_b16 v[18:19], v184 offset:18432
v_mul_f32 v162, v38, v38
v_mfma_f32_16x16x32_bf16 v[120:123], v[20:23], a[72:75], v[120:123]
v_mul_f32 v163, v39, v39
v_fma_f32 v160, v160, v12, s44
v_mfma_f32_16x16x32_bf16 v[124:127], v[20:23], a[76:79], v[124:127]
v_fma_f32 v161, v161, v12, s44
v_fma_f32 v162, v162, v12, s44
s_waitcnt lgkmcnt(2)
v_mfma_f32_16x16x32_bf16 v[128:131], v[24:27], a[64:67], v[128:131]
ds_read_b64_tr_b16 v[20:21], v185 offset:16384
v_fma_f32 v163, v163, v12, s44
v_mfma_f32_16x16x32_bf16 v[132:135], v[24:27], a[68:71], v[132:135]
ds_read_b64_tr_b16 v[22:23], v185 offset:18432
v_mul_f32 v160, v36, v160
v_mfma_f32_16x16x32_bf16 v[136:139], v[24:27], a[72:75], v[136:139]
v_exp_f32 v160, v160
v_mfma_f32_16x16x32_bf16 v[140:143], v[24:27], a[76:79], v[140:143]
v_mul_f32 v161, v37, v161
v_mul_f32 v162, v38, v162
v_mfma_f32_16x16x32_bf16 v[144:147], v[28:31], a[64:67], v[144:147]
ds_read_b64_tr_b16 v[24:25], v184 offset:20480
v_mul_f32 v163, v39, v163
v_mfma_f32_16x16x32_bf16 v[148:151], v[28:31], a[68:71], v[148:151]
ds_read_b64_tr_b16 v[26:27], v184 offset:22528
v_mul_f32 v68, v36, v68
v_mfma_f32_16x16x32_bf16 v[152:155], v[28:31], a[72:75], v[152:155]
v_exp_f32 v161, v161
v_mfma_f32_16x16x32_bf16 v[156:159], v[28:31], a[76:79], v[156:159]
v_exp_f32 v162, v162
s_waitcnt lgkmcnt(2)
v_mfma_f32_16x16x32_bf16 v[96:99], v[16:19], a[80:83], v[96:99]
ds_read_b64_tr_b16 v[28:29], v185 offset:20480
v_mul_f32 v69, v37, v69
v_mfma_f32_16x16x32_bf16 v[100:103], v[16:19], a[84:87], v[100:103]
ds_read_b64_tr_b16 v[30:31], v185 offset:22528
v_mul_f32 v70, v38, v70
v_mfma_f32_16x16x32_bf16 v[104:107], v[16:19], a[88:91], v[104:107]
v_exp_f32 v163, v163
v_mfma_f32_16x16x32_bf16 v[108:111], v[16:19], a[92:95], v[108:111]
v_add_u32 v184, 0xfffe2000, v184
v_add_u32 v185, 0xfffe2000, v185
v_mfma_f32_16x16x32_bf16 v[112:115], v[20:23], a[80:83], v[112:115]
s_barrier
ds_read_b64_tr_b16 v[16:17], v184 offset:0
v_mfma_f32_16x16x32_bf16 v[116:119], v[20:23], a[84:87], v[116:119]
ds_read_b64_tr_b16 v[18:19], v184 offset:2048
s_add_u32 m0, s31, 98304
v_mul_f32 v71, v39, v71
v_mfma_f32_16x16x32_bf16 v[120:123], v[20:23], a[88:91], v[120:123]
s_add_u32 s40, s32, 128
buffer_load_dwordx4 v1, s[12:15], s40 offen lds
v_mfma_f32_16x16x32_bf16 v[124:127], v[20:23], a[92:95], v[124:127]
v_add_f32 v160, 1.0, v160
v_add_f32 v161, 1.0, v161
s_waitcnt lgkmcnt(2)
v_mfma_f32_16x16x32_bf16 v[128:131], v[24:27], a[80:83], v[128:131]
ds_read_b64_tr_b16 v[20:21], v185 offset:0
s_add_u32 m0, s31, 102400
v_add_f32 v162, 1.0, v162
v_mfma_f32_16x16x32_bf16 v[132:135], v[24:27], a[84:87], v[132:135]
ds_read_b64_tr_b16 v[22:23], v185 offset:2048
s_add_u32 s40, s32, 295040
v_add_f32 v163, 1.0, v163
v_mfma_f32_16x16x32_bf16 v[136:139], v[24:27], a[88:91], v[136:139]
v_rcp_f32 v160, v160
v_mfma_f32_16x16x32_bf16 v[140:143], v[24:27], a[92:95], v[140:143]
buffer_load_dwordx4 v1, s[12:15], s40 offen lds
v_mfma_f32_16x16x32_bf16 v[144:147], v[28:31], a[80:83], v[144:147]
ds_read_b64_tr_b16 v[24:25], v184 offset:4096
v_mul_f32 v68, v68, v160
v_mfma_f32_16x16x32_bf16 v[148:151], v[28:31], a[84:87], v[148:151]
ds_read_b64_tr_b16 v[26:27], v184 offset:6144
v_mul_f32 v164, v52, v52
v_mfma_f32_16x16x32_bf16 v[152:155], v[28:31], a[88:91], v[152:155]
s_add_u32 m0, s31, 106496
s_add_u32 s40, s32, 589952
v_rcp_f32 v161, v161
v_mfma_f32_16x16x32_bf16 v[156:159], v[28:31], a[92:95], v[156:159]
v_rcp_f32 v162, v162
s_waitcnt lgkmcnt(2)
v_mfma_f32_16x16x32_bf16 v[96:99], v[16:19], a[96:99], v[96:99]
ds_read_b64_tr_b16 v[28:29], v185 offset:4096
v_mul_f32 v69, v69, v161
v_mfma_f32_16x16x32_bf16 v[100:103], v[16:19], a[100:103], v[100:103]
ds_read_b64_tr_b16 v[30:31], v185 offset:6144
v_mul_f32 v70, v70, v162
v_mfma_f32_16x16x32_bf16 v[104:107], v[16:19], a[104:107], v[104:107]
buffer_load_dwordx4 v1, s[12:15], s40 offen lds
v_mfma_f32_16x16x32_bf16 v[108:111], v[16:19], a[108:111], v[108:111]
v_rcp_f32 v163, v163
v_mfma_f32_16x16x32_bf16 v[112:115], v[20:23], a[96:99], v[112:115]
ds_read_b64_tr_b16 v[16:17], v184 offset:8192
s_add_u32 m0, s31, 110592
v_mul_f32 v71, v71, v163
v_mfma_f32_16x16x32_bf16 v[116:119], v[20:23], a[100:103], v[116:119]
ds_read_b64_tr_b16 v[18:19], v184 offset:10240
s_add_u32 s40, s32, 884864
v_cvt_pk_bf16_f32 v172, v68, v69
v_mfma_f32_16x16x32_bf16 v[120:123], v[20:23], a[104:107], v[120:123]
v_cvt_pk_bf16_f32 v173, v70, v71
v_mul_f32 v165, v53, v53
v_mfma_f32_16x16x32_bf16 v[124:127], v[20:23], a[108:111], v[124:127]
buffer_load_dwordx4 v1, s[12:15], s40 offen lds
s_waitcnt lgkmcnt(2)
v_mfma_f32_16x16x32_bf16 v[128:131], v[24:27], a[96:99], v[128:131]
ds_read_b64_tr_b16 v[20:21], v185 offset:8192
v_mul_f32 v166, v54, v54
v_mfma_f32_16x16x32_bf16 v[132:135], v[24:27], a[100:103], v[132:135]
ds_read_b64_tr_b16 v[22:23], v185 offset:10240
v_mul_f32 v167, v55, v55
v_mfma_f32_16x16x32_bf16 v[136:139], v[24:27], a[104:107], v[136:139]
s_add_u32 m0, s31, 114688
s_add_u32 s40, s32, 1179776
v_fma_f32 v164, v164, v12, s44
v_mfma_f32_16x16x32_bf16 v[140:143], v[24:27], a[108:111], v[140:143]
v_fma_f32 v165, v165, v12, s44
v_fma_f32 v166, v166, v12, s44
v_mfma_f32_16x16x32_bf16 v[144:147], v[28:31], a[96:99], v[144:147]
ds_read_b64_tr_b16 v[24:25], v184 offset:12288
v_fma_f32 v167, v167, v12, s44
v_mfma_f32_16x16x32_bf16 v[148:151], v[28:31], a[100:103], v[148:151]
ds_read_b64_tr_b16 v[26:27], v184 offset:14336
v_mul_f32 v164, v52, v164
v_mfma_f32_16x16x32_bf16 v[152:155], v[28:31], a[104:107], v[152:155]
buffer_load_dwordx4 v1, s[12:15], s40 offen lds
v_mfma_f32_16x16x32_bf16 v[156:159], v[28:31], a[108:111], v[156:159]
v_exp_f32 v164, v164
s_waitcnt lgkmcnt(2)
v_mfma_f32_16x16x32_bf16 v[96:99], v[16:19], a[112:115], v[96:99]
ds_read_b64_tr_b16 v[28:29], v185 offset:12288
s_add_u32 m0, s31, 118784
v_mul_f32 v165, v53, v165
v_mfma_f32_16x16x32_bf16 v[100:103], v[16:19], a[116:119], v[100:103]
ds_read_b64_tr_b16 v[30:31], v185 offset:14336
s_add_u32 s40, s32, 1474688
v_mul_f32 v166, v54, v166
v_mfma_f32_16x16x32_bf16 v[104:107], v[16:19], a[120:123], v[104:107]
v_exp_f32 v165, v165
v_mfma_f32_16x16x32_bf16 v[108:111], v[16:19], a[124:127], v[108:111]
buffer_load_dwordx4 v1, s[12:15], s40 offen lds
v_mfma_f32_16x16x32_bf16 v[112:115], v[20:23], a[112:115], v[112:115]
ds_read_b64_tr_b16 v[16:17], v184 offset:16384
v_mul_f32 v167, v55, v167
v_mfma_f32_16x16x32_bf16 v[116:119], v[20:23], a[116:119], v[116:119]
ds_read_b64_tr_b16 v[18:19], v184 offset:18432
v_mul_f32 v84, v52, v84
v_mfma_f32_16x16x32_bf16 v[120:123], v[20:23], a[120:123], v[120:123]
v_exp_f32 v166, v166
v_mfma_f32_16x16x32_bf16 v[124:127], v[20:23], a[124:127], v[124:127]
v_exp_f32 v167, v167
s_waitcnt lgkmcnt(2)
v_mfma_f32_16x16x32_bf16 v[128:131], v[24:27], a[112:115], v[128:131]
ds_read_b64_tr_b16 v[20:21], v185 offset:16384
v_mul_f32 v85, v53, v85
v_mfma_f32_16x16x32_bf16 v[132:135], v[24:27], a[116:119], v[132:135]
ds_read_b64_tr_b16 v[22:23], v185 offset:18432
v_mul_f32 v86, v54, v86
v_mfma_f32_16x16x32_bf16 v[136:139], v[24:27], a[120:123], v[136:139]
v_mul_f32 v87, v55, v87
v_add_f32 v164, 1.0, v164
v_mfma_f32_16x16x32_bf16 v[140:143], v[24:27], a[124:127], v[140:143]
v_rcp_f32 v164, v164
v_mfma_f32_16x16x32_bf16 v[144:147], v[28:31], a[112:115], v[144:147]
ds_read_b64_tr_b16 v[24:25], v184 offset:20480
v_add_f32 v165, 1.0, v165
v_mfma_f32_16x16x32_bf16 v[148:151], v[28:31], a[116:119], v[148:151]
ds_read_b64_tr_b16 v[26:27], v184 offset:22528
v_add_f32 v166, 1.0, v166
v_mfma_f32_16x16x32_bf16 v[152:155], v[28:31], a[120:123], v[152:155]
v_rcp_f32 v165, v165
v_mfma_f32_16x16x32_bf16 v[156:159], v[28:31], a[124:127], v[156:159]
v_rcp_f32 v166, v166
s_waitcnt lgkmcnt(2)
v_mfma_f32_16x16x32_bf16 v[96:99], v[16:19], a[128:131], v[96:99]
ds_read_b64_tr_b16 v[28:29], v185 offset:20480
v_add_f32 v167, 1.0, v167
v_mfma_f32_16x16x32_bf16 v[100:103], v[16:19], a[132:135], v[100:103]
ds_read_b64_tr_b16 v[30:31], v185 offset:22528
v_mul_f32 v84, v84, v164
v_mfma_f32_16x16x32_bf16 v[104:107], v[16:19], a[136:139], v[104:107]
v_rcp_f32 v167, v167
v_mfma_f32_16x16x32_bf16 v[108:111], v[16:19], a[140:143], v[108:111]
v_add_u32 v184, 0x6000, v184
v_add_u32 v185, 0x6000, v185
v_mfma_f32_16x16x32_bf16 v[112:115], v[20:23], a[128:131], v[112:115]
s_barrier
ds_read_b64_tr_b16 v[16:17], v184 offset:0
v_mfma_f32_16x16x32_bf16 v[116:119], v[20:23], a[132:135], v[116:119]
ds_read_b64_tr_b16 v[18:19], v184 offset:2048
s_add_u32 m0, s31, 122880
v_mul_f32 v85, v85, v165
v_mfma_f32_16x16x32_bf16 v[120:123], v[20:23], a[136:139], v[120:123]
s_add_u32 s40, s32, 1769600
buffer_load_dwordx4 v1, s[12:15], s40 offen lds
v_mfma_f32_16x16x32_bf16 v[124:127], v[20:23], a[140:143], v[124:127]
v_mul_f32 v86, v86, v166
v_mul_f32 v87, v87, v167
s_waitcnt lgkmcnt(2)
v_mfma_f32_16x16x32_bf16 v[128:131], v[24:27], a[128:131], v[128:131]
ds_read_b64_tr_b16 v[20:21], v185 offset:0
s_add_u32 m0, s31, 126976
v_cvt_pk_bf16_f32 v174, v84, v85
v_mfma_f32_16x16x32_bf16 v[132:135], v[24:27], a[132:135], v[132:135]
ds_read_b64_tr_b16 v[22:23], v185 offset:2048
s_add_u32 s40, s32, 2064512
v_cvt_pk_bf16_f32 v175, v86, v87
v_mfma_f32_16x16x32_bf16 v[136:139], v[24:27], a[136:139], v[136:139]
buffer_store_dwordx4 v[172:175], v9, s[8:11], s42 offen offset:1024 sc1
v_mfma_f32_16x16x32_bf16 v[140:143], v[24:27], a[140:143], v[140:143]
buffer_load_dwordx4 v1, s[12:15], s40 offen lds
v_mfma_f32_16x16x32_bf16 v[144:147], v[28:31], a[128:131], v[144:147]
ds_read_b64_tr_b16 v[24:25], v184 offset:4096
v_mul_f32 v160, v40, v40
v_mfma_f32_16x16x32_bf16 v[148:151], v[28:31], a[132:135], v[148:151]
ds_read_b64_tr_b16 v[26:27], v184 offset:6144
v_mul_f32 v161, v41, v41
v_mfma_f32_16x16x32_bf16 v[152:155], v[28:31], a[136:139], v[152:155]
s_add_u32 m0, s31, 131072
s_add_u32 s40, s32, 2359424
v_mul_f32 v162, v42, v42
v_mfma_f32_16x16x32_bf16 v[156:159], v[28:31], a[140:143], v[156:159]
v_mul_f32 v163, v43, v43
v_fma_f32 v160, v160, v12, s44
s_waitcnt lgkmcnt(2)
v_mfma_f32_16x16x32_bf16 v[96:99], v[16:19], a[144:147], v[96:99]
ds_read_b64_tr_b16 v[28:29], v185 offset:4096
v_fma_f32 v161, v161, v12, s44
v_mfma_f32_16x16x32_bf16 v[100:103], v[16:19], a[148:151], v[100:103]
ds_read_b64_tr_b16 v[30:31], v185 offset:6144
v_fma_f32 v162, v162, v12, s44
v_mfma_f32_16x16x32_bf16 v[104:107], v[16:19], a[152:155], v[104:107]
buffer_load_dwordx4 v1, s[12:15], s40 offen lds
v_mfma_f32_16x16x32_bf16 v[108:111], v[16:19], a[156:159], v[108:111]
v_fma_f32 v163, v163, v12, s44
v_mul_f32 v160, v40, v160
v_mfma_f32_16x16x32_bf16 v[112:115], v[20:23], a[144:147], v[112:115]
ds_read_b64_tr_b16 v[16:17], v184 offset:8192
s_add_u32 m0, s31, 135168
v_mul_f32 v161, v41, v161
v_mfma_f32_16x16x32_bf16 v[116:119], v[20:23], a[148:151], v[116:119]
ds_read_b64_tr_b16 v[18:19], v184 offset:10240
s_add_u32 s40, s32, 2654336
v_mul_f32 v162, v42, v162
v_mfma_f32_16x16x32_bf16 v[120:123], v[20:23], a[152:155], v[120:123]
v_exp_f32 v160, v160
v_mfma_f32_16x16x32_bf16 v[124:127], v[20:23], a[156:159], v[124:127]
buffer_load_dwordx4 v1, s[12:15], s40 offen lds
s_waitcnt lgkmcnt(2)
v_mfma_f32_16x16x32_bf16 v[128:131], v[24:27], a[144:147], v[128:131]
ds_read_b64_tr_b16 v[20:21], v185 offset:8192
v_mul_f32 v163, v43, v163
v_mfma_f32_16x16x32_bf16 v[132:135], v[24:27], a[148:151], v[132:135]
ds_read_b64_tr_b16 v[22:23], v185 offset:10240
v_mul_f32 v72, v40, v72
v_mfma_f32_16x16x32_bf16 v[136:139], v[24:27], a[152:155], v[136:139]
s_add_u32 m0, s31, 139264
s_add_u32 s40, s32, 2949248
v_exp_f32 v161, v161
v_mfma_f32_16x16x32_bf16 v[140:143], v[24:27], a[156:159], v[140:143]
v_exp_f32 v162, v162
v_mfma_f32_16x16x32_bf16 v[144:147], v[28:31], a[144:147], v[144:147]
ds_read_b64_tr_b16 v[24:25], v184 offset:12288
v_mul_f32 v73, v41, v73
v_mfma_f32_16x16x32_bf16 v[148:151], v[28:31], a[148:151], v[148:151]
ds_read_b64_tr_b16 v[26:27], v184 offset:14336
v_mul_f32 v74, v42, v74
v_mfma_f32_16x16x32_bf16 v[152:155], v[28:31], a[152:155], v[152:155]
buffer_load_dwordx4 v1, s[12:15], s40 offen lds
v_mfma_f32_16x16x32_bf16 v[156:159], v[28:31], a[156:159], v[156:159]
v_exp_f32 v163, v163
s_waitcnt lgkmcnt(2)
v_mfma_f32_16x16x32_bf16 v[96:99], v[16:19], a[160:163], v[96:99]
ds_read_b64_tr_b16 v[28:29], v185 offset:12288
s_add_u32 m0, s31, 143360
v_mul_f32 v75, v43, v75
v_mfma_f32_16x16x32_bf16 v[100:103], v[16:19], a[164:167], v[100:103]
ds_read_b64_tr_b16 v[30:31], v185 offset:14336
s_add_u32 s40, s32, 3244160
v_add_f32 v160, 1.0, v160
v_mfma_f32_16x16x32_bf16 v[104:107], v[16:19], a[168:171], v[104:107]
v_rcp_f32 v160, v160
v_mfma_f32_16x16x32_bf16 v[108:111], v[16:19], a[172:175], v[108:111]
buffer_load_dwordx4 v1, s[12:15], s40 offen lds
v_mfma_f32_16x16x32_bf16 v[112:115], v[20:23], a[160:163], v[112:115]
ds_read_b64_tr_b16 v[16:17], v184 offset:16384
v_add_f32 v161, 1.0, v161
v_mfma_f32_16x16x32_bf16 v[116:119], v[20:23], a[164:167], v[116:119]
ds_read_b64_tr_b16 v[18:19], v184 offset:18432
v_add_f32 v162, 1.0, v162
v_mfma_f32_16x16x32_bf16 v[120:123], v[20:23], a[168:171], v[120:123]
v_rcp_f32 v161, v161
v_mfma_f32_16x16x32_bf16 v[124:127], v[20:23], a[172:175], v[124:127]
v_rcp_f32 v162, v162
s_waitcnt lgkmcnt(2)
v_mfma_f32_16x16x32_bf16 v[128:131], v[24:27], a[160:163], v[128:131]
ds_read_b64_tr_b16 v[20:21], v185 offset:16384
v_add_f32 v163, 1.0, v163
v_mfma_f32_16x16x32_bf16 v[132:135], v[24:27], a[164:167], v[132:135]
ds_read_b64_tr_b16 v[22:23], v185 offset:18432
v_mul_f32 v72, v72, v160
v_mfma_f32_16x16x32_bf16 v[136:139], v[24:27], a[168:171], v[136:139]
v_rcp_f32 v163, v163
v_mfma_f32_16x16x32_bf16 v[140:143], v[24:27], a[172:175], v[140:143]
v_mul_f32 v73, v73, v161
v_mul_f32 v74, v74, v162
v_mfma_f32_16x16x32_bf16 v[144:147], v[28:31], a[160:163], v[144:147]
ds_read_b64_tr_b16 v[24:25], v184 offset:20480
v_mul_f32 v75, v75, v163
v_mfma_f32_16x16x32_bf16 v[148:151], v[28:31], a[164:167], v[148:151]
ds_read_b64_tr_b16 v[26:27], v184 offset:22528
v_cvt_pk_bf16_f32 v168, v72, v73
v_mfma_f32_16x16x32_bf16 v[152:155], v[28:31], a[168:171], v[152:155]
v_cvt_pk_bf16_f32 v169, v74, v75
v_mul_f32 v164, v56, v56
v_mfma_f32_16x16x32_bf16 v[156:159], v[28:31], a[172:175], v[156:159]
v_mul_f32 v165, v57, v57
v_mul_f32 v166, v58, v58
s_waitcnt lgkmcnt(2)
v_mfma_f32_16x16x32_bf16 v[96:99], v[16:19], a[176:179], v[96:99]
ds_read_b64_tr_b16 v[28:29], v185 offset:20480
v_mul_f32 v167, v59, v59
v_mfma_f32_16x16x32_bf16 v[100:103], v[16:19], a[180:183], v[100:103]
ds_read_b64_tr_b16 v[30:31], v185 offset:22528
v_fma_f32 v164, v164, v12, s44
v_mfma_f32_16x16x32_bf16 v[104:107], v[16:19], a[184:187], v[104:107]
v_fma_f32 v165, v165, v12, s44
v_fma_f32 v166, v166, v12, s44
v_mfma_f32_16x16x32_bf16 v[108:111], v[16:19], a[188:191], v[108:111]
v_add_u32 v184, 0x6000, v184
v_add_u32 v185, 0x6000, v185
v_mfma_f32_16x16x32_bf16 v[112:115], v[20:23], a[176:179], v[112:115]
s_barrier
ds_read_b64_tr_b16 v[16:17], v184 offset:0
v_mfma_f32_16x16x32_bf16 v[116:119], v[20:23], a[180:183], v[116:119]
ds_read_b64_tr_b16 v[18:19], v184 offset:2048
s_add_u32 m0, s31, 0
v_fma_f32 v167, v167, v12, s44
v_mfma_f32_16x16x32_bf16 v[120:123], v[20:23], a[184:187], v[120:123]
s_add_u32 s40, s32, 3539072
buffer_load_dwordx4 v1, s[12:15], s40 offen lds
v_mfma_f32_16x16x32_bf16 v[124:127], v[20:23], a[188:191], v[124:127]
v_mul_f32 v164, v56, v164
v_mul_f32 v165, v57, v165
s_waitcnt lgkmcnt(2)
v_mfma_f32_16x16x32_bf16 v[128:131], v[24:27], a[176:179], v[128:131]
ds_read_b64_tr_b16 v[20:21], v185 offset:0
s_add_u32 m0, s31, 4096
v_mul_f32 v166, v58, v166
v_mfma_f32_16x16x32_bf16 v[132:135], v[24:27], a[180:183], v[132:135]
ds_read_b64_tr_b16 v[22:23], v185 offset:2048
s_add_u32 s40, s32, 3833984
v_mul_f32 v167, v59, v167
v_mfma_f32_16x16x32_bf16 v[136:139], v[24:27], a[184:187], v[136:139]
v_exp_f32 v164, v164
v_mfma_f32_16x16x32_bf16 v[140:143], v[24:27], a[188:191], v[140:143]
buffer_load_dwordx4 v1, s[12:15], s40 offen lds
v_mfma_f32_16x16x32_bf16 v[144:147], v[28:31], a[176:179], v[144:147]
ds_read_b64_tr_b16 v[24:25], v184 offset:4096
v_mul_f32 v88, v56, v88
v_mfma_f32_16x16x32_bf16 v[148:151], v[28:31], a[180:183], v[148:151]
ds_read_b64_tr_b16 v[26:27], v184 offset:6144
v_mul_f32 v89, v57, v89
v_mfma_f32_16x16x32_bf16 v[152:155], v[28:31], a[184:187], v[152:155]
s_add_u32 m0, s31, 8192
s_add_u32 s40, s32, 4128896
v_exp_f32 v165, v165
v_mfma_f32_16x16x32_bf16 v[156:159], v[28:31], a[188:191], v[156:159]
v_exp_f32 v166, v166
s_waitcnt lgkmcnt(2)
v_mfma_f32_16x16x32_bf16 v[96:99], v[16:19], a[192:195], v[96:99]
ds_read_b64_tr_b16 v[28:29], v185 offset:4096
v_mul_f32 v90, v58, v90
v_mfma_f32_16x16x32_bf16 v[100:103], v[16:19], a[196:199], v[100:103]
ds_read_b64_tr_b16 v[30:31], v185 offset:6144
v_mul_f32 v91, v59, v91
v_mfma_f32_16x16x32_bf16 v[104:107], v[16:19], a[200:203], v[104:107]
buffer_load_dwordx4 v1, s[12:15], s40 offen lds
v_mfma_f32_16x16x32_bf16 v[108:111], v[16:19], a[204:207], v[108:111]
v_exp_f32 v167, v167
v_mfma_f32_16x16x32_bf16 v[112:115], v[20:23], a[192:195], v[112:115]
ds_read_b64_tr_b16 v[16:17], v184 offset:8192
s_add_u32 m0, s31, 12288
v_add_f32 v164, 1.0, v164
v_mfma_f32_16x16x32_bf16 v[116:119], v[20:23], a[196:199], v[116:119]
ds_read_b64_tr_b16 v[18:19], v184 offset:10240
s_add_u32 s40, s32, 4423808
v_add_f32 v165, 1.0, v165
v_mfma_f32_16x16x32_bf16 v[120:123], v[20:23], a[200:203], v[120:123]
v_rcp_f32 v164, v164
v_mfma_f32_16x16x32_bf16 v[124:127], v[20:23], a[204:207], v[124:127]
buffer_load_dwordx4 v1, s[12:15], s40 offen lds
s_waitcnt lgkmcnt(2)
v_mfma_f32_16x16x32_bf16 v[128:131], v[24:27], a[192:195], v[128:131]
ds_read_b64_tr_b16 v[20:21], v185 offset:8192
v_add_f32 v166, 1.0, v166
v_mfma_f32_16x16x32_bf16 v[132:135], v[24:27], a[196:199], v[132:135]
ds_read_b64_tr_b16 v[22:23], v185 offset:10240
v_add_f32 v167, 1.0, v167
v_mfma_f32_16x16x32_bf16 v[136:139], v[24:27], a[200:203], v[136:139]
s_add_u32 m0, s31, 16384
s_add_u32 s40, s32, 4718720
v_rcp_f32 v165, v165
v_mfma_f32_16x16x32_bf16 v[140:143], v[24:27], a[204:207], v[140:143]
v_rcp_f32 v166, v166
v_mfma_f32_16x16x32_bf16 v[144:147], v[28:31], a[192:195], v[144:147]
ds_read_b64_tr_b16 v[24:25], v184 offset:12288
v_mul_f32 v88, v88, v164
v_mfma_f32_16x16x32_bf16 v[148:151], v[28:31], a[196:199], v[148:151]
ds_read_b64_tr_b16 v[26:27], v184 offset:14336
v_mul_f32 v89, v89, v165
v_mfma_f32_16x16x32_bf16 v[152:155], v[28:31], a[200:203], v[152:155]
buffer_load_dwordx4 v1, s[12:15], s40 offen lds
v_mfma_f32_16x16x32_bf16 v[156:159], v[28:31], a[204:207], v[156:159]
v_rcp_f32 v167, v167
s_waitcnt lgkmcnt(2)
v_mfma_f32_16x16x32_bf16 v[96:99], v[16:19], a[208:211], v[96:99]
ds_read_b64_tr_b16 v[28:29], v185 offset:12288
s_add_u32 m0, s31, 20480
v_mul_f32 v90, v90, v166
v_mfma_f32_16x16x32_bf16 v[100:103], v[16:19], a[212:215], v[100:103]
ds_read_b64_tr_b16 v[30:31], v185 offset:14336
s_add_u32 s40, s32, 5013632
v_mul_f32 v91, v91, v167
v_mfma_f32_16x16x32_bf16 v[104:107], v[16:19], a[216:219], v[104:107]
v_cvt_pk_bf16_f32 v170, v88, v89
v_cvt_pk_bf16_f32 v171, v90, v91
v_mfma_f32_16x16x32_bf16 v[108:111], v[16:19], a[220:223], v[108:111]
buffer_load_dwordx4 v1, s[12:15], s40 offen lds
v_mfma_f32_16x16x32_bf16 v[112:115], v[20:23], a[208:211], v[112:115]
ds_read_b64_tr_b16 v[16:17], v184 offset:16384
v_mul_f32 v160, v44, v44
v_mfma_f32_16x16x32_bf16 v[116:119], v[20:23], a[212:215], v[116:119]
ds_read_b64_tr_b16 v[18:19], v184 offset:18432
v_mul_f32 v161, v45, v45
v_mfma_f32_16x16x32_bf16 v[120:123], v[20:23], a[216:219], v[120:123]
buffer_store_dwordx4 v[168:171], v9, s[8:11], s42 offen offset:2048 sc1
v_mfma_f32_16x16x32_bf16 v[124:127], v[20:23], a[220:223], v[124:127]
v_mul_f32 v162, v46, v46
v_mul_f32 v163, v47, v47
s_waitcnt lgkmcnt(2)
v_mfma_f32_16x16x32_bf16 v[128:131], v[24:27], a[208:211], v[128:131]
ds_read_b64_tr_b16 v[20:21], v185 offset:16384
v_fma_f32 v160, v160, v12, s44
v_mfma_f32_16x16x32_bf16 v[132:135], v[24:27], a[212:215], v[132:135]
ds_read_b64_tr_b16 v[22:23], v185 offset:18432
v_fma_f32 v161, v161, v12, s44
v_mfma_f32_16x16x32_bf16 v[136:139], v[24:27], a[216:219], v[136:139]
v_fma_f32 v162, v162, v12, s44
v_fma_f32 v163, v163, v12, s44
v_mfma_f32_16x16x32_bf16 v[140:143], v[24:27], a[220:223], v[140:143]
v_mul_f32 v160, v44, v160
v_mul_f32 v161, v45, v161
v_mfma_f32_16x16x32_bf16 v[144:147], v[28:31], a[208:211], v[144:147]
ds_read_b64_tr_b16 v[24:25], v184 offset:20480
v_mul_f32 v162, v46, v162
v_mfma_f32_16x16x32_bf16 v[148:151], v[28:31], a[212:215], v[148:151]
ds_read_b64_tr_b16 v[26:27], v184 offset:22528
v_mul_f32 v163, v47, v163
v_mfma_f32_16x16x32_bf16 v[152:155], v[28:31], a[216:219], v[152:155]
v_exp_f32 v160, v160
v_mfma_f32_16x16x32_bf16 v[156:159], v[28:31], a[220:223], v[156:159]
v_exp_f32 v161, v161
s_waitcnt lgkmcnt(2)
v_mfma_f32_16x16x32_bf16 v[96:99], v[16:19], a[224:227], v[96:99]
ds_read_b64_tr_b16 v[28:29], v185 offset:20480
v_mul_f32 v76, v44, v76
v_mfma_f32_16x16x32_bf16 v[100:103], v[16:19], a[228:231], v[100:103]
ds_read_b64_tr_b16 v[30:31], v185 offset:22528
v_mul_f32 v77, v45, v77
v_mfma_f32_16x16x32_bf16 v[104:107], v[16:19], a[232:235], v[104:107]
v_exp_f32 v162, v162
v_mfma_f32_16x16x32_bf16 v[108:111], v[16:19], a[236:239], v[108:111]
v_add_u32 v184, 0x6000, v184
v_add_u32 v185, 0x6000, v185
v_mfma_f32_16x16x32_bf16 v[112:115], v[20:23], a[224:227], v[112:115]
s_barrier
ds_read_b64_tr_b16 v[16:17], v184 offset:0
v_mfma_f32_16x16x32_bf16 v[116:119], v[20:23], a[228:231], v[116:119]
ds_read_b64_tr_b16 v[18:19], v184 offset:2048
s_add_u32 m0, s31, 24576
v_mul_f32 v78, v46, v78
v_mfma_f32_16x16x32_bf16 v[120:123], v[20:23], a[232:235], v[120:123]
s_add_u32 s40, s32, 192
buffer_load_dwordx4 v1, s[12:15], s40 offen lds
v_mfma_f32_16x16x32_bf16 v[124:127], v[20:23], a[236:239], v[124:127]
v_exp_f32 v163, v163
s_waitcnt lgkmcnt(2)
v_mfma_f32_16x16x32_bf16 v[128:131], v[24:27], a[224:227], v[128:131]
ds_read_b64_tr_b16 v[20:21], v185 offset:0
v_mul_f32 v79, v47, v79
v_mfma_f32_16x16x32_bf16 v[132:135], v[24:27], a[228:231], v[132:135]
ds_read_b64_tr_b16 v[22:23], v185 offset:2048
v_add_f32 v160, 1.0, v160
v_mfma_f32_16x16x32_bf16 v[136:139], v[24:27], a[232:235], v[136:139]
v_rcp_f32 v160, v160
v_mfma_f32_16x16x32_bf16 v[140:143], v[24:27], a[236:239], v[140:143]
v_add_f32 v161, 1.0, v161
v_add_f32 v162, 1.0, v162
v_mfma_f32_16x16x32_bf16 v[144:147], v[28:31], a[224:227], v[144:147]
ds_read_b64_tr_b16 v[24:25], v184 offset:4096
v_add_f32 v163, 1.0, v163
v_mfma_f32_16x16x32_bf16 v[148:151], v[28:31], a[228:231], v[148:151]
ds_read_b64_tr_b16 v[26:27], v184 offset:6144
v_mul_f32 v76, v76, v160
v_mfma_f32_16x16x32_bf16 v[152:155], v[28:31], a[232:235], v[152:155]
s_add_u32 m0, s31, 28672
s_add_u32 s40, s32, 295104
v_rcp_f32 v161, v161
v_mfma_f32_16x16x32_bf16 v[156:159], v[28:31], a[236:239], v[156:159]
v_rcp_f32 v162, v162
s_waitcnt lgkmcnt(2)
v_mfma_f32_16x16x32_bf16 v[96:99], v[16:19], a[240:243], v[96:99]
ds_read_b64_tr_b16 v[28:29], v185 offset:4096
v_mul_f32 v77, v77, v161
v_mfma_f32_16x16x32_bf16 v[100:103], v[16:19], a[244:247], v[100:103]
ds_read_b64_tr_b16 v[30:31], v185 offset:6144
v_mul_f32 v78, v78, v162
v_mfma_f32_16x16x32_bf16 v[104:107], v[16:19], a[248:251], v[104:107]
buffer_load_dwordx4 v1, s[12:15], s40 offen lds
v_mfma_f32_16x16x32_bf16 v[108:111], v[16:19], a[252:255], v[108:111]
v_rcp_f32 v163, v163
v_mfma_f32_16x16x32_bf16 v[112:115], v[20:23], a[240:243], v[112:115]
ds_read_b64_tr_b16 v[16:17], v184 offset:8192
v_mul_f32 v79, v79, v163
v_mfma_f32_16x16x32_bf16 v[116:119], v[20:23], a[244:247], v[116:119]
ds_read_b64_tr_b16 v[18:19], v184 offset:10240
v_cvt_pk_bf16_f32 v172, v76, v77
v_mfma_f32_16x16x32_bf16 v[120:123], v[20:23], a[248:251], v[120:123]
v_cvt_pk_bf16_f32 v173, v78, v79
v_mul_f32 v164, v60, v60
v_mfma_f32_16x16x32_bf16 v[124:127], v[20:23], a[252:255], v[124:127]
v_mul_f32 v165, v61, v61
v_mul_f32 v166, v62, v62
s_waitcnt lgkmcnt(2)
v_mfma_f32_16x16x32_bf16 v[128:131], v[24:27], a[240:243], v[128:131]
ds_read_b64_tr_b16 v[20:21], v185 offset:8192
v_mul_f32 v167, v63, v63
v_mfma_f32_16x16x32_bf16 v[132:135], v[24:27], a[244:247], v[132:135]
ds_read_b64_tr_b16 v[22:23], v185 offset:10240
v_fma_f32 v164, v164, v12, s44
v_mfma_f32_16x16x32_bf16 v[136:139], v[24:27], a[248:251], v[136:139]
s_add_u32 m0, s31, 32768
s_add_u32 s40, s32, 590016
v_fma_f32 v165, v165, v12, s44
v_mfma_f32_16x16x32_bf16 v[140:143], v[24:27], a[252:255], v[140:143]
v_fma_f32 v166, v166, v12, s44
v_fma_f32 v167, v167, v12, s44
v_mfma_f32_16x16x32_bf16 v[144:147], v[28:31], a[240:243], v[144:147]
ds_read_b64_tr_b16 v[24:25], v184 offset:12288
v_mul_f32 v164, v60, v164
v_mfma_f32_16x16x32_bf16 v[148:151], v[28:31], a[244:247], v[148:151]
ds_read_b64_tr_b16 v[26:27], v184 offset:14336
v_mul_f32 v165, v61, v165
v_mfma_f32_16x16x32_bf16 v[152:155], v[28:31], a[248:251], v[152:155]
buffer_load_dwordx4 v1, s[12:15], s40 offen lds
v_mfma_f32_16x16x32_bf16 v[156:159], v[28:31], a[252:255], v[156:159]
v_exp_f32 v164, v164
s_waitcnt lgkmcnt(2)
v_mfma_f32_16x16x32_bf16 v[96:99], v[16:19], v[224:227], v[96:99]
ds_read_b64_tr_b16 v[28:29], v185 offset:12288
v_mul_f32 v166, v62, v166
v_mfma_f32_16x16x32_bf16 v[100:103], v[16:19], v[228:231], v[100:103]
ds_read_b64_tr_b16 v[30:31], v185 offset:14336
v_mul_f32 v167, v63, v167
v_mfma_f32_16x16x32_bf16 v[104:107], v[16:19], v[232:235], v[104:107]
v_exp_f32 v165, v165
v_mfma_f32_16x16x32_bf16 v[108:111], v[16:19], v[236:239], v[108:111]
v_exp_f32 v166, v166
v_mfma_f32_16x16x32_bf16 v[112:115], v[20:23], v[224:227], v[112:115]
ds_read_b64_tr_b16 v[16:17], v184 offset:16384
v_mul_f32 v92, v60, v92
v_mfma_f32_16x16x32_bf16 v[116:119], v[20:23], v[228:231], v[116:119]
ds_read_b64_tr_b16 v[18:19], v184 offset:18432
v_mul_f32 v93, v61, v93
v_mfma_f32_16x16x32_bf16 v[120:123], v[20:23], v[232:235], v[120:123]
s_add_u32 m0, s31, 36864
s_add_u32 s40, s32, 884928
v_exp_f32 v167, v167
v_mfma_f32_16x16x32_bf16 v[124:127], v[20:23], v[236:239], v[124:127]
v_mul_f32 v94, v62, v94
v_mul_f32 v95, v63, v95
s_waitcnt lgkmcnt(2)
v_mfma_f32_16x16x32_bf16 v[128:131], v[24:27], v[224:227], v[128:131]
ds_read_b64_tr_b16 v[20:21], v185 offset:16384
v_add_f32 v164, 1.0, v164
v_mfma_f32_16x16x32_bf16 v[132:135], v[24:27], v[228:231], v[132:135]
ds_read_b64_tr_b16 v[22:23], v185 offset:18432
v_add_f32 v165, 1.0, v165
v_mfma_f32_16x16x32_bf16 v[136:139], v[24:27], v[232:235], v[136:139]
buffer_load_dwordx4 v1, s[12:15], s40 offen lds
v_mfma_f32_16x16x32_bf16 v[140:143], v[24:27], v[236:239], v[140:143]
v_rcp_f32 v164, v164
v_mfma_f32_16x16x32_bf16 v[144:147], v[28:31], v[224:227], v[144:147]
ds_read_b64_tr_b16 v[24:25], v184 offset:20480
v_add_f32 v166, 1.0, v166
v_mfma_f32_16x16x32_bf16 v[148:151], v[28:31], v[228:231], v[148:151]
ds_read_b64_tr_b16 v[26:27], v184 offset:22528
v_add_f32 v167, 1.0, v167
v_mfma_f32_16x16x32_bf16 v[152:155], v[28:31], v[232:235], v[152:155]
v_rcp_f32 v165, v165
v_mfma_f32_16x16x32_bf16 v[156:159], v[28:31], v[236:239], v[156:159]
v_rcp_f32 v166, v166
s_waitcnt lgkmcnt(2)
v_mfma_f32_16x16x32_bf16 v[96:99], v[16:19], v[240:243], v[96:99]
ds_read_b64_tr_b16 v[28:29], v185 offset:20480
v_mul_f32 v92, v92, v164
v_mfma_f32_16x16x32_bf16 v[100:103], v[16:19], v[244:247], v[100:103]
ds_read_b64_tr_b16 v[30:31], v185 offset:22528
v_mul_f32 v93, v93, v165
v_mfma_f32_16x16x32_bf16 v[104:107], v[16:19], v[248:251], v[104:107]
s_add_u32 m0, s31, 40960
s_add_u32 s40, s32, 1179840
v_rcp_f32 v167, v167
v_mfma_f32_16x16x32_bf16 v[108:111], v[16:19], v[252:255], v[108:111]
v_add_u32 v4, 0x18000, v4
v_add_u32 v5, 0x18000, v5
v_mfma_f32_16x16x32_bf16 v[112:115], v[20:23], v[240:243], v[112:115]
s_waitcnt vmcnt(18)
s_barrier
ds_read_b64_tr_b16 v[16:17], v4 offset:0
v_mfma_f32_16x16x32_bf16 v[116:119], v[20:23], v[244:247], v[116:119]
ds_read_b64_tr_b16 v[18:19], v4 offset:1024
v_mul_f32 v94, v94, v166
v_mfma_f32_16x16x32_bf16 v[120:123], v[20:23], v[248:251], v[120:123]
buffer_load_dwordx4 v1, s[12:15], s40 offen lds
v_mfma_f32_16x16x32_bf16 v[124:127], v[20:23], v[252:255], v[124:127]
v_mul_f32 v95, v95, v167
v_cvt_pk_bf16_f32 v174, v92, v93
s_waitcnt lgkmcnt(2)
v_mfma_f32_16x16x32_bf16 v[128:131], v[24:27], v[240:243], v[128:131]
ds_read_b64_tr_b16 v[20:21], v5 offset:0
v_cvt_pk_bf16_f32 v175, v94, v95
v_mfma_f32_16x16x32_bf16 v[132:135], v[24:27], v[244:247], v[132:135]
ds_read_b64_tr_b16 v[22:23], v5 offset:1024
v_mfma_f32_16x16x32_bf16 v[136:139], v[24:27], v[248:251], v[136:139]
buffer_store_dwordx4 v[172:175], v9, s[8:11], s42 offen offset:3072 sc1
v_mfma_f32_16x16x32_bf16 v[140:143], v[24:27], v[252:255], v[140:143]
v_mfma_f32_16x16x32_bf16 v[144:147], v[28:31], v[240:243], v[144:147]
ds_read_b64_tr_b16 v[24:25], v4 offset:2048
v_mfma_f32_16x16x32_bf16 v[148:151], v[28:31], v[244:247], v[148:151]
ds_read_b64_tr_b16 v[26:27], v4 offset:3072
v_mfma_f32_16x16x32_bf16 v[152:155], v[28:31], v[248:251], v[152:155]
s_add_u32 m0, s31, 45056
s_add_u32 s40, s32, 1474752
v_mfma_f32_16x16x32_bf16 v[156:159], v[28:31], v[252:255], v[156:159]
s_waitcnt lgkmcnt(2)
v_mfma_f32_16x16x32_bf16 v[32:35], v[16:19], a[0:3], 0
ds_read_b64_tr_b16 v[28:29], v5 offset:2048
v_mfma_f32_16x16x32_bf16 v[36:39], v[16:19], a[4:7], 0
ds_read_b64_tr_b16 v[30:31], v5 offset:3072
v_mfma_f32_16x16x32_bf16 v[40:43], v[16:19], a[8:11], 0
buffer_load_dwordx4 v1, s[12:15], s40 offen lds
v_mfma_f32_16x16x32_bf16 v[44:47], v[16:19], a[12:15], 0
v_mfma_f32_16x16x32_bf16 v[48:51], v[20:23], a[0:3], 0
ds_read_b64_tr_b16 v[16:17], v4 offset:4096
v_mfma_f32_16x16x32_bf16 v[52:55], v[20:23], a[4:7], 0
ds_read_b64_tr_b16 v[18:19], v4 offset:5120
v_mfma_f32_16x16x32_bf16 v[56:59], v[20:23], a[8:11], 0
v_mfma_f32_16x16x32_bf16 v[60:63], v[20:23], a[12:15], 0
s_waitcnt lgkmcnt(2)
v_mfma_f32_16x16x32_bf16 v[64:67], v[24:27], a[0:3], 0
ds_read_b64_tr_b16 v[20:21], v5 offset:4096
v_mul_f32 v160, v96, v96
v_mfma_f32_16x16x32_bf16 v[68:71], v[24:27], a[4:7], 0
ds_read_b64_tr_b16 v[22:23], v5 offset:5120
v_mul_f32 v161, v97, v97
v_mfma_f32_16x16x32_bf16 v[72:75], v[24:27], a[8:11], 0
s_add_u32 m0, s31, 49152
s_add_u32 s40, s32, 1769664
v_mul_f32 v162, v98, v98
v_mfma_f32_16x16x32_bf16 v[76:79], v[24:27], a[12:15], 0
v_mul_f32 v163, v99, v99
v_fma_f32 v160, v160, v12, s44
v_mfma_f32_16x16x32_bf16 v[80:83], v[28:31], a[0:3], 0
ds_read_b64_tr_b16 v[24:25], v4 offset:6144
v_fma_f32 v161, v161, v12, s44
v_mfma_f32_16x16x32_bf16 v[84:87], v[28:31], a[4:7], 0
ds_read_b64_tr_b16 v[26:27], v4 offset:7168
v_fma_f32 v162, v162, v12, s44
v_mfma_f32_16x16x32_bf16 v[88:91], v[28:31], a[8:11], 0
buffer_load_dwordx4 v1, s[12:15], s40 offen lds
v_mfma_f32_16x16x32_bf16 v[92:95], v[28:31], a[12:15], 0
v_fma_f32 v163, v163, v12, s44
v_mul_f32 v160, v96, v160
s_waitcnt lgkmcnt(2)
v_mfma_f32_16x16x32_bf16 v[32:35], v[16:19], a[16:19], v[32:35]
ds_read_b64_tr_b16 v[28:29], v5 offset:6144
v_mul_f32 v161, v97, v161
v_mfma_f32_16x16x32_bf16 v[36:39], v[16:19], a[20:23], v[36:39]
ds_read_b64_tr_b16 v[30:31], v5 offset:7168
v_mul_f32 v162, v98, v162
v_mfma_f32_16x16x32_bf16 v[40:43], v[16:19], a[24:27], v[40:43]
v_exp_f32 v160, v160
v_mfma_f32_16x16x32_bf16 v[44:47], v[16:19], a[28:31], v[44:47]
v_exp_f32 v161, v161
v_mfma_f32_16x16x32_bf16 v[48:51], v[20:23], a[16:19], v[48:51]
ds_read_b64_tr_b16 v[16:17], v4 offset:8192
v_mul_f32 v163, v99, v163
v_mfma_f32_16x16x32_bf16 v[52:55], v[20:23], a[20:23], v[52:55]
ds_read_b64_tr_b16 v[18:19], v4 offset:9216
v_mul_f32 v128, v96, v128
v_mfma_f32_16x16x32_bf16 v[56:59], v[20:23], a[24:27], v[56:59]
s_add_u32 m0, s31, 53248
s_add_u32 s40, s32, 2064576
v_exp_f32 v162, v162
v_mfma_f32_16x16x32_bf16 v[60:63], v[20:23], a[28:31], v[60:63]
v_exp_f32 v163, v163
s_waitcnt lgkmcnt(2)
v_mfma_f32_16x16x32_bf16 v[64:67], v[24:27], a[16:19], v[64:67]
ds_read_b64_tr_b16 v[20:21], v5 offset:8192
v_mul_f32 v129, v97, v129
v_mfma_f32_16x16x32_bf16 v[68:71], v[24:27], a[20:23], v[68:71]
ds_read_b64_tr_b16 v[22:23], v5 offset:9216
v_mul_f32 v130, v98, v130
v_mfma_f32_16x16x32_bf16 v[72:75], v[24:27], a[24:27], v[72:75]
buffer_load_dwordx4 v1, s[12:15], s40 offen lds
v_mfma_f32_16x16x32_bf16 v[76:79], v[24:27], a[28:31], v[76:79]
v_mul_f32 v131, v99, v131
v_add_f32 v160, 1.0, v160
v_mfma_f32_16x16x32_bf16 v[80:83], v[28:31], a[16:19], v[80:83]
ds_read_b64_tr_b16 v[24:25], v4 offset:10240
v_add_f32 v161, 1.0, v161
v_mfma_f32_16x16x32_bf16 v[84:87], v[28:31], a[20:23], v[84:87]
ds_read_b64_tr_b16 v[26:27], v4 offset:11264
v_add_f32 v162, 1.0, v162
v_mfma_f32_16x16x32_bf16 v[88:91], v[28:31], a[24:27], v[88:91]
v_rcp_f32 v160, v160
v_mfma_f32_16x16x32_bf16 v[92:95], v[28:31], a[28:31], v[92:95]
v_rcp_f32 v161, v161
s_waitcnt lgkmcnt(2)
v_mfma_f32_16x16x32_bf16 v[32:35], v[16:19], a[32:35], v[32:35]
ds_read_b64_tr_b16 v[28:29], v5 offset:10240
v_add_f32 v163, 1.0, v163
v_mfma_f32_16x16x32_bf16 v[36:39], v[16:19], a[36:39], v[36:39]
ds_read_b64_tr_b16 v[30:31], v5 offset:11264
v_mul_f32 v128, v128, v160
v_mfma_f32_16x16x32_bf16 v[40:43], v[16:19], a[40:43], v[40:43]
s_add_u32 m0, s31, 57344
s_add_u32 s40, s32, 2359488
v_rcp_f32 v162, v162
v_mfma_f32_16x16x32_bf16 v[44:47], v[16:19], a[44:47], v[44:47]
v_rcp_f32 v163, v163
s_add_u32 s42, s37, 4096
v_mfma_f32_16x16x32_bf16 v[48:51], v[20:23], a[32:35], v[48:51]
ds_read_b64_tr_b16 v[16:17], v4 offset:12288
v_mul_f32 v129, v129, v161
v_mfma_f32_16x16x32_bf16 v[52:55], v[20:23], a[36:39], v[52:55]
ds_read_b64_tr_b16 v[18:19], v4 offset:13312
v_mul_f32 v130, v130, v162
v_mfma_f32_16x16x32_bf16 v[56:59], v[20:23], a[40:43], v[56:59]
buffer_load_dwordx4 v1, s[12:15], s40 offen lds
v_mfma_f32_16x16x32_bf16 v[60:63], v[20:23], a[44:47], v[60:63]
v_mul_f32 v131, v131, v163
v_cvt_pk_bf16_f32 v168, v128, v129
s_waitcnt lgkmcnt(2)
v_mfma_f32_16x16x32_bf16 v[64:67], v[24:27], a[32:35], v[64:67]
ds_read_b64_tr_b16 v[20:21], v5 offset:12288
v_cvt_pk_bf16_f32 v169, v130, v131
v_mfma_f32_16x16x32_bf16 v[68:71], v[24:27], a[36:39], v[68:71]
ds_read_b64_tr_b16 v[22:23], v5 offset:13312
v_mul_f32 v164, v112, v112
v_mfma_f32_16x16x32_bf16 v[72:75], v[24:27], a[40:43], v[72:75]
v_mul_f32 v165, v113, v113
v_mul_f32 v166, v114, v114
v_mfma_f32_16x16x32_bf16 v[76:79], v[24:27], a[44:47], v[76:79]
v_mul_f32 v167, v115, v115
v_fma_f32 v164, v164, v12, s44
v_mfma_f32_16x16x32_bf16 v[80:83], v[28:31], a[32:35], v[80:83]
ds_read_b64_tr_b16 v[24:25], v4 offset:14336
v_fma_f32 v165, v165, v12, s44
v_mfma_f32_16x16x32_bf16 v[84:87], v[28:31], a[36:39], v[84:87]
ds_read_b64_tr_b16 v[26:27], v4 offset:15360
v_fma_f32 v166, v166, v12, s44
v_mfma_f32_16x16x32_bf16 v[88:91], v[28:31], a[40:43], v[88:91]
s_add_u32 m0, s31, 61440
s_add_u32 s40, s32, 2654400
v_fma_f32 v167, v167, v12, s44
v_mfma_f32_16x16x32_bf16 v[92:95], v[28:31], a[44:47], v[92:95]
v_mul_f32 v164, v112, v164
v_mul_f32 v165, v113, v165
s_waitcnt lgkmcnt(2)
v_mfma_f32_16x16x32_bf16 v[32:35], v[16:19], a[48:51], v[32:35]
ds_read_b64_tr_b16 v[28:29], v5 offset:14336
v_mul_f32 v166, v114, v166
v_mfma_f32_16x16x32_bf16 v[36:39], v[16:19], a[52:55], v[36:39]
ds_read_b64_tr_b16 v[30:31], v5 offset:15360
v_mul_f32 v167, v115, v167
v_mfma_f32_16x16x32_bf16 v[40:43], v[16:19], a[56:59], v[40:43]
buffer_load_dwordx4 v1, s[12:15], s40 offen lds
v_mfma_f32_16x16x32_bf16 v[44:47], v[16:19], a[60:63], v[44:47]
v_exp_f32 v164, v164
v_mfma_f32_16x16x32_bf16 v[48:51], v[20:23], a[48:51], v[48:51]
ds_read_b64_tr_b16 v[16:17], v4 offset:16384
v_mul_f32 v144, v112, v144
v_mfma_f32_16x16x32_bf16 v[52:55], v[20:23], a[52:55], v[52:55]
ds_read_b64_tr_b16 v[18:19], v4 offset:17408
v_mul_f32 v145, v113, v145
v_mfma_f32_16x16x32_bf16 v[56:59], v[20:23], a[56:59], v[56:59]
v_exp_f32 v165, v165
v_mfma_f32_16x16x32_bf16 v[60:63], v[20:23], a[60:63], v[60:63]
v_exp_f32 v166, v166
s_waitcnt lgkmcnt(2)
v_mfma_f32_16x16x32_bf16 v[64:67], v[24:27], a[48:51], v[64:67]
ds_read_b64_tr_b16 v[20:21], v5 offset:16384
v_mul_f32 v146, v114, v146
v_mfma_f32_16x16x32_bf16 v[68:71], v[24:27], a[52:55], v[68:71]
ds_read_b64_tr_b16 v[22:23], v5 offset:17408
v_mul_f32 v147, v115, v147
v_mfma_f32_16x16x32_bf16 v[72:75], v[24:27], a[56:59], v[72:75]
s_add_u32 m0, s31, 65536
s_add_u32 s40, s32, 2949312
v_exp_f32 v167, v167
v_mfma_f32_16x16x32_bf16 v[76:79], v[24:27], a[60:63], v[76:79]
v_add_f32 v164, 1.0, v164
v_add_f32 v165, 1.0, v165
v_mfma_f32_16x16x32_bf16 v[80:83], v[28:31], a[48:51], v[80:83]
ds_read_b64_tr_b16 v[24:25], v4 offset:18432
v_add_f32 v166, 1.0, v166
v_mfma_f32_16x16x32_bf16 v[84:87], v[28:31], a[52:55], v[84:87]
ds_read_b64_tr_b16 v[26:27], v4 offset:19456
v_add_f32 v167, 1.0, v167
v_mfma_f32_16x16x32_bf16 v[88:91], v[28:31], a[56:59], v[88:91]
buffer_load_dwordx4 v1, s[12:15], s40 offen lds
v_mfma_f32_16x16x32_bf16 v[92:95], v[28:31], a[60:63], v[92:95]
v_rcp_f32 v164, v164
s_waitcnt lgkmcnt(2)
v_mfma_f32_16x16x32_bf16 v[32:35], v[16:19], a[64:67], v[32:35]
ds_read_b64_tr_b16 v[28:29], v5 offset:18432
v_mul_f32 v144, v144, v164
v_mfma_f32_16x16x32_bf16 v[36:39], v[16:19], a[68:71], v[36:39]
ds_read_b64_tr_b16 v[30:31], v5 offset:19456
v_mul_f32 v160, v100, v100
v_mfma_f32_16x16x32_bf16 v[40:43], v[16:19], a[72:75], v[40:43]
v_rcp_f32 v165, v165
v_mfma_f32_16x16x32_bf16 v[44:47], v[16:19], a[76:79], v[44:47]
v_rcp_f32 v166, v166
v_mfma_f32_16x16x32_bf16 v[48:51], v[20:23], a[64:67], v[48:51]
ds_read_b64_tr_b16 v[16:17], v4 offset:20480
v_mul_f32 v145, v145, v165
v_mfma_f32_16x16x32_bf16 v[52:55], v[20:23], a[68:71], v[52:55]
ds_read_b64_tr_b16 v[18:19], v4 offset:21504
v_mul_f32 v146, v146, v166
v_mfma_f32_16x16x32_bf16 v[56:59], v[20:23], a[72:75], v[56:59]
s_add_u32 m0, s31, 69632
s_add_u32 s40, s32, 3244224
v_rcp_f32 v167, v167
v_mfma_f32_16x16x32_bf16 v[60:63], v[20:23], a[76:79], v[60:63]
v_mul_f32 v147, v147, v167
v_cvt_pk_bf16_f32 v170, v144, v145
s_waitcnt lgkmcnt(2)
v_mfma_f32_16x16x32_bf16 v[64:67], v[24:27], a[64:67], v[64:67]
ds_read_b64_tr_b16 v[20:21], v5 offset:20480
v_cvt_pk_bf16_f32 v171, v146, v147
v_mfma_f32_16x16x32_bf16 v[68:71], v[24:27], a[68:71], v[68:71]
ds_read_b64_tr_b16 v[22:23], v5 offset:21504
v_mul_f32 v161, v101, v101
v_mfma_f32_16x16x32_bf16 v[72:75], v[24:27], a[72:75], v[72:75]
buffer_load_dwordx4 v1, s[12:15], s40 offen lds
v_mfma_f32_16x16x32_bf16 v[76:79], v[24:27], a[76:79], v[76:79]
buffer_store_dwordx4 v[168:171], v9, s[8:11], s42 offen offset:0 sc1
v_mfma_f32_16x16x32_bf16 v[80:83], v[28:31], a[64:67], v[80:83]
ds_read_b64_tr_b16 v[24:25], v4 offset:22528
v_mul_f32 v162, v102, v102
v_mfma_f32_16x16x32_bf16 v[84:87], v[28:31], a[68:71], v[84:87]
ds_read_b64_tr_b16 v[26:27], v4 offset:23552
v_mul_f32 v163, v103, v103
v_mfma_f32_16x16x32_bf16 v[88:91], v[28:31], a[72:75], v[88:91]
v_fma_f32 v160, v160, v12, s44
v_fma_f32 v161, v161, v12, s44
v_mfma_f32_16x16x32_bf16 v[92:95], v[28:31], a[76:79], v[92:95]
v_fma_f32 v162, v162, v12, s44
v_fma_f32 v163, v163, v12, s44
s_waitcnt lgkmcnt(2)
v_mfma_f32_16x16x32_bf16 v[32:35], v[16:19], a[80:83], v[32:35]
ds_read_b64_tr_b16 v[28:29], v5 offset:22528
v_mul_f32 v160, v100, v160
v_mfma_f32_16x16x32_bf16 v[36:39], v[16:19], a[84:87], v[36:39]
ds_read_b64_tr_b16 v[30:31], v5 offset:23552
v_mul_f32 v161, v101, v161
v_mfma_f32_16x16x32_bf16 v[40:43], v[16:19], a[88:91], v[40:43]
v_exp_f32 v160, v160
v_mfma_f32_16x16x32_bf16 v[44:47], v[16:19], a[92:95], v[44:47]
v_add_u32 v4, 0x6000, v4
v_add_u32 v5, 0x6000, v5
v_mfma_f32_16x16x32_bf16 v[48:51], v[20:23], a[80:83], v[48:51]
s_waitcnt vmcnt(21)
s_barrier
ds_read_b64_tr_b16 v[16:17], v4 offset:0
v_mfma_f32_16x16x32_bf16 v[52:55], v[20:23], a[84:87], v[52:55]
ds_read_b64_tr_b16 v[18:19], v4 offset:1024
s_add_u32 m0, s31, 73728
v_mul_f32 v162, v102, v162
v_mfma_f32_16x16x32_bf16 v[56:59], v[20:23], a[88:91], v[56:59]
s_add_u32 s40, s32, 3539136
buffer_load_dwordx4 v1, s[12:15], s40 offen lds
v_mfma_f32_16x16x32_bf16 v[60:63], v[20:23], a[92:95], v[60:63]
v_exp_f32 v161, v161
s_waitcnt lgkmcnt(2)
v_mfma_f32_16x16x32_bf16 v[64:67], v[24:27], a[80:83], v[64:67]
ds_read_b64_tr_b16 v[20:21], v5 offset:0
v_mul_f32 v163, v103, v163
v_mfma_f32_16x16x32_bf16 v[68:71], v[24:27], a[84:87], v[68:71]
ds_read_b64_tr_b16 v[22:23], v5 offset:1024
v_mul_f32 v132, v100, v132
v_mfma_f32_16x16x32_bf16 v[72:75], v[24:27], a[88:91], v[72:75]
v_exp_f32 v162, v162
v_mfma_f32_16x16x32_bf16 v[76:79], v[24:27], a[92:95], v[76:79]
v_exp_f32 v163, v163
v_mfma_f32_16x16x32_bf16 v[80:83], v[28:31], a[80:83], v[80:83]
ds_read_b64_tr_b16 v[24:25], v4 offset:2048
v_mul_f32 v133, v101, v133
v_mfma_f32_16x16x32_bf16 v[84:87], v[28:31], a[84:87], v[84:87]
ds_read_b64_tr_b16 v[26:27], v4 offset:3072
v_mul_f32 v134, v102, v134
v_mfma_f32_16x16x32_bf16 v[88:91], v[28:31], a[88:91], v[88:91]
s_add_u32 m0, s31, 77824
s_add_u32 s40, s32, 3834048
v_mul_f32 v135, v103, v135
v_mfma_f32_16x16x32_bf16 v[92:95], v[28:31], a[92:95], v[92:95]
v_add_f32 v160, 1.0, v160
v_add_f32 v161, 1.0, v161
s_waitcnt lgkmcnt(2)
v_mfma_f32_16x16x32_bf16 v[32:35], v[16:19], a[96:99], v[32:35]
ds_read_b64_tr_b16 v[28:29], v5 offset:2048
v_add_f32 v162, 1.0, v162
v_mfma_f32_16x16x32_bf16 v[36:39], v[16:19], a[100:103], v[36:39]
ds_read_b64_tr_b16 v[30:31], v5 offset:3072
v_add_f32 v163, 1.0, v163
v_mfma_f32_16x16x32_bf16 v[40:43], v[16:19], a[104:107], v[40:43]
buffer_load_dwordx4 v1, s[12:15], s40 offen lds
v_mfma_f32_16x16x32_bf16 v[44:47], v[16:19], a[108:111], v[44:47]
v_rcp_f32 v160, v160
v_mfma_f32_16x16x32_bf16 v[48:51], v[20:23], a[96:99], v[48:51]
ds_read_b64_tr_b16 v[16:17], v4 offset:4096
v_mul_f32 v132, v132, v160
v_mfma_f32_16x16x32_bf16 v[52:55], v[20:23], a[100:103], v[52:55]
ds_read_b64_tr_b16 v[18:19], v4 offset:5120
v_mul_f32 v164, v116, v116
v_mfma_f32_16x16x32_bf16 v[56:59], v[20:23], a[104:107], v[56:59]
v_rcp_f32 v161, v161
v_mfma_f32_16x16x32_bf16 v[60:63], v[20:23], a[108:111], v[60:63]
v_rcp_f32 v162, v162
s_waitcnt lgkmcnt(2)
v_mfma_f32_16x16x32_bf16 v[64:67], v[24:27], a[96:99], v[64:67]
ds_read_b64_tr_b16 v[20:21], v5 offset:4096
v_mul_f32 v133, v133, v161
v_mfma_f32_16x16x32_bf16 v[68:71], v[24:27], a[100:103], v[68:71]
ds_read_b64_tr_b16 v[22:23], v5 offset:5120
v_mul_f32 v134, v134, v162
v_mfma_f32_16x16x32_bf16 v[72:75], v[24:27], a[104:107], v[72:75]
s_add_u32 m0, s31, 81920
s_add_u32 s40, s32, 4128960
v_rcp_f32 v163, v163
v_mfma_f32_16x16x32_bf16 v[76:79], v[24:27], a[108:111], v[76:79]
v_mul_f32 v135, v135, v163
v_cvt_pk_bf16_f32 v172, v132, v133
v_mfma_f32_16x16x32_bf16 v[80:83], v[28:31], a[96:99], v[80:83]
ds_read_b64_tr_b16 v[24:25], v4 offset:6144
v_cvt_pk_bf16_f32 v173, v134, v135
v_mfma_f32_16x16x32_bf16 v[84:87], v[28:31], a[100:103], v[84:87]
ds_read_b64_tr_b16 v[26:27], v4 offset:7168
v_mul_f32 v165, v117, v117
v_mfma_f32_16x16x32_bf16 v[88:91], v[28:31], a[104:107], v[88:91]
buffer_load_dwordx4 v1, s[12:15], s40 offen lds
v_mfma_f32_16x16x32_bf16 v[92:95], v[28:31], a[108:111], v[92:95]
v_mul_f32 v166, v118, v118
v_mul_f32 v167, v119, v119
s_waitcnt lgkmcnt(2)
v_mfma_f32_16x16x32_bf16 v[32:35], v[16:19], a[112:115], v[32:35]
ds_read_b64_tr_b16 v[28:29], v5 offset:6144
v_fma_f32 v164, v164, v12, s44
v_mfma_f32_16x16x32_bf16 v[36:39], v[16:19], a[116:119], v[36:39]
ds_read_b64_tr_b16 v[30:31], v5 offset:7168
v_fma_f32 v165, v165, v12, s44
v_mfma_f32_16x16x32_bf16 v[40:43], v[16:19], a[120:123], v[40:43]
v_fma_f32 v166, v166, v12, s44
v_fma_f32 v167, v167, v12, s44
v_mfma_f32_16x16x32_bf16 v[44:47], v[16:19], a[124:127], v[44:47]
v_mul_f32 v164, v116, v164
v_mul_f32 v165, v117, v165
v_mfma_f32_16x16x32_bf16 v[48:51], v[20:23], a[112:115], v[48:51]
ds_read_b64_tr_b16 v[16:17], v4 offset:8192
v_mul_f32 v166, v118, v166
v_mfma_f32_16x16x32_bf16 v[52:55], v[20:23], a[116:119], v[52:55]
ds_read_b64_tr_b16 v[18:19], v4 offset:9216
v_mul_f32 v167, v119, v167
v_mfma_f32_16x16x32_bf16 v[56:59], v[20:23], a[120:123], v[56:59]
s_add_u32 m0, s31, 86016
s_add_u32 s40, s32, 4423872
v_exp_f32 v164, v164
v_mfma_f32_16x16x32_bf16 v[60:63], v[20:23], a[124:127], v[60:63]
v_exp_f32 v165, v165
s_waitcnt lgkmcnt(2)
v_mfma_f32_16x16x32_bf16 v[64:67], v[24:27], a[112:115], v[64:67]
ds_read_b64_tr_b16 v[20:21], v5 offset:8192
v_mul_f32 v148, v116, v148
v_mfma_f32_16x16x32_bf16 v[68:71], v[24:27], a[116:119], v[68:71]
ds_read_b64_tr_b16 v[22:23], v5 offset:9216
v_mul_f32 v149, v117, v149
v_mfma_f32_16x16x32_bf16 v[72:75], v[24:27], a[120:123], v[72:75]
buffer_load_dwordx4 v1, s[12:15], s40 offen lds
v_mfma_f32_16x16x32_bf16 v[76:79], v[24:27], a[124:127], v[76:79]
v_exp_f32 v166, v166
v_mfma_f32_16x16x32_bf16 v[80:83], v[28:31], a[112:115], v[80:83]
ds_read_b64_tr_b16 v[24:25], v4 offset:10240
v_mul_f32 v150, v118, v150
v_mfma_f32_16x16x32_bf16 v[84:87], v[28:31], a[116:119], v[84:87]
ds_read_b64_tr_b16 v[26:27], v4 offset:11264
v_mul_f32 v151, v119, v151
v_mfma_f32_16x16x32_bf16 v[88:91], v[28:31], a[120:123], v[88:91]
v_exp_f32 v167, v167
v_mfma_f32_16x16x32_bf16 v[92:95], v[28:31], a[124:127], v[92:95]
v_add_f32 v164, 1.0, v164
v_add_f32 v165, 1.0, v165
s_waitcnt lgkmcnt(2)
v_mfma_f32_16x16x32_bf16 v[32:35], v[16:19], a[128:131], v[32:35]
ds_read_b64_tr_b16 v[28:29], v5 offset:10240
v_add_f32 v166, 1.0, v166
v_mfma_f32_16x16x32_bf16 v[36:39], v[16:19], a[132:135], v[36:39]
ds_read_b64_tr_b16 v[30:31], v5 offset:11264
v_add_f32 v167, 1.0, v167
v_mfma_f32_16x16x32_bf16 v[40:43], v[16:19], a[136:139], v[40:43]
s_add_u32 m0, s31, 90112
s_add_u32 s40, s32, 4718784
v_rcp_f32 v164, v164
v_mfma_f32_16x16x32_bf16 v[44:47], v[16:19], a[140:143], v[44:47]
v_rcp_f32 v165, v165
v_mfma_f32_16x16x32_bf16 v[48:51], v[20:23], a[128:131], v[48:51]
ds_read_b64_tr_b16 v[16:17], v4 offset:12288
v_mul_f32 v148, v148, v164
v_mfma_f32_16x16x32_bf16 v[52:55], v[20:23], a[132:135], v[52:55]
ds_read_b64_tr_b16 v[18:19], v4 offset:13312
v_mul_f32 v149, v149, v165
v_mfma_f32_16x16x32_bf16 v[56:59], v[20:23], a[136:139], v[56:59]
buffer_load_dwordx4 v1, s[12:15], s40 offen lds
v_mfma_f32_16x16x32_bf16 v[60:63], v[20:23], a[140:143], v[60:63]
v_rcp_f32 v166, v166
s_waitcnt lgkmcnt(2)
v_mfma_f32_16x16x32_bf16 v[64:67], v[24:27], a[128:131], v[64:67]
ds_read_b64_tr_b16 v[20:21], v5 offset:12288
v_mul_f32 v150, v150, v166
v_mfma_f32_16x16x32_bf16 v[68:71], v[24:27], a[132:135], v[68:71]
ds_read_b64_tr_b16 v[22:23], v5 offset:13312
v_cvt_pk_bf16_f32 v174, v148, v149
v_mfma_f32_16x16x32_bf16 v[72:75], v[24:27], a[136:139], v[72:75]
v_rcp_f32 v167, v167
v_mfma_f32_16x16x32_bf16 v[76:79], v[24:27], a[140:143], v[76:79]
v_mul_f32 v151, v151, v167
v_cvt_pk_bf16_f32 v175, v150, v151
v_mfma_f32_16x16x32_bf16 v[80:83], v[28:31], a[128:131], v[80:83]
ds_read_b64_tr_b16 v[24:25], v4 offset:14336
v_mul_f32 v160, v104, v104
v_mfma_f32_16x16x32_bf16 v[84:87], v[28:31], a[132:135], v[84:87]
ds_read_b64_tr_b16 v[26:27], v4 offset:15360
v_mul_f32 v161, v105, v105
v_mfma_f32_16x16x32_bf16 v[88:91], v[28:31], a[136:139], v[88:91]
s_add_u32 m0, s31, 94208
s_add_u32 s40, s32, 5013696
buffer_store_dwordx4 v[172:175], v9, s[8:11], s42 offen offset:1024 sc1
v_mfma_f32_16x16x32_bf16 v[92:95], v[28:31], a[140:143], v[92:95]
v_mul_f32 v162, v106, v106
v_mul_f32 v163, v107, v107
s_waitcnt lgkmcnt(2)
v_mfma_f32_16x16x32_bf16 v[32:35], v[16:19], a[144:147], v[32:35]
ds_read_b64_tr_b16 v[28:29], v5 offset:14336
v_fma_f32 v160, v160, v12, s44
v_mfma_f32_16x16x32_bf16 v[36:39], v[16:19], a[148:151], v[36:39]
ds_read_b64_tr_b16 v[30:31], v5 offset:15360
v_fma_f32 v161, v161, v12, s44
v_mfma_f32_16x16x32_bf16 v[40:43], v[16:19], a[152:155], v[40:43]
buffer_load_dwordx4 v1, s[12:15], s40 offen lds
v_mfma_f32_16x16x32_bf16 v[44:47], v[16:19], a[156:159], v[44:47]
v_fma_f32 v162, v162, v12, s44
v_fma_f32 v163, v163, v12, s44
v_mfma_f32_16x16x32_bf16 v[48:51], v[20:23], a[144:147], v[48:51]
ds_read_b64_tr_b16 v[16:17], v4 offset:16384
v_mul_f32 v160, v104, v160
v_mfma_f32_16x16x32_bf16 v[52:55], v[20:23], a[148:151], v[52:55]
ds_read_b64_tr_b16 v[18:19], v4 offset:17408
v_mul_f32 v161, v105, v161
v_mfma_f32_16x16x32_bf16 v[56:59], v[20:23], a[152:155], v[56:59]
v_exp_f32 v160, v160
v_mfma_f32_16x16x32_bf16 v[60:63], v[20:23], a[156:159], v[60:63]
v_exp_f32 v161, v161
s_waitcnt lgkmcnt(2)
v_mfma_f32_16x16x32_bf16 v[64:67], v[24:27], a[144:147], v[64:67]
ds_read_b64_tr_b16 v[20:21], v5 offset:16384
v_mul_f32 v162, v106, v162
v_mfma_f32_16x16x32_bf16 v[68:71], v[24:27], a[148:151], v[68:71]
ds_read_b64_tr_b16 v[22:23], v5 offset:17408
v_mul_f32 v163, v107, v163
v_mfma_f32_16x16x32_bf16 v[72:75], v[24:27], a[152:155], v[72:75]
v_exp_f32 v162, v162
v_mfma_f32_16x16x32_bf16 v[76:79], v[24:27], a[156:159], v[76:79]
v_exp_f32 v163, v163
v_mfma_f32_16x16x32_bf16 v[80:83], v[28:31], a[144:147], v[80:83]
ds_read_b64_tr_b16 v[24:25], v4 offset:18432
v_mul_f32 v136, v104, v136
v_mfma_f32_16x16x32_bf16 v[84:87], v[28:31], a[148:151], v[84:87]
ds_read_b64_tr_b16 v[26:27], v4 offset:19456
v_mul_f32 v137, v105, v137
v_mfma_f32_16x16x32_bf16 v[88:91], v[28:31], a[152:155], v[88:91]
v_mul_f32 v138, v106, v138
v_mul_f32 v139, v107, v139
v_mfma_f32_16x16x32_bf16 v[92:95], v[28:31], a[156:159], v[92:95]
v_add_f32 v160, 1.0, v160
v_add_f32 v161, 1.0, v161
s_waitcnt lgkmcnt(2)
v_mfma_f32_16x16x32_bf16 v[32:35], v[16:19], a[160:163], v[32:35]
ds_read_b64_tr_b16 v[28:29], v5 offset:18432
v_add_f32 v162, 1.0, v162
v_mfma_f32_16x16x32_bf16 v[36:39], v[16:19], a[164:167], v[36:39]
ds_read_b64_tr_b16 v[30:31], v5 offset:19456
v_add_f32 v163, 1.0, v163
v_mfma_f32_16x16x32_bf16 v[40:43], v[16:19], a[168:171], v[40:43]
v_rcp_f32 v160, v160
v_mfma_f32_16x16x32_bf16 v[44:47], v[16:19], a[172:175], v[44:47]
v_rcp_f32 v161, v161
v_mfma_f32_16x16x32_bf16 v[48:51], v[20:23], a[160:163], v[48:51]
ds_read_b64_tr_b16 v[16:17], v4 offset:20480
v_mul_f32 v136, v136, v160
v_mfma_f32_16x16x32_bf16 v[52:55], v[20:23], a[164:167], v[52:55]
ds_read_b64_tr_b16 v[18:19], v4 offset:21504
v_mul_f32 v137, v137, v161
v_mfma_f32_16x16x32_bf16 v[56:59], v[20:23], a[168:171], v[56:59]
v_rcp_f32 v162, v162
v_mfma_f32_16x16x32_bf16 v[60:63], v[20:23], a[172:175], v[60:63]
v_rcp_f32 v163, v163
s_waitcnt lgkmcnt(2)
v_mfma_f32_16x16x32_bf16 v[64:67], v[24:27], a[160:163], v[64:67]
ds_read_b64_tr_b16 v[20:21], v5 offset:20480
v_mul_f32 v138, v138, v162
v_mfma_f32_16x16x32_bf16 v[68:71], v[24:27], a[164:167], v[68:71]
ds_read_b64_tr_b16 v[22:23], v5 offset:21504
v_mul_f32 v139, v139, v163
v_mfma_f32_16x16x32_bf16 v[72:75], v[24:27], a[168:171], v[72:75]
v_cvt_pk_bf16_f32 v168, v136, v137
v_cvt_pk_bf16_f32 v169, v138, v139
v_mfma_f32_16x16x32_bf16 v[76:79], v[24:27], a[172:175], v[76:79]
v_mul_f32 v164, v120, v120
v_mul_f32 v165, v121, v121
v_mfma_f32_16x16x32_bf16 v[80:83], v[28:31], a[160:163], v[80:83]
ds_read_b64_tr_b16 v[24:25], v4 offset:22528
v_mul_f32 v166, v122, v122
v_mfma_f32_16x16x32_bf16 v[84:87], v[28:31], a[164:167], v[84:87]
ds_read_b64_tr_b16 v[26:27], v4 offset:23552
v_mul_f32 v167, v123, v123
v_mfma_f32_16x16x32_bf16 v[88:91], v[28:31], a[168:171], v[88:91]
v_fma_f32 v164, v164, v12, s44
v_fma_f32 v165, v165, v12, s44
v_mfma_f32_16x16x32_bf16 v[92:95], v[28:31], a[172:175], v[92:95]
v_fma_f32 v166, v166, v12, s44
v_fma_f32 v167, v167, v12, s44
s_waitcnt lgkmcnt(2)
v_mfma_f32_16x16x32_bf16 v[32:35], v[16:19], a[176:179], v[32:35]
ds_read_b64_tr_b16 v[28:29], v5 offset:22528
v_mul_f32 v164, v120, v164
v_mfma_f32_16x16x32_bf16 v[36:39], v[16:19], a[180:183], v[36:39]
ds_read_b64_tr_b16 v[30:31], v5 offset:23552
v_mul_f32 v165, v121, v165
v_mfma_f32_16x16x32_bf16 v[40:43], v[16:19], a[184:187], v[40:43]
v_exp_f32 v164, v164
v_mfma_f32_16x16x32_bf16 v[44:47], v[16:19], a[188:191], v[44:47]
v_add_u32 v4, 0xfffe2000, v4
v_add_u32 v5, 0xfffe2000, v5
v_mfma_f32_16x16x32_bf16 v[48:51], v[20:23], a[176:179], v[48:51]
s_waitcnt vmcnt(22)
s_barrier
ds_read_b64_tr_b16 v[16:17], v4 offset:0
v_mfma_f32_16x16x32_bf16 v[52:55], v[20:23], a[180:183], v[52:55]
ds_read_b64_tr_b16 v[18:19], v4 offset:1024
s_add_u32 m0, s31, 98304
v_mul_f32 v166, v122, v166
v_mfma_f32_16x16x32_bf16 v[56:59], v[20:23], a[184:187], v[56:59]
s_add_u32 s40, s34, 0
buffer_load_dwordx4 v3, s[16:19], s40 offen lds
v_mfma_f32_16x16x32_bf16 v[60:63], v[20:23], a[188:191], v[60:63]
v_exp_f32 v165, v165
s_waitcnt lgkmcnt(2)
v_mfma_f32_16x16x32_bf16 v[64:67], v[24:27], a[176:179], v[64:67]
ds_read_b64_tr_b16 v[20:21], v5 offset:0
v_mul_f32 v167, v123, v167
v_mfma_f32_16x16x32_bf16 v[68:71], v[24:27], a[180:183], v[68:71]
ds_read_b64_tr_b16 v[22:23], v5 offset:1024
v_mul_f32 v152, v120, v152
v_mfma_f32_16x16x32_bf16 v[72:75], v[24:27], a[184:187], v[72:75]
v_exp_f32 v166, v166
v_mfma_f32_16x16x32_bf16 v[76:79], v[24:27], a[188:191], v[76:79]
v_exp_f32 v167, v167
v_mfma_f32_16x16x32_bf16 v[80:83], v[28:31], a[176:179], v[80:83]
ds_read_b64_tr_b16 v[24:25], v4 offset:2048
v_mul_f32 v153, v121, v153
v_mfma_f32_16x16x32_bf16 v[84:87], v[28:31], a[180:183], v[84:87]
ds_read_b64_tr_b16 v[26:27], v4 offset:3072
v_mul_f32 v154, v122, v154
v_mfma_f32_16x16x32_bf16 v[88:91], v[28:31], a[184:187], v[88:91]
s_add_u32 m0, s31, 102400
s_add_u32 s40, s34, 262144
v_mul_f32 v155, v123, v155
v_mfma_f32_16x16x32_bf16 v[92:95], v[28:31], a[188:191], v[92:95]
v_add_f32 v164, 1.0, v164
v_add_f32 v165, 1.0, v165
s_waitcnt lgkmcnt(2)
v_mfma_f32_16x16x32_bf16 v[32:35], v[16:19], a[192:195], v[32:35]
ds_read_b64_tr_b16 v[28:29], v5 offset:2048
v_add_f32 v166, 1.0, v166
v_mfma_f32_16x16x32_bf16 v[36:39], v[16:19], a[196:199], v[36:39]
ds_read_b64_tr_b16 v[30:31], v5 offset:3072
v_add_f32 v167, 1.0, v167
v_mfma_f32_16x16x32_bf16 v[40:43], v[16:19], a[200:203], v[40:43]
buffer_load_dwordx4 v3, s[16:19], s40 offen lds
v_mfma_f32_16x16x32_bf16 v[44:47], v[16:19], a[204:207], v[44:47]
v_rcp_f32 v164, v164
v_mfma_f32_16x16x32_bf16 v[48:51], v[20:23], a[192:195], v[48:51]
ds_read_b64_tr_b16 v[16:17], v4 offset:4096
v_mul_f32 v152, v152, v164
v_mfma_f32_16x16x32_bf16 v[52:55], v[20:23], a[196:199], v[52:55]
ds_read_b64_tr_b16 v[18:19], v4 offset:5120
v_mul_f32 v160, v108, v108
v_mfma_f32_16x16x32_bf16 v[56:59], v[20:23], a[200:203], v[56:59]
v_rcp_f32 v165, v165
v_mfma_f32_16x16x32_bf16 v[60:63], v[20:23], a[204:207], v[60:63]
v_rcp_f32 v166, v166
s_waitcnt lgkmcnt(2)
v_mfma_f32_16x16x32_bf16 v[64:67], v[24:27], a[192:195], v[64:67]
ds_read_b64_tr_b16 v[20:21], v5 offset:4096
v_mul_f32 v153, v153, v165
v_mfma_f32_16x16x32_bf16 v[68:71], v[24:27], a[196:199], v[68:71]
ds_read_b64_tr_b16 v[22:23], v5 offset:5120
v_mul_f32 v154, v154, v166
v_mfma_f32_16x16x32_bf16 v[72:75], v[24:27], a[200:203], v[72:75]
s_add_u32 m0, s31, 106496
s_add_u32 s40, s34, 524288
v_rcp_f32 v167, v167
v_mfma_f32_16x16x32_bf16 v[76:79], v[24:27], a[204:207], v[76:79]
v_mul_f32 v155, v155, v167
v_cvt_pk_bf16_f32 v170, v152, v153
v_mfma_f32_16x16x32_bf16 v[80:83], v[28:31], a[192:195], v[80:83]
ds_read_b64_tr_b16 v[24:25], v4 offset:6144
v_cvt_pk_bf16_f32 v171, v154, v155
v_mfma_f32_16x16x32_bf16 v[84:87], v[28:31], a[196:199], v[84:87]
ds_read_b64_tr_b16 v[26:27], v4 offset:7168
v_mul_f32 v161, v109, v109
v_mfma_f32_16x16x32_bf16 v[88:91], v[28:31], a[200:203], v[88:91]
buffer_load_dwordx4 v3, s[16:19], s40 offen lds
v_mfma_f32_16x16x32_bf16 v[92:95], v[28:31], a[204:207], v[92:95]
buffer_store_dwordx4 v[168:171], v9, s[8:11], s42 offen offset:2048 sc1
s_waitcnt lgkmcnt(2)
v_mfma_f32_16x16x32_bf16 v[32:35], v[16:19], a[208:211], v[32:35]
ds_read_b64_tr_b16 v[28:29], v5 offset:6144
v_mul_f32 v162, v110, v110
v_mfma_f32_16x16x32_bf16 v[36:39], v[16:19], a[212:215], v[36:39]
ds_read_b64_tr_b16 v[30:31], v5 offset:7168
v_mul_f32 v163, v111, v111
v_mfma_f32_16x16x32_bf16 v[40:43], v[16:19], a[216:219], v[40:43]
v_fma_f32 v160, v160, v12, s44
v_fma_f32 v161, v161, v12, s44
v_mfma_f32_16x16x32_bf16 v[44:47], v[16:19], a[220:223], v[44:47]
v_fma_f32 v162, v162, v12, s44
v_fma_f32 v163, v163, v12, s44
v_mfma_f32_16x16x32_bf16 v[48:51], v[20:23], a[208:211], v[48:51]
ds_read_b64_tr_b16 v[16:17], v4 offset:8192
v_mul_f32 v160, v108, v160
v_mfma_f32_16x16x32_bf16 v[52:55], v[20:23], a[212:215], v[52:55]
ds_read_b64_tr_b16 v[18:19], v4 offset:9216
v_mul_f32 v161, v109, v161
v_mfma_f32_16x16x32_bf16 v[56:59], v[20:23], a[216:219], v[56:59]
s_add_u32 m0, s31, 110592
s_add_u32 s40, s34, 786432
v_exp_f32 v160, v160
v_mfma_f32_16x16x32_bf16 v[60:63], v[20:23], a[220:223], v[60:63]
v_exp_f32 v161, v161
s_waitcnt lgkmcnt(2)
v_mfma_f32_16x16x32_bf16 v[64:67], v[24:27], a[208:211], v[64:67]
ds_read_b64_tr_b16 v[20:21], v5 offset:8192
v_mul_f32 v162, v110, v162
v_mfma_f32_16x16x32_bf16 v[68:71], v[24:27], a[212:215], v[68:71]
ds_read_b64_tr_b16 v[22:23], v5 offset:9216
v_mul_f32 v163, v111, v163
v_mfma_f32_16x16x32_bf16 v[72:75], v[24:27], a[216:219], v[72:75]
buffer_load_dwordx4 v3, s[16:19], s40 offen lds
v_mfma_f32_16x16x32_bf16 v[76:79], v[24:27], a[220:223], v[76:79]
v_exp_f32 v162, v162
v_mfma_f32_16x16x32_bf16 v[80:83], v[28:31], a[208:211], v[80:83]
ds_read_b64_tr_b16 v[24:25], v4 offset:10240
v_mul_f32 v140, v108, v140
v_mfma_f32_16x16x32_bf16 v[84:87], v[28:31], a[212:215], v[84:87]
ds_read_b64_tr_b16 v[26:27], v4 offset:11264
v_mul_f32 v141, v109, v141
v_mfma_f32_16x16x32_bf16 v[88:91], v[28:31], a[216:219], v[88:91]
v_exp_f32 v163, v163
v_mfma_f32_16x16x32_bf16 v[92:95], v[28:31], a[220:223], v[92:95]
v_mul_f32 v142, v110, v142
v_mul_f32 v143, v111, v143
s_waitcnt lgkmcnt(2)
v_mfma_f32_16x16x32_bf16 v[32:35], v[16:19], a[224:227], v[32:35]
ds_read_b64_tr_b16 v[28:29], v5 offset:10240
v_add_f32 v160, 1.0, v160
v_mfma_f32_16x16x32_bf16 v[36:39], v[16:19], a[228:231], v[36:39]
ds_read_b64_tr_b16 v[30:31], v5 offset:11264
v_add_f32 v161, 1.0, v161
v_mfma_f32_16x16x32_bf16 v[40:43], v[16:19], a[232:235], v[40:43]
s_add_u32 m0, s31, 114688
s_add_u32 s40, s34, 1048576
v_rcp_f32 v160, v160
v_mfma_f32_16x16x32_bf16 v[44:47], v[16:19], a[236:239], v[44:47]
v_rcp_f32 v161, v161
v_mfma_f32_16x16x32_bf16 v[48:51], v[20:23], a[224:227], v[48:51]
ds_read_b64_tr_b16 v[16:17], v4 offset:12288
v_add_f32 v162, 1.0, v162
v_mfma_f32_16x16x32_bf16 v[52:55], v[20:23], a[228:231], v[52:55]
ds_read_b64_tr_b16 v[18:19], v4 offset:13312
v_add_f32 v163, 1.0, v163
v_mfma_f32_16x16x32_bf16 v[56:59], v[20:23], a[232:235], v[56:59]
buffer_load_dwordx4 v3, s[16:19], s40 offen lds
v_mfma_f32_16x16x32_bf16 v[60:63], v[20:23], a[236:239], v[60:63]
v_rcp_f32 v162, v162
s_waitcnt lgkmcnt(2)
v_mfma_f32_16x16x32_bf16 v[64:67], v[24:27], a[224:227], v[64:67]
ds_read_b64_tr_b16 v[20:21], v5 offset:12288
v_mul_f32 v140, v140, v160
v_mfma_f32_16x16x32_bf16 v[68:71], v[24:27], a[228:231], v[68:71]
ds_read_b64_tr_b16 v[22:23], v5 offset:13312
v_mul_f32 v141, v141, v161
v_mfma_f32_16x16x32_bf16 v[72:75], v[24:27], a[232:235], v[72:75]
v_rcp_f32 v163, v163
v_mfma_f32_16x16x32_bf16 v[76:79], v[24:27], a[236:239], v[76:79]
v_mul_f32 v142, v142, v162
v_mul_f32 v143, v143, v163
v_mfma_f32_16x16x32_bf16 v[80:83], v[28:31], a[224:227], v[80:83]
ds_read_b64_tr_b16 v[24:25], v4 offset:14336
v_cvt_pk_bf16_f32 v172, v140, v141
v_mfma_f32_16x16x32_bf16 v[84:87], v[28:31], a[228:231], v[84:87]
ds_read_b64_tr_b16 v[26:27], v4 offset:15360
v_cvt_pk_bf16_f32 v173, v142, v143
v_mfma_f32_16x16x32_bf16 v[88:91], v[28:31], a[232:235], v[88:91]
s_add_u32 m0, s31, 118784
s_add_u32 s40, s34, 1310720
v_mul_f32 v164, v124, v124
v_mfma_f32_16x16x32_bf16 v[92:95], v[28:31], a[236:239], v[92:95]
v_mul_f32 v165, v125, v125
v_mul_f32 v166, v126, v126
s_waitcnt lgkmcnt(2)
v_mfma_f32_16x16x32_bf16 v[32:35], v[16:19], a[240:243], v[32:35]
ds_read_b64_tr_b16 v[28:29], v5 offset:14336
v_mul_f32 v167, v127, v127
v_mfma_f32_16x16x32_bf16 v[36:39], v[16:19], a[244:247], v[36:39]
ds_read_b64_tr_b16 v[30:31], v5 offset:15360
v_fma_f32 v164, v164, v12, s44
v_mfma_f32_16x16x32_bf16 v[40:43], v[16:19], a[248:251], v[40:43]
buffer_load_dwordx4 v3, s[16:19], s40 offen lds
v_mfma_f32_16x16x32_bf16 v[44:47], v[16:19], a[252:255], v[44:47]
v_fma_f32 v165, v165, v12, s44
v_fma_f32 v166, v166, v12, s44
v_mfma_f32_16x16x32_bf16 v[48:51], v[20:23], a[240:243], v[48:51]
ds_read_b64_tr_b16 v[16:17], v4 offset:16384
v_fma_f32 v167, v167, v12, s44
v_mfma_f32_16x16x32_bf16 v[52:55], v[20:23], a[244:247], v[52:55]
ds_read_b64_tr_b16 v[18:19], v4 offset:17408
v_mul_f32 v164, v124, v164
v_mfma_f32_16x16x32_bf16 v[56:59], v[20:23], a[248:251], v[56:59]
v_exp_f32 v164, v164
v_mfma_f32_16x16x32_bf16 v[60:63], v[20:23], a[252:255], v[60:63]
v_mul_f32 v165, v125, v165
v_mul_f32 v166, v126, v166
s_waitcnt lgkmcnt(2)
v_mfma_f32_16x16x32_bf16 v[64:67], v[24:27], a[240:243], v[64:67]
ds_read_b64_tr_b16 v[20:21], v5 offset:16384
v_mul_f32 v167, v127, v167
v_mfma_f32_16x16x32_bf16 v[68:71], v[24:27], a[244:247], v[68:71]
ds_read_b64_tr_b16 v[22:23], v5 offset:17408
v_mul_f32 v156, v124, v156
v_mfma_f32_16x16x32_bf16 v[72:75], v[24:27], a[248:251], v[72:75]
v_exp_f32 v165, v165
v_mfma_f32_16x16x32_bf16 v[76:79], v[24:27], a[252:255], v[76:79]
v_exp_f32 v166, v166
v_mfma_f32_16x16x32_bf16 v[80:83], v[28:31], a[240:243], v[80:83]
ds_read_b64_tr_b16 v[24:25], v4 offset:18432
v_mul_f32 v157, v125, v157
v_mfma_f32_16x16x32_bf16 v[84:87], v[28:31], a[244:247], v[84:87]
ds_read_b64_tr_b16 v[26:27], v4 offset:19456
v_mul_f32 v158, v126, v158
v_mfma_f32_16x16x32_bf16 v[88:91], v[28:31], a[248:251], v[88:91]
v_exp_f32 v167, v167
v_mfma_f32_16x16x32_bf16 v[92:95], v[28:31], a[252:255], v[92:95]
v_mul_f32 v159, v127, v159
v_add_f32 v164, 1.0, v164
s_waitcnt lgkmcnt(2)
v_mfma_f32_16x16x32_bf16 v[32:35], v[16:19], v[224:227], v[32:35]
ds_read_b64_tr_b16 v[28:29], v5 offset:18432
v_add_f32 v165, 1.0, v165
v_mfma_f32_16x16x32_bf16 v[36:39], v[16:19], v[228:231], v[36:39]
ds_read_b64_tr_b16 v[30:31], v5 offset:19456
v_add_f32 v166, 1.0, v166
v_mfma_f32_16x16x32_bf16 v[40:43], v[16:19], v[232:235], v[40:43]
v_rcp_f32 v164, v164
v_mfma_f32_16x16x32_bf16 v[44:47], v[16:19], v[236:239], v[44:47]
v_rcp_f32 v165, v165
v_mfma_f32_16x16x32_bf16 v[48:51], v[20:23], v[224:227], v[48:51]
ds_read_b64_tr_b16 v[16:17], v4 offset:20480
v_add_f32 v167, 1.0, v167
v_mfma_f32_16x16x32_bf16 v[52:55], v[20:23], v[228:231], v[52:55]
ds_read_b64_tr_b16 v[18:19], v4 offset:21504
v_mul_f32 v156, v156, v164
v_mfma_f32_16x16x32_bf16 v[56:59], v[20:23], v[232:235], v[56:59]
v_rcp_f32 v166, v166
v_mfma_f32_16x16x32_bf16 v[60:63], v[20:23], v[236:239], v[60:63]
v_rcp_f32 v167, v167
s_waitcnt lgkmcnt(2)
v_mfma_f32_16x16x32_bf16 v[64:67], v[24:27], v[224:227], v[64:67]
ds_read_b64_tr_b16 v[20:21], v5 offset:20480
v_mul_f32 v157, v157, v165
v_mfma_f32_16x16x32_bf16 v[68:71], v[24:27], v[228:231], v[68:71]
ds_read_b64_tr_b16 v[22:23], v5 offset:21504
v_mul_f32 v158, v158, v166
v_mfma_f32_16x16x32_bf16 v[72:75], v[24:27], v[232:235], v[72:75]
v_mul_f32 v159, v159, v167
v_cvt_pk_bf16_f32 v174, v156, v157
v_mfma_f32_16x16x32_bf16 v[76:79], v[24:27], v[236:239], v[76:79]
v_cvt_pk_bf16_f32 v175, v158, v159
v_mfma_f32_16x16x32_bf16 v[80:83], v[28:31], v[224:227], v[80:83]
ds_read_b64_tr_b16 v[24:25], v4 offset:22528
v_mfma_f32_16x16x32_bf16 v[84:87], v[28:31], v[228:231], v[84:87]
ds_read_b64_tr_b16 v[26:27], v4 offset:23552
v_mfma_f32_16x16x32_bf16 v[88:91], v[28:31], v[232:235], v[88:91]
buffer_store_dwordx4 v[172:175], v9, s[8:11], s42 offen offset:3072 sc1
v_mfma_f32_16x16x32_bf16 v[92:95], v[28:31], v[236:239], v[92:95]
s_waitcnt lgkmcnt(2)
v_mfma_f32_16x16x32_bf16 v[32:35], v[16:19], v[240:243], v[32:35]
ds_read_b64_tr_b16 v[28:29], v5 offset:22528
v_mfma_f32_16x16x32_bf16 v[36:39], v[16:19], v[244:247], v[36:39]
ds_read_b64_tr_b16 v[30:31], v5 offset:23552
v_mfma_f32_16x16x32_bf16 v[40:43], v[16:19], v[248:251], v[40:43]
v_mfma_f32_16x16x32_bf16 v[44:47], v[16:19], v[252:255], v[44:47]
v_add_u32 v4, 0x6000, v4
v_add_u32 v5, 0x6000, v5
v_mfma_f32_16x16x32_bf16 v[48:51], v[20:23], v[240:243], v[48:51]
s_waitcnt vmcnt(22)
s_barrier
ds_read_b64_tr_b16 v[16:17], v4 offset:0
v_mfma_f32_16x16x32_bf16 v[52:55], v[20:23], v[244:247], v[52:55]
ds_read_b64_tr_b16 v[18:19], v4 offset:1024
s_add_u32 m0, s31, 122880
s_add_u32 s40, s34, 1572864
v_mfma_f32_16x16x32_bf16 v[56:59], v[20:23], v[248:251], v[56:59]
buffer_load_dwordx4 v3, s[16:19], s40 offen lds
v_mfma_f32_16x16x32_bf16 v[60:63], v[20:23], v[252:255], v[60:63]
s_waitcnt lgkmcnt(2)
v_mfma_f32_16x16x32_bf16 v[64:67], v[24:27], v[240:243], v[64:67]
ds_read_b64_tr_b16 v[20:21], v5 offset:0
v_mfma_f32_16x16x32_bf16 v[68:71], v[24:27], v[244:247], v[68:71]
ds_read_b64_tr_b16 v[22:23], v5 offset:1024
v_mfma_f32_16x16x32_bf16 v[72:75], v[24:27], v[248:251], v[72:75]
v_mfma_f32_16x16x32_bf16 v[76:79], v[24:27], v[252:255], v[76:79]
v_mfma_f32_16x16x32_bf16 v[80:83], v[28:31], v[240:243], v[80:83]
ds_read_b64_tr_b16 v[24:25], v4 offset:2048
v_mfma_f32_16x16x32_bf16 v[84:87], v[28:31], v[244:247], v[84:87]
ds_read_b64_tr_b16 v[26:27], v4 offset:3072
v_mfma_f32_16x16x32_bf16 v[88:91], v[28:31], v[248:251], v[88:91]
s_add_u32 m0, s31, 126976
s_add_u32 s40, s34, 1835008
v_mfma_f32_16x16x32_bf16 v[92:95], v[28:31], v[252:255], v[92:95]
s_waitcnt lgkmcnt(2)
v_mfma_f32_16x16x32_bf16 v[96:99], v[16:19], a[0:3], 0
ds_read_b64_tr_b16 v[28:29], v5 offset:2048
v_mfma_f32_16x16x32_bf16 v[100:103], v[16:19], a[4:7], 0
ds_read_b64_tr_b16 v[30:31], v5 offset:3072
v_mfma_f32_16x16x32_bf16 v[104:107], v[16:19], a[8:11], 0
buffer_load_dwordx4 v3, s[16:19], s40 offen lds
v_mfma_f32_16x16x32_bf16 v[108:111], v[16:19], a[12:15], 0
v_mfma_f32_16x16x32_bf16 v[112:115], v[20:23], a[0:3], 0
ds_read_b64_tr_b16 v[16:17], v4 offset:4096
v_mfma_f32_16x16x32_bf16 v[116:119], v[20:23], a[4:7], 0
ds_read_b64_tr_b16 v[18:19], v4 offset:5120
v_mfma_f32_16x16x32_bf16 v[120:123], v[20:23], a[8:11], 0
v_mfma_f32_16x16x32_bf16 v[124:127], v[20:23], a[12:15], 0
s_waitcnt lgkmcnt(2)
v_mfma_f32_16x16x32_bf16 v[128:131], v[24:27], a[0:3], 0
ds_read_b64_tr_b16 v[20:21], v5 offset:4096
v_mul_f32 v160, v32, v32
v_mfma_f32_16x16x32_bf16 v[132:135], v[24:27], a[4:7], 0
ds_read_b64_tr_b16 v[22:23], v5 offset:5120
v_mul_f32 v161, v33, v33
v_mfma_f32_16x16x32_bf16 v[136:139], v[24:27], a[8:11], 0
s_add_u32 m0, s31, 131072
s_add_u32 s40, s34, 2097152
v_mul_f32 v162, v34, v34
v_mfma_f32_16x16x32_bf16 v[140:143], v[24:27], a[12:15], 0
v_mul_f32 v163, v35, v35
v_fma_f32 v160, v160, v12, s44
v_mfma_f32_16x16x32_bf16 v[144:147], v[28:31], a[0:3], 0
ds_read_b64_tr_b16 v[24:25], v4 offset:6144
v_fma_f32 v161, v161, v12, s44
v_mfma_f32_16x16x32_bf16 v[148:151], v[28:31], a[4:7], 0
ds_read_b64_tr_b16 v[26:27], v4 offset:7168
v_fma_f32 v162, v162, v12, s44
v_mfma_f32_16x16x32_bf16 v[152:155], v[28:31], a[8:11], 0
buffer_load_dwordx4 v3, s[16:19], s40 offen lds
v_mfma_f32_16x16x32_bf16 v[156:159], v[28:31], a[12:15], 0
v_fma_f32 v163, v163, v12, s44
v_mul_f32 v160, v32, v160
s_waitcnt lgkmcnt(2)
v_mfma_f32_16x16x32_bf16 v[96:99], v[16:19], a[16:19], v[96:99]
ds_read_b64_tr_b16 v[28:29], v5 offset:6144
v_mul_f32 v161, v33, v161
v_mfma_f32_16x16x32_bf16 v[100:103], v[16:19], a[20:23], v[100:103]
ds_read_b64_tr_b16 v[30:31], v5 offset:7168
v_mul_f32 v162, v34, v162
v_mfma_f32_16x16x32_bf16 v[104:107], v[16:19], a[24:27], v[104:107]
v_exp_f32 v160, v160
v_mfma_f32_16x16x32_bf16 v[108:111], v[16:19], a[28:31], v[108:111]
v_exp_f32 v161, v161
v_mfma_f32_16x16x32_bf16 v[112:115], v[20:23], a[16:19], v[112:115]
ds_read_b64_tr_b16 v[16:17], v4 offset:8192
v_mul_f32 v163, v35, v163
v_mfma_f32_16x16x32_bf16 v[116:119], v[20:23], a[20:23], v[116:119]
ds_read_b64_tr_b16 v[18:19], v4 offset:9216
v_mul_f32 v64, v32, v64
v_mfma_f32_16x16x32_bf16 v[120:123], v[20:23], a[24:27], v[120:123]
s_add_u32 m0, s31, 135168
s_add_u32 s40, s34, 2359296
v_exp_f32 v162, v162
v_mfma_f32_16x16x32_bf16 v[124:127], v[20:23], a[28:31], v[124:127]
s_lshl_b32 s72, s28, 13
v_exp_f32 v163, v163
s_waitcnt lgkmcnt(2)
v_mfma_f32_16x16x32_bf16 v[128:131], v[24:27], a[16:19], v[128:131]
ds_read_b64_tr_b16 v[20:21], v5 offset:8192
s_add_u32 s72, s72, mk_L_Q0-mk_pc
v_lshl_add_u32 v179, v0, 7, s72
v_mfma_f32_16x16x32_bf16 v[132:135], v[24:27], a[20:23], v[132:135]
ds_read_b64_tr_b16 v[22:23], v5 offset:9216
v_min_u32 v179, mk_fin-mk_pc, v179
v_mfma_f32_16x16x32_bf16 v[136:139], v[24:27], a[24:27], v[136:139]
buffer_load_dwordx4 v3, s[16:19], s40 offen lds
v_mfma_f32_16x16x32_bf16 v[140:143], v[24:27], a[28:31], v[140:143]
global_load_dword v8, v179, s[4:5]
v_mfma_f32_16x16x32_bf16 v[144:147], v[28:31], a[16:19], v[144:147]
ds_read_b64_tr_b16 v[24:25], v4 offset:10240
v_mul_f32 v65, v33, v65
v_mfma_f32_16x16x32_bf16 v[148:151], v[28:31], a[20:23], v[148:151]
ds_read_b64_tr_b16 v[26:27], v4 offset:11264
v_mul_f32 v66, v34, v66
v_mfma_f32_16x16x32_bf16 v[152:155], v[28:31], a[24:27], v[152:155]
v_mul_f32 v67, v35, v67
v_add_f32 v160, 1.0, v160
v_mfma_f32_16x16x32_bf16 v[156:159], v[28:31], a[28:31], v[156:159]
v_rcp_f32 v160, v160
s_waitcnt lgkmcnt(2)
v_mfma_f32_16x16x32_bf16 v[96:99], v[16:19], a[32:35], v[96:99]
ds_read_b64_tr_b16 v[28:29], v5 offset:10240
v_add_f32 v161, 1.0, v161
v_mfma_f32_16x16x32_bf16 v[100:103], v[16:19], a[36:39], v[100:103]
ds_read_b64_tr_b16 v[30:31], v5 offset:11264
v_add_f32 v162, 1.0, v162
v_mfma_f32_16x16x32_bf16 v[104:107], v[16:19], a[40:43], v[104:107]
s_add_u32 m0, s31, 139264
s_add_u32 s40, s34, 2621440
v_rcp_f32 v161, v161
v_mfma_f32_16x16x32_bf16 v[108:111], v[16:19], a[44:47], v[108:111]
v_rcp_f32 v162, v162
v_mfma_f32_16x16x32_bf16 v[112:115], v[20:23], a[32:35], v[112:115]
ds_read_b64_tr_b16 v[16:17], v4 offset:12288
v_add_f32 v163, 1.0, v163
v_mfma_f32_16x16x32_bf16 v[116:119], v[20:23], a[36:39], v[116:119]
ds_read_b64_tr_b16 v[18:19], v4 offset:13312
v_mul_f32 v64, v64, v160
v_mfma_f32_16x16x32_bf16 v[120:123], v[20:23], a[40:43], v[120:123]
buffer_load_dwordx4 v3, s[16:19], s40 offen lds
v_mfma_f32_16x16x32_bf16 v[124:127], v[20:23], a[44:47], v[124:127]
v_rcp_f32 v163, v163
s_add_u32 s42, s37, 8192
s_waitcnt lgkmcnt(2)
v_mfma_f32_16x16x32_bf16 v[128:131], v[24:27], a[32:35], v[128:131]
ds_read_b64_tr_b16 v[20:21], v5 offset:12288
v_mul_f32 v65, v65, v161
v_mfma_f32_16x16x32_bf16 v[132:135], v[24:27], a[36:39], v[132:135]
ds_read_b64_tr_b16 v[22:23], v5 offset:13312
v_mul_f32 v66, v66, v162
v_mfma_f32_16x16x32_bf16 v[136:139], v[24:27], a[40:43], v[136:139]
v_mul_f32 v67, v67, v163
v_cvt_pk_bf16_f32 v168, v64, v65
v_mfma_f32_16x16x32_bf16 v[140:143], v[24:27], a[44:47], v[140:143]
v_cvt_pk_bf16_f32 v169, v66, v67
v_mul_f32 v164, v48, v48
v_mfma_f32_16x16x32_bf16 v[144:147], v[28:31], a[32:35], v[144:147]
ds_read_b64_tr_b16 v[24:25], v4 offset:14336
v_mul_f32 v165, v49, v49
v_mfma_f32_16x16x32_bf16 v[148:151], v[28:31], a[36:39], v[148:151]
ds_read_b64_tr_b16 v[26:27], v4 offset:15360
v_mul_f32 v166, v50, v50
v_mfma_f32_16x16x32_bf16 v[152:155], v[28:31], a[40:43], v[152:155]
s_add_u32 m0, s31, 143360
s_add_u32 s40, s34, 2883584
v_mul_f32 v167, v51, v51
v_mfma_f32_16x16x32_bf16 v[156:159], v[28:31], a[44:47], v[156:159]
v_fma_f32 v164, v164, v12, s44
v_fma_f32 v165, v165, v12, s44
s_waitcnt lgkmcnt(2)
v_mfma_f32_16x16x32_bf16 v[96:99], v[16:19], a[48:51], v[96:99]
ds_read_b64_tr_b16 v[28:29], v5 offset:14336
v_fma_f32 v166, v166, v12, s44
v_mfma_f32_16x16x32_bf16 v[100:103], v[16:19], a[52:55], v[100:103]
ds_read_b64_tr_b16 v[30:31], v5 offset:15360
v_fma_f32 v167, v167, v12, s44
v_mfma_f32_16x16x32_bf16 v[104:107], v[16:19], a[56:59], v[104:107]
buffer_load_dwordx4 v3, s[16:19], s40 offen lds
v_mfma_f32_16x16x32_bf16 v[108:111], v[16:19], a[60:63], v[108:111]
v_mul_f32 v164, v48, v164
v_mul_f32 v165, v49, v165
v_mfma_f32_16x16x32_bf16 v[112:115], v[20:23], a[48:51], v[112:115]
ds_read_b64_tr_b16 v[16:17], v4 offset:16384
v_mul_f32 v166, v50, v166
v_mfma_f32_16x16x32_bf16 v[116:119], v[20:23], a[52:55], v[116:119]
ds_read_b64_tr_b16 v[18:19], v4 offset:17408
v_mul_f32 v167, v51, v167
v_mfma_f32_16x16x32_bf16 v[120:123], v[20:23], a[56:59], v[120:123]
v_exp_f32 v164, v164
v_mfma_f32_16x16x32_bf16 v[124:127], v[20:23], a[60:63], v[124:127]
v_exp_f32 v165, v165
s_waitcnt lgkmcnt(2)
v_mfma_f32_16x16x32_bf16 v[128:131], v[24:27], a[48:51], v[128:131]
ds_read_b64_tr_b16 v[20:21], v5 offset:16384
v_mul_f32 v80, v48, v80
v_mfma_f32_16x16x32_bf16 v[132:135], v[24:27], a[52:55], v[132:135]
ds_read_b64_tr_b16 v[22:23], v5 offset:17408
v_mul_f32 v81, v49, v81
v_mfma_f32_16x16x32_bf16 v[136:139], v[24:27], a[56:59], v[136:139]
v_exp_f32 v166, v166
v_mfma_f32_16x16x32_bf16 v[140:143], v[24:27], a[60:63], v[140:143]
v_exp_f32 v167, v167
v_mfma_f32_16x16x32_bf16 v[144:147], v[28:31], a[48:51], v[144:147]
ds_read_b64_tr_b16 v[24:25], v4 offset:18432
v_mul_f32 v82, v50, v82
v_mfma_f32_16x16x32_bf16 v[148:151], v[28:31], a[52:55], v[148:151]
ds_read_b64_tr_b16 v[26:27], v4 offset:19456
v_mul_f32 v83, v51, v83
v_mfma_f32_16x16x32_bf16 v[152:155], v[28:31], a[56:59], v[152:155]
v_add_f32 v164, 1.0, v164
v_add_f32 v165, 1.0, v165
v_mfma_f32_16x16x32_bf16 v[156:159], v[28:31], a[60:63], v[156:159]
v_rcp_f32 v164, v164
s_waitcnt lgkmcnt(2)
v_mfma_f32_16x16x32_bf16 v[96:99], v[16:19], a[64:67], v[96:99]
ds_read_b64_tr_b16 v[28:29], v5 offset:18432
v_add_f32 v166, 1.0, v166
v_mfma_f32_16x16x32_bf16 v[100:103], v[16:19], a[68:71], v[100:103]
ds_read_b64_tr_b16 v[30:31], v5 offset:19456
v_add_f32 v167, 1.0, v167
v_mfma_f32_16x16x32_bf16 v[104:107], v[16:19], a[72:75], v[104:107]
v_rcp_f32 v165, v165
v_mfma_f32_16x16x32_bf16 v[108:111], v[16:19], a[76:79], v[108:111]
v_rcp_f32 v166, v166
v_mfma_f32_16x16x32_bf16 v[112:115], v[20:23], a[64:67], v[112:115]
ds_read_b64_tr_b16 v[16:17], v4 offset:20480
v_mul_f32 v80, v80, v164
v_mfma_f32_16x16x32_bf16 v[116:119], v[20:23], a[68:71], v[116:119]
ds_read_b64_tr_b16 v[18:19], v4 offset:21504
v_mul_f32 v81, v81, v165
v_mfma_f32_16x16x32_bf16 v[120:123], v[20:23], a[72:75], v[120:123]
v_rcp_f32 v167, v167
v_mfma_f32_16x16x32_bf16 v[124:127], v[20:23], a[76:79], v[124:127]
v_mul_f32 v82, v82, v166
v_mul_f32 v83, v83, v167
s_waitcnt lgkmcnt(2)
v_mfma_f32_16x16x32_bf16 v[128:131], v[24:27], a[64:67], v[128:131]
ds_read_b64_tr_b16 v[20:21], v5 offset:20480
v_cvt_pk_bf16_f32 v170, v80, v81
v_mfma_f32_16x16x32_bf16 v[132:135], v[24:27], a[68:71], v[132:135]
ds_read_b64_tr_b16 v[22:23], v5 offset:21504
v_cvt_pk_bf16_f32 v171, v82, v83
v_mfma_f32_16x16x32_bf16 v[136:139], v[24:27], a[72:75], v[136:139]
buffer_store_dwordx4 v[168:171], v9, s[8:11], s42 offen offset:0 sc1
v_mfma_f32_16x16x32_bf16 v[140:143], v[24:27], a[76:79], v[140:143]
v_mul_f32 v160, v36, v36
v_mul_f32 v161, v37, v37
v_mfma_f32_16x16x32_bf16 v[144:147], v[28:31], a[64:67], v[144:147]
ds_read_b64_tr_b16 v[24:25], v4 offset:22528
v_mul_f32 v162, v38, v38
v_mfma_f32_16x16x32_bf16 v[148:151], v[28:31], a[68:71], v[148:151]
ds_read_b64_tr_b16 v[26:27], v4 offset:23552
v_mul_f32 v163, v39, v39
v_mfma_f32_16x16x32_bf16 v[152:155], v[28:31], a[72:75], v[152:155]
v_fma_f32 v160, v160, v12, s44
v_fma_f32 v161, v161, v12, s44
v_mfma_f32_16x16x32_bf16 v[156:159], v[28:31], a[76:79], v[156:159]
v_fma_f32 v162, v162, v12, s44
v_fma_f32 v163, v163, v12, s44
s_waitcnt lgkmcnt(2)
v_mfma_f32_16x16x32_bf16 v[96:99], v[16:19], a[80:83], v[96:99]
ds_read_b64_tr_b16 v[28:29], v5 offset:22528
v_mul_f32 v160, v36, v160
v_mfma_f32_16x16x32_bf16 v[100:103], v[16:19], a[84:87], v[100:103]
ds_read_b64_tr_b16 v[30:31], v5 offset:23552
v_mul_f32 v161, v37, v161
v_mfma_f32_16x16x32_bf16 v[104:107], v[16:19], a[88:91], v[104:107]
v_exp_f32 v160, v160
v_mfma_f32_16x16x32_bf16 v[108:111], v[16:19], a[92:95], v[108:111]
v_add_u32 v4, 0x6000, v4
v_add_u32 v5, 0x6000, v5
v_mfma_f32_16x16x32_bf16 v[112:115], v[20:23], a[80:83], v[112:115]
s_waitcnt vmcnt(24)
s_barrier
ds_read_b64_tr_b16 v[16:17], v4 offset:0
v_mfma_f32_16x16x32_bf16 v[116:119], v[20:23], a[84:87], v[116:119]
ds_read_b64_tr_b16 v[18:19], v4 offset:1024
s_add_u32 m0, s31, 0
v_mul_f32 v162, v38, v162
v_mfma_f32_16x16x32_bf16 v[120:123], v[20:23], a[88:91], v[120:123]
s_add_u32 s40, s34, 3145728
buffer_load_dwordx4 v3, s[16:19], s40 offen lds
v_mfma_f32_16x16x32_bf16 v[124:127], v[20:23], a[92:95], v[124:127]
v_exp_f32 v161, v161
s_waitcnt lgkmcnt(2)
v_mfma_f32_16x16x32_bf16 v[128:131], v[24:27], a[80:83], v[128:131]
ds_read_b64_tr_b16 v[20:21], v5 offset:0
v_mul_f32 v163, v39, v163
v_mfma_f32_16x16x32_bf16 v[132:135], v[24:27], a[84:87], v[132:135]
ds_read_b64_tr_b16 v[22:23], v5 offset:1024
v_mul_f32 v68, v36, v68
v_mfma_f32_16x16x32_bf16 v[136:139], v[24:27], a[88:91], v[136:139]
v_exp_f32 v162, v162
v_mfma_f32_16x16x32_bf16 v[140:143], v[24:27], a[92:95], v[140:143]
v_exp_f32 v163, v163
v_mfma_f32_16x16x32_bf16 v[144:147], v[28:31], a[80:83], v[144:147]
ds_read_b64_tr_b16 v[24:25], v4 offset:2048
v_mul_f32 v69, v37, v69
v_mfma_f32_16x16x32_bf16 v[148:151], v[28:31], a[84:87], v[148:151]
ds_read_b64_tr_b16 v[26:27], v4 offset:3072
v_mul_f32 v70, v38, v70
v_mfma_f32_16x16x32_bf16 v[152:155], v[28:31], a[88:91], v[152:155]
s_add_u32 m0, s31, 4096
s_add_u32 s40, s34, 3407872
v_mul_f32 v71, v39, v71
v_mfma_f32_16x16x32_bf16 v[156:159], v[28:31], a[92:95], v[156:159]
v_add_f32 v160, 1.0, v160
v_add_f32 v161, 1.0, v161
s_waitcnt lgkmcnt(2)
v_mfma_f32_16x16x32_bf16 v[96:99], v[16:19], a[96:99], v[96:99]
ds_read_b64_tr_b16 v[28:29], v5 offset:2048
v_add_f32 v162, 1.0, v162
v_mfma_f32_16x16x32_bf16 v[100:103], v[16:19], a[100:103], v[100:103]
ds_read_b64_tr_b16 v[30:31], v5 offset:3072
v_add_f32 v163, 1.0, v163
v_mfma_f32_16x16x32_bf16 v[104:107], v[16:19], a[104:107], v[104:107]
buffer_load_dwordx4 v3, s[16:19], s40 offen lds
v_mfma_f32_16x16x32_bf16 v[108:111], v[16:19], a[108:111], v[108:111]
v_rcp_f32 v160, v160
v_mfma_f32_16x16x32_bf16 v[112:115], v[20:23], a[96:99], v[112:115]
ds_read_b64_tr_b16 v[16:17], v4 offset:4096
v_mul_f32 v68, v68, v160
v_mfma_f32_16x16x32_bf16 v[116:119], v[20:23], a[100:103], v[116:119]
ds_read_b64_tr_b16 v[18:19], v4 offset:5120
v_mul_f32 v164, v52, v52
v_mfma_f32_16x16x32_bf16 v[120:123], v[20:23], a[104:107], v[120:123]
v_rcp_f32 v161, v161
v_mfma_f32_16x16x32_bf16 v[124:127], v[20:23], a[108:111], v[124:127]
v_rcp_f32 v162, v162
s_waitcnt lgkmcnt(2)
v_mfma_f32_16x16x32_bf16 v[128:131], v[24:27], a[96:99], v[128:131]
ds_read_b64_tr_b16 v[20:21], v5 offset:4096
v_mul_f32 v69, v69, v161
v_mfma_f32_16x16x32_bf16 v[132:135], v[24:27], a[100:103], v[132:135]
ds_read_b64_tr_b16 v[22:23], v5 offset:5120
v_mul_f32 v70, v70, v162
v_mfma_f32_16x16x32_bf16 v[136:139], v[24:27], a[104:107], v[136:139]
s_add_u32 m0, s31, 8192
s_add_u32 s40, s34, 3670016
v_rcp_f32 v163, v163
v_mfma_f32_16x16x32_bf16 v[140:143], v[24:27], a[108:111], v[140:143]
v_mul_f32 v71, v71, v163
v_cvt_pk_bf16_f32 v172, v68, v69
v_mfma_f32_16x16x32_bf16 v[144:147], v[28:31], a[96:99], v[144:147]
ds_read_b64_tr_b16 v[24:25], v4 offset:6144
v_cvt_pk_bf16_f32 v173, v70, v71
v_mfma_f32_16x16x32_bf16 v[148:151], v[28:31], a[100:103], v[148:151]
ds_read_b64_tr_b16 v[26:27], v4 offset:7168
v_mul_f32 v165, v53, v53
v_mfma_f32_16x16x32_bf16 v[152:155], v[28:31], a[104:107], v[152:155]
buffer_load_dwordx4 v3, s[16:19], s40 offen lds
v_mfma_f32_16x16x32_bf16 v[156:159], v[28:31], a[108:111], v[156:159]
v_mul_f32 v166, v54, v54
v_mul_f32 v167, v55, v55
s_waitcnt lgkmcnt(2)
v_mfma_f32_16x16x32_bf16 v[96:99], v[16:19], a[112:115], v[96:99]
ds_read_b64_tr_b16 v[28:29], v5 offset:6144
v_fma_f32 v164, v164, v12, s44
v_mfma_f32_16x16x32_bf16 v[100:103], v[16:19], a[116:119], v[100:103]
ds_read_b64_tr_b16 v[30:31], v5 offset:7168
v_fma_f32 v165, v165, v12, s44
v_mfma_f32_16x16x32_bf16 v[104:107], v[16:19], a[120:123], v[104:107]
v_fma_f32 v166, v166, v12, s44
v_fma_f32 v167, v167, v12, s44
v_mfma_f32_16x16x32_bf16 v[108:111], v[16:19], a[124:127], v[108:111]
v_mul_f32 v164, v52, v164
v_mul_f32 v165, v53, v165
v_mfma_f32_16x16x32_bf16 v[112:115], v[20:23], a[112:115], v[112:115]
ds_read_b64_tr_b16 v[16:17], v4 offset:8192
v_mul_f32 v166, v54, v166
v_mfma_f32_16x16x32_bf16 v[116:119], v[20:23], a[116:119], v[116:119]
ds_read_b64_tr_b16 v[18:19], v4 offset:9216
v_mul_f32 v167, v55, v167
v_mfma_f32_16x16x32_bf16 v[120:123], v[20:23], a[120:123], v[120:123]
s_add_u32 m0, s31, 12288
s_add_u32 s40, s34, 3932160
v_exp_f32 v164, v164
v_mfma_f32_16x16x32_bf16 v[124:127], v[20:23], a[124:127], v[124:127]
v_exp_f32 v165, v165
s_waitcnt lgkmcnt(2)
v_mfma_f32_16x16x32_bf16 v[128:131], v[24:27], a[112:115], v[128:131]
ds_read_b64_tr_b16 v[20:21], v5 offset:8192
v_mul_f32 v84, v52, v84
v_mfma_f32_16x16x32_bf16 v[132:135], v[24:27], a[116:119], v[132:135]
ds_read_b64_tr_b16 v[22:23], v5 offset:9216
v_mul_f32 v85, v53, v85
v_mfma_f32_16x16x32_bf16 v[136:139], v[24:27], a[120:123], v[136:139]
buffer_load_dwordx4 v3, s[16:19], s40 offen lds
v_mfma_f32_16x16x32_bf16 v[140:143], v[24:27], a[124:127], v[140:143]
v_exp_f32 v166, v166
v_mfma_f32_16x16x32_bf16 v[144:147], v[28:31], a[112:115], v[144:147]
ds_read_b64_tr_b16 v[24:25], v4 offset:10240
v_mul_f32 v86, v54, v86
v_mfma_f32_16x16x32_bf16 v[148:151], v[28:31], a[116:119], v[148:151]
ds_read_b64_tr_b16 v[26:27], v4 offset:11264
v_mul_f32 v87, v55, v87
v_mfma_f32_16x16x32_bf16 v[152:155], v[28:31], a[120:123], v[152:155]
v_exp_f32 v167, v167
v_mfma_f32_16x16x32_bf16 v[156:159], v[28:31], a[124:127], v[156:159]
v_add_f32 v164, 1.0, v164
v_add_f32 v165, 1.0, v165
s_waitcnt lgkmcnt(2)
v_mfma_f32_16x16x32_bf16 v[96:99], v[16:19], a[128:131], v[96:99]
ds_read_b64_tr_b16 v[28:29], v5 offset:10240
v_add_f32 v166, 1.0, v166
v_mfma_f32_16x16x32_bf16 v[100:103], v[16:19], a[132:135], v[100:103]
ds_read_b64_tr_b16 v[30:31], v5 offset:11264
v_add_f32 v167, 1.0, v167
v_mfma_f32_16x16x32_bf16 v[104:107], v[16:19], a[136:139], v[104:107]
s_add_u32 m0, s31, 16384
s_add_u32 s40, s34, 4194304
v_rcp_f32 v164, v164
v_mfma_f32_16x16x32_bf16 v[108:111], v[16:19], a[140:143], v[108:111]
v_rcp_f32 v165, v165
v_mfma_f32_16x16x32_bf16 v[112:115], v[20:23], a[128:131], v[112:115]
ds_read_b64_tr_b16 v[16:17], v4 offset:12288
v_mul_f32 v84, v84, v164
v_mfma_f32_16x16x32_bf16 v[116:119], v[20:23], a[132:135], v[116:119]
ds_read_b64_tr_b16 v[18:19], v4 offset:13312
v_mul_f32 v85, v85, v165
v_mfma_f32_16x16x32_bf16 v[120:123], v[20:23], a[136:139], v[120:123]
buffer_load_dwordx4 v3, s[16:19], s40 offen lds
v_mfma_f32_16x16x32_bf16 v[124:127], v[20:23], a[140:143], v[124:127]
v_rcp_f32 v166, v166
s_waitcnt lgkmcnt(2)
v_mfma_f32_16x16x32_bf16 v[128:131], v[24:27], a[128:131], v[128:131]
ds_read_b64_tr_b16 v[20:21], v5 offset:12288
v_mul_f32 v86, v86, v166
v_mfma_f32_16x16x32_bf16 v[132:135], v[24:27], a[132:135], v[132:135]
ds_read_b64_tr_b16 v[22:23], v5 offset:13312
v_cvt_pk_bf16_f32 v174, v84, v85
v_mfma_f32_16x16x32_bf16 v[136:139], v[24:27], a[136:139], v[136:139]
v_rcp_f32 v167, v167
v_mfma_f32_16x16x32_bf16 v[140:143], v[24:27], a[140:143], v[140:143]
v_mul_f32 v87, v87, v167
v_cvt_pk_bf16_f32 v175, v86, v87
v_mfma_f32_16x16x32_bf16 v[144:147], v[28:31], a[128:131], v[144:147]
ds_read_b64_tr_b16 v[24:25], v4 offset:14336
v_mul_f32 v160, v40, v40
v_mfma_f32_16x16x32_bf16 v[148:151], v[28:31], a[132:135], v[148:151]
ds_read_b64_tr_b16 v[26:27], v4 offset:15360
v_mul_f32 v161, v41, v41
v_mfma_f32_16x16x32_bf16 v[152:155], v[28:31], a[136:139], v[152:155]
s_add_u32 m0, s31, 20480
s_add_u32 s40, s34, 4456448
buffer_store_dwordx4 v[172:175], v9, s[8:11], s42 offen offset:1024 sc1
v_mfma_f32_16x16x32_bf16 v[156:159], v[28:31], a[140:143], v[156:159]
v_mul_f32 v162, v42, v42
v_mul_f32 v163, v43, v43
s_waitcnt lgkmcnt(2)
v_mfma_f32_16x16x32_bf16 v[96:99], v[16:19], a[144:147], v[96:99]
ds_read_b64_tr_b16 v[28:29], v5 offset:14336
v_fma_f32 v160, v160, v12, s44
v_mfma_f32_16x16x32_bf16 v[100:103], v[16:19], a[148:151], v[100:103]
ds_read_b64_tr_b16 v[30:31], v5 offset:15360
v_fma_f32 v161, v161, v12, s44
v_mfma_f32_16x16x32_bf16 v[104:107], v[16:19], a[152:155], v[104:107]
buffer_load_dwordx4 v3, s[16:19], s40 offen lds
v_mfma_f32_16x16x32_bf16 v[108:111], v[16:19], a[156:159], v[108:111]
v_fma_f32 v162, v162, v12, s44
v_fma_f32 v163, v163, v12, s44
v_mfma_f32_16x16x32_bf16 v[112:115], v[20:23], a[144:147], v[112:115]
ds_read_b64_tr_b16 v[16:17], v4 offset:16384
v_mul_f32 v160, v40, v160
v_mfma_f32_16x16x32_bf16 v[116:119], v[20:23], a[148:151], v[116:119]
ds_read_b64_tr_b16 v[18:19], v4 offset:17408
v_mul_f32 v161, v41, v161
v_mfma_f32_16x16x32_bf16 v[120:123], v[20:23], a[152:155], v[120:123]
v_exp_f32 v160, v160
v_mfma_f32_16x16x32_bf16 v[124:127], v[20:23], a[156:159], v[124:127]
v_exp_f32 v161, v161
s_waitcnt lgkmcnt(2)
v_mfma_f32_16x16x32_bf16 v[128:131], v[24:27], a[144:147], v[128:131]
ds_read_b64_tr_b16 v[20:21], v5 offset:16384
v_mul_f32 v162, v42, v162
v_mfma_f32_16x16x32_bf16 v[132:135], v[24:27], a[148:151], v[132:135]
ds_read_b64_tr_b16 v[22:23], v5 offset:17408
v_mul_f32 v163, v43, v163
v_mfma_f32_16x16x32_bf16 v[136:139], v[24:27], a[152:155], v[136:139]
v_exp_f32 v162, v162
v_mfma_f32_16x16x32_bf16 v[140:143], v[24:27], a[156:159], v[140:143]
v_exp_f32 v163, v163
v_mfma_f32_16x16x32_bf16 v[144:147], v[28:31], a[144:147], v[144:147]
ds_read_b64_tr_b16 v[24:25], v4 offset:18432
v_mul_f32 v72, v40, v72
v_mfma_f32_16x16x32_bf16 v[148:151], v[28:31], a[148:151], v[148:151]
ds_read_b64_tr_b16 v[26:27], v4 offset:19456
v_mul_f32 v73, v41, v73
v_mfma_f32_16x16x32_bf16 v[152:155], v[28:31], a[152:155], v[152:155]
v_mul_f32 v74, v42, v74
v_mul_f32 v75, v43, v75
v_mfma_f32_16x16x32_bf16 v[156:159], v[28:31], a[156:159], v[156:159]
v_add_f32 v160, 1.0, v160
v_add_f32 v161, 1.0, v161
s_waitcnt lgkmcnt(2)
v_mfma_f32_16x16x32_bf16 v[96:99], v[16:19], a[160:163], v[96:99]
ds_read_b64_tr_b16 v[28:29], v5 offset:18432
v_add_f32 v162, 1.0, v162
v_mfma_f32_16x16x32_bf16 v[100:103], v[16:19], a[164:167], v[100:103]
ds_read_b64_tr_b16 v[30:31], v5 offset:19456
v_add_f32 v163, 1.0, v163
v_mfma_f32_16x16x32_bf16 v[104:107], v[16:19], a[168:171], v[104:107]
v_rcp_f32 v160, v160
v_mfma_f32_16x16x32_bf16 v[108:111], v[16:19], a[172:175], v[108:111]
v_rcp_f32 v161, v161
v_mfma_f32_16x16x32_bf16 v[112:115], v[20:23], a[160:163], v[112:115]
ds_read_b64_tr_b16 v[16:17], v4 offset:20480
v_mul_f32 v72, v72, v160
v_mfma_f32_16x16x32_bf16 v[116:119], v[20:23], a[164:167], v[116:119]
ds_read_b64_tr_b16 v[18:19], v4 offset:21504
v_mul_f32 v73, v73, v161
v_mfma_f32_16x16x32_bf16 v[120:123], v[20:23], a[168:171], v[120:123]
v_rcp_f32 v162, v162
v_mfma_f32_16x16x32_bf16 v[124:127], v[20:23], a[172:175], v[124:127]
v_rcp_f32 v163, v163
s_waitcnt lgkmcnt(2)
v_mfma_f32_16x16x32_bf16 v[128:131], v[24:27], a[160:163], v[128:131]
ds_read_b64_tr_b16 v[20:21], v5 offset:20480
v_mul_f32 v74, v74, v162
v_mfma_f32_16x16x32_bf16 v[132:135], v[24:27], a[164:167], v[132:135]
ds_read_b64_tr_b16 v[22:23], v5 offset:21504
v_mul_f32 v75, v75, v163
v_mfma_f32_16x16x32_bf16 v[136:139], v[24:27], a[168:171], v[136:139]
v_cvt_pk_bf16_f32 v168, v72, v73
v_cvt_pk_bf16_f32 v169, v74, v75
v_mfma_f32_16x16x32_bf16 v[140:143], v[24:27], a[172:175], v[140:143]
v_mul_f32 v164, v56, v56
v_mul_f32 v165, v57, v57
v_mfma_f32_16x16x32_bf16 v[144:147], v[28:31], a[160:163], v[144:147]
ds_read_b64_tr_b16 v[24:25], v4 offset:22528
v_mul_f32 v166, v58, v58
v_mfma_f32_16x16x32_bf16 v[148:151], v[28:31], a[164:167], v[148:151]
ds_read_b64_tr_b16 v[26:27], v4 offset:23552
v_mul_f32 v167, v59, v59
v_mfma_f32_16x16x32_bf16 v[152:155], v[28:31], a[168:171], v[152:155]
v_fma_f32 v164, v164, v12, s44
v_fma_f32 v165, v165, v12, s44
v_mfma_f32_16x16x32_bf16 v[156:159], v[28:31], a[172:175], v[156:159]
v_fma_f32 v166, v166, v12, s44
v_fma_f32 v167, v167, v12, s44
s_waitcnt lgkmcnt(2)
v_mfma_f32_16x16x32_bf16 v[96:99], v[16:19], a[176:179], v[96:99]
ds_read_b64_tr_b16 v[28:29], v5 offset:22528
v_mul_f32 v164, v56, v164
v_mfma_f32_16x16x32_bf16 v[100:103], v[16:19], a[180:183], v[100:103]
ds_read_b64_tr_b16 v[30:31], v5 offset:23552
v_mul_f32 v165, v57, v165
v_mfma_f32_16x16x32_bf16 v[104:107], v[16:19], a[184:187], v[104:107]
v_exp_f32 v164, v164
v_mfma_f32_16x16x32_bf16 v[108:111], v[16:19], a[188:191], v[108:111]
v_add_u32 v4, 0x6000, v4
v_add_u32 v5, 0x6000, v5
v_mfma_f32_16x16x32_bf16 v[112:115], v[20:23], a[176:179], v[112:115]
s_waitcnt vmcnt(23)
s_barrier
ds_read_b64_tr_b16 v[16:17], v4 offset:0
v_mfma_f32_16x16x32_bf16 v[116:119], v[20:23], a[180:183], v[116:119]
ds_read_b64_tr_b16 v[18:19], v4 offset:1024
s_add_u32 m0, s31, 24576
v_mul_f32 v166, v58, v166
v_mfma_f32_16x16x32_bf16 v[120:123], v[20:23], a[184:187], v[120:123]
s_add_u32 s40, s33, 0
buffer_load_dwordx4 v2, s[12:15], s40 offen lds
v_mfma_f32_16x16x32_bf16 v[124:127], v[20:23], a[188:191], v[124:127]
v_exp_f32 v165, v165
s_waitcnt lgkmcnt(2)
v_mfma_f32_16x16x32_bf16 v[128:131], v[24:27], a[176:179], v[128:131]
ds_read_b64_tr_b16 v[20:21], v5 offset:0
v_mul_f32 v167, v59, v167
v_mfma_f32_16x16x32_bf16 v[132:135], v[24:27], a[180:183], v[132:135]
ds_read_b64_tr_b16 v[22:23], v5 offset:1024
v_mul_f32 v88, v56, v88
v_mfma_f32_16x16x32_bf16 v[136:139], v[24:27], a[184:187], v[136:139]
v_exp_f32 v166, v166
v_mfma_f32_16x16x32_bf16 v[140:143], v[24:27], a[188:191], v[140:143]
v_exp_f32 v167, v167
v_mfma_f32_16x16x32_bf16 v[144:147], v[28:31], a[176:179], v[144:147]
ds_read_b64_tr_b16 v[24:25], v4 offset:2048
v_mul_f32 v89, v57, v89
v_mfma_f32_16x16x32_bf16 v[148:151], v[28:31], a[180:183], v[148:151]
ds_read_b64_tr_b16 v[26:27], v4 offset:3072
v_mul_f32 v90, v58, v90
v_mfma_f32_16x16x32_bf16 v[152:155], v[28:31], a[184:187], v[152:155]
s_add_u32 m0, s31, 28672
s_add_u32 s40, s33, 589824
v_mul_f32 v91, v59, v91
v_mfma_f32_16x16x32_bf16 v[156:159], v[28:31], a[188:191], v[156:159]
v_add_f32 v164, 1.0, v164
v_add_f32 v165, 1.0, v165
s_waitcnt lgkmcnt(2)
v_mfma_f32_16x16x32_bf16 v[96:99], v[16:19], a[192:195], v[96:99]
ds_read_b64_tr_b16 v[28:29], v5 offset:2048
v_add_f32 v166, 1.0, v166
v_mfma_f32_16x16x32_bf16 v[100:103], v[16:19], a[196:199], v[100:103]
ds_read_b64_tr_b16 v[30:31], v5 offset:3072
v_add_f32 v167, 1.0, v167
v_mfma_f32_16x16x32_bf16 v[104:107], v[16:19], a[200:203], v[104:107]
buffer_load_dwordx4 v2, s[12:15], s40 offen lds
v_mfma_f32_16x16x32_bf16 v[108:111], v[16:19], a[204:207], v[108:111]
v_rcp_f32 v164, v164
v_mfma_f32_16x16x32_bf16 v[112:115], v[20:23], a[192:195], v[112:115]
ds_read_b64_tr_b16 v[16:17], v4 offset:4096
v_mul_f32 v88, v88, v164
v_mfma_f32_16x16x32_bf16 v[116:119], v[20:23], a[196:199], v[116:119]
ds_read_b64_tr_b16 v[18:19], v4 offset:5120
v_mul_f32 v160, v44, v44
v_mfma_f32_16x16x32_bf16 v[120:123], v[20:23], a[200:203], v[120:123]
v_rcp_f32 v165, v165
v_mfma_f32_16x16x32_bf16 v[124:127], v[20:23], a[204:207], v[124:127]
v_rcp_f32 v166, v166
s_waitcnt lgkmcnt(2)
v_mfma_f32_16x16x32_bf16 v[128:131], v[24:27], a[192:195], v[128:131]
ds_read_b64_tr_b16 v[20:21], v5 offset:4096
v_mul_f32 v89, v89, v165
v_mfma_f32_16x16x32_bf16 v[132:135], v[24:27], a[196:199], v[132:135]
ds_read_b64_tr_b16 v[22:23], v5 offset:5120
v_mul_f32 v90, v90, v166
v_mfma_f32_16x16x32_bf16 v[136:139], v[24:27], a[200:203], v[136:139]
s_add_u32 m0, s31, 32768
s_add_u32 s40, s33, 1179648
v_rcp_f32 v167, v167
v_mfma_f32_16x16x32_bf16 v[140:143], v[24:27], a[204:207], v[140:143]
v_mul_f32 v91, v91, v167
v_cvt_pk_bf16_f32 v170, v88, v89
v_mfma_f32_16x16x32_bf16 v[144:147], v[28:31], a[192:195], v[144:147]
ds_read_b64_tr_b16 v[24:25], v4 offset:6144
v_cvt_pk_bf16_f32 v171, v90, v91
v_mfma_f32_16x16x32_bf16 v[148:151], v[28:31], a[196:199], v[148:151]
ds_read_b64_tr_b16 v[26:27], v4 offset:7168
v_mul_f32 v161, v45, v45
v_mfma_f32_16x16x32_bf16 v[152:155], v[28:31], a[200:203], v[152:155]
buffer_load_dwordx4 v2, s[12:15], s40 offen lds
v_mfma_f32_16x16x32_bf16 v[156:159], v[28:31], a[204:207], v[156:159]
buffer_store_dwordx4 v[168:171], v9, s[8:11], s42 offen offset:2048 sc1
s_waitcnt lgkmcnt(2)
v_mfma_f32_16x16x32_bf16 v[96:99], v[16:19], a[208:211], v[96:99]
ds_read_b64_tr_b16 v[28:29], v5 offset:6144
v_mul_f32 v162, v46, v46
v_mfma_f32_16x16x32_bf16 v[100:103], v[16:19], a[212:215], v[100:103]
ds_read_b64_tr_b16 v[30:31], v5 offset:7168
v_mul_f32 v163, v47, v47
v_mfma_f32_16x16x32_bf16 v[104:107], v[16:19], a[216:219], v[104:107]
v_fma_f32 v160, v160, v12, s44
v_fma_f32 v161, v161, v12, s44
v_mfma_f32_16x16x32_bf16 v[108:111], v[16:19], a[220:223], v[108:111]
v_fma_f32 v162, v162, v12, s44
v_fma_f32 v163, v163, v12, s44
v_mfma_f32_16x16x32_bf16 v[112:115], v[20:23], a[208:211], v[112:115]
ds_read_b64_tr_b16 v[16:17], v4 offset:8192
v_mul_f32 v160, v44, v160
v_mfma_f32_16x16x32_bf16 v[116:119], v[20:23], a[212:215], v[116:119]
ds_read_b64_tr_b16 v[18:19], v4 offset:9216
v_mul_f32 v161, v45, v161
v_mfma_f32_16x16x32_bf16 v[120:123], v[20:23], a[216:219], v[120:123]
s_add_u32 m0, s31, 36864
s_add_u32 s40, s33, 1769472
v_exp_f32 v160, v160
v_mfma_f32_16x16x32_bf16 v[124:127], v[20:23], a[220:223], v[124:127]
v_exp_f32 v161, v161
s_waitcnt lgkmcnt(2)
v_mfma_f32_16x16x32_bf16 v[128:131], v[24:27], a[208:211], v[128:131]
ds_read_b64_tr_b16 v[20:21], v5 offset:8192
v_mul_f32 v162, v46, v162
v_mfma_f32_16x16x32_bf16 v[132:135], v[24:27], a[212:215], v[132:135]
ds_read_b64_tr_b16 v[22:23], v5 offset:9216
v_mul_f32 v163, v47, v163
v_mfma_f32_16x16x32_bf16 v[136:139], v[24:27], a[216:219], v[136:139]
buffer_load_dwordx4 v2, s[12:15], s40 offen lds
v_mfma_f32_16x16x32_bf16 v[140:143], v[24:27], a[220:223], v[140:143]
v_exp_f32 v162, v162
v_mfma_f32_16x16x32_bf16 v[144:147], v[28:31], a[208:211], v[144:147]
ds_read_b64_tr_b16 v[24:25], v4 offset:10240
v_mul_f32 v76, v44, v76
v_mfma_f32_16x16x32_bf16 v[148:151], v[28:31], a[212:215], v[148:151]
ds_read_b64_tr_b16 v[26:27], v4 offset:11264
v_mul_f32 v77, v45, v77
v_mfma_f32_16x16x32_bf16 v[152:155], v[28:31], a[216:219], v[152:155]
v_exp_f32 v163, v163
v_mfma_f32_16x16x32_bf16 v[156:159], v[28:31], a[220:223], v[156:159]
v_mul_f32 v78, v46, v78
v_mul_f32 v79, v47, v79
s_waitcnt lgkmcnt(2)
v_mfma_f32_16x16x32_bf16 v[96:99], v[16:19], a[224:227], v[96:99]
ds_read_b64_tr_b16 v[28:29], v5 offset:10240
v_add_f32 v160, 1.0, v160
v_mfma_f32_16x16x32_bf16 v[100:103], v[16:19], a[228:231], v[100:103]
ds_read_b64_tr_b16 v[30:31], v5 offset:11264
v_add_f32 v161, 1.0, v161
v_mfma_f32_16x16x32_bf16 v[104:107], v[16:19], a[232:235], v[104:107]
s_add_u32 m0, s31, 40960
s_add_u32 s40, s33, 2359296
v_rcp_f32 v160, v160
v_mfma_f32_16x16x32_bf16 v[108:111], v[16:19], a[236:239], v[108:111]
v_rcp_f32 v161, v161
v_mfma_f32_16x16x32_bf16 v[112:115], v[20:23], a[224:227], v[112:115]
ds_read_b64_tr_b16 v[16:17], v4 offset:12288
v_add_f32 v162, 1.0, v162
v_mfma_f32_16x16x32_bf16 v[116:119], v[20:23], a[228:231], v[116:119]
ds_read_b64_tr_b16 v[18:19], v4 offset:13312
v_add_f32 v163, 1.0, v163
v_mfma_f32_16x16x32_bf16 v[120:123], v[20:23], a[232:235], v[120:123]
buffer_load_dwordx4 v2, s[12:15], s40 offen lds
v_mfma_f32_16x16x32_bf16 v[124:127], v[20:23], a[236:239], v[124:127]
v_rcp_f32 v162, v162
s_waitcnt lgkmcnt(2)
v_mfma_f32_16x16x32_bf16 v[128:131], v[24:27], a[224:227], v[128:131]
ds_read_b64_tr_b16 v[20:21], v5 offset:12288
v_mul_f32 v76, v76, v160
v_mfma_f32_16x16x32_bf16 v[132:135], v[24:27], a[228:231], v[132:135]
ds_read_b64_tr_b16 v[22:23], v5 offset:13312
v_mul_f32 v77, v77, v161
v_mfma_f32_16x16x32_bf16 v[136:139], v[24:27], a[232:235], v[136:139]
v_rcp_f32 v163, v163
v_mfma_f32_16x16x32_bf16 v[140:143], v[24:27], a[236:239], v[140:143]
v_mul_f32 v78, v78, v162
v_mul_f32 v79, v79, v163
v_mfma_f32_16x16x32_bf16 v[144:147], v[28:31], a[224:227], v[144:147]
ds_read_b64_tr_b16 v[24:25], v4 offset:14336
v_cvt_pk_bf16_f32 v172, v76, v77
v_mfma_f32_16x16x32_bf16 v[148:151], v[28:31], a[228:231], v[148:151]
ds_read_b64_tr_b16 v[26:27], v4 offset:15360
v_cvt_pk_bf16_f32 v173, v78, v79
v_mfma_f32_16x16x32_bf16 v[152:155], v[28:31], a[232:235], v[152:155]
v_mul_f32 v164, v60, v60
v_mul_f32 v165, v61, v61
v_mfma_f32_16x16x32_bf16 v[156:159], v[28:31], a[236:239], v[156:159]
v_mul_f32 v166, v62, v62
v_mul_f32 v167, v63, v63
s_waitcnt lgkmcnt(2)
v_mfma_f32_16x16x32_bf16 v[96:99], v[16:19], a[240:243], v[96:99]
ds_read_b64_tr_b16 v[28:29], v5 offset:14336
v_fma_f32 v164, v164, v12, s44
v_mfma_f32_16x16x32_bf16 v[100:103], v[16:19], a[244:247], v[100:103]
ds_read_b64_tr_b16 v[30:31], v5 offset:15360
v_fma_f32 v165, v165, v12, s44
v_mfma_f32_16x16x32_bf16 v[104:107], v[16:19], a[248:251], v[104:107]
v_fma_f32 v166, v166, v12, s44
v_fma_f32 v167, v167, v12, s44
v_mfma_f32_16x16x32_bf16 v[108:111], v[16:19], a[252:255], v[108:111]
v_mul_f32 v164, v60, v164
v_mul_f32 v165, v61, v165
v_mfma_f32_16x16x32_bf16 v[112:115], v[20:23], a[240:243], v[112:115]
ds_read_b64_tr_b16 v[16:17], v4 offset:16384
v_mul_f32 v166, v62, v166
v_mfma_f32_16x16x32_bf16 v[116:119], v[20:23], a[244:247], v[116:119]
ds_read_b64_tr_b16 v[18:19], v4 offset:17408
v_mul_f32 v167, v63, v167
v_mfma_f32_16x16x32_bf16 v[120:123], v[20:23], a[248:251], v[120:123]
v_exp_f32 v164, v164
v_mfma_f32_16x16x32_bf16 v[124:127], v[20:23], a[252:255], v[124:127]
v_exp_f32 v165, v165
s_waitcnt lgkmcnt(2)
v_mfma_f32_16x16x32_bf16 v[128:131], v[24:27], a[240:243], v[128:131]
ds_read_b64_tr_b16 v[20:21], v5 offset:16384
v_mul_f32 v92, v60, v92
v_mfma_f32_16x16x32_bf16 v[132:135], v[24:27], a[244:247], v[132:135]
ds_read_b64_tr_b16 v[22:23], v5 offset:17408
v_mul_f32 v93, v61, v93
v_mfma_f32_16x16x32_bf16 v[136:139], v[24:27], a[248:251], v[136:139]
v_exp_f32 v166, v166
v_mfma_f32_16x16x32_bf16 v[140:143], v[24:27], a[252:255], v[140:143]
v_exp_f32 v167, v167
v_mfma_f32_16x16x32_bf16 v[144:147], v[28:31], a[240:243], v[144:147]
ds_read_b64_tr_b16 v[24:25], v4 offset:18432
v_mul_f32 v94, v62, v94
v_mfma_f32_16x16x32_bf16 v[148:151], v[28:31], a[244:247], v[148:151]
ds_read_b64_tr_b16 v[26:27], v4 offset:19456
v_mul_f32 v95, v63, v95
v_mfma_f32_16x16x32_bf16 v[152:155], v[28:31], a[248:251], v[152:155]
v_add_f32 v164, 1.0, v164
v_add_f32 v165, 1.0, v165
v_mfma_f32_16x16x32_bf16 v[156:159], v[28:31], a[252:255], v[156:159]
v_rcp_f32 v164, v164
s_waitcnt lgkmcnt(2)
v_mfma_f32_16x16x32_bf16 v[96:99], v[16:19], v[224:227], v[96:99]
ds_read_b64_tr_b16 v[28:29], v5 offset:18432
v_add_f32 v166, 1.0, v166
v_mfma_f32_16x16x32_bf16 v[100:103], v[16:19], v[228:231], v[100:103]
ds_read_b64_tr_b16 v[30:31], v5 offset:19456
v_add_f32 v167, 1.0, v167
v_mfma_f32_16x16x32_bf16 v[104:107], v[16:19], v[232:235], v[104:107]
v_rcp_f32 v165, v165
v_mfma_f32_16x16x32_bf16 v[108:111], v[16:19], v[236:239], v[108:111]
v_rcp_f32 v166, v166
v_mfma_f32_16x16x32_bf16 v[112:115], v[20:23], v[224:227], v[112:115]
ds_read_b64_tr_b16 v[16:17], v4 offset:20480
v_mul_f32 v92, v92, v164
v_mfma_f32_16x16x32_bf16 v[116:119], v[20:23], v[228:231], v[116:119]
ds_read_b64_tr_b16 v[18:19], v4 offset:21504
v_mul_f32 v93, v93, v165
v_mfma_f32_16x16x32_bf16 v[120:123], v[20:23], v[232:235], v[120:123]
v_rcp_f32 v167, v167
v_mfma_f32_16x16x32_bf16 v[124:127], v[20:23], v[236:239], v[124:127]
v_mul_f32 v94, v94, v166
v_mul_f32 v95, v95, v167
s_waitcnt lgkmcnt(2)
v_mfma_f32_16x16x32_bf16 v[128:131], v[24:27], v[224:227], v[128:131]
ds_read_b64_tr_b16 v[20:21], v5 offset:20480
v_cvt_pk_bf16_f32 v174, v92, v93
v_mfma_f32_16x16x32_bf16 v[132:135], v[24:27], v[228:231], v[132:135]
ds_read_b64_tr_b16 v[22:23], v5 offset:21504
v_cvt_pk_bf16_f32 v175, v94, v95
v_mfma_f32_16x16x32_bf16 v[136:139], v[24:27], v[232:235], v[136:139]
buffer_store_dwordx4 v[172:175], v9, s[8:11], s42 offen offset:3072 sc1
v_mfma_f32_16x16x32_bf16 v[140:143], v[24:27], v[236:239], v[140:143]
v_mfma_f32_16x16x32_bf16 v[144:147], v[28:31], v[224:227], v[144:147]
ds_read_b64_tr_b16 v[24:25], v4 offset:22528
v_mfma_f32_16x16x32_bf16 v[148:151], v[28:31], v[228:231], v[148:151]
ds_read_b64_tr_b16 v[26:27], v4 offset:23552
v_mfma_f32_16x16x32_bf16 v[152:155], v[28:31], v[232:235], v[152:155]
v_mfma_f32_16x16x32_bf16 v[156:159], v[28:31], v[236:239], v[156:159]
s_waitcnt lgkmcnt(2)
v_mfma_f32_16x16x32_bf16 v[96:99], v[16:19], v[240:243], v[96:99]
ds_read_b64_tr_b16 v[28:29], v5 offset:22528
v_mfma_f32_16x16x32_bf16 v[100:103], v[16:19], v[244:247], v[100:103]
ds_read_b64_tr_b16 v[30:31], v5 offset:23552
v_mfma_f32_16x16x32_bf16 v[104:107], v[16:19], v[248:251], v[104:107]
v_mfma_f32_16x16x32_bf16 v[108:111], v[16:19], v[252:255], v[108:111]
v_add_u32 v13, 0x18000, v13
v_add_u32 v14, 0x18000, v14
v_mfma_f32_16x16x32_bf16 v[112:115], v[20:23], v[240:243], v[112:115]
s_waitcnt vmcnt(23)
s_barrier
ds_read_b64_tr_b16 v[16:17], v13 offset:0
v_mfma_f32_16x16x32_bf16 v[116:119], v[20:23], v[244:247], v[116:119]
ds_read_b64_tr_b16 v[18:19], v13 offset:2048
s_add_u32 m0, s31, 49152
s_add_u32 s40, s33, 2949120
v_mfma_f32_16x16x32_bf16 v[120:123], v[20:23], v[248:251], v[120:123]
buffer_load_dwordx4 v2, s[12:15], s40 offen lds
v_mfma_f32_16x16x32_bf16 v[124:127], v[20:23], v[252:255], v[124:127]
s_waitcnt lgkmcnt(2)
v_mfma_f32_16x16x32_bf16 v[128:131], v[24:27], v[240:243], v[128:131]
ds_read_b64_tr_b16 v[20:21], v13 offset:8
v_mfma_f32_16x16x32_bf16 v[132:135], v[24:27], v[244:247], v[132:135]
ds_read_b64_tr_b16 v[22:23], v13 offset:2056
v_mfma_f32_16x16x32_bf16 v[136:139], v[24:27], v[248:251], v[136:139]
v_mfma_f32_16x16x32_bf16 v[140:143], v[24:27], v[252:255], v[140:143]
v_mfma_f32_16x16x32_bf16 v[144:147], v[28:31], v[240:243], v[144:147]
ds_read_b64_tr_b16 v[24:25], v14 offset:0
v_mfma_f32_16x16x32_bf16 v[148:151], v[28:31], v[244:247], v[148:151]
ds_read_b64_tr_b16 v[26:27], v14 offset:2048
v_mfma_f32_16x16x32_bf16 v[152:155], v[28:31], v[248:251], v[152:155]
s_add_u32 m0, s31, 53248
s_add_u32 s40, s33, 3538944
v_mfma_f32_16x16x32_bf16 v[156:159], v[28:31], v[252:255], v[156:159]
mk_L_Q0:
s_waitcnt lgkmcnt(2)
v_mfma_f32_16x16x32_bf16 v[32:35], v[16:19], a[0:3], 0
ds_read_b64_tr_b16 v[28:29], v14 offset:8
v_mfma_f32_16x16x32_bf16 v[36:39], v[16:19], a[4:7], 0
ds_read_b64_tr_b16 v[30:31], v14 offset:2056
v_mfma_f32_16x16x32_bf16 v[40:43], v[16:19], a[8:11], 0
buffer_load_dwordx4 v2, s[12:15], s40 offen lds
v_mfma_f32_16x16x32_bf16 v[44:47], v[16:19], a[12:15], 0
v_mfma_f32_16x16x32_bf16 v[48:51], v[20:23], a[0:3], 0
ds_read_b64_tr_b16 v[16:17], v13 offset:4096
v_mfma_f32_16x16x32_bf16 v[52:55], v[20:23], a[4:7], 0
ds_read_b64_tr_b16 v[18:19], v13 offset:6144
v_mfma_f32_16x16x32_bf16 v[56:59], v[20:23], a[8:11], 0
v_mfma_f32_16x16x32_bf16 v[60:63], v[20:23], a[12:15], 0
s_waitcnt lgkmcnt(2)
v_mfma_f32_16x16x32_bf16 v[64:67], v[24:27], a[0:3], 0
ds_read_b64_tr_b16 v[20:21], v13 offset:4104
v_mul_f32 v160, v96, v96
v_mfma_f32_16x16x32_bf16 v[68:71], v[24:27], a[4:7], 0
ds_read_b64_tr_b16 v[22:23], v13 offset:6152
v_mul_f32 v161, v97, v97
v_mfma_f32_16x16x32_bf16 v[72:75], v[24:27], a[8:11], 0
s_add_u32 m0, s31, 57344
s_add_u32 s40, s33, 4128768
v_mul_f32 v162, v98, v98
v_mfma_f32_16x16x32_bf16 v[76:79], v[24:27], a[12:15], 0
v_mul_f32 v163, v99, v99
v_fma_f32 v160, v160, v12, s44
v_mfma_f32_16x16x32_bf16 v[80:83], v[28:31], a[0:3], 0
ds_read_b64_tr_b16 v[24:25], v14 offset:4096
v_fma_f32 v161, v161, v12, s44
v_mfma_f32_16x16x32_bf16 v[84:87], v[28:31], a[4:7], 0
ds_read_b64_tr_b16 v[26:27], v14 offset:6144
v_fma_f32 v162, v162, v12, s44
v_mfma_f32_16x16x32_bf16 v[88:91], v[28:31], a[8:11], 0
buffer_load_dwordx4 v2, s[12:15], s40 offen lds
v_mfma_f32_16x16x32_bf16 v[92:95], v[28:31], a[12:15], 0
v_fma_f32 v163, v163, v12, s44
v_mul_f32 v160, v96, v160
s_waitcnt lgkmcnt(2)
v_mfma_f32_16x16x32_bf16 v[32:35], v[16:19], a[16:19], v[32:35]
ds_read_b64_tr_b16 v[28:29], v14 offset:4104
v_mul_f32 v161, v97, v161
v_mfma_f32_16x16x32_bf16 v[36:39], v[16:19], a[20:23], v[36:39]
ds_read_b64_tr_b16 v[30:31], v14 offset:6152
v_mul_f32 v162, v98, v162
v_mfma_f32_16x16x32_bf16 v[40:43], v[16:19], a[24:27], v[40:43]
v_exp_f32 v160, v160
v_mfma_f32_16x16x32_bf16 v[44:47], v[16:19], a[28:31], v[44:47]
v_exp_f32 v161, v161
v_mfma_f32_16x16x32_bf16 v[48:51], v[20:23], a[16:19], v[48:51]
ds_read_b64_tr_b16 v[16:17], v13 offset:8192
v_mul_f32 v163, v99, v163
v_mfma_f32_16x16x32_bf16 v[52:55], v[20:23], a[20:23], v[52:55]
ds_read_b64_tr_b16 v[18:19], v13 offset:10240
v_mul_f32 v128, v96, v128
v_mfma_f32_16x16x32_bf16 v[56:59], v[20:23], a[24:27], v[56:59]
s_add_u32 m0, s31, 61440
s_add_u32 s40, s33, 4718592
v_exp_f32 v162, v162
v_mfma_f32_16x16x32_bf16 v[60:63], v[20:23], a[28:31], v[60:63]
v_exp_f32 v163, v163
s_waitcnt lgkmcnt(2)
v_mfma_f32_16x16x32_bf16 v[64:67], v[24:27], a[16:19], v[64:67]
ds_read_b64_tr_b16 v[20:21], v13 offset:8200
v_mul_f32 v129, v97, v129
v_mfma_f32_16x16x32_bf16 v[68:71], v[24:27], a[20:23], v[68:71]
ds_read_b64_tr_b16 v[22:23], v13 offset:10248
v_mul_f32 v130, v98, v130
v_mfma_f32_16x16x32_bf16 v[72:75], v[24:27], a[24:27], v[72:75]
buffer_load_dwordx4 v2, s[12:15], s40 offen lds
v_mfma_f32_16x16x32_bf16 v[76:79], v[24:27], a[28:31], v[76:79]
v_mul_f32 v131, v99, v131
v_add_f32 v160, 1.0, v160
v_mfma_f32_16x16x32_bf16 v[80:83], v[28:31], a[16:19], v[80:83]
ds_read_b64_tr_b16 v[24:25], v14 offset:8192
v_add_f32 v161, 1.0, v161
v_mfma_f32_16x16x32_bf16 v[84:87], v[28:31], a[20:23], v[84:87]
ds_read_b64_tr_b16 v[26:27], v14 offset:10240
v_add_f32 v162, 1.0, v162
v_mfma_f32_16x16x32_bf16 v[88:91], v[28:31], a[24:27], v[88:91]
v_rcp_f32 v160, v160
v_mfma_f32_16x16x32_bf16 v[92:95], v[28:31], a[28:31], v[92:95]
s_lshr_b32 s43, s2, 3
v_rcp_f32 v161, v161
s_waitcnt lgkmcnt(2)
v_mfma_f32_16x16x32_bf16 v[32:35], v[16:19], a[32:35], v[32:35]
ds_read_b64_tr_b16 v[28:29], v14 offset:8200
v_lshlrev_b32 v178, 7, v0
s_lshr_b32 s73, s43, 4
v_mfma_f32_16x16x32_bf16 v[36:39], v[16:19], a[36:39], v[36:39]
ds_read_b64_tr_b16 v[30:31], v14 offset:10248
s_and_b32 s43, s43, 15
v_add_f32 v163, 1.0, v163
v_mfma_f32_16x16x32_bf16 v[40:43], v[16:19], a[40:43], v[40:43]
s_lshl_b32 s43, s43, 13
s_and_b32 s72, s2, 7
v_rcp_f32 v162, v162
v_mfma_f32_16x16x32_bf16 v[44:47], v[16:19], a[44:47], v[44:47]
s_lshl_b32 s72, s72, 1
s_add_u32 s73, s73, s72
v_rcp_f32 v163, v163
v_mfma_f32_16x16x32_bf16 v[48:51], v[20:23], a[32:35], v[48:51]
ds_read_b64_tr_b16 v[16:17], v13 offset:12288
s_lshl_b32 s73, s73, 19
v_mul_f32 v128, v128, v160
v_mfma_f32_16x16x32_bf16 v[52:55], v[20:23], a[36:39], v[52:55]
ds_read_b64_tr_b16 v[18:19], v13 offset:14336
s_add_u32 s43, s43, s73
v_mul_f32 v129, v129, v161
v_mfma_f32_16x16x32_bf16 v[56:59], v[20:23], a[40:43], v[56:59]
s_add_u32 s43, s43, 393216
buffer_load_dword v8, v178, s[20:23], s43 offen
s_add_u32 s42, s37, 12288
v_mfma_f32_16x16x32_bf16 v[60:63], v[20:23], a[44:47], v[60:63]
v_mul_f32 v130, v130, v162
v_mul_f32 v131, v131, v163
s_waitcnt lgkmcnt(2)
v_mfma_f32_16x16x32_bf16 v[64:67], v[24:27], a[32:35], v[64:67]
ds_read_b64_tr_b16 v[20:21], v13 offset:12296
v_cvt_pk_bf16_f32 v168, v128, v129
v_mfma_f32_16x16x32_bf16 v[68:71], v[24:27], a[36:39], v[68:71]
ds_read_b64_tr_b16 v[22:23], v13 offset:14344
v_cvt_pk_bf16_f32 v169, v130, v131
v_mfma_f32_16x16x32_bf16 v[72:75], v[24:27], a[40:43], v[72:75]
v_mul_f32 v164, v112, v112
v_mul_f32 v165, v113, v113
v_mfma_f32_16x16x32_bf16 v[76:79], v[24:27], a[44:47], v[76:79]
v_mul_f32 v166, v114, v114
v_mul_f32 v167, v115, v115
v_mfma_f32_16x16x32_bf16 v[80:83], v[28:31], a[32:35], v[80:83]
ds_read_b64_tr_b16 v[24:25], v14 offset:12288
v_fma_f32 v164, v164, v12, s44
v_mfma_f32_16x16x32_bf16 v[84:87], v[28:31], a[36:39], v[84:87]
ds_read_b64_tr_b16 v[26:27], v14 offset:14336
v_fma_f32 v165, v165, v12, s44
v_mfma_f32_16x16x32_bf16 v[88:91], v[28:31], a[40:43], v[88:91]
v_fma_f32 v166, v166, v12, s44
v_fma_f32 v167, v167, v12, s44
v_mfma_f32_16x16x32_bf16 v[92:95], v[28:31], a[44:47], v[92:95]
v_mul_f32 v164, v112, v164
v_mul_f32 v165, v113, v165
s_waitcnt lgkmcnt(2)
v_mfma_f32_16x16x32_bf16 v[32:35], v[16:19], a[48:51], v[32:35]
ds_read_b64_tr_b16 v[28:29], v14 offset:12296
v_mul_f32 v166, v114, v166
v_mfma_f32_16x16x32_bf16 v[36:39], v[16:19], a[52:55], v[36:39]
ds_read_b64_tr_b16 v[30:31], v14 offset:14344
v_mul_f32 v167, v115, v167
v_mfma_f32_16x16x32_bf16 v[40:43], v[16:19], a[56:59], v[40:43]
v_exp_f32 v164, v164
v_mfma_f32_16x16x32_bf16 v[44:47], v[16:19], a[60:63], v[44:47]
v_exp_f32 v165, v165
v_mfma_f32_16x16x32_bf16 v[48:51], v[20:23], a[48:51], v[48:51]
ds_read_b64_tr_b16 v[16:17], v13 offset:16384
v_mul_f32 v144, v112, v144
v_mfma_f32_16x16x32_bf16 v[52:55], v[20:23], a[52:55], v[52:55]
ds_read_b64_tr_b16 v[18:19], v13 offset:18432
v_mul_f32 v145, v113, v145
v_mfma_f32_16x16x32_bf16 v[56:59], v[20:23], a[56:59], v[56:59]
v_exp_f32 v166, v166
v_mfma_f32_16x16x32_bf16 v[60:63], v[20:23], a[60:63], v[60:63]
buffer_load_dword v15, v178, s[24:27], s43 offen
s_waitcnt lgkmcnt(2)
v_mfma_f32_16x16x32_bf16 v[64:67], v[24:27], a[48:51], v[64:67]
ds_read_b64_tr_b16 v[20:21], v13 offset:16392
v_mul_f32 v146, v114, v146
v_mfma_f32_16x16x32_bf16 v[68:71], v[24:27], a[52:55], v[68:71]
ds_read_b64_tr_b16 v[22:23], v13 offset:18440
v_mul_f32 v147, v115, v147
v_mfma_f32_16x16x32_bf16 v[72:75], v[24:27], a[56:59], v[72:75]
v_exp_f32 v167, v167
v_mfma_f32_16x16x32_bf16 v[76:79], v[24:27], a[60:63], v[76:79]
v_add_f32 v164, 1.0, v164
v_add_f32 v165, 1.0, v165
v_mfma_f32_16x16x32_bf16 v[80:83], v[28:31], a[48:51], v[80:83]
ds_read_b64_tr_b16 v[24:25], v14 offset:16384
v_add_f32 v166, 1.0, v166
v_mfma_f32_16x16x32_bf16 v[84:87], v[28:31], a[52:55], v[84:87]
ds_read_b64_tr_b16 v[26:27], v14 offset:18432
v_add_f32 v167, 1.0, v167
v_mfma_f32_16x16x32_bf16 v[88:91], v[28:31], a[56:59], v[88:91]
v_rcp_f32 v164, v164
v_mfma_f32_16x16x32_bf16 v[92:95], v[28:31], a[60:63], v[92:95]
v_rcp_f32 v165, v165
s_waitcnt lgkmcnt(2)
v_mfma_f32_16x16x32_bf16 v[32:35], v[16:19], a[64:67], v[32:35]
ds_read_b64_tr_b16 v[28:29], v14 offset:16392
v_mul_f32 v144, v144, v164
v_mfma_f32_16x16x32_bf16 v[36:39], v[16:19], a[68:71], v[36:39]
ds_read_b64_tr_b16 v[30:31], v14 offset:18440
v_mul_f32 v145, v145, v165
v_mfma_f32_16x16x32_bf16 v[40:43], v[16:19], a[72:75], v[40:43]
v_rcp_f32 v166, v166
v_mfma_f32_16x16x32_bf16 v[44:47], v[16:19], a[76:79], v[44:47]
v_rcp_f32 v167, v167
v_mfma_f32_16x16x32_bf16 v[48:51], v[20:23], a[64:67], v[48:51]
ds_read_b64_tr_b16 v[16:17], v13 offset:20480
v_mul_f32 v146, v146, v166
v_mfma_f32_16x16x32_bf16 v[52:55], v[20:23], a[68:71], v[52:55]
ds_read_b64_tr_b16 v[18:19], v13 offset:22528
v_mul_f32 v147, v147, v167
v_mfma_f32_16x16x32_bf16 v[56:59], v[20:23], a[72:75], v[56:59]
v_cvt_pk_bf16_f32 v170, v144, v145
v_cvt_pk_bf16_f32 v171, v146, v147
v_mfma_f32_16x16x32_bf16 v[60:63], v[20:23], a[76:79], v[60:63]
buffer_store_dwordx4 v[168:171], v9, s[8:11], s42 offen offset:0 sc1
s_waitcnt lgkmcnt(2)
v_mfma_f32_16x16x32_bf16 v[64:67], v[24:27], a[64:67], v[64:67]
ds_read_b64_tr_b16 v[20:21], v13 offset:20488
v_mul_f32 v160, v100, v100
v_mfma_f32_16x16x32_bf16 v[68:71], v[24:27], a[68:71], v[68:71]
ds_read_b64_tr_b16 v[22:23], v13 offset:22536
v_mul_f32 v161, v101, v101
v_mfma_f32_16x16x32_bf16 v[72:75], v[24:27], a[72:75], v[72:75]
v_mul_f32 v162, v102, v102
v_mul_f32 v163, v103, v103
v_mfma_f32_16x16x32_bf16 v[76:79], v[24:27], a[76:79], v[76:79]
v_fma_f32 v160, v160, v12, s44
v_fma_f32 v161, v161, v12, s44
v_mfma_f32_16x16x32_bf16 v[80:83], v[28:31], a[64:67], v[80:83]
ds_read_b64_tr_b16 v[24:25], v14 offset:20480
v_fma_f32 v162, v162, v12, s44
v_mfma_f32_16x16x32_bf16 v[84:87], v[28:31], a[68:71], v[84:87]
ds_read_b64_tr_b16 v[26:27], v14 offset:22528
v_fma_f32 v163, v163, v12, s44
v_mfma_f32_16x16x32_bf16 v[88:91], v[28:31], a[72:75], v[88:91]
v_mul_f32 v160, v100, v160
v_mul_f32 v161, v101, v161
v_mfma_f32_16x16x32_bf16 v[92:95], v[28:31], a[76:79], v[92:95]
v_exp_f32 v160, v160
s_waitcnt lgkmcnt(2)
v_mfma_f32_16x16x32_bf16 v[32:35], v[16:19], a[80:83], v[32:35]
ds_read_b64_tr_b16 v[28:29], v14 offset:20488
v_mul_f32 v162, v102, v162
v_mfma_f32_16x16x32_bf16 v[36:39], v[16:19], a[84:87], v[36:39]
ds_read_b64_tr_b16 v[30:31], v14 offset:22536
v_mul_f32 v163, v103, v163
v_mfma_f32_16x16x32_bf16 v[40:43], v[16:19], a[88:91], v[40:43]
v_exp_f32 v161, v161
v_mfma_f32_16x16x32_bf16 v[44:47], v[16:19], a[92:95], v[44:47]
v_add_u32 v13, 0x6000, v13
v_add_u32 v14, 0x6000, v14
v_mfma_f32_16x16x32_bf16 v[48:51], v[20:23], a[80:83], v[48:51]
s_waitcnt vmcnt(22)
s_barrier
ds_read_b64_tr_b16 v[16:17], v13 offset:0
v_mfma_f32_16x16x32_bf16 v[52:55], v[20:23], a[84:87], v[52:55]
ds_read_b64_tr_b16 v[18:19], v13 offset:2048
s_add_u32 m0, s31, 73728
v_mul_f32 v132, v100, v132
v_mfma_f32_16x16x32_bf16 v[56:59], v[20:23], a[88:91], v[56:59]
s_add_u32 s40, s34, 128
buffer_load_dwordx4 v3, s[16:19], s40 offen lds
v_mfma_f32_16x16x32_bf16 v[60:63], v[20:23], a[92:95], v[60:63]
v_exp_f32 v162, v162
s_waitcnt lgkmcnt(2)
v_mfma_f32_16x16x32_bf16 v[64:67], v[24:27], a[80:83], v[64:67]
ds_read_b64_tr_b16 v[20:21], v13 offset:8
v_mul_f32 v133, v101, v133
v_mfma_f32_16x16x32_bf16 v[68:71], v[24:27], a[84:87], v[68:71]
ds_read_b64_tr_b16 v[22:23], v13 offset:2056
v_mul_f32 v134, v102, v134
v_mfma_f32_16x16x32_bf16 v[72:75], v[24:27], a[88:91], v[72:75]
v_exp_f32 v163, v163
v_mfma_f32_16x16x32_bf16 v[76:79], v[24:27], a[92:95], v[76:79]
v_mul_f32 v135, v103, v135
v_add_f32 v160, 1.0, v160
v_mfma_f32_16x16x32_bf16 v[80:83], v[28:31], a[80:83], v[80:83]
ds_read_b64_tr_b16 v[24:25], v14 offset:0
v_add_f32 v161, 1.0, v161
v_mfma_f32_16x16x32_bf16 v[84:87], v[28:31], a[84:87], v[84:87]
ds_read_b64_tr_b16 v[26:27], v14 offset:2048
v_add_f32 v162, 1.0, v162
v_mfma_f32_16x16x32_bf16 v[88:91], v[28:31], a[88:91], v[88:91]
s_add_u32 m0, s31, 77824
s_add_u32 s40, s34, 262272
v_rcp_f32 v160, v160
v_mfma_f32_16x16x32_bf16 v[92:95], v[28:31], a[92:95], v[92:95]
v_rcp_f32 v161, v161
s_waitcnt lgkmcnt(2)
v_mfma_f32_16x16x32_bf16 v[32:35], v[16:19], a[96:99], v[32:35]
ds_read_b64_tr_b16 v[28:29], v14 offset:8
v_add_f32 v163, 1.0, v163
v_mfma_f32_16x16x32_bf16 v[36:39], v[16:19], a[100:103], v[36:39]
ds_read_b64_tr_b16 v[30:31], v14 offset:2056
v_mul_f32 v132, v132, v160
v_mfma_f32_16x16x32_bf16 v[40:43], v[16:19], a[104:107], v[40:43]
buffer_load_dwordx4 v3, s[16:19], s40 offen lds
v_mfma_f32_16x16x32_bf16 v[44:47], v[16:19], a[108:111], v[44:47]
v_rcp_f32 v162, v162
v_mfma_f32_16x16x32_bf16 v[48:51], v[20:23], a[96:99], v[48:51]
ds_read_b64_tr_b16 v[16:17], v13 offset:4096
v_mul_f32 v133, v133, v161
v_mfma_f32_16x16x32_bf16 v[52:55], v[20:23], a[100:103], v[52:55]
ds_read_b64_tr_b16 v[18:19], v13 offset:6144
v_mul_f32 v134, v134, v162
v_mfma_f32_16x16x32_bf16 v[56:59], v[20:23], a[104:107], v[56:59]
v_rcp_f32 v163, v163
v_mfma_f32_16x16x32_bf16 v[60:63], v[20:23], a[108:111], v[60:63]
v_mul_f32 v135, v135, v163
v_cvt_pk_bf16_f32 v172, v132, v133
s_waitcnt lgkmcnt(2)
v_mfma_f32_16x16x32_bf16 v[64:67], v[24:27], a[96:99], v[64:67]
ds_read_b64_tr_b16 v[20:21], v13 offset:4104
v_cvt_pk_bf16_f32 v173, v134, v135
v_mfma_f32_16x16x32_bf16 v[68:71], v[24:27], a[100:103], v[68:71]
ds_read_b64_tr_b16 v[22:23], v13 offset:6152
v_mul_f32 v164, v116, v116
v_mfma_f32_16x16x32_bf16 v[72:75], v[24:27], a[104:107], v[72:75]
s_add_u32 m0, s31, 81920
s_add_u32 s40, s34, 524416
v_mul_f32 v165, v117, v117
v_mfma_f32_16x16x32_bf16 v[76:79], v[24:27], a[108:111], v[76:79]
v_mul_f32 v166, v118, v118
v_mul_f32 v167, v119, v119
v_mfma_f32_16x16x32_bf16 v[80:83], v[28:31], a[96:99], v[80:83]
ds_read_b64_tr_b16 v[24:25], v14 offset:4096
v_fma_f32 v164, v164, v12, s44
v_mfma_f32_16x16x32_bf16 v[84:87], v[28:31], a[100:103], v[84:87]
ds_read_b64_tr_b16 v[26:27], v14 offset:6144
v_fma_f32 v165, v165, v12, s44
v_mfma_f32_16x16x32_bf16 v[88:91], v[28:31], a[104:107], v[88:91]
buffer_load_dwordx4 v3, s[16:19], s40 offen lds
v_mfma_f32_16x16x32_bf16 v[92:95], v[28:31], a[108:111], v[92:95]
v_fma_f32 v166, v166, v12, s44
v_fma_f32 v167, v167, v12, s44
s_waitcnt lgkmcnt(2)
v_mfma_f32_16x16x32_bf16 v[32:35], v[16:19], a[112:115], v[32:35]
ds_read_b64_tr_b16 v[28:29], v14 offset:4104
v_mul_f32 v164, v116, v164
v_mfma_f32_16x16x32_bf16 v[36:39], v[16:19], a[116:119], v[36:39]
ds_read_b64_tr_b16 v[30:31], v14 offset:6152
v_mul_f32 v165, v117, v165
v_mfma_f32_16x16x32_bf16 v[40:43], v[16:19], a[120:123], v[40:43]
v_exp_f32 v164, v164
v_mfma_f32_16x16x32_bf16 v[44:47], v[16:19], a[124:127], v[44:47]
v_exp_f32 v165, v165
v_mfma_f32_16x16x32_bf16 v[48:51], v[20:23], a[112:115], v[48:51]
ds_read_b64_tr_b16 v[16:17], v13 offset:8192
v_mul_f32 v166, v118, v166
v_mfma_f32_16x16x32_bf16 v[52:55], v[20:23], a[116:119], v[52:55]
ds_read_b64_tr_b16 v[18:19], v13 offset:10240
v_mul_f32 v167, v119, v167
v_mfma_f32_16x16x32_bf16 v[56:59], v[20:23], a[120:123], v[56:59]
s_add_u32 m0, s31, 86016
s_add_u32 s40, s34, 786560
v_exp_f32 v166, v166
v_mfma_f32_16x16x32_bf16 v[60:63], v[20:23], a[124:127], v[60:63]
v_exp_f32 v167, v167
s_waitcnt lgkmcnt(2)
v_mfma_f32_16x16x32_bf16 v[64:67], v[24:27], a[112:115], v[64:67]
ds_read_b64_tr_b16 v[20:21], v13 offset:8200
v_mul_f32 v148, v116, v148
v_mfma_f32_16x16x32_bf16 v[68:71], v[24:27], a[116:119], v[68:71]
ds_read_b64_tr_b16 v[22:23], v13 offset:10248
v_mul_f32 v149, v117, v149
v_mfma_f32_16x16x32_bf16 v[72:75], v[24:27], a[120:123], v[72:75]
buffer_load_dwordx4 v3, s[16:19], s40 offen lds
v_mfma_f32_16x16x32_bf16 v[76:79], v[24:27], a[124:127], v[76:79]
v_mul_f32 v150, v118, v150
v_mul_f32 v151, v119, v151
v_mfma_f32_16x16x32_bf16 v[80:83], v[28:31], a[112:115], v[80:83]
ds_read_b64_tr_b16 v[24:25], v14 offset:8192
v_add_f32 v164, 1.0, v164
v_mfma_f32_16x16x32_bf16 v[84:87], v[28:31], a[116:119], v[84:87]
ds_read_b64_tr_b16 v[26:27], v14 offset:10240
v_add_f32 v165, 1.0, v165
v_mfma_f32_16x16x32_bf16 v[88:91], v[28:31], a[120:123], v[88:91]
v_rcp_f32 v164, v164
v_mfma_f32_16x16x32_bf16 v[92:95], v[28:31], a[124:127], v[92:95]
v_rcp_f32 v165, v165
s_waitcnt lgkmcnt(2)
v_mfma_f32_16x16x32_bf16 v[32:35], v[16:19], a[128:131], v[32:35]
ds_read_b64_tr_b16 v[28:29], v14 offset:8200
v_add_f32 v166, 1.0, v166
v_mfma_f32_16x16x32_bf16 v[36:39], v[16:19], a[132:135], v[36:39]
ds_read_b64_tr_b16 v[30:31], v14 offset:10248
v_add_f32 v167, 1.0, v167
v_mfma_f32_16x16x32_bf16 v[40:43], v[16:19], a[136:139], v[40:43]
s_add_u32 m0, s31, 90112
s_add_u32 s40, s34, 1048704
v_rcp_f32 v166, v166
v_mfma_f32_16x16x32_bf16 v[44:47], v[16:19], a[140:143], v[44:47]
v_rcp_f32 v167, v167
v_mfma_f32_16x16x32_bf16 v[48:51], v[20:23], a[128:131], v[48:51]
ds_read_b64_tr_b16 v[16:17], v13 offset:12288
v_mul_f32 v148, v148, v164
v_mfma_f32_16x16x32_bf16 v[52:55], v[20:23], a[132:135], v[52:55]
ds_read_b64_tr_b16 v[18:19], v13 offset:14336
v_mul_f32 v149, v149, v165
v_mfma_f32_16x16x32_bf16 v[56:59], v[20:23], a[136:139], v[56:59]
buffer_load_dwordx4 v3, s[16:19], s40 offen lds
v_mfma_f32_16x16x32_bf16 v[60:63], v[20:23], a[140:143], v[60:63]
v_mul_f32 v150, v150, v166
v_mul_f32 v151, v151, v167
s_waitcnt lgkmcnt(2)
v_mfma_f32_16x16x32_bf16 v[64:67], v[24:27], a[128:131], v[64:67]
ds_read_b64_tr_b16 v[20:21], v13 offset:12296
v_cvt_pk_bf16_f32 v174, v148, v149
v_mfma_f32_16x16x32_bf16 v[68:71], v[24:27], a[132:135], v[68:71]
ds_read_b64_tr_b16 v[22:23], v13 offset:14344
v_cvt_pk_bf16_f32 v175, v150, v151
v_mfma_f32_16x16x32_bf16 v[72:75], v[24:27], a[136:139], v[72:75]
buffer_store_dwordx4 v[172:175], v9, s[8:11], s42 offen offset:1024 sc1
v_mfma_f32_16x16x32_bf16 v[76:79], v[24:27], a[140:143], v[76:79]
v_mul_f32 v160, v104, v104
v_mul_f32 v161, v105, v105
v_mfma_f32_16x16x32_bf16 v[80:83], v[28:31], a[128:131], v[80:83]
ds_read_b64_tr_b16 v[24:25], v14 offset:12288
v_mul_f32 v162, v106, v106
v_mfma_f32_16x16x32_bf16 v[84:87], v[28:31], a[132:135], v[84:87]
ds_read_b64_tr_b16 v[26:27], v14 offset:14336
v_mul_f32 v163, v107, v107
v_mfma_f32_16x16x32_bf16 v[88:91], v[28:31], a[136:139], v[88:91]
s_add_u32 m0, s31, 94208
s_add_u32 s40, s34, 1310848
v_fma_f32 v160, v160, v12, s44
v_mfma_f32_16x16x32_bf16 v[92:95], v[28:31], a[140:143], v[92:95]
v_fma_f32 v161, v161, v12, s44
v_fma_f32 v162, v162, v12, s44
s_waitcnt lgkmcnt(2)
v_mfma_f32_16x16x32_bf16 v[32:35], v[16:19], a[144:147], v[32:35]
ds_read_b64_tr_b16 v[28:29], v14 offset:12296
v_fma_f32 v163, v163, v12, s44
v_mfma_f32_16x16x32_bf16 v[36:39], v[16:19], a[148:151], v[36:39]
ds_read_b64_tr_b16 v[30:31], v14 offset:14344
v_mul_f32 v160, v104, v160
v_mfma_f32_16x16x32_bf16 v[40:43], v[16:19], a[152:155], v[40:43]
buffer_load_dwordx4 v3, s[16:19], s40 offen lds
v_mfma_f32_16x16x32_bf16 v[44:47], v[16:19], a[156:159], v[44:47]
v_exp_f32 v160, v160
v_mfma_f32_16x16x32_bf16 v[48:51], v[20:23], a[144:147], v[48:51]
ds_read_b64_tr_b16 v[16:17], v13 offset:16384
v_mul_f32 v161, v105, v161
v_mfma_f32_16x16x32_bf16 v[52:55], v[20:23], a[148:151], v[52:55]
ds_read_b64_tr_b16 v[18:19], v13 offset:18432
v_mul_f32 v162, v106, v162
v_mfma_f32_16x16x32_bf16 v[56:59], v[20:23], a[152:155], v[56:59]
v_exp_f32 v161, v161
v_mfma_f32_16x16x32_bf16 v[60:63], v[20:23], a[156:159], v[60:63]
v_exp_f32 v162, v162
s_waitcnt lgkmcnt(2)
v_mfma_f32_16x16x32_bf16 v[64:67], v[24:27], a[144:147], v[64:67]
ds_read_b64_tr_b16 v[20:21], v13 offset:16392
v_mul_f32 v163, v107, v163
v_mfma_f32_16x16x32_bf16 v[68:71], v[24:27], a[148:151], v[68:71]
ds_read_b64_tr_b16 v[22:23], v13 offset:18440
v_mul_f32 v136, v104, v136
v_mfma_f32_16x16x32_bf16 v[72:75], v[24:27], a[152:155], v[72:75]
v_exp_f32 v163, v163
v_mfma_f32_16x16x32_bf16 v[76:79], v[24:27], a[156:159], v[76:79]
v_mul_f32 v137, v105, v137
v_mul_f32 v138, v106, v138
v_mfma_f32_16x16x32_bf16 v[80:83], v[28:31], a[144:147], v[80:83]
ds_read_b64_tr_b16 v[24:25], v14 offset:16384
v_mul_f32 v139, v107, v139
v_mfma_f32_16x16x32_bf16 v[84:87], v[28:31], a[148:151], v[84:87]
ds_read_b64_tr_b16 v[26:27], v14 offset:18432
v_add_f32 v160, 1.0, v160
v_mfma_f32_16x16x32_bf16 v[88:91], v[28:31], a[152:155], v[88:91]
v_rcp_f32 v160, v160
v_mfma_f32_16x16x32_bf16 v[92:95], v[28:31], a[156:159], v[92:95]
v_add_f32 v161, 1.0, v161
v_add_f32 v162, 1.0, v162
s_waitcnt lgkmcnt(2)
v_mfma_f32_16x16x32_bf16 v[32:35], v[16:19], a[160:163], v[32:35]
ds_read_b64_tr_b16 v[28:29], v14 offset:16392
v_add_f32 v163, 1.0, v163
v_mfma_f32_16x16x32_bf16 v[36:39], v[16:19], a[164:167], v[36:39]
ds_read_b64_tr_b16 v[30:31], v14 offset:18440
v_mul_f32 v136, v136, v160
v_mfma_f32_16x16x32_bf16 v[40:43], v[16:19], a[168:171], v[40:43]
v_rcp_f32 v161, v161
v_mfma_f32_16x16x32_bf16 v[44:47], v[16:19], a[172:175], v[44:47]
v_rcp_f32 v162, v162
v_mfma_f32_16x16x32_bf16 v[48:51], v[20:23], a[160:163], v[48:51]
ds_read_b64_tr_b16 v[16:17], v13 offset:20480
v_mul_f32 v137, v137, v161
v_mfma_f32_16x16x32_bf16 v[52:55], v[20:23], a[164:167], v[52:55]
ds_read_b64_tr_b16 v[18:19], v13 offset:22528
v_mul_f32 v138, v138, v162
v_mfma_f32_16x16x32_bf16 v[56:59], v[20:23], a[168:171], v[56:59]
v_rcp_f32 v163, v163
v_mfma_f32_16x16x32_bf16 v[60:63], v[20:23], a[172:175], v[60:63]
v_mul_f32 v139, v139, v163
v_cvt_pk_bf16_f32 v168, v136, v137
s_waitcnt lgkmcnt(2)
v_mfma_f32_16x16x32_bf16 v[64:67], v[24:27], a[160:163], v[64:67]
ds_read_b64_tr_b16 v[20:21], v13 offset:20488
v_cvt_pk_bf16_f32 v169, v138, v139
v_mfma_f32_16x16x32_bf16 v[68:71], v[24:27], a[164:167], v[68:71]
ds_read_b64_tr_b16 v[22:23], v13 offset:22536
v_mul_f32 v164, v120, v120
v_mfma_f32_16x16x32_bf16 v[72:75], v[24:27], a[168:171], v[72:75]
v_mul_f32 v165, v121, v121
v_mul_f32 v166, v122, v122
v_mfma_f32_16x16x32_bf16 v[76:79], v[24:27], a[172:175], v[76:79]
v_mul_f32 v167, v123, v123
v_fma_f32 v164, v164, v12, s44
v_mfma_f32_16x16x32_bf16 v[80:83], v[28:31], a[160:163], v[80:83]
ds_read_b64_tr_b16 v[24:25], v14 offset:20480
v_fma_f32 v165, v165, v12, s44
v_mfma_f32_16x16x32_bf16 v[84:87], v[28:31], a[164:167], v[84:87]
ds_read_b64_tr_b16 v[26:27], v14 offset:22528
v_fma_f32 v166, v166, v12, s44
v_mfma_f32_16x16x32_bf16 v[88:91], v[28:31], a[168:171], v[88:91]
v_fma_f32 v167, v167, v12, s44
v_mul_f32 v164, v120, v164
v_mfma_f32_16x16x32_bf16 v[92:95], v[28:31], a[172:175], v[92:95]
v_exp_f32 v164, v164
s_waitcnt lgkmcnt(2)
v_mfma_f32_16x16x32_bf16 v[32:35], v[16:19], a[176:179], v[32:35]
ds_read_b64_tr_b16 v[28:29], v14 offset:20488
v_mul_f32 v165, v121, v165
v_mfma_f32_16x16x32_bf16 v[36:39], v[16:19], a[180:183], v[36:39]
ds_read_b64_tr_b16 v[30:31], v14 offset:22536
v_mul_f32 v166, v122, v166
v_mfma_f32_16x16x32_bf16 v[40:43], v[16:19], a[184:187], v[40:43]
v_exp_f32 v165, v165
v_mfma_f32_16x16x32_bf16 v[44:47], v[16:19], a[188:191], v[44:47]
v_add_u32 v13, 0xfffe2000, v13
v_add_u32 v14, 0xfffe2000, v14
v_mfma_f32_16x16x32_bf16 v[48:51], v[20:23], a[176:179], v[48:51]
s_waitcnt vmcnt(21)
s_barrier
ds_read_b64_tr_b16 v[16:17], v13 offset:0
v_mfma_f32_16x16x32_bf16 v[52:55], v[20:23], a[180:183], v[52:55]
ds_read_b64_tr_b16 v[18:19], v13 offset:2048
s_add_u32 m0, s31, 98304
v_mul_f32 v167, v123, v167
v_mfma_f32_16x16x32_bf16 v[56:59], v[20:23], a[184:187], v[56:59]
s_add_u32 s40, s34, 1572992
buffer_load_dwordx4 v3, s[16:19], s40 offen lds
v_mfma_f32_16x16x32_bf16 v[60:63], v[20:23], a[188:191], v[60:63]
v_exp_f32 v166, v166
s_waitcnt lgkmcnt(2)
v_mfma_f32_16x16x32_bf16 v[64:67], v[24:27], a[176:179], v[64:67]
ds_read_b64_tr_b16 v[20:21], v13 offset:8
v_mul_f32 v152, v120, v152
v_mfma_f32_16x16x32_bf16 v[68:71], v[24:27], a[180:183], v[68:71]
ds_read_b64_tr_b16 v[22:23], v13 offset:2056
v_mul_f32 v153, v121, v153
v_mfma_f32_16x16x32_bf16 v[72:75], v[24:27], a[184:187], v[72:75]
v_exp_f32 v167, v167
v_mfma_f32_16x16x32_bf16 v[76:79], v[24:27], a[188:191], v[76:79]
v_mul_f32 v154, v122, v154
v_mul_f32 v155, v123, v155
v_mfma_f32_16x16x32_bf16 v[80:83], v[28:31], a[176:179], v[80:83]
ds_read_b64_tr_b16 v[24:25], v14 offset:0
v_add_f32 v164, 1.0, v164
v_mfma_f32_16x16x32_bf16 v[84:87], v[28:31], a[180:183], v[84:87]
ds_read_b64_tr_b16 v[26:27], v14 offset:2048
v_add_f32 v165, 1.0, v165
v_mfma_f32_16x16x32_bf16 v[88:91], v[28:31], a[184:187], v[88:91]
s_add_u32 m0, s31, 102400
s_add_u32 s40, s34, 1835136
v_rcp_f32 v164, v164
v_mfma_f32_16x16x32_bf16 v[92:95], v[28:31], a[188:191], v[92:95]
v_rcp_f32 v165, v165
s_waitcnt lgkmcnt(2)
v_mfma_f32_16x16x32_bf16 v[32:35], v[16:19], a[192:195], v[32:35]
ds_read_b64_tr_b16 v[28:29], v14 offset:8
v_add_f32 v166, 1.0, v166
v_mfma_f32_16x16x32_bf16 v[36:39], v[16:19], a[196:199], v[36:39]
ds_read_b64_tr_b16 v[30:31], v14 offset:2056
v_add_f32 v167, 1.0, v167
v_mfma_f32_16x16x32_bf16 v[40:43], v[16:19], a[200:203], v[40:43]
buffer_load_dwordx4 v3, s[16:19], s40 offen lds
v_mfma_f32_16x16x32_bf16 v[44:47], v[16:19], a[204:207], v[44:47]
v_rcp_f32 v166, v166
v_mfma_f32_16x16x32_bf16 v[48:51], v[20:23], a[192:195], v[48:51]
ds_read_b64_tr_b16 v[16:17], v13 offset:4096
v_mul_f32 v152, v152, v164
v_mfma_f32_16x16x32_bf16 v[52:55], v[20:23], a[196:199], v[52:55]
ds_read_b64_tr_b16 v[18:19], v13 offset:6144
v_mul_f32 v153, v153, v165
v_mfma_f32_16x16x32_bf16 v[56:59], v[20:23], a[200:203], v[56:59]
v_rcp_f32 v167, v167
v_mfma_f32_16x16x32_bf16 v[60:63], v[20:23], a[204:207], v[60:63]
v_mul_f32 v154, v154, v166
v_mul_f32 v155, v155, v167
s_waitcnt lgkmcnt(2)
v_mfma_f32_16x16x32_bf16 v[64:67], v[24:27], a[192:195], v[64:67]
ds_read_b64_tr_b16 v[20:21], v13 offset:4104
v_cvt_pk_bf16_f32 v170, v152, v153
v_mfma_f32_16x16x32_bf16 v[68:71], v[24:27], a[196:199], v[68:71]
ds_read_b64_tr_b16 v[22:23], v13 offset:6152
v_cvt_pk_bf16_f32 v171, v154, v155
v_mfma_f32_16x16x32_bf16 v[72:75], v[24:27], a[200:203], v[72:75]
s_add_u32 m0, s31, 106496
s_add_u32 s40, s34, 2097280
buffer_store_dwordx4 v[168:171], v9, s[8:11], s42 offen offset:2048 sc1
v_mfma_f32_16x16x32_bf16 v[76:79], v[24:27], a[204:207], v[76:79]
v_mul_f32 v160, v108, v108
v_mul_f32 v161, v109, v109
v_mfma_f32_16x16x32_bf16 v[80:83], v[28:31], a[192:195], v[80:83]
ds_read_b64_tr_b16 v[24:25], v14 offset:4096
v_mul_f32 v162, v110, v110
v_mfma_f32_16x16x32_bf16 v[84:87], v[28:31], a[196:199], v[84:87]
ds_read_b64_tr_b16 v[26:27], v14 offset:6144
v_mul_f32 v163, v111, v111
v_mfma_f32_16x16x32_bf16 v[88:91], v[28:31], a[200:203], v[88:91]
buffer_load_dwordx4 v3, s[16:19], s40 offen lds
v_mfma_f32_16x16x32_bf16 v[92:95], v[28:31], a[204:207], v[92:95]
v_fma_f32 v160, v160, v12, s44
v_fma_f32 v161, v161, v12, s44
s_waitcnt lgkmcnt(2)
v_mfma_f32_16x16x32_bf16 v[32:35], v[16:19], a[208:211], v[32:35]
ds_read_b64_tr_b16 v[28:29], v14 offset:4104
v_fma_f32 v162, v162, v12, s44
v_mfma_f32_16x16x32_bf16 v[36:39], v[16:19], a[212:215], v[36:39]
ds_read_b64_tr_b16 v[30:31], v14 offset:6152
v_fma_f32 v163, v163, v12, s44
v_mfma_f32_16x16x32_bf16 v[40:43], v[16:19], a[216:219], v[40:43]
v_mul_f32 v160, v108, v160
v_mul_f32 v161, v109, v161
v_mfma_f32_16x16x32_bf16 v[44:47], v[16:19], a[220:223], v[44:47]
v_exp_f32 v160, v160
v_mfma_f32_16x16x32_bf16 v[48:51], v[20:23], a[208:211], v[48:51]
ds_read_b64_tr_b16 v[16:17], v13 offset:8192
v_mul_f32 v162, v110, v162
v_mfma_f32_16x16x32_bf16 v[52:55], v[20:23], a[212:215], v[52:55]
ds_read_b64_tr_b16 v[18:19], v13 offset:10240
v_mul_f32 v163, v111, v163
v_mfma_f32_16x16x32_bf16 v[56:59], v[20:23], a[216:219], v[56:59]
s_add_u32 m0, s31, 110592
s_add_u32 s40, s34, 2359424
v_exp_f32 v161, v161
v_mfma_f32_16x16x32_bf16 v[60:63], v[20:23], a[220:223], v[60:63]
v_exp_f32 v162, v162
s_waitcnt lgkmcnt(2)
v_mfma_f32_16x16x32_bf16 v[64:67], v[24:27], a[208:211], v[64:67]
ds_read_b64_tr_b16 v[20:21], v13 offset:8200
v_mul_f32 v140, v108, v140
v_mfma_f32_16x16x32_bf16 v[68:71], v[24:27], a[212:215], v[68:71]
ds_read_b64_tr_b16 v[22:23], v13 offset:10248
v_mul_f32 v141, v109, v141
v_mfma_f32_16x16x32_bf16 v[72:75], v[24:27], a[216:219], v[72:75]
buffer_load_dwordx4 v3, s[16:19], s40 offen lds
v_mfma_f32_16x16x32_bf16 v[76:79], v[24:27], a[220:223], v[76:79]
v_exp_f32 v163, v163
v_mfma_f32_16x16x32_bf16 v[80:83], v[28:31], a[208:211], v[80:83]
ds_read_b64_tr_b16 v[24:25], v14 offset:8192
v_mul_f32 v142, v110, v142
v_mfma_f32_16x16x32_bf16 v[84:87], v[28:31], a[212:215], v[84:87]
ds_read_b64_tr_b16 v[26:27], v14 offset:10240
v_mul_f32 v143, v111, v143
v_mfma_f32_16x16x32_bf16 v[88:91], v[28:31], a[216:219], v[88:91]
v_add_f32 v160, 1.0, v160
v_add_f32 v161, 1.0, v161
v_mfma_f32_16x16x32_bf16 v[92:95], v[28:31], a[220:223], v[92:95]
v_rcp_f32 v160, v160
s_waitcnt lgkmcnt(2)
v_mfma_f32_16x16x32_bf16 v[32:35], v[16:19], a[224:227], v[32:35]
ds_read_b64_tr_b16 v[28:29], v14 offset:8200
v_add_f32 v162, 1.0, v162
v_mfma_f32_16x16x32_bf16 v[36:39], v[16:19], a[228:231], v[36:39]
ds_read_b64_tr_b16 v[30:31], v14 offset:10248
v_add_f32 v163, 1.0, v163
v_mfma_f32_16x16x32_bf16 v[40:43], v[16:19], a[232:235], v[40:43]
s_add_u32 m0, s31, 114688
s_add_u32 s40, s34, 2621568
v_rcp_f32 v161, v161
v_mfma_f32_16x16x32_bf16 v[44:47], v[16:19], a[236:239], v[44:47]
v_rcp_f32 v162, v162
v_mfma_f32_16x16x32_bf16 v[48:51], v[20:23], a[224:227], v[48:51]
ds_read_b64_tr_b16 v[16:17], v13 offset:12288
v_mul_f32 v140, v140, v160
v_mfma_f32_16x16x32_bf16 v[52:55], v[20:23], a[228:231], v[52:55]
ds_read_b64_tr_b16 v[18:19], v13 offset:14336
v_mul_f32 v141, v141, v161
v_mfma_f32_16x16x32_bf16 v[56:59], v[20:23], a[232:235], v[56:59]
buffer_load_dwordx4 v3, s[16:19], s40 offen lds
v_mfma_f32_16x16x32_bf16 v[60:63], v[20:23], a[236:239], v[60:63]
v_rcp_f32 v163, v163
s_waitcnt lgkmcnt(2)
v_mfma_f32_16x16x32_bf16 v[64:67], v[24:27], a[224:227], v[64:67]
ds_read_b64_tr_b16 v[20:21], v13 offset:12296
v_mul_f32 v142, v142, v162
v_mfma_f32_16x16x32_bf16 v[68:71], v[24:27], a[228:231], v[68:71]
ds_read_b64_tr_b16 v[22:23], v13 offset:14344
v_mul_f32 v143, v143, v163
v_mfma_f32_16x16x32_bf16 v[72:75], v[24:27], a[232:235], v[72:75]
v_cvt_pk_bf16_f32 v172, v140, v141
v_cvt_pk_bf16_f32 v173, v142, v143
v_mfma_f32_16x16x32_bf16 v[76:79], v[24:27], a[236:239], v[76:79]
v_mul_f32 v164, v124, v124
v_mul_f32 v165, v125, v125
v_mfma_f32_16x16x32_bf16 v[80:83], v[28:31], a[224:227], v[80:83]
ds_read_b64_tr_b16 v[24:25], v14 offset:12288
v_mul_f32 v166, v126, v126
v_mfma_f32_16x16x32_bf16 v[84:87], v[28:31], a[228:231], v[84:87]
ds_read_b64_tr_b16 v[26:27], v14 offset:14336
v_mul_f32 v167, v127, v127
v_mfma_f32_16x16x32_bf16 v[88:91], v[28:31], a[232:235], v[88:91]
s_add_u32 m0, s31, 118784
s_add_u32 s40, s34, 2883712
v_fma_f32 v164, v164, v12, s44
v_mfma_f32_16x16x32_bf16 v[92:95], v[28:31], a[236:239], v[92:95]
v_fma_f32 v165, v165, v12, s44
v_fma_f32 v166, v166, v12, s44
s_waitcnt lgkmcnt(2)
v_mfma_f32_16x16x32_bf16 v[32:35], v[16:19], a[240:243], v[32:35]
ds_read_b64_tr_b16 v[28:29], v14 offset:12296
v_fma_f32 v167, v167, v12, s44
v_mfma_f32_16x16x32_bf16 v[36:39], v[16:19], a[244:247], v[36:39]
ds_read_b64_tr_b16 v[30:31], v14 offset:14344
v_mul_f32 v164, v124, v164
v_mfma_f32_16x16x32_bf16 v[40:43], v[16:19], a[248:251], v[40:43]
buffer_load_dwordx4 v3, s[16:19], s40 offen lds
v_mfma_f32_16x16x32_bf16 v[44:47], v[16:19], a[252:255], v[44:47]
v_exp_f32 v164, v164
v_mfma_f32_16x16x32_bf16 v[48:51], v[20:23], a[240:243], v[48:51]
ds_read_b64_tr_b16 v[16:17], v13 offset:16384
v_mul_f32 v165, v125, v165
v_mfma_f32_16x16x32_bf16 v[52:55], v[20:23], a[244:247], v[52:55]
ds_read_b64_tr_b16 v[18:19], v13 offset:18432
v_mul_f32 v166, v126, v166
v_mfma_f32_16x16x32_bf16 v[56:59], v[20:23], a[248:251], v[56:59]
v_exp_f32 v165, v165
v_mfma_f32_16x16x32_bf16 v[60:63], v[20:23], a[252:255], v[60:63]
v_exp_f32 v166, v166
s_waitcnt lgkmcnt(2)
v_mfma_f32_16x16x32_bf16 v[64:67], v[24:27], a[240:243], v[64:67]
ds_read_b64_tr_b16 v[20:21], v13 offset:16392
v_mul_f32 v167, v127, v167
v_mfma_f32_16x16x32_bf16 v[68:71], v[24:27], a[244:247], v[68:71]
ds_read_b64_tr_b16 v[22:23], v13 offset:18440
v_mul_f32 v156, v124, v156
v_mfma_f32_16x16x32_bf16 v[72:75], v[24:27], a[248:251], v[72:75]
v_exp_f32 v167, v167
v_mfma_f32_16x16x32_bf16 v[76:79], v[24:27], a[252:255], v[76:79]
v_mul_f32 v157, v125, v157
v_mul_f32 v158, v126, v158
v_mfma_f32_16x16x32_bf16 v[80:83], v[28:31], a[240:243], v[80:83]
ds_read_b64_tr_b16 v[24:25], v14 offset:16384
v_mul_f32 v159, v127, v159
v_mfma_f32_16x16x32_bf16 v[84:87], v[28:31], a[244:247], v[84:87]
ds_read_b64_tr_b16 v[26:27], v14 offset:18432
v_add_f32 v164, 1.0, v164
v_mfma_f32_16x16x32_bf16 v[88:91], v[28:31], a[248:251], v[88:91]
v_rcp_f32 v164, v164
v_mfma_f32_16x16x32_bf16 v[92:95], v[28:31], a[252:255], v[92:95]
v_add_f32 v165, 1.0, v165
v_add_f32 v166, 1.0, v166
s_waitcnt lgkmcnt(2)
v_mfma_f32_16x16x32_bf16 v[32:35], v[16:19], v[224:227], v[32:35]
ds_read_b64_tr_b16 v[28:29], v14 offset:16392
v_add_f32 v167, 1.0, v167
v_mfma_f32_16x16x32_bf16 v[36:39], v[16:19], v[228:231], v[36:39]
ds_read_b64_tr_b16 v[30:31], v14 offset:18440
v_mul_f32 v156, v156, v164
v_mfma_f32_16x16x32_bf16 v[40:43], v[16:19], v[232:235], v[40:43]
v_rcp_f32 v165, v165
v_mfma_f32_16x16x32_bf16 v[44:47], v[16:19], v[236:239], v[44:47]
v_rcp_f32 v166, v166
v_mfma_f32_16x16x32_bf16 v[48:51], v[20:23], v[224:227], v[48:51]
ds_read_b64_tr_b16 v[16:17], v13 offset:20480
v_mul_f32 v157, v157, v165
v_mfma_f32_16x16x32_bf16 v[52:55], v[20:23], v[228:231], v[52:55]
ds_read_b64_tr_b16 v[18:19], v13 offset:22528
v_mul_f32 v158, v158, v166
v_mfma_f32_16x16x32_bf16 v[56:59], v[20:23], v[232:235], v[56:59]
v_rcp_f32 v167, v167
v_mfma_f32_16x16x32_bf16 v[60:63], v[20:23], v[236:239], v[60:63]
v_mul_f32 v159, v159, v167
v_cvt_pk_bf16_f32 v174, v156, v157
s_waitcnt lgkmcnt(2)
v_mfma_f32_16x16x32_bf16 v[64:67], v[24:27], v[224:227], v[64:67]
ds_read_b64_tr_b16 v[20:21], v13 offset:20488
v_cvt_pk_bf16_f32 v175, v158, v159
v_mfma_f32_16x16x32_bf16 v[68:71], v[24:27], v[228:231], v[68:71]
ds_read_b64_tr_b16 v[22:23], v13 offset:22536
v_mfma_f32_16x16x32_bf16 v[72:75], v[24:27], v[232:235], v[72:75]
buffer_store_dwordx4 v[172:175], v9, s[8:11], s42 offen offset:3072 sc1
v_mfma_f32_16x16x32_bf16 v[76:79], v[24:27], v[236:239], v[76:79]
v_mfma_f32_16x16x32_bf16 v[80:83], v[28:31], v[224:227], v[80:83]
ds_read_b64_tr_b16 v[24:25], v14 offset:20480
v_mfma_f32_16x16x32_bf16 v[84:87], v[28:31], v[228:231], v[84:87]
ds_read_b64_tr_b16 v[26:27], v14 offset:22528
v_mfma_f32_16x16x32_bf16 v[88:91], v[28:31], v[232:235], v[88:91]
v_mfma_f32_16x16x32_bf16 v[92:95], v[28:31], v[236:239], v[92:95]
s_waitcnt lgkmcnt(2)
v_mfma_f32_16x16x32_bf16 v[32:35], v[16:19], v[240:243], v[32:35]
ds_read_b64_tr_b16 v[28:29], v14 offset:20488
v_mfma_f32_16x16x32_bf16 v[36:39], v[16:19], v[244:247], v[36:39]
ds_read_b64_tr_b16 v[30:31], v14 offset:22536
v_mfma_f32_16x16x32_bf16 v[40:43], v[16:19], v[248:251], v[40:43]
v_mfma_f32_16x16x32_bf16 v[44:47], v[16:19], v[252:255], v[44:47]
v_add_u32 v6, 0x6000, v6
v_mfma_f32_16x16x32_bf16 v[48:51], v[20:23], v[240:243], v[48:51]
s_waitcnt vmcnt(23)
s_barrier
ds_read_b64_tr_b16 v[16:17], v6 offset:0
v_mfma_f32_16x16x32_bf16 v[52:55], v[20:23], v[244:247], v[52:55]
ds_read_b64_tr_b16 v[18:19], v6 offset:512
s_add_u32 m0, s31, 122880
s_add_u32 s40, s34, 3145856
v_mfma_f32_16x16x32_bf16 v[56:59], v[20:23], v[248:251], v[56:59]
buffer_load_dwordx4 v3, s[16:19], s40 offen lds
v_mfma_f32_16x16x32_bf16 v[60:63], v[20:23], v[252:255], v[60:63]
s_waitcnt lgkmcnt(2)
v_mfma_f32_16x16x32_bf16 v[64:67], v[24:27], v[240:243], v[64:67]
ds_read_b64_tr_b16 v[20:21], v6 offset:2048
v_mfma_f32_16x16x32_bf16 v[68:71], v[24:27], v[244:247], v[68:71]
ds_read_b64_tr_b16 v[22:23], v6 offset:2560
v_mfma_f32_16x16x32_bf16 v[72:75], v[24:27], v[248:251], v[72:75]
v_mfma_f32_16x16x32_bf16 v[76:79], v[24:27], v[252:255], v[76:79]
v_mfma_f32_16x16x32_bf16 v[80:83], v[28:31], v[240:243], v[80:83]
ds_read_b64_tr_b16 v[24:25], v6 offset:1024
v_mfma_f32_16x16x32_bf16 v[84:87], v[28:31], v[244:247], v[84:87]
ds_read_b64_tr_b16 v[26:27], v6 offset:1536
v_mfma_f32_16x16x32_bf16 v[88:91], v[28:31], v[248:251], v[88:91]
s_add_u32 m0, s31, 126976
s_add_u32 s40, s34, 3408000
v_mfma_f32_16x16x32_bf16 v[92:95], v[28:31], v[252:255], v[92:95]
s_waitcnt lgkmcnt(2)
v_mfma_f32_16x16x32_bf16 v[96:99], v[16:19], a[0:3], 0
ds_read_b64_tr_b16 v[28:29], v6 offset:3072
v_mfma_f32_16x16x32_bf16 v[100:103], v[16:19], a[4:7], 0
ds_read_b64_tr_b16 v[30:31], v6 offset:3584
v_mfma_f32_16x16x32_bf16 v[104:107], v[16:19], a[8:11], 0
buffer_load_dwordx4 v3, s[16:19], s40 offen lds
v_mfma_f32_16x16x32_bf16 v[108:111], v[16:19], a[12:15], 0
v_mfma_f32_16x16x32_bf16 v[112:115], v[20:23], a[0:3], 0
ds_read_b64_tr_b16 v[16:17], v6 offset:4096
v_mfma_f32_16x16x32_bf16 v[116:119], v[20:23], a[4:7], 0
ds_read_b64_tr_b16 v[18:19], v6 offset:4608
v_mfma_f32_16x16x32_bf16 v[120:123], v[20:23], a[8:11], 0
v_mfma_f32_16x16x32_bf16 v[124:127], v[20:23], a[12:15], 0
s_waitcnt lgkmcnt(2)
v_mfma_f32_16x16x32_bf16 v[96:99], v[24:27], a[16:19], v[96:99]
ds_read_b64_tr_b16 v[20:21], v6 offset:6144
v_mul_f32 v32, s45, v32
v_mfma_f32_16x16x32_bf16 v[100:103], v[24:27], a[20:23], v[100:103]
ds_read_b64_tr_b16 v[22:23], v6 offset:6656
v_mul_f32 v33, s45, v33
v_mfma_f32_16x16x32_bf16 v[104:107], v[24:27], a[24:27], v[104:107]
s_add_u32 m0, s31, 131072
s_add_u32 s40, s34, 3670144
v_mul_f32 v34, s45, v34
v_mfma_f32_16x16x32_bf16 v[108:111], v[24:27], a[28:31], v[108:111]
v_mul_f32 v35, s45, v35
v_cvt_pk_bf16_f32 v192, v32, v33
v_mfma_f32_16x16x32_bf16 v[112:115], v[28:31], a[16:19], v[112:115]
ds_read_b64_tr_b16 v[24:25], v6 offset:5120
v_cvt_pk_bf16_f32 v193, v34, v35
v_mfma_f32_16x16x32_bf16 v[116:119], v[28:31], a[20:23], v[116:119]
ds_read_b64_tr_b16 v[26:27], v6 offset:5632
v_mul_f32 v48, s45, v48
v_mfma_f32_16x16x32_bf16 v[120:123], v[28:31], a[24:27], v[120:123]
buffer_load_dwordx4 v3, s[16:19], s40 offen lds
v_mfma_f32_16x16x32_bf16 v[124:127], v[28:31], a[28:31], v[124:127]
v_mul_f32 v49, s45, v49
v_mul_f32 v50, s45, v50
s_waitcnt lgkmcnt(2)
v_mfma_f32_16x16x32_bf16 v[96:99], v[16:19], a[32:35], v[96:99]
ds_read_b64_tr_b16 v[28:29], v6 offset:7168
v_mul_f32 v51, s45, v51
v_mfma_f32_16x16x32_bf16 v[100:103], v[16:19], a[36:39], v[100:103]
ds_read_b64_tr_b16 v[30:31], v6 offset:7680
v_cvt_pk_bf16_f32 v194, v48, v49
v_mfma_f32_16x16x32_bf16 v[104:107], v[16:19], a[40:43], v[104:107]
v_cvt_pk_bf16_f32 v195, v50, v51
v_mul_f32 v36, s45, v36
v_mfma_f32_16x16x32_bf16 v[108:111], v[16:19], a[44:47], v[108:111]
v_mul_f32 v37, s45, v37
v_mul_f32 v38, s45, v38
v_mfma_f32_16x16x32_bf16 v[112:115], v[20:23], a[32:35], v[112:115]
ds_read_b64_tr_b16 v[16:17], v6 offset:8192
v_mul_f32 v39, s45, v39
v_mfma_f32_16x16x32_bf16 v[116:119], v[20:23], a[36:39], v[116:119]
ds_read_b64_tr_b16 v[18:19], v6 offset:8704
v_cvt_pk_bf16_f32 v196, v36, v37
v_mfma_f32_16x16x32_bf16 v[120:123], v[20:23], a[40:43], v[120:123]
s_add_u32 m0, s31, 135168
s_add_u32 s40, s34, 3932288
v_cvt_pk_bf16_f32 v197, v38, v39
v_mfma_f32_16x16x32_bf16 v[124:127], v[20:23], a[44:47], v[124:127]
v_mul_f32 v52, s45, v52
v_mul_f32 v53, s45, v53
s_waitcnt lgkmcnt(2)
v_mfma_f32_16x16x32_bf16 v[96:99], v[24:27], a[48:51], v[96:99]
ds_read_b64_tr_b16 v[20:21], v6 offset:10240
v_mul_f32 v54, s45, v54
v_mfma_f32_16x16x32_bf16 v[100:103], v[24:27], a[52:55], v[100:103]
ds_read_b64_tr_b16 v[22:23], v6 offset:10752
v_mul_f32 v55, s45, v55
v_mfma_f32_16x16x32_bf16 v[104:107], v[24:27], a[56:59], v[104:107]
buffer_load_dwordx4 v3, s[16:19], s40 offen lds
v_mfma_f32_16x16x32_bf16 v[108:111], v[24:27], a[60:63], v[108:111]
v_cvt_pk_bf16_f32 v198, v52, v53
v_cvt_pk_bf16_f32 v199, v54, v55
v_mfma_f32_16x16x32_bf16 v[112:115], v[28:31], a[48:51], v[112:115]
ds_read_b64_tr_b16 v[24:25], v6 offset:9216
v_mul_f32 v40, s45, v40
v_mfma_f32_16x16x32_bf16 v[116:119], v[28:31], a[52:55], v[116:119]
ds_read_b64_tr_b16 v[26:27], v6 offset:9728
v_mul_f32 v41, s45, v41
v_mfma_f32_16x16x32_bf16 v[120:123], v[28:31], a[56:59], v[120:123]
v_mul_f32 v42, s45, v42
v_mul_f32 v43, s45, v43
v_mfma_f32_16x16x32_bf16 v[124:127], v[28:31], a[60:63], v[124:127]
v_cvt_pk_bf16_f32 v200, v40, v41
v_cvt_pk_bf16_f32 v201, v42, v43
s_waitcnt lgkmcnt(2)
v_mfma_f32_16x16x32_bf16 v[96:99], v[16:19], a[64:67], v[96:99]
ds_read_b64_tr_b16 v[28:29], v6 offset:11264
v_mul_f32 v56, s45, v56
v_mfma_f32_16x16x32_bf16 v[100:103], v[16:19], a[68:71], v[100:103]
ds_read_b64_tr_b16 v[30:31], v6 offset:11776
v_mul_f32 v57, s45, v57
v_mfma_f32_16x16x32_bf16 v[104:107], v[16:19], a[72:75], v[104:107]
s_add_u32 m0, s31, 139264
s_add_u32 s40, s34, 4194432
v_mul_f32 v58, s45, v58
v_mfma_f32_16x16x32_bf16 v[108:111], v[16:19], a[76:79], v[108:111]
v_mul_f32 v59, s45, v59
v_cvt_pk_bf16_f32 v202, v56, v57
v_mfma_f32_16x16x32_bf16 v[112:115], v[20:23], a[64:67], v[112:115]
ds_read_b64_tr_b16 v[16:17], v6 offset:12288
v_cvt_pk_bf16_f32 v203, v58, v59
v_mfma_f32_16x16x32_bf16 v[116:119], v[20:23], a[68:71], v[116:119]
ds_read_b64_tr_b16 v[18:19], v6 offset:12800
v_mul_f32 v44, s45, v44
v_mfma_f32_16x16x32_bf16 v[120:123], v[20:23], a[72:75], v[120:123]
buffer_load_dwordx4 v3, s[16:19], s40 offen lds
v_mfma_f32_16x16x32_bf16 v[124:127], v[20:23], a[76:79], v[124:127]
v_mul_f32 v45, s45, v45
v_mul_f32 v46, s45, v46
s_waitcnt lgkmcnt(2)
v_mfma_f32_16x16x32_bf16 v[96:99], v[24:27], a[80:83], v[96:99]
ds_read_b64_tr_b16 v[20:21], v6 offset:14336
v_mul_f32 v47, s45, v47
v_mfma_f32_16x16x32_bf16 v[100:103], v[24:27], a[84:87], v[100:103]
ds_read_b64_tr_b16 v[22:23], v6 offset:14848
v_cvt_pk_bf16_f32 v204, v44, v45
v_mfma_f32_16x16x32_bf16 v[104:107], v[24:27], a[88:91], v[104:107]
v_cvt_pk_bf16_f32 v205, v46, v47
v_mul_f32 v60, s45, v60
v_mfma_f32_16x16x32_bf16 v[108:111], v[24:27], a[92:95], v[108:111]
v_mul_f32 v61, s45, v61
v_mul_f32 v62, s45, v62
v_mfma_f32_16x16x32_bf16 v[112:115], v[28:31], a[80:83], v[112:115]
ds_read_b64_tr_b16 v[24:25], v6 offset:13312
v_mul_f32 v63, s45, v63
v_mfma_f32_16x16x32_bf16 v[116:119], v[28:31], a[84:87], v[116:119]
ds_read_b64_tr_b16 v[26:27], v6 offset:13824
v_cvt_pk_bf16_f32 v206, v60, v61
v_mfma_f32_16x16x32_bf16 v[120:123], v[28:31], a[88:91], v[120:123]
s_add_u32 m0, s31, 143360
s_add_u32 s40, s34, 4456576
v_cvt_pk_bf16_f32 v207, v62, v63
v_mfma_f32_16x16x32_bf16 v[124:127], v[28:31], a[92:95], v[124:127]
v_mul_f32 v64, s45, v64
v_mul_f32 v65, s45, v65
s_waitcnt lgkmcnt(2)
v_mfma_f32_16x16x32_bf16 v[96:99], v[16:19], a[96:99], v[96:99]
ds_read_b64_tr_b16 v[28:29], v6 offset:15360
v_mul_f32 v66, s45, v66
v_mfma_f32_16x16x32_bf16 v[100:103], v[16:19], a[100:103], v[100:103]
ds_read_b64_tr_b16 v[30:31], v6 offset:15872
v_mul_f32 v67, s45, v67
v_mfma_f32_16x16x32_bf16 v[104:107], v[16:19], a[104:107], v[104:107]
buffer_load_dwordx4 v3, s[16:19], s40 offen lds
v_mfma_f32_16x16x32_bf16 v[108:111], v[16:19], a[108:111], v[108:111]
v_cvt_pk_bf16_f32 v208, v64, v65
v_cvt_pk_bf16_f32 v209, v66, v67
v_mfma_f32_16x16x32_bf16 v[112:115], v[20:23], a[96:99], v[112:115]
ds_read_b64_tr_b16 v[16:17], v6 offset:16384
v_mul_f32 v80, s45, v80
v_mfma_f32_16x16x32_bf16 v[116:119], v[20:23], a[100:103], v[116:119]
ds_read_b64_tr_b16 v[18:19], v6 offset:16896
v_mul_f32 v81, s45, v81
v_mfma_f32_16x16x32_bf16 v[120:123], v[20:23], a[104:107], v[120:123]
v_mul_f32 v82, s45, v82
v_mul_f32 v83, s45, v83
v_mfma_f32_16x16x32_bf16 v[124:127], v[20:23], a[108:111], v[124:127]
v_cvt_pk_bf16_f32 v210, v80, v81
v_cvt_pk_bf16_f32 v211, v82, v83
s_waitcnt lgkmcnt(2)
v_mfma_f32_16x16x32_bf16 v[96:99], v[24:27], a[112:115], v[96:99]
ds_read_b64_tr_b16 v[20:21], v6 offset:18432
v_mul_f32 v68, s45, v68
v_mfma_f32_16x16x32_bf16 v[100:103], v[24:27], a[116:119], v[100:103]
ds_read_b64_tr_b16 v[22:23], v6 offset:18944
v_mul_f32 v69, s45, v69
v_mfma_f32_16x16x32_bf16 v[104:107], v[24:27], a[120:123], v[104:107]
v_mul_f32 v70, s45, v70
v_mul_f32 v71, s45, v71
v_mfma_f32_16x16x32_bf16 v[108:111], v[24:27], a[124:127], v[108:111]
v_cvt_pk_bf16_f32 v212, v68, v69
v_cvt_pk_bf16_f32 v213, v70, v71
v_mfma_f32_16x16x32_bf16 v[112:115], v[28:31], a[112:115], v[112:115]
ds_read_b64_tr_b16 v[24:25], v6 offset:17408
v_mul_f32 v84, s45, v84
v_mfma_f32_16x16x32_bf16 v[116:119], v[28:31], a[116:119], v[116:119]
ds_read_b64_tr_b16 v[26:27], v6 offset:17920
v_mul_f32 v85, s45, v85
v_mfma_f32_16x16x32_bf16 v[120:123], v[28:31], a[120:123], v[120:123]
v_mul_f32 v86, s45, v86
v_mul_f32 v87, s45, v87
v_mfma_f32_16x16x32_bf16 v[124:127], v[28:31], a[124:127], v[124:127]
v_cvt_pk_bf16_f32 v214, v84, v85
v_cvt_pk_bf16_f32 v215, v86, v87
s_waitcnt lgkmcnt(2)
v_mfma_f32_16x16x32_bf16 v[96:99], v[16:19], a[128:131], v[96:99]
ds_read_b64_tr_b16 v[28:29], v6 offset:19456
v_mul_f32 v72, s45, v72
v_mfma_f32_16x16x32_bf16 v[100:103], v[16:19], a[132:135], v[100:103]
ds_read_b64_tr_b16 v[30:31], v6 offset:19968
v_mul_f32 v73, s45, v73
v_mfma_f32_16x16x32_bf16 v[104:107], v[16:19], a[136:139], v[104:107]
v_mul_f32 v74, s45, v74
v_mul_f32 v75, s45, v75
v_mfma_f32_16x16x32_bf16 v[108:111], v[16:19], a[140:143], v[108:111]
v_add_u32 v6, 0x6000, v6
v_cvt_pk_bf16_f32 v216, v72, v73
v_mfma_f32_16x16x32_bf16 v[112:115], v[20:23], a[128:131], v[112:115]
s_waitcnt vmcnt(24)
s_barrier
ds_read_b64_tr_b16 v[16:17], v6 offset:0
v_mfma_f32_16x16x32_bf16 v[116:119], v[20:23], a[132:135], v[116:119]
ds_read_b64_tr_b16 v[18:19], v6 offset:512
s_add_u32 m0, s46, 0
v_cvt_pk_bf16_f32 v217, v74, v75
v_mfma_f32_16x16x32_bf16 v[120:123], v[20:23], a[136:139], v[120:123]
s_add_u32 s40, s35, 0
buffer_load_dwordx4 v10, s[20:23], s40 offen lds
v_mfma_f32_16x16x32_bf16 v[124:127], v[20:23], a[140:143], v[124:127]
v_mul_f32 v88, s45, v88
v_mul_f32 v89, s45, v89
s_waitcnt lgkmcnt(2)
v_mfma_f32_16x16x32_bf16 v[96:99], v[24:27], a[144:147], v[96:99]
ds_read_b64_tr_b16 v[20:21], v6 offset:2048
v_mul_f32 v90, s45, v90
v_mfma_f32_16x16x32_bf16 v[100:103], v[24:27], a[148:151], v[100:103]
ds_read_b64_tr_b16 v[22:23], v6 offset:2560
v_mul_f32 v91, s45, v91
v_mfma_f32_16x16x32_bf16 v[104:107], v[24:27], a[152:155], v[104:107]
v_cvt_pk_bf16_f32 v218, v88, v89
v_cvt_pk_bf16_f32 v219, v90, v91
v_mfma_f32_16x16x32_bf16 v[108:111], v[24:27], a[156:159], v[108:111]
v_mul_f32 v76, s45, v76
v_mul_f32 v77, s45, v77
v_mfma_f32_16x16x32_bf16 v[112:115], v[28:31], a[144:147], v[112:115]
ds_read_b64_tr_b16 v[24:25], v6 offset:1024
v_mul_f32 v78, s45, v78
v_mfma_f32_16x16x32_bf16 v[116:119], v[28:31], a[148:151], v[116:119]
ds_read_b64_tr_b16 v[26:27], v6 offset:1536
v_mul_f32 v79, s45, v79
v_mfma_f32_16x16x32_bf16 v[120:123], v[28:31], a[152:155], v[120:123]
v_cvt_pk_bf16_f32 v220, v76, v77
v_cvt_pk_bf16_f32 v221, v78, v79
v_mfma_f32_16x16x32_bf16 v[124:127], v[28:31], a[156:159], v[124:127]
v_mul_f32 v92, s45, v92
v_mul_f32 v93, s45, v93
s_waitcnt lgkmcnt(2)
v_mfma_f32_16x16x32_bf16 v[96:99], v[16:19], a[160:163], v[96:99]
ds_read_b64_tr_b16 v[28:29], v6 offset:3072
v_mul_f32 v94, s45, v94
v_mfma_f32_16x16x32_bf16 v[100:103], v[16:19], a[164:167], v[100:103]
ds_read_b64_tr_b16 v[30:31], v6 offset:3584
v_mul_f32 v95, s45, v95
v_mfma_f32_16x16x32_bf16 v[104:107], v[16:19], a[168:171], v[104:107]
buffer_load_dwordx4 v11, s[20:23], s40 offen offset:1024 lds
v_mfma_f32_16x16x32_bf16 v[108:111], v[16:19], a[172:175], v[108:111]
v_cvt_pk_bf16_f32 v222, v92, v93
v_cvt_pk_bf16_f32 v223, v94, v95
v_mfma_f32_16x16x32_bf16 v[112:115], v[20:23], a[160:163], v[112:115]
ds_read_b64_tr_b16 v[16:17], v6 offset:4096
v_mfma_f32_16x16x32_bf16 v[116:119], v[20:23], a[164:167], v[116:119]
ds_read_b64_tr_b16 v[18:19], v6 offset:4608
v_mfma_f32_16x16x32_bf16 v[120:123], v[20:23], a[168:171], v[120:123]
v_mfma_f32_16x16x32_bf16 v[124:127], v[20:23], a[172:175], v[124:127]
s_waitcnt lgkmcnt(2)
v_mfma_f32_16x16x32_bf16 v[96:99], v[24:27], a[176:179], v[96:99]
ds_read_b64_tr_b16 v[20:21], v6 offset:6144
v_mfma_f32_16x16x32_bf16 v[100:103], v[24:27], a[180:183], v[100:103]
ds_read_b64_tr_b16 v[22:23], v6 offset:6656
v_mfma_f32_16x16x32_bf16 v[104:107], v[24:27], a[184:187], v[104:107]
s_add_u32 m0, s46, 8192
s_add_u32 s40, s35, 8192
v_mfma_f32_16x16x32_bf16 v[108:111], v[24:27], a[188:191], v[108:111]
v_mfma_f32_16x16x32_bf16 v[112:115], v[28:31], a[176:179], v[112:115]
ds_read_b64_tr_b16 v[24:25], v6 offset:5120
v_mfma_f32_16x16x32_bf16 v[116:119], v[28:31], a[180:183], v[116:119]
ds_read_b64_tr_b16 v[26:27], v6 offset:5632
v_mfma_f32_16x16x32_bf16 v[120:123], v[28:31], a[184:187], v[120:123]
buffer_load_dwordx4 v10, s[20:23], s40 offen lds
v_mfma_f32_16x16x32_bf16 v[124:127], v[28:31], a[188:191], v[124:127]
s_waitcnt lgkmcnt(2)
v_mfma_f32_16x16x32_bf16 v[96:99], v[16:19], a[192:195], v[96:99]
ds_read_b64_tr_b16 v[28:29], v6 offset:7168
v_mfma_f32_16x16x32_bf16 v[100:103], v[16:19], a[196:199], v[100:103]
ds_read_b64_tr_b16 v[30:31], v6 offset:7680
v_mfma_f32_16x16x32_bf16 v[104:107], v[16:19], a[200:203], v[104:107]
v_mfma_f32_16x16x32_bf16 v[108:111], v[16:19], a[204:207], v[108:111]
v_mfma_f32_16x16x32_bf16 v[112:115], v[20:23], a[192:195], v[112:115]
ds_read_b64_tr_b16 v[16:17], v6 offset:8192
v_mfma_f32_16x16x32_bf16 v[116:119], v[20:23], a[196:199], v[116:119]
ds_read_b64_tr_b16 v[18:19], v6 offset:8704
v_mfma_f32_16x16x32_bf16 v[120:123], v[20:23], a[200:203], v[120:123]
v_mfma_f32_16x16x32_bf16 v[124:127], v[20:23], a[204:207], v[124:127]
s_waitcnt lgkmcnt(2)
v_mfma_f32_16x16x32_bf16 v[96:99], v[24:27], a[208:211], v[96:99]
ds_read_b64_tr_b16 v[20:21], v6 offset:10240
v_mfma_f32_16x16x32_bf16 v[100:103], v[24:27], a[212:215], v[100:103]
ds_read_b64_tr_b16 v[22:23], v6 offset:10752
v_mfma_f32_16x16x32_bf16 v[104:107], v[24:27], a[216:219], v[104:107]
buffer_load_dwordx4 v11, s[20:23], s40 offen offset:1024 lds
v_mfma_f32_16x16x32_bf16 v[108:111], v[24:27], a[220:223], v[108:111]
v_mfma_f32_16x16x32_bf16 v[112:115], v[28:31], a[208:211], v[112:115]
ds_read_b64_tr_b16 v[24:25], v6 offset:9216
v_mfma_f32_16x16x32_bf16 v[116:119], v[28:31], a[212:215], v[116:119]
ds_read_b64_tr_b16 v[26:27], v6 offset:9728
v_mfma_f32_16x16x32_bf16 v[120:123], v[28:31], a[216:219], v[120:123]
v_mfma_f32_16x16x32_bf16 v[124:127], v[28:31], a[220:223], v[124:127]
s_waitcnt lgkmcnt(2)
v_mfma_f32_16x16x32_bf16 v[96:99], v[16:19], a[224:227], v[96:99]
ds_read_b64_tr_b16 v[28:29], v6 offset:11264
v_mfma_f32_16x16x32_bf16 v[100:103], v[16:19], a[228:231], v[100:103]
ds_read_b64_tr_b16 v[30:31], v6 offset:11776
v_mfma_f32_16x16x32_bf16 v[104:107], v[16:19], a[232:235], v[104:107]
s_add_u32 m0, s46, 16384
s_add_u32 s40, s35, 16384
v_mfma_f32_16x16x32_bf16 v[108:111], v[16:19], a[236:239], v[108:111]
v_mfma_f32_16x16x32_bf16 v[112:115], v[20:23], a[224:227], v[112:115]
ds_read_b64_tr_b16 v[16:17], v6 offset:12288
v_mfma_f32_16x16x32_bf16 v[116:119], v[20:23], a[228:231], v[116:119]
ds_read_b64_tr_b16 v[18:19], v6 offset:12800
v_mfma_f32_16x16x32_bf16 v[120:123], v[20:23], a[232:235], v[120:123]
buffer_load_dwordx4 v10, s[20:23], s40 offen lds
v_mfma_f32_16x16x32_bf16 v[124:127], v[20:23], a[236:239], v[124:127]
s_waitcnt lgkmcnt(2)
v_mfma_f32_16x16x32_bf16 v[96:99], v[24:27], a[240:243], v[96:99]
ds_read_b64_tr_b16 v[20:21], v6 offset:14336
v_mfma_f32_16x16x32_bf16 v[100:103], v[24:27], a[244:247], v[100:103]
ds_read_b64_tr_b16 v[22:23], v6 offset:14848
v_mfma_f32_16x16x32_bf16 v[104:107], v[24:27], a[248:251], v[104:107]
v_mfma_f32_16x16x32_bf16 v[108:111], v[24:27], a[252:255], v[108:111]
v_mfma_f32_16x16x32_bf16 v[112:115], v[28:31], a[240:243], v[112:115]
ds_read_b64_tr_b16 v[24:25], v6 offset:13312
v_mfma_f32_16x16x32_bf16 v[116:119], v[28:31], a[244:247], v[116:119]
ds_read_b64_tr_b16 v[26:27], v6 offset:13824
v_mfma_f32_16x16x32_bf16 v[120:123], v[28:31], a[248:251], v[120:123]
v_mfma_f32_16x16x32_bf16 v[124:127], v[28:31], a[252:255], v[124:127]
s_waitcnt lgkmcnt(2)
v_mfma_f32_16x16x32_bf16 v[96:99], v[16:19], v[224:227], v[96:99]
ds_read_b64_tr_b16 v[28:29], v6 offset:15360
v_mfma_f32_16x16x32_bf16 v[100:103], v[16:19], v[228:231], v[100:103]
ds_read_b64_tr_b16 v[30:31], v6 offset:15872
v_mfma_f32_16x16x32_bf16 v[104:107], v[16:19], v[232:235], v[104:107]
buffer_load_dwordx4 v11, s[20:23], s40 offen offset:1024 lds
v_mfma_f32_16x16x32_bf16 v[108:111], v[16:19], v[236:239], v[108:111]
v_add_u32 v13, 0x12000, v13
v_add_u32 v14, 0x12000, v14
v_mfma_f32_16x16x32_bf16 v[112:115], v[20:23], v[224:227], v[112:115]
s_waitcnt vmcnt(20)
s_barrier
ds_read_b64_tr_b16 v[16:17], v13 offset:0
v_mfma_f32_16x16x32_bf16 v[116:119], v[20:23], v[228:231], v[116:119]
ds_read_b64_tr_b16 v[18:19], v13 offset:2048
v_mfma_f32_16x16x32_bf16 v[120:123], v[20:23], v[232:235], v[120:123]
v_mfma_f32_16x16x32_bf16 v[124:127], v[20:23], v[236:239], v[124:127]
s_waitcnt lgkmcnt(2)
v_mfma_f32_16x16x32_bf16 v[96:99], v[24:27], v[240:243], v[96:99]
ds_read_b64_tr_b16 v[20:21], v13 offset:8
v_mfma_f32_16x16x32_bf16 v[100:103], v[24:27], v[244:247], v[100:103]
ds_read_b64_tr_b16 v[22:23], v13 offset:2056
v_mfma_f32_16x16x32_bf16 v[104:107], v[24:27], v[248:251], v[104:107]
s_add_u32 m0, s46, 65536
s_add_u32 s40, s35, 0
v_mfma_f32_16x16x32_bf16 v[108:111], v[24:27], v[252:255], v[108:111]
v_mfma_f32_16x16x32_bf16 v[112:115], v[28:31], v[240:243], v[112:115]
ds_read_b64_tr_b16 v[24:25], v14 offset:0
v_mfma_f32_16x16x32_bf16 v[116:119], v[28:31], v[244:247], v[116:119]
ds_read_b64_tr_b16 v[26:27], v14 offset:2048
v_mfma_f32_16x16x32_bf16 v[120:123], v[28:31], v[248:251], v[120:123]
buffer_load_dwordx4 v10, s[24:27], s40 offen lds
v_mfma_f32_16x16x32_bf16 v[124:127], v[28:31], v[252:255], v[124:127]
s_waitcnt lgkmcnt(2)
v_mfma_f32_16x16x32_bf16 v[32:35], v[16:19], a[0:3], 0
ds_read_b64_tr_b16 v[28:29], v14 offset:8
v_mfma_f32_16x16x32_bf16 v[36:39], v[16:19], a[4:7], 0
ds_read_b64_tr_b16 v[30:31], v14 offset:2056
v_mfma_f32_16x16x32_bf16 v[40:43], v[16:19], a[8:11], 0
v_mfma_f32_16x16x32_bf16 v[44:47], v[16:19], a[12:15], 0
v_mfma_f32_16x16x32_bf16 v[48:51], v[20:23], a[0:3], 0
ds_read_b64_tr_b16 v[16:17], v13 offset:4096
v_mfma_f32_16x16x32_bf16 v[52:55], v[20:23], a[4:7], 0
ds_read_b64_tr_b16 v[18:19], v13 offset:6144
v_mfma_f32_16x16x32_bf16 v[56:59], v[20:23], a[8:11], 0
v_mfma_f32_16x16x32_bf16 v[60:63], v[20:23], a[12:15], 0
v_and_b32 v172, 15, v0
v_lshrrev_b32 v173, 4, v0
s_waitcnt lgkmcnt(2)
v_mfma_f32_16x16x32_bf16 v[64:67], v[24:27], a[0:3], 0
ds_read_b64_tr_b16 v[20:21], v13 offset:4104
v_and_b32 v174, 7, v172
v_mfma_f32_16x16x32_bf16 v[68:71], v[24:27], a[4:7], 0
ds_read_b64_tr_b16 v[22:23], v13 offset:6152
v_lshlrev_b32 v174, 1, v174
v_mfma_f32_16x16x32_bf16 v[72:75], v[24:27], a[8:11], 0
buffer_load_dwordx4 v11, s[24:27], s40 offen offset:1024 lds
v_mfma_f32_16x16x32_bf16 v[76:79], v[24:27], a[12:15], 0
v_xor_b32 v174, v174, v173
v_lshlrev_b32 v174, 4, v174
v_mfma_f32_16x16x32_bf16 v[80:83], v[28:31], a[0:3], 0
ds_read_b64_tr_b16 v[24:25], v14 offset:4096
v_lshl_add_u32 v4, v172, 8, v174
v_mfma_f32_16x16x32_bf16 v[84:87], v[28:31], a[4:7], 0
ds_read_b64_tr_b16 v[26:27], v14 offset:6144
v_xor_b32 v5, 64, v4
v_mfma_f32_16x16x32_bf16 v[88:91], v[28:31], a[8:11], 0
v_xor_b32 v6, 128, v4
v_xor_b32 v7, 192, v4
v_mfma_f32_16x16x32_bf16 v[92:95], v[28:31], a[12:15], 0
s_waitcnt lgkmcnt(2)
v_mfma_f32_16x16x32_bf16 v[32:35], v[16:19], a[16:19], v[32:35]
ds_read_b64_tr_b16 v[28:29], v14 offset:4104
v_mfma_f32_16x16x32_bf16 v[36:39], v[16:19], a[20:23], v[36:39]
ds_read_b64_tr_b16 v[30:31], v14 offset:6152
v_mfma_f32_16x16x32_bf16 v[40:43], v[16:19], a[24:27], v[40:43]
s_add_u32 m0, s46, 24576
s_add_u32 s40, s35, 24576
v_mfma_f32_16x16x32_bf16 v[44:47], v[16:19], a[28:31], v[44:47]
v_mfma_f32_16x16x32_bf16 v[48:51], v[20:23], a[16:19], v[48:51]
ds_read_b64_tr_b16 v[16:17], v13 offset:8192
v_mfma_f32_16x16x32_bf16 v[52:55], v[20:23], a[20:23], v[52:55]
ds_read_b64_tr_b16 v[18:19], v13 offset:10240
v_mfma_f32_16x16x32_bf16 v[56:59], v[20:23], a[24:27], v[56:59]
buffer_load_dwordx4 v10, s[20:23], s40 offen lds
v_mfma_f32_16x16x32_bf16 v[60:63], v[20:23], a[28:31], v[60:63]
s_lshl_b32 s72, s28, 13
s_add_u32 s72, s72, mk_L_A1-mk_pc
s_waitcnt lgkmcnt(2)
v_mfma_f32_16x16x32_bf16 v[64:67], v[24:27], a[16:19], v[64:67]
ds_read_b64_tr_b16 v[20:21], v13 offset:8200
v_lshl_add_u32 v179, v0, 7, s72
v_mfma_f32_16x16x32_bf16 v[68:71], v[24:27], a[20:23], v[68:71]
ds_read_b64_tr_b16 v[22:23], v13 offset:10248
v_min_u32 v179, mk_fin-mk_pc, v179
v_mfma_f32_16x16x32_bf16 v[72:75], v[24:27], a[24:27], v[72:75]
global_load_dword v8, v179, s[4:5]
v_mfma_f32_16x16x32_bf16 v[76:79], v[24:27], a[28:31], v[76:79]
v_mfma_f32_16x16x32_bf16 v[80:83], v[28:31], a[16:19], v[80:83]
ds_read_b64_tr_b16 v[24:25], v14 offset:8192
v_mfma_f32_16x16x32_bf16 v[84:87], v[28:31], a[20:23], v[84:87]
ds_read_b64_tr_b16 v[26:27], v14 offset:10240
v_mfma_f32_16x16x32_bf16 v[88:91], v[28:31], a[24:27], v[88:91]
v_mfma_f32_16x16x32_bf16 v[92:95], v[28:31], a[28:31], v[92:95]
s_waitcnt lgkmcnt(2)
v_mfma_f32_16x16x32_bf16 v[32:35], v[16:19], a[32:35], v[32:35]
ds_read_b64_tr_b16 v[28:29], v14 offset:8200
v_mfma_f32_16x16x32_bf16 v[36:39], v[16:19], a[36:39], v[36:39]
ds_read_b64_tr_b16 v[30:31], v14 offset:10248
v_mfma_f32_16x16x32_bf16 v[40:43], v[16:19], a[40:43], v[40:43]
buffer_load_dwordx4 v11, s[20:23], s40 offen offset:1024 lds
v_mfma_f32_16x16x32_bf16 v[44:47], v[16:19], a[44:47], v[44:47]
v_mfma_f32_16x16x32_bf16 v[48:51], v[20:23], a[32:35], v[48:51]
ds_read_b64_tr_b16 v[16:17], v13 offset:12288
v_mfma_f32_16x16x32_bf16 v[52:55], v[20:23], a[36:39], v[52:55]
ds_read_b64_tr_b16 v[18:19], v13 offset:14336
v_mfma_f32_16x16x32_bf16 v[56:59], v[20:23], a[40:43], v[56:59]
v_mfma_f32_16x16x32_bf16 v[60:63], v[20:23], a[44:47], v[60:63]
s_waitcnt lgkmcnt(2)
v_mfma_f32_16x16x32_bf16 v[64:67], v[24:27], a[32:35], v[64:67]
ds_read_b64_tr_b16 v[20:21], v13 offset:12296
v_mfma_f32_16x16x32_bf16 v[68:71], v[24:27], a[36:39], v[68:71]
ds_read_b64_tr_b16 v[22:23], v13 offset:14344
v_mfma_f32_16x16x32_bf16 v[72:75], v[24:27], a[40:43], v[72:75]
v_mfma_f32_16x16x32_bf16 v[76:79], v[24:27], a[44:47], v[76:79]
v_mfma_f32_16x16x32_bf16 v[80:83], v[28:31], a[32:35], v[80:83]
ds_read_b64_tr_b16 v[24:25], v14 offset:12288
v_mfma_f32_16x16x32_bf16 v[84:87], v[28:31], a[36:39], v[84:87]
ds_read_b64_tr_b16 v[26:27], v14 offset:14336
v_mfma_f32_16x16x32_bf16 v[88:91], v[28:31], a[40:43], v[88:91]
v_mfma_f32_16x16x32_bf16 v[92:95], v[28:31], a[44:47], v[92:95]
s_waitcnt lgkmcnt(2)
v_mfma_f32_16x16x32_bf16 v[32:35], v[16:19], a[48:51], v[32:35]
ds_read_b64_tr_b16 v[28:29], v14 offset:12296
v_mul_f32 v160, v96, v96
v_mfma_f32_16x16x32_bf16 v[36:39], v[16:19], a[52:55], v[36:39]
ds_read_b64_tr_b16 v[30:31], v14 offset:14344
v_mul_f32 v161, v97, v97
v_mfma_f32_16x16x32_bf16 v[40:43], v[16:19], a[56:59], v[40:43]
v_mul_f32 v162, v98, v98
v_mul_f32 v163, v99, v99
v_mfma_f32_16x16x32_bf16 v[44:47], v[16:19], a[60:63], v[44:47]
v_fma_f32 v160, v160, v12, s44
v_fma_f32 v161, v161, v12, s44
v_mfma_f32_16x16x32_bf16 v[48:51], v[20:23], a[48:51], v[48:51]
ds_read_b64_tr_b16 v[16:17], v13 offset:16384
v_fma_f32 v162, v162, v12, s44
v_mfma_f32_16x16x32_bf16 v[52:55], v[20:23], a[52:55], v[52:55]
ds_read_b64_tr_b16 v[18:19], v13 offset:18432
v_fma_f32 v163, v163, v12, s44
v_mfma_f32_16x16x32_bf16 v[56:59], v[20:23], a[56:59], v[56:59]
v_mul_f32 v160, v96, v160
v_mul_f32 v161, v97, v161
v_mfma_f32_16x16x32_bf16 v[60:63], v[20:23], a[60:63], v[60:63]
v_exp_f32 v160, v160
s_waitcnt lgkmcnt(2)
v_mfma_f32_16x16x32_bf16 v[64:67], v[24:27], a[48:51], v[64:67]
ds_read_b64_tr_b16 v[20:21], v13 offset:16392
v_mul_f32 v162, v98, v162
v_mfma_f32_16x16x32_bf16 v[68:71], v[24:27], a[52:55], v[68:71]
ds_read_b64_tr_b16 v[22:23], v13 offset:18440
v_mul_f32 v163, v99, v163
v_mfma_f32_16x16x32_bf16 v[72:75], v[24:27], a[56:59], v[72:75]
v_exp_f32 v161, v161
v_mfma_f32_16x16x32_bf16 v[76:79], v[24:27], a[60:63], v[76:79]
v_exp_f32 v162, v162
v_mfma_f32_16x16x32_bf16 v[80:83], v[28:31], a[48:51], v[80:83]
ds_read_b64_tr_b16 v[24:25], v14 offset:16384
v_mul_f32 v112, v96, v112
v_mfma_f32_16x16x32_bf16 v[84:87], v[28:31], a[52:55], v[84:87]
ds_read_b64_tr_b16 v[26:27], v14 offset:18432
v_mul_f32 v113, v97, v113
v_mfma_f32_16x16x32_bf16 v[88:91], v[28:31], a[56:59], v[88:91]
v_exp_f32 v163, v163
v_mfma_f32_16x16x32_bf16 v[92:95], v[28:31], a[60:63], v[92:95]
v_mul_f32 v114, v98, v114
v_mul_f32 v115, v99, v115
s_waitcnt lgkmcnt(2)
v_mfma_f32_16x16x32_bf16 v[32:35], v[16:19], a[64:67], v[32:35]
ds_read_b64_tr_b16 v[28:29], v14 offset:16392
v_add_f32 v160, 1.0, v160
v_mfma_f32_16x16x32_bf16 v[36:39], v[16:19], a[68:71], v[36:39]
ds_read_b64_tr_b16 v[30:31], v14 offset:18440
v_add_f32 v161, 1.0, v161
v_mfma_f32_16x16x32_bf16 v[40:43], v[16:19], a[72:75], v[40:43]
v_rcp_f32 v160, v160
v_mfma_f32_16x16x32_bf16 v[44:47], v[16:19], a[76:79], v[44:47]
v_rcp_f32 v161, v161
v_mfma_f32_16x16x32_bf16 v[48:51], v[20:23], a[64:67], v[48:51]
ds_read_b64_tr_b16 v[16:17], v13 offset:20480
v_add_f32 v162, 1.0, v162
v_mfma_f32_16x16x32_bf16 v[52:55], v[20:23], a[68:71], v[52:55]
ds_read_b64_tr_b16 v[18:19], v13 offset:22528
v_add_f32 v163, 1.0, v163
v_mfma_f32_16x16x32_bf16 v[56:59], v[20:23], a[72:75], v[56:59]
v_rcp_f32 v162, v162
v_mfma_f32_16x16x32_bf16 v[60:63], v[20:23], a[76:79], v[60:63]
v_rcp_f32 v163, v163
s_waitcnt lgkmcnt(2)
v_mfma_f32_16x16x32_bf16 v[64:67], v[24:27], a[64:67], v[64:67]
ds_read_b64_tr_b16 v[20:21], v13 offset:20488
v_mul_f32 v112, v112, v160
v_mfma_f32_16x16x32_bf16 v[68:71], v[24:27], a[68:71], v[68:71]
ds_read_b64_tr_b16 v[22:23], v13 offset:22536
v_mul_f32 v113, v113, v161
v_mfma_f32_16x16x32_bf16 v[72:75], v[24:27], a[72:75], v[72:75]
v_mul_f32 v114, v114, v162
v_mul_f32 v115, v115, v163
v_mfma_f32_16x16x32_bf16 v[76:79], v[24:27], a[76:79], v[76:79]
v_cvt_pk_bf16_f32 v168, v112, v113
v_cvt_pk_bf16_f32 v169, v114, v115
v_mfma_f32_16x16x32_bf16 v[80:83], v[28:31], a[64:67], v[80:83]
ds_read_b64_tr_b16 v[24:25], v14 offset:20480
v_mul_f32 v164, v100, v100
v_mfma_f32_16x16x32_bf16 v[84:87], v[28:31], a[68:71], v[84:87]
ds_read_b64_tr_b16 v[26:27], v14 offset:22528
v_mul_f32 v165, v101, v101
v_mfma_f32_16x16x32_bf16 v[88:91], v[28:31], a[72:75], v[88:91]
buffer_store_dwordx2 v[168:169], v9, s[8:11], s39 offen offset:0 sc1
v_mfma_f32_16x16x32_bf16 v[92:95], v[28:31], a[76:79], v[92:95]
v_mul_f32 v166, v102, v102
v_mul_f32 v167, v103, v103
s_waitcnt lgkmcnt(2)
v_mfma_f32_16x16x32_bf16 v[32:35], v[16:19], a[80:83], v[32:35]
ds_read_b64_tr_b16 v[28:29], v14 offset:20488
v_fma_f32 v164, v164, v12, s44
v_mfma_f32_16x16x32_bf16 v[36:39], v[16:19], a[84:87], v[36:39]
ds_read_b64_tr_b16 v[30:31], v14 offset:22536
v_fma_f32 v165, v165, v12, s44
v_mfma_f32_16x16x32_bf16 v[40:43], v[16:19], a[88:91], v[40:43]
v_fma_f32 v166, v166, v12, s44
v_fma_f32 v167, v167, v12, s44
v_mfma_f32_16x16x32_bf16 v[44:47], v[16:19], a[92:95], v[44:47]
v_add_u32 v13, 0x6000, v13
v_add_u32 v14, 0x6000, v14
v_mfma_f32_16x16x32_bf16 v[48:51], v[20:23], a[80:83], v[48:51]
s_waitcnt vmcnt(19)
s_barrier
ds_read_b64_tr_b16 v[16:17], v13 offset:0
v_mfma_f32_16x16x32_bf16 v[52:55], v[20:23], a[84:87], v[52:55]
ds_read_b64_tr_b16 v[18:19], v13 offset:2048
v_mul_f32 v164, v100, v164
v_mfma_f32_16x16x32_bf16 v[56:59], v[20:23], a[88:91], v[56:59]
v_exp_f32 v164, v164
v_mfma_f32_16x16x32_bf16 v[60:63], v[20:23], a[92:95], v[60:63]
v_mul_f32 v165, v101, v165
v_mul_f32 v166, v102, v166
s_waitcnt lgkmcnt(2)
v_mfma_f32_16x16x32_bf16 v[64:67], v[24:27], a[80:83], v[64:67]
ds_read_b64_tr_b16 v[20:21], v13 offset:8
v_mul_f32 v167, v103, v167
v_mfma_f32_16x16x32_bf16 v[68:71], v[24:27], a[84:87], v[68:71]
ds_read_b64_tr_b16 v[22:23], v13 offset:2056
v_mul_f32 v116, v100, v116
v_mfma_f32_16x16x32_bf16 v[72:75], v[24:27], a[88:91], v[72:75]
v_exp_f32 v165, v165
v_mfma_f32_16x16x32_bf16 v[76:79], v[24:27], a[92:95], v[76:79]
v_exp_f32 v166, v166
v_mfma_f32_16x16x32_bf16 v[80:83], v[28:31], a[80:83], v[80:83]
ds_read_b64_tr_b16 v[24:25], v14 offset:0
v_mul_f32 v117, v101, v117
v_mfma_f32_16x16x32_bf16 v[84:87], v[28:31], a[84:87], v[84:87]
ds_read_b64_tr_b16 v[26:27], v14 offset:2048
v_mul_f32 v118, v102, v118
v_mfma_f32_16x16x32_bf16 v[88:91], v[28:31], a[88:91], v[88:91]
v_exp_f32 v167, v167
v_mfma_f32_16x16x32_bf16 v[92:95], v[28:31], a[92:95], v[92:95]
v_mul_f32 v119, v103, v119
v_add_f32 v164, 1.0, v164
s_waitcnt lgkmcnt(2)
v_mfma_f32_16x16x32_bf16 v[32:35], v[16:19], a[96:99], v[32:35]
ds_read_b64_tr_b16 v[28:29], v14 offset:8
v_add_f32 v165, 1.0, v165
v_mfma_f32_16x16x32_bf16 v[36:39], v[16:19], a[100:103], v[36:39]
ds_read_b64_tr_b16 v[30:31], v14 offset:2056
v_add_f32 v166, 1.0, v166
v_mfma_f32_16x16x32_bf16 v[40:43], v[16:19], a[104:107], v[40:43]
v_rcp_f32 v164, v164
v_mfma_f32_16x16x32_bf16 v[44:47], v[16:19], a[108:111], v[44:47]
v_rcp_f32 v165, v165
v_mfma_f32_16x16x32_bf16 v[48:51], v[20:23], a[96:99], v[48:51]
ds_read_b64_tr_b16 v[16:17], v13 offset:4096
v_add_f32 v167, 1.0, v167
v_mfma_f32_16x16x32_bf16 v[52:55], v[20:23], a[100:103], v[52:55]
ds_read_b64_tr_b16 v[18:19], v13 offset:6144
v_mul_f32 v116, v116, v164
v_mfma_f32_16x16x32_bf16 v[56:59], v[20:23], a[104:107], v[56:59]
v_rcp_f32 v166, v166
v_mfma_f32_16x16x32_bf16 v[60:63], v[20:23], a[108:111], v[60:63]
v_rcp_f32 v167, v167
s_waitcnt lgkmcnt(2)
v_mfma_f32_16x16x32_bf16 v[64:67], v[24:27], a[96:99], v[64:67]
ds_read_b64_tr_b16 v[20:21], v13 offset:4104
v_mul_f32 v117, v117, v165
v_mfma_f32_16x16x32_bf16 v[68:71], v[24:27], a[100:103], v[68:71]
ds_read_b64_tr_b16 v[22:23], v13 offset:6152
v_mul_f32 v118, v118, v166
v_mfma_f32_16x16x32_bf16 v[72:75], v[24:27], a[104:107], v[72:75]
v_mul_f32 v119, v119, v167
v_cvt_pk_bf16_f32 v172, v116, v117
v_mfma_f32_16x16x32_bf16 v[76:79], v[24:27], a[108:111], v[76:79]
v_cvt_pk_bf16_f32 v173, v118, v119
v_mul_f32 v160, v104, v104
v_mfma_f32_16x16x32_bf16 v[80:83], v[28:31], a[96:99], v[80:83]
ds_read_b64_tr_b16 v[24:25], v14 offset:4096
v_mul_f32 v161, v105, v105
v_mfma_f32_16x16x32_bf16 v[84:87], v[28:31], a[100:103], v[84:87]
ds_read_b64_tr_b16 v[26:27], v14 offset:6144
v_mul_f32 v162, v106, v106
v_mfma_f32_16x16x32_bf16 v[88:91], v[28:31], a[104:107], v[88:91]
buffer_store_dwordx2 v[172:173], v9, s[8:11], s39 offen offset:1024 sc1
v_mfma_f32_16x16x32_bf16 v[92:95], v[28:31], a[108:111], v[92:95]
v_mul_f32 v163, v107, v107
v_fma_f32 v160, v160, v12, s44
s_waitcnt lgkmcnt(2)
v_mfma_f32_16x16x32_bf16 v[32:35], v[16:19], a[112:115], v[32:35]
ds_read_b64_tr_b16 v[28:29], v14 offset:4104
v_fma_f32 v161, v161, v12, s44
v_mfma_f32_16x16x32_bf16 v[36:39], v[16:19], a[116:119], v[36:39]
ds_read_b64_tr_b16 v[30:31], v14 offset:6152
v_fma_f32 v162, v162, v12, s44
v_mfma_f32_16x16x32_bf16 v[40:43], v[16:19], a[120:123], v[40:43]
v_fma_f32 v163, v163, v12, s44
v_mul_f32 v160, v104, v160
v_mfma_f32_16x16x32_bf16 v[44:47], v[16:19], a[124:127], v[44:47]
v_exp_f32 v160, v160
v_mfma_f32_16x16x32_bf16 v[48:51], v[20:23], a[112:115], v[48:51]
ds_read_b64_tr_b16 v[16:17], v13 offset:8192
v_mul_f32 v161, v105, v161
v_mfma_f32_16x16x32_bf16 v[52:55], v[20:23], a[116:119], v[52:55]
ds_read_b64_tr_b16 v[18:19], v13 offset:10240
v_mul_f32 v162, v106, v162
v_mfma_f32_16x16x32_bf16 v[56:59], v[20:23], a[120:123], v[56:59]
v_exp_f32 v161, v161
v_mfma_f32_16x16x32_bf16 v[60:63], v[20:23], a[124:127], v[60:63]
v_exp_f32 v162, v162
s_waitcnt lgkmcnt(2)
v_mfma_f32_16x16x32_bf16 v[64:67], v[24:27], a[112:115], v[64:67]
ds_read_b64_tr_b16 v[20:21], v13 offset:8200
v_mul_f32 v163, v107, v163
v_mfma_f32_16x16x32_bf16 v[68:71], v[24:27], a[116:119], v[68:71]
ds_read_b64_tr_b16 v[22:23], v13 offset:10248
v_mul_f32 v120, v104, v120
v_mfma_f32_16x16x32_bf16 v[72:75], v[24:27], a[120:123], v[72:75]
v_exp_f32 v163, v163
v_mfma_f32_16x16x32_bf16 v[76:79], v[24:27], a[124:127], v[76:79]
v_mul_f32 v121, v105, v121
v_mul_f32 v122, v106, v122
v_mfma_f32_16x16x32_bf16 v[80:83], v[28:31], a[112:115], v[80:83]
ds_read_b64_tr_b16 v[24:25], v14 offset:8192
v_mul_f32 v123, v107, v123
v_mfma_f32_16x16x32_bf16 v[84:87], v[28:31], a[116:119], v[84:87]
ds_read_b64_tr_b16 v[26:27], v14 offset:10240
v_add_f32 v160, 1.0, v160
v_mfma_f32_16x16x32_bf16 v[88:91], v[28:31], a[120:123], v[88:91]
v_rcp_f32 v160, v160
v_mfma_f32_16x16x32_bf16 v[92:95], v[28:31], a[124:127], v[92:95]
v_add_f32 v161, 1.0, v161
v_add_f32 v162, 1.0, v162
s_waitcnt lgkmcnt(2)
v_mfma_f32_16x16x32_bf16 v[32:35], v[16:19], a[128:131], v[32:35]
ds_read_b64_tr_b16 v[28:29], v14 offset:8200
v_add_f32 v163, 1.0, v163
v_mfma_f32_16x16x32_bf16 v[36:39], v[16:19], a[132:135], v[36:39]
ds_read_b64_tr_b16 v[30:31], v14 offset:10248
v_mul_f32 v120, v120, v160
v_mfma_f32_16x16x32_bf16 v[40:43], v[16:19], a[136:139], v[40:43]
v_rcp_f32 v161, v161
v_mfma_f32_16x16x32_bf16 v[44:47], v[16:19], a[140:143], v[44:47]
v_rcp_f32 v162, v162
v_mfma_f32_16x16x32_bf16 v[48:51], v[20:23], a[128:131], v[48:51]
ds_read_b64_tr_b16 v[16:17], v13 offset:12288
v_mul_f32 v121, v121, v161
v_mfma_f32_16x16x32_bf16 v[52:55], v[20:23], a[132:135], v[52:55]
ds_read_b64_tr_b16 v[18:19], v13 offset:14336
v_mul_f32 v122, v122, v162
v_mfma_f32_16x16x32_bf16 v[56:59], v[20:23], a[136:139], v[56:59]
v_rcp_f32 v163, v163
v_mfma_f32_16x16x32_bf16 v[60:63], v[20:23], a[140:143], v[60:63]
v_mul_f32 v123, v123, v163
v_cvt_pk_bf16_f32 v168, v120, v121
s_waitcnt lgkmcnt(2)
v_mfma_f32_16x16x32_bf16 v[64:67], v[24:27], a[128:131], v[64:67]
ds_read_b64_tr_b16 v[20:21], v13 offset:12296
v_cvt_pk_bf16_f32 v169, v122, v123
v_mfma_f32_16x16x32_bf16 v[68:71], v[24:27], a[132:135], v[68:71]
ds_read_b64_tr_b16 v[22:23], v13 offset:14344
v_mul_f32 v164, v108, v108
v_mfma_f32_16x16x32_bf16 v[72:75], v[24:27], a[136:139], v[72:75]
buffer_store_dwordx2 v[168:169], v9, s[8:11], s39 offen offset:2048 sc1
v_mfma_f32_16x16x32_bf16 v[76:79], v[24:27], a[140:143], v[76:79]
v_mul_f32 v165, v109, v109
v_mul_f32 v166, v110, v110
v_mfma_f32_16x16x32_bf16 v[80:83], v[28:31], a[128:131], v[80:83]
ds_read_b64_tr_b16 v[24:25], v14 offset:12288
v_mul_f32 v167, v111, v111
v_mfma_f32_16x16x32_bf16 v[84:87], v[28:31], a[132:135], v[84:87]
ds_read_b64_tr_b16 v[26:27], v14 offset:14336
v_fma_f32 v164, v164, v12, s44
v_mfma_f32_16x16x32_bf16 v[88:91], v[28:31], a[136:139], v[88:91]
v_fma_f32 v165, v165, v12, s44
v_fma_f32 v166, v166, v12, s44
v_mfma_f32_16x16x32_bf16 v[92:95], v[28:31], a[140:143], v[92:95]
v_fma_f32 v167, v167, v12, s44
v_mul_f32 v164, v108, v164
s_waitcnt lgkmcnt(2)
v_mfma_f32_16x16x32_bf16 v[32:35], v[16:19], a[144:147], v[32:35]
ds_read_b64_tr_b16 v[28:29], v14 offset:12296
v_mul_f32 v165, v109, v165
v_mfma_f32_16x16x32_bf16 v[36:39], v[16:19], a[148:151], v[36:39]
ds_read_b64_tr_b16 v[30:31], v14 offset:14344
v_mul_f32 v166, v110, v166
v_mfma_f32_16x16x32_bf16 v[40:43], v[16:19], a[152:155], v[40:43]
v_exp_f32 v164, v164
v_mfma_f32_16x16x32_bf16 v[44:47], v[16:19], a[156:159], v[44:47]
v_exp_f32 v165, v165
v_mfma_f32_16x16x32_bf16 v[48:51], v[20:23], a[144:147], v[48:51]
ds_read_b64_tr_b16 v[16:17], v13 offset:16384
v_mul_f32 v167, v111, v167
v_mfma_f32_16x16x32_bf16 v[52:55], v[20:23], a[148:151], v[52:55]
ds_read_b64_tr_b16 v[18:19], v13 offset:18432
v_mul_f32 v124, v108, v124
v_mfma_f32_16x16x32_bf16 v[56:59], v[20:23], a[152:155], v[56:59]
v_exp_f32 v166, v166
v_mfma_f32_16x16x32_bf16 v[60:63], v[20:23], a[156:159], v[60:63]
v_exp_f32 v167, v167
s_waitcnt lgkmcnt(2)
v_mfma_f32_16x16x32_bf16 v[64:67], v[24:27], a[144:147], v[64:67]
ds_read_b64_tr_b16 v[20:21], v13 offset:16392
v_mul_f32 v125, v109, v125
v_mfma_f32_16x16x32_bf16 v[68:71], v[24:27], a[148:151], v[68:71]
ds_read_b64_tr_b16 v[22:23], v13 offset:18440
v_mul_f32 v126, v110, v126
v_mfma_f32_16x16x32_bf16 v[72:75], v[24:27], a[152:155], v[72:75]
v_mul_f32 v127, v111, v127
v_add_f32 v164, 1.0, v164
v_mfma_f32_16x16x32_bf16 v[76:79], v[24:27], a[156:159], v[76:79]
v_rcp_f32 v164, v164
v_mfma_f32_16x16x32_bf16 v[80:83], v[28:31], a[144:147], v[80:83]
ds_read_b64_tr_b16 v[24:25], v14 offset:16384
v_add_f32 v165, 1.0, v165
v_mfma_f32_16x16x32_bf16 v[84:87], v[28:31], a[148:151], v[84:87]
ds_read_b64_tr_b16 v[26:27], v14 offset:18432
v_add_f32 v166, 1.0, v166
v_mfma_f32_16x16x32_bf16 v[88:91], v[28:31], a[152:155], v[88:91]
v_rcp_f32 v165, v165
v_mfma_f32_16x16x32_bf16 v[92:95], v[28:31], a[156:159], v[92:95]
v_rcp_f32 v166, v166
s_waitcnt lgkmcnt(2)
v_mfma_f32_16x16x32_bf16 v[32:35], v[16:19], a[160:163], v[32:35]
ds_read_b64_tr_b16 v[28:29], v14 offset:16392
v_add_f32 v167, 1.0, v167
v_mfma_f32_16x16x32_bf16 v[36:39], v[16:19], a[164:167], v[36:39]
ds_read_b64_tr_b16 v[30:31], v14 offset:18440
v_mul_f32 v124, v124, v164
v_mfma_f32_16x16x32_bf16 v[40:43], v[16:19], a[168:171], v[40:43]
v_rcp_f32 v167, v167
v_mfma_f32_16x16x32_bf16 v[44:47], v[16:19], a[172:175], v[44:47]
v_mul_f32 v125, v125, v165
v_mul_f32 v126, v126, v166
v_mfma_f32_16x16x32_bf16 v[48:51], v[20:23], a[160:163], v[48:51]
ds_read_b64_tr_b16 v[16:17], v13 offset:20480
v_mul_f32 v127, v127, v167
v_mfma_f32_16x16x32_bf16 v[52:55], v[20:23], a[164:167], v[52:55]
ds_read_b64_tr_b16 v[18:19], v13 offset:22528
v_cvt_pk_bf16_f32 v172, v124, v125
v_mfma_f32_16x16x32_bf16 v[56:59], v[20:23], a[168:171], v[56:59]
v_cvt_pk_bf16_f32 v173, v126, v127
v_mfma_f32_16x16x32_bf16 v[60:63], v[20:23], a[172:175], v[60:63]
buffer_store_dwordx2 v[172:173], v9, s[8:11], s39 offen offset:3072 sc1
s_waitcnt lgkmcnt(2)
v_mfma_f32_16x16x32_bf16 v[64:67], v[24:27], a[160:163], v[64:67]
ds_read_b64_tr_b16 v[20:21], v13 offset:20488
v_mfma_f32_16x16x32_bf16 v[68:71], v[24:27], a[164:167], v[68:71]
ds_read_b64_tr_b16 v[22:23], v13 offset:22536
v_mfma_f32_16x16x32_bf16 v[72:75], v[24:27], a[168:171], v[72:75]
v_mfma_f32_16x16x32_bf16 v[76:79], v[24:27], a[172:175], v[76:79]
v_mfma_f32_16x16x32_bf16 v[80:83], v[28:31], a[160:163], v[80:83]
ds_read_b64_tr_b16 v[24:25], v14 offset:20480
v_mfma_f32_16x16x32_bf16 v[84:87], v[28:31], a[164:167], v[84:87]
ds_read_b64_tr_b16 v[26:27], v14 offset:22528
v_mfma_f32_16x16x32_bf16 v[88:91], v[28:31], a[168:171], v[88:91]
v_mfma_f32_16x16x32_bf16 v[92:95], v[28:31], a[172:175], v[92:95]
s_waitcnt lgkmcnt(2)
v_mfma_f32_16x16x32_bf16 v[32:35], v[16:19], a[176:179], v[32:35]
ds_read_b64_tr_b16 v[28:29], v14 offset:20488
v_mfma_f32_16x16x32_bf16 v[36:39], v[16:19], a[180:183], v[36:39]
ds_read_b64_tr_b16 v[30:31], v14 offset:22536
v_mfma_f32_16x16x32_bf16 v[40:43], v[16:19], a[184:187], v[40:43]
v_mfma_f32_16x16x32_bf16 v[44:47], v[16:19], a[188:191], v[44:47]
v_add_u32 v13, 0x6000, v13
v_add_u32 v14, 0x6000, v14
v_mfma_f32_16x16x32_bf16 v[48:51], v[20:23], a[176:179], v[48:51]
s_waitcnt vmcnt(15)
s_barrier
ds_read_b64_tr_b16 v[16:17], v13 offset:0
v_mfma_f32_16x16x32_bf16 v[52:55], v[20:23], a[180:183], v[52:55]
ds_read_b64_tr_b16 v[18:19], v13 offset:2048
s_add_u32 m0, s46, 73728
s_add_u32 s40, s35, 8192
v_mfma_f32_16x16x32_bf16 v[56:59], v[20:23], a[184:187], v[56:59]
buffer_load_dwordx4 v10, s[24:27], s40 offen lds
v_mfma_f32_16x16x32_bf16 v[60:63], v[20:23], a[188:191], v[60:63]
s_waitcnt lgkmcnt(2)
v_mfma_f32_16x16x32_bf16 v[64:67], v[24:27], a[176:179], v[64:67]
ds_read_b64_tr_b16 v[20:21], v13 offset:8
v_mfma_f32_16x16x32_bf16 v[68:71], v[24:27], a[180:183], v[68:71]
ds_read_b64_tr_b16 v[22:23], v13 offset:2056
v_mfma_f32_16x16x32_bf16 v[72:75], v[24:27], a[184:187], v[72:75]
v_mfma_f32_16x16x32_bf16 v[76:79], v[24:27], a[188:191], v[76:79]
v_mfma_f32_16x16x32_bf16 v[80:83], v[28:31], a[176:179], v[80:83]
ds_read_b64_tr_b16 v[24:25], v14 offset:0
v_mfma_f32_16x16x32_bf16 v[84:87], v[28:31], a[180:183], v[84:87]
ds_read_b64_tr_b16 v[26:27], v14 offset:2048
v_mfma_f32_16x16x32_bf16 v[88:91], v[28:31], a[184:187], v[88:91]
v_mfma_f32_16x16x32_bf16 v[92:95], v[28:31], a[188:191], v[92:95]
s_waitcnt lgkmcnt(2)
v_mfma_f32_16x16x32_bf16 v[32:35], v[16:19], a[192:195], v[32:35]
ds_read_b64_tr_b16 v[28:29], v14 offset:8
v_mfma_f32_16x16x32_bf16 v[36:39], v[16:19], a[196:199], v[36:39]
ds_read_b64_tr_b16 v[30:31], v14 offset:2056
v_mfma_f32_16x16x32_bf16 v[40:43], v[16:19], a[200:203], v[40:43]
buffer_load_dwordx4 v11, s[24:27], s40 offen offset:1024 lds
v_mfma_f32_16x16x32_bf16 v[44:47], v[16:19], a[204:207], v[44:47]
v_mfma_f32_16x16x32_bf16 v[48:51], v[20:23], a[192:195], v[48:51]
ds_read_b64_tr_b16 v[16:17], v13 offset:4096
v_mfma_f32_16x16x32_bf16 v[52:55], v[20:23], a[196:199], v[52:55]
ds_read_b64_tr_b16 v[18:19], v13 offset:6144
v_mfma_f32_16x16x32_bf16 v[56:59], v[20:23], a[200:203], v[56:59]
v_mfma_f32_16x16x32_bf16 v[60:63], v[20:23], a[204:207], v[60:63]
s_waitcnt lgkmcnt(2)
v_mfma_f32_16x16x32_bf16 v[64:67], v[24:27], a[192:195], v[64:67]
ds_read_b64_tr_b16 v[20:21], v13 offset:4104
v_mfma_f32_16x16x32_bf16 v[68:71], v[24:27], a[196:199], v[68:71]
ds_read_b64_tr_b16 v[22:23], v13 offset:6152
v_mfma_f32_16x16x32_bf16 v[72:75], v[24:27], a[200:203], v[72:75]
s_add_u32 m0, s46, 32768
s_add_u32 s40, s35, 32768
v_mfma_f32_16x16x32_bf16 v[76:79], v[24:27], a[204:207], v[76:79]
v_mfma_f32_16x16x32_bf16 v[80:83], v[28:31], a[192:195], v[80:83]
ds_read_b64_tr_b16 v[24:25], v14 offset:4096
v_mfma_f32_16x16x32_bf16 v[84:87], v[28:31], a[196:199], v[84:87]
ds_read_b64_tr_b16 v[26:27], v14 offset:6144
v_mfma_f32_16x16x32_bf16 v[88:91], v[28:31], a[200:203], v[88:91]
buffer_load_dwordx4 v10, s[20:23], s40 offen lds
v_mfma_f32_16x16x32_bf16 v[92:95], v[28:31], a[204:207], v[92:95]
s_waitcnt lgkmcnt(2)
v_mfma_f32_16x16x32_bf16 v[32:35], v[16:19], a[208:211], v[32:35]
ds_read_b64_tr_b16 v[28:29], v14 offset:4104
v_mfma_f32_16x16x32_bf16 v[36:39], v[16:19], a[212:215], v[36:39]
ds_read_b64_tr_b16 v[30:31], v14 offset:6152
v_mfma_f32_16x16x32_bf16 v[40:43], v[16:19], a[216:219], v[40:43]
v_mfma_f32_16x16x32_bf16 v[44:47], v[16:19], a[220:223], v[44:47]
v_mfma_f32_16x16x32_bf16 v[48:51], v[20:23], a[208:211], v[48:51]
ds_read_b64_tr_b16 v[16:17], v13 offset:8192
v_mfma_f32_16x16x32_bf16 v[52:55], v[20:23], a[212:215], v[52:55]
ds_read_b64_tr_b16 v[18:19], v13 offset:10240
v_mfma_f32_16x16x32_bf16 v[56:59], v[20:23], a[216:219], v[56:59]
v_mfma_f32_16x16x32_bf16 v[60:63], v[20:23], a[220:223], v[60:63]
s_waitcnt lgkmcnt(2)
v_mfma_f32_16x16x32_bf16 v[64:67], v[24:27], a[208:211], v[64:67]
ds_read_b64_tr_b16 v[20:21], v13 offset:8200
v_mfma_f32_16x16x32_bf16 v[68:71], v[24:27], a[212:215], v[68:71]
ds_read_b64_tr_b16 v[22:23], v13 offset:10248
v_mfma_f32_16x16x32_bf16 v[72:75], v[24:27], a[216:219], v[72:75]
buffer_load_dwordx4 v11, s[20:23], s40 offen offset:1024 lds
v_mfma_f32_16x16x32_bf16 v[76:79], v[24:27], a[220:223], v[76:79]
v_mfma_f32_16x16x32_bf16 v[80:83], v[28:31], a[208:211], v[80:83]
ds_read_b64_tr_b16 v[24:25], v14 offset:8192
v_mfma_f32_16x16x32_bf16 v[84:87], v[28:31], a[212:215], v[84:87]
ds_read_b64_tr_b16 v[26:27], v14 offset:10240
v_mfma_f32_16x16x32_bf16 v[88:91], v[28:31], a[216:219], v[88:91]
v_mfma_f32_16x16x32_bf16 v[92:95], v[28:31], a[220:223], v[92:95]
s_waitcnt lgkmcnt(2)
v_mfma_f32_16x16x32_bf16 v[32:35], v[16:19], a[224:227], v[32:35]
ds_read_b64_tr_b16 v[28:29], v14 offset:8200
v_mfma_f32_16x16x32_bf16 v[36:39], v[16:19], a[228:231], v[36:39]
ds_read_b64_tr_b16 v[30:31], v14 offset:10248
v_mfma_f32_16x16x32_bf16 v[40:43], v[16:19], a[232:235], v[40:43]
s_add_u32 m0, s46, 81920
s_add_u32 s40, s35, 16384
v_mfma_f32_16x16x32_bf16 v[44:47], v[16:19], a[236:239], v[44:47]
v_mfma_f32_16x16x32_bf16 v[48:51], v[20:23], a[224:227], v[48:51]
ds_read_b64_tr_b16 v[16:17], v13 offset:12288
v_mfma_f32_16x16x32_bf16 v[52:55], v[20:23], a[228:231], v[52:55]
ds_read_b64_tr_b16 v[18:19], v13 offset:14336
v_mfma_f32_16x16x32_bf16 v[56:59], v[20:23], a[232:235], v[56:59]
buffer_load_dwordx4 v10, s[24:27], s40 offen lds
v_mfma_f32_16x16x32_bf16 v[60:63], v[20:23], a[236:239], v[60:63]
s_waitcnt lgkmcnt(2)
v_mfma_f32_16x16x32_bf16 v[64:67], v[24:27], a[224:227], v[64:67]
ds_read_b64_tr_b16 v[20:21], v13 offset:12296
v_mfma_f32_16x16x32_bf16 v[68:71], v[24:27], a[228:231], v[68:71]
ds_read_b64_tr_b16 v[22:23], v13 offset:14344
v_mfma_f32_16x16x32_bf16 v[72:75], v[24:27], a[232:235], v[72:75]
v_mfma_f32_16x16x32_bf16 v[76:79], v[24:27], a[236:239], v[76:79]
v_mfma_f32_16x16x32_bf16 v[80:83], v[28:31], a[224:227], v[80:83]
ds_read_b64_tr_b16 v[24:25], v14 offset:12288
v_mfma_f32_16x16x32_bf16 v[84:87], v[28:31], a[228:231], v[84:87]
ds_read_b64_tr_b16 v[26:27], v14 offset:14336
v_mfma_f32_16x16x32_bf16 v[88:91], v[28:31], a[232:235], v[88:91]
v_mfma_f32_16x16x32_bf16 v[92:95], v[28:31], a[236:239], v[92:95]
s_waitcnt lgkmcnt(2)
v_mfma_f32_16x16x32_bf16 v[32:35], v[16:19], a[240:243], v[32:35]
ds_read_b64_tr_b16 v[28:29], v14 offset:12296
v_mfma_f32_16x16x32_bf16 v[36:39], v[16:19], a[244:247], v[36:39]
ds_read_b64_tr_b16 v[30:31], v14 offset:14344
v_mfma_f32_16x16x32_bf16 v[40:43], v[16:19], a[248:251], v[40:43]
buffer_load_dwordx4 v11, s[24:27], s40 offen offset:1024 lds
v_mfma_f32_16x16x32_bf16 v[44:47], v[16:19], a[252:255], v[44:47]
v_mfma_f32_16x16x32_bf16 v[48:51], v[20:23], a[240:243], v[48:51]
ds_read_b64_tr_b16 v[16:17], v13 offset:16384
v_mfma_f32_16x16x32_bf16 v[52:55], v[20:23], a[244:247], v[52:55]
ds_read_b64_tr_b16 v[18:19], v13 offset:18432
v_mfma_f32_16x16x32_bf16 v[56:59], v[20:23], a[248:251], v[56:59]
v_mfma_f32_16x16x32_bf16 v[60:63], v[20:23], a[252:255], v[60:63]
s_waitcnt lgkmcnt(2)
v_mfma_f32_16x16x32_bf16 v[64:67], v[24:27], a[240:243], v[64:67]
ds_read_b64_tr_b16 v[20:21], v13 offset:16392
v_mfma_f32_16x16x32_bf16 v[68:71], v[24:27], a[244:247], v[68:71]
ds_read_b64_tr_b16 v[22:23], v13 offset:18440
v_mfma_f32_16x16x32_bf16 v[72:75], v[24:27], a[248:251], v[72:75]
s_add_u32 m0, s46, 40960
s_add_u32 s40, s35, 40960
v_mfma_f32_16x16x32_bf16 v[76:79], v[24:27], a[252:255], v[76:79]
v_mfma_f32_16x16x32_bf16 v[80:83], v[28:31], a[240:243], v[80:83]
ds_read_b64_tr_b16 v[24:25], v14 offset:16384
v_mfma_f32_16x16x32_bf16 v[84:87], v[28:31], a[244:247], v[84:87]
ds_read_b64_tr_b16 v[26:27], v14 offset:18432
v_mfma_f32_16x16x32_bf16 v[88:91], v[28:31], a[248:251], v[88:91]
buffer_load_dwordx4 v10, s[20:23], s40 offen lds
v_mfma_f32_16x16x32_bf16 v[92:95], v[28:31], a[252:255], v[92:95]
s_waitcnt lgkmcnt(2)
v_mfma_f32_16x16x32_bf16 v[32:35], v[16:19], v[224:227], v[32:35]
ds_read_b64_tr_b16 v[28:29], v14 offset:16392
v_mfma_f32_16x16x32_bf16 v[36:39], v[16:19], v[228:231], v[36:39]
ds_read_b64_tr_b16 v[30:31], v14 offset:18440
v_mfma_f32_16x16x32_bf16 v[40:43], v[16:19], v[232:235], v[40:43]
v_mfma_f32_16x16x32_bf16 v[44:47], v[16:19], v[236:239], v[44:47]
v_mfma_f32_16x16x32_bf16 v[48:51], v[20:23], v[224:227], v[48:51]
ds_read_b64_tr_b16 v[16:17], v13 offset:20480
v_mfma_f32_16x16x32_bf16 v[52:55], v[20:23], v[228:231], v[52:55]
ds_read_b64_tr_b16 v[18:19], v13 offset:22528
v_mfma_f32_16x16x32_bf16 v[56:59], v[20:23], v[232:235], v[56:59]
v_mfma_f32_16x16x32_bf16 v[60:63], v[20:23], v[236:239], v[60:63]
s_waitcnt lgkmcnt(2)
v_mfma_f32_16x16x32_bf16 v[64:67], v[24:27], v[224:227], v[64:67]
ds_read_b64_tr_b16 v[20:21], v13 offset:20488
v_mfma_f32_16x16x32_bf16 v[68:71], v[24:27], v[228:231], v[68:71]
ds_read_b64_tr_b16 v[22:23], v13 offset:22536
v_mfma_f32_16x16x32_bf16 v[72:75], v[24:27], v[232:235], v[72:75]
buffer_load_dwordx4 v11, s[20:23], s40 offen offset:1024 lds
v_mfma_f32_16x16x32_bf16 v[76:79], v[24:27], v[236:239], v[76:79]
v_mfma_f32_16x16x32_bf16 v[80:83], v[28:31], v[224:227], v[80:83]
ds_read_b64_tr_b16 v[24:25], v14 offset:20480
v_mfma_f32_16x16x32_bf16 v[84:87], v[28:31], v[228:231], v[84:87]
ds_read_b64_tr_b16 v[26:27], v14 offset:22528
v_mfma_f32_16x16x32_bf16 v[88:91], v[28:31], v[232:235], v[88:91]
v_mfma_f32_16x16x32_bf16 v[92:95], v[28:31], v[236:239], v[92:95]
s_waitcnt lgkmcnt(2)
v_mfma_f32_16x16x32_bf16 v[32:35], v[16:19], v[240:243], v[32:35]
ds_read_b64_tr_b16 v[28:29], v14 offset:20488
v_mfma_f32_16x16x32_bf16 v[36:39], v[16:19], v[244:247], v[36:39]
ds_read_b64_tr_b16 v[30:31], v14 offset:22536
v_mfma_f32_16x16x32_bf16 v[40:43], v[16:19], v[248:251], v[40:43]
s_add_u32 m0, s46, 90112
s_add_u32 s40, s35, 24576
v_mfma_f32_16x16x32_bf16 v[44:47], v[16:19], v[252:255], v[44:47]
v_mfma_f32_16x16x32_bf16 v[48:51], v[20:23], v[240:243], v[48:51]
s_waitcnt vmcnt(21)
s_barrier
ds_read_b128 v[16:19], v4 offset:0
v_mfma_f32_16x16x32_bf16 v[52:55], v[20:23], v[244:247], v[52:55]
buffer_load_dwordx4 v10, s[24:27], s40 offen lds
v_mfma_f32_16x16x32_bf16 v[56:59], v[20:23], v[248:251], v[56:59]
v_mfma_f32_16x16x32_bf16 v[60:63], v[20:23], v[252:255], v[60:63]
s_waitcnt lgkmcnt(1)
v_mfma_f32_16x16x32_bf16 v[64:67], v[24:27], v[240:243], v[64:67]
ds_read_b128 v[20:23], v4 offset:4096
v_mfma_f32_16x16x32_bf16 v[68:71], v[24:27], v[244:247], v[68:71]
v_mfma_f32_16x16x32_bf16 v[72:75], v[24:27], v[248:251], v[72:75]
v_mfma_f32_16x16x32_bf16 v[76:79], v[24:27], v[252:255], v[76:79]
v_mfma_f32_16x16x32_bf16 v[80:83], v[28:31], v[240:243], v[80:83]
ds_read_b128 v[24:27], v5 offset:0
v_mfma_f32_16x16x32_bf16 v[84:87], v[28:31], v[244:247], v[84:87]
v_mul_f32 v32, s45, v32
v_mul_f32 v33, s45, v33
v_mfma_f32_16x16x32_bf16 v[88:91], v[28:31], v[248:251], v[88:91]
v_mul_f32 v34, s45, v34
v_mul_f32 v35, s45, v35
v_mfma_f32_16x16x32_bf16 v[92:95], v[28:31], v[252:255], v[92:95]
v_cvt_pk_bf16_f32 v224, v32, v33
v_cvt_pk_bf16_f32 v225, v34, v35
s_waitcnt lgkmcnt(1)
v_mfma_f32_16x16x32_bf16 v[96:99], v[16:19], v[192:195], 0
ds_read_b128 v[28:31], v5 offset:4096
v_mul_f32 v48, s45, v48
v_mfma_f32_16x16x32_bf16 v[100:103], v[16:19], v[196:199], 0
buffer_load_dwordx4 v11, s[24:27], s40 offen offset:1024 lds
v_mfma_f32_16x16x32_bf16 v[104:107], v[16:19], v[200:203], 0
v_mul_f32 v49, s45, v49
v_mul_f32 v50, s45, v50
v_mfma_f32_16x16x32_bf16 v[108:111], v[16:19], v[204:207], 0
v_mul_f32 v51, s45, v51
v_cvt_pk_bf16_f32 v226, v48, v49
v_mfma_f32_16x16x32_bf16 v[112:115], v[20:23], v[192:195], 0
ds_read_b128 v[16:19], v6 offset:0
v_cvt_pk_bf16_f32 v227, v50, v51
v_mfma_f32_16x16x32_bf16 v[116:119], v[20:23], v[196:199], 0
v_mul_f32 v36, s45, v36
v_mul_f32 v37, s45, v37
v_mfma_f32_16x16x32_bf16 v[120:123], v[20:23], v[200:203], 0
v_mul_f32 v38, s45, v38
v_mul_f32 v39, s45, v39
v_mfma_f32_16x16x32_bf16 v[124:127], v[20:23], v[204:207], 0
v_cvt_pk_bf16_f32 v228, v36, v37
v_cvt_pk_bf16_f32 v229, v38, v39
s_waitcnt lgkmcnt(1)
v_mfma_f32_16x16x32_bf16 v[96:99], v[24:27], v[208:211], v[96:99]
ds_read_b128 v[20:23], v6 offset:4096
v_mul_f32 v52, s45, v52
v_mfma_f32_16x16x32_bf16 v[100:103], v[24:27], v[212:215], v[100:103]
v_mul_f32 v53, s45, v53
v_mul_f32 v54, s45, v54
v_mfma_f32_16x16x32_bf16 v[104:107], v[24:27], v[216:219], v[104:107]
v_mul_f32 v55, s45, v55
v_cvt_pk_bf16_f32 v230, v52, v53
s_add_u32 m0, s46, 49152
v_mfma_f32_16x16x32_bf16 v[108:111], v[24:27], v[220:223], v[108:111]
v_cvt_pk_bf16_f32 v231, v54, v55
v_mul_f32 v40, s45, v40
s_add_u32 s40, s35, 49152
v_mfma_f32_16x16x32_bf16 v[112:115], v[28:31], v[208:211], v[112:115]
ds_read_b128 v[24:27], v7 offset:0
v_mul_f32 v41, s45, v41
v_mfma_f32_16x16x32_bf16 v[116:119], v[28:31], v[212:215], v[116:119]
v_mul_f32 v42, s45, v42
v_mul_f32 v43, s45, v43
v_mfma_f32_16x16x32_bf16 v[120:123], v[28:31], v[216:219], v[120:123]
v_cvt_pk_bf16_f32 v232, v40, v41
v_cvt_pk_bf16_f32 v233, v42, v43
v_mul_f32 v56, s45, v56
v_mul_f32 v57, s45, v57
v_mul_f32 v58, s45, v58
v_mul_f32 v59, s45, v59
v_cvt_pk_bf16_f32 v234, v56, v57
v_cvt_pk_bf16_f32 v235, v58, v59
v_mul_f32 v44, s45, v44
v_mul_f32 v45, s45, v45
v_mul_f32 v46, s45, v46
v_mul_f32 v47, s45, v47
v_cvt_pk_bf16_f32 v236, v44, v45
v_cvt_pk_bf16_f32 v237, v46, v47
v_mul_f32 v60, s45, v60
v_mul_f32 v61, s45, v61
v_mul_f32 v62, s45, v62
v_mul_f32 v63, s45, v63
v_cvt_pk_bf16_f32 v238, v60, v61
v_cvt_pk_bf16_f32 v239, v62, v63
v_mfma_f32_16x16x32_bf16 v[124:127], v[28:31], v[220:223], v[124:127]
buffer_load_dwordx4 v10, s[20:23], s40 offen lds
s_waitcnt lgkmcnt(1)
v_mfma_f32_16x16x32_bf16 v[96:99], v[16:19], v[224:227], v[96:99]
ds_read_b128 v[28:31], v7 offset:4096
v_mul_f32 v64, s45, v64
v_mfma_f32_16x16x32_bf16 v[100:103], v[16:19], v[228:231], v[100:103]
v_mul_f32 v65, s45, v65
v_mul_f32 v66, s45, v66
v_mfma_f32_16x16x32_bf16 v[104:107], v[16:19], v[232:235], v[104:107]
v_mul_f32 v67, s45, v67
v_cvt_pk_bf16_f32 v240, v64, v65
v_mfma_f32_16x16x32_bf16 v[108:111], v[16:19], v[236:239], v[108:111]
v_cvt_pk_bf16_f32 v241, v66, v67
v_mul_f32 v80, s45, v80
v_mfma_f32_16x16x32_bf16 v[112:115], v[20:23], v[224:227], v[112:115]
s_waitcnt vmcnt(22)
s_barrier
ds_read_b128 v[16:19], v4 offset:8192
v_mfma_f32_16x16x32_bf16 v[116:119], v[20:23], v[228:231], v[116:119]
v_mul_f32 v81, s45, v81
v_mul_f32 v82, s45, v82
v_mfma_f32_16x16x32_bf16 v[120:123], v[20:23], v[232:235], v[120:123]
v_mul_f32 v83, s45, v83
v_cvt_pk_bf16_f32 v242, v80, v81
v_cvt_pk_bf16_f32 v243, v82, v83
v_mul_f32 v68, s45, v68
v_mul_f32 v69, s45, v69
v_mul_f32 v70, s45, v70
v_mul_f32 v71, s45, v71
v_cvt_pk_bf16_f32 v244, v68, v69
v_cvt_pk_bf16_f32 v245, v70, v71
v_mul_f32 v84, s45, v84
v_mul_f32 v85, s45, v85
v_mul_f32 v86, s45, v86
v_mul_f32 v87, s45, v87
v_cvt_pk_bf16_f32 v246, v84, v85
v_cvt_pk_bf16_f32 v247, v86, v87
v_mul_f32 v72, s45, v72
v_mul_f32 v73, s45, v73
v_mul_f32 v74, s45, v74
v_mul_f32 v75, s45, v75
v_cvt_pk_bf16_f32 v248, v72, v73
v_cvt_pk_bf16_f32 v249, v74, v75
v_mul_f32 v88, s45, v88
v_mul_f32 v89, s45, v89
v_mul_f32 v90, s45, v90
v_mul_f32 v91, s45, v91
v_cvt_pk_bf16_f32 v250, v88, v89
v_cvt_pk_bf16_f32 v251, v90, v91
v_mul_f32 v76, s45, v76
v_mul_f32 v77, s45, v77
v_mul_f32 v78, s45, v78
v_mul_f32 v79, s45, v79
v_cvt_pk_bf16_f32 v252, v76, v77
v_cvt_pk_bf16_f32 v253, v78, v79
v_mul_f32 v92, s45, v92
v_mul_f32 v93, s45, v93
v_mul_f32 v94, s45, v94
v_mul_f32 v95, s45, v95
v_cvt_pk_bf16_f32 v254, v92, v93
v_cvt_pk_bf16_f32 v255, v94, v95
v_mfma_f32_16x16x32_bf16 v[124:127], v[20:23], v[236:239], v[124:127]
s_waitcnt lgkmcnt(1)
v_mfma_f32_16x16x32_bf16 v[96:99], v[24:27], v[240:243], v[96:99]
ds_read_b128 v[20:23], v5 offset:8192
v_mfma_f32_16x16x32_bf16 v[100:103], v[24:27], v[244:247], v[100:103]
buffer_load_dwordx4 v11, s[20:23], s40 offen offset:1024 lds
v_mfma_f32_16x16x32_bf16 v[104:107], v[24:27], v[248:251], v[104:107]
v_mfma_f32_16x16x32_bf16 v[108:111], v[24:27], v[252:255], v[108:111]
v_lshrrev_b32 v48, 4, v0
v_and_b32 v49, 15, v0
v_mfma_f32_16x16x32_bf16 v[112:115], v[28:31], v[240:243], v[112:115]
ds_read_b128 v[24:27], v6 offset:8192
v_lshrrev_b32 v50, 2, v49
v_mfma_f32_16x16x32_bf16 v[116:119], v[28:31], v[244:247], v[116:119]
v_and_b32 v51, 3, v49
v_lshl_add_u32 v52, v48, 2, v50
v_mfma_f32_16x16x32_bf16 v[120:123], v[28:31], v[248:251], v[120:123]
v_and_b32 v53, 7, v52
v_lshlrev_b32 v53, 1, v53
v_mfma_f32_16x16x32_bf16 v[124:127], v[28:31], v[252:255], v[124:127]
v_lshrrev_b32 v49, 1, v51
v_xor_b32 v53, v53, v49
s_waitcnt lgkmcnt(1)
v_mfma_f32_16x16x32_bf16 v[128:131], v[16:19], v[192:195], 0
ds_read_b128 v[28:31], v7 offset:8192
v_lshlrev_b32 v53, 4, v53
v_mfma_f32_16x16x32_bf16 v[132:135], v[16:19], v[196:199], 0
v_and_b32 v51, 1, v51
v_lshl_add_u32 v53, v51, 3, v53
v_mfma_f32_16x16x32_bf16 v[136:139], v[16:19], v[200:203], 0
s_add_u32 m0, s46, 98304
s_add_u32 s40, s35, 32768
v_lshl_add_u32 v53, v52, 8, v53
v_mfma_f32_16x16x32_bf16 v[140:143], v[16:19], v[204:207], 0
v_add_u32 v32, 0x10000, v53
v_xor_b32 v33, 32, v32
v_mfma_f32_16x16x32_bf16 v[128:131], v[20:23], v[208:211], v[128:131]
ds_read_b128 v[16:19], v4 offset:12288
v_xor_b32 v34, 64, v32
v_mfma_f32_16x16x32_bf16 v[132:135], v[20:23], v[212:215], v[132:135]
buffer_load_dwordx4 v10, s[24:27], s40 offen lds
v_mfma_f32_16x16x32_bf16 v[136:139], v[20:23], v[216:219], v[136:139]
v_exp_f32 v96, v96
v_mfma_f32_16x16x32_bf16 v[140:143], v[20:23], v[220:223], v[140:143]
v_exp_f32 v97, v97
s_waitcnt lgkmcnt(1)
v_mfma_f32_16x16x32_bf16 v[128:131], v[24:27], v[224:227], v[128:131]
ds_read_b128 v[20:23], v5 offset:12288
v_xor_b32 v35, 96, v32
v_mfma_f32_16x16x32_bf16 v[132:135], v[24:27], v[228:231], v[132:135]
v_exp_f32 v98, v98
v_mfma_f32_16x16x32_bf16 v[136:139], v[24:27], v[232:235], v[136:139]
v_exp_f32 v99, v99
v_mfma_f32_16x16x32_bf16 v[140:143], v[24:27], v[236:239], v[140:143]
v_exp_f32 v100, v100
v_mfma_f32_16x16x32_bf16 v[128:131], v[28:31], v[240:243], v[128:131]
ds_read_b128 v[24:27], v6 offset:12288
v_xor_b32 v36, 128, v32
v_mfma_f32_16x16x32_bf16 v[132:135], v[28:31], v[244:247], v[132:135]
v_exp_f32 v101, v101
v_mfma_f32_16x16x32_bf16 v[136:139], v[28:31], v[248:251], v[136:139]
v_xor_b32 v37, 160, v32
v_xor_b32 v38, 192, v32
v_mfma_f32_16x16x32_bf16 v[140:143], v[28:31], v[252:255], v[140:143]
v_xor_b32 v39, 224, v32
v_mov_b32 v54, 0x3f803f80
v_accvgpr_write_b32 a144, v54
v_accvgpr_write_b32 a145, v54
v_accvgpr_write_b32 a146, v54
v_accvgpr_write_b32 a147, v54
s_waitcnt lgkmcnt(1)
v_mfma_f32_16x16x32_bf16 v[144:147], v[16:19], v[192:195], 0
ds_read_b128 v[28:31], v7 offset:12288
v_cvt_pk_bf16_f32 v160, v96, v97
v_mfma_f32_16x16x32_bf16 v[148:151], v[16:19], v[196:199], 0
buffer_load_dwordx4 v11, s[24:27], s40 offen offset:1024 lds
v_mfma_f32_16x16x32_bf16 v[152:155], v[16:19], v[200:203], 0
v_exp_f32 v102, v102
v_mfma_f32_16x16x32_bf16 v[156:159], v[16:19], v[204:207], 0
v_exp_f32 v103, v103
v_mfma_f32_16x16x32_bf16 v[144:147], v[20:23], v[208:211], v[144:147]
s_waitcnt vmcnt(21)
s_barrier
ds_read_b128 v[16:19], v4 offset:16384
v_mfma_f32_16x16x32_bf16 v[148:151], v[20:23], v[212:215], v[148:151]
v_exp_f32 v104, v104
v_mfma_f32_16x16x32_bf16 v[152:155], v[20:23], v[216:219], v[152:155]
v_exp_f32 v105, v105
v_mfma_f32_16x16x32_bf16 v[156:159], v[20:23], v[220:223], v[156:159]
v_exp_f32 v106, v106
s_waitcnt lgkmcnt(1)
v_mfma_f32_16x16x32_bf16 v[144:147], v[24:27], v[224:227], v[144:147]
ds_read_b64_tr_b16 v[20:21], v32 offset:0
v_cvt_pk_bf16_f32 v161, v98, v99
v_mfma_f32_16x16x32_bf16 v[148:151], v[24:27], v[228:231], v[148:151]
ds_read_b64_tr_b16 v[22:23], v32 offset:4096
v_cvt_pk_bf16_f32 v164, v100, v101
v_mfma_f32_16x16x32_bf16 v[152:155], v[24:27], v[232:235], v[152:155]
v_exp_f32 v107, v107
s_add_u32 m0, s46, 57344
s_add_u32 s40, s35, 57344
v_mfma_f32_16x16x32_bf16 v[156:159], v[24:27], v[236:239], v[156:159]
v_exp_f32 v108, v108
v_mfma_f32_16x16x32_bf16 v[144:147], v[28:31], v[240:243], v[144:147]
ds_read_b128 v[24:27], v5 offset:16384
v_cvt_pk_bf16_f32 v165, v102, v103
v_mfma_f32_16x16x32_bf16 v[148:151], v[28:31], v[244:247], v[148:151]
v_exp_f32 v109, v109
v_mfma_f32_16x16x32_bf16 v[152:155], v[28:31], v[248:251], v[152:155]
v_exp_f32 v110, v110
v_cvt_pk_bf16_f32 v168, v104, v105
v_cvt_pk_bf16_f32 v169, v106, v107
v_exp_f32 v111, v111
v_cvt_pk_bf16_f32 v172, v108, v109
v_exp_f32 v112, v112
v_exp_f32 v113, v113
v_exp_f32 v114, v114
v_exp_f32 v115, v115
v_exp_f32 v116, v116
v_exp_f32 v117, v117
v_exp_f32 v118, v118
v_exp_f32 v119, v119
v_exp_f32 v120, v120
v_exp_f32 v121, v121
v_exp_f32 v122, v122
v_exp_f32 v123, v123
v_exp_f32 v124, v124
v_exp_f32 v125, v125
v_exp_f32 v126, v126
v_exp_f32 v127, v127
v_mfma_f32_16x16x32_bf16 v[156:159], v[28:31], v[252:255], v[156:159]
mk_L_A1:
buffer_load_dwordx4 v10, s[20:23], s40 offen lds
v_cvt_pk_bf16_f32 v173, v110, v111
v_cvt_pk_bf16_f32 v162, v112, v113
v_cvt_pk_bf16_f32 v163, v114, v115
v_cvt_pk_bf16_f32 v166, v116, v117
v_cvt_pk_bf16_f32 v167, v118, v119
v_cvt_pk_bf16_f32 v170, v120, v121
v_cvt_pk_bf16_f32 v171, v122, v123
v_cvt_pk_bf16_f32 v174, v124, v125
v_cvt_pk_bf16_f32 v175, v126, v127
s_waitcnt lgkmcnt(1)
v_mfma_f32_16x16x32_bf16 v[96:99], v[16:19], v[192:195], 0
ds_read_b64_tr_b16 v[28:29], v33 offset:0
v_mov_b32 v41, 268435456
v_mfma_f32_16x16x32_bf16 v[100:103], v[16:19], v[196:199], 0
ds_read_b64_tr_b16 v[30:31], v33 offset:4096
v_cmp_eq_u32 vcc, 0, v0
v_mfma_f32_16x16x32_bf16 v[104:107], v[16:19], v[200:203], 0
v_exp_f32 v128, v128
v_mfma_f32_16x16x32_bf16 v[108:111], v[16:19], v[204:207], 0
v_exp_f32 v129, v129
v_mfma_f32_16x16x32_bf16 a[0:3], v[20:23], v[160:163], 0
ds_read_b128 v[16:19], v6 offset:16384
v_cvt_pk_bf16_f32 v176, v128, v129
v_mfma_f32_16x16x32_bf16 a[4:7], v[20:23], v[164:167], 0
v_exp_f32 v130, v130
v_mfma_f32_16x16x32_bf16 a[8:11], v[20:23], v[168:171], 0
v_exp_f32 v131, v131
v_mfma_f32_16x16x32_bf16 a[12:15], v[20:23], v[172:175], 0
v_exp_f32 v132, v132
s_waitcnt lgkmcnt(1)
v_mfma_f32_16x16x32_bf16 v[96:99], v[24:27], v[208:211], v[96:99]
ds_read_b64_tr_b16 v[20:21], v34 offset:0
v_cvt_pk_bf16_f32 v177, v130, v131
v_mfma_f32_16x16x32_bf16 v[100:103], v[24:27], v[212:215], v[100:103]
ds_read_b64_tr_b16 v[22:23], v34 offset:4096
v_cndmask_b32 v40, v41, 0, vcc
v_mfma_f32_16x16x32_bf16 v[104:107], v[24:27], v[216:219], v[104:107]
buffer_load_dwordx4 v11, s[20:23], s40 offen offset:1024 lds
v_mfma_f32_16x16x32_bf16 v[108:111], v[24:27], v[220:223], v[108:111]
v_exp_f32 v133, v133
v_mfma_f32_16x16x32_bf16 a[16:19], v[28:31], v[160:163], 0
ds_read_b128 v[24:27], v7 offset:16384
v_cvt_pk_bf16_f32 v180, v132, v133
v_mfma_f32_16x16x32_bf16 a[20:23], v[28:31], v[164:167], 0
v_exp_f32 v134, v134
v_mfma_f32_16x16x32_bf16 a[24:27], v[28:31], v[168:171], 0
v_exp_f32 v135, v135
v_mfma_f32_16x16x32_bf16 a[28:31], v[28:31], v[172:175], 0
v_exp_f32 v136, v136
v_mfma_f32_16x16x32_bf16 a[128:131], a[144:147], v[160:163], 0
v_exp_f32 v137, v137
s_waitcnt lgkmcnt(1)
v_mfma_f32_16x16x32_bf16 v[96:99], v[16:19], v[224:227], v[96:99]
ds_read_b64_tr_b16 v[28:29], v35 offset:0
v_cvt_pk_bf16_f32 v181, v134, v135
v_mfma_f32_16x16x32_bf16 v[100:103], v[16:19], v[228:231], v[100:103]
ds_read_b64_tr_b16 v[30:31], v35 offset:4096
s_add_u32 m0, s46, 106496
v_cvt_pk_bf16_f32 v184, v136, v137
v_mfma_f32_16x16x32_bf16 v[104:107], v[16:19], v[232:235], v[104:107]
s_add_u32 s40, s35, 40960
v_exp_f32 v138, v138
v_mfma_f32_16x16x32_bf16 v[108:111], v[16:19], v[236:239], v[108:111]
v_exp_f32 v139, v139
v_mfma_f32_16x16x32_bf16 a[32:35], v[20:23], v[160:163], 0
ds_read_b128 v[16:19], v4 offset:20480
v_cvt_pk_bf16_f32 v185, v138, v139
v_mfma_f32_16x16x32_bf16 a[36:39], v[20:23], v[164:167], 0
buffer_load_dwordx4 v10, s[24:27], s40 offen lds
v_mfma_f32_16x16x32_bf16 a[40:43], v[20:23], v[168:171], 0
v_exp_f32 v140, v140
v_mfma_f32_16x16x32_bf16 a[44:47], v[20:23], v[172:175], 0
v_exp_f32 v141, v141
s_waitcnt lgkmcnt(1)
v_mfma_f32_16x16x32_bf16 v[96:99], v[24:27], v[240:243], v[96:99]
ds_read_b64_tr_b16 v[20:21], v36 offset:0
v_cvt_pk_bf16_f32 v188, v140, v141
v_mfma_f32_16x16x32_bf16 v[100:103], v[24:27], v[244:247], v[100:103]
ds_read_b64_tr_b16 v[22:23], v36 offset:4096
v_lshlrev_b32 v42, 2, v0
v_mfma_f32_16x16x32_bf16 v[104:107], v[24:27], v[248:251], v[104:107]
v_exp_f32 v142, v142
v_mfma_f32_16x16x32_bf16 v[108:111], v[24:27], v[252:255], v[108:111]
v_exp_f32 v143, v143
v_mfma_f32_16x16x32_bf16 a[48:51], v[28:31], v[160:163], 0
ds_read_b128 v[24:27], v5 offset:20480
v_cvt_pk_bf16_f32 v189, v142, v143
v_mfma_f32_16x16x32_bf16 a[52:55], v[28:31], v[164:167], 0
v_exp_f32 v144, v144
v_mfma_f32_16x16x32_bf16 a[56:59], v[28:31], v[168:171], 0
v_exp_f32 v145, v145
v_mfma_f32_16x16x32_bf16 a[60:63], v[28:31], v[172:175], 0
v_exp_f32 v146, v146
v_mfma_f32_16x16x32_bf16 a[132:135], a[144:147], v[164:167], 0
buffer_load_dwordx4 v11, s[24:27], s40 offen offset:1024 lds
s_waitcnt lgkmcnt(1)
v_mfma_f32_16x16x32_bf16 v[112:115], v[16:19], v[192:195], 0
ds_read_b64_tr_b16 v[28:29], v37 offset:0
v_cvt_pk_bf16_f32 v178, v144, v145
v_mfma_f32_16x16x32_bf16 v[116:119], v[16:19], v[196:199], 0
ds_read_b64_tr_b16 v[30:31], v37 offset:4096
v_cmp_gt_u32 vcc, 8, v0
v_mfma_f32_16x16x32_bf16 v[120:123], v[16:19], v[200:203], 0
v_exp_f32 v147, v147
v_mfma_f32_16x16x32_bf16 v[124:127], v[16:19], v[204:207], 0
v_exp_f32 v148, v148
v_mfma_f32_16x16x32_bf16 a[64:67], v[20:23], v[160:163], 0
ds_read_b128 v[16:19], v6 offset:20480
v_cvt_pk_bf16_f32 v179, v146, v147
v_mfma_f32_16x16x32_bf16 a[68:71], v[20:23], v[164:167], 0
v_exp_f32 v149, v149
v_mfma_f32_16x16x32_bf16 a[72:75], v[20:23], v[168:171], 0
v_exp_f32 v150, v150
v_mfma_f32_16x16x32_bf16 a[76:79], v[20:23], v[172:175], 0
v_exp_f32 v151, v151
s_waitcnt lgkmcnt(1)
v_mfma_f32_16x16x32_bf16 v[112:115], v[24:27], v[208:211], v[112:115]
ds_read_b64_tr_b16 v[20:21], v38 offset:0
s_add_u32 m0, s46, 0
v_cvt_pk_bf16_f32 v182, v148, v149
v_mfma_f32_16x16x32_bf16 v[116:119], v[24:27], v[212:215], v[116:119]
ds_read_b64_tr_b16 v[22:23], v38 offset:4096
s_add_u32 s40, s35, 65536
v_cvt_pk_bf16_f32 v183, v150, v151
v_mfma_f32_16x16x32_bf16 v[120:123], v[24:27], v[216:219], v[120:123]
v_exp_f32 v152, v152
v_mfma_f32_16x16x32_bf16 v[124:127], v[24:27], v[220:223], v[124:127]
buffer_load_dwordx4 v10, s[20:23], s40 offen lds
v_mfma_f32_16x16x32_bf16 a[80:83], v[28:31], v[160:163], 0
ds_read_b128 v[24:27], v7 offset:20480
v_cndmask_b32 v42, v41, v42, vcc
v_mfma_f32_16x16x32_bf16 a[84:87], v[28:31], v[164:167], 0
v_exp_f32 v153, v153
v_mfma_f32_16x16x32_bf16 a[88:91], v[28:31], v[168:171], 0
v_exp_f32 v154, v154
v_mfma_f32_16x16x32_bf16 a[92:95], v[28:31], v[172:175], 0
v_exp_f32 v155, v155
v_mfma_f32_16x16x32_bf16 a[136:139], a[144:147], v[168:171], 0
v_exp_f32 v156, v156
s_waitcnt lgkmcnt(1)
v_mfma_f32_16x16x32_bf16 v[112:115], v[16:19], v[224:227], v[112:115]
ds_read_b64_tr_b16 v[28:29], v39 offset:0
v_cvt_pk_bf16_f32 v186, v152, v153
v_mfma_f32_16x16x32_bf16 v[116:119], v[16:19], v[228:231], v[116:119]
ds_read_b64_tr_b16 v[30:31], v39 offset:4096
v_cvt_pk_bf16_f32 v187, v154, v155
v_mfma_f32_16x16x32_bf16 v[120:123], v[16:19], v[232:235], v[120:123]
v_exp_f32 v157, v157
v_mfma_f32_16x16x32_bf16 v[124:127], v[16:19], v[236:239], v[124:127]
v_exp_f32 v158, v158
v_mfma_f32_16x16x32_bf16 a[96:99], v[20:23], v[160:163], 0
s_waitcnt vmcnt(17)
s_barrier
ds_read_b128 v[16:19], v4 offset:24576
v_mfma_f32_16x16x32_bf16 a[100:103], v[20:23], v[164:167], 0
v_exp_f32 v159, v159
v_mfma_f32_16x16x32_bf16 a[104:107], v[20:23], v[168:171], 0
buffer_load_dwordx4 v11, s[20:23], s40 offen offset:1024 lds
v_mfma_f32_16x16x32_bf16 a[108:111], v[20:23], v[172:175], 0
v_cvt_pk_bf16_f32 v190, v156, v157
v_cvt_pk_bf16_f32 v191, v158, v159
s_waitcnt lgkmcnt(1)
v_mfma_f32_16x16x32_bf16 v[112:115], v[24:27], v[240:243], v[112:115]
ds_read_b64_tr_b16 v[20:21], v32 offset:8192
v_mov_b32 v41, s100
v_mfma_f32_16x16x32_bf16 v[116:119], v[24:27], v[244:247], v[116:119]
ds_read_b64_tr_b16 v[22:23], v32 offset:12288
v_mfma_f32_16x16x32_bf16 v[120:123], v[24:27], v[248:251], v[120:123]
v_mfma_f32_16x16x32_bf16 v[124:127], v[24:27], v[252:255], v[124:127]
v_mfma_f32_16x16x32_bf16 a[112:115], v[28:31], v[160:163], 0
ds_read_b128 v[24:27], v5 offset:24576
v_mfma_f32_16x16x32_bf16 a[116:119], v[28:31], v[164:167], 0
v_mfma_f32_16x16x32_bf16 a[120:123], v[28:31], v[168:171], 0
v_mfma_f32_16x16x32_bf16 a[124:127], v[28:31], v[172:175], 0
s_add_u32 m0, s46, 114688
s_add_u32 s40, s35, 49152
v_mfma_f32_16x16x32_bf16 a[140:143], a[144:147], v[172:175], 0
s_waitcnt lgkmcnt(1)
v_mfma_f32_16x16x32_bf16 v[128:131], v[16:19], v[192:195], 0
ds_read_b64_tr_b16 v[28:29], v33 offset:8192
v_mfma_f32_16x16x32_bf16 v[132:135], v[16:19], v[196:199], 0
ds_read_b64_tr_b16 v[30:31], v33 offset:12288
v_mfma_f32_16x16x32_bf16 v[136:139], v[16:19], v[200:203], 0
buffer_load_dwordx4 v10, s[24:27], s40 offen lds
v_mfma_f32_16x16x32_bf16 v[140:143], v[16:19], v[204:207], 0
v_exp_f32 v96, v96
v_mfma_f32_16x16x32_bf16 a[0:3], v[20:23], v[176:179], a[0:3]
ds_read_b128 v[16:19], v6 offset:24576
v_mfma_f32_16x16x32_bf16 a[4:7], v[20:23], v[180:183], a[4:7]
v_exp_f32 v97, v97
v_mfma_f32_16x16x32_bf16 a[8:11], v[20:23], v[184:187], a[8:11]
v_exp_f32 v98, v98
v_mfma_f32_16x16x32_bf16 a[12:15], v[20:23], v[188:191], a[12:15]
v_exp_f32 v99, v99
s_waitcnt lgkmcnt(1)
v_mfma_f32_16x16x32_bf16 v[128:131], v[24:27], v[208:211], v[128:131]
ds_read_b64_tr_b16 v[20:21], v34 offset:8192
v_cvt_pk_bf16_f32 v160, v96, v97
v_mfma_f32_16x16x32_bf16 v[132:135], v[24:27], v[212:215], v[132:135]
ds_read_b64_tr_b16 v[22:23], v34 offset:12288
v_cvt_pk_bf16_f32 v161, v98, v99
v_mfma_f32_16x16x32_bf16 v[136:139], v[24:27], v[216:219], v[136:139]
v_exp_f32 v100, v100
v_mfma_f32_16x16x32_bf16 v[140:143], v[24:27], v[220:223], v[140:143]
v_exp_f32 v101, v101
v_mfma_f32_16x16x32_bf16 a[16:19], v[28:31], v[176:179], a[16:19]
ds_read_b128 v[24:27], v7 offset:24576
v_cvt_pk_bf16_f32 v164, v100, v101
v_mfma_f32_16x16x32_bf16 a[20:23], v[28:31], v[180:183], a[20:23]
buffer_load_dwordx4 v11, s[24:27], s40 offen offset:1024 lds
v_mfma_f32_16x16x32_bf16 a[24:27], v[28:31], v[184:187], a[24:27]
v_exp_f32 v102, v102
v_mfma_f32_16x16x32_bf16 a[28:31], v[28:31], v[188:191], a[28:31]
v_exp_f32 v103, v103
v_mfma_f32_16x16x32_bf16 a[128:131], a[144:147], v[176:179], a[128:131]
v_exp_f32 v104, v104
s_waitcnt lgkmcnt(1)
v_mfma_f32_16x16x32_bf16 v[128:131], v[16:19], v[224:227], v[128:131]
ds_read_b64_tr_b16 v[28:29], v35 offset:8192
v_cvt_pk_bf16_f32 v165, v102, v103
v_mfma_f32_16x16x32_bf16 v[132:135], v[16:19], v[228:231], v[132:135]
ds_read_b64_tr_b16 v[30:31], v35 offset:12288
v_mfma_f32_16x16x32_bf16 v[136:139], v[16:19], v[232:235], v[136:139]
v_exp_f32 v105, v105
v_mfma_f32_16x16x32_bf16 v[140:143], v[16:19], v[236:239], v[140:143]
v_exp_f32 v106, v106
v_mfma_f32_16x16x32_bf16 a[32:35], v[20:23], v[176:179], a[32:35]
ds_read_b128 v[16:19], v4 offset:28672
v_cvt_pk_bf16_f32 v168, v104, v105
v_mfma_f32_16x16x32_bf16 a[36:39], v[20:23], v[180:183], a[36:39]
s_add_u32 m0, s46, 8192
s_add_u32 s40, s35, 73728
v_exp_f32 v107, v107
v_mfma_f32_16x16x32_bf16 a[40:43], v[20:23], v[184:187], a[40:43]
v_exp_f32 v108, v108
v_mfma_f32_16x16x32_bf16 a[44:47], v[20:23], v[188:191], a[44:47]
v_exp_f32 v109, v109
s_waitcnt lgkmcnt(1)
v_mfma_f32_16x16x32_bf16 v[128:131], v[24:27], v[240:243], v[128:131]
ds_read_b64_tr_b16 v[20:21], v36 offset:8192
v_cvt_pk_bf16_f32 v169, v106, v107
v_mfma_f32_16x16x32_bf16 v[132:135], v[24:27], v[244:247], v[132:135]
ds_read_b64_tr_b16 v[22:23], v36 offset:12288
v_cvt_pk_bf16_f32 v172, v108, v109
v_mfma_f32_16x16x32_bf16 v[136:139], v[24:27], v[248:251], v[136:139]
buffer_load_dwordx4 v10, s[20:23], s40 offen lds
v_mfma_f32_16x16x32_bf16 v[140:143], v[24:27], v[252:255], v[140:143]
v_exp_f32 v110, v110
v_mfma_f32_16x16x32_bf16 a[48:51], v[28:31], v[176:179], a[48:51]
ds_read_b128 v[24:27], v5 offset:28672
v_mfma_f32_16x16x32_bf16 a[52:55], v[28:31], v[180:183], a[52:55]
v_exp_f32 v111, v111
v_mfma_f32_16x16x32_bf16 a[56:59], v[28:31], v[184:187], a[56:59]
v_exp_f32 v112, v112
v_mfma_f32_16x16x32_bf16 a[60:63], v[28:31], v[188:191], a[60:63]
v_exp_f32 v113, v113
v_mfma_f32_16x16x32_bf16 a[132:135], a[144:147], v[180:183], a[132:135]
v_exp_f32 v114, v114
s_waitcnt lgkmcnt(1)
v_mfma_f32_16x16x32_bf16 v[144:147], v[16:19], v[192:195], 0
ds_read_b64_tr_b16 v[28:29], v37 offset:8192
v_cvt_pk_bf16_f32 v173, v110, v111
v_mfma_f32_16x16x32_bf16 v[148:151], v[16:19], v[196:199], 0
ds_read_b64_tr_b16 v[30:31], v37 offset:12288
v_cvt_pk_bf16_f32 v162, v112, v113
v_mfma_f32_16x16x32_bf16 v[152:155], v[16:19], v[200:203], 0
v_exp_f32 v115, v115
v_mfma_f32_16x16x32_bf16 v[156:159], v[16:19], v[204:207], 0
buffer_load_dwordx4 v11, s[20:23], s40 offen offset:1024 lds
v_mfma_f32_16x16x32_bf16 a[64:67], v[20:23], v[176:179], a[64:67]
ds_read_b128 v[16:19], v6 offset:28672
v_cvt_pk_bf16_f32 v163, v114, v115
v_mfma_f32_16x16x32_bf16 a[68:71], v[20:23], v[180:183], a[68:71]
v_exp_f32 v116, v116
v_mfma_f32_16x16x32_bf16 a[72:75], v[20:23], v[184:187], a[72:75]
v_exp_f32 v117, v117
v_mfma_f32_16x16x32_bf16 a[76:79], v[20:23], v[188:191], a[76:79]
v_exp_f32 v118, v118
s_waitcnt lgkmcnt(1)
v_mfma_f32_16x16x32_bf16 v[144:147], v[24:27], v[208:211], v[144:147]
ds_read_b64_tr_b16 v[20:21], v38 offset:8192
v_cvt_pk_bf16_f32 v166, v116, v117
v_mfma_f32_16x16x32_bf16 v[148:151], v[24:27], v[212:215], v[148:151]
ds_read_b64_tr_b16 v[22:23], v38 offset:12288
v_mfma_f32_16x16x32_bf16 v[152:155], v[24:27], v[216:219], v[152:155]
v_exp_f32 v119, v119
v_mfma_f32_16x16x32_bf16 v[156:159], v[24:27], v[220:223], v[156:159]
v_exp_f32 v120, v120
v_mfma_f32_16x16x32_bf16 a[80:83], v[28:31], v[176:179], a[80:83]
ds_read_b128 v[24:27], v7 offset:28672
s_add_u32 m0, s46, 122880
v_cvt_pk_bf16_f32 v167, v118, v119
v_mfma_f32_16x16x32_bf16 a[84:87], v[28:31], v[180:183], a[84:87]
s_add_u32 s40, s35, 57344
v_exp_f32 v121, v121
v_mfma_f32_16x16x32_bf16 a[88:91], v[28:31], v[184:187], a[88:91]
v_exp_f32 v122, v122
v_mfma_f32_16x16x32_bf16 a[92:95], v[28:31], v[188:191], a[92:95]
buffer_load_dwordx4 v10, s[24:27], s40 offen lds
v_mfma_f32_16x16x32_bf16 a[136:139], a[144:147], v[184:187], a[136:139]
v_exp_f32 v123, v123
s_waitcnt lgkmcnt(1)
v_mfma_f32_16x16x32_bf16 v[144:147], v[16:19], v[224:227], v[144:147]
ds_read_b64_tr_b16 v[28:29], v39 offset:8192
v_cvt_pk_bf16_f32 v170, v120, v121
v_mfma_f32_16x16x32_bf16 v[148:151], v[16:19], v[228:231], v[148:151]
ds_read_b64_tr_b16 v[30:31], v39 offset:12288
v_cvt_pk_bf16_f32 v171, v122, v123
v_mfma_f32_16x16x32_bf16 v[152:155], v[16:19], v[232:235], v[152:155]
v_exp_f32 v124, v124
v_mfma_f32_16x16x32_bf16 v[156:159], v[16:19], v[236:239], v[156:159]
v_exp_f32 v125, v125
v_mfma_f32_16x16x32_bf16 a[96:99], v[20:23], v[176:179], a[96:99]
s_waitcnt vmcnt(19)
s_barrier
ds_read_b128 v[16:19], v4 offset:32768
v_mfma_f32_16x16x32_bf16 a[100:103], v[20:23], v[180:183], a[100:103]
v_exp_f32 v126, v126
v_mfma_f32_16x16x32_bf16 a[104:107], v[20:23], v[184:187], a[104:107]
v_exp_f32 v127, v127
v_mfma_f32_16x16x32_bf16 a[108:111], v[20:23], v[188:191], a[108:111]
v_cvt_pk_bf16_f32 v174, v124, v125
v_cvt_pk_bf16_f32 v175, v126, v127
s_waitcnt lgkmcnt(1)
v_mfma_f32_16x16x32_bf16 v[144:147], v[24:27], v[240:243], v[144:147]
ds_read_b64_tr_b16 v[20:21], v32 offset:16384
v_mfma_f32_16x16x32_bf16 v[148:151], v[24:27], v[244:247], v[148:151]
ds_read_b64_tr_b16 v[22:23], v32 offset:20480
v_mfma_f32_16x16x32_bf16 v[152:155], v[24:27], v[248:251], v[152:155]
buffer_load_dwordx4 v11, s[24:27], s40 offen offset:1024 lds
v_mfma_f32_16x16x32_bf16 v[156:159], v[24:27], v[252:255], v[156:159]
v_mfma_f32_16x16x32_bf16 a[112:115], v[28:31], v[176:179], a[112:115]
ds_read_b128 v[24:27], v5 offset:32768
v_mfma_f32_16x16x32_bf16 a[116:119], v[28:31], v[180:183], a[116:119]
v_mfma_f32_16x16x32_bf16 a[120:123], v[28:31], v[184:187], a[120:123]
v_mfma_f32_16x16x32_bf16 a[124:127], v[28:31], v[188:191], a[124:127]
v_mfma_f32_16x16x32_bf16 a[140:143], a[144:147], v[188:191], a[140:143]
s_waitcnt lgkmcnt(1)
v_mfma_f32_16x16x32_bf16 v[96:99], v[16:19], v[192:195], 0
ds_read_b64_tr_b16 v[28:29], v33 offset:16384
v_mfma_f32_16x16x32_bf16 v[100:103], v[16:19], v[196:199], 0
ds_read_b64_tr_b16 v[30:31], v33 offset:20480
v_mfma_f32_16x16x32_bf16 v[104:107], v[16:19], v[200:203], 0
s_add_u32 m0, s46, 16384
s_add_u32 s40, s35, 81920
v_exp_f32 v128, v128
v_mfma_f32_16x16x32_bf16 v[108:111], v[16:19], v[204:207], 0
v_exp_f32 v129, v129
v_mfma_f32_16x16x32_bf16 a[0:3], v[20:23], v[160:163], a[0:3]
ds_read_b128 v[16:19], v6 offset:32768
v_cvt_pk_bf16_f32 v176, v128, v129
v_mfma_f32_16x16x32_bf16 a[4:7], v[20:23], v[164:167], a[4:7]
buffer_load_dwordx4 v10, s[20:23], s40 offen lds
v_mfma_f32_16x16x32_bf16 a[8:11], v[20:23], v[168:171], a[8:11]
v_exp_f32 v130, v130
v_mfma_f32_16x16x32_bf16 a[12:15], v[20:23], v[172:175], a[12:15]
v_exp_f32 v131, v131
s_waitcnt lgkmcnt(1)
v_mfma_f32_16x16x32_bf16 v[96:99], v[24:27], v[208:211], v[96:99]
ds_read_b64_tr_b16 v[20:21], v34 offset:16384
v_cvt_pk_bf16_f32 v177, v130, v131
v_mfma_f32_16x16x32_bf16 v[100:103], v[24:27], v[212:215], v[100:103]
ds_read_b64_tr_b16 v[22:23], v34 offset:20480
v_mfma_f32_16x16x32_bf16 v[104:107], v[24:27], v[216:219], v[104:107]
v_exp_f32 v132, v132
v_mfma_f32_16x16x32_bf16 v[108:111], v[24:27], v[220:223], v[108:111]
v_exp_f32 v133, v133
v_mfma_f32_16x16x32_bf16 a[16:19], v[28:31], v[160:163], a[16:19]
ds_read_b128 v[24:27], v7 offset:32768
v_cvt_pk_bf16_f32 v180, v132, v133
v_mfma_f32_16x16x32_bf16 a[20:23], v[28:31], v[164:167], a[20:23]
v_exp_f32 v134, v134
v_mfma_f32_16x16x32_bf16 a[24:27], v[28:31], v[168:171], a[24:27]
v_exp_f32 v135, v135
v_mfma_f32_16x16x32_bf16 a[28:31], v[28:31], v[172:175], a[28:31]
v_exp_f32 v136, v136
v_mfma_f32_16x16x32_bf16 a[128:131], a[144:147], v[160:163], a[128:131]
v_exp_f32 v137, v137
s_waitcnt lgkmcnt(1)
v_mfma_f32_16x16x32_bf16 v[96:99], v[16:19], v[224:227], v[96:99]
ds_read_b64_tr_b16 v[28:29], v35 offset:16384
v_cvt_pk_bf16_f32 v181, v134, v135
v_mfma_f32_16x16x32_bf16 v[100:103], v[16:19], v[228:231], v[100:103]
ds_read_b64_tr_b16 v[30:31], v35 offset:20480
v_cvt_pk_bf16_f32 v184, v136, v137
v_mfma_f32_16x16x32_bf16 v[104:107], v[16:19], v[232:235], v[104:107]
buffer_load_dwordx4 v11, s[20:23], s40 offen offset:1024 lds
v_mfma_f32_16x16x32_bf16 v[108:111], v[16:19], v[236:239], v[108:111]
v_exp_f32 v138, v138
v_mfma_f32_16x16x32_bf16 a[32:35], v[20:23], v[160:163], a[32:35]
ds_read_b128 v[16:19], v4 offset:36864
v_mfma_f32_16x16x32_bf16 a[36:39], v[20:23], v[164:167], a[36:39]
v_exp_f32 v139, v139
v_mfma_f32_16x16x32_bf16 a[40:43], v[20:23], v[168:171], a[40:43]
v_exp_f32 v140, v140
v_mfma_f32_16x16x32_bf16 a[44:47], v[20:23], v[172:175], a[44:47]
v_exp_f32 v141, v141
s_waitcnt lgkmcnt(1)
v_mfma_f32_16x16x32_bf16 v[96:99], v[24:27], v[240:243], v[96:99]
ds_read_b64_tr_b16 v[20:21], v36 offset:16384
v_cvt_pk_bf16_f32 v185, v138, v139
v_mfma_f32_16x16x32_bf16 v[100:103], v[24:27], v[244:247], v[100:103]
ds_read_b64_tr_b16 v[22:23], v36 offset:20480
s_add_u32 m0, s46, 65536
v_cvt_pk_bf16_f32 v188, v140, v141
v_mfma_f32_16x16x32_bf16 v[104:107], v[24:27], v[248:251], v[104:107]
s_add_u32 s40, s35, 65536
v_exp_f32 v142, v142
v_mfma_f32_16x16x32_bf16 v[108:111], v[24:27], v[252:255], v[108:111]
v_exp_f32 v143, v143
v_mfma_f32_16x16x32_bf16 a[48:51], v[28:31], v[160:163], a[48:51]
ds_read_b128 v[24:27], v5 offset:36864
v_cvt_pk_bf16_f32 v189, v142, v143
v_mfma_f32_16x16x32_bf16 a[52:55], v[28:31], v[164:167], a[52:55]
buffer_load_dwordx4 v10, s[24:27], s40 offen lds
v_mfma_f32_16x16x32_bf16 a[56:59], v[28:31], v[168:171], a[56:59]
v_exp_f32 v144, v144
v_mfma_f32_16x16x32_bf16 a[60:63], v[28:31], v[172:175], a[60:63]
v_exp_f32 v145, v145
v_mfma_f32_16x16x32_bf16 a[132:135], a[144:147], v[164:167], a[132:135]
v_exp_f32 v146, v146
s_waitcnt lgkmcnt(1)
v_mfma_f32_16x16x32_bf16 v[112:115], v[16:19], v[192:195], 0
ds_read_b64_tr_b16 v[28:29], v37 offset:16384
v_cvt_pk_bf16_f32 v178, v144, v145
v_mfma_f32_16x16x32_bf16 v[116:119], v[16:19], v[196:199], 0
ds_read_b64_tr_b16 v[30:31], v37 offset:20480
v_mfma_f32_16x16x32_bf16 v[120:123], v[16:19], v[200:203], 0
v_exp_f32 v147, v147
v_mfma_f32_16x16x32_bf16 v[124:127], v[16:19], v[204:207], 0
v_exp_f32 v148, v148
v_mfma_f32_16x16x32_bf16 a[64:67], v[20:23], v[160:163], a[64:67]
ds_read_b128 v[16:19], v6 offset:36864
v_cvt_pk_bf16_f32 v179, v146, v147
v_mfma_f32_16x16x32_bf16 a[68:71], v[20:23], v[164:167], a[68:71]
v_exp_f32 v149, v149
v_mfma_f32_16x16x32_bf16 a[72:75], v[20:23], v[168:171], a[72:75]
v_exp_f32 v150, v150
v_mfma_f32_16x16x32_bf16 a[76:79], v[20:23], v[172:175], a[76:79]
buffer_load_dwordx4 v11, s[24:27], s40 offen offset:1024 lds
s_waitcnt lgkmcnt(1)
v_mfma_f32_16x16x32_bf16 v[112:115], v[24:27], v[208:211], v[112:115]
ds_read_b64_tr_b16 v[20:21], v38 offset:16384
v_cvt_pk_bf16_f32 v182, v148, v149
v_mfma_f32_16x16x32_bf16 v[116:119], v[24:27], v[212:215], v[116:119]
ds_read_b64_tr_b16 v[22:23], v38 offset:20480
v_mfma_f32_16x16x32_bf16 v[120:123], v[24:27], v[216:219], v[120:123]
v_exp_f32 v151, v151
v_mfma_f32_16x16x32_bf16 v[124:127], v[24:27], v[220:223], v[124:127]
v_exp_f32 v152, v152
v_mfma_f32_16x16x32_bf16 a[80:83], v[28:31], v[160:163], a[80:83]
ds_read_b128 v[24:27], v7 offset:36864
v_cvt_pk_bf16_f32 v183, v150, v151
v_mfma_f32_16x16x32_bf16 a[84:87], v[28:31], v[164:167], a[84:87]
v_exp_f32 v153, v153
v_mfma_f32_16x16x32_bf16 a[88:91], v[28:31], v[168:171], a[88:91]
v_exp_f32 v154, v154
v_mfma_f32_16x16x32_bf16 a[92:95], v[28:31], v[172:175], a[92:95]
v_exp_f32 v155, v155
v_mfma_f32_16x16x32_bf16 a[136:139], a[144:147], v[168:171], a[136:139]
v_exp_f32 v156, v156
s_waitcnt lgkmcnt(1)
v_mfma_f32_16x16x32_bf16 v[112:115], v[16:19], v[224:227], v[112:115]
ds_read_b64_tr_b16 v[28:29], v39 offset:16384
v_cvt_pk_bf16_f32 v186, v152, v153
v_mfma_f32_16x16x32_bf16 v[116:119], v[16:19], v[228:231], v[116:119]
ds_read_b64_tr_b16 v[30:31], v39 offset:20480
v_cvt_pk_bf16_f32 v187, v154, v155
v_mfma_f32_16x16x32_bf16 v[120:123], v[16:19], v[232:235], v[120:123]
v_exp_f32 v157, v157
v_mfma_f32_16x16x32_bf16 v[124:127], v[16:19], v[236:239], v[124:127]
v_exp_f32 v158, v158
v_mfma_f32_16x16x32_bf16 a[96:99], v[20:23], v[160:163], a[96:99]
s_waitcnt vmcnt(20)
s_barrier
ds_read_b128 v[16:19], v4 offset:40960
v_mfma_f32_16x16x32_bf16 a[100:103], v[20:23], v[164:167], a[100:103]
s_add_u32 m0, s46, 24576
s_add_u32 s40, s35, 90112
buffer_load_dwordx4 v10, s[20:23], s40 offen lds
v_mfma_f32_16x16x32_bf16 a[104:107], v[20:23], v[168:171], a[104:107]
v_exp_f32 v159, v159
v_mfma_f32_16x16x32_bf16 a[108:111], v[20:23], v[172:175], a[108:111]
v_cvt_pk_bf16_f32 v190, v156, v157
v_cvt_pk_bf16_f32 v191, v158, v159
s_waitcnt lgkmcnt(1)
v_mfma_f32_16x16x32_bf16 v[112:115], v[24:27], v[240:243], v[112:115]
ds_read_b64_tr_b16 v[20:21], v32 offset:24576
v_mfma_f32_16x16x32_bf16 v[116:119], v[24:27], v[244:247], v[116:119]
ds_read_b64_tr_b16 v[22:23], v32 offset:28672
v_mfma_f32_16x16x32_bf16 v[120:123], v[24:27], v[248:251], v[120:123]
v_mfma_f32_16x16x32_bf16 v[124:127], v[24:27], v[252:255], v[124:127]
v_mfma_f32_16x16x32_bf16 a[112:115], v[28:31], v[160:163], a[112:115]
ds_read_b128 v[24:27], v5 offset:40960
v_mfma_f32_16x16x32_bf16 a[116:119], v[28:31], v[164:167], a[116:119]
v_mfma_f32_16x16x32_bf16 a[120:123], v[28:31], v[168:171], a[120:123]
v_mfma_f32_16x16x32_bf16 a[124:127], v[28:31], v[172:175], a[124:127]
v_mfma_f32_16x16x32_bf16 a[140:143], a[144:147], v[172:175], a[140:143]
s_waitcnt lgkmcnt(1)
v_mfma_f32_16x16x32_bf16 v[128:131], v[16:19], v[192:195], 0
ds_read_b64_tr_b16 v[28:29], v33 offset:24576
v_mfma_f32_16x16x32_bf16 v[132:135], v[16:19], v[196:199], 0
ds_read_b64_tr_b16 v[30:31], v33 offset:28672
v_mfma_f32_16x16x32_bf16 v[136:139], v[16:19], v[200:203], 0
buffer_load_dwordx4 v11, s[20:23], s40 offen offset:1024 lds
v_mfma_f32_16x16x32_bf16 v[140:143], v[16:19], v[204:207], 0
v_exp_f32 v96, v96
v_mfma_f32_16x16x32_bf16 a[0:3], v[20:23], v[176:179], a[0:3]
ds_read_b128 v[16:19], v6 offset:40960
v_mfma_f32_16x16x32_bf16 a[4:7], v[20:23], v[180:183], a[4:7]
v_exp_f32 v97, v97
v_mfma_f32_16x16x32_bf16 a[8:11], v[20:23], v[184:187], a[8:11]
v_exp_f32 v98, v98
v_mfma_f32_16x16x32_bf16 a[12:15], v[20:23], v[188:191], a[12:15]
v_exp_f32 v99, v99
s_waitcnt lgkmcnt(1)
v_mfma_f32_16x16x32_bf16 v[128:131], v[24:27], v[208:211], v[128:131]
ds_read_b64_tr_b16 v[20:21], v34 offset:24576
v_cvt_pk_bf16_f32 v160, v96, v97
v_mfma_f32_16x16x32_bf16 v[132:135], v[24:27], v[212:215], v[132:135]
ds_read_b64_tr_b16 v[22:23], v34 offset:28672
s_add_u32 m0, s46, 73728
v_cvt_pk_bf16_f32 v161, v98, v99
v_mfma_f32_16x16x32_bf16 v[136:139], v[24:27], v[216:219], v[136:139]
s_add_u32 s40, s35, 73728
v_exp_f32 v100, v100
v_mfma_f32_16x16x32_bf16 v[140:143], v[24:27], v[220:223], v[140:143]
v_exp_f32 v101, v101
v_mfma_f32_16x16x32_bf16 a[16:19], v[28:31], v[176:179], a[16:19]
ds_read_b128 v[24:27], v7 offset:40960
v_cvt_pk_bf16_f32 v164, v100, v101
v_mfma_f32_16x16x32_bf16 a[20:23], v[28:31], v[180:183], a[20:23]
buffer_load_dwordx4 v10, s[24:27], s40 offen lds
v_mfma_f32_16x16x32_bf16 a[24:27], v[28:31], v[184:187], a[24:27]
v_exp_f32 v102, v102
v_mfma_f32_16x16x32_bf16 a[28:31], v[28:31], v[188:191], a[28:31]
v_exp_f32 v103, v103
v_mfma_f32_16x16x32_bf16 a[128:131], a[144:147], v[176:179], a[128:131]
v_exp_f32 v104, v104
s_waitcnt lgkmcnt(1)
v_mfma_f32_16x16x32_bf16 v[128:131], v[16:19], v[224:227], v[128:131]
ds_read_b64_tr_b16 v[28:29], v35 offset:24576
v_cvt_pk_bf16_f32 v165, v102, v103
v_mfma_f32_16x16x32_bf16 v[132:135], v[16:19], v[228:231], v[132:135]
ds_read_b64_tr_b16 v[30:31], v35 offset:28672
v_mfma_f32_16x16x32_bf16 v[136:139], v[16:19], v[232:235], v[136:139]
v_exp_f32 v105, v105
v_mfma_f32_16x16x32_bf16 v[140:143], v[16:19], v[236:239], v[140:143]
v_exp_f32 v106, v106
v_mfma_f32_16x16x32_bf16 a[32:35], v[20:23], v[176:179], a[32:35]
ds_read_b128 v[16:19], v4 offset:45056
v_cvt_pk_bf16_f32 v168, v104, v105
v_mfma_f32_16x16x32_bf16 a[36:39], v[20:23], v[180:183], a[36:39]
v_exp_f32 v107, v107
v_mfma_f32_16x16x32_bf16 a[40:43], v[20:23], v[184:187], a[40:43]
v_exp_f32 v108, v108
v_mfma_f32_16x16x32_bf16 a[44:47], v[20:23], v[188:191], a[44:47]
buffer_load_dwordx4 v11, s[24:27], s40 offen offset:1024 lds
s_waitcnt lgkmcnt(1)
v_mfma_f32_16x16x32_bf16 v[128:131], v[24:27], v[240:243], v[128:131]
ds_read_b64_tr_b16 v[20:21], v36 offset:24576
v_cvt_pk_bf16_f32 v169, v106, v107
v_mfma_f32_16x16x32_bf16 v[132:135], v[24:27], v[244:247], v[132:135]
ds_read_b64_tr_b16 v[22:23], v36 offset:28672
v_mfma_f32_16x16x32_bf16 v[136:139], v[24:27], v[248:251], v[136:139]
v_exp_f32 v109, v109
v_mfma_f32_16x16x32_bf16 v[140:143], v[24:27], v[252:255], v[140:143]
v_exp_f32 v110, v110
v_mfma_f32_16x16x32_bf16 a[48:51], v[28:31], v[176:179], a[48:51]
ds_read_b128 v[24:27], v5 offset:45056
v_cvt_pk_bf16_f32 v172, v108, v109
v_mfma_f32_16x16x32_bf16 a[52:55], v[28:31], v[180:183], a[52:55]
v_exp_f32 v111, v111
v_mfma_f32_16x16x32_bf16 a[56:59], v[28:31], v[184:187], a[56:59]
v_exp_f32 v112, v112
v_mfma_f32_16x16x32_bf16 a[60:63], v[28:31], v[188:191], a[60:63]
v_exp_f32 v113, v113
v_mfma_f32_16x16x32_bf16 a[132:135], a[144:147], v[180:183], a[132:135]
v_exp_f32 v114, v114
s_waitcnt lgkmcnt(1)
v_mfma_f32_16x16x32_bf16 v[144:147], v[16:19], v[192:195], 0
ds_read_b64_tr_b16 v[28:29], v37 offset:24576
v_cvt_pk_bf16_f32 v173, v110, v111
v_mfma_f32_16x16x32_bf16 v[148:151], v[16:19], v[196:199], 0
ds_read_b64_tr_b16 v[30:31], v37 offset:28672
v_cvt_pk_bf16_f32 v162, v112, v113
v_mfma_f32_16x16x32_bf16 v[152:155], v[16:19], v[200:203], 0
v_exp_f32 v115, v115
v_mfma_f32_16x16x32_bf16 v[156:159], v[16:19], v[204:207], 0
v_exp_f32 v116, v116
v_mfma_f32_16x16x32_bf16 a[64:67], v[20:23], v[176:179], a[64:67]
ds_read_b128 v[16:19], v6 offset:45056
v_cvt_pk_bf16_f32 v163, v114, v115
v_mfma_f32_16x16x32_bf16 a[68:71], v[20:23], v[180:183], a[68:71]
v_exp_f32 v117, v117
v_mfma_f32_16x16x32_bf16 a[72:75], v[20:23], v[184:187], a[72:75]
v_exp_f32 v118, v118
v_mfma_f32_16x16x32_bf16 a[76:79], v[20:23], v[188:191], a[76:79]
v_exp_f32 v119, v119
s_waitcnt lgkmcnt(1)
v_mfma_f32_16x16x32_bf16 v[144:147], v[24:27], v[208:211], v[144:147]
ds_read_b64_tr_b16 v[20:21], v38 offset:24576
v_cvt_pk_bf16_f32 v166, v116, v117
v_mfma_f32_16x16x32_bf16 v[148:151], v[24:27], v[212:215], v[148:151]
ds_read_b64_tr_b16 v[22:23], v38 offset:28672
v_cvt_pk_bf16_f32 v167, v118, v119
v_mfma_f32_16x16x32_bf16 v[152:155], v[24:27], v[216:219], v[152:155]
v_exp_f32 v120, v120
v_mfma_f32_16x16x32_bf16 v[156:159], v[24:27], v[220:223], v[156:159]
v_exp_f32 v121, v121
v_mfma_f32_16x16x32_bf16 a[80:83], v[28:31], v[176:179], a[80:83]
ds_read_b128 v[24:27], v7 offset:45056
v_cvt_pk_bf16_f32 v170, v120, v121
v_mfma_f32_16x16x32_bf16 a[84:87], v[28:31], v[180:183], a[84:87]
v_exp_f32 v122, v122
v_mfma_f32_16x16x32_bf16 a[88:91], v[28:31], v[184:187], a[88:91]
v_exp_f32 v123, v123
v_mfma_f32_16x16x32_bf16 a[92:95], v[28:31], v[188:191], a[92:95]
v_exp_f32 v124, v124
v_mfma_f32_16x16x32_bf16 a[136:139], a[144:147], v[184:187], a[136:139]
v_exp_f32 v125, v125
s_waitcnt lgkmcnt(1)
v_mfma_f32_16x16x32_bf16 v[144:147], v[16:19], v[224:227], v[144:147]
ds_read_b64_tr_b16 v[28:29], v39 offset:24576
v_cvt_pk_bf16_f32 v171, v122, v123
v_mfma_f32_16x16x32_bf16 v[148:151], v[16:19], v[228:231], v[148:151]
ds_read_b64_tr_b16 v[30:31], v39 offset:28672
v_cvt_pk_bf16_f32 v174, v124, v125
v_mfma_f32_16x16x32_bf16 v[152:155], v[16:19], v[232:235], v[152:155]
v_exp_f32 v126, v126
v_mfma_f32_16x16x32_bf16 v[156:159], v[16:19], v[236:239], v[156:159]
v_exp_f32 v127, v127
v_mfma_f32_16x16x32_bf16 a[96:99], v[20:23], v[176:179], a[96:99]
s_waitcnt vmcnt(20)
s_barrier
ds_read_b128 v[16:19], v4 offset:49152
v_mfma_f32_16x16x32_bf16 a[100:103], v[20:23], v[180:183], a[100:103]
s_add_u32 m0, s46, 32768
s_add_u32 s40, s35, 98304
buffer_load_dwordx4 v10, s[20:23], s40 offen lds
v_mfma_f32_16x16x32_bf16 a[104:107], v[20:23], v[184:187], a[104:107]
v_cvt_pk_bf16_f32 v175, v126, v127
v_mfma_f32_16x16x32_bf16 a[108:111], v[20:23], v[188:191], a[108:111]
s_waitcnt lgkmcnt(1)
v_mfma_f32_16x16x32_bf16 v[144:147], v[24:27], v[240:243], v[144:147]
ds_read_b64_tr_b16 v[20:21], v32 offset:32768
v_mfma_f32_16x16x32_bf16 v[148:151], v[24:27], v[244:247], v[148:151]
ds_read_b64_tr_b16 v[22:23], v32 offset:36864
v_mfma_f32_16x16x32_bf16 v[152:155], v[24:27], v[248:251], v[152:155]
v_mfma_f32_16x16x32_bf16 v[156:159], v[24:27], v[252:255], v[156:159]
v_mfma_f32_16x16x32_bf16 a[112:115], v[28:31], v[176:179], a[112:115]
ds_read_b128 v[24:27], v5 offset:49152
v_mfma_f32_16x16x32_bf16 a[116:119], v[28:31], v[180:183], a[116:119]
v_mfma_f32_16x16x32_bf16 a[120:123], v[28:31], v[184:187], a[120:123]
v_mfma_f32_16x16x32_bf16 a[124:127], v[28:31], v[188:191], a[124:127]
v_mfma_f32_16x16x32_bf16 a[140:143], a[144:147], v[188:191], a[140:143]
buffer_store_dword v41, v40, s[8:11], s63 offen sc1
s_waitcnt lgkmcnt(1)
v_mfma_f32_16x16x32_bf16 v[96:99], v[16:19], v[192:195], 0
ds_read_b64_tr_b16 v[28:29], v33 offset:32768
v_mfma_f32_16x16x32_bf16 v[100:103], v[16:19], v[196:199], 0
ds_read_b64_tr_b16 v[30:31], v33 offset:36864
v_mfma_f32_16x16x32_bf16 v[104:107], v[16:19], v[200:203], 0
buffer_load_dwordx4 v11, s[20:23], s40 offen offset:1024 lds
v_mfma_f32_16x16x32_bf16 v[108:111], v[16:19], v[204:207], 0
v_exp_f32 v128, v128
v_mfma_f32_16x16x32_bf16 a[0:3], v[20:23], v[160:163], a[0:3]
ds_read_b128 v[16:19], v6 offset:49152
v_mfma_f32_16x16x32_bf16 a[4:7], v[20:23], v[164:167], a[4:7]
v_exp_f32 v129, v129
v_mfma_f32_16x16x32_bf16 a[8:11], v[20:23], v[168:171], a[8:11]
v_exp_f32 v130, v130
v_mfma_f32_16x16x32_bf16 a[12:15], v[20:23], v[172:175], a[12:15]
v_exp_f32 v131, v131
s_waitcnt lgkmcnt(1)
v_mfma_f32_16x16x32_bf16 v[96:99], v[24:27], v[208:211], v[96:99]
ds_read_b64_tr_b16 v[20:21], v34 offset:32768
v_cvt_pk_bf16_f32 v176, v128, v129
v_mfma_f32_16x16x32_bf16 v[100:103], v[24:27], v[212:215], v[100:103]
ds_read_b64_tr_b16 v[22:23], v34 offset:36864
s_add_u32 m0, s46, 81920
v_cvt_pk_bf16_f32 v177, v130, v131
v_mfma_f32_16x16x32_bf16 v[104:107], v[24:27], v[216:219], v[104:107]
s_add_u32 s40, s35, 81920
v_exp_f32 v132, v132
v_mfma_f32_16x16x32_bf16 v[108:111], v[24:27], v[220:223], v[108:111]
v_exp_f32 v133, v133
v_mfma_f32_16x16x32_bf16 a[16:19], v[28:31], v[160:163], a[16:19]
ds_read_b128 v[24:27], v7 offset:49152
v_cvt_pk_bf16_f32 v180, v132, v133
v_mfma_f32_16x16x32_bf16 a[20:23], v[28:31], v[164:167], a[20:23]
buffer_load_dwordx4 v10, s[24:27], s40 offen lds
v_mfma_f32_16x16x32_bf16 a[24:27], v[28:31], v[168:171], a[24:27]
v_exp_f32 v134, v134
v_mfma_f32_16x16x32_bf16 a[28:31], v[28:31], v[172:175], a[28:31]
v_exp_f32 v135, v135
v_mfma_f32_16x16x32_bf16 a[128:131], a[144:147], v[160:163], a[128:131]
v_exp_f32 v136, v136
s_waitcnt lgkmcnt(1)
v_mfma_f32_16x16x32_bf16 v[96:99], v[16:19], v[224:227], v[96:99]
ds_read_b64_tr_b16 v[28:29], v35 offset:32768
v_cvt_pk_bf16_f32 v181, v134, v135
v_mfma_f32_16x16x32_bf16 v[100:103], v[16:19], v[228:231], v[100:103]
ds_read_b64_tr_b16 v[30:31], v35 offset:36864
v_mfma_f32_16x16x32_bf16 v[104:107], v[16:19], v[232:235], v[104:107]
v_exp_f32 v137, v137
v_mfma_f32_16x16x32_bf16 v[108:111], v[16:19], v[236:239], v[108:111]
v_exp_f32 v138, v138
v_mfma_f32_16x16x32_bf16 a[32:35], v[20:23], v[160:163], a[32:35]
ds_read_b128 v[16:19], v4 offset:53248
v_cvt_pk_bf16_f32 v184, v136, v137
v_mfma_f32_16x16x32_bf16 a[36:39], v[20:23], v[164:167], a[36:39]
v_exp_f32 v139, v139
v_mfma_f32_16x16x32_bf16 a[40:43], v[20:23], v[168:171], a[40:43]
v_exp_f32 v140, v140
v_mfma_f32_16x16x32_bf16 a[44:47], v[20:23], v[172:175], a[44:47]
buffer_load_dwordx4 v11, s[24:27], s40 offen offset:1024 lds
s_waitcnt lgkmcnt(1)
v_mfma_f32_16x16x32_bf16 v[96:99], v[24:27], v[240:243], v[96:99]
ds_read_b64_tr_b16 v[20:21], v36 offset:32768
v_cvt_pk_bf16_f32 v185, v138, v139
v_mfma_f32_16x16x32_bf16 v[100:103], v[24:27], v[244:247], v[100:103]
ds_read_b64_tr_b16 v[22:23], v36 offset:36864
v_mfma_f32_16x16x32_bf16 v[104:107], v[24:27], v[248:251], v[104:107]
v_exp_f32 v141, v141
v_mfma_f32_16x16x32_bf16 v[108:111], v[24:27], v[252:255], v[108:111]
v_exp_f32 v142, v142
v_mfma_f32_16x16x32_bf16 a[48:51], v[28:31], v[160:163], a[48:51]
ds_read_b128 v[24:27], v5 offset:53248
v_cvt_pk_bf16_f32 v188, v140, v141
v_mfma_f32_16x16x32_bf16 a[52:55], v[28:31], v[164:167], a[52:55]
v_exp_f32 v143, v143
v_mfma_f32_16x16x32_bf16 a[56:59], v[28:31], v[168:171], a[56:59]
v_exp_f32 v144, v144
v_mfma_f32_16x16x32_bf16 a[60:63], v[28:31], v[172:175], a[60:63]
v_exp_f32 v145, v145
v_mfma_f32_16x16x32_bf16 a[132:135], a[144:147], v[164:167], a[132:135]
v_exp_f32 v146, v146
s_waitcnt lgkmcnt(1)
v_mfma_f32_16x16x32_bf16 v[112:115], v[16:19], v[192:195], 0
ds_read_b64_tr_b16 v[28:29], v37 offset:32768
v_cvt_pk_bf16_f32 v189, v142, v143
v_mfma_f32_16x16x32_bf16 v[116:119], v[16:19], v[196:199], 0
ds_read_b64_tr_b16 v[30:31], v37 offset:36864
v_cvt_pk_bf16_f32 v178, v144, v145
v_mfma_f32_16x16x32_bf16 v[120:123], v[16:19], v[200:203], 0
v_exp_f32 v147, v147
v_mfma_f32_16x16x32_bf16 v[124:127], v[16:19], v[204:207], 0
v_exp_f32 v148, v148
v_mfma_f32_16x16x32_bf16 a[64:67], v[20:23], v[160:163], a[64:67]
ds_read_b128 v[16:19], v6 offset:53248
v_cvt_pk_bf16_f32 v179, v146, v147
v_mfma_f32_16x16x32_bf16 a[68:71], v[20:23], v[164:167], a[68:71]
v_exp_f32 v149, v149
v_mfma_f32_16x16x32_bf16 a[72:75], v[20:23], v[168:171], a[72:75]
v_exp_f32 v150, v150
v_mfma_f32_16x16x32_bf16 a[76:79], v[20:23], v[172:175], a[76:79]
v_exp_f32 v151, v151
s_waitcnt lgkmcnt(1)
v_mfma_f32_16x16x32_bf16 v[112:115], v[24:27], v[208:211], v[112:115]
ds_read_b64_tr_b16 v[20:21], v38 offset:32768
v_cvt_pk_bf16_f32 v182, v148, v149
v_mfma_f32_16x16x32_bf16 v[116:119], v[24:27], v[212:215], v[116:119]
ds_read_b64_tr_b16 v[22:23], v38 offset:36864
v_cvt_pk_bf16_f32 v183, v150, v151
v_mfma_f32_16x16x32_bf16 v[120:123], v[24:27], v[216:219], v[120:123]
v_exp_f32 v152, v152
v_mfma_f32_16x16x32_bf16 v[124:127], v[24:27], v[220:223], v[124:127]
v_exp_f32 v153, v153
v_mfma_f32_16x16x32_bf16 a[80:83], v[28:31], v[160:163], a[80:83]
ds_read_b128 v[24:27], v7 offset:53248
v_cvt_pk_bf16_f32 v186, v152, v153
v_mfma_f32_16x16x32_bf16 a[84:87], v[28:31], v[164:167], a[84:87]
v_exp_f32 v154, v154
v_mfma_f32_16x16x32_bf16 a[88:91], v[28:31], v[168:171], a[88:91]
v_exp_f32 v155, v155
v_mfma_f32_16x16x32_bf16 a[92:95], v[28:31], v[172:175], a[92:95]
v_exp_f32 v156, v156
v_mfma_f32_16x16x32_bf16 a[136:139], a[144:147], v[168:171], a[136:139]
v_exp_f32 v157, v157
s_waitcnt lgkmcnt(1)
v_mfma_f32_16x16x32_bf16 v[112:115], v[16:19], v[224:227], v[112:115]
ds_read_b64_tr_b16 v[28:29], v39 offset:32768
v_cvt_pk_bf16_f32 v187, v154, v155
v_mfma_f32_16x16x32_bf16 v[116:119], v[16:19], v[228:231], v[116:119]
ds_read_b64_tr_b16 v[30:31], v39 offset:36864
v_cvt_pk_bf16_f32 v190, v156, v157
v_mfma_f32_16x16x32_bf16 v[120:123], v[16:19], v[232:235], v[120:123]
v_exp_f32 v158, v158
v_mfma_f32_16x16x32_bf16 v[124:127], v[16:19], v[236:239], v[124:127]
v_exp_f32 v159, v159
v_mfma_f32_16x16x32_bf16 a[96:99], v[20:23], v[160:163], a[96:99]
s_waitcnt vmcnt(21)
s_barrier
ds_read_b128 v[16:19], v4 offset:57344
v_mfma_f32_16x16x32_bf16 a[100:103], v[20:23], v[164:167], a[100:103]
s_add_u32 m0, s46, 40960
s_add_u32 s40, s35, 106496
buffer_load_dwordx4 v10, s[20:23], s40 offen lds
v_mfma_f32_16x16x32_bf16 a[104:107], v[20:23], v[168:171], a[104:107]
v_cvt_pk_bf16_f32 v191, v158, v159
v_mfma_f32_16x16x32_bf16 a[108:111], v[20:23], v[172:175], a[108:111]
s_waitcnt lgkmcnt(1)
v_mfma_f32_16x16x32_bf16 v[112:115], v[24:27], v[240:243], v[112:115]
ds_read_b64_tr_b16 v[20:21], v32 offset:40960
v_mfma_f32_16x16x32_bf16 v[116:119], v[24:27], v[244:247], v[116:119]
ds_read_b64_tr_b16 v[22:23], v32 offset:45056
v_mfma_f32_16x16x32_bf16 v[120:123], v[24:27], v[248:251], v[120:123]
v_mfma_f32_16x16x32_bf16 v[124:127], v[24:27], v[252:255], v[124:127]
v_mfma_f32_16x16x32_bf16 a[112:115], v[28:31], v[160:163], a[112:115]
ds_read_b128 v[24:27], v5 offset:57344
v_mfma_f32_16x16x32_bf16 a[116:119], v[28:31], v[164:167], a[116:119]
v_mfma_f32_16x16x32_bf16 a[120:123], v[28:31], v[168:171], a[120:123]
v_mfma_f32_16x16x32_bf16 a[124:127], v[28:31], v[172:175], a[124:127]
v_mfma_f32_16x16x32_bf16 a[140:143], a[144:147], v[172:175], a[140:143]
s_waitcnt lgkmcnt(1)
v_mfma_f32_16x16x32_bf16 v[128:131], v[16:19], v[192:195], 0
ds_read_b64_tr_b16 v[28:29], v33 offset:40960
v_mfma_f32_16x16x32_bf16 v[132:135], v[16:19], v[196:199], 0
ds_read_b64_tr_b16 v[30:31], v33 offset:45056
v_mfma_f32_16x16x32_bf16 v[136:139], v[16:19], v[200:203], 0
buffer_load_dwordx4 v11, s[20:23], s40 offen offset:1024 lds
v_mfma_f32_16x16x32_bf16 v[140:143], v[16:19], v[204:207], 0
v_exp_f32 v96, v96
v_mfma_f32_16x16x32_bf16 a[0:3], v[20:23], v[176:179], a[0:3]
ds_read_b128 v[16:19], v6 offset:57344
v_mfma_f32_16x16x32_bf16 a[4:7], v[20:23], v[180:183], a[4:7]
v_exp_f32 v97, v97
v_mfma_f32_16x16x32_bf16 a[8:11], v[20:23], v[184:187], a[8:11]
v_exp_f32 v98, v98
v_mfma_f32_16x16x32_bf16 a[12:15], v[20:23], v[188:191], a[12:15]
s_lshr_b32 s43, s2, 3
v_exp_f32 v99, v99
s_waitcnt lgkmcnt(1)
v_mfma_f32_16x16x32_bf16 v[128:131], v[24:27], v[208:211], v[128:131]
ds_read_b64_tr_b16 v[20:21], v34 offset:40960
v_lshlrev_b32 v44, 7, v0
s_lshl_b32 s43, s43, 2
v_mfma_f32_16x16x32_bf16 v[132:135], v[24:27], v[212:215], v[132:135]
ds_read_b64_tr_b16 v[22:23], v34 offset:45056
s_add_u32 m0, s46, 90112
v_cvt_pk_bf16_f32 v160, v96, v97
v_mfma_f32_16x16x32_bf16 v[136:139], v[24:27], v[216:219], v[136:139]
s_add_u32 s40, s35, 90112
s_add_u32 s43, s43, s28
v_exp_f32 v100, v100
v_mfma_f32_16x16x32_bf16 v[140:143], v[24:27], v[220:223], v[140:143]
s_mul_i32 s72, s43, 1152
s_mul_i32 s43, s43, 9216
v_exp_f32 v101, v101
v_mfma_f32_16x16x32_bf16 a[16:19], v[28:31], v[176:179], a[16:19]
ds_read_b128 v[24:27], v7 offset:57344
s_mul_i32 s73, s69, 1179648
v_cvt_pk_bf16_f32 v161, v98, v99
v_mfma_f32_16x16x32_bf16 a[20:23], v[28:31], v[180:183], a[20:23]
s_add_u32 s43, s43, s73
s_mul_i32 s73, s69, 147456
buffer_load_dwordx4 v10, s[24:27], s40 offen lds
v_mfma_f32_16x16x32_bf16 a[24:27], v[28:31], v[184:187], a[24:27]
s_add_u32 s72, s72, s73
s_add_u32 s72, s72, 4718592
buffer_load_dword v60, v44, s[48:51], s43 offen
v_mfma_f32_16x16x32_bf16 a[28:31], v[28:31], v[188:191], a[28:31]
v_exp_f32 v102, v102
v_mfma_f32_16x16x32_bf16 a[128:131], a[144:147], v[176:179], a[128:131]
v_exp_f32 v103, v103
s_waitcnt lgkmcnt(1)
v_mfma_f32_16x16x32_bf16 v[128:131], v[16:19], v[224:227], v[128:131]
ds_read_b64_tr_b16 v[28:29], v35 offset:40960
v_cvt_pk_bf16_f32 v164, v100, v101
v_mfma_f32_16x16x32_bf16 v[132:135], v[16:19], v[228:231], v[132:135]
ds_read_b64_tr_b16 v[30:31], v35 offset:45056
v_cvt_pk_bf16_f32 v165, v102, v103
v_mfma_f32_16x16x32_bf16 v[136:139], v[16:19], v[232:235], v[136:139]
v_exp_f32 v104, v104
v_mfma_f32_16x16x32_bf16 v[140:143], v[16:19], v[236:239], v[140:143]
v_exp_f32 v105, v105
v_mfma_f32_16x16x32_bf16 a[32:35], v[20:23], v[176:179], a[32:35]
ds_read_b128 v[16:19], v4 offset:61440
v_cvt_pk_bf16_f32 v168, v104, v105
v_mfma_f32_16x16x32_bf16 a[36:39], v[20:23], v[180:183], a[36:39]
v_exp_f32 v106, v106
v_mfma_f32_16x16x32_bf16 a[40:43], v[20:23], v[184:187], a[40:43]
v_exp_f32 v107, v107
v_mfma_f32_16x16x32_bf16 a[44:47], v[20:23], v[188:191], a[44:47]
buffer_load_dwordx4 v11, s[24:27], s40 offen offset:1024 lds
s_waitcnt lgkmcnt(1)
v_mfma_f32_16x16x32_bf16 v[128:131], v[24:27], v[240:243], v[128:131]
ds_read_b64_tr_b16 v[20:21], v36 offset:40960
v_cvt_pk_bf16_f32 v169, v106, v107
v_mfma_f32_16x16x32_bf16 v[132:135], v[24:27], v[244:247], v[132:135]
ds_read_b64_tr_b16 v[22:23], v36 offset:45056
v_mfma_f32_16x16x32_bf16 v[136:139], v[24:27], v[248:251], v[136:139]
v_exp_f32 v108, v108
v_mfma_f32_16x16x32_bf16 v[140:143], v[24:27], v[252:255], v[140:143]
v_exp_f32 v109, v109
v_mfma_f32_16x16x32_bf16 a[48:51], v[28:31], v[176:179], a[48:51]
ds_read_b128 v[24:27], v5 offset:61440
v_cvt_pk_bf16_f32 v172, v108, v109
v_mfma_f32_16x16x32_bf16 a[52:55], v[28:31], v[180:183], a[52:55]
v_exp_f32 v110, v110
v_mfma_f32_16x16x32_bf16 a[56:59], v[28:31], v[184:187], a[56:59]
buffer_load_dword v61, v44, s[48:51], s43 offen offset:1024
v_mfma_f32_16x16x32_bf16 a[60:63], v[28:31], v[188:191], a[60:63]
v_exp_f32 v111, v111
v_mfma_f32_16x16x32_bf16 a[132:135], a[144:147], v[180:183], a[132:135]
v_exp_f32 v112, v112
s_waitcnt lgkmcnt(1)
v_mfma_f32_16x16x32_bf16 v[144:147], v[16:19], v[192:195], 0
ds_read_b64_tr_b16 v[28:29], v37 offset:40960
v_cvt_pk_bf16_f32 v173, v110, v111
v_mfma_f32_16x16x32_bf16 v[148:151], v[16:19], v[196:199], 0
ds_read_b64_tr_b16 v[30:31], v37 offset:45056
v_mfma_f32_16x16x32_bf16 v[152:155], v[16:19], v[200:203], 0
v_exp_f32 v113, v113
v_mfma_f32_16x16x32_bf16 v[156:159], v[16:19], v[204:207], 0
v_exp_f32 v114, v114
v_mfma_f32_16x16x32_bf16 a[64:67], v[20:23], v[176:179], a[64:67]
ds_read_b128 v[16:19], v6 offset:61440
v_cvt_pk_bf16_f32 v162, v112, v113
v_mfma_f32_16x16x32_bf16 a[68:71], v[20:23], v[180:183], a[68:71]
v_exp_f32 v115, v115
v_mfma_f32_16x16x32_bf16 a[72:75], v[20:23], v[184:187], a[72:75]
v_exp_f32 v116, v116
v_mfma_f32_16x16x32_bf16 a[76:79], v[20:23], v[188:191], a[76:79]
v_exp_f32 v117, v117
s_waitcnt lgkmcnt(1)
v_mfma_f32_16x16x32_bf16 v[144:147], v[24:27], v[208:211], v[144:147]
ds_read_b64_tr_b16 v[20:21], v38 offset:40960
v_cvt_pk_bf16_f32 v163, v114, v115
v_mfma_f32_16x16x32_bf16 v[148:151], v[24:27], v[212:215], v[148:151]
ds_read_b64_tr_b16 v[22:23], v38 offset:45056
v_cvt_pk_bf16_f32 v166, v116, v117
v_mfma_f32_16x16x32_bf16 v[152:155], v[24:27], v[216:219], v[152:155]
v_exp_f32 v118, v118
v_mfma_f32_16x16x32_bf16 v[156:159], v[24:27], v[220:223], v[156:159]
v_exp_f32 v119, v119
v_mfma_f32_16x16x32_bf16 a[80:83], v[28:31], v[176:179], a[80:83]
ds_read_b128 v[24:27], v7 offset:61440
v_cvt_pk_bf16_f32 v167, v118, v119
v_mfma_f32_16x16x32_bf16 a[84:87], v[28:31], v[180:183], a[84:87]
v_exp_f32 v120, v120
v_mfma_f32_16x16x32_bf16 a[88:91], v[28:31], v[184:187], a[88:91]
v_exp_f32 v121, v121
v_mfma_f32_16x16x32_bf16 a[92:95], v[28:31], v[188:191], a[92:95]
v_exp_f32 v122, v122
v_mfma_f32_16x16x32_bf16 a[136:139], a[144:147], v[184:187], a[136:139]
v_exp_f32 v123, v123
s_waitcnt lgkmcnt(1)
v_mfma_f32_16x16x32_bf16 v[144:147], v[16:19], v[224:227], v[144:147]
ds_read_b64_tr_b16 v[28:29], v39 offset:40960
v_cvt_pk_bf16_f32 v170, v120, v121
v_mfma_f32_16x16x32_bf16 v[148:151], v[16:19], v[228:231], v[148:151]
ds_read_b64_tr_b16 v[30:31], v39 offset:45056
v_cvt_pk_bf16_f32 v171, v122, v123
v_mfma_f32_16x16x32_bf16 v[152:155], v[16:19], v[232:235], v[152:155]
v_exp_f32 v124, v124
v_mfma_f32_16x16x32_bf16 v[156:159], v[16:19], v[236:239], v[156:159]
v_exp_f32 v125, v125
v_mfma_f32_16x16x32_bf16 a[96:99], v[20:23], v[176:179], a[96:99]
s_waitcnt vmcnt(23)
s_barrier
ds_read_b128 v[16:19], v4 offset:0
v_mfma_f32_16x16x32_bf16 a[100:103], v[20:23], v[180:183], a[100:103]
s_add_u32 m0, s46, 49152
s_add_u32 s40, s35, 114688
buffer_load_dwordx4 v10, s[20:23], s40 offen lds
v_mfma_f32_16x16x32_bf16 a[104:107], v[20:23], v[184:187], a[104:107]
buffer_load_dword v62, v44, s[48:51], s72 offen
v_mfma_f32_16x16x32_bf16 a[108:111], v[20:23], v[188:191], a[108:111]
v_exp_f32 v126, v126
s_waitcnt lgkmcnt(1)
v_mfma_f32_16x16x32_bf16 v[144:147], v[24:27], v[240:243], v[144:147]
ds_read_b64_tr_b16 v[20:21], v32 offset:49152
v_cvt_pk_bf16_f32 v174, v124, v125
v_mfma_f32_16x16x32_bf16 v[148:151], v[24:27], v[244:247], v[148:151]
ds_read_b64_tr_b16 v[22:23], v32 offset:53248
v_mfma_f32_16x16x32_bf16 v[152:155], v[24:27], v[248:251], v[152:155]
v_exp_f32 v127, v127
v_mfma_f32_16x16x32_bf16 v[156:159], v[24:27], v[252:255], v[156:159]
v_cvt_pk_bf16_f32 v175, v126, v127
v_mfma_f32_16x16x32_bf16 a[112:115], v[28:31], v[176:179], a[112:115]
ds_read_b128 v[24:27], v5 offset:0
v_mfma_f32_16x16x32_bf16 a[116:119], v[28:31], v[180:183], a[116:119]
v_mfma_f32_16x16x32_bf16 a[120:123], v[28:31], v[184:187], a[120:123]
v_mfma_f32_16x16x32_bf16 a[124:127], v[28:31], v[188:191], a[124:127]
v_mfma_f32_16x16x32_bf16 a[140:143], a[144:147], v[188:191], a[140:143]
s_waitcnt lgkmcnt(1)
v_mfma_f32_16x16x32_bf16 v[96:99], v[16:19], v[192:195], 0
ds_read_b64_tr_b16 v[28:29], v33 offset:49152
v_mfma_f32_16x16x32_bf16 v[100:103], v[16:19], v[196:199], 0
ds_read_b64_tr_b16 v[30:31], v33 offset:53248
v_mfma_f32_16x16x32_bf16 v[104:107], v[16:19], v[200:203], 0
buffer_load_dwordx4 v11, s[20:23], s40 offen offset:1024 lds
v_mfma_f32_16x16x32_bf16 v[108:111], v[16:19], v[204:207], 0
v_exp_f32 v128, v128
v_mfma_f32_16x16x32_bf16 a[0:3], v[20:23], v[160:163], a[0:3]
ds_read_b128 v[16:19], v6 offset:0
v_mfma_f32_16x16x32_bf16 a[4:7], v[20:23], v[164:167], a[4:7]
v_exp_f32 v129, v129
v_mfma_f32_16x16x32_bf16 a[8:11], v[20:23], v[168:171], a[8:11]
v_exp_f32 v130, v130
v_mfma_f32_16x16x32_bf16 a[12:15], v[20:23], v[172:175], a[12:15]
v_exp_f32 v131, v131
s_waitcnt lgkmcnt(1)
v_mfma_f32_16x16x32_bf16 v[96:99], v[24:27], v[208:211], v[96:99]
ds_read_b64_tr_b16 v[20:21], v34 offset:49152
v_cvt_pk_bf16_f32 v176, v128, v129
v_mfma_f32_16x16x32_bf16 v[100:103], v[24:27], v[212:215], v[100:103]
ds_read_b64_tr_b16 v[22:23], v34 offset:53248
s_add_u32 m0, s46, 98304
v_cvt_pk_bf16_f32 v177, v130, v131
v_mfma_f32_16x16x32_bf16 v[104:107], v[24:27], v[216:219], v[104:107]
s_add_u32 s40, s35, 98304
v_exp_f32 v132, v132
v_mfma_f32_16x16x32_bf16 v[108:111], v[24:27], v[220:223], v[108:111]
v_exp_f32 v133, v133
v_mfma_f32_16x16x32_bf16 a[16:19], v[28:31], v[160:163], a[16:19]
ds_read_b128 v[24:27], v7 offset:0
v_cvt_pk_bf16_f32 v180, v132, v133
v_mfma_f32_16x16x32_bf16 a[20:23], v[28:31], v[164:167], a[20:23]
buffer_load_dwordx4 v10, s[24:27], s40 offen lds
v_mfma_f32_16x16x32_bf16 a[24:27], v[28:31], v[168:171], a[24:27]
v_exp_f32 v134, v134
v_mfma_f32_16x16x32_bf16 a[28:31], v[28:31], v[172:175], a[28:31]
v_exp_f32 v135, v135
v_mfma_f32_16x16x32_bf16 a[128:131], a[144:147], v[160:163], a[128:131]
v_exp_f32 v136, v136
s_waitcnt lgkmcnt(1)
v_mfma_f32_16x16x32_bf16 v[96:99], v[16:19], v[224:227], v[96:99]
ds_read_b64_tr_b16 v[28:29], v35 offset:49152
v_cvt_pk_bf16_f32 v181, v134, v135
v_mfma_f32_16x16x32_bf16 v[100:103], v[16:19], v[228:231], v[100:103]
ds_read_b64_tr_b16 v[30:31], v35 offset:53248
v_mfma_f32_16x16x32_bf16 v[104:107], v[16:19], v[232:235], v[104:107]
v_exp_f32 v137, v137
v_mfma_f32_16x16x32_bf16 v[108:111], v[16:19], v[236:239], v[108:111]
v_exp_f32 v138, v138
v_mfma_f32_16x16x32_bf16 a[32:35], v[20:23], v[160:163], a[32:35]
ds_read_b128 v[16:19], v4 offset:4096
v_cvt_pk_bf16_f32 v184, v136, v137
v_mfma_f32_16x16x32_bf16 a[36:39], v[20:23], v[164:167], a[36:39]
v_exp_f32 v139, v139
v_mfma_f32_16x16x32_bf16 a[40:43], v[20:23], v[168:171], a[40:43]
v_exp_f32 v140, v140
v_mfma_f32_16x16x32_bf16 a[44:47], v[20:23], v[172:175], a[44:47]
buffer_load_dwordx4 v11, s[24:27], s40 offen offset:1024 lds
s_waitcnt lgkmcnt(1)
v_mfma_f32_16x16x32_bf16 v[96:99], v[24:27], v[240:243], v[96:99]
ds_read_b64_tr_b16 v[20:21], v36 offset:49152
v_cvt_pk_bf16_f32 v185, v138, v139
v_mfma_f32_16x16x32_bf16 v[100:103], v[24:27], v[244:247], v[100:103]
ds_read_b64_tr_b16 v[22:23], v36 offset:53248
v_mfma_f32_16x16x32_bf16 v[104:107], v[24:27], v[248:251], v[104:107]
v_exp_f32 v141, v141
v_mfma_f32_16x16x32_bf16 v[108:111], v[24:27], v[252:255], v[108:111]
v_exp_f32 v142, v142
v_mfma_f32_16x16x32_bf16 a[48:51], v[28:31], v[160:163], a[48:51]
ds_read_b128 v[24:27], v5 offset:4096
v_cvt_pk_bf16_f32 v188, v140, v141
v_mfma_f32_16x16x32_bf16 a[52:55], v[28:31], v[164:167], a[52:55]
v_exp_f32 v143, v143
v_mfma_f32_16x16x32_bf16 a[56:59], v[28:31], v[168:171], a[56:59]
v_exp_f32 v144, v144
v_mfma_f32_16x16x32_bf16 a[60:63], v[28:31], v[172:175], a[60:63]
v_exp_f32 v145, v145
v_mfma_f32_16x16x32_bf16 a[132:135], a[144:147], v[164:167], a[132:135]
v_exp_f32 v146, v146
s_waitcnt lgkmcnt(1)
v_mfma_f32_16x16x32_bf16 v[112:115], v[16:19], v[192:195], 0
ds_read_b64_tr_b16 v[28:29], v37 offset:49152
v_cvt_pk_bf16_f32 v189, v142, v143
v_mfma_f32_16x16x32_bf16 v[116:119], v[16:19], v[196:199], 0
ds_read_b64_tr_b16 v[30:31], v37 offset:53248
v_cvt_pk_bf16_f32 v178, v144, v145
v_mfma_f32_16x16x32_bf16 v[120:123], v[16:19], v[200:203], 0
v_exp_f32 v147, v147
v_mfma_f32_16x16x32_bf16 v[124:127], v[16:19], v[204:207], 0
v_exp_f32 v148, v148
v_mfma_f32_16x16x32_bf16 a[64:67], v[20:23], v[160:163], a[64:67]
ds_read_b128 v[16:19], v6 offset:4096
v_cvt_pk_bf16_f32 v179, v146, v147
v_mfma_f32_16x16x32_bf16 a[68:71], v[20:23], v[164:167], a[68:71]
v_exp_f32 v149, v149
v_mfma_f32_16x16x32_bf16 a[72:75], v[20:23], v[168:171], a[72:75]
v_exp_f32 v150, v150
v_mfma_f32_16x16x32_bf16 a[76:79], v[20:23], v[172:175], a[76:79]
v_exp_f32 v151, v151
s_waitcnt lgkmcnt(1)
v_mfma_f32_16x16x32_bf16 v[112:115], v[24:27], v[208:211], v[112:115]
ds_read_b64_tr_b16 v[20:21], v38 offset:49152
v_cvt_pk_bf16_f32 v182, v148, v149
v_mfma_f32_16x16x32_bf16 v[116:119], v[24:27], v[212:215], v[116:119]
ds_read_b64_tr_b16 v[22:23], v38 offset:53248
v_cvt_pk_bf16_f32 v183, v150, v151
v_mfma_f32_16x16x32_bf16 v[120:123], v[24:27], v[216:219], v[120:123]
v_exp_f32 v152, v152
v_mfma_f32_16x16x32_bf16 v[124:127], v[24:27], v[220:223], v[124:127]
v_exp_f32 v153, v153
v_mfma_f32_16x16x32_bf16 a[80:83], v[28:31], v[160:163], a[80:83]
ds_read_b128 v[24:27], v7 offset:4096
v_cvt_pk_bf16_f32 v186, v152, v153
v_mfma_f32_16x16x32_bf16 a[84:87], v[28:31], v[164:167], a[84:87]
v_exp_f32 v154, v154
v_mfma_f32_16x16x32_bf16 a[88:91], v[28:31], v[168:171], a[88:91]
v_exp_f32 v155, v155
v_mfma_f32_16x16x32_bf16 a[92:95], v[28:31], v[172:175], a[92:95]
v_exp_f32 v156, v156
v_mfma_f32_16x16x32_bf16 a[136:139], a[144:147], v[168:171], a[136:139]
v_exp_f32 v157, v157
s_waitcnt lgkmcnt(1)
v_mfma_f32_16x16x32_bf16 v[112:115], v[16:19], v[224:227], v[112:115]
ds_read_b64_tr_b16 v[28:29], v39 offset:49152
v_cvt_pk_bf16_f32 v187, v154, v155
v_mfma_f32_16x16x32_bf16 v[116:119], v[16:19], v[228:231], v[116:119]
ds_read_b64_tr_b16 v[30:31], v39 offset:53248
v_cvt_pk_bf16_f32 v190, v156, v157
v_mfma_f32_16x16x32_bf16 v[120:123], v[16:19], v[232:235], v[120:123]
v_exp_f32 v158, v158
v_mfma_f32_16x16x32_bf16 v[124:127], v[16:19], v[236:239], v[124:127]
v_exp_f32 v159, v159
v_mfma_f32_16x16x32_bf16 a[96:99], v[20:23], v[160:163], a[96:99]
s_waitcnt vmcnt(24)
s_barrier
ds_read_b128 v[16:19], v4 offset:8192
v_mfma_f32_16x16x32_bf16 a[100:103], v[20:23], v[164:167], a[100:103]
s_add_u32 m0, s46, 57344
s_add_u32 s40, s35, 122880
buffer_load_dwordx4 v10, s[20:23], s40 offen lds
v_mfma_f32_16x16x32_bf16 a[104:107], v[20:23], v[168:171], a[104:107]
v_cvt_pk_bf16_f32 v191, v158, v159
v_mfma_f32_16x16x32_bf16 a[108:111], v[20:23], v[172:175], a[108:111]
s_waitcnt lgkmcnt(1)
v_mfma_f32_16x16x32_bf16 v[112:115], v[24:27], v[240:243], v[112:115]
ds_read_b64_tr_b16 v[20:21], v32 offset:57344
v_mfma_f32_16x16x32_bf16 v[116:119], v[24:27], v[244:247], v[116:119]
ds_read_b64_tr_b16 v[22:23], v32 offset:61440
v_mfma_f32_16x16x32_bf16 v[120:123], v[24:27], v[248:251], v[120:123]
v_mfma_f32_16x16x32_bf16 v[124:127], v[24:27], v[252:255], v[124:127]
v_mfma_f32_16x16x32_bf16 a[112:115], v[28:31], v[160:163], a[112:115]
ds_read_b128 v[24:27], v5 offset:8192
v_mfma_f32_16x16x32_bf16 a[116:119], v[28:31], v[164:167], a[116:119]
v_mfma_f32_16x16x32_bf16 a[120:123], v[28:31], v[168:171], a[120:123]
v_mfma_f32_16x16x32_bf16 a[124:127], v[28:31], v[172:175], a[124:127]
v_mfma_f32_16x16x32_bf16 a[140:143], a[144:147], v[172:175], a[140:143]
s_cmp_eq_u32 s70, 1
s_cbranch_scc1 mk_Y
mk_S:
s_waitcnt lgkmcnt(1)
v_mfma_f32_16x16x32_bf16 v[128:131], v[16:19], v[192:195], 0
ds_read_b64_tr_b16 v[28:29], v33 offset:57344
s_and_b32 s75, s3, 4
s_xor_b32 s74, s75, 4
v_mfma_f32_16x16x32_bf16 v[132:135], v[16:19], v[196:199], 0
ds_read_b64_tr_b16 v[30:31], v33 offset:61440
v_mfma_f32_16x16x32_bf16 v[136:139], v[16:19], v[200:203], 0
buffer_load_dwordx4 v11, s[20:23], s40 offen offset:1024 lds
v_mfma_f32_16x16x32_bf16 v[140:143], v[16:19], v[204:207], 0
v_exp_f32 v96, v96
v_mfma_f32_16x16x32_bf16 a[0:3], v[20:23], v[176:179], a[0:3]
ds_read_b128 v[16:19], v6 offset:8192
v_mfma_f32_16x16x32_bf16 a[4:7], v[20:23], v[180:183], a[4:7]
v_exp_f32 v97, v97
v_mfma_f32_16x16x32_bf16 a[8:11], v[20:23], v[184:187], a[8:11]
v_exp_f32 v98, v98
v_mfma_f32_16x16x32_bf16 a[12:15], v[20:23], v[188:191], a[12:15]
v_exp_f32 v99, v99
s_waitcnt lgkmcnt(1)
v_mfma_f32_16x16x32_bf16 v[128:131], v[24:27], v[208:211], v[128:131]
ds_read_b64_tr_b16 v[20:21], v34 offset:57344
v_cvt_pk_bf16_f32 v160, v96, v97
v_mfma_f32_16x16x32_bf16 v[132:135], v[24:27], v[212:215], v[132:135]
ds_read_b64_tr_b16 v[22:23], v34 offset:61440
s_add_u32 m0, s46, 106496
v_cvt_pk_bf16_f32 v161, v98, v99
v_mfma_f32_16x16x32_bf16 v[136:139], v[24:27], v[216:219], v[136:139]
s_add_u32 s40, s35, 106496
v_exp_f32 v100, v100
v_mfma_f32_16x16x32_bf16 v[140:143], v[24:27], v[220:223], v[140:143]
v_exp_f32 v101, v101
v_mfma_f32_16x16x32_bf16 a[16:19], v[28:31], v[176:179], a[16:19]
ds_read_b128 v[24:27], v7 offset:8192
v_cvt_pk_bf16_f32 v164, v100, v101
v_mfma_f32_16x16x32_bf16 a[20:23], v[28:31], v[180:183], a[20:23]
buffer_load_dwordx4 v10, s[24:27], s40 offen lds
v_mfma_f32_16x16x32_bf16 a[24:27], v[28:31], v[184:187], a[24:27]
v_exp_f32 v102, v102
v_mfma_f32_16x16x32_bf16 a[28:31], v[28:31], v[188:191], a[28:31]
v_exp_f32 v103, v103
v_mfma_f32_16x16x32_bf16 a[128:131], a[144:147], v[176:179], a[128:131]
v_exp_f32 v104, v104
s_waitcnt lgkmcnt(1)
v_mfma_f32_16x16x32_bf16 v[128:131], v[16:19], v[224:227], v[128:131]
ds_read_b64_tr_b16 v[28:29], v35 offset:57344
v_cvt_pk_bf16_f32 v165, v102, v103
v_mfma_f32_16x16x32_bf16 v[132:135], v[16:19], v[228:231], v[132:135]
ds_read_b64_tr_b16 v[30:31], v35 offset:61440
v_mfma_f32_16x16x32_bf16 v[136:139], v[16:19], v[232:235], v[136:139]
v_exp_f32 v105, v105
v_mfma_f32_16x16x32_bf16 v[140:143], v[16:19], v[236:239], v[140:143]
v_exp_f32 v106, v106
v_mfma_f32_16x16x32_bf16 a[32:35], v[20:23], v[176:179], a[32:35]
ds_read_b128 v[16:19], v4 offset:12288
v_cvt_pk_bf16_f32 v168, v104, v105
v_mfma_f32_16x16x32_bf16 a[36:39], v[20:23], v[180:183], a[36:39]
v_exp_f32 v107, v107
v_mfma_f32_16x16x32_bf16 a[40:43], v[20:23], v[184:187], a[40:43]
v_exp_f32 v108, v108
v_mfma_f32_16x16x32_bf16 a[44:47], v[20:23], v[188:191], a[44:47]
buffer_load_dwordx4 v11, s[24:27], s40 offen offset:1024 lds
s_lshl_b32 s72, s28, 13
s_waitcnt lgkmcnt(1)
v_mfma_f32_16x16x32_bf16 v[128:131], v[24:27], v[240:243], v[128:131]
ds_read_b64_tr_b16 v[20:21], v36 offset:57344
s_add_u32 s72, s72, mk_LS_A9-mk_pc
v_lshl_add_u32 v56, v0, 7, s72
v_mfma_f32_16x16x32_bf16 v[132:135], v[24:27], v[244:247], v[132:135]
ds_read_b64_tr_b16 v[22:23], v36 offset:61440
v_min_u32 v56, mk_fin-mk_pc, v56
v_mfma_f32_16x16x32_bf16 v[136:139], v[24:27], v[248:251], v[136:139]
global_load_dword v57, v56, s[4:5]
v_mfma_f32_16x16x32_bf16 v[140:143], v[24:27], v[252:255], v[140:143]
v_exp_f32 v109, v109
v_mfma_f32_16x16x32_bf16 a[48:51], v[28:31], v[176:179], a[48:51]
ds_read_b128 v[24:27], v5 offset:12288
v_cvt_pk_bf16_f32 v169, v106, v107
v_mfma_f32_16x16x32_bf16 a[52:55], v[28:31], v[180:183], a[52:55]
v_exp_f32 v110, v110
v_mfma_f32_16x16x32_bf16 a[56:59], v[28:31], v[184:187], a[56:59]
v_exp_f32 v111, v111
v_mfma_f32_16x16x32_bf16 a[60:63], v[28:31], v[188:191], a[60:63]
v_exp_f32 v112, v112
v_mfma_f32_16x16x32_bf16 a[132:135], a[144:147], v[180:183], a[132:135]
v_exp_f32 v113, v113
s_waitcnt lgkmcnt(1)
v_mfma_f32_16x16x32_bf16 v[144:147], v[16:19], v[192:195], 0
ds_read_b64_tr_b16 v[28:29], v37 offset:57344
v_cvt_pk_bf16_f32 v172, v108, v109
v_mfma_f32_16x16x32_bf16 v[148:151], v[16:19], v[196:199], 0
ds_read_b64_tr_b16 v[30:31], v37 offset:61440
v_cvt_pk_bf16_f32 v173, v110, v111
v_mfma_f32_16x16x32_bf16 v[152:155], v[16:19], v[200:203], 0
v_exp_f32 v114, v114
v_mfma_f32_16x16x32_bf16 v[156:159], v[16:19], v[204:207], 0
v_exp_f32 v115, v115
v_mfma_f32_16x16x32_bf16 a[64:67], v[20:23], v[176:179], a[64:67]
ds_read_b128 v[16:19], v6 offset:12288
v_cvt_pk_bf16_f32 v162, v112, v113
v_mfma_f32_16x16x32_bf16 a[68:71], v[20:23], v[180:183], a[68:71]
v_exp_f32 v116, v116
v_mfma_f32_16x16x32_bf16 a[72:75], v[20:23], v[184:187], a[72:75]
v_exp_f32 v117, v117
v_mfma_f32_16x16x32_bf16 a[76:79], v[20:23], v[188:191], a[76:79]
v_exp_f32 v118, v118
s_waitcnt lgkmcnt(1)
v_mfma_f32_16x16x32_bf16 v[144:147], v[24:27], v[208:211], v[144:147]
ds_read_b64_tr_b16 v[20:21], v38 offset:57344
v_cvt_pk_bf16_f32 v163, v114, v115
v_mfma_f32_16x16x32_bf16 v[148:151], v[24:27], v[212:215], v[148:151]
ds_read_b64_tr_b16 v[22:23], v38 offset:61440
v_cvt_pk_bf16_f32 v166, v116, v117
v_mfma_f32_16x16x32_bf16 v[152:155], v[24:27], v[216:219], v[152:155]
v_exp_f32 v119, v119
v_mfma_f32_16x16x32_bf16 v[156:159], v[24:27], v[220:223], v[156:159]
v_exp_f32 v120, v120
v_mfma_f32_16x16x32_bf16 a[80:83], v[28:31], v[176:179], a[80:83]
ds_read_b128 v[24:27], v7 offset:12288
v_cvt_pk_bf16_f32 v167, v118, v119
v_mfma_f32_16x16x32_bf16 a[84:87], v[28:31], v[180:183], a[84:87]
v_exp_f32 v121, v121
v_mfma_f32_16x16x32_bf16 a[88:91], v[28:31], v[184:187], a[88:91]
v_exp_f32 v122, v122
v_mfma_f32_16x16x32_bf16 a[92:95], v[28:31], v[188:191], a[92:95]
v_exp_f32 v123, v123
v_mfma_f32_16x16x32_bf16 a[136:139], a[144:147], v[184:187], a[136:139]
v_exp_f32 v124, v124
s_waitcnt lgkmcnt(1)
v_mfma_f32_16x16x32_bf16 v[144:147], v[16:19], v[224:227], v[144:147]
ds_read_b64_tr_b16 v[28:29], v39 offset:57344
v_cvt_pk_bf16_f32 v170, v120, v121
v_mfma_f32_16x16x32_bf16 v[148:151], v[16:19], v[228:231], v[148:151]
ds_read_b64_tr_b16 v[30:31], v39 offset:61440
v_cvt_pk_bf16_f32 v171, v122, v123
v_mfma_f32_16x16x32_bf16 v[152:155], v[16:19], v[232:235], v[152:155]
v_exp_f32 v125, v125
v_mfma_f32_16x16x32_bf16 v[156:159], v[16:19], v[236:239], v[156:159]
v_exp_f32 v126, v126
v_mfma_f32_16x16x32_bf16 a[96:99], v[20:23], v[176:179], a[96:99]
s_waitcnt vmcnt(25)
s_barrier
ds_read_b128 v[16:19], v4 offset:16384
v_mfma_f32_16x16x32_bf16 a[100:103], v[20:23], v[180:183], a[100:103]
s_add_u32 m0, s46, 114688
s_add_u32 s40, s35, 114688
buffer_load_dwordx4 v10, s[24:27], s40 offen lds
v_mfma_f32_16x16x32_bf16 a[104:107], v[20:23], v[184:187], a[104:107]
v_exp_f32 v127, v127
v_mfma_f32_16x16x32_bf16 a[108:111], v[20:23], v[188:191], a[108:111]
v_cvt_pk_bf16_f32 v174, v124, v125
v_cvt_pk_bf16_f32 v175, v126, v127
s_waitcnt lgkmcnt(1)
v_mfma_f32_16x16x32_bf16 v[144:147], v[24:27], v[240:243], v[144:147]
ds_read_b64_tr_b16 v[20:21], v32 offset:0
v_mfma_f32_16x16x32_bf16 v[148:151], v[24:27], v[244:247], v[148:151]
ds_read_b64_tr_b16 v[22:23], v32 offset:4096
v_mfma_f32_16x16x32_bf16 v[152:155], v[24:27], v[248:251], v[152:155]
v_mfma_f32_16x16x32_bf16 v[156:159], v[24:27], v[252:255], v[156:159]
v_mfma_f32_16x16x32_bf16 a[112:115], v[28:31], v[176:179], a[112:115]
ds_read_b128 v[24:27], v5 offset:16384
v_mfma_f32_16x16x32_bf16 a[116:119], v[28:31], v[180:183], a[116:119]
v_mfma_f32_16x16x32_bf16 a[120:123], v[28:31], v[184:187], a[120:123]
v_mfma_f32_16x16x32_bf16 a[124:127], v[28:31], v[188:191], a[124:127]
v_mfma_f32_16x16x32_bf16 a[140:143], a[144:147], v[188:191], a[140:143]
mk_LS_A9:
s_waitcnt lgkmcnt(1)
v_mfma_f32_16x16x32_bf16 v[96:99], v[16:19], v[192:195], 0
ds_read_b64_tr_b16 v[28:29], v33 offset:0
v_mfma_f32_16x16x32_bf16 v[100:103], v[16:19], v[196:199], 0
ds_read_b64_tr_b16 v[30:31], v33 offset:4096
v_mfma_f32_16x16x32_bf16 v[104:107], v[16:19], v[200:203], 0
buffer_load_dwordx4 v11, s[24:27], s40 offen offset:1024 lds
v_mfma_f32_16x16x32_bf16 v[108:111], v[16:19], v[204:207], 0
v_exp_f32 v128, v128
v_mfma_f32_16x16x32_bf16 a[0:3], v[20:23], v[160:163], a[0:3]
ds_read_b128 v[16:19], v6 offset:16384
v_mfma_f32_16x16x32_bf16 a[4:7], v[20:23], v[164:167], a[4:7]
v_exp_f32 v129, v129
v_mfma_f32_16x16x32_bf16 a[8:11], v[20:23], v[168:171], a[8:11]
v_exp_f32 v130, v130
v_mfma_f32_16x16x32_bf16 a[12:15], v[20:23], v[172:175], a[12:15]
v_exp_f32 v131, v131
s_waitcnt lgkmcnt(1)
v_mfma_f32_16x16x32_bf16 v[96:99], v[24:27], v[208:211], v[96:99]
ds_read_b64_tr_b16 v[20:21], v34 offset:0
v_cvt_pk_bf16_f32 v176, v128, v129
v_mfma_f32_16x16x32_bf16 v[100:103], v[24:27], v[212:215], v[100:103]
ds_read_b64_tr_b16 v[22:23], v34 offset:4096
v_cvt_pk_bf16_f32 v177, v130, v131
v_mfma_f32_16x16x32_bf16 v[104:107], v[24:27], v[216:219], v[104:107]
v_exp_f32 v132, v132
v_mfma_f32_16x16x32_bf16 v[108:111], v[24:27], v[220:223], v[108:111]
v_exp_f32 v133, v133
v_mfma_f32_16x16x32_bf16 a[16:19], v[28:31], v[160:163], a[16:19]
ds_read_b128 v[24:27], v7 offset:16384
v_cvt_pk_bf16_f32 v180, v132, v133
v_mfma_f32_16x16x32_bf16 a[20:23], v[28:31], v[164:167], a[20:23]
v_exp_f32 v134, v134
v_mfma_f32_16x16x32_bf16 a[24:27], v[28:31], v[168:171], a[24:27]
v_exp_f32 v135, v135
v_mfma_f32_16x16x32_bf16 a[28:31], v[28:31], v[172:175], a[28:31]
v_exp_f32 v136, v136
v_mfma_f32_16x16x32_bf16 a[128:131], a[144:147], v[160:163], a[128:131]
v_exp_f32 v137, v137
s_waitcnt lgkmcnt(1)
v_mfma_f32_16x16x32_bf16 v[96:99], v[16:19], v[224:227], v[96:99]
ds_read_b64_tr_b16 v[28:29], v35 offset:0
v_cvt_pk_bf16_f32 v181, v134, v135
v_mfma_f32_16x16x32_bf16 v[100:103], v[16:19], v[228:231], v[100:103]
ds_read_b64_tr_b16 v[30:31], v35 offset:4096
v_cvt_pk_bf16_f32 v184, v136, v137
v_mfma_f32_16x16x32_bf16 v[104:107], v[16:19], v[232:235], v[104:107]
v_exp_f32 v138, v138
v_mfma_f32_16x16x32_bf16 v[108:111], v[16:19], v[236:239], v[108:111]
v_exp_f32 v139, v139
v_mfma_f32_16x16x32_bf16 a[32:35], v[20:23], v[160:163], a[32:35]
ds_read_b128 v[16:19], v4 offset:20480
v_cvt_pk_bf16_f32 v185, v138, v139
v_mfma_f32_16x16x32_bf16 a[36:39], v[20:23], v[164:167], a[36:39]
v_exp_f32 v140, v140
v_mfma_f32_16x16x32_bf16 a[40:43], v[20:23], v[168:171], a[40:43]
v_exp_f32 v141, v141
v_mfma_f32_16x16x32_bf16 a[44:47], v[20:23], v[172:175], a[44:47]
v_exp_f32 v142, v142
s_waitcnt lgkmcnt(1)
v_mfma_f32_16x16x32_bf16 v[96:99], v[24:27], v[240:243], v[96:99]
ds_read_b64_tr_b16 v[20:21], v36 offset:0
v_cvt_pk_bf16_f32 v188, v140, v141
v_mfma_f32_16x16x32_bf16 v[100:103], v[24:27], v[244:247], v[100:103]
ds_read_b64_tr_b16 v[22:23], v36 offset:4096
v_mfma_f32_16x16x32_bf16 v[104:107], v[24:27], v[248:251], v[104:107]
v_exp_f32 v143, v143
v_mfma_f32_16x16x32_bf16 v[108:111], v[24:27], v[252:255], v[108:111]
v_exp_f32 v144, v144
v_mfma_f32_16x16x32_bf16 a[48:51], v[28:31], v[160:163], a[48:51]
ds_read_b128 v[24:27], v5 offset:20480
v_cvt_pk_bf16_f32 v189, v142, v143
v_mfma_f32_16x16x32_bf16 a[52:55], v[28:31], v[164:167], a[52:55]
v_exp_f32 v145, v145
v_mfma_f32_16x16x32_bf16 a[56:59], v[28:31], v[168:171], a[56:59]
v_exp_f32 v146, v146
v_mfma_f32_16x16x32_bf16 a[60:63], v[28:31], v[172:175], a[60:63]
v_exp_f32 v147, v147
v_mfma_f32_16x16x32_bf16 a[132:135], a[144:147], v[164:167], a[132:135]
v_exp_f32 v148, v148
s_waitcnt lgkmcnt(1)
v_mfma_f32_16x16x32_bf16 v[112:115], v[16:19], v[192:195], 0
ds_read_b64_tr_b16 v[28:29], v37 offset:0
v_cvt_pk_bf16_f32 v178, v144, v145
v_mfma_f32_16x16x32_bf16 v[116:119], v[16:19], v[196:199], 0
ds_read_b64_tr_b16 v[30:31], v37 offset:4096
v_cvt_pk_bf16_f32 v179, v146, v147
v_mfma_f32_16x16x32_bf16 v[120:123], v[16:19], v[200:203], 0
v_exp_f32 v149, v149
v_mfma_f32_16x16x32_bf16 v[124:127], v[16:19], v[204:207], 0
v_exp_f32 v150, v150
v_mfma_f32_16x16x32_bf16 a[64:67], v[20:23], v[160:163], a[64:67]
ds_read_b128 v[16:19], v6 offset:20480
v_cvt_pk_bf16_f32 v182, v148, v149
v_mfma_f32_16x16x32_bf16 a[68:71], v[20:23], v[164:167], a[68:71]
v_exp_f32 v151, v151
v_mfma_f32_16x16x32_bf16 a[72:75], v[20:23], v[168:171], a[72:75]
v_exp_f32 v152, v152
v_mfma_f32_16x16x32_bf16 a[76:79], v[20:23], v[172:175], a[76:79]
v_exp_f32 v153, v153
s_waitcnt lgkmcnt(1)
v_mfma_f32_16x16x32_bf16 v[112:115], v[24:27], v[208:211], v[112:115]
ds_read_b64_tr_b16 v[20:21], v38 offset:0
v_cvt_pk_bf16_f32 v183, v150, v151
v_mfma_f32_16x16x32_bf16 v[116:119], v[24:27], v[212:215], v[116:119]
ds_read_b64_tr_b16 v[22:23], v38 offset:4096
v_cvt_pk_bf16_f32 v186, v152, v153
v_mfma_f32_16x16x32_bf16 v[120:123], v[24:27], v[216:219], v[120:123]
v_exp_f32 v154, v154
v_mfma_f32_16x16x32_bf16 v[124:127], v[24:27], v[220:223], v[124:127]
v_exp_f32 v155, v155
v_mfma_f32_16x16x32_bf16 a[80:83], v[28:31], v[160:163], a[80:83]
ds_read_b128 v[24:27], v7 offset:20480
v_cvt_pk_bf16_f32 v187, v154, v155
v_mfma_f32_16x16x32_bf16 a[84:87], v[28:31], v[164:167], a[84:87]
v_exp_f32 v156, v156
v_mfma_f32_16x16x32_bf16 a[88:91], v[28:31], v[168:171], a[88:91]
v_exp_f32 v157, v157
v_mfma_f32_16x16x32_bf16 a[92:95], v[28:31], v[172:175], a[92:95]
v_exp_f32 v158, v158
v_mfma_f32_16x16x32_bf16 a[136:139], a[144:147], v[168:171], a[136:139]
v_exp_f32 v159, v159
s_waitcnt lgkmcnt(1)
v_mfma_f32_16x16x32_bf16 v[112:115], v[16:19], v[224:227], v[112:115]
ds_read_b64_tr_b16 v[28:29], v39 offset:0
v_cvt_pk_bf16_f32 v190, v156, v157
v_mfma_f32_16x16x32_bf16 v[116:119], v[16:19], v[228:231], v[116:119]
ds_read_b64_tr_b16 v[30:31], v39 offset:4096
v_cvt_pk_bf16_f32 v191, v158, v159
v_mfma_f32_16x16x32_bf16 v[120:123], v[16:19], v[232:235], v[120:123]
v_mfma_f32_16x16x32_bf16 v[124:127], v[16:19], v[236:239], v[124:127]
v_mfma_f32_16x16x32_bf16 a[96:99], v[20:23], v[160:163], a[96:99]
s_waitcnt vmcnt(23)
s_barrier
ds_read_b128 v[16:19], v4 offset:24576
v_mfma_f32_16x16x32_bf16 a[100:103], v[20:23], v[164:167], a[100:103]
s_add_u32 m0, s46, 122880
s_add_u32 s40, s35, 122880
buffer_load_dwordx4 v10, s[24:27], s40 offen lds
v_mfma_f32_16x16x32_bf16 a[104:107], v[20:23], v[168:171], a[104:107]
v_mfma_f32_16x16x32_bf16 a[108:111], v[20:23], v[172:175], a[108:111]
s_waitcnt lgkmcnt(1)
v_mfma_f32_16x16x32_bf16 v[112:115], v[24:27], v[240:243], v[112:115]
ds_read_b64_tr_b16 v[20:21], v32 offset:8192
v_mfma_f32_16x16x32_bf16 v[116:119], v[24:27], v[244:247], v[116:119]
ds_read_b64_tr_b16 v[22:23], v32 offset:12288
v_mfma_f32_16x16x32_bf16 v[120:123], v[24:27], v[248:251], v[120:123]
v_mfma_f32_16x16x32_bf16 v[124:127], v[24:27], v[252:255], v[124:127]
v_mfma_f32_16x16x32_bf16 a[112:115], v[28:31], v[160:163], a[112:115]
ds_read_b128 v[24:27], v5 offset:24576
v_mfma_f32_16x16x32_bf16 a[116:119], v[28:31], v[164:167], a[116:119]
v_mfma_f32_16x16x32_bf16 a[120:123], v[28:31], v[168:171], a[120:123]
v_mfma_f32_16x16x32_bf16 a[124:127], v[28:31], v[172:175], a[124:127]
v_mfma_f32_16x16x32_bf16 a[140:143], a[144:147], v[172:175], a[140:143]
s_waitcnt lgkmcnt(1)
v_mfma_f32_16x16x32_bf16 v[128:131], v[16:19], v[192:195], 0
ds_read_b64_tr_b16 v[28:29], v33 offset:8192
v_mfma_f32_16x16x32_bf16 v[132:135], v[16:19], v[196:199], 0
ds_read_b64_tr_b16 v[30:31], v33 offset:12288
v_mfma_f32_16x16x32_bf16 v[136:139], v[16:19], v[200:203], 0
buffer_load_dwordx4 v11, s[24:27], s40 offen offset:1024 lds
v_mfma_f32_16x16x32_bf16 v[140:143], v[16:19], v[204:207], 0
v_exp_f32 v96, v96
v_mfma_f32_16x16x32_bf16 a[0:3], v[20:23], v[176:179], a[0:3]
ds_read_b128 v[16:19], v6 offset:24576
v_mfma_f32_16x16x32_bf16 a[4:7], v[20:23], v[180:183], a[4:7]
v_exp_f32 v97, v97
v_mfma_f32_16x16x32_bf16 a[8:11], v[20:23], v[184:187], a[8:11]
v_exp_f32 v98, v98
v_mfma_f32_16x16x32_bf16 a[12:15], v[20:23], v[188:191], a[12:15]
v_exp_f32 v99, v99
s_waitcnt lgkmcnt(1)
v_mfma_f32_16x16x32_bf16 v[128:131], v[24:27], v[208:211], v[128:131]
ds_read_b64_tr_b16 v[20:21], v34 offset:8192
v_cvt_pk_bf16_f32 v160, v96, v97
v_mfma_f32_16x16x32_bf16 v[132:135], v[24:27], v[212:215], v[132:135]
ds_read_b64_tr_b16 v[22:23], v34 offset:12288
v_cvt_pk_bf16_f32 v161, v98, v99
v_mfma_f32_16x16x32_bf16 v[136:139], v[24:27], v[216:219], v[136:139]
v_exp_f32 v100, v100
v_mfma_f32_16x16x32_bf16 v[140:143], v[24:27], v[220:223], v[140:143]
v_exp_f32 v101, v101
v_mfma_f32_16x16x32_bf16 a[16:19], v[28:31], v[176:179], a[16:19]
ds_read_b128 v[24:27], v7 offset:24576
v_cvt_pk_bf16_f32 v164, v100, v101
v_mfma_f32_16x16x32_bf16 a[20:23], v[28:31], v[180:183], a[20:23]
v_exp_f32 v102, v102
v_mfma_f32_16x16x32_bf16 a[24:27], v[28:31], v[184:187], a[24:27]
v_exp_f32 v103, v103
v_mfma_f32_16x16x32_bf16 a[28:31], v[28:31], v[188:191], a[28:31]
v_exp_f32 v104, v104
v_mfma_f32_16x16x32_bf16 a[128:131], a[144:147], v[176:179], a[128:131]
v_exp_f32 v105, v105
s_waitcnt lgkmcnt(1)
v_mfma_f32_16x16x32_bf16 v[128:131], v[16:19], v[224:227], v[128:131]
ds_read_b64_tr_b16 v[28:29], v35 offset:8192
v_cvt_pk_bf16_f32 v165, v102, v103
v_mfma_f32_16x16x32_bf16 v[132:135], v[16:19], v[228:231], v[132:135]
ds_read_b64_tr_b16 v[30:31], v35 offset:12288
v_cvt_pk_bf16_f32 v168, v104, v105
v_mfma_f32_16x16x32_bf16 v[136:139], v[16:19], v[232:235], v[136:139]
v_exp_f32 v106, v106
v_mfma_f32_16x16x32_bf16 v[140:143], v[16:19], v[236:239], v[140:143]
v_exp_f32 v107, v107
v_mfma_f32_16x16x32_bf16 a[32:35], v[20:23], v[176:179], a[32:35]
ds_read_b128 v[16:19], v4 offset:28672
v_cvt_pk_bf16_f32 v169, v106, v107
v_mfma_f32_16x16x32_bf16 a[36:39], v[20:23], v[180:183], a[36:39]
v_exp_f32 v108, v108
v_mfma_f32_16x16x32_bf16 a[40:43], v[20:23], v[184:187], a[40:43]
v_exp_f32 v109, v109
v_mfma_f32_16x16x32_bf16 a[44:47], v[20:23], v[188:191], a[44:47]
v_exp_f32 v110, v110
s_waitcnt lgkmcnt(1)
v_mfma_f32_16x16x32_bf16 v[128:131], v[24:27], v[240:243], v[128:131]
ds_read_b64_tr_b16 v[20:21], v36 offset:8192
v_cvt_pk_bf16_f32 v172, v108, v109
v_mfma_f32_16x16x32_bf16 v[132:135], v[24:27], v[244:247], v[132:135]
ds_read_b64_tr_b16 v[22:23], v36 offset:12288
v_mfma_f32_16x16x32_bf16 v[136:139], v[24:27], v[248:251], v[136:139]
v_exp_f32 v111, v111
v_mfma_f32_16x16x32_bf16 v[140:143], v[24:27], v[252:255], v[140:143]
v_exp_f32 v112, v112
v_mfma_f32_16x16x32_bf16 a[48:51], v[28:31], v[176:179], a[48:51]
ds_read_b128 v[24:27], v5 offset:28672
v_cvt_pk_bf16_f32 v173, v110, v111
v_mfma_f32_16x16x32_bf16 a[52:55], v[28:31], v[180:183], a[52:55]
v_exp_f32 v113, v113
v_mfma_f32_16x16x32_bf16 a[56:59], v[28:31], v[184:187], a[56:59]
v_exp_f32 v114, v114
v_mfma_f32_16x16x32_bf16 a[60:63], v[28:31], v[188:191], a[60:63]
v_exp_f32 v115, v115
v_mfma_f32_16x16x32_bf16 a[132:135], a[144:147], v[180:183], a[132:135]
v_exp_f32 v116, v116
s_waitcnt lgkmcnt(1)
v_mfma_f32_16x16x32_bf16 v[144:147], v[16:19], v[192:195], 0
ds_read_b64_tr_b16 v[28:29], v37 offset:8192
v_cvt_pk_bf16_f32 v162, v112, v113
v_mfma_f32_16x16x32_bf16 v[148:151], v[16:19], v[196:199], 0
ds_read_b64_tr_b16 v[30:31], v37 offset:12288
v_cvt_pk_bf16_f32 v163, v114, v115
v_mfma_f32_16x16x32_bf16 v[152:155], v[16:19], v[200:203], 0
v_exp_f32 v117, v117
v_mfma_f32_16x16x32_bf16 v[156:159], v[16:19], v[204:207], 0
v_exp_f32 v118, v118
v_mfma_f32_16x16x32_bf16 a[64:67], v[20:23], v[176:179], a[64:67]
ds_read_b128 v[16:19], v6 offset:28672
v_cvt_pk_bf16_f32 v166, v116, v117
v_mfma_f32_16x16x32_bf16 a[68:71], v[20:23], v[180:183], a[68:71]
v_exp_f32 v119, v119
v_mfma_f32_16x16x32_bf16 a[72:75], v[20:23], v[184:187], a[72:75]
v_exp_f32 v120, v120
v_mfma_f32_16x16x32_bf16 a[76:79], v[20:23], v[188:191], a[76:79]
v_exp_f32 v121, v121
s_waitcnt lgkmcnt(1)
v_mfma_f32_16x16x32_bf16 v[144:147], v[24:27], v[208:211], v[144:147]
ds_read_b64_tr_b16 v[20:21], v38 offset:8192
v_cvt_pk_bf16_f32 v167, v118, v119
v_mfma_f32_16x16x32_bf16 v[148:151], v[24:27], v[212:215], v[148:151]
ds_read_b64_tr_b16 v[22:23], v38 offset:12288
v_cvt_pk_bf16_f32 v170, v120, v121
v_mfma_f32_16x16x32_bf16 v[152:155], v[24:27], v[216:219], v[152:155]
v_exp_f32 v122, v122
v_mfma_f32_16x16x32_bf16 v[156:159], v[24:27], v[220:223], v[156:159]
v_exp_f32 v123, v123
v_mfma_f32_16x16x32_bf16 a[80:83], v[28:31], v[176:179], a[80:83]
ds_read_b128 v[24:27], v7 offset:28672
v_cvt_pk_bf16_f32 v171, v122, v123
v_mfma_f32_16x16x32_bf16 a[84:87], v[28:31], v[180:183], a[84:87]
v_exp_f32 v124, v124
v_mfma_f32_16x16x32_bf16 a[88:91], v[28:31], v[184:187], a[88:91]
v_exp_f32 v125, v125
v_mfma_f32_16x16x32_bf16 a[92:95], v[28:31], v[188:191], a[92:95]
v_exp_f32 v126, v126
v_mfma_f32_16x16x32_bf16 a[136:139], a[144:147], v[184:187], a[136:139]
v_exp_f32 v127, v127
s_waitcnt lgkmcnt(1)
v_mfma_f32_16x16x32_bf16 v[144:147], v[16:19], v[224:227], v[144:147]
ds_read_b64_tr_b16 v[28:29], v39 offset:8192
v_cvt_pk_bf16_f32 v174, v124, v125
v_mfma_f32_16x16x32_bf16 v[148:151], v[16:19], v[228:231], v[148:151]
ds_read_b64_tr_b16 v[30:31], v39 offset:12288
v_cvt_pk_bf16_f32 v175, v126, v127
v_mfma_f32_16x16x32_bf16 v[152:155], v[16:19], v[232:235], v[152:155]
v_mfma_f32_16x16x32_bf16 v[156:159], v[16:19], v[236:239], v[156:159]
v_mfma_f32_16x16x32_bf16 a[96:99], v[20:23], v[176:179], a[96:99]
s_waitcnt vmcnt(20)
s_barrier
ds_read_b128 v[16:19], v4 offset:32768
v_mfma_f32_16x16x32_bf16 a[100:103], v[20:23], v[180:183], a[100:103]
v_mfma_f32_16x16x32_bf16 a[104:107], v[20:23], v[184:187], a[104:107]
v_mfma_f32_16x16x32_bf16 a[108:111], v[20:23], v[188:191], a[108:111]
s_waitcnt lgkmcnt(1)
v_mfma_f32_16x16x32_bf16 v[144:147], v[24:27], v[240:243], v[144:147]
ds_read_b64_tr_b16 v[20:21], v32 offset:16384
v_mfma_f32_16x16x32_bf16 v[148:151], v[24:27], v[244:247], v[148:151]
ds_read_b64_tr_b16 v[22:23], v32 offset:20480
v_mfma_f32_16x16x32_bf16 v[152:155], v[24:27], v[248:251], v[152:155]
v_mfma_f32_16x16x32_bf16 v[156:159], v[24:27], v[252:255], v[156:159]
v_mfma_f32_16x16x32_bf16 a[112:115], v[28:31], v[176:179], a[112:115]
ds_read_b128 v[24:27], v5 offset:32768
v_mfma_f32_16x16x32_bf16 a[116:119], v[28:31], v[180:183], a[116:119]
v_mfma_f32_16x16x32_bf16 a[120:123], v[28:31], v[184:187], a[120:123]
v_mfma_f32_16x16x32_bf16 a[124:127], v[28:31], v[188:191], a[124:127]
v_mfma_f32_16x16x32_bf16 a[140:143], a[144:147], v[188:191], a[140:143]
s_movk_i32 s72, 1152
s_mov_b32 s73, 238609295
s_waitcnt lgkmcnt(1)
v_mfma_f32_16x16x32_bf16 v[96:99], v[16:19], v[192:195], 0
ds_read_b64_tr_b16 v[28:29], v33 offset:16384
v_add_u32 v44, 0, v0
v_mfma_f32_16x16x32_bf16 v[100:103], v[16:19], v[196:199], 0
ds_read_b64_tr_b16 v[30:31], v33 offset:20480
v_mul_hi_u32 v45, v44, s73
v_mfma_f32_16x16x32_bf16 v[104:107], v[16:19], v[200:203], 0
v_exp_f32 v128, v128
v_mfma_f32_16x16x32_bf16 v[108:111], v[16:19], v[204:207], 0
v_exp_f32 v129, v129
v_mfma_f32_16x16x32_bf16 a[0:3], v[20:23], v[160:163], a[0:3]
ds_read_b128 v[16:19], v6 offset:32768
v_mul_u32_u24 v46, 18, v45
v_mfma_f32_16x16x32_bf16 a[4:7], v[20:23], v[164:167], a[4:7]
v_exp_f32 v130, v130
v_mfma_f32_16x16x32_bf16 a[8:11], v[20:23], v[168:171], a[8:11]
v_exp_f32 v131, v131
v_mfma_f32_16x16x32_bf16 a[12:15], v[20:23], v[172:175], a[12:15]
v_exp_f32 v132, v132
s_waitcnt lgkmcnt(1)
v_mfma_f32_16x16x32_bf16 v[96:99], v[24:27], v[208:211], v[96:99]
ds_read_b64_tr_b16 v[20:21], v34 offset:16384
v_sub_u32 v46, v44, v46
v_mfma_f32_16x16x32_bf16 v[100:103], v[24:27], v[212:215], v[100:103]
ds_read_b64_tr_b16 v[22:23], v34 offset:20480
v_mul_lo_u32 v45, v45, s72
v_mfma_f32_16x16x32_bf16 v[104:107], v[24:27], v[216:219], v[104:107]
v_exp_f32 v133, v133
v_mfma_f32_16x16x32_bf16 v[108:111], v[24:27], v[220:223], v[108:111]
v_exp_f32 v134, v134
v_mfma_f32_16x16x32_bf16 a[16:19], v[28:31], v[160:163], a[16:19]
ds_read_b128 v[24:27], v7 offset:32768
v_lshl_add_u32 v45, v46, 4, v45
v_mfma_f32_16x16x32_bf16 a[20:23], v[28:31], v[164:167], a[20:23]
v_exp_f32 v135, v135
v_mfma_f32_16x16x32_bf16 a[24:27], v[28:31], v[168:171], a[24:27]
v_exp_f32 v136, v136
v_mfma_f32_16x16x32_bf16 a[28:31], v[28:31], v[172:175], a[28:31]
v_exp_f32 v137, v137
v_mfma_f32_16x16x32_bf16 a[128:131], a[144:147], v[160:163], a[128:131]
v_exp_f32 v138, v138
s_waitcnt lgkmcnt(1)
v_mfma_f32_16x16x32_bf16 v[96:99], v[16:19], v[224:227], v[96:99]
ds_read_b64_tr_b16 v[28:29], v35 offset:16384
v_subrev_u32 v1, 0, v45
v_mfma_f32_16x16x32_bf16 v[100:103], v[16:19], v[228:231], v[100:103]
ds_read_b64_tr_b16 v[30:31], v35 offset:20480
v_add_u32 v44, 64, v0
v_mfma_f32_16x16x32_bf16 v[104:107], v[16:19], v[232:235], v[104:107]
v_exp_f32 v139, v139
v_mfma_f32_16x16x32_bf16 v[108:111], v[16:19], v[236:239], v[108:111]
v_exp_f32 v140, v140
v_mfma_f32_16x16x32_bf16 a[32:35], v[20:23], v[160:163], a[32:35]
ds_read_b128 v[16:19], v4 offset:36864
v_mul_hi_u32 v45, v44, s73
v_mfma_f32_16x16x32_bf16 a[36:39], v[20:23], v[164:167], a[36:39]
v_exp_f32 v141, v141
v_mfma_f32_16x16x32_bf16 a[40:43], v[20:23], v[168:171], a[40:43]
v_exp_f32 v142, v142
v_mfma_f32_16x16x32_bf16 a[44:47], v[20:23], v[172:175], a[44:47]
v_exp_f32 v143, v143
s_waitcnt lgkmcnt(1)
v_mfma_f32_16x16x32_bf16 v[96:99], v[24:27], v[240:243], v[96:99]
ds_read_b64_tr_b16 v[20:21], v36 offset:16384
v_mul_u32_u24 v46, 18, v45
v_mfma_f32_16x16x32_bf16 v[100:103], v[24:27], v[244:247], v[100:103]
ds_read_b64_tr_b16 v[22:23], v36 offset:20480
v_sub_u32 v46, v44, v46
v_mfma_f32_16x16x32_bf16 v[104:107], v[24:27], v[248:251], v[104:107]
v_exp_f32 v144, v144
v_mfma_f32_16x16x32_bf16 v[108:111], v[24:27], v[252:255], v[108:111]
v_exp_f32 v145, v145
v_mfma_f32_16x16x32_bf16 a[48:51], v[28:31], v[160:163], a[48:51]
ds_read_b128 v[24:27], v5 offset:36864
v_mul_lo_u32 v45, v45, s72
v_mfma_f32_16x16x32_bf16 a[52:55], v[28:31], v[164:167], a[52:55]
v_exp_f32 v146, v146
v_mfma_f32_16x16x32_bf16 a[56:59], v[28:31], v[168:171], a[56:59]
v_exp_f32 v147, v147
v_mfma_f32_16x16x32_bf16 a[60:63], v[28:31], v[172:175], a[60:63]
v_exp_f32 v148, v148
v_mfma_f32_16x16x32_bf16 a[132:135], a[144:147], v[164:167], a[132:135]
v_exp_f32 v149, v149
s_waitcnt lgkmcnt(1)
v_mfma_f32_16x16x32_bf16 v[112:115], v[16:19], v[192:195], 0
ds_read_b64_tr_b16 v[28:29], v37 offset:16384
v_lshl_add_u32 v45, v46, 4, v45
v_mfma_f32_16x16x32_bf16 v[116:119], v[16:19], v[196:199], 0
ds_read_b64_tr_b16 v[30:31], v37 offset:20480
v_subrev_u32 v2, 1024, v45
v_mfma_f32_16x16x32_bf16 v[120:123], v[16:19], v[200:203], 0
v_exp_f32 v150, v150
v_mfma_f32_16x16x32_bf16 v[124:127], v[16:19], v[204:207], 0
v_exp_f32 v151, v151
v_mfma_f32_16x16x32_bf16 a[64:67], v[20:23], v[160:163], a[64:67]
ds_read_b128 v[16:19], v6 offset:36864
v_add_u32 v44, 128, v0
v_mfma_f32_16x16x32_bf16 a[68:71], v[20:23], v[164:167], a[68:71]
v_exp_f32 v152, v152
v_mfma_f32_16x16x32_bf16 a[72:75], v[20:23], v[168:171], a[72:75]
v_exp_f32 v153, v153
v_mfma_f32_16x16x32_bf16 a[76:79], v[20:23], v[172:175], a[76:79]
v_exp_f32 v154, v154
s_waitcnt lgkmcnt(1)
v_mfma_f32_16x16x32_bf16 v[112:115], v[24:27], v[208:211], v[112:115]
ds_read_b64_tr_b16 v[20:21], v38 offset:16384
v_mul_hi_u32 v45, v44, s73
v_mfma_f32_16x16x32_bf16 v[116:119], v[24:27], v[212:215], v[116:119]
ds_read_b64_tr_b16 v[22:23], v38 offset:20480
v_mul_u32_u24 v46, 18, v45
v_mfma_f32_16x16x32_bf16 v[120:123], v[24:27], v[216:219], v[120:123]
v_exp_f32 v155, v155
v_mfma_f32_16x16x32_bf16 v[124:127], v[24:27], v[220:223], v[124:127]
v_exp_f32 v156, v156
v_mfma_f32_16x16x32_bf16 a[80:83], v[28:31], v[160:163], a[80:83]
ds_read_b128 v[24:27], v7 offset:36864
v_sub_u32 v46, v44, v46
v_mfma_f32_16x16x32_bf16 a[84:87], v[28:31], v[164:167], a[84:87]
v_exp_f32 v157, v157
v_mfma_f32_16x16x32_bf16 a[88:91], v[28:31], v[168:171], a[88:91]
v_mul_lo_u32 v45, v45, s72
v_lshl_add_u32 v45, v46, 4, v45
v_mfma_f32_16x16x32_bf16 a[92:95], v[28:31], v[172:175], a[92:95]
v_subrev_u32 v3, 2048, v45
v_add_u32 v44, 192, v0
v_mfma_f32_16x16x32_bf16 a[136:139], a[144:147], v[168:171], a[136:139]
v_mul_hi_u32 v45, v44, s73
v_mul_u32_u24 v46, 18, v45
s_waitcnt lgkmcnt(1)
v_mfma_f32_16x16x32_bf16 v[112:115], v[16:19], v[224:227], v[112:115]
ds_read_b64_tr_b16 v[28:29], v39 offset:16384
v_sub_u32 v46, v44, v46
v_mfma_f32_16x16x32_bf16 v[116:119], v[16:19], v[228:231], v[116:119]
ds_read_b64_tr_b16 v[30:31], v39 offset:20480
v_mul_lo_u32 v45, v45, s72
v_mfma_f32_16x16x32_bf16 v[120:123], v[16:19], v[232:235], v[120:123]
v_lshl_add_u32 v45, v46, 4, v45
v_subrev_u32 v8, 3072, v45
v_mfma_f32_16x16x32_bf16 v[124:127], v[16:19], v[236:239], v[124:127]
v_add_u32 v44, 256, v0
v_mul_hi_u32 v45, v44, s73
v_mfma_f32_16x16x32_bf16 a[96:99], v[20:23], v[160:163], a[96:99]
s_waitcnt vmcnt(15)
s_barrier
ds_read_b128 v[16:19], v4 offset:40960
v_mfma_f32_16x16x32_bf16 a[100:103], v[20:23], v[164:167], a[100:103]
v_mul_u32_u24 v46, 18, v45
v_sub_u32 v46, v44, v46
v_mfma_f32_16x16x32_bf16 a[104:107], v[20:23], v[168:171], a[104:107]
v_mul_lo_u32 v45, v45, s72
v_lshl_add_u32 v45, v46, 4, v45
v_mfma_f32_16x16x32_bf16 a[108:111], v[20:23], v[172:175], a[108:111]
v_subrev_u32 v10, 0, v45
v_add_u32 v44, 320, v0
s_waitcnt lgkmcnt(1)
v_mfma_f32_16x16x32_bf16 v[112:115], v[24:27], v[240:243], v[112:115]
ds_read_b64_tr_b16 v[20:21], v32 offset:24576
v_mul_hi_u32 v45, v44, s73
v_mfma_f32_16x16x32_bf16 v[116:119], v[24:27], v[244:247], v[116:119]
ds_read_b64_tr_b16 v[22:23], v32 offset:28672
v_mul_u32_u24 v46, 18, v45
v_mfma_f32_16x16x32_bf16 v[120:123], v[24:27], v[248:251], v[120:123]
v_sub_u32 v46, v44, v46
v_mul_lo_u32 v45, v45, s72
v_mfma_f32_16x16x32_bf16 v[124:127], v[24:27], v[252:255], v[124:127]
v_lshl_add_u32 v45, v46, 4, v45
v_subrev_u32 v11, 1024, v45
v_mfma_f32_16x16x32_bf16 a[112:115], v[28:31], v[160:163], a[112:115]
ds_read_b128 v[24:27], v5 offset:40960
v_add_u32 v44, 384, v0
v_mul_hi_u32 v45, v44, s73
v_mul_u32_u24 v46, 18, v45
v_sub_u32 v46, v44, v46
v_mul_lo_u32 v45, v45, s72
v_lshl_add_u32 v45, v46, 4, v45
v_subrev_u32 v12, 2048, v45
v_add_u32 v44, 448, v0
v_mul_hi_u32 v45, v44, s73
v_mul_u32_u24 v46, 18, v45
v_sub_u32 v46, v44, v46
v_mul_lo_u32 v45, v45, s72
v_lshl_add_u32 v45, v46, 4, v45
v_subrev_u32 v13, 3072, v45
v_add_u32 v44, 512, v0
v_mul_hi_u32 v45, v44, s73
v_mul_u32_u24 v46, 18, v45
v_sub_u32 v46, v44, v46
v_mul_lo_u32 v45, v45, s72
v_lshl_add_u32 v45, v46, 4, v45
v_subrev_u32 v14, 0, v45
v_lshrrev_b32 v44, 4, v0
v_and_b32 v45, 15, v0
v_lshrrev_b32 v46, 2, v45
v_and_b32 v47, 3, v45
v_lshl_add_u32 v44, v44, 2, v46
v_mul_u32_u24 v44, 288, v44
v_lshl_add_u32 v15, v47, 3, v44
v_mfma_f32_16x16x32_bf16 a[116:119], v[28:31], v[164:167], a[116:119]
v_cvt_pk_bf16_f32 v176, v128, v129
v_cvt_pk_bf16_f32 v177, v130, v131
v_mfma_f32_16x16x32_bf16 a[120:123], v[28:31], v[168:171], a[120:123]
v_exp_f32 v158, v158
v_mfma_f32_16x16x32_bf16 a[124:127], v[28:31], v[172:175], a[124:127]
v_exp_f32 v159, v159
v_cvt_pk_bf16_f32 v180, v132, v133
v_cvt_pk_bf16_f32 v181, v134, v135
v_cvt_pk_bf16_f32 v184, v136, v137
v_cvt_pk_bf16_f32 v185, v138, v139
v_cvt_pk_bf16_f32 v188, v140, v141
v_cvt_pk_bf16_f32 v189, v142, v143
v_cvt_pk_bf16_f32 v178, v144, v145
v_cvt_pk_bf16_f32 v179, v146, v147
v_cvt_pk_bf16_f32 v182, v148, v149
v_cvt_pk_bf16_f32 v183, v150, v151
v_cvt_pk_bf16_f32 v186, v152, v153
v_cvt_pk_bf16_f32 v187, v154, v155
v_cvt_pk_bf16_f32 v190, v156, v157
v_mfma_f32_16x16x32_bf16 a[140:143], a[144:147], v[172:175], a[140:143]
v_cvt_pk_bf16_f32 v191, v158, v159
s_waitcnt lgkmcnt(1)
v_mfma_f32_16x16x32_bf16 v[128:131], v[16:19], v[192:195], 0
ds_read_b64_tr_b16 v[28:29], v33 offset:24576
v_mfma_f32_16x16x32_bf16 v[132:135], v[16:19], v[196:199], 0
ds_read_b64_tr_b16 v[30:31], v33 offset:28672
v_mfma_f32_16x16x32_bf16 v[136:139], v[16:19], v[200:203], 0
v_exp_f32 v96, v96
v_mfma_f32_16x16x32_bf16 v[140:143], v[16:19], v[204:207], 0
v_exp_f32 v97, v97
v_mfma_f32_16x16x32_bf16 a[0:3], v[20:23], v[176:179], a[0:3]
ds_read_b128 v[16:19], v6 offset:40960
v_cvt_pk_bf16_f32 v160, v96, v97
v_mfma_f32_16x16x32_bf16 a[4:7], v[20:23], v[180:183], a[4:7]
v_exp_f32 v98, v98
v_mfma_f32_16x16x32_bf16 a[8:11], v[20:23], v[184:187], a[8:11]
v_exp_f32 v99, v99
v_mfma_f32_16x16x32_bf16 a[12:15], v[20:23], v[188:191], a[12:15]
v_exp_f32 v100, v100
s_waitcnt lgkmcnt(1)
v_mfma_f32_16x16x32_bf16 v[128:131], v[24:27], v[208:211], v[128:131]
ds_read_b64_tr_b16 v[20:21], v34 offset:24576
v_cvt_pk_bf16_f32 v161, v98, v99
v_mfma_f32_16x16x32_bf16 v[132:135], v[24:27], v[212:215], v[132:135]
ds_read_b64_tr_b16 v[22:23], v34 offset:28672
v_mfma_f32_16x16x32_bf16 v[136:139], v[24:27], v[216:219], v[136:139]
v_exp_f32 v101, v101
v_mfma_f32_16x16x32_bf16 v[140:143], v[24:27], v[220:223], v[140:143]
v_exp_f32 v102, v102
v_mfma_f32_16x16x32_bf16 a[16:19], v[28:31], v[176:179], a[16:19]
ds_read_b128 v[24:27], v7 offset:40960
v_cvt_pk_bf16_f32 v164, v100, v101
v_mfma_f32_16x16x32_bf16 a[20:23], v[28:31], v[180:183], a[20:23]
v_exp_f32 v103, v103
v_mfma_f32_16x16x32_bf16 a[24:27], v[28:31], v[184:187], a[24:27]
v_exp_f32 v104, v104
v_mfma_f32_16x16x32_bf16 a[28:31], v[28:31], v[188:191], a[28:31]
v_exp_f32 v105, v105
v_mfma_f32_16x16x32_bf16 a[128:131], a[144:147], v[176:179], a[128:131]
v_exp_f32 v106, v106
s_waitcnt lgkmcnt(1)
v_mfma_f32_16x16x32_bf16 v[128:131], v[16:19], v[224:227], v[128:131]
ds_read_b64_tr_b16 v[28:29], v35 offset:24576
v_cvt_pk_bf16_f32 v165, v102, v103
v_mfma_f32_16x16x32_bf16 v[132:135], v[16:19], v[228:231], v[132:135]
ds_read_b64_tr_b16 v[30:31], v35 offset:28672
v_cvt_pk_bf16_f32 v168, v104, v105
v_mfma_f32_16x16x32_bf16 v[136:139], v[16:19], v[232:235], v[136:139]
v_exp_f32 v107, v107
v_mfma_f32_16x16x32_bf16 v[140:143], v[16:19], v[236:239], v[140:143]
v_exp_f32 v108, v108
v_mfma_f32_16x16x32_bf16 a[32:35], v[20:23], v[176:179], a[32:35]
ds_read_b128 v[16:19], v4 offset:45056
v_cvt_pk_bf16_f32 v169, v106, v107
v_mfma_f32_16x16x32_bf16 a[36:39], v[20:23], v[180:183], a[36:39]
v_exp_f32 v109, v109
v_mfma_f32_16x16x32_bf16 a[40:43], v[20:23], v[184:187], a[40:43]
v_exp_f32 v110, v110
v_mfma_f32_16x16x32_bf16 a[44:47], v[20:23], v[188:191], a[44:47]
v_exp_f32 v111, v111
s_waitcnt lgkmcnt(1)
v_mfma_f32_16x16x32_bf16 v[128:131], v[24:27], v[240:243], v[128:131]
ds_read_b64_tr_b16 v[20:21], v36 offset:24576
v_cvt_pk_bf16_f32 v172, v108, v109
v_mfma_f32_16x16x32_bf16 v[132:135], v[24:27], v[244:247], v[132:135]
ds_read_b64_tr_b16 v[22:23], v36 offset:28672
v_cvt_pk_bf16_f32 v173, v110, v111
v_mfma_f32_16x16x32_bf16 v[136:139], v[24:27], v[248:251], v[136:139]
v_exp_f32 v112, v112
v_mfma_f32_16x16x32_bf16 v[140:143], v[24:27], v[252:255], v[140:143]
v_exp_f32 v113, v113
v_mfma_f32_16x16x32_bf16 a[48:51], v[28:31], v[176:179], a[48:51]
ds_read_b128 v[24:27], v5 offset:45056
v_cvt_pk_bf16_f32 v162, v112, v113
v_mfma_f32_16x16x32_bf16 a[52:55], v[28:31], v[180:183], a[52:55]
v_exp_f32 v114, v114
v_mfma_f32_16x16x32_bf16 a[56:59], v[28:31], v[184:187], a[56:59]
v_exp_f32 v115, v115
v_mfma_f32_16x16x32_bf16 a[60:63], v[28:31], v[188:191], a[60:63]
v_exp_f32 v116, v116
v_mfma_f32_16x16x32_bf16 a[132:135], a[144:147], v[180:183], a[132:135]
v_exp_f32 v117, v117
s_waitcnt lgkmcnt(1)
v_mfma_f32_16x16x32_bf16 v[144:147], v[16:19], v[192:195], 0
ds_read_b64_tr_b16 v[28:29], v37 offset:24576
v_cvt_pk_bf16_f32 v163, v114, v115
v_mfma_f32_16x16x32_bf16 v[148:151], v[16:19], v[196:199], 0
ds_read_b64_tr_b16 v[30:31], v37 offset:28672
v_cvt_pk_bf16_f32 v166, v116, v117
v_mfma_f32_16x16x32_bf16 v[152:155], v[16:19], v[200:203], 0
v_exp_f32 v118, v118
v_mfma_f32_16x16x32_bf16 v[156:159], v[16:19], v[204:207], 0
v_exp_f32 v119, v119
v_mfma_f32_16x16x32_bf16 a[64:67], v[20:23], v[176:179], a[64:67]
ds_read_b128 v[16:19], v6 offset:45056
v_cvt_pk_bf16_f32 v167, v118, v119
v_mfma_f32_16x16x32_bf16 a[68:71], v[20:23], v[180:183], a[68:71]
v_exp_f32 v120, v120
v_mfma_f32_16x16x32_bf16 a[72:75], v[20:23], v[184:187], a[72:75]
v_exp_f32 v121, v121
v_mfma_f32_16x16x32_bf16 a[76:79], v[20:23], v[188:191], a[76:79]
v_exp_f32 v122, v122
s_waitcnt lgkmcnt(1)
v_mfma_f32_16x16x32_bf16 v[144:147], v[24:27], v[208:211], v[144:147]
ds_read_b64_tr_b16 v[20:21], v38 offset:24576
v_cvt_pk_bf16_f32 v170, v120, v121
v_mfma_f32_16x16x32_bf16 v[148:151], v[24:27], v[212:215], v[148:151]
ds_read_b64_tr_b16 v[22:23], v38 offset:28672
v_mfma_f32_16x16x32_bf16 v[152:155], v[24:27], v[216:219], v[152:155]
v_exp_f32 v123, v123
v_mfma_f32_16x16x32_bf16 v[156:159], v[24:27], v[220:223], v[156:159]
v_exp_f32 v124, v124
v_mfma_f32_16x16x32_bf16 a[80:83], v[28:31], v[176:179], a[80:83]
ds_read_b128 v[24:27], v7 offset:45056
v_cvt_pk_bf16_f32 v171, v122, v123
v_mfma_f32_16x16x32_bf16 a[84:87], v[28:31], v[180:183], a[84:87]
v_exp_f32 v125, v125
v_mfma_f32_16x16x32_bf16 a[88:91], v[28:31], v[184:187], a[88:91]
v_exp_f32 v126, v126
v_mfma_f32_16x16x32_bf16 a[92:95], v[28:31], v[188:191], a[92:95]
v_exp_f32 v127, v127
v_mfma_f32_16x16x32_bf16 a[136:139], a[144:147], v[184:187], a[136:139]
v_cvt_pk_bf16_f32 v174, v124, v125
v_cvt_pk_bf16_f32 v175, v126, v127
s_waitcnt lgkmcnt(1)
v_mfma_f32_16x16x32_bf16 v[144:147], v[16:19], v[224:227], v[144:147]
ds_read_b64_tr_b16 v[28:29], v39 offset:24576
v_mfma_f32_16x16x32_bf16 v[148:151], v[16:19], v[228:231], v[148:151]
ds_read_b64_tr_b16 v[30:31], v39 offset:28672
v_mfma_f32_16x16x32_bf16 v[152:155], v[16:19], v[232:235], v[152:155]
v_mfma_f32_16x16x32_bf16 v[156:159], v[16:19], v[236:239], v[156:159]
v_mfma_f32_16x16x32_bf16 a[96:99], v[20:23], v[176:179], a[96:99]
s_waitcnt vmcnt(9)
s_barrier
ds_read_b128 v[16:19], v4 offset:49152
v_mfma_f32_16x16x32_bf16 a[100:103], v[20:23], v[180:183], a[100:103]
s_add_u32 m0, s47, 0
s_mov_b32 s40, s3
s_mul_i32 s40, s40, 147456
v_mfma_f32_16x16x32_bf16 a[104:107], v[20:23], v[184:187], a[104:107]
s_add_u32 s40, s40, s60
buffer_load_dwordx4 v1, s[48:51], s40 offen offset:0 lds
v_mfma_f32_16x16x32_bf16 a[108:111], v[20:23], v[188:191], a[108:111]
s_waitcnt lgkmcnt(1)
v_mfma_f32_16x16x32_bf16 v[144:147], v[24:27], v[240:243], v[144:147]
ds_read_b64_tr_b16 v[20:21], v32 offset:32768
v_mfma_f32_16x16x32_bf16 v[148:151], v[24:27], v[244:247], v[148:151]
ds_read_b64_tr_b16 v[22:23], v32 offset:36864
v_mfma_f32_16x16x32_bf16 v[152:155], v[24:27], v[248:251], v[152:155]
v_mfma_f32_16x16x32_bf16 v[156:159], v[24:27], v[252:255], v[156:159]
v_mfma_f32_16x16x32_bf16 a[112:115], v[28:31], v[176:179], a[112:115]
ds_read_b128 v[24:27], v5 offset:49152
v_mfma_f32_16x16x32_bf16 a[116:119], v[28:31], v[180:183], a[116:119]
v_mfma_f32_16x16x32_bf16 a[120:123], v[28:31], v[184:187], a[120:123]
v_mfma_f32_16x16x32_bf16 a[124:127], v[28:31], v[188:191], a[124:127]
v_mfma_f32_16x16x32_bf16 a[140:143], a[144:147], v[188:191], a[140:143]
s_waitcnt lgkmcnt(1)
v_mfma_f32_16x16x32_bf16 v[96:99], v[16:19], v[192:195], 0
ds_read_b64_tr_b16 v[28:29], v33 offset:32768
v_mfma_f32_16x16x32_bf16 v[100:103], v[16:19], v[196:199], 0
ds_read_b64_tr_b16 v[30:31], v33 offset:36864
v_mfma_f32_16x16x32_bf16 v[104:107], v[16:19], v[200:203], 0
buffer_load_dwordx4 v2, s[48:51], s40 offen offset:1024 lds
v_mfma_f32_16x16x32_bf16 v[108:111], v[16:19], v[204:207], 0
v_exp_f32 v128, v128
v_mfma_f32_16x16x32_bf16 a[0:3], v[20:23], v[160:163], a[0:3]
ds_read_b128 v[16:19], v6 offset:49152
v_mfma_f32_16x16x32_bf16 a[4:7], v[20:23], v[164:167], a[4:7]
v_exp_f32 v129, v129
v_mfma_f32_16x16x32_bf16 a[8:11], v[20:23], v[168:171], a[8:11]
v_exp_f32 v130, v130
v_mfma_f32_16x16x32_bf16 a[12:15], v[20:23], v[172:175], a[12:15]
v_exp_f32 v131, v131
s_waitcnt lgkmcnt(1)
v_mfma_f32_16x16x32_bf16 v[96:99], v[24:27], v[208:211], v[96:99]
ds_read_b64_tr_b16 v[20:21], v34 offset:32768
v_cvt_pk_bf16_f32 v176, v128, v129
v_mfma_f32_16x16x32_bf16 v[100:103], v[24:27], v[212:215], v[100:103]
ds_read_b64_tr_b16 v[22:23], v34 offset:36864
v_cvt_pk_bf16_f32 v177, v130, v131
v_mfma_f32_16x16x32_bf16 v[104:107], v[24:27], v[216:219], v[104:107]
v_exp_f32 v132, v132
v_mfma_f32_16x16x32_bf16 v[108:111], v[24:27], v[220:223], v[108:111]
v_exp_f32 v133, v133
v_mfma_f32_16x16x32_bf16 a[16:19], v[28:31], v[160:163], a[16:19]
ds_read_b128 v[24:27], v7 offset:49152
v_cvt_pk_bf16_f32 v180, v132, v133
v_mfma_f32_16x16x32_bf16 a[20:23], v[28:31], v[164:167], a[20:23]
v_exp_f32 v134, v134
v_mfma_f32_16x16x32_bf16 a[24:27], v[28:31], v[168:171], a[24:27]
v_exp_f32 v135, v135
v_mfma_f32_16x16x32_bf16 a[28:31], v[28:31], v[172:175], a[28:31]
v_exp_f32 v136, v136
v_mfma_f32_16x16x32_bf16 a[128:131], a[144:147], v[160:163], a[128:131]
buffer_load_dwordx4 v3, s[48:51], s40 offen offset:2048 lds
s_waitcnt lgkmcnt(1)
v_mfma_f32_16x16x32_bf16 v[96:99], v[16:19], v[224:227], v[96:99]
ds_read_b64_tr_b16 v[28:29], v35 offset:32768
v_cvt_pk_bf16_f32 v181, v134, v135
v_mfma_f32_16x16x32_bf16 v[100:103], v[16:19], v[228:231], v[100:103]
ds_read_b64_tr_b16 v[30:31], v35 offset:36864
v_mfma_f32_16x16x32_bf16 v[104:107], v[16:19], v[232:235], v[104:107]
v_exp_f32 v137, v137
v_mfma_f32_16x16x32_bf16 v[108:111], v[16:19], v[236:239], v[108:111]
v_exp_f32 v138, v138
v_mfma_f32_16x16x32_bf16 a[32:35], v[20:23], v[160:163], a[32:35]
ds_read_b128 v[16:19], v4 offset:53248
v_cvt_pk_bf16_f32 v184, v136, v137
v_mfma_f32_16x16x32_bf16 a[36:39], v[20:23], v[164:167], a[36:39]
v_exp_f32 v139, v139
v_mfma_f32_16x16x32_bf16 a[40:43], v[20:23], v[168:171], a[40:43]
v_exp_f32 v140, v140
v_mfma_f32_16x16x32_bf16 a[44:47], v[20:23], v[172:175], a[44:47]
s_lshl_b32 s72, s28, 13
v_exp_f32 v141, v141
s_waitcnt lgkmcnt(1)
v_mfma_f32_16x16x32_bf16 v[96:99], v[24:27], v[240:243], v[96:99]
ds_read_b64_tr_b16 v[20:21], v36 offset:32768
s_add_u32 s72, s72, mk_LS_W1-mk_pc
v_lshl_add_u32 v56, v0, 7, s72
v_mfma_f32_16x16x32_bf16 v[100:103], v[24:27], v[244:247], v[100:103]
ds_read_b64_tr_b16 v[22:23], v36 offset:36864
v_min_u32 v56, mk_fin-mk_pc, v56
v_mfma_f32_16x16x32_bf16 v[104:107], v[24:27], v[248:251], v[104:107]
global_load_dword v57, v56, s[4:5]
v_mfma_f32_16x16x32_bf16 v[108:111], v[24:27], v[252:255], v[108:111]
v_exp_f32 v142, v142
v_mfma_f32_16x16x32_bf16 a[48:51], v[28:31], v[160:163], a[48:51]
ds_read_b128 v[24:27], v5 offset:53248
v_cvt_pk_bf16_f32 v185, v138, v139
v_mfma_f32_16x16x32_bf16 a[52:55], v[28:31], v[164:167], a[52:55]
buffer_load_dwordx4 v8, s[48:51], s40 offen offset:3072 lds
v_mfma_f32_16x16x32_bf16 a[56:59], v[28:31], v[168:171], a[56:59]
v_exp_f32 v143, v143
v_mfma_f32_16x16x32_bf16 a[60:63], v[28:31], v[172:175], a[60:63]
v_exp_f32 v144, v144
v_mfma_f32_16x16x32_bf16 a[132:135], a[144:147], v[164:167], a[132:135]
v_exp_f32 v145, v145
s_waitcnt lgkmcnt(1)
v_mfma_f32_16x16x32_bf16 v[112:115], v[16:19], v[192:195], 0
ds_read_b64_tr_b16 v[28:29], v37 offset:32768
v_cvt_pk_bf16_f32 v188, v140, v141
v_mfma_f32_16x16x32_bf16 v[116:119], v[16:19], v[196:199], 0
ds_read_b64_tr_b16 v[30:31], v37 offset:36864
v_cvt_pk_bf16_f32 v189, v142, v143
v_mfma_f32_16x16x32_bf16 v[120:123], v[16:19], v[200:203], 0
v_exp_f32 v146, v146
v_mfma_f32_16x16x32_bf16 v[124:127], v[16:19], v[204:207], 0
v_exp_f32 v147, v147
v_mfma_f32_16x16x32_bf16 a[64:67], v[20:23], v[160:163], a[64:67]
ds_read_b128 v[16:19], v6 offset:53248
v_cvt_pk_bf16_f32 v178, v144, v145
v_mfma_f32_16x16x32_bf16 a[68:71], v[20:23], v[164:167], a[68:71]
v_exp_f32 v148, v148
v_mfma_f32_16x16x32_bf16 a[72:75], v[20:23], v[168:171], a[72:75]
v_exp_f32 v149, v149
v_mfma_f32_16x16x32_bf16 a[76:79], v[20:23], v[172:175], a[76:79]
s_add_u32 m0, s47, 4096
v_exp_f32 v150, v150
s_waitcnt lgkmcnt(1)
v_mfma_f32_16x16x32_bf16 v[112:115], v[24:27], v[208:211], v[112:115]
ds_read_b64_tr_b16 v[20:21], v38 offset:32768
v_cvt_pk_bf16_f32 v179, v146, v147
v_mfma_f32_16x16x32_bf16 v[116:119], v[24:27], v[212:215], v[116:119]
ds_read_b64_tr_b16 v[22:23], v38 offset:36864
v_cvt_pk_bf16_f32 v182, v148, v149
v_mfma_f32_16x16x32_bf16 v[120:123], v[24:27], v[216:219], v[120:123]
buffer_load_dwordx4 v10, s[48:51], s40 offen offset:0 lds
v_mfma_f32_16x16x32_bf16 v[124:127], v[24:27], v[220:223], v[124:127]
v_exp_f32 v151, v151
v_mfma_f32_16x16x32_bf16 a[80:83], v[28:31], v[160:163], a[80:83]
ds_read_b128 v[24:27], v7 offset:53248
v_cvt_pk_bf16_f32 v183, v150, v151
v_mfma_f32_16x16x32_bf16 a[84:87], v[28:31], v[164:167], a[84:87]
v_exp_f32 v152, v152
v_mfma_f32_16x16x32_bf16 a[88:91], v[28:31], v[168:171], a[88:91]
v_exp_f32 v153, v153
v_mfma_f32_16x16x32_bf16 a[92:95], v[28:31], v[172:175], a[92:95]
v_exp_f32 v154, v154
v_mfma_f32_16x16x32_bf16 a[136:139], a[144:147], v[168:171], a[136:139]
v_exp_f32 v155, v155
s_waitcnt lgkmcnt(1)
v_mfma_f32_16x16x32_bf16 v[112:115], v[16:19], v[224:227], v[112:115]
ds_read_b64_tr_b16 v[28:29], v39 offset:32768
v_cvt_pk_bf16_f32 v186, v152, v153
v_mfma_f32_16x16x32_bf16 v[116:119], v[16:19], v[228:231], v[116:119]
ds_read_b64_tr_b16 v[30:31], v39 offset:36864
v_cvt_pk_bf16_f32 v187, v154, v155
v_mfma_f32_16x16x32_bf16 v[120:123], v[16:19], v[232:235], v[120:123]
v_exp_f32 v156, v156
v_mfma_f32_16x16x32_bf16 v[124:127], v[16:19], v[236:239], v[124:127]
v_exp_f32 v157, v157
v_mfma_f32_16x16x32_bf16 a[96:99], v[20:23], v[160:163], a[96:99]
s_waitcnt vmcnt(11)
s_barrier
ds_read_b128 v[16:19], v4 offset:57344
v_mfma_f32_16x16x32_bf16 a[100:103], v[20:23], v[164:167], a[100:103]
v_exp_f32 v158, v158
v_mfma_f32_16x16x32_bf16 a[104:107], v[20:23], v[168:171], a[104:107]
v_exp_f32 v159, v159
v_mfma_f32_16x16x32_bf16 a[108:111], v[20:23], v[172:175], a[108:111]
buffer_load_dwordx4 v11, s[48:51], s40 offen offset:1024 lds
s_waitcnt lgkmcnt(1)
v_mfma_f32_16x16x32_bf16 v[112:115], v[24:27], v[240:243], v[112:115]
ds_read_b64_tr_b16 v[20:21], v32 offset:40960
v_cvt_pk_bf16_f32 v190, v156, v157
v_mfma_f32_16x16x32_bf16 v[116:119], v[24:27], v[244:247], v[116:119]
ds_read_b64_tr_b16 v[22:23], v32 offset:45056
v_cvt_pk_bf16_f32 v191, v158, v159
v_mfma_f32_16x16x32_bf16 v[120:123], v[24:27], v[248:251], v[120:123]
v_mfma_f32_16x16x32_bf16 v[124:127], v[24:27], v[252:255], v[124:127]
v_mfma_f32_16x16x32_bf16 a[112:115], v[28:31], v[160:163], a[112:115]
ds_read_b128 v[24:27], v5 offset:57344
v_mfma_f32_16x16x32_bf16 a[116:119], v[28:31], v[164:167], a[116:119]
v_mfma_f32_16x16x32_bf16 a[120:123], v[28:31], v[168:171], a[120:123]
v_mfma_f32_16x16x32_bf16 a[124:127], v[28:31], v[172:175], a[124:127]
v_mfma_f32_16x16x32_bf16 a[140:143], a[144:147], v[172:175], a[140:143]
s_waitcnt lgkmcnt(1)
v_mfma_f32_16x16x32_bf16 v[128:131], v[16:19], v[192:195], 0
ds_read_b64_tr_b16 v[28:29], v33 offset:40960
v_mfma_f32_16x16x32_bf16 v[132:135], v[16:19], v[196:199], 0
ds_read_b64_tr_b16 v[30:31], v33 offset:45056
v_mfma_f32_16x16x32_bf16 v[136:139], v[16:19], v[200:203], 0
v_exp_f32 v96, v96
v_mfma_f32_16x16x32_bf16 v[140:143], v[16:19], v[204:207], 0
v_exp_f32 v97, v97
v_mfma_f32_16x16x32_bf16 a[0:3], v[20:23], v[176:179], a[0:3]
ds_read_b128 v[16:19], v6 offset:57344
v_cvt_pk_bf16_f32 v160, v96, v97
v_mfma_f32_16x16x32_bf16 a[4:7], v[20:23], v[180:183], a[4:7]
buffer_load_dwordx4 v12, s[48:51], s40 offen offset:2048 lds
v_mfma_f32_16x16x32_bf16 a[8:11], v[20:23], v[184:187], a[8:11]
v_exp_f32 v98, v98
v_mfma_f32_16x16x32_bf16 a[12:15], v[20:23], v[188:191], a[12:15]
v_exp_f32 v99, v99
s_waitcnt lgkmcnt(1)
v_mfma_f32_16x16x32_bf16 v[128:131], v[24:27], v[208:211], v[128:131]
ds_read_b64_tr_b16 v[20:21], v34 offset:40960
v_cvt_pk_bf16_f32 v161, v98, v99
v_mfma_f32_16x16x32_bf16 v[132:135], v[24:27], v[212:215], v[132:135]
ds_read_b64_tr_b16 v[22:23], v34 offset:45056
v_mfma_f32_16x16x32_bf16 v[136:139], v[24:27], v[216:219], v[136:139]
v_exp_f32 v100, v100
v_mfma_f32_16x16x32_bf16 v[140:143], v[24:27], v[220:223], v[140:143]
v_exp_f32 v101, v101
v_mfma_f32_16x16x32_bf16 a[16:19], v[28:31], v[176:179], a[16:19]
ds_read_b128 v[24:27], v7 offset:57344
v_cvt_pk_bf16_f32 v164, v100, v101
v_mfma_f32_16x16x32_bf16 a[20:23], v[28:31], v[180:183], a[20:23]
v_exp_f32 v102, v102
v_mfma_f32_16x16x32_bf16 a[24:27], v[28:31], v[184:187], a[24:27]
v_exp_f32 v103, v103
v_mfma_f32_16x16x32_bf16 a[28:31], v[28:31], v[188:191], a[28:31]
v_exp_f32 v104, v104
v_mfma_f32_16x16x32_bf16 a[128:131], a[144:147], v[176:179], a[128:131]
v_exp_f32 v105, v105
s_waitcnt lgkmcnt(1)
v_mfma_f32_16x16x32_bf16 v[128:131], v[16:19], v[224:227], v[128:131]
ds_read_b64_tr_b16 v[28:29], v35 offset:40960
v_cvt_pk_bf16_f32 v165, v102, v103
v_mfma_f32_16x16x32_bf16 v[132:135], v[16:19], v[228:231], v[132:135]
ds_read_b64_tr_b16 v[30:31], v35 offset:45056
v_cvt_pk_bf16_f32 v168, v104, v105
v_mfma_f32_16x16x32_bf16 v[136:139], v[16:19], v[232:235], v[136:139]
buffer_load_dwordx4 v13, s[48:51], s40 offen offset:3072 lds
v_mfma_f32_16x16x32_bf16 v[140:143], v[16:19], v[236:239], v[140:143]
v_exp_f32 v106, v106
v_mfma_f32_16x16x32_bf16 a[32:35], v[20:23], v[176:179], a[32:35]
ds_read_b128 v[16:19], v4 offset:61440
v_mfma_f32_16x16x32_bf16 a[36:39], v[20:23], v[180:183], a[36:39]
v_exp_f32 v107, v107
v_mfma_f32_16x16x32_bf16 a[40:43], v[20:23], v[184:187], a[40:43]
v_exp_f32 v108, v108
v_mfma_f32_16x16x32_bf16 a[44:47], v[20:23], v[188:191], a[44:47]
v_exp_f32 v109, v109
s_waitcnt lgkmcnt(1)
v_mfma_f32_16x16x32_bf16 v[128:131], v[24:27], v[240:243], v[128:131]
ds_read_b64_tr_b16 v[20:21], v36 offset:40960
v_cvt_pk_bf16_f32 v169, v106, v107
v_mfma_f32_16x16x32_bf16 v[132:135], v[24:27], v[244:247], v[132:135]
ds_read_b64_tr_b16 v[22:23], v36 offset:45056
v_cvt_pk_bf16_f32 v172, v108, v109
v_mfma_f32_16x16x32_bf16 v[136:139], v[24:27], v[248:251], v[136:139]
v_exp_f32 v110, v110
v_mfma_f32_16x16x32_bf16 v[140:143], v[24:27], v[252:255], v[140:143]
v_exp_f32 v111, v111
v_mfma_f32_16x16x32_bf16 a[48:51], v[28:31], v[176:179], a[48:51]
ds_read_b128 v[24:27], v5 offset:61440
s_add_u32 m0, s47, 8192
v_cvt_pk_bf16_f32 v173, v110, v111
v_mfma_f32_16x16x32_bf16 a[52:55], v[28:31], v[180:183], a[52:55]
v_exp_f32 v112, v112
v_mfma_f32_16x16x32_bf16 a[56:59], v[28:31], v[184:187], a[56:59]
v_exp_f32 v113, v113
v_mfma_f32_16x16x32_bf16 a[60:63], v[28:31], v[188:191], a[60:63]
buffer_load_dwordx4 v14, s[48:51], s40 offen offset:0 lds
v_mfma_f32_16x16x32_bf16 a[132:135], a[144:147], v[180:183], a[132:135]
v_exp_f32 v114, v114
s_waitcnt lgkmcnt(1)
v_mfma_f32_16x16x32_bf16 v[144:147], v[16:19], v[192:195], 0
ds_read_b64_tr_b16 v[28:29], v37 offset:40960
v_cvt_pk_bf16_f32 v162, v112, v113
v_mfma_f32_16x16x32_bf16 v[148:151], v[16:19], v[196:199], 0
ds_read_b64_tr_b16 v[30:31], v37 offset:45056
v_mfma_f32_16x16x32_bf16 v[152:155], v[16:19], v[200:203], 0
v_exp_f32 v115, v115
v_mfma_f32_16x16x32_bf16 v[156:159], v[16:19], v[204:207], 0
v_exp_f32 v116, v116
v_mfma_f32_16x16x32_bf16 a[64:67], v[20:23], v[176:179], a[64:67]
ds_read_b128 v[16:19], v6 offset:61440
v_cvt_pk_bf16_f32 v163, v114, v115
v_mfma_f32_16x16x32_bf16 a[68:71], v[20:23], v[180:183], a[68:71]
v_exp_f32 v117, v117
v_mfma_f32_16x16x32_bf16 a[72:75], v[20:23], v[184:187], a[72:75]
v_exp_f32 v118, v118
v_mfma_f32_16x16x32_bf16 a[76:79], v[20:23], v[188:191], a[76:79]
v_exp_f32 v119, v119
s_waitcnt lgkmcnt(1)
v_mfma_f32_16x16x32_bf16 v[144:147], v[24:27], v[208:211], v[144:147]
ds_read_b64_tr_b16 v[20:21], v38 offset:40960
v_cvt_pk_bf16_f32 v166, v116, v117
v_mfma_f32_16x16x32_bf16 v[148:151], v[24:27], v[212:215], v[148:151]
ds_read_b64_tr_b16 v[22:23], v38 offset:45056
v_cvt_pk_bf16_f32 v167, v118, v119
v_mfma_f32_16x16x32_bf16 v[152:155], v[24:27], v[216:219], v[152:155]
v_exp_f32 v120, v120
v_mfma_f32_16x16x32_bf16 v[156:159], v[24:27], v[220:223], v[156:159]
v_exp_f32 v121, v121
v_mfma_f32_16x16x32_bf16 a[80:83], v[28:31], v[176:179], a[80:83]
ds_read_b128 v[24:27], v7 offset:61440
v_cvt_pk_bf16_f32 v170, v120, v121
v_mfma_f32_16x16x32_bf16 a[84:87], v[28:31], v[180:183], a[84:87]
v_exp_f32 v122, v122
v_mfma_f32_16x16x32_bf16 a[88:91], v[28:31], v[184:187], a[88:91]
v_exp_f32 v123, v123
v_mfma_f32_16x16x32_bf16 a[92:95], v[28:31], v[188:191], a[92:95]
v_exp_f32 v124, v124
v_mfma_f32_16x16x32_bf16 a[136:139], a[144:147], v[184:187], a[136:139]
v_exp_f32 v125, v125
s_waitcnt lgkmcnt(1)
v_mfma_f32_16x16x32_bf16 v[144:147], v[16:19], v[224:227], v[144:147]
ds_read_b64_tr_b16 v[28:29], v39 offset:40960
v_cvt_pk_bf16_f32 v171, v122, v123
v_mfma_f32_16x16x32_bf16 v[148:151], v[16:19], v[228:231], v[148:151]
ds_read_b64_tr_b16 v[30:31], v39 offset:45056
v_cvt_pk_bf16_f32 v174, v124, v125
v_mfma_f32_16x16x32_bf16 v[152:155], v[16:19], v[232:235], v[152:155]
v_exp_f32 v126, v126
v_mfma_f32_16x16x32_bf16 v[156:159], v[16:19], v[236:239], v[156:159]
v_exp_f32 v127, v127
v_mfma_f32_16x16x32_bf16 a[96:99], v[20:23], v[176:179], a[96:99]
s_waitcnt vmcnt(12)
s_barrier
ds_read_b64_tr_b16 v[16:17], v32 offset:49152
v_mfma_f32_16x16x32_bf16 a[100:103], v[20:23], v[180:183], a[100:103]
ds_read_b64_tr_b16 v[18:19], v32 offset:53248
v_cvt_pk_bf16_f32 v175, v126, v127
v_mfma_f32_16x16x32_bf16 a[104:107], v[20:23], v[184:187], a[104:107]
v_mfma_f32_16x16x32_bf16 a[108:111], v[20:23], v[188:191], a[108:111]
s_waitcnt lgkmcnt(2)
v_mfma_f32_16x16x32_bf16 v[144:147], v[24:27], v[240:243], v[144:147]
ds_read_b64_tr_b16 v[20:21], v33 offset:49152
v_mfma_f32_16x16x32_bf16 v[148:151], v[24:27], v[244:247], v[148:151]
ds_read_b64_tr_b16 v[22:23], v33 offset:53248
v_mfma_f32_16x16x32_bf16 v[152:155], v[24:27], v[248:251], v[152:155]
v_mfma_f32_16x16x32_bf16 v[156:159], v[24:27], v[252:255], v[156:159]
v_mfma_f32_16x16x32_bf16 a[112:115], v[28:31], v[176:179], a[112:115]
ds_read_b64_tr_b16 v[24:25], v34 offset:49152
v_mfma_f32_16x16x32_bf16 a[116:119], v[28:31], v[180:183], a[116:119]
ds_read_b64_tr_b16 v[26:27], v34 offset:53248
v_mfma_f32_16x16x32_bf16 a[120:123], v[28:31], v[184:187], a[120:123]
v_mfma_f32_16x16x32_bf16 a[124:127], v[28:31], v[188:191], a[124:127]
v_mfma_f32_16x16x32_bf16 a[140:143], a[144:147], v[188:191], a[140:143]
s_waitcnt lgkmcnt(2)
v_mfma_f32_16x16x32_bf16 a[0:3], v[16:19], v[160:163], a[0:3]
ds_read_b64_tr_b16 v[28:29], v35 offset:49152
v_mfma_f32_16x16x32_bf16 a[4:7], v[16:19], v[164:167], a[4:7]
ds_read_b64_tr_b16 v[30:31], v35 offset:53248
v_mfma_f32_16x16x32_bf16 a[8:11], v[16:19], v[168:171], a[8:11]
v_exp_f32 v128, v128
v_mfma_f32_16x16x32_bf16 a[12:15], v[16:19], v[172:175], a[12:15]
v_exp_f32 v129, v129
v_mfma_f32_16x16x32_bf16 a[16:19], v[20:23], v[160:163], a[16:19]
ds_read_b64_tr_b16 v[16:17], v36 offset:49152
v_cvt_pk_bf16_f32 v176, v128, v129
v_mfma_f32_16x16x32_bf16 a[20:23], v[20:23], v[164:167], a[20:23]
ds_read_b64_tr_b16 v[18:19], v36 offset:53248
v_mfma_f32_16x16x32_bf16 a[24:27], v[20:23], v[168:171], a[24:27]
v_exp_f32 v130, v130
v_mfma_f32_16x16x32_bf16 a[28:31], v[20:23], v[172:175], a[28:31]
v_exp_f32 v131, v131
v_mfma_f32_16x16x32_bf16 a[128:131], a[144:147], v[160:163], a[128:131]
v_exp_f32 v132, v132
s_waitcnt lgkmcnt(2)
v_mfma_f32_16x16x32_bf16 a[32:35], v[24:27], v[160:163], a[32:35]
ds_read_b64_tr_b16 v[20:21], v37 offset:49152
v_cvt_pk_bf16_f32 v177, v130, v131
v_mfma_f32_16x16x32_bf16 a[36:39], v[24:27], v[164:167], a[36:39]
ds_read_b64_tr_b16 v[22:23], v37 offset:53248
v_mfma_f32_16x16x32_bf16 a[40:43], v[24:27], v[168:171], a[40:43]
v_exp_f32 v133, v133
v_mfma_f32_16x16x32_bf16 a[44:47], v[24:27], v[172:175], a[44:47]
v_exp_f32 v134, v134
v_mfma_f32_16x16x32_bf16 a[48:51], v[28:31], v[160:163], a[48:51]
ds_read_b64_tr_b16 v[24:25], v38 offset:49152
v_cvt_pk_bf16_f32 v180, v132, v133
v_mfma_f32_16x16x32_bf16 a[52:55], v[28:31], v[164:167], a[52:55]
ds_read_b64_tr_b16 v[26:27], v38 offset:53248
v_mfma_f32_16x16x32_bf16 a[56:59], v[28:31], v[168:171], a[56:59]
v_exp_f32 v135, v135
v_mfma_f32_16x16x32_bf16 a[60:63], v[28:31], v[172:175], a[60:63]
v_exp_f32 v136, v136
v_mfma_f32_16x16x32_bf16 a[132:135], a[144:147], v[164:167], a[132:135]
v_exp_f32 v137, v137
s_waitcnt lgkmcnt(2)
v_mfma_f32_16x16x32_bf16 a[64:67], v[16:19], v[160:163], a[64:67]
ds_read_b64_tr_b16 v[28:29], v39 offset:49152
v_cvt_pk_bf16_f32 v181, v134, v135
v_mfma_f32_16x16x32_bf16 a[68:71], v[16:19], v[164:167], a[68:71]
ds_read_b64_tr_b16 v[30:31], v39 offset:53248
v_cvt_pk_bf16_f32 v184, v136, v137
v_mfma_f32_16x16x32_bf16 a[72:75], v[16:19], v[168:171], a[72:75]
v_exp_f32 v138, v138
v_mfma_f32_16x16x32_bf16 a[76:79], v[16:19], v[172:175], a[76:79]
v_exp_f32 v139, v139
v_mfma_f32_16x16x32_bf16 a[80:83], v[20:23], v[160:163], a[80:83]
s_waitcnt vmcnt(10)
s_barrier
ds_read_b64_tr_b16 v[16:17], v32 offset:57344
v_mfma_f32_16x16x32_bf16 a[84:87], v[20:23], v[164:167], a[84:87]
ds_read_b64_tr_b16 v[18:19], v32 offset:61440
s_add_u32 m0, s47, 36864
v_cvt_pk_bf16_f32 v185, v138, v139
v_mfma_f32_16x16x32_bf16 a[88:91], v[20:23], v[168:171], a[88:91]
s_add_u32 s40, s68, 0
s_and_b32 s40, s40, 3
v_exp_f32 v140, v140
v_mfma_f32_16x16x32_bf16 a[92:95], v[20:23], v[172:175], a[92:95]
s_add_u32 s40, s40, s74
s_mul_i32 s40, s40, 147456
v_exp_f32 v141, v141
v_mfma_f32_16x16x32_bf16 a[136:139], a[144:147], v[168:171], a[136:139]
s_add_u32 s40, s40, s60
buffer_load_dwordx4 v1, s[48:51], s40 offen offset:0 lds
s_waitcnt lgkmcnt(2)
v_mfma_f32_16x16x32_bf16 a[96:99], v[24:27], v[160:163], a[96:99]
ds_read_b64_tr_b16 v[20:21], v33 offset:57344
v_cvt_pk_bf16_f32 v188, v140, v141
v_mfma_f32_16x16x32_bf16 a[100:103], v[24:27], v[164:167], a[100:103]
ds_read_b64_tr_b16 v[22:23], v33 offset:61440
v_mfma_f32_16x16x32_bf16 a[104:107], v[24:27], v[168:171], a[104:107]
v_exp_f32 v142, v142
v_mfma_f32_16x16x32_bf16 a[108:111], v[24:27], v[172:175], a[108:111]
v_exp_f32 v143, v143
v_mfma_f32_16x16x32_bf16 a[112:115], v[28:31], v[160:163], a[112:115]
ds_read_b64_tr_b16 v[24:25], v34 offset:57344
v_cvt_pk_bf16_f32 v189, v142, v143
v_mfma_f32_16x16x32_bf16 a[116:119], v[28:31], v[164:167], a[116:119]
ds_read_b64_tr_b16 v[26:27], v34 offset:61440
v_mfma_f32_16x16x32_bf16 a[120:123], v[28:31], v[168:171], a[120:123]
v_exp_f32 v144, v144
v_mfma_f32_16x16x32_bf16 a[124:127], v[28:31], v[172:175], a[124:127]
v_exp_f32 v145, v145
v_exp_f32 v146, v146
v_exp_f32 v147, v147
v_exp_f32 v148, v148
v_exp_f32 v149, v149
v_exp_f32 v150, v150
v_exp_f32 v151, v151
v_exp_f32 v152, v152
v_exp_f32 v153, v153
v_exp_f32 v154, v154
v_exp_f32 v155, v155
v_exp_f32 v156, v156
v_exp_f32 v157, v157
v_exp_f32 v158, v158
v_exp_f32 v159, v159
v_mfma_f32_16x16x32_bf16 a[140:143], a[144:147], v[172:175], a[140:143]
v_cvt_pk_bf16_f32 v178, v144, v145
v_cvt_pk_bf16_f32 v179, v146, v147
v_cvt_pk_bf16_f32 v182, v148, v149
v_cvt_pk_bf16_f32 v183, v150, v151
v_cvt_pk_bf16_f32 v186, v152, v153
v_cvt_pk_bf16_f32 v187, v154, v155
v_cvt_pk_bf16_f32 v190, v156, v157
v_cvt_pk_bf16_f32 v191, v158, v159
s_waitcnt lgkmcnt(2)
v_mfma_f32_16x16x32_bf16 a[128:131], a[144:147], v[176:179], a[128:131]
ds_read_b64_tr_b16 v[28:29], v35 offset:57344
v_mfma_f32_16x16x32_bf16 a[132:135], a[144:147], v[180:183], a[132:135]
ds_read_b64_tr_b16 v[30:31], v35 offset:61440
v_mfma_f32_16x16x32_bf16 a[136:139], a[144:147], v[184:187], a[136:139]
buffer_load_dwordx4 v2, s[48:51], s40 offen offset:1024 lds
v_mfma_f32_16x16x32_bf16 a[140:143], a[144:147], v[188:191], a[140:143]
v_mfma_f32_16x16x32_bf16 a[0:3], v[16:19], v[176:179], a[0:3]
v_mfma_f32_16x16x32_bf16 a[4:7], v[16:19], v[180:183], a[4:7]
v_mfma_f32_16x16x32_bf16 a[8:11], v[16:19], v[184:187], a[8:11]
v_mfma_f32_16x16x32_bf16 a[12:15], v[16:19], v[188:191], a[12:15]
v_mfma_f32_16x16x32_bf16 a[16:19], v[20:23], v[176:179], a[16:19]
ds_read_b64_tr_b16 v[16:17], v36 offset:57344
v_mfma_f32_16x16x32_bf16 a[20:23], v[20:23], v[180:183], a[20:23]
ds_read_b64_tr_b16 v[18:19], v36 offset:61440
v_accvgpr_read_b32 v4, a128
v_mfma_f32_16x16x32_bf16 a[24:27], v[20:23], v[184:187], a[24:27]
v_rcp_f32 v4, v4
v_mfma_f32_16x16x32_bf16 a[28:31], v[20:23], v[188:191], a[28:31]
v_accvgpr_read_b32 v5, a132
v_accvgpr_read_b32 v6, a136
s_waitcnt lgkmcnt(2)
v_mfma_f32_16x16x32_bf16 a[32:35], v[24:27], v[176:179], a[32:35]
ds_read_b64_tr_b16 v[20:21], v37 offset:57344
v_accvgpr_read_b32 v7, a140
v_mfma_f32_16x16x32_bf16 a[36:39], v[24:27], v[180:183], a[36:39]
ds_read_b64_tr_b16 v[22:23], v37 offset:61440
v_mfma_f32_16x16x32_bf16 a[40:43], v[24:27], v[184:187], a[40:43]
v_rcp_f32 v5, v5
v_mfma_f32_16x16x32_bf16 a[44:47], v[24:27], v[188:191], a[44:47]
buffer_load_dwordx4 v3, s[48:51], s40 offen offset:2048 lds
v_mfma_f32_16x16x32_bf16 a[48:51], v[28:31], v[176:179], a[48:51]
ds_read_b64_tr_b16 v[24:25], v38 offset:57344
v_accvgpr_read_b32 v40, a0
v_mfma_f32_16x16x32_bf16 a[52:55], v[28:31], v[180:183], a[52:55]
ds_read_b64_tr_b16 v[26:27], v38 offset:61440
v_accvgpr_read_b32 v41, a1
v_mfma_f32_16x16x32_bf16 a[56:59], v[28:31], v[184:187], a[56:59]
v_rcp_f32 v6, v6
v_mfma_f32_16x16x32_bf16 a[60:63], v[28:31], v[188:191], a[60:63]
v_rcp_f32 v7, v7
s_waitcnt lgkmcnt(2)
v_mfma_f32_16x16x32_bf16 a[64:67], v[16:19], v[176:179], a[64:67]
ds_read_b64_tr_b16 v[28:29], v39 offset:57344
v_accvgpr_read_b32 v42, a2
v_mfma_f32_16x16x32_bf16 a[68:71], v[16:19], v[180:183], a[68:71]
ds_read_b64_tr_b16 v[30:31], v39 offset:61440
v_accvgpr_read_b32 v43, a3
v_mfma_f32_16x16x32_bf16 a[72:75], v[16:19], v[184:187], a[72:75]
v_accvgpr_read_b32 v44, a16
v_accvgpr_read_b32 v45, a17
v_mfma_f32_16x16x32_bf16 a[76:79], v[16:19], v[188:191], a[76:79]
v_accvgpr_read_b32 v46, a18
v_accvgpr_read_b32 v47, a19
v_mfma_f32_16x16x32_bf16 a[80:83], v[20:23], v[176:179], a[80:83]
s_waitcnt vmcnt(3)
s_barrier
ds_read_b64_tr_b16 v[16:17], v15 offset:0
v_mfma_f32_16x16x32_bf16 a[84:87], v[20:23], v[180:183], a[84:87]
ds_read_b64_tr_b16 v[18:19], v15 offset:4608
v_mul_f32 v40, v40, v4
v_mfma_f32_16x16x32_bf16 a[88:91], v[20:23], v[184:187], a[88:91]
v_mul_f32 v41, v41, v4
v_mul_f32 v42, v42, v4
v_mfma_f32_16x16x32_bf16 a[92:95], v[20:23], v[188:191], a[92:95]
v_mul_f32 v43, v43, v4
v_mul_f32 v44, v44, v4
s_waitcnt lgkmcnt(2)
v_mfma_f32_16x16x32_bf16 a[96:99], v[24:27], v[176:179], a[96:99]
ds_read_b64_tr_b16 v[20:21], v15 offset:32
v_mul_f32 v45, v45, v4
v_mfma_f32_16x16x32_bf16 a[100:103], v[24:27], v[180:183], a[100:103]
ds_read_b64_tr_b16 v[22:23], v15 offset:4640
v_mul_f32 v46, v46, v4
v_mfma_f32_16x16x32_bf16 a[104:107], v[24:27], v[184:187], a[104:107]
buffer_load_dwordx4 v8, s[48:51], s40 offen offset:3072 lds
v_mfma_f32_16x16x32_bf16 a[108:111], v[24:27], v[188:191], a[108:111]
v_mul_f32 v47, v47, v4
v_cvt_pk_bf16_f32 v48, v40, v41
v_mfma_f32_16x16x32_bf16 a[112:115], v[28:31], v[176:179], a[112:115]
ds_read_b64_tr_b16 v[24:25], v15 offset:64
v_cvt_pk_bf16_f32 v49, v42, v43
v_mfma_f32_16x16x32_bf16 a[116:119], v[28:31], v[180:183], a[116:119]
ds_read_b64_tr_b16 v[26:27], v15 offset:4672
v_cvt_pk_bf16_f32 v50, v44, v45
v_mfma_f32_16x16x32_bf16 a[120:123], v[28:31], v[184:187], a[120:123]
v_cvt_pk_bf16_f32 v51, v46, v47
v_accvgpr_read_b32 v40, a4
v_accvgpr_read_b32 v41, a5
v_accvgpr_read_b32 v42, a6
v_accvgpr_read_b32 v43, a7
v_accvgpr_read_b32 v44, a20
v_accvgpr_read_b32 v45, a21
v_accvgpr_read_b32 v46, a22
v_accvgpr_read_b32 v47, a23
v_mul_f32 v40, v40, v5
v_mul_f32 v41, v41, v5
v_mul_f32 v42, v42, v5
v_mul_f32 v43, v43, v5
v_mul_f32 v44, v44, v5
v_mul_f32 v45, v45, v5
v_mul_f32 v46, v46, v5
v_mul_f32 v47, v47, v5
v_cvt_pk_bf16_f32 v52, v40, v41
v_cvt_pk_bf16_f32 v53, v42, v43
v_cvt_pk_bf16_f32 v54, v44, v45
v_cvt_pk_bf16_f32 v55, v46, v47
v_accvgpr_read_b32 v40, a8
v_accvgpr_read_b32 v41, a9
v_accvgpr_read_b32 v42, a10
v_accvgpr_read_b32 v43, a11
v_accvgpr_read_b32 v44, a24
v_accvgpr_read_b32 v45, a25
v_accvgpr_read_b32 v46, a26
v_accvgpr_read_b32 v47, a27
v_mul_f32 v40, v40, v6
v_mul_f32 v41, v41, v6
v_mul_f32 v42, v42, v6
v_mul_f32 v43, v43, v6
v_mul_f32 v44, v44, v6
v_mul_f32 v45, v45, v6
v_mul_f32 v46, v46, v6
v_mul_f32 v47, v47, v6
v_cvt_pk_bf16_f32 v56, v40, v41
v_cvt_pk_bf16_f32 v57, v42, v43
v_cvt_pk_bf16_f32 v58, v44, v45
v_cvt_pk_bf16_f32 v59, v46, v47
v_accvgpr_read_b32 v40, a12
v_accvgpr_read_b32 v41, a13
v_accvgpr_read_b32 v42, a14
v_accvgpr_read_b32 v43, a15
v_accvgpr_read_b32 v44, a28
v_accvgpr_read_b32 v45, a29
v_accvgpr_read_b32 v46, a30
v_accvgpr_read_b32 v47, a31
v_mul_f32 v40, v40, v7
v_mul_f32 v41, v41, v7
v_mul_f32 v42, v42, v7
v_mul_f32 v43, v43, v7
v_mul_f32 v44, v44, v7
v_mul_f32 v45, v45, v7
v_mul_f32 v46, v46, v7
v_mul_f32 v47, v47, v7
v_cvt_pk_bf16_f32 v60, v40, v41
v_cvt_pk_bf16_f32 v61, v42, v43
v_cvt_pk_bf16_f32 v62, v44, v45
v_cvt_pk_bf16_f32 v63, v46, v47
v_mfma_f32_16x16x32_bf16 a[124:127], v[28:31], v[188:191], a[124:127]
v_min3_f32 v40, v4, v5, v6
v_max3_f32 v41, v4, v5, v6
v_min_f32 v40, v40, v7
v_max_f32 v41, v41, v7
v_subrev_u32 v40, 0x30800000, v40
v_sub_u32 v41, 0x4e800000, v41
v_or_b32 v40, v40, v41
v_cmp_gt_i32 vcc, 0, v40
s_nop 4
s_cbranch_vccnz mk_fbS
mk_fbbackS:
v_accvgpr_read_b32 v40, a32
v_accvgpr_read_b32 v41, a33
v_accvgpr_read_b32 v42, a34
v_accvgpr_read_b32 v43, a35
v_accvgpr_read_b32 v44, a48
v_accvgpr_read_b32 v45, a49
v_accvgpr_read_b32 v46, a50
v_accvgpr_read_b32 v47, a51
v_pk_mul_f32 v[40:41], v[40:41], v[4:5] op_sel_hi:[1,0]
v_pk_mul_f32 v[42:43], v[42:43], v[4:5] op_sel_hi:[1,0]
v_pk_mul_f32 v[44:45], v[44:45], v[4:5] op_sel_hi:[1,0]
v_pk_mul_f32 v[46:47], v[46:47], v[4:5] op_sel_hi:[1,0]
v_cvt_pk_bf16_f32 v64, v40, v41
v_cvt_pk_bf16_f32 v65, v42, v43
v_cvt_pk_bf16_f32 v66, v44, v45
v_cvt_pk_bf16_f32 v67, v46, v47
v_accvgpr_read_b32 v32, a36
v_accvgpr_read_b32 v33, a37
v_accvgpr_read_b32 v34, a38
v_accvgpr_read_b32 v35, a39
v_accvgpr_read_b32 v36, a52
v_accvgpr_read_b32 v37, a53
v_accvgpr_read_b32 v38, a54
v_accvgpr_read_b32 v39, a55
v_pk_mul_f32 v[32:33], v[32:33], v[4:5] op_sel:[0,1] op_sel_hi:[1,1]
v_pk_mul_f32 v[34:35], v[34:35], v[4:5] op_sel:[0,1] op_sel_hi:[1,1]
v_pk_mul_f32 v[36:37], v[36:37], v[4:5] op_sel:[0,1] op_sel_hi:[1,1]
v_pk_mul_f32 v[38:39], v[38:39], v[4:5] op_sel:[0,1] op_sel_hi:[1,1]
v_cvt_pk_bf16_f32 v68, v32, v33
v_cvt_pk_bf16_f32 v69, v34, v35
v_cvt_pk_bf16_f32 v70, v36, v37
v_cvt_pk_bf16_f32 v71, v38, v39
v_accvgpr_read_b32 v40, a40
v_accvgpr_read_b32 v41, a41
v_accvgpr_read_b32 v42, a42
v_accvgpr_read_b32 v43, a43
v_accvgpr_read_b32 v44, a56
v_accvgpr_read_b32 v45, a57
v_accvgpr_read_b32 v46, a58
v_accvgpr_read_b32 v47, a59
v_pk_mul_f32 v[40:41], v[40:41], v[6:7] op_sel_hi:[1,0]
v_pk_mul_f32 v[42:43], v[42:43], v[6:7] op_sel_hi:[1,0]
v_pk_mul_f32 v[44:45], v[44:45], v[6:7] op_sel_hi:[1,0]
v_pk_mul_f32 v[46:47], v[46:47], v[6:7] op_sel_hi:[1,0]
v_cvt_pk_bf16_f32 v72, v40, v41
v_cvt_pk_bf16_f32 v73, v42, v43
v_cvt_pk_bf16_f32 v74, v44, v45
v_cvt_pk_bf16_f32 v75, v46, v47
v_accvgpr_read_b32 v32, a44
v_accvgpr_read_b32 v33, a45
v_accvgpr_read_b32 v34, a46
v_accvgpr_read_b32 v35, a47
v_accvgpr_read_b32 v36, a60
v_accvgpr_read_b32 v37, a61
v_accvgpr_read_b32 v38, a62
v_accvgpr_read_b32 v39, a63
v_pk_mul_f32 v[32:33], v[32:33], v[6:7] op_sel:[0,1] op_sel_hi:[1,1]
v_pk_mul_f32 v[34:35], v[34:35], v[6:7] op_sel:[0,1] op_sel_hi:[1,1]
v_pk_mul_f32 v[36:37], v[36:37], v[6:7] op_sel:[0,1] op_sel_hi:[1,1]
v_pk_mul_f32 v[38:39], v[38:39], v[6:7] op_sel:[0,1] op_sel_hi:[1,1]
v_cvt_pk_bf16_f32 v76, v32, v33
v_cvt_pk_bf16_f32 v77, v34, v35
v_cvt_pk_bf16_f32 v78, v36, v37
v_cvt_pk_bf16_f32 v79, v38, v39
v_accvgpr_read_b32 v40, a64
v_accvgpr_read_b32 v41, a65
v_accvgpr_read_b32 v42, a66
v_accvgpr_read_b32 v43, a67
v_accvgpr_read_b32 v44, a80
v_accvgpr_read_b32 v45, a81
v_accvgpr_read_b32 v46, a82
v_accvgpr_read_b32 v47, a83
v_pk_mul_f32 v[40:41], v[40:41], v[4:5] op_sel_hi:[1,0]
v_pk_mul_f32 v[42:43], v[42:43], v[4:5] op_sel_hi:[1,0]
v_pk_mul_f32 v[44:45], v[44:45], v[4:5] op_sel_hi:[1,0]
v_pk_mul_f32 v[46:47], v[46:47], v[4:5] op_sel_hi:[1,0]
v_cvt_pk_bf16_f32 v80, v40, v41
v_cvt_pk_bf16_f32 v81, v42, v43
v_cvt_pk_bf16_f32 v82, v44, v45
v_cvt_pk_bf16_f32 v83, v46, v47
v_accvgpr_read_b32 v32, a68
v_accvgpr_read_b32 v33, a69
v_accvgpr_read_b32 v34, a70
v_accvgpr_read_b32 v35, a71
v_accvgpr_read_b32 v36, a84
v_accvgpr_read_b32 v37, a85
v_accvgpr_read_b32 v38, a86
v_accvgpr_read_b32 v39, a87
v_pk_mul_f32 v[32:33], v[32:33], v[4:5] op_sel:[0,1] op_sel_hi:[1,1]
v_pk_mul_f32 v[34:35], v[34:35], v[4:5] op_sel:[0,1] op_sel_hi:[1,1]
v_pk_mul_f32 v[36:37], v[36:37], v[4:5] op_sel:[0,1] op_sel_hi:[1,1]
v_pk_mul_f32 v[38:39], v[38:39], v[4:5] op_sel:[0,1] op_sel_hi:[1,1]
v_cvt_pk_bf16_f32 v84, v32, v33
v_cvt_pk_bf16_f32 v85, v34, v35
v_cvt_pk_bf16_f32 v86, v36, v37
v_cvt_pk_bf16_f32 v87, v38, v39
v_accvgpr_read_b32 v40, a72
v_accvgpr_read_b32 v41, a73
v_accvgpr_read_b32 v42, a74
v_accvgpr_read_b32 v43, a75
v_accvgpr_read_b32 v44, a88
v_accvgpr_read_b32 v45, a89
v_accvgpr_read_b32 v46, a90
v_accvgpr_read_b32 v47, a91
v_pk_mul_f32 v[40:41], v[40:41], v[6:7] op_sel_hi:[1,0]
v_pk_mul_f32 v[42:43], v[42:43], v[6:7] op_sel_hi:[1,0]
v_pk_mul_f32 v[44:45], v[44:45], v[6:7] op_sel_hi:[1,0]
v_pk_mul_f32 v[46:47], v[46:47], v[6:7] op_sel_hi:[1,0]
v_cvt_pk_bf16_f32 v88, v40, v41
v_cvt_pk_bf16_f32 v89, v42, v43
v_cvt_pk_bf16_f32 v90, v44, v45
v_cvt_pk_bf16_f32 v91, v46, v47
v_accvgpr_read_b32 v32, a76
v_accvgpr_read_b32 v33, a77
v_accvgpr_read_b32 v34, a78
v_accvgpr_read_b32 v35, a79
v_accvgpr_read_b32 v36, a92
v_accvgpr_read_b32 v37, a93
v_accvgpr_read_b32 v38, a94
v_accvgpr_read_b32 v39, a95
v_pk_mul_f32 v[32:33], v[32:33], v[6:7] op_sel:[0,1] op_sel_hi:[1,1]
v_pk_mul_f32 v[34:35], v[34:35], v[6:7] op_sel:[0,1] op_sel_hi:[1,1]
v_pk_mul_f32 v[36:37], v[36:37], v[6:7] op_sel:[0,1] op_sel_hi:[1,1]
v_pk_mul_f32 v[38:39], v[38:39], v[6:7] op_sel:[0,1] op_sel_hi:[1,1]
v_cvt_pk_bf16_f32 v92, v32, v33
v_cvt_pk_bf16_f32 v93, v34, v35
v_cvt_pk_bf16_f32 v94, v36, v37
v_cvt_pk_bf16_f32 v95, v38, v39
v_accvgpr_read_b32 v40, a96
v_accvgpr_read_b32 v41, a97
v_accvgpr_read_b32 v42, a98
v_accvgpr_read_b32 v43, a99
v_accvgpr_read_b32 v44, a112
v_accvgpr_read_b32 v45, a113
v_accvgpr_read_b32 v46, a114
v_accvgpr_read_b32 v47, a115
v_pk_mul_f32 v[40:41], v[40:41], v[4:5] op_sel_hi:[1,0]
v_pk_mul_f32 v[42:43], v[42:43], v[4:5] op_sel_hi:[1,0]
v_pk_mul_f32 v[44:45], v[44:45], v[4:5] op_sel_hi:[1,0]
v_pk_mul_f32 v[46:47], v[46:47], v[4:5] op_sel_hi:[1,0]
v_cvt_pk_bf16_f32 v96, v40, v41
v_cvt_pk_bf16_f32 v97, v42, v43
v_cvt_pk_bf16_f32 v98, v44, v45
v_cvt_pk_bf16_f32 v99, v46, v47
v_accvgpr_read_b32 v32, a100
v_accvgpr_read_b32 v33, a101
v_accvgpr_read_b32 v34, a102
v_accvgpr_read_b32 v35, a103
v_accvgpr_read_b32 v36, a116
v_accvgpr_read_b32 v37, a117
v_accvgpr_read_b32 v38, a118
v_accvgpr_read_b32 v39, a119
v_pk_mul_f32 v[32:33], v[32:33], v[4:5] op_sel:[0,1] op_sel_hi:[1,1]
v_pk_mul_f32 v[34:35], v[34:35], v[4:5] op_sel:[0,1] op_sel_hi:[1,1]
v_pk_mul_f32 v[36:37], v[36:37], v[4:5] op_sel:[0,1] op_sel_hi:[1,1]
v_pk_mul_f32 v[38:39], v[38:39], v[4:5] op_sel:[0,1] op_sel_hi:[1,1]
v_cvt_pk_bf16_f32 v100, v32, v33
v_cvt_pk_bf16_f32 v101, v34, v35
v_cvt_pk_bf16_f32 v102, v36, v37
v_cvt_pk_bf16_f32 v103, v38, v39
v_accvgpr_read_b32 v40, a104
v_accvgpr_read_b32 v41, a105
v_accvgpr_read_b32 v42, a106
v_accvgpr_read_b32 v43, a107
v_accvgpr_read_b32 v44, a120
v_accvgpr_read_b32 v45, a121
v_accvgpr_read_b32 v46, a122
v_accvgpr_read_b32 v47, a123
v_pk_mul_f32 v[40:41], v[40:41], v[6:7] op_sel_hi:[1,0]
v_pk_mul_f32 v[42:43], v[42:43], v[6:7] op_sel_hi:[1,0]
v_pk_mul_f32 v[44:45], v[44:45], v[6:7] op_sel_hi:[1,0]
v_pk_mul_f32 v[46:47], v[46:47], v[6:7] op_sel_hi:[1,0]
v_cvt_pk_bf16_f32 v104, v40, v41
v_cvt_pk_bf16_f32 v105, v42, v43
v_cvt_pk_bf16_f32 v106, v44, v45
v_cvt_pk_bf16_f32 v107, v46, v47
v_accvgpr_read_b32 v32, a108
v_accvgpr_read_b32 v33, a109
v_accvgpr_read_b32 v34, a110
v_accvgpr_read_b32 v35, a111
v_accvgpr_read_b32 v36, a124
v_accvgpr_read_b32 v37, a125
v_accvgpr_read_b32 v38, a126
v_accvgpr_read_b32 v39, a127
v_pk_mul_f32 v[32:33], v[32:33], v[6:7] op_sel:[0,1] op_sel_hi:[1,1]
v_pk_mul_f32 v[34:35], v[34:35], v[6:7] op_sel:[0,1] op_sel_hi:[1,1]
v_pk_mul_f32 v[36:37], v[36:37], v[6:7] op_sel:[0,1] op_sel_hi:[1,1]
v_pk_mul_f32 v[38:39], v[38:39], v[6:7] op_sel:[0,1] op_sel_hi:[1,1]
v_cvt_pk_bf16_f32 v108, v32, v33
v_cvt_pk_bf16_f32 v109, v34, v35
v_cvt_pk_bf16_f32 v110, v36, v37
v_cvt_pk_bf16_f32 v111, v38, v39
v_mov_b32 v5, 268435456
v_cmp_eq_u32 vcc, 0, v0
s_nop 1
v_cndmask_b32 v4, v5, 0, vcc
v_lshlrev_b32 v6, 2, v0
v_cmp_gt_u32 vcc, 8, v0
s_nop 1
v_cndmask_b32 v6, v5, v6, vcc
v_mov_b32 v5, s100
s_waitcnt lgkmcnt(2)
v_mfma_f32_16x16x32_bf16 v[112:115], v[16:19], v[48:51], 0
ds_read_b64_tr_b16 v[28:29], v15 offset:96
v_mfma_f32_16x16x32_bf16 v[116:119], v[16:19], v[52:55], 0
ds_read_b64_tr_b16 v[30:31], v15 offset:4704
v_mfma_f32_16x16x32_bf16 v[120:123], v[16:19], v[56:59], 0
v_mfma_f32_16x16x32_bf16 v[124:127], v[16:19], v[60:63], 0
s_add_u32 s42, s38, 0
v_mfma_f32_16x16x32_bf16 v[128:131], v[20:23], v[48:51], 0
ds_read_b64_tr_b16 v[16:17], v15 offset:128
s_add_u32 m0, s47, 40960
v_mfma_f32_16x16x32_bf16 v[132:135], v[20:23], v[52:55], 0
ds_read_b64_tr_b16 v[18:19], v15 offset:4736
s_barrier
v_mfma_f32_16x16x32_bf16 v[136:139], v[20:23], v[56:59], 0
buffer_store_dwordx4 v[48:51], v9, s[8:11], s42 offen offset:0 sc1
v_mfma_f32_16x16x32_bf16 v[140:143], v[20:23], v[60:63], 0
buffer_load_dwordx4 v10, s[48:51], s40 offen offset:0 lds
s_waitcnt lgkmcnt(2)
v_mfma_f32_16x16x32_bf16 v[144:147], v[24:27], v[48:51], 0
ds_read_b64_tr_b16 v[20:21], v15 offset:160
v_mfma_f32_16x16x32_bf16 v[148:151], v[24:27], v[52:55], 0
ds_read_b64_tr_b16 v[22:23], v15 offset:4768
v_mfma_f32_16x16x32_bf16 v[152:155], v[24:27], v[56:59], 0
v_mfma_f32_16x16x32_bf16 v[156:159], v[24:27], v[60:63], 0
v_mfma_f32_16x16x32_bf16 v[160:163], v[28:31], v[48:51], 0
ds_read_b64_tr_b16 v[24:25], v15 offset:192
v_mfma_f32_16x16x32_bf16 v[164:167], v[28:31], v[52:55], 0
ds_read_b64_tr_b16 v[26:27], v15 offset:4800
v_mfma_f32_16x16x32_bf16 v[168:171], v[28:31], v[56:59], 0
buffer_store_dwordx4 v[52:55], v9, s[8:11], s42 offen offset:1024 sc1
v_mfma_f32_16x16x32_bf16 v[172:175], v[28:31], v[60:63], 0
s_waitcnt lgkmcnt(2)
v_mfma_f32_16x16x32_bf16 v[176:179], v[16:19], v[48:51], 0
ds_read_b64_tr_b16 v[28:29], v15 offset:224
v_mfma_f32_16x16x32_bf16 v[180:183], v[16:19], v[52:55], 0
ds_read_b64_tr_b16 v[30:31], v15 offset:4832
v_mfma_f32_16x16x32_bf16 v[184:187], v[16:19], v[56:59], 0
v_mfma_f32_16x16x32_bf16 v[188:191], v[16:19], v[60:63], 0
v_mfma_f32_16x16x32_bf16 v[192:195], v[20:23], v[48:51], 0
ds_read_b64_tr_b16 v[16:17], v15 offset:256
v_mfma_f32_16x16x32_bf16 v[196:199], v[20:23], v[52:55], 0
ds_read_b64_tr_b16 v[18:19], v15 offset:4864
v_mfma_f32_16x16x32_bf16 v[200:203], v[20:23], v[56:59], 0
buffer_load_dwordx4 v11, s[48:51], s40 offen offset:1024 lds
v_mfma_f32_16x16x32_bf16 v[204:207], v[20:23], v[60:63], 0
buffer_store_dwordx4 v[56:59], v9, s[8:11], s42 offen offset:2048 sc1
s_waitcnt lgkmcnt(2)
v_mfma_f32_16x16x32_bf16 v[208:211], v[24:27], v[48:51], 0
ds_read_b64_tr_b16 v[20:21], v15 offset:9216
v_mfma_f32_16x16x32_bf16 v[212:215], v[24:27], v[52:55], 0
ds_read_b64_tr_b16 v[22:23], v15 offset:13824
v_mfma_f32_16x16x32_bf16 v[216:219], v[24:27], v[56:59], 0
v_mfma_f32_16x16x32_bf16 v[220:223], v[24:27], v[60:63], 0
v_mfma_f32_16x16x32_bf16 v[224:227], v[28:31], v[48:51], 0
ds_read_b64_tr_b16 v[24:25], v15 offset:9248
v_mfma_f32_16x16x32_bf16 v[228:231], v[28:31], v[52:55], 0
ds_read_b64_tr_b16 v[26:27], v15 offset:13856
v_mfma_f32_16x16x32_bf16 v[232:235], v[28:31], v[56:59], 0
buffer_store_dwordx4 v[60:63], v9, s[8:11], s42 offen offset:3072 sc1
v_mfma_f32_16x16x32_bf16 v[236:239], v[28:31], v[60:63], 0
s_waitcnt lgkmcnt(2)
v_mfma_f32_16x16x32_bf16 v[240:243], v[16:19], v[48:51], 0
ds_read_b64_tr_b16 v[28:29], v15 offset:9280
v_mfma_f32_16x16x32_bf16 v[244:247], v[16:19], v[52:55], 0
ds_read_b64_tr_b16 v[30:31], v15 offset:13888
v_mfma_f32_16x16x32_bf16 v[248:251], v[16:19], v[56:59], 0
v_mfma_f32_16x16x32_bf16 v[252:255], v[16:19], v[60:63], 0
buffer_load_dwordx4 v12, s[48:51], s40 offen offset:2048 lds
s_add_u32 s42, s38, 4096
v_mfma_f32_16x16x32_bf16 v[112:115], v[20:23], v[64:67], v[112:115]
ds_read_b64_tr_b16 v[16:17], v15 offset:9312
v_mfma_f32_16x16x32_bf16 v[116:119], v[20:23], v[68:71], v[116:119]
ds_read_b64_tr_b16 v[18:19], v15 offset:13920
v_mfma_f32_16x16x32_bf16 v[120:123], v[20:23], v[72:75], v[120:123]
buffer_store_dwordx4 v[64:67], v9, s[8:11], s42 offen offset:0 sc1
v_mfma_f32_16x16x32_bf16 v[124:127], v[20:23], v[76:79], v[124:127]
s_waitcnt lgkmcnt(2)
v_mfma_f32_16x16x32_bf16 v[128:131], v[24:27], v[64:67], v[128:131]
ds_read_b64_tr_b16 v[20:21], v15 offset:9344
v_mfma_f32_16x16x32_bf16 v[132:135], v[24:27], v[68:71], v[132:135]
ds_read_b64_tr_b16 v[22:23], v15 offset:13952
v_mfma_f32_16x16x32_bf16 v[136:139], v[24:27], v[72:75], v[136:139]
v_mfma_f32_16x16x32_bf16 v[140:143], v[24:27], v[76:79], v[140:143]
v_mfma_f32_16x16x32_bf16 v[144:147], v[28:31], v[64:67], v[144:147]
ds_read_b64_tr_b16 v[24:25], v15 offset:9376
v_mfma_f32_16x16x32_bf16 v[148:151], v[28:31], v[68:71], v[148:151]
ds_read_b64_tr_b16 v[26:27], v15 offset:13984
v_mfma_f32_16x16x32_bf16 v[152:155], v[28:31], v[72:75], v[152:155]
buffer_store_dwordx4 v[68:71], v9, s[8:11], s42 offen offset:1024 sc1
v_mfma_f32_16x16x32_bf16 v[156:159], v[28:31], v[76:79], v[156:159]
s_waitcnt lgkmcnt(2)
v_mfma_f32_16x16x32_bf16 v[160:163], v[16:19], v[64:67], v[160:163]
ds_read_b64_tr_b16 v[28:29], v15 offset:9408
v_mfma_f32_16x16x32_bf16 v[164:167], v[16:19], v[68:71], v[164:167]
ds_read_b64_tr_b16 v[30:31], v15 offset:14016
v_mfma_f32_16x16x32_bf16 v[168:171], v[16:19], v[72:75], v[168:171]
buffer_load_dwordx4 v13, s[48:51], s40 offen offset:3072 lds
v_mfma_f32_16x16x32_bf16 v[172:175], v[16:19], v[76:79], v[172:175]
v_mfma_f32_16x16x32_bf16 v[176:179], v[20:23], v[64:67], v[176:179]
ds_read_b64_tr_b16 v[16:17], v15 offset:9440
v_mfma_f32_16x16x32_bf16 v[180:183], v[20:23], v[68:71], v[180:183]
ds_read_b64_tr_b16 v[18:19], v15 offset:14048
v_mfma_f32_16x16x32_bf16 v[184:187], v[20:23], v[72:75], v[184:187]
buffer_store_dwordx4 v[72:75], v9, s[8:11], s42 offen offset:2048 sc1
v_mfma_f32_16x16x32_bf16 v[188:191], v[20:23], v[76:79], v[188:191]
s_waitcnt lgkmcnt(2)
v_mfma_f32_16x16x32_bf16 v[192:195], v[24:27], v[64:67], v[192:195]
ds_read_b64_tr_b16 v[20:21], v15 offset:9472
v_mfma_f32_16x16x32_bf16 v[196:199], v[24:27], v[68:71], v[196:199]
ds_read_b64_tr_b16 v[22:23], v15 offset:14080
v_mfma_f32_16x16x32_bf16 v[200:203], v[24:27], v[72:75], v[200:203]
v_mfma_f32_16x16x32_bf16 v[204:207], v[24:27], v[76:79], v[204:207]
v_mfma_f32_16x16x32_bf16 v[208:211], v[28:31], v[64:67], v[208:211]
ds_read_b64_tr_b16 v[24:25], v15 offset:18432
s_add_u32 m0, s47, 45056
v_mfma_f32_16x16x32_bf16 v[212:215], v[28:31], v[68:71], v[212:215]
ds_read_b64_tr_b16 v[26:27], v15 offset:23040
v_mfma_f32_16x16x32_bf16 v[216:219], v[28:31], v[72:75], v[216:219]
buffer_store_dwordx4 v[76:79], v9, s[8:11], s42 offen offset:3072 sc1
v_mfma_f32_16x16x32_bf16 v[220:223], v[28:31], v[76:79], v[220:223]
buffer_load_dwordx4 v14, s[48:51], s40 offen offset:0 lds
s_waitcnt lgkmcnt(2)
v_mfma_f32_16x16x32_bf16 v[224:227], v[16:19], v[64:67], v[224:227]
ds_read_b64_tr_b16 v[28:29], v15 offset:18464
v_mfma_f32_16x16x32_bf16 v[228:231], v[16:19], v[68:71], v[228:231]
ds_read_b64_tr_b16 v[30:31], v15 offset:23072
v_mfma_f32_16x16x32_bf16 v[232:235], v[16:19], v[72:75], v[232:235]
v_mfma_f32_16x16x32_bf16 v[236:239], v[16:19], v[76:79], v[236:239]
s_add_u32 s42, s38, 8192
v_mfma_f32_16x16x32_bf16 v[240:243], v[20:23], v[64:67], v[240:243]
ds_read_b64_tr_b16 v[16:17], v15 offset:18496
v_mfma_f32_16x16x32_bf16 v[244:247], v[20:23], v[68:71], v[244:247]
ds_read_b64_tr_b16 v[18:19], v15 offset:23104
v_mfma_f32_16x16x32_bf16 v[248:251], v[20:23], v[72:75], v[248:251]
buffer_store_dwordx4 v[80:83], v9, s[8:11], s42 offen offset:0 sc1
v_mfma_f32_16x16x32_bf16 v[252:255], v[20:23], v[76:79], v[252:255]
s_waitcnt lgkmcnt(2)
v_mfma_f32_16x16x32_bf16 v[112:115], v[24:27], v[80:83], v[112:115]
ds_read_b64_tr_b16 v[20:21], v15 offset:18528
v_mfma_f32_16x16x32_bf16 v[116:119], v[24:27], v[84:87], v[116:119]
ds_read_b64_tr_b16 v[22:23], v15 offset:23136
v_mfma_f32_16x16x32_bf16 v[120:123], v[24:27], v[88:91], v[120:123]
s_add_u32 m0, s47, 73728
s_add_u32 s40, s68, 1
s_and_b32 s40, s40, 3
v_mfma_f32_16x16x32_bf16 v[124:127], v[24:27], v[92:95], v[124:127]
s_add_u32 s40, s40, s74
s_mul_i32 s40, s40, 147456
s_add_u32 s40, s40, s60
v_mfma_f32_16x16x32_bf16 v[128:131], v[28:31], v[80:83], v[128:131]
ds_read_b64_tr_b16 v[24:25], v15 offset:18560
v_mfma_f32_16x16x32_bf16 v[132:135], v[28:31], v[84:87], v[132:135]
ds_read_b64_tr_b16 v[26:27], v15 offset:23168
v_mfma_f32_16x16x32_bf16 v[136:139], v[28:31], v[88:91], v[136:139]
buffer_load_dwordx4 v1, s[48:51], s40 offen offset:0 lds
v_mfma_f32_16x16x32_bf16 v[140:143], v[28:31], v[92:95], v[140:143]
buffer_store_dwordx4 v[84:87], v9, s[8:11], s42 offen offset:1024 sc1
s_waitcnt lgkmcnt(2)
v_mfma_f32_16x16x32_bf16 v[144:147], v[16:19], v[80:83], v[144:147]
ds_read_b64_tr_b16 v[28:29], v15 offset:18592
v_mfma_f32_16x16x32_bf16 v[148:151], v[16:19], v[84:87], v[148:151]
ds_read_b64_tr_b16 v[30:31], v15 offset:23200
v_mfma_f32_16x16x32_bf16 v[152:155], v[16:19], v[88:91], v[152:155]
v_mfma_f32_16x16x32_bf16 v[156:159], v[16:19], v[92:95], v[156:159]
v_mfma_f32_16x16x32_bf16 v[160:163], v[20:23], v[80:83], v[160:163]
ds_read_b64_tr_b16 v[16:17], v15 offset:18624
v_mfma_f32_16x16x32_bf16 v[164:167], v[20:23], v[84:87], v[164:167]
ds_read_b64_tr_b16 v[18:19], v15 offset:23232
v_mfma_f32_16x16x32_bf16 v[168:171], v[20:23], v[88:91], v[168:171]
buffer_store_dwordx4 v[88:91], v9, s[8:11], s42 offen offset:2048 sc1
v_mfma_f32_16x16x32_bf16 v[172:175], v[20:23], v[92:95], v[172:175]
s_waitcnt lgkmcnt(2)
v_mfma_f32_16x16x32_bf16 v[176:179], v[24:27], v[80:83], v[176:179]
ds_read_b64_tr_b16 v[20:21], v15 offset:18656
v_mfma_f32_16x16x32_bf16 v[180:183], v[24:27], v[84:87], v[180:183]
ds_read_b64_tr_b16 v[22:23], v15 offset:23264
v_mfma_f32_16x16x32_bf16 v[184:187], v[24:27], v[88:91], v[184:187]
v_mfma_f32_16x16x32_bf16 v[188:191], v[24:27], v[92:95], v[188:191]
buffer_load_dwordx4 v2, s[48:51], s40 offen offset:1024 lds
v_mfma_f32_16x16x32_bf16 v[192:195], v[28:31], v[80:83], v[192:195]
ds_read_b64_tr_b16 v[24:25], v15 offset:18688
v_mfma_f32_16x16x32_bf16 v[196:199], v[28:31], v[84:87], v[196:199]
ds_read_b64_tr_b16 v[26:27], v15 offset:23296
v_mfma_f32_16x16x32_bf16 v[200:203], v[28:31], v[88:91], v[200:203]
buffer_store_dwordx4 v[92:95], v9, s[8:11], s42 offen offset:3072 sc1
v_mfma_f32_16x16x32_bf16 v[204:207], v[28:31], v[92:95], v[204:207]
s_waitcnt lgkmcnt(2)
v_mfma_f32_16x16x32_bf16 v[208:211], v[16:19], v[80:83], v[208:211]
ds_read_b64_tr_b16 v[28:29], v15 offset:27648
v_mfma_f32_16x16x32_bf16 v[212:215], v[16:19], v[84:87], v[212:215]
ds_read_b64_tr_b16 v[30:31], v15 offset:32256
v_mfma_f32_16x16x32_bf16 v[216:219], v[16:19], v[88:91], v[216:219]
v_mfma_f32_16x16x32_bf16 v[220:223], v[16:19], v[92:95], v[220:223]
s_add_u32 s42, s38, 12288
v_mfma_f32_16x16x32_bf16 v[224:227], v[20:23], v[80:83], v[224:227]
ds_read_b64_tr_b16 v[16:17], v15 offset:27680
v_mfma_f32_16x16x32_bf16 v[228:231], v[20:23], v[84:87], v[228:231]
ds_read_b64_tr_b16 v[18:19], v15 offset:32288
v_mfma_f32_16x16x32_bf16 v[232:235], v[20:23], v[88:91], v[232:235]
buffer_store_dwordx4 v[96:99], v9, s[8:11], s42 offen offset:0 sc1
v_mfma_f32_16x16x32_bf16 v[236:239], v[20:23], v[92:95], v[236:239]
s_waitcnt lgkmcnt(2)
v_mfma_f32_16x16x32_bf16 v[240:243], v[24:27], v[80:83], v[240:243]
ds_read_b64_tr_b16 v[20:21], v15 offset:27712
v_mfma_f32_16x16x32_bf16 v[244:247], v[24:27], v[84:87], v[244:247]
ds_read_b64_tr_b16 v[22:23], v15 offset:32320
v_mfma_f32_16x16x32_bf16 v[248:251], v[24:27], v[88:91], v[248:251]
buffer_load_dwordx4 v3, s[48:51], s40 offen offset:2048 lds
v_mfma_f32_16x16x32_bf16 v[252:255], v[24:27], v[92:95], v[252:255]
v_mfma_f32_16x16x32_bf16 v[112:115], v[28:31], v[96:99], v[112:115]
ds_read_b64_tr_b16 v[24:25], v15 offset:27744
v_mfma_f32_16x16x32_bf16 v[116:119], v[28:31], v[100:103], v[116:119]
ds_read_b64_tr_b16 v[26:27], v15 offset:32352
v_mfma_f32_16x16x32_bf16 v[120:123], v[28:31], v[104:107], v[120:123]
buffer_store_dwordx4 v[100:103], v9, s[8:11], s42 offen offset:1024 sc1
v_mfma_f32_16x16x32_bf16 v[124:127], v[28:31], v[108:111], v[124:127]
s_waitcnt lgkmcnt(2)
v_mfma_f32_16x16x32_bf16 v[128:131], v[16:19], v[96:99], v[128:131]
ds_read_b64_tr_b16 v[28:29], v15 offset:27776
v_mfma_f32_16x16x32_bf16 v[132:135], v[16:19], v[100:103], v[132:135]
ds_read_b64_tr_b16 v[30:31], v15 offset:32384
v_mfma_f32_16x16x32_bf16 v[136:139], v[16:19], v[104:107], v[136:139]
v_mfma_f32_16x16x32_bf16 v[140:143], v[16:19], v[108:111], v[140:143]
v_mfma_f32_16x16x32_bf16 v[144:147], v[20:23], v[96:99], v[144:147]
ds_read_b64_tr_b16 v[16:17], v15 offset:27808
v_mfma_f32_16x16x32_bf16 v[148:151], v[20:23], v[100:103], v[148:151]
ds_read_b64_tr_b16 v[18:19], v15 offset:32416
v_mfma_f32_16x16x32_bf16 v[152:155], v[20:23], v[104:107], v[152:155]
buffer_store_dwordx4 v[104:107], v9, s[8:11], s42 offen offset:2048 sc1
v_mfma_f32_16x16x32_bf16 v[156:159], v[20:23], v[108:111], v[156:159]
buffer_load_dwordx4 v8, s[48:51], s40 offen offset:3072 lds
s_waitcnt lgkmcnt(2)
v_mfma_f32_16x16x32_bf16 v[160:163], v[24:27], v[96:99], v[160:163]
ds_read_b64_tr_b16 v[20:21], v15 offset:27840
v_mfma_f32_16x16x32_bf16 v[164:167], v[24:27], v[100:103], v[164:167]
ds_read_b64_tr_b16 v[22:23], v15 offset:32448
v_mfma_f32_16x16x32_bf16 v[168:171], v[24:27], v[104:107], v[168:171]
v_mfma_f32_16x16x32_bf16 v[172:175], v[24:27], v[108:111], v[172:175]
v_mfma_f32_16x16x32_bf16 v[176:179], v[28:31], v[96:99], v[176:179]
ds_read_b64_tr_b16 v[24:25], v15 offset:27872
v_mfma_f32_16x16x32_bf16 v[180:183], v[28:31], v[100:103], v[180:183]
ds_read_b64_tr_b16 v[26:27], v15 offset:32480
v_mfma_f32_16x16x32_bf16 v[184:187], v[28:31], v[104:107], v[184:187]
buffer_store_dwordx4 v[108:111], v9, s[8:11], s42 offen offset:3072 sc1
v_mfma_f32_16x16x32_bf16 v[188:191], v[28:31], v[108:111], v[188:191]
s_waitcnt lgkmcnt(2)
v_mfma_f32_16x16x32_bf16 v[192:195], v[16:19], v[96:99], v[192:195]
ds_read_b64_tr_b16 v[28:29], v15 offset:27904
v_mfma_f32_16x16x32_bf16 v[196:199], v[16:19], v[100:103], v[196:199]
ds_read_b64_tr_b16 v[30:31], v15 offset:32512
v_mfma_f32_16x16x32_bf16 v[200:203], v[16:19], v[104:107], v[200:203]
s_add_u32 m0, s47, 77824
v_mfma_f32_16x16x32_bf16 v[204:207], v[16:19], v[108:111], v[204:207]
v_add_u32 v15, 0x9000, v15
v_mfma_f32_16x16x32_bf16 v[208:211], v[20:23], v[96:99], v[208:211]
s_waitcnt vmcnt(12)
s_barrier
ds_read_b64_tr_b16 v[16:17], v15 offset:0
v_mfma_f32_16x16x32_bf16 v[212:215], v[20:23], v[100:103], v[212:215]
ds_read_b64_tr_b16 v[18:19], v15 offset:4608
v_mfma_f32_16x16x32_bf16 v[216:219], v[20:23], v[104:107], v[216:219]
buffer_load_dwordx4 v10, s[48:51], s40 offen offset:0 lds
v_mfma_f32_16x16x32_bf16 v[220:223], v[20:23], v[108:111], v[220:223]
s_waitcnt lgkmcnt(2)
v_mfma_f32_16x16x32_bf16 v[224:227], v[24:27], v[96:99], v[224:227]
ds_read_b64_tr_b16 v[20:21], v15 offset:32
v_mfma_f32_16x16x32_bf16 v[228:231], v[24:27], v[100:103], v[228:231]
ds_read_b64_tr_b16 v[22:23], v15 offset:4640
v_mfma_f32_16x16x32_bf16 v[232:235], v[24:27], v[104:107], v[232:235]
v_mfma_f32_16x16x32_bf16 v[236:239], v[24:27], v[108:111], v[236:239]
v_mfma_f32_16x16x32_bf16 v[240:243], v[28:31], v[96:99], v[240:243]
ds_read_b64_tr_b16 v[24:25], v15 offset:64
v_mfma_f32_16x16x32_bf16 v[244:247], v[28:31], v[100:103], v[244:247]
ds_read_b64_tr_b16 v[26:27], v15 offset:4672
v_mfma_f32_16x16x32_bf16 v[248:251], v[28:31], v[104:107], v[248:251]
v_mfma_f32_16x16x32_bf16 v[252:255], v[28:31], v[108:111], v[252:255]
mk_LS_W1:
s_lshl_b32 s73, 15, s74
s_mov_b32 s71, 0x20000
buffer_load_dword v7, v6, s[8:11], s66 offen sc1
s_sleep 3
buffer_load_dword v46, v6, s[8:11], s66 offen sc1
s_sleep 3
buffer_load_dword v47, v6, s[8:11], s66 offen sc1
mk_poll_O:
s_waitcnt vmcnt(2)
v_cmp_eq_u32 vcc, s100, v7
s_sub_u32 s71, s71, 1
s_cbranch_scc1 mk_pollx_O
s_nop 1
s_and_b32 s43, vcc_lo, s73
s_cmp_eq_u32 s43, s73
s_cbranch_scc1 mk_pollx_O
buffer_load_dword v7, v6, s[8:11], s66 offen sc1
s_sleep 3
s_waitcnt vmcnt(2)
v_cmp_eq_u32 vcc, s100, v46
s_sub_u32 s71, s71, 1
s_cbranch_scc1 mk_pollx_O
s_nop 1
s_and_b32 s43, vcc_lo, s73
s_cmp_eq_u32 s43, s73
s_cbranch_scc1 mk_pollx_O
buffer_load_dword v46, v6, s[8:11], s66 offen sc1
s_sleep 3
s_waitcnt vmcnt(2)
v_cmp_eq_u32 vcc, s100, v47
s_sub_u32 s71, s71, 1
s_cbranch_scc1 mk_pollx_O
s_nop 1
s_and_b32 s43, vcc_lo, s73
s_cmp_eq_u32 s43, s73
s_cbranch_scc1 mk_pollx_O
buffer_load_dword v47, v6, s[8:11], s66 offen sc1
s_sleep 3
s_branch mk_poll_O
mk_pollx_O:
s_add_u32 s41, s68, 0
s_and_b32 s41, s41, 3
s_add_u32 s41, s41, s74
s_lshl_b32 s41, s41, 14
s_add_u32 s41, s41, s61
buffer_load_dwordx4 a[160:163], v9, s[8:11], s41 offen offset:0 sc1
buffer_load_dwordx4 a[164:167], v9, s[8:11], s41 offen offset:1024 sc1
buffer_load_dwordx4 a[168:171], v9, s[8:11], s41 offen offset:2048 sc1
buffer_load_dwordx4 a[172:175], v9, s[8:11], s41 offen offset:3072 sc1
s_add_u32 s41, s68, 0
s_and_b32 s41, s41, 3
s_add_u32 s41, s41, s74
s_lshl_b32 s41, s41, 14
s_add_u32 s41, s41, s61
s_add_u32 s41, s41, 4096
buffer_load_dwordx4 a[176:179], v9, s[8:11], s41 offen offset:0 sc1
buffer_load_dwordx4 a[180:183], v9, s[8:11], s41 offen offset:1024 sc1
buffer_load_dwordx4 a[184:187], v9, s[8:11], s41 offen offset:2048 sc1
buffer_load_dwordx4 a[188:191], v9, s[8:11], s41 offen offset:3072 sc1
s_add_u32 s41, s68, 0
s_and_b32 s41, s41, 3
s_add_u32 s41, s41, s74
s_lshl_b32 s41, s41, 14
s_add_u32 s41, s41, s61
s_add_u32 s41, s41, 8192
buffer_load_dwordx4 a[192:195], v9, s[8:11], s41 offen offset:0 sc1
buffer_load_dwordx4 a[196:199], v9, s[8:11], s41 offen offset:1024 sc1
buffer_load_dwordx4 a[200:203], v9, s[8:11], s41 offen offset:2048 sc1
buffer_load_dwordx4 a[204:207], v9, s[8:11], s41 offen offset:3072 sc1
s_waitcnt lgkmcnt(2)
s_waitcnt vmcnt(8)
v_mfma_f32_16x16x32_bf16 v[112:115], v[16:19], a[160:163], v[112:115]
ds_read_b64_tr_b16 v[28:29], v15 offset:96
s_add_u32 s41, s68, 0
s_and_b32 s41, s41, 3
v_mfma_f32_16x16x32_bf16 v[116:119], v[16:19], a[164:167], v[116:119]
ds_read_b64_tr_b16 v[30:31], v15 offset:4704
s_add_u32 s41, s41, s74
s_lshl_b32 s41, s41, 14
v_mfma_f32_16x16x32_bf16 v[120:123], v[16:19], a[168:171], v[120:123]
s_add_u32 s41, s41, s61
s_add_u32 s41, s41, 12288
buffer_load_dwordx4 a[208:211], v9, s[8:11], s41 offen offset:0 sc1
v_mfma_f32_16x16x32_bf16 v[124:127], v[16:19], a[172:175], v[124:127]
buffer_load_dwordx4 v11, s[48:51], s40 offen offset:1024 lds
v_mfma_f32_16x16x32_bf16 v[128:131], v[20:23], a[160:163], v[128:131]
ds_read_b64_tr_b16 v[16:17], v15 offset:128
v_mfma_f32_16x16x32_bf16 v[132:135], v[20:23], a[164:167], v[132:135]
ds_read_b64_tr_b16 v[18:19], v15 offset:4736
s_barrier
v_mfma_f32_16x16x32_bf16 v[136:139], v[20:23], a[168:171], v[136:139]
v_mfma_f32_16x16x32_bf16 v[140:143], v[20:23], a[172:175], v[140:143]
buffer_load_dwordx4 a[212:215], v9, s[8:11], s41 offen offset:1024 sc1
s_waitcnt lgkmcnt(2)
v_mfma_f32_16x16x32_bf16 v[144:147], v[24:27], a[160:163], v[144:147]
ds_read_b64_tr_b16 v[20:21], v15 offset:160
v_mfma_f32_16x16x32_bf16 v[148:151], v[24:27], a[164:167], v[148:151]
ds_read_b64_tr_b16 v[22:23], v15 offset:4768
v_mfma_f32_16x16x32_bf16 v[152:155], v[24:27], a[168:171], v[152:155]
v_mfma_f32_16x16x32_bf16 v[156:159], v[24:27], a[172:175], v[156:159]
v_mfma_f32_16x16x32_bf16 v[160:163], v[28:31], a[160:163], v[160:163]
ds_read_b64_tr_b16 v[24:25], v15 offset:192
v_mfma_f32_16x16x32_bf16 v[164:167], v[28:31], a[164:167], v[164:167]
ds_read_b64_tr_b16 v[26:27], v15 offset:4800
v_mfma_f32_16x16x32_bf16 v[168:171], v[28:31], a[168:171], v[168:171]
buffer_load_dwordx4 a[216:219], v9, s[8:11], s41 offen offset:2048 sc1
v_mfma_f32_16x16x32_bf16 v[172:175], v[28:31], a[172:175], v[172:175]
s_waitcnt lgkmcnt(2)
v_mfma_f32_16x16x32_bf16 v[176:179], v[16:19], a[160:163], v[176:179]
ds_read_b64_tr_b16 v[28:29], v15 offset:224
v_mfma_f32_16x16x32_bf16 v[180:183], v[16:19], a[164:167], v[180:183]
ds_read_b64_tr_b16 v[30:31], v15 offset:4832
v_mfma_f32_16x16x32_bf16 v[184:187], v[16:19], a[168:171], v[184:187]
buffer_load_dwordx4 v12, s[48:51], s40 offen offset:2048 lds
v_mfma_f32_16x16x32_bf16 v[188:191], v[16:19], a[172:175], v[188:191]
v_mfma_f32_16x16x32_bf16 v[192:195], v[20:23], a[160:163], v[192:195]
ds_read_b64_tr_b16 v[16:17], v15 offset:256
v_mfma_f32_16x16x32_bf16 v[196:199], v[20:23], a[164:167], v[196:199]
ds_read_b64_tr_b16 v[18:19], v15 offset:4864
v_mfma_f32_16x16x32_bf16 v[200:203], v[20:23], a[168:171], v[200:203]
buffer_load_dwordx4 a[220:223], v9, s[8:11], s41 offen offset:3072 sc1
v_mfma_f32_16x16x32_bf16 v[204:207], v[20:23], a[172:175], v[204:207]
s_waitcnt lgkmcnt(2)
v_mfma_f32_16x16x32_bf16 v[208:211], v[24:27], a[160:163], v[208:211]
ds_read_b64_tr_b16 v[20:21], v15 offset:9216
v_mfma_f32_16x16x32_bf16 v[212:215], v[24:27], a[164:167], v[212:215]
ds_read_b64_tr_b16 v[22:23], v15 offset:13824
v_mfma_f32_16x16x32_bf16 v[216:219], v[24:27], a[168:171], v[216:219]
s_add_u32 s41, s68, 1
s_and_b32 s41, s41, 3
s_add_u32 s41, s41, s74
v_mfma_f32_16x16x32_bf16 v[220:223], v[24:27], a[172:175], v[220:223]
s_lshl_b32 s41, s41, 14
s_add_u32 s41, s41, s61
v_mfma_f32_16x16x32_bf16 v[224:227], v[28:31], a[160:163], v[224:227]
ds_read_b64_tr_b16 v[24:25], v15 offset:9248
v_mfma_f32_16x16x32_bf16 v[228:231], v[28:31], a[164:167], v[228:231]
ds_read_b64_tr_b16 v[26:27], v15 offset:13856
v_mfma_f32_16x16x32_bf16 v[232:235], v[28:31], a[168:171], v[232:235]
buffer_load_dwordx4 a[224:227], v9, s[8:11], s41 offen offset:0 sc1
v_mfma_f32_16x16x32_bf16 v[236:239], v[28:31], a[172:175], v[236:239]
buffer_load_dwordx4 v13, s[48:51], s40 offen offset:3072 lds
s_waitcnt lgkmcnt(2)
v_mfma_f32_16x16x32_bf16 v[240:243], v[16:19], a[160:163], v[240:243]
ds_read_b64_tr_b16 v[28:29], v15 offset:9280
v_mfma_f32_16x16x32_bf16 v[244:247], v[16:19], a[164:167], v[244:247]
ds_read_b64_tr_b16 v[30:31], v15 offset:13888
v_mfma_f32_16x16x32_bf16 v[248:251], v[16:19], a[168:171], v[248:251]
v_mfma_f32_16x16x32_bf16 v[252:255], v[16:19], a[172:175], v[252:255]
buffer_load_dwordx4 a[228:231], v9, s[8:11], s41 offen offset:1024 sc1
s_waitcnt vmcnt(13)
v_mfma_f32_16x16x32_bf16 v[112:115], v[20:23], a[176:179], v[112:115]
ds_read_b64_tr_b16 v[16:17], v15 offset:9312
v_mfma_f32_16x16x32_bf16 v[116:119], v[20:23], a[180:183], v[116:119]
ds_read_b64_tr_b16 v[18:19], v15 offset:13920
v_mfma_f32_16x16x32_bf16 v[120:123], v[20:23], a[184:187], v[120:123]
v_mfma_f32_16x16x32_bf16 v[124:127], v[20:23], a[188:191], v[124:127]
s_waitcnt lgkmcnt(2)
v_mfma_f32_16x16x32_bf16 v[128:131], v[24:27], a[176:179], v[128:131]
ds_read_b64_tr_b16 v[20:21], v15 offset:9344
v_mfma_f32_16x16x32_bf16 v[132:135], v[24:27], a[180:183], v[132:135]
ds_read_b64_tr_b16 v[22:23], v15 offset:13952
v_mfma_f32_16x16x32_bf16 v[136:139], v[24:27], a[184:187], v[136:139]
buffer_load_dwordx4 a[232:235], v9, s[8:11], s41 offen offset:2048 sc1
s_add_u32 m0, s47, 81920
v_mfma_f32_16x16x32_bf16 v[140:143], v[24:27], a[188:191], v[140:143]
v_mfma_f32_16x16x32_bf16 v[144:147], v[28:31], a[176:179], v[144:147]
ds_read_b64_tr_b16 v[24:25], v15 offset:9376
v_mfma_f32_16x16x32_bf16 v[148:151], v[28:31], a[180:183], v[148:151]
ds_read_b64_tr_b16 v[26:27], v15 offset:13984
v_mfma_f32_16x16x32_bf16 v[152:155], v[28:31], a[184:187], v[152:155]
buffer_load_dwordx4 v14, s[48:51], s40 offen offset:0 lds
v_mfma_f32_16x16x32_bf16 v[156:159], v[28:31], a[188:191], v[156:159]
s_waitcnt lgkmcnt(2)
v_mfma_f32_16x16x32_bf16 v[160:163], v[16:19], a[176:179], v[160:163]
ds_read_b64_tr_b16 v[28:29], v15 offset:9408
v_mfma_f32_16x16x32_bf16 v[164:167], v[16:19], a[180:183], v[164:167]
ds_read_b64_tr_b16 v[30:31], v15 offset:14016
v_mfma_f32_16x16x32_bf16 v[168:171], v[16:19], a[184:187], v[168:171]
buffer_load_dwordx4 a[236:239], v9, s[8:11], s41 offen offset:3072 sc1
v_mfma_f32_16x16x32_bf16 v[172:175], v[16:19], a[188:191], v[172:175]
v_mfma_f32_16x16x32_bf16 v[176:179], v[20:23], a[176:179], v[176:179]
ds_read_b64_tr_b16 v[16:17], v15 offset:9440
v_mfma_f32_16x16x32_bf16 v[180:183], v[20:23], a[180:183], v[180:183]
ds_read_b64_tr_b16 v[18:19], v15 offset:14048
v_mfma_f32_16x16x32_bf16 v[184:187], v[20:23], a[184:187], v[184:187]
s_add_u32 s41, s68, 1
s_and_b32 s41, s41, 3
s_add_u32 s41, s41, s74
v_mfma_f32_16x16x32_bf16 v[188:191], v[20:23], a[188:191], v[188:191]
s_lshl_b32 s41, s41, 14
s_add_u32 s41, s41, s61
s_waitcnt lgkmcnt(2)
v_mfma_f32_16x16x32_bf16 v[192:195], v[24:27], a[176:179], v[192:195]
ds_read_b64_tr_b16 v[20:21], v15 offset:9472
s_add_u32 s41, s41, 4096
s_add_u32 m0, s47, 110592
v_mfma_f32_16x16x32_bf16 v[196:199], v[24:27], a[180:183], v[196:199]
ds_read_b64_tr_b16 v[22:23], v15 offset:14080
s_add_u32 s40, s68, 2
s_and_b32 s40, s40, 3
v_mfma_f32_16x16x32_bf16 v[200:203], v[24:27], a[184:187], v[200:203]
buffer_load_dwordx4 a[240:243], v9, s[8:11], s41 offen offset:0 sc1
s_add_u32 s40, s40, s74
s_mul_i32 s40, s40, 147456
v_mfma_f32_16x16x32_bf16 v[204:207], v[24:27], a[188:191], v[204:207]
s_add_u32 s40, s40, s60
buffer_load_dwordx4 v1, s[48:51], s40 offen offset:0 lds
v_mfma_f32_16x16x32_bf16 v[208:211], v[28:31], a[176:179], v[208:211]
ds_read_b64_tr_b16 v[24:25], v15 offset:18432
v_mfma_f32_16x16x32_bf16 v[212:215], v[28:31], a[180:183], v[212:215]
ds_read_b64_tr_b16 v[26:27], v15 offset:23040
v_mfma_f32_16x16x32_bf16 v[216:219], v[28:31], a[184:187], v[216:219]
v_mfma_f32_16x16x32_bf16 v[220:223], v[28:31], a[188:191], v[220:223]
buffer_load_dwordx4 a[244:247], v9, s[8:11], s41 offen offset:1024 sc1
s_waitcnt lgkmcnt(2)
v_mfma_f32_16x16x32_bf16 v[224:227], v[16:19], a[176:179], v[224:227]
ds_read_b64_tr_b16 v[28:29], v15 offset:18464
v_mfma_f32_16x16x32_bf16 v[228:231], v[16:19], a[180:183], v[228:231]
ds_read_b64_tr_b16 v[30:31], v15 offset:23072
v_mfma_f32_16x16x32_bf16 v[232:235], v[16:19], a[184:187], v[232:235]
v_mfma_f32_16x16x32_bf16 v[236:239], v[16:19], a[188:191], v[236:239]
v_mfma_f32_16x16x32_bf16 v[240:243], v[20:23], a[176:179], v[240:243]
ds_read_b64_tr_b16 v[16:17], v15 offset:18496
v_mfma_f32_16x16x32_bf16 v[244:247], v[20:23], a[180:183], v[244:247]
ds_read_b64_tr_b16 v[18:19], v15 offset:23104
v_mfma_f32_16x16x32_bf16 v[248:251], v[20:23], a[184:187], v[248:251]
buffer_load_dwordx4 a[248:251], v9, s[8:11], s41 offen offset:2048 sc1
v_mfma_f32_16x16x32_bf16 v[252:255], v[20:23], a[188:191], v[252:255]
s_waitcnt lgkmcnt(2)
s_waitcnt vmcnt(16)
v_mfma_f32_16x16x32_bf16 v[112:115], v[24:27], a[192:195], v[112:115]
ds_read_b64_tr_b16 v[20:21], v15 offset:18528
v_mfma_f32_16x16x32_bf16 v[116:119], v[24:27], a[196:199], v[116:119]
ds_read_b64_tr_b16 v[22:23], v15 offset:23136
v_mfma_f32_16x16x32_bf16 v[120:123], v[24:27], a[200:203], v[120:123]
buffer_load_dwordx4 v2, s[48:51], s40 offen offset:1024 lds
v_mfma_f32_16x16x32_bf16 v[124:127], v[24:27], a[204:207], v[124:127]
v_mfma_f32_16x16x32_bf16 v[128:131], v[28:31], a[192:195], v[128:131]
ds_read_b64_tr_b16 v[24:25], v15 offset:18560
v_mfma_f32_16x16x32_bf16 v[132:135], v[28:31], a[196:199], v[132:135]
ds_read_b64_tr_b16 v[26:27], v15 offset:23168
v_mfma_f32_16x16x32_bf16 v[136:139], v[28:31], a[200:203], v[136:139]
buffer_load_dwordx4 a[252:255], v9, s[8:11], s41 offen offset:3072 sc1
v_mfma_f32_16x16x32_bf16 v[140:143], v[28:31], a[204:207], v[140:143]
s_waitcnt lgkmcnt(2)
v_mfma_f32_16x16x32_bf16 v[144:147], v[16:19], a[192:195], v[144:147]
ds_read_b64_tr_b16 v[28:29], v15 offset:18592
v_mfma_f32_16x16x32_bf16 v[148:151], v[16:19], a[196:199], v[148:151]
ds_read_b64_tr_b16 v[30:31], v15 offset:23200
v_mfma_f32_16x16x32_bf16 v[152:155], v[16:19], a[200:203], v[152:155]
s_add_u32 s41, s68, 1
s_and_b32 s41, s41, 3
s_add_u32 s41, s41, s74
v_mfma_f32_16x16x32_bf16 v[156:159], v[16:19], a[204:207], v[156:159]
s_lshl_b32 s41, s41, 14
s_add_u32 s41, s41, s61
s_add_u32 s41, s41, 8192
v_mfma_f32_16x16x32_bf16 v[160:163], v[20:23], a[192:195], v[160:163]
ds_read_b64_tr_b16 v[16:17], v15 offset:18624
v_mfma_f32_16x16x32_bf16 v[164:167], v[20:23], a[196:199], v[164:167]
ds_read_b64_tr_b16 v[18:19], v15 offset:23232
v_mfma_f32_16x16x32_bf16 v[168:171], v[20:23], a[200:203], v[168:171]
buffer_load_dwordx4 a[0:3], v9, s[8:11], s41 offen offset:0 sc1
v_mfma_f32_16x16x32_bf16 v[172:175], v[20:23], a[204:207], v[172:175]
buffer_load_dwordx4 v3, s[48:51], s40 offen offset:2048 lds
s_waitcnt lgkmcnt(2)
v_mfma_f32_16x16x32_bf16 v[176:179], v[24:27], a[192:195], v[176:179]
ds_read_b64_tr_b16 v[20:21], v15 offset:18656
v_mfma_f32_16x16x32_bf16 v[180:183], v[24:27], a[196:199], v[180:183]
ds_read_b64_tr_b16 v[22:23], v15 offset:23264
v_mfma_f32_16x16x32_bf16 v[184:187], v[24:27], a[200:203], v[184:187]
v_mfma_f32_16x16x32_bf16 v[188:191], v[24:27], a[204:207], v[188:191]
buffer_load_dwordx4 a[4:7], v9, s[8:11], s41 offen offset:1024 sc1
v_mfma_f32_16x16x32_bf16 v[192:195], v[28:31], a[192:195], v[192:195]
ds_read_b64_tr_b16 v[24:25], v15 offset:18688
v_mfma_f32_16x16x32_bf16 v[196:199], v[28:31], a[196:199], v[196:199]
ds_read_b64_tr_b16 v[26:27], v15 offset:23296
v_mfma_f32_16x16x32_bf16 v[200:203], v[28:31], a[200:203], v[200:203]
v_mfma_f32_16x16x32_bf16 v[204:207], v[28:31], a[204:207], v[204:207]
s_waitcnt lgkmcnt(2)
v_mfma_f32_16x16x32_bf16 v[208:211], v[16:19], a[192:195], v[208:211]
ds_read_b64_tr_b16 v[28:29], v15 offset:27648
v_mfma_f32_16x16x32_bf16 v[212:215], v[16:19], a[196:199], v[212:215]
ds_read_b64_tr_b16 v[30:31], v15 offset:32256
v_mfma_f32_16x16x32_bf16 v[216:219], v[16:19], a[200:203], v[216:219]
buffer_load_dwordx4 a[8:11], v9, s[8:11], s41 offen offset:2048 sc1
v_mfma_f32_16x16x32_bf16 v[220:223], v[16:19], a[204:207], v[220:223]
v_mfma_f32_16x16x32_bf16 v[224:227], v[20:23], a[192:195], v[224:227]
ds_read_b64_tr_b16 v[16:17], v15 offset:27680
v_mfma_f32_16x16x32_bf16 v[228:231], v[20:23], a[196:199], v[228:231]
ds_read_b64_tr_b16 v[18:19], v15 offset:32288
v_mfma_f32_16x16x32_bf16 v[232:235], v[20:23], a[200:203], v[232:235]
buffer_load_dwordx4 v8, s[48:51], s40 offen offset:3072 lds
v_mfma_f32_16x16x32_bf16 v[236:239], v[20:23], a[204:207], v[236:239]
s_waitcnt lgkmcnt(2)
v_mfma_f32_16x16x32_bf16 v[240:243], v[24:27], a[192:195], v[240:243]
ds_read_b64_tr_b16 v[20:21], v15 offset:27712
v_mfma_f32_16x16x32_bf16 v[244:247], v[24:27], a[196:199], v[244:247]
ds_read_b64_tr_b16 v[22:23], v15 offset:32320
buffer_store_dword v5, v4, s[8:11], s64 offen sc1
v_mfma_f32_16x16x32_bf16 v[248:251], v[24:27], a[200:203], v[248:251]
buffer_load_dwordx4 a[12:15], v9, s[8:11], s41 offen offset:3072 sc1
v_mfma_f32_16x16x32_bf16 v[252:255], v[24:27], a[204:207], v[252:255]
s_waitcnt vmcnt(19)
v_mfma_f32_16x16x32_bf16 v[112:115], v[28:31], a[208:211], v[112:115]
ds_read_b64_tr_b16 v[24:25], v15 offset:27744
v_mfma_f32_16x16x32_bf16 v[116:119], v[28:31], a[212:215], v[116:119]
ds_read_b64_tr_b16 v[26:27], v15 offset:32352
v_mfma_f32_16x16x32_bf16 v[120:123], v[28:31], a[216:219], v[120:123]
s_add_u32 s41, s68, 1
s_and_b32 s41, s41, 3
s_add_u32 s41, s41, s74
v_mfma_f32_16x16x32_bf16 v[124:127], v[28:31], a[220:223], v[124:127]
s_lshl_b32 s41, s41, 14
s_add_u32 s41, s41, s61
s_waitcnt lgkmcnt(2)
v_mfma_f32_16x16x32_bf16 v[128:131], v[16:19], a[208:211], v[128:131]
ds_read_b64_tr_b16 v[28:29], v15 offset:27776
s_add_u32 s41, s41, 12288
s_add_u32 m0, s47, 114688
v_mfma_f32_16x16x32_bf16 v[132:135], v[16:19], a[212:215], v[132:135]
ds_read_b64_tr_b16 v[30:31], v15 offset:32384
v_mfma_f32_16x16x32_bf16 v[136:139], v[16:19], a[216:219], v[136:139]
buffer_load_dwordx4 a[16:19], v9, s[8:11], s41 offen offset:0 sc1
v_mfma_f32_16x16x32_bf16 v[140:143], v[16:19], a[220:223], v[140:143]
buffer_load_dwordx4 v10, s[48:51], s40 offen offset:0 lds
v_mfma_f32_16x16x32_bf16 v[144:147], v[20:23], a[208:211], v[144:147]
ds_read_b64_tr_b16 v[16:17], v15 offset:27808
v_mfma_f32_16x16x32_bf16 v[148:151], v[20:23], a[212:215], v[148:151]
ds_read_b64_tr_b16 v[18:19], v15 offset:32416
v_mfma_f32_16x16x32_bf16 v[152:155], v[20:23], a[216:219], v[152:155]
v_mfma_f32_16x16x32_bf16 v[156:159], v[20:23], a[220:223], v[156:159]
buffer_load_dwordx4 a[20:23], v9, s[8:11], s41 offen offset:1024 sc1
s_waitcnt lgkmcnt(2)
v_mfma_f32_16x16x32_bf16 v[160:163], v[24:27], a[208:211], v[160:163]
ds_read_b64_tr_b16 v[20:21], v15 offset:27840
v_mfma_f32_16x16x32_bf16 v[164:167], v[24:27], a[212:215], v[164:167]
ds_read_b64_tr_b16 v[22:23], v15 offset:32448
v_mfma_f32_16x16x32_bf16 v[168:171], v[24:27], a[216:219], v[168:171]
v_mfma_f32_16x16x32_bf16 v[172:175], v[24:27], a[220:223], v[172:175]
v_mfma_f32_16x16x32_bf16 v[176:179], v[28:31], a[208:211], v[176:179]
ds_read_b64_tr_b16 v[24:25], v15 offset:27872
v_mfma_f32_16x16x32_bf16 v[180:183], v[28:31], a[212:215], v[180:183]
ds_read_b64_tr_b16 v[26:27], v15 offset:32480
v_mfma_f32_16x16x32_bf16 v[184:187], v[28:31], a[216:219], v[184:187]
buffer_load_dwordx4 a[24:27], v9, s[8:11], s41 offen offset:2048 sc1
v_mfma_f32_16x16x32_bf16 v[188:191], v[28:31], a[220:223], v[188:191]
s_waitcnt lgkmcnt(2)
v_mfma_f32_16x16x32_bf16 v[192:195], v[16:19], a[208:211], v[192:195]
ds_read_b64_tr_b16 v[28:29], v15 offset:27904
v_mfma_f32_16x16x32_bf16 v[196:199], v[16:19], a[212:215], v[196:199]
ds_read_b64_tr_b16 v[30:31], v15 offset:32512
v_mfma_f32_16x16x32_bf16 v[200:203], v[16:19], a[216:219], v[200:203]
buffer_load_dwordx4 v11, s[48:51], s40 offen offset:1024 lds
v_mfma_f32_16x16x32_bf16 v[204:207], v[16:19], a[220:223], v[204:207]
v_add_u32 v15, 0x9000, v15
v_mfma_f32_16x16x32_bf16 v[208:211], v[20:23], a[208:211], v[208:211]
s_waitcnt vmcnt(19)
s_barrier
ds_read_b64_tr_b16 v[16:17], v15 offset:0
v_mfma_f32_16x16x32_bf16 v[212:215], v[20:23], a[212:215], v[212:215]
ds_read_b64_tr_b16 v[18:19], v15 offset:4608
v_mfma_f32_16x16x32_bf16 v[216:219], v[20:23], a[216:219], v[216:219]
buffer_load_dwordx4 a[28:31], v9, s[8:11], s41 offen offset:3072 sc1
v_mfma_f32_16x16x32_bf16 v[220:223], v[20:23], a[220:223], v[220:223]
s_waitcnt lgkmcnt(2)
v_mfma_f32_16x16x32_bf16 v[224:227], v[24:27], a[208:211], v[224:227]
ds_read_b64_tr_b16 v[20:21], v15 offset:32
v_mfma_f32_16x16x32_bf16 v[228:231], v[24:27], a[212:215], v[228:231]
ds_read_b64_tr_b16 v[22:23], v15 offset:4640
v_mfma_f32_16x16x32_bf16 v[232:235], v[24:27], a[216:219], v[232:235]
s_add_u32 s41, s68, 2
s_and_b32 s41, s41, 3
s_add_u32 s41, s41, s74
v_mfma_f32_16x16x32_bf16 v[236:239], v[24:27], a[220:223], v[236:239]
s_lshl_b32 s41, s41, 14
s_add_u32 s41, s41, s61
v_mfma_f32_16x16x32_bf16 v[240:243], v[28:31], a[208:211], v[240:243]
ds_read_b64_tr_b16 v[24:25], v15 offset:64
v_mfma_f32_16x16x32_bf16 v[244:247], v[28:31], a[212:215], v[244:247]
ds_read_b64_tr_b16 v[26:27], v15 offset:4672
v_mfma_f32_16x16x32_bf16 v[248:251], v[28:31], a[216:219], v[248:251]
buffer_load_dwordx4 a[32:35], v9, s[8:11], s41 offen offset:0 sc1
v_mfma_f32_16x16x32_bf16 v[252:255], v[28:31], a[220:223], v[252:255]
buffer_load_dwordx4 v12, s[48:51], s40 offen offset:2048 lds
s_waitcnt lgkmcnt(2)
s_waitcnt vmcnt(21)
v_mfma_f32_16x16x32_bf16 v[112:115], v[16:19], a[224:227], v[112:115]
ds_read_b64_tr_b16 v[28:29], v15 offset:96
v_mfma_f32_16x16x32_bf16 v[116:119], v[16:19], a[228:231], v[116:119]
ds_read_b64_tr_b16 v[30:31], v15 offset:4704
v_mfma_f32_16x16x32_bf16 v[120:123], v[16:19], a[232:235], v[120:123]
v_mfma_f32_16x16x32_bf16 v[124:127], v[16:19], a[236:239], v[124:127]
buffer_load_dwordx4 a[36:39], v9, s[8:11], s41 offen offset:1024 sc1
v_mfma_f32_16x16x32_bf16 v[128:131], v[20:23], a[224:227], v[128:131]
ds_read_b64_tr_b16 v[16:17], v15 offset:128
v_mfma_f32_16x16x32_bf16 v[132:135], v[20:23], a[228:231], v[132:135]
ds_read_b64_tr_b16 v[18:19], v15 offset:4736
s_barrier
v_mfma_f32_16x16x32_bf16 v[136:139], v[20:23], a[232:235], v[136:139]
v_mfma_f32_16x16x32_bf16 v[140:143], v[20:23], a[236:239], v[140:143]
s_waitcnt lgkmcnt(2)
v_mfma_f32_16x16x32_bf16 v[144:147], v[24:27], a[224:227], v[144:147]
ds_read_b64_tr_b16 v[20:21], v15 offset:160
v_mfma_f32_16x16x32_bf16 v[148:151], v[24:27], a[228:231], v[148:151]
ds_read_b64_tr_b16 v[22:23], v15 offset:4768
v_mfma_f32_16x16x32_bf16 v[152:155], v[24:27], a[232:235], v[152:155]
buffer_load_dwordx4 a[40:43], v9, s[8:11], s41 offen offset:2048 sc1
v_mfma_f32_16x16x32_bf16 v[156:159], v[24:27], a[236:239], v[156:159]
v_mfma_f32_16x16x32_bf16 v[160:163], v[28:31], a[224:227], v[160:163]
ds_read_b64_tr_b16 v[24:25], v15 offset:192
v_mfma_f32_16x16x32_bf16 v[164:167], v[28:31], a[228:231], v[164:167]
ds_read_b64_tr_b16 v[26:27], v15 offset:4800
v_mfma_f32_16x16x32_bf16 v[168:171], v[28:31], a[232:235], v[168:171]
buffer_load_dwordx4 v13, s[48:51], s40 offen offset:3072 lds
v_mfma_f32_16x16x32_bf16 v[172:175], v[28:31], a[236:239], v[172:175]
s_waitcnt lgkmcnt(2)
v_mfma_f32_16x16x32_bf16 v[176:179], v[16:19], a[224:227], v[176:179]
ds_read_b64_tr_b16 v[28:29], v15 offset:224
v_mfma_f32_16x16x32_bf16 v[180:183], v[16:19], a[228:231], v[180:183]
ds_read_b64_tr_b16 v[30:31], v15 offset:4832
v_mfma_f32_16x16x32_bf16 v[184:187], v[16:19], a[232:235], v[184:187]
buffer_load_dwordx4 a[44:47], v9, s[8:11], s41 offen offset:3072 sc1
v_mfma_f32_16x16x32_bf16 v[188:191], v[16:19], a[236:239], v[188:191]
v_mfma_f32_16x16x32_bf16 v[192:195], v[20:23], a[224:227], v[192:195]
ds_read_b64_tr_b16 v[16:17], v15 offset:256
v_mfma_f32_16x16x32_bf16 v[196:199], v[20:23], a[228:231], v[196:199]
ds_read_b64_tr_b16 v[18:19], v15 offset:4864
v_mfma_f32_16x16x32_bf16 v[200:203], v[20:23], a[232:235], v[200:203]
s_add_u32 s41, s68, 2
s_and_b32 s41, s41, 3
s_add_u32 s41, s41, s74
v_mfma_f32_16x16x32_bf16 v[204:207], v[20:23], a[236:239], v[204:207]
s_lshl_b32 s41, s41, 14
s_add_u32 s41, s41, s61
s_waitcnt lgkmcnt(2)
v_mfma_f32_16x16x32_bf16 v[208:211], v[24:27], a[224:227], v[208:211]
ds_read_b64_tr_b16 v[20:21], v15 offset:9216
s_add_u32 s41, s41, 4096
s_add_u32 m0, s47, 118784
v_mfma_f32_16x16x32_bf16 v[212:215], v[24:27], a[228:231], v[212:215]
ds_read_b64_tr_b16 v[22:23], v15 offset:13824
v_mfma_f32_16x16x32_bf16 v[216:219], v[24:27], a[232:235], v[216:219]
buffer_load_dwordx4 a[48:51], v9, s[8:11], s41 offen offset:0 sc1
v_mfma_f32_16x16x32_bf16 v[220:223], v[24:27], a[236:239], v[220:223]
buffer_load_dwordx4 v14, s[48:51], s40 offen offset:0 lds
v_mfma_f32_16x16x32_bf16 v[224:227], v[28:31], a[224:227], v[224:227]
ds_read_b64_tr_b16 v[24:25], v15 offset:9248
v_mfma_f32_16x16x32_bf16 v[228:231], v[28:31], a[228:231], v[228:231]
ds_read_b64_tr_b16 v[26:27], v15 offset:13856
v_mfma_f32_16x16x32_bf16 v[232:235], v[28:31], a[232:235], v[232:235]
v_mfma_f32_16x16x32_bf16 v[236:239], v[28:31], a[236:239], v[236:239]
buffer_load_dwordx4 a[52:55], v9, s[8:11], s41 offen offset:1024 sc1
s_waitcnt lgkmcnt(2)
v_mfma_f32_16x16x32_bf16 v[240:243], v[16:19], a[224:227], v[240:243]
ds_read_b64_tr_b16 v[28:29], v15 offset:9280
v_mfma_f32_16x16x32_bf16 v[244:247], v[16:19], a[228:231], v[244:247]
ds_read_b64_tr_b16 v[30:31], v15 offset:13888
v_mfma_f32_16x16x32_bf16 v[248:251], v[16:19], a[232:235], v[248:251]
v_mfma_f32_16x16x32_bf16 v[252:255], v[16:19], a[236:239], v[252:255]
s_waitcnt vmcnt(22)
v_mfma_f32_16x16x32_bf16 v[112:115], v[20:23], a[240:243], v[112:115]
ds_read_b64_tr_b16 v[16:17], v15 offset:9312
v_mfma_f32_16x16x32_bf16 v[116:119], v[20:23], a[244:247], v[116:119]
ds_read_b64_tr_b16 v[18:19], v15 offset:13920
v_mfma_f32_16x16x32_bf16 v[120:123], v[20:23], a[248:251], v[120:123]
buffer_load_dwordx4 a[56:59], v9, s[8:11], s41 offen offset:2048 sc1
s_add_u32 m0, s47, 0
s_add_u32 s40, s68, 3
v_mfma_f32_16x16x32_bf16 v[124:127], v[20:23], a[252:255], v[124:127]
s_and_b32 s40, s40, 3
s_add_u32 s40, s40, s74
s_waitcnt lgkmcnt(2)
v_mfma_f32_16x16x32_bf16 v[128:131], v[24:27], a[240:243], v[128:131]
ds_read_b64_tr_b16 v[20:21], v15 offset:9344
s_mul_i32 s40, s40, 147456
s_add_u32 s40, s40, s60
v_mfma_f32_16x16x32_bf16 v[132:135], v[24:27], a[244:247], v[132:135]
ds_read_b64_tr_b16 v[22:23], v15 offset:13952
v_mfma_f32_16x16x32_bf16 v[136:139], v[24:27], a[248:251], v[136:139]
buffer_load_dwordx4 v1, s[48:51], s40 offen offset:0 lds
v_mfma_f32_16x16x32_bf16 v[140:143], v[24:27], a[252:255], v[140:143]
v_mfma_f32_16x16x32_bf16 v[144:147], v[28:31], a[240:243], v[144:147]
ds_read_b64_tr_b16 v[24:25], v15 offset:9376
v_mfma_f32_16x16x32_bf16 v[148:151], v[28:31], a[244:247], v[148:151]
ds_read_b64_tr_b16 v[26:27], v15 offset:13984
v_mfma_f32_16x16x32_bf16 v[152:155], v[28:31], a[248:251], v[152:155]
buffer_load_dwordx4 a[60:63], v9, s[8:11], s41 offen offset:3072 sc1
v_mfma_f32_16x16x32_bf16 v[156:159], v[28:31], a[252:255], v[156:159]
s_waitcnt lgkmcnt(2)
v_mfma_f32_16x16x32_bf16 v[160:163], v[16:19], a[240:243], v[160:163]
ds_read_b64_tr_b16 v[28:29], v15 offset:9408
v_mfma_f32_16x16x32_bf16 v[164:167], v[16:19], a[244:247], v[164:167]
ds_read_b64_tr_b16 v[30:31], v15 offset:14016
v_mfma_f32_16x16x32_bf16 v[168:171], v[16:19], a[248:251], v[168:171]
s_add_u32 s41, s68, 2
s_and_b32 s41, s41, 3
s_add_u32 s41, s41, s74
v_mfma_f32_16x16x32_bf16 v[172:175], v[16:19], a[252:255], v[172:175]
s_lshl_b32 s41, s41, 14
s_add_u32 s41, s41, s61
s_add_u32 s41, s41, 8192
v_mfma_f32_16x16x32_bf16 v[176:179], v[20:23], a[240:243], v[176:179]
ds_read_b64_tr_b16 v[16:17], v15 offset:9440
v_mfma_f32_16x16x32_bf16 v[180:183], v[20:23], a[244:247], v[180:183]
ds_read_b64_tr_b16 v[18:19], v15 offset:14048
v_mfma_f32_16x16x32_bf16 v[184:187], v[20:23], a[248:251], v[184:187]
buffer_load_dwordx4 a[64:67], v9, s[8:11], s41 offen offset:0 sc1
v_mfma_f32_16x16x32_bf16 v[188:191], v[20:23], a[252:255], v[188:191]
buffer_load_dwordx4 v2, s[48:51], s40 offen offset:1024 lds
s_waitcnt lgkmcnt(2)
v_mfma_f32_16x16x32_bf16 v[192:195], v[24:27], a[240:243], v[192:195]
ds_read_b64_tr_b16 v[20:21], v15 offset:9472
v_mfma_f32_16x16x32_bf16 v[196:199], v[24:27], a[244:247], v[196:199]
ds_read_b64_tr_b16 v[22:23], v15 offset:14080
buffer_load_dword v7, v6, s[8:11], s66 offen sc1
v_mfma_f32_16x16x32_bf16 v[200:203], v[24:27], a[248:251], v[200:203]
v_mfma_f32_16x16x32_bf16 v[204:207], v[24:27], a[252:255], v[204:207]
buffer_load_dwordx4 a[68:71], v9, s[8:11], s41 offen offset:1024 sc1
v_mfma_f32_16x16x32_bf16 v[208:211], v[28:31], a[240:243], v[208:211]
ds_read_b64_tr_b16 v[24:25], v15 offset:18432
v_mfma_f32_16x16x32_bf16 v[212:215], v[28:31], a[244:247], v[212:215]
ds_read_b64_tr_b16 v[26:27], v15 offset:23040
v_mfma_f32_16x16x32_bf16 v[216:219], v[28:31], a[248:251], v[216:219]
v_mfma_f32_16x16x32_bf16 v[220:223], v[28:31], a[252:255], v[220:223]
s_waitcnt lgkmcnt(2)
v_mfma_f32_16x16x32_bf16 v[224:227], v[16:19], a[240:243], v[224:227]
ds_read_b64_tr_b16 v[28:29], v15 offset:18464
v_mfma_f32_16x16x32_bf16 v[228:231], v[16:19], a[244:247], v[228:231]
ds_read_b64_tr_b16 v[30:31], v15 offset:23072
v_mfma_f32_16x16x32_bf16 v[232:235], v[16:19], a[248:251], v[232:235]
buffer_load_dwordx4 a[72:75], v9, s[8:11], s41 offen offset:2048 sc1
v_mfma_f32_16x16x32_bf16 v[236:239], v[16:19], a[252:255], v[236:239]
v_mfma_f32_16x16x32_bf16 v[240:243], v[20:23], a[240:243], v[240:243]
ds_read_b64_tr_b16 v[16:17], v15 offset:18496
v_mfma_f32_16x16x32_bf16 v[244:247], v[20:23], a[244:247], v[244:247]
ds_read_b64_tr_b16 v[18:19], v15 offset:23104
v_mfma_f32_16x16x32_bf16 v[248:251], v[20:23], a[248:251], v[248:251]
buffer_load_dwordx4 v3, s[48:51], s40 offen offset:2048 lds
v_mfma_f32_16x16x32_bf16 v[252:255], v[20:23], a[252:255], v[252:255]
s_waitcnt lgkmcnt(2)
s_waitcnt vmcnt(24)
v_mfma_f32_16x16x32_bf16 v[112:115], v[24:27], a[0:3], v[112:115]
ds_read_b64_tr_b16 v[20:21], v15 offset:18528
v_mfma_f32_16x16x32_bf16 v[116:119], v[24:27], a[4:7], v[116:119]
ds_read_b64_tr_b16 v[22:23], v15 offset:23136
v_mfma_f32_16x16x32_bf16 v[120:123], v[24:27], a[8:11], v[120:123]
buffer_load_dwordx4 a[76:79], v9, s[8:11], s41 offen offset:3072 sc1
v_mfma_f32_16x16x32_bf16 v[124:127], v[24:27], a[12:15], v[124:127]
v_mfma_f32_16x16x32_bf16 v[128:131], v[28:31], a[0:3], v[128:131]
ds_read_b64_tr_b16 v[24:25], v15 offset:18560
v_mfma_f32_16x16x32_bf16 v[132:135], v[28:31], a[4:7], v[132:135]
ds_read_b64_tr_b16 v[26:27], v15 offset:23168
v_mfma_f32_16x16x32_bf16 v[136:139], v[28:31], a[8:11], v[136:139]
s_add_u32 s41, s68, 2
s_and_b32 s41, s41, 3
s_add_u32 s41, s41, s74
v_mfma_f32_16x16x32_bf16 v[140:143], v[28:31], a[12:15], v[140:143]
s_lshl_b32 s41, s41, 14
s_add_u32 s41, s41, s61
s_waitcnt lgkmcnt(2)
v_mfma_f32_16x16x32_bf16 v[144:147], v[16:19], a[0:3], v[144:147]
ds_read_b64_tr_b16 v[28:29], v15 offset:18592
s_add_u32 s41, s41, 12288
v_mfma_f32_16x16x32_bf16 v[148:151], v[16:19], a[4:7], v[148:151]
ds_read_b64_tr_b16 v[30:31], v15 offset:23200
v_mfma_f32_16x16x32_bf16 v[152:155], v[16:19], a[8:11], v[152:155]
buffer_load_dwordx4 a[80:83], v9, s[8:11], s41 offen offset:0 sc1
v_mfma_f32_16x16x32_bf16 v[156:159], v[16:19], a[12:15], v[156:159]
buffer_load_dwordx4 v8, s[48:51], s40 offen offset:3072 lds
v_mfma_f32_16x16x32_bf16 v[160:163], v[20:23], a[0:3], v[160:163]
ds_read_b64_tr_b16 v[16:17], v15 offset:18624
v_mfma_f32_16x16x32_bf16 v[164:167], v[20:23], a[4:7], v[164:167]
ds_read_b64_tr_b16 v[18:19], v15 offset:23232
v_mfma_f32_16x16x32_bf16 v[168:171], v[20:23], a[8:11], v[168:171]
v_mfma_f32_16x16x32_bf16 v[172:175], v[20:23], a[12:15], v[172:175]
buffer_load_dwordx4 a[84:87], v9, s[8:11], s41 offen offset:1024 sc1
s_waitcnt lgkmcnt(2)
v_mfma_f32_16x16x32_bf16 v[176:179], v[24:27], a[0:3], v[176:179]
ds_read_b64_tr_b16 v[20:21], v15 offset:18656
v_mfma_f32_16x16x32_bf16 v[180:183], v[24:27], a[4:7], v[180:183]
ds_read_b64_tr_b16 v[22:23], v15 offset:23264
v_mfma_f32_16x16x32_bf16 v[184:187], v[24:27], a[8:11], v[184:187]
v_mfma_f32_16x16x32_bf16 v[188:191], v[24:27], a[12:15], v[188:191]
v_mfma_f32_16x16x32_bf16 v[192:195], v[28:31], a[0:3], v[192:195]
ds_read_b64_tr_b16 v[24:25], v15 offset:18688
v_mfma_f32_16x16x32_bf16 v[196:199], v[28:31], a[4:7], v[196:199]
ds_read_b64_tr_b16 v[26:27], v15 offset:23296
v_mfma_f32_16x16x32_bf16 v[200:203], v[28:31], a[8:11], v[200:203]
buffer_load_dwordx4 a[88:91], v9, s[8:11], s41 offen offset:2048 sc1
s_add_u32 m0, s47, 4096
v_mfma_f32_16x16x32_bf16 v[204:207], v[28:31], a[12:15], v[204:207]
s_waitcnt lgkmcnt(2)
v_mfma_f32_16x16x32_bf16 v[208:211], v[16:19], a[0:3], v[208:211]
ds_read_b64_tr_b16 v[28:29], v15 offset:27648
v_mfma_f32_16x16x32_bf16 v[212:215], v[16:19], a[4:7], v[212:215]
ds_read_b64_tr_b16 v[30:31], v15 offset:32256
v_mfma_f32_16x16x32_bf16 v[216:219], v[16:19], a[8:11], v[216:219]
buffer_load_dwordx4 v10, s[48:51], s40 offen offset:0 lds
v_mfma_f32_16x16x32_bf16 v[220:223], v[16:19], a[12:15], v[220:223]
v_mfma_f32_16x16x32_bf16 v[224:227], v[20:23], a[0:3], v[224:227]
ds_read_b64_tr_b16 v[16:17], v15 offset:27680
v_mfma_f32_16x16x32_bf16 v[228:231], v[20:23], a[4:7], v[228:231]
ds_read_b64_tr_b16 v[18:19], v15 offset:32288
v_mfma_f32_16x16x32_bf16 v[232:235], v[20:23], a[8:11], v[232:235]
buffer_load_dwordx4 a[92:95], v9, s[8:11], s41 offen offset:3072 sc1
v_mfma_f32_16x16x32_bf16 v[236:239], v[20:23], a[12:15], v[236:239]
s_waitcnt lgkmcnt(2)
v_mfma_f32_16x16x32_bf16 v[240:243], v[24:27], a[0:3], v[240:243]
ds_read_b64_tr_b16 v[20:21], v15 offset:27712
v_mfma_f32_16x16x32_bf16 v[244:247], v[24:27], a[4:7], v[244:247]
ds_read_b64_tr_b16 v[22:23], v15 offset:32320
v_mfma_f32_16x16x32_bf16 v[248:251], v[24:27], a[8:11], v[248:251]
s_add_u32 s41, s68, 3
s_and_b32 s41, s41, 3
s_add_u32 s41, s41, s74
v_mfma_f32_16x16x32_bf16 v[252:255], v[24:27], a[12:15], v[252:255]
s_lshl_b32 s41, s41, 14
s_add_u32 s41, s41, s61
s_waitcnt vmcnt(25)
v_mfma_f32_16x16x32_bf16 v[112:115], v[28:31], a[16:19], v[112:115]
ds_read_b64_tr_b16 v[24:25], v15 offset:27744
v_mfma_f32_16x16x32_bf16 v[116:119], v[28:31], a[20:23], v[116:119]
ds_read_b64_tr_b16 v[26:27], v15 offset:32352
v_mfma_f32_16x16x32_bf16 v[120:123], v[28:31], a[24:27], v[120:123]
buffer_load_dwordx4 a[96:99], v9, s[8:11], s41 offen offset:0 sc1
v_mfma_f32_16x16x32_bf16 v[124:127], v[28:31], a[28:31], v[124:127]
buffer_load_dwordx4 v11, s[48:51], s40 offen offset:1024 lds
s_waitcnt lgkmcnt(2)
v_mfma_f32_16x16x32_bf16 v[128:131], v[16:19], a[16:19], v[128:131]
ds_read_b64_tr_b16 v[28:29], v15 offset:27776
v_mfma_f32_16x16x32_bf16 v[132:135], v[16:19], a[20:23], v[132:135]
ds_read_b64_tr_b16 v[30:31], v15 offset:32384
v_mfma_f32_16x16x32_bf16 v[136:139], v[16:19], a[24:27], v[136:139]
v_mfma_f32_16x16x32_bf16 v[140:143], v[16:19], a[28:31], v[140:143]
buffer_load_dwordx4 a[100:103], v9, s[8:11], s41 offen offset:1024 sc1
v_mfma_f32_16x16x32_bf16 v[144:147], v[20:23], a[16:19], v[144:147]
ds_read_b64_tr_b16 v[16:17], v15 offset:27808
v_mfma_f32_16x16x32_bf16 v[148:151], v[20:23], a[20:23], v[148:151]
ds_read_b64_tr_b16 v[18:19], v15 offset:32416
v_mfma_f32_16x16x32_bf16 v[152:155], v[20:23], a[24:27], v[152:155]
v_mfma_f32_16x16x32_bf16 v[156:159], v[20:23], a[28:31], v[156:159]
s_waitcnt lgkmcnt(2)
v_mfma_f32_16x16x32_bf16 v[160:163], v[24:27], a[16:19], v[160:163]
ds_read_b64_tr_b16 v[20:21], v15 offset:27840
v_mfma_f32_16x16x32_bf16 v[164:167], v[24:27], a[20:23], v[164:167]
ds_read_b64_tr_b16 v[22:23], v15 offset:32448
v_mfma_f32_16x16x32_bf16 v[168:171], v[24:27], a[24:27], v[168:171]
buffer_load_dwordx4 a[104:107], v9, s[8:11], s41 offen offset:2048 sc1
v_mfma_f32_16x16x32_bf16 v[172:175], v[24:27], a[28:31], v[172:175]
v_mfma_f32_16x16x32_bf16 v[176:179], v[28:31], a[16:19], v[176:179]
ds_read_b64_tr_b16 v[24:25], v15 offset:27872
v_mfma_f32_16x16x32_bf16 v[180:183], v[28:31], a[20:23], v[180:183]
ds_read_b64_tr_b16 v[26:27], v15 offset:32480
v_mfma_f32_16x16x32_bf16 v[184:187], v[28:31], a[24:27], v[184:187]
buffer_load_dwordx4 v12, s[48:51], s40 offen offset:2048 lds
v_mfma_f32_16x16x32_bf16 v[188:191], v[28:31], a[28:31], v[188:191]
s_waitcnt lgkmcnt(2)
v_mfma_f32_16x16x32_bf16 v[192:195], v[16:19], a[16:19], v[192:195]
ds_read_b64_tr_b16 v[28:29], v15 offset:27904
v_mfma_f32_16x16x32_bf16 v[196:199], v[16:19], a[20:23], v[196:199]
ds_read_b64_tr_b16 v[30:31], v15 offset:32512
s_waitcnt vmcnt(15)
v_cmp_eq_u32 vcc, s100, v7
s_lshl_b32 s73, 15, s75
s_nop 2
s_and_b32 s43, vcc_lo, s73
s_cmp_eq_u32 s43, s73
s_cbranch_scc0 mk_slowO2
mk_backO2:
v_mfma_f32_16x16x32_bf16 v[200:203], v[16:19], a[24:27], v[200:203]
buffer_load_dwordx4 a[108:111], v9, s[8:11], s41 offen offset:3072 sc1
v_mfma_f32_16x16x32_bf16 v[204:207], v[16:19], a[28:31], v[204:207]
v_add_u32 v15, 0x9000, v15
v_mfma_f32_16x16x32_bf16 v[208:211], v[20:23], a[16:19], v[208:211]
s_barrier
ds_read_b64_tr_b16 v[16:17], v15 offset:0
v_mfma_f32_16x16x32_bf16 v[212:215], v[20:23], a[20:23], v[212:215]
ds_read_b64_tr_b16 v[18:19], v15 offset:4608
v_mfma_f32_16x16x32_bf16 v[216:219], v[20:23], a[24:27], v[216:219]
s_add_u32 s41, s68, 3
s_and_b32 s41, s41, 3
s_add_u32 s41, s41, s74
v_mfma_f32_16x16x32_bf16 v[220:223], v[20:23], a[28:31], v[220:223]
s_lshl_b32 s41, s41, 14
s_add_u32 s41, s41, s61
s_waitcnt lgkmcnt(2)
v_mfma_f32_16x16x32_bf16 v[224:227], v[24:27], a[16:19], v[224:227]
ds_read_b64_tr_b16 v[20:21], v15 offset:32
s_add_u32 s41, s41, 4096
v_mfma_f32_16x16x32_bf16 v[228:231], v[24:27], a[20:23], v[228:231]
ds_read_b64_tr_b16 v[22:23], v15 offset:4640
v_mfma_f32_16x16x32_bf16 v[232:235], v[24:27], a[24:27], v[232:235]
buffer_load_dwordx4 a[112:115], v9, s[8:11], s41 offen offset:0 sc1
v_mfma_f32_16x16x32_bf16 v[236:239], v[24:27], a[28:31], v[236:239]
buffer_load_dwordx4 v13, s[48:51], s40 offen offset:3072 lds
v_mfma_f32_16x16x32_bf16 v[240:243], v[28:31], a[16:19], v[240:243]
ds_read_b64_tr_b16 v[24:25], v15 offset:64
v_mfma_f32_16x16x32_bf16 v[244:247], v[28:31], a[20:23], v[244:247]
ds_read_b64_tr_b16 v[26:27], v15 offset:4672
v_mfma_f32_16x16x32_bf16 v[248:251], v[28:31], a[24:27], v[248:251]
v_mfma_f32_16x16x32_bf16 v[252:255], v[28:31], a[28:31], v[252:255]
buffer_load_dwordx4 a[116:119], v9, s[8:11], s41 offen offset:1024 sc1
s_waitcnt lgkmcnt(2)
v_mfma_f32_16x16x32_bf16 v[112:115], v[16:19], a[32:35], v[112:115]
ds_read_b64_tr_b16 v[28:29], v15 offset:96
v_mfma_f32_16x16x32_bf16 v[116:119], v[16:19], a[36:39], v[116:119]
ds_read_b64_tr_b16 v[30:31], v15 offset:4704
v_mfma_f32_16x16x32_bf16 v[120:123], v[16:19], a[40:43], v[120:123]
v_mfma_f32_16x16x32_bf16 v[124:127], v[16:19], a[44:47], v[124:127]
v_mfma_f32_16x16x32_bf16 v[128:131], v[20:23], a[32:35], v[128:131]
ds_read_b64_tr_b16 v[16:17], v15 offset:128
v_mfma_f32_16x16x32_bf16 v[132:135], v[20:23], a[36:39], v[132:135]
ds_read_b64_tr_b16 v[18:19], v15 offset:4736
s_barrier
v_mfma_f32_16x16x32_bf16 v[136:139], v[20:23], a[40:43], v[136:139]
buffer_load_dwordx4 a[120:123], v9, s[8:11], s41 offen offset:2048 sc1
s_add_u32 m0, s47, 8192
v_mfma_f32_16x16x32_bf16 v[140:143], v[20:23], a[44:47], v[140:143]
s_waitcnt lgkmcnt(2)
v_mfma_f32_16x16x32_bf16 v[144:147], v[24:27], a[32:35], v[144:147]
ds_read_b64_tr_b16 v[20:21], v15 offset:160
v_mfma_f32_16x16x32_bf16 v[148:151], v[24:27], a[36:39], v[148:151]
ds_read_b64_tr_b16 v[22:23], v15 offset:4768
v_mfma_f32_16x16x32_bf16 v[152:155], v[24:27], a[40:43], v[152:155]
buffer_load_dwordx4 v14, s[48:51], s40 offen offset:0 lds
v_mfma_f32_16x16x32_bf16 v[156:159], v[24:27], a[44:47], v[156:159]
v_mfma_f32_16x16x32_bf16 v[160:163], v[28:31], a[32:35], v[160:163]
ds_read_b64_tr_b16 v[24:25], v15 offset:192
v_mfma_f32_16x16x32_bf16 v[164:167], v[28:31], a[36:39], v[164:167]
ds_read_b64_tr_b16 v[26:27], v15 offset:4800
v_mfma_f32_16x16x32_bf16 v[168:171], v[28:31], a[40:43], v[168:171]
buffer_load_dwordx4 a[124:127], v9, s[8:11], s41 offen offset:3072 sc1
v_mfma_f32_16x16x32_bf16 v[172:175], v[28:31], a[44:47], v[172:175]
s_waitcnt lgkmcnt(2)
v_mfma_f32_16x16x32_bf16 v[176:179], v[16:19], a[32:35], v[176:179]
ds_read_b64_tr_b16 v[28:29], v15 offset:224
v_mfma_f32_16x16x32_bf16 v[180:183], v[16:19], a[36:39], v[180:183]
ds_read_b64_tr_b16 v[30:31], v15 offset:4832
v_mfma_f32_16x16x32_bf16 v[184:187], v[16:19], a[40:43], v[184:187]
s_add_u32 s41, s68, 3
s_and_b32 s41, s41, 3
s_add_u32 s41, s41, s74
v_mfma_f32_16x16x32_bf16 v[188:191], v[16:19], a[44:47], v[188:191]
s_lshl_b32 s41, s41, 14
s_add_u32 s41, s41, s61
s_add_u32 s41, s41, 8192
v_mfma_f32_16x16x32_bf16 v[192:195], v[20:23], a[32:35], v[192:195]
ds_read_b64_tr_b16 v[16:17], v15 offset:256
s_add_u32 m0, s47, 36864
s_add_u32 s40, s68, 1
v_mfma_f32_16x16x32_bf16 v[196:199], v[20:23], a[36:39], v[196:199]
ds_read_b64_tr_b16 v[18:19], v15 offset:4864
s_and_b32 s40, s40, 3
s_add_u32 s40, s40, s75
v_mfma_f32_16x16x32_bf16 v[200:203], v[20:23], a[40:43], v[200:203]
buffer_load_dwordx4 a[128:131], v9, s[8:11], s41 offen offset:0 sc1
s_mul_i32 s40, s40, 147456
s_add_u32 s40, s40, s60
v_mfma_f32_16x16x32_bf16 v[204:207], v[20:23], a[44:47], v[204:207]
buffer_load_dwordx4 v1, s[48:51], s40 offen offset:0 lds
s_lshl_b32 s72, s28, 13
s_waitcnt lgkmcnt(2)
v_mfma_f32_16x16x32_bf16 v[208:211], v[24:27], a[32:35], v[208:211]
ds_read_b64_tr_b16 v[20:21], v15 offset:9216
s_add_u32 s72, s72, mk_LS_W5-mk_pc
v_lshl_add_u32 v46, v0, 7, s72
v_mfma_f32_16x16x32_bf16 v[212:215], v[24:27], a[36:39], v[212:215]
ds_read_b64_tr_b16 v[22:23], v15 offset:13824
v_min_u32 v46, mk_fin-mk_pc, v46
v_mfma_f32_16x16x32_bf16 v[216:219], v[24:27], a[40:43], v[216:219]
global_load_dword v47, v46, s[4:5]
v_mfma_f32_16x16x32_bf16 v[220:223], v[24:27], a[44:47], v[220:223]
buffer_load_dwordx4 a[132:135], v9, s[8:11], s41 offen offset:1024 sc1
v_mfma_f32_16x16x32_bf16 v[224:227], v[28:31], a[32:35], v[224:227]
ds_read_b64_tr_b16 v[24:25], v15 offset:9248
v_mfma_f32_16x16x32_bf16 v[228:231], v[28:31], a[36:39], v[228:231]
ds_read_b64_tr_b16 v[26:27], v15 offset:13856
v_mfma_f32_16x16x32_bf16 v[232:235], v[28:31], a[40:43], v[232:235]
v_mfma_f32_16x16x32_bf16 v[236:239], v[28:31], a[44:47], v[236:239]
s_waitcnt lgkmcnt(2)
v_mfma_f32_16x16x32_bf16 v[240:243], v[16:19], a[32:35], v[240:243]
ds_read_b64_tr_b16 v[28:29], v15 offset:9280
v_mfma_f32_16x16x32_bf16 v[244:247], v[16:19], a[36:39], v[244:247]
ds_read_b64_tr_b16 v[30:31], v15 offset:13888
v_mfma_f32_16x16x32_bf16 v[248:251], v[16:19], a[40:43], v[248:251]
buffer_load_dwordx4 a[136:139], v9, s[8:11], s41 offen offset:2048 sc1
v_mfma_f32_16x16x32_bf16 v[252:255], v[16:19], a[44:47], v[252:255]
v_mfma_f32_16x16x32_bf16 v[112:115], v[20:23], a[48:51], v[112:115]
ds_read_b64_tr_b16 v[16:17], v15 offset:9312
v_mfma_f32_16x16x32_bf16 v[116:119], v[20:23], a[52:55], v[116:119]
ds_read_b64_tr_b16 v[18:19], v15 offset:13920
v_mfma_f32_16x16x32_bf16 v[120:123], v[20:23], a[56:59], v[120:123]
buffer_load_dwordx4 v2, s[48:51], s40 offen offset:1024 lds
v_mfma_f32_16x16x32_bf16 v[124:127], v[20:23], a[60:63], v[124:127]
s_waitcnt lgkmcnt(2)
v_mfma_f32_16x16x32_bf16 v[128:131], v[24:27], a[48:51], v[128:131]
ds_read_b64_tr_b16 v[20:21], v15 offset:9344
v_mfma_f32_16x16x32_bf16 v[132:135], v[24:27], a[52:55], v[132:135]
ds_read_b64_tr_b16 v[22:23], v15 offset:13952
v_mfma_f32_16x16x32_bf16 v[136:139], v[24:27], a[56:59], v[136:139]
buffer_load_dwordx4 a[140:143], v9, s[8:11], s41 offen offset:3072 sc1
v_mfma_f32_16x16x32_bf16 v[140:143], v[24:27], a[60:63], v[140:143]
v_mfma_f32_16x16x32_bf16 v[144:147], v[28:31], a[48:51], v[144:147]
ds_read_b64_tr_b16 v[24:25], v15 offset:9376
v_mfma_f32_16x16x32_bf16 v[148:151], v[28:31], a[52:55], v[148:151]
ds_read_b64_tr_b16 v[26:27], v15 offset:13984
v_mfma_f32_16x16x32_bf16 v[152:155], v[28:31], a[56:59], v[152:155]
s_add_u32 s41, s68, 3
s_and_b32 s41, s41, 3
s_add_u32 s41, s41, s74
v_mfma_f32_16x16x32_bf16 v[156:159], v[28:31], a[60:63], v[156:159]
s_lshl_b32 s41, s41, 14
s_add_u32 s41, s41, s61
s_waitcnt lgkmcnt(2)
v_mfma_f32_16x16x32_bf16 v[160:163], v[16:19], a[48:51], v[160:163]
ds_read_b64_tr_b16 v[28:29], v15 offset:9408
s_add_u32 s41, s41, 12288
v_mfma_f32_16x16x32_bf16 v[164:167], v[16:19], a[52:55], v[164:167]
ds_read_b64_tr_b16 v[30:31], v15 offset:14016
v_mfma_f32_16x16x32_bf16 v[168:171], v[16:19], a[56:59], v[168:171]
buffer_load_dwordx4 a[160:163], v9, s[8:11], s41 offen offset:0 sc1
v_mfma_f32_16x16x32_bf16 v[172:175], v[16:19], a[60:63], v[172:175]
buffer_load_dwordx4 v3, s[48:51], s40 offen offset:2048 lds
v_mfma_f32_16x16x32_bf16 v[176:179], v[20:23], a[48:51], v[176:179]
ds_read_b64_tr_b16 v[16:17], v15 offset:9440
v_mfma_f32_16x16x32_bf16 v[180:183], v[20:23], a[52:55], v[180:183]
ds_read_b64_tr_b16 v[18:19], v15 offset:14048
v_mfma_f32_16x16x32_bf16 v[184:187], v[20:23], a[56:59], v[184:187]
v_mfma_f32_16x16x32_bf16 v[188:191], v[20:23], a[60:63], v[188:191]
s_waitcnt lgkmcnt(2)
v_mfma_f32_16x16x32_bf16 v[192:195], v[24:27], a[48:51], v[192:195]
ds_read_b64_tr_b16 v[20:21], v15 offset:9472
v_mfma_f32_16x16x32_bf16 v[196:199], v[24:27], a[52:55], v[196:199]
ds_read_b64_tr_b16 v[22:23], v15 offset:14080
v_mfma_f32_16x16x32_bf16 v[200:203], v[24:27], a[56:59], v[200:203]
buffer_load_dwordx4 a[164:167], v9, s[8:11], s41 offen offset:1024 sc1
v_mfma_f32_16x16x32_bf16 v[204:207], v[24:27], a[60:63], v[204:207]
v_mfma_f32_16x16x32_bf16 v[208:211], v[28:31], a[48:51], v[208:211]
ds_read_b64_tr_b16 v[24:25], v15 offset:18432
v_mfma_f32_16x16x32_bf16 v[212:215], v[28:31], a[52:55], v[212:215]
ds_read_b64_tr_b16 v[26:27], v15 offset:23040
v_mfma_f32_16x16x32_bf16 v[216:219], v[28:31], a[56:59], v[216:219]
v_mfma_f32_16x16x32_bf16 v[220:223], v[28:31], a[60:63], v[220:223]
s_waitcnt lgkmcnt(2)
v_mfma_f32_16x16x32_bf16 v[224:227], v[16:19], a[48:51], v[224:227]
ds_read_b64_tr_b16 v[28:29], v15 offset:18464
v_mfma_f32_16x16x32_bf16 v[228:231], v[16:19], a[52:55], v[228:231]
ds_read_b64_tr_b16 v[30:31], v15 offset:23072
v_mfma_f32_16x16x32_bf16 v[232:235], v[16:19], a[56:59], v[232:235]
buffer_load_dwordx4 a[168:171], v9, s[8:11], s41 offen offset:2048 sc1
v_mfma_f32_16x16x32_bf16 v[236:239], v[16:19], a[60:63], v[236:239]
buffer_load_dwordx4 v8, s[48:51], s40 offen offset:3072 lds
v_mfma_f32_16x16x32_bf16 v[240:243], v[20:23], a[48:51], v[240:243]
ds_read_b64_tr_b16 v[16:17], v15 offset:18496
v_mfma_f32_16x16x32_bf16 v[244:247], v[20:23], a[52:55], v[244:247]
ds_read_b64_tr_b16 v[18:19], v15 offset:23104
v_mfma_f32_16x16x32_bf16 v[248:251], v[20:23], a[56:59], v[248:251]
v_mfma_f32_16x16x32_bf16 v[252:255], v[20:23], a[60:63], v[252:255]
s_waitcnt lgkmcnt(2)
s_waitcnt vmcnt(30)
v_mfma_f32_16x16x32_bf16 v[112:115], v[24:27], a[64:67], v[112:115]
ds_read_b64_tr_b16 v[20:21], v15 offset:18528
v_mfma_f32_16x16x32_bf16 v[116:119], v[24:27], a[68:71], v[116:119]
ds_read_b64_tr_b16 v[22:23], v15 offset:23136
v_mfma_f32_16x16x32_bf16 v[120:123], v[24:27], a[72:75], v[120:123]
buffer_load_dwordx4 a[172:175], v9, s[8:11], s41 offen offset:3072 sc1
v_mfma_f32_16x16x32_bf16 v[124:127], v[24:27], a[76:79], v[124:127]
v_mfma_f32_16x16x32_bf16 v[128:131], v[28:31], a[64:67], v[128:131]
ds_read_b64_tr_b16 v[24:25], v15 offset:18560
s_add_u32 m0, s47, 40960
v_mfma_f32_16x16x32_bf16 v[132:135], v[28:31], a[68:71], v[132:135]
ds_read_b64_tr_b16 v[26:27], v15 offset:23168
v_mfma_f32_16x16x32_bf16 v[136:139], v[28:31], a[72:75], v[136:139]
s_add_u32 s41, s68, 1
s_and_b32 s41, s41, 3
s_add_u32 s41, s41, s75
v_mfma_f32_16x16x32_bf16 v[140:143], v[28:31], a[76:79], v[140:143]
buffer_load_dwordx4 v10, s[48:51], s40 offen offset:0 lds
s_lshl_b32 s41, s41, 14
s_waitcnt lgkmcnt(2)
v_mfma_f32_16x16x32_bf16 v[144:147], v[16:19], a[64:67], v[144:147]
ds_read_b64_tr_b16 v[28:29], v15 offset:18592
s_add_u32 s41, s41, s61
v_mfma_f32_16x16x32_bf16 v[148:151], v[16:19], a[68:71], v[148:151]
ds_read_b64_tr_b16 v[30:31], v15 offset:23200
v_mfma_f32_16x16x32_bf16 v[152:155], v[16:19], a[72:75], v[152:155]
buffer_load_dwordx4 a[176:179], v9, s[8:11], s41 offen offset:0 sc1
v_mfma_f32_16x16x32_bf16 v[156:159], v[16:19], a[76:79], v[156:159]
v_mfma_f32_16x16x32_bf16 v[160:163], v[20:23], a[64:67], v[160:163]
ds_read_b64_tr_b16 v[16:17], v15 offset:18624
v_mfma_f32_16x16x32_bf16 v[164:167], v[20:23], a[68:71], v[164:167]
ds_read_b64_tr_b16 v[18:19], v15 offset:23232
v_mfma_f32_16x16x32_bf16 v[168:171], v[20:23], a[72:75], v[168:171]
v_mfma_f32_16x16x32_bf16 v[172:175], v[20:23], a[76:79], v[172:175]
s_waitcnt lgkmcnt(2)
v_mfma_f32_16x16x32_bf16 v[176:179], v[24:27], a[64:67], v[176:179]
ds_read_b64_tr_b16 v[20:21], v15 offset:18656
v_mfma_f32_16x16x32_bf16 v[180:183], v[24:27], a[68:71], v[180:183]
ds_read_b64_tr_b16 v[22:23], v15 offset:23264
v_mfma_f32_16x16x32_bf16 v[184:187], v[24:27], a[72:75], v[184:187]
buffer_load_dwordx4 a[180:183], v9, s[8:11], s41 offen offset:1024 sc1
v_mfma_f32_16x16x32_bf16 v[188:191], v[24:27], a[76:79], v[188:191]
v_mfma_f32_16x16x32_bf16 v[192:195], v[28:31], a[64:67], v[192:195]
ds_read_b64_tr_b16 v[24:25], v15 offset:18688
v_mfma_f32_16x16x32_bf16 v[196:199], v[28:31], a[68:71], v[196:199]
ds_read_b64_tr_b16 v[26:27], v15 offset:23296
v_mfma_f32_16x16x32_bf16 v[200:203], v[28:31], a[72:75], v[200:203]
buffer_load_dwordx4 v11, s[48:51], s40 offen offset:1024 lds
v_mfma_f32_16x16x32_bf16 v[204:207], v[28:31], a[76:79], v[204:207]
s_waitcnt lgkmcnt(2)
v_mfma_f32_16x16x32_bf16 v[208:211], v[16:19], a[64:67], v[208:211]
ds_read_b64_tr_b16 v[28:29], v15 offset:27648
v_mfma_f32_16x16x32_bf16 v[212:215], v[16:19], a[68:71], v[212:215]
ds_read_b64_tr_b16 v[30:31], v15 offset:32256
v_mfma_f32_16x16x32_bf16 v[216:219], v[16:19], a[72:75], v[216:219]
buffer_load_dwordx4 a[184:187], v9, s[8:11], s41 offen offset:2048 sc1
v_mfma_f32_16x16x32_bf16 v[220:223], v[16:19], a[76:79], v[220:223]
v_mfma_f32_16x16x32_bf16 v[224:227], v[20:23], a[64:67], v[224:227]
ds_read_b64_tr_b16 v[16:17], v15 offset:27680
v_mfma_f32_16x16x32_bf16 v[228:231], v[20:23], a[68:71], v[228:231]
ds_read_b64_tr_b16 v[18:19], v15 offset:32288
v_mfma_f32_16x16x32_bf16 v[232:235], v[20:23], a[72:75], v[232:235]
v_mfma_f32_16x16x32_bf16 v[236:239], v[20:23], a[76:79], v[236:239]
s_waitcnt lgkmcnt(2)
v_mfma_f32_16x16x32_bf16 v[240:243], v[24:27], a[64:67], v[240:243]
ds_read_b64_tr_b16 v[20:21], v15 offset:27712
v_mfma_f32_16x16x32_bf16 v[244:247], v[24:27], a[68:71], v[244:247]
ds_read_b64_tr_b16 v[22:23], v15 offset:32320
v_mfma_f32_16x16x32_bf16 v[248:251], v[24:27], a[72:75], v[248:251]
buffer_load_dwordx4 a[188:191], v9, s[8:11], s41 offen offset:3072 sc1
v_mfma_f32_16x16x32_bf16 v[252:255], v[24:27], a[76:79], v[252:255]
buffer_load_dwordx4 v12, s[48:51], s40 offen offset:2048 lds
s_waitcnt vmcnt(32)
v_mfma_f32_16x16x32_bf16 v[112:115], v[28:31], a[80:83], v[112:115]
ds_read_b64_tr_b16 v[24:25], v15 offset:27744
v_mfma_f32_16x16x32_bf16 v[116:119], v[28:31], a[84:87], v[116:119]
ds_read_b64_tr_b16 v[26:27], v15 offset:32352
v_mfma_f32_16x16x32_bf16 v[120:123], v[28:31], a[88:91], v[120:123]
s_add_u32 s41, s68, 1
s_and_b32 s41, s41, 3
s_add_u32 s41, s41, s75
v_mfma_f32_16x16x32_bf16 v[124:127], v[28:31], a[92:95], v[124:127]
s_lshl_b32 s41, s41, 14
s_add_u32 s41, s41, s61
s_waitcnt lgkmcnt(2)
v_mfma_f32_16x16x32_bf16 v[128:131], v[16:19], a[80:83], v[128:131]
ds_read_b64_tr_b16 v[28:29], v15 offset:27776
s_add_u32 s41, s41, 4096
v_mfma_f32_16x16x32_bf16 v[132:135], v[16:19], a[84:87], v[132:135]
ds_read_b64_tr_b16 v[30:31], v15 offset:32384
v_mfma_f32_16x16x32_bf16 v[136:139], v[16:19], a[88:91], v[136:139]
buffer_load_dwordx4 a[192:195], v9, s[8:11], s41 offen offset:0 sc1
v_mfma_f32_16x16x32_bf16 v[140:143], v[16:19], a[92:95], v[140:143]
v_mfma_f32_16x16x32_bf16 v[144:147], v[20:23], a[80:83], v[144:147]
ds_read_b64_tr_b16 v[16:17], v15 offset:27808
v_mfma_f32_16x16x32_bf16 v[148:151], v[20:23], a[84:87], v[148:151]
ds_read_b64_tr_b16 v[18:19], v15 offset:32416
v_mfma_f32_16x16x32_bf16 v[152:155], v[20:23], a[88:91], v[152:155]
v_mfma_f32_16x16x32_bf16 v[156:159], v[20:23], a[92:95], v[156:159]
s_waitcnt lgkmcnt(2)
v_mfma_f32_16x16x32_bf16 v[160:163], v[24:27], a[80:83], v[160:163]
ds_read_b64_tr_b16 v[20:21], v15 offset:27840
v_mfma_f32_16x16x32_bf16 v[164:167], v[24:27], a[84:87], v[164:167]
ds_read_b64_tr_b16 v[22:23], v15 offset:32448
v_mfma_f32_16x16x32_bf16 v[168:171], v[24:27], a[88:91], v[168:171]
buffer_load_dwordx4 a[196:199], v9, s[8:11], s41 offen offset:1024 sc1
v_mfma_f32_16x16x32_bf16 v[172:175], v[24:27], a[92:95], v[172:175]
buffer_load_dwordx4 v13, s[48:51], s40 offen offset:3072 lds
v_mfma_f32_16x16x32_bf16 v[176:179], v[28:31], a[80:83], v[176:179]
ds_read_b64_tr_b16 v[24:25], v15 offset:27872
v_mfma_f32_16x16x32_bf16 v[180:183], v[28:31], a[84:87], v[180:183]
ds_read_b64_tr_b16 v[26:27], v15 offset:32480
v_mfma_f32_16x16x32_bf16 v[184:187], v[28:31], a[88:91], v[184:187]
v_mfma_f32_16x16x32_bf16 v[188:191], v[28:31], a[92:95], v[188:191]
s_waitcnt lgkmcnt(2)
v_mfma_f32_16x16x32_bf16 v[192:195], v[16:19], a[80:83], v[192:195]
ds_read_b64_tr_b16 v[28:29], v15 offset:27904
v_mfma_f32_16x16x32_bf16 v[196:199], v[16:19], a[84:87], v[196:199]
ds_read_b64_tr_b16 v[30:31], v15 offset:32512
v_mfma_f32_16x16x32_bf16 v[200:203], v[16:19], a[88:91], v[200:203]
buffer_load_dwordx4 a[200:203], v9, s[8:11], s41 offen offset:2048 sc1
v_mfma_f32_16x16x32_bf16 v[204:207], v[16:19], a[92:95], v[204:207]
v_add_u32 v15, 0xfffe5000, v15
v_mfma_f32_16x16x32_bf16 v[208:211], v[20:23], a[80:83], v[208:211]
s_waitcnt vmcnt(25)
s_barrier
ds_read_b64_tr_b16 v[16:17], v15 offset:0
v_mfma_f32_16x16x32_bf16 v[212:215], v[20:23], a[84:87], v[212:215]
ds_read_b64_tr_b16 v[18:19], v15 offset:4608
s_add_u32 m0, s47, 45056
v_mfma_f32_16x16x32_bf16 v[216:219], v[20:23], a[88:91], v[216:219]
v_mfma_f32_16x16x32_bf16 v[220:223], v[20:23], a[92:95], v[220:223]
buffer_load_dwordx4 v14, s[48:51], s40 offen offset:0 lds
s_waitcnt lgkmcnt(2)
v_mfma_f32_16x16x32_bf16 v[224:227], v[24:27], a[80:83], v[224:227]
ds_read_b64_tr_b16 v[20:21], v15 offset:32
v_mfma_f32_16x16x32_bf16 v[228:231], v[24:27], a[84:87], v[228:231]
ds_read_b64_tr_b16 v[22:23], v15 offset:4640
v_mfma_f32_16x16x32_bf16 v[232:235], v[24:27], a[88:91], v[232:235]
buffer_load_dwordx4 a[204:207], v9, s[8:11], s41 offen offset:3072 sc1
v_mfma_f32_16x16x32_bf16 v[236:239], v[24:27], a[92:95], v[236:239]
v_mfma_f32_16x16x32_bf16 v[240:243], v[28:31], a[80:83], v[240:243]
ds_read_b64_tr_b16 v[24:25], v15 offset:64
v_mfma_f32_16x16x32_bf16 v[244:247], v[28:31], a[84:87], v[244:247]
ds_read_b64_tr_b16 v[26:27], v15 offset:4672
v_mfma_f32_16x16x32_bf16 v[248:251], v[28:31], a[88:91], v[248:251]
s_add_u32 s41, s68, 1
s_and_b32 s41, s41, 3
s_add_u32 s41, s41, s75
v_mfma_f32_16x16x32_bf16 v[252:255], v[28:31], a[92:95], v[252:255]
s_lshl_b32 s41, s41, 14
s_waitcnt lgkmcnt(2)
v_mfma_f32_16x16x32_bf16 v[112:115], v[16:19], a[96:99], v[112:115]
ds_read_b64_tr_b16 v[28:29], v15 offset:96
s_add_u32 s41, s41, s61
s_add_u32 s41, s41, 8192
v_mfma_f32_16x16x32_bf16 v[116:119], v[16:19], a[100:103], v[116:119]
ds_read_b64_tr_b16 v[30:31], v15 offset:4704
v_mfma_f32_16x16x32_bf16 v[120:123], v[16:19], a[104:107], v[120:123]
buffer_load_dwordx4 a[208:211], v9, s[8:11], s41 offen offset:0 sc1
s_add_u32 m0, s47, 73728
s_add_u32 s40, s68, 2
v_mfma_f32_16x16x32_bf16 v[124:127], v[16:19], a[108:111], v[124:127]
s_and_b32 s40, s40, 3
s_add_u32 s40, s40, s75
s_mul_i32 s40, s40, 147456
v_mfma_f32_16x16x32_bf16 v[128:131], v[20:23], a[96:99], v[128:131]
ds_read_b64_tr_b16 v[16:17], v15 offset:128
s_add_u32 s40, s40, s60
v_mfma_f32_16x16x32_bf16 v[132:135], v[20:23], a[100:103], v[132:135]
ds_read_b64_tr_b16 v[18:19], v15 offset:4736
s_barrier
v_mfma_f32_16x16x32_bf16 v[136:139], v[20:23], a[104:107], v[136:139]
buffer_load_dwordx4 v1, s[48:51], s40 offen offset:0 lds
v_mfma_f32_16x16x32_bf16 v[140:143], v[20:23], a[108:111], v[140:143]
s_waitcnt lgkmcnt(2)
v_mfma_f32_16x16x32_bf16 v[144:147], v[24:27], a[96:99], v[144:147]
ds_read_b64_tr_b16 v[20:21], v15 offset:160
v_mfma_f32_16x16x32_bf16 v[148:151], v[24:27], a[100:103], v[148:151]
ds_read_b64_tr_b16 v[22:23], v15 offset:4768
v_mfma_f32_16x16x32_bf16 v[152:155], v[24:27], a[104:107], v[152:155]
buffer_load_dwordx4 a[212:215], v9, s[8:11], s41 offen offset:1024 sc1
v_mfma_f32_16x16x32_bf16 v[156:159], v[24:27], a[108:111], v[156:159]
v_mfma_f32_16x16x32_bf16 v[160:163], v[28:31], a[96:99], v[160:163]
ds_read_b64_tr_b16 v[24:25], v15 offset:192
v_mfma_f32_16x16x32_bf16 v[164:167], v[28:31], a[100:103], v[164:167]
ds_read_b64_tr_b16 v[26:27], v15 offset:4800
v_mfma_f32_16x16x32_bf16 v[168:171], v[28:31], a[104:107], v[168:171]
v_mfma_f32_16x16x32_bf16 v[172:175], v[28:31], a[108:111], v[172:175]
s_waitcnt lgkmcnt(2)
v_mfma_f32_16x16x32_bf16 v[176:179], v[16:19], a[96:99], v[176:179]
ds_read_b64_tr_b16 v[28:29], v15 offset:224
v_mfma_f32_16x16x32_bf16 v[180:183], v[16:19], a[100:103], v[180:183]
ds_read_b64_tr_b16 v[30:31], v15 offset:4832
v_mfma_f32_16x16x32_bf16 v[184:187], v[16:19], a[104:107], v[184:187]
buffer_load_dwordx4 a[216:219], v9, s[8:11], s41 offen offset:2048 sc1
v_mfma_f32_16x16x32_bf16 v[188:191], v[16:19], a[108:111], v[188:191]
buffer_load_dwordx4 v2, s[48:51], s40 offen offset:1024 lds
v_mfma_f32_16x16x32_bf16 v[192:195], v[20:23], a[96:99], v[192:195]
ds_read_b64_tr_b16 v[16:17], v15 offset:256
v_mfma_f32_16x16x32_bf16 v[196:199], v[20:23], a[100:103], v[196:199]
ds_read_b64_tr_b16 v[18:19], v15 offset:4864
v_mfma_f32_16x16x32_bf16 v[200:203], v[20:23], a[104:107], v[200:203]
v_mfma_f32_16x16x32_bf16 v[204:207], v[20:23], a[108:111], v[204:207]
s_waitcnt lgkmcnt(2)
v_mfma_f32_16x16x32_bf16 v[208:211], v[24:27], a[96:99], v[208:211]
ds_read_b64_tr_b16 v[20:21], v15 offset:9216
v_mfma_f32_16x16x32_bf16 v[212:215], v[24:27], a[100:103], v[212:215]
ds_read_b64_tr_b16 v[22:23], v15 offset:13824
v_mfma_f32_16x16x32_bf16 v[216:219], v[24:27], a[104:107], v[216:219]
buffer_load_dwordx4 a[220:223], v9, s[8:11], s41 offen offset:3072 sc1
v_mfma_f32_16x16x32_bf16 v[220:223], v[24:27], a[108:111], v[220:223]
v_mfma_f32_16x16x32_bf16 v[224:227], v[28:31], a[96:99], v[224:227]
ds_read_b64_tr_b16 v[24:25], v15 offset:9248
v_mfma_f32_16x16x32_bf16 v[228:231], v[28:31], a[100:103], v[228:231]
ds_read_b64_tr_b16 v[26:27], v15 offset:13856
v_mfma_f32_16x16x32_bf16 v[232:235], v[28:31], a[104:107], v[232:235]
s_add_u32 s41, s68, 1
s_and_b32 s41, s41, 3
s_add_u32 s41, s41, s75
v_mfma_f32_16x16x32_bf16 v[236:239], v[28:31], a[108:111], v[236:239]
s_lshl_b32 s41, s41, 14
s_add_u32 s41, s41, s61
s_waitcnt lgkmcnt(2)
v_mfma_f32_16x16x32_bf16 v[240:243], v[16:19], a[96:99], v[240:243]
ds_read_b64_tr_b16 v[28:29], v15 offset:9280
s_add_u32 s41, s41, 12288
v_mfma_f32_16x16x32_bf16 v[244:247], v[16:19], a[100:103], v[244:247]
ds_read_b64_tr_b16 v[30:31], v15 offset:13888
v_mfma_f32_16x16x32_bf16 v[248:251], v[16:19], a[104:107], v[248:251]
buffer_load_dwordx4 a[224:227], v9, s[8:11], s41 offen offset:0 sc1
v_mfma_f32_16x16x32_bf16 v[252:255], v[16:19], a[108:111], v[252:255]
buffer_load_dwordx4 v3, s[48:51], s40 offen offset:2048 lds
s_waitcnt vmcnt(34)
v_mfma_f32_16x16x32_bf16 v[112:115], v[20:23], a[112:115], v[112:115]
ds_read_b64_tr_b16 v[16:17], v15 offset:9312
v_mfma_f32_16x16x32_bf16 v[116:119], v[20:23], a[116:119], v[116:119]
ds_read_b64_tr_b16 v[18:19], v15 offset:13920
v_mfma_f32_16x16x32_bf16 v[120:123], v[20:23], a[120:123], v[120:123]
v_mfma_f32_16x16x32_bf16 v[124:127], v[20:23], a[124:127], v[124:127]
s_waitcnt lgkmcnt(2)
v_mfma_f32_16x16x32_bf16 v[128:131], v[24:27], a[112:115], v[128:131]
ds_read_b64_tr_b16 v[20:21], v15 offset:9344
v_mfma_f32_16x16x32_bf16 v[132:135], v[24:27], a[116:119], v[132:135]
ds_read_b64_tr_b16 v[22:23], v15 offset:13952
v_mfma_f32_16x16x32_bf16 v[136:139], v[24:27], a[120:123], v[136:139]
buffer_load_dwordx4 a[228:231], v9, s[8:11], s41 offen offset:1024 sc1
v_mfma_f32_16x16x32_bf16 v[140:143], v[24:27], a[124:127], v[140:143]
v_mfma_f32_16x16x32_bf16 v[144:147], v[28:31], a[112:115], v[144:147]
ds_read_b64_tr_b16 v[24:25], v15 offset:9376
v_mfma_f32_16x16x32_bf16 v[148:151], v[28:31], a[116:119], v[148:151]
ds_read_b64_tr_b16 v[26:27], v15 offset:13984
v_mfma_f32_16x16x32_bf16 v[152:155], v[28:31], a[120:123], v[152:155]
v_mfma_f32_16x16x32_bf16 v[156:159], v[28:31], a[124:127], v[156:159]
buffer_load_dwordx4 v8, s[48:51], s40 offen offset:3072 lds
s_waitcnt lgkmcnt(2)
v_mfma_f32_16x16x32_bf16 v[160:163], v[16:19], a[112:115], v[160:163]
ds_read_b64_tr_b16 v[28:29], v15 offset:9408
v_mfma_f32_16x16x32_bf16 v[164:167], v[16:19], a[116:119], v[164:167]
ds_read_b64_tr_b16 v[30:31], v15 offset:14016
v_mfma_f32_16x16x32_bf16 v[168:171], v[16:19], a[120:123], v[168:171]
buffer_load_dwordx4 a[232:235], v9, s[8:11], s41 offen offset:2048 sc1
v_mfma_f32_16x16x32_bf16 v[172:175], v[16:19], a[124:127], v[172:175]
v_mfma_f32_16x16x32_bf16 v[176:179], v[20:23], a[112:115], v[176:179]
ds_read_b64_tr_b16 v[16:17], v15 offset:9440
v_mfma_f32_16x16x32_bf16 v[180:183], v[20:23], a[116:119], v[180:183]
ds_read_b64_tr_b16 v[18:19], v15 offset:14048
v_mfma_f32_16x16x32_bf16 v[184:187], v[20:23], a[120:123], v[184:187]
v_mfma_f32_16x16x32_bf16 v[188:191], v[20:23], a[124:127], v[188:191]
s_waitcnt lgkmcnt(2)
v_mfma_f32_16x16x32_bf16 v[192:195], v[24:27], a[112:115], v[192:195]
ds_read_b64_tr_b16 v[20:21], v15 offset:9472
v_mfma_f32_16x16x32_bf16 v[196:199], v[24:27], a[116:119], v[196:199]
ds_read_b64_tr_b16 v[22:23], v15 offset:14080
v_mfma_f32_16x16x32_bf16 v[200:203], v[24:27], a[120:123], v[200:203]
buffer_load_dwordx4 a[236:239], v9, s[8:11], s41 offen offset:3072 sc1
s_add_u32 m0, s47, 77824
v_mfma_f32_16x16x32_bf16 v[204:207], v[24:27], a[124:127], v[204:207]
v_mfma_f32_16x16x32_bf16 v[208:211], v[28:31], a[112:115], v[208:211]
ds_read_b64_tr_b16 v[24:25], v15 offset:18432
v_mfma_f32_16x16x32_bf16 v[212:215], v[28:31], a[116:119], v[212:215]
ds_read_b64_tr_b16 v[26:27], v15 offset:23040
v_mfma_f32_16x16x32_bf16 v[216:219], v[28:31], a[120:123], v[216:219]
buffer_load_dwordx4 v10, s[48:51], s40 offen offset:0 lds
s_add_u32 s41, s68, 2
s_and_b32 s41, s41, 3
v_mfma_f32_16x16x32_bf16 v[220:223], v[28:31], a[124:127], v[220:223]
s_add_u32 s41, s41, s75
s_lshl_b32 s41, s41, 14
s_waitcnt lgkmcnt(2)
v_mfma_f32_16x16x32_bf16 v[224:227], v[16:19], a[112:115], v[224:227]
ds_read_b64_tr_b16 v[28:29], v15 offset:18464
s_add_u32 s41, s41, s61
v_mfma_f32_16x16x32_bf16 v[228:231], v[16:19], a[116:119], v[228:231]
ds_read_b64_tr_b16 v[30:31], v15 offset:23072
v_mfma_f32_16x16x32_bf16 v[232:235], v[16:19], a[120:123], v[232:235]
buffer_load_dwordx4 a[240:243], v9, s[8:11], s41 offen offset:0 sc1
v_mfma_f32_16x16x32_bf16 v[236:239], v[16:19], a[124:127], v[236:239]
v_mfma_f32_16x16x32_bf16 v[240:243], v[20:23], a[112:115], v[240:243]
ds_read_b64_tr_b16 v[16:17], v15 offset:18496
v_mfma_f32_16x16x32_bf16 v[244:247], v[20:23], a[116:119], v[244:247]
ds_read_b64_tr_b16 v[18:19], v15 offset:23104
v_mfma_f32_16x16x32_bf16 v[248:251], v[20:23], a[120:123], v[248:251]
v_mfma_f32_16x16x32_bf16 v[252:255], v[20:23], a[124:127], v[252:255]
s_waitcnt lgkmcnt(2)
s_waitcnt vmcnt(33)
v_mfma_f32_16x16x32_bf16 v[112:115], v[24:27], a[128:131], v[112:115]
ds_read_b64_tr_b16 v[20:21], v15 offset:18528
v_mfma_f32_16x16x32_bf16 v[116:119], v[24:27], a[132:135], v[116:119]
ds_read_b64_tr_b16 v[22:23], v15 offset:23136
v_mfma_f32_16x16x32_bf16 v[120:123], v[24:27], a[136:139], v[120:123]
buffer_load_dwordx4 a[244:247], v9, s[8:11], s41 offen offset:1024 sc1
v_mfma_f32_16x16x32_bf16 v[124:127], v[24:27], a[140:143], v[124:127]
buffer_load_dwordx4 v11, s[48:51], s40 offen offset:1024 lds
v_mfma_f32_16x16x32_bf16 v[128:131], v[28:31], a[128:131], v[128:131]
ds_read_b64_tr_b16 v[24:25], v15 offset:18560
v_mfma_f32_16x16x32_bf16 v[132:135], v[28:31], a[132:135], v[132:135]
ds_read_b64_tr_b16 v[26:27], v15 offset:23168
v_mfma_f32_16x16x32_bf16 v[136:139], v[28:31], a[136:139], v[136:139]
v_mfma_f32_16x16x32_bf16 v[140:143], v[28:31], a[140:143], v[140:143]
s_waitcnt lgkmcnt(2)
v_mfma_f32_16x16x32_bf16 v[144:147], v[16:19], a[128:131], v[144:147]
ds_read_b64_tr_b16 v[28:29], v15 offset:18592
v_mfma_f32_16x16x32_bf16 v[148:151], v[16:19], a[132:135], v[148:151]
ds_read_b64_tr_b16 v[30:31], v15 offset:23200
v_mfma_f32_16x16x32_bf16 v[152:155], v[16:19], a[136:139], v[152:155]
buffer_load_dwordx4 a[248:251], v9, s[8:11], s41 offen offset:2048 sc1
v_mfma_f32_16x16x32_bf16 v[156:159], v[16:19], a[140:143], v[156:159]
v_mfma_f32_16x16x32_bf16 v[160:163], v[20:23], a[128:131], v[160:163]
ds_read_b64_tr_b16 v[16:17], v15 offset:18624
v_mfma_f32_16x16x32_bf16 v[164:167], v[20:23], a[132:135], v[164:167]
ds_read_b64_tr_b16 v[18:19], v15 offset:23232
v_mfma_f32_16x16x32_bf16 v[168:171], v[20:23], a[136:139], v[168:171]
v_mfma_f32_16x16x32_bf16 v[172:175], v[20:23], a[140:143], v[172:175]
s_waitcnt lgkmcnt(2)
v_mfma_f32_16x16x32_bf16 v[176:179], v[24:27], a[128:131], v[176:179]
ds_read_b64_tr_b16 v[20:21], v15 offset:18656
v_mfma_f32_16x16x32_bf16 v[180:183], v[24:27], a[132:135], v[180:183]
ds_read_b64_tr_b16 v[22:23], v15 offset:23264
v_mfma_f32_16x16x32_bf16 v[184:187], v[24:27], a[136:139], v[184:187]
buffer_load_dwordx4 a[252:255], v9, s[8:11], s41 offen offset:3072 sc1
v_mfma_f32_16x16x32_bf16 v[188:191], v[24:27], a[140:143], v[188:191]
buffer_load_dwordx4 v12, s[48:51], s40 offen offset:2048 lds
v_mfma_f32_16x16x32_bf16 v[192:195], v[28:31], a[128:131], v[192:195]
ds_read_b64_tr_b16 v[24:25], v15 offset:18688
v_mfma_f32_16x16x32_bf16 v[196:199], v[28:31], a[132:135], v[196:199]
ds_read_b64_tr_b16 v[26:27], v15 offset:23296
v_mfma_f32_16x16x32_bf16 v[200:203], v[28:31], a[136:139], v[200:203]
s_add_u32 s41, s68, 2
s_and_b32 s41, s41, 3
s_add_u32 s41, s41, s75
v_mfma_f32_16x16x32_bf16 v[204:207], v[28:31], a[140:143], v[204:207]
s_lshl_b32 s41, s41, 14
s_add_u32 s41, s41, s61
s_waitcnt lgkmcnt(2)
v_mfma_f32_16x16x32_bf16 v[208:211], v[16:19], a[128:131], v[208:211]
ds_read_b64_tr_b16 v[28:29], v15 offset:27648
s_add_u32 s41, s41, 4096
v_mfma_f32_16x16x32_bf16 v[212:215], v[16:19], a[132:135], v[212:215]
ds_read_b64_tr_b16 v[30:31], v15 offset:32256
v_mfma_f32_16x16x32_bf16 v[216:219], v[16:19], a[136:139], v[216:219]
buffer_load_dwordx4 a[0:3], v9, s[8:11], s41 offen offset:0 sc1
v_mfma_f32_16x16x32_bf16 v[220:223], v[16:19], a[140:143], v[220:223]
v_mfma_f32_16x16x32_bf16 v[224:227], v[20:23], a[128:131], v[224:227]
ds_read_b64_tr_b16 v[16:17], v15 offset:27680
v_mfma_f32_16x16x32_bf16 v[228:231], v[20:23], a[132:135], v[228:231]
ds_read_b64_tr_b16 v[18:19], v15 offset:32288
v_mfma_f32_16x16x32_bf16 v[232:235], v[20:23], a[136:139], v[232:235]
v_mfma_f32_16x16x32_bf16 v[236:239], v[20:23], a[140:143], v[236:239]
buffer_load_dwordx4 v13, s[48:51], s40 offen offset:3072 lds
s_waitcnt lgkmcnt(2)
v_mfma_f32_16x16x32_bf16 v[240:243], v[24:27], a[128:131], v[240:243]
ds_read_b64_tr_b16 v[20:21], v15 offset:27712
v_mfma_f32_16x16x32_bf16 v[244:247], v[24:27], a[132:135], v[244:247]
ds_read_b64_tr_b16 v[22:23], v15 offset:32320
v_mfma_f32_16x16x32_bf16 v[248:251], v[24:27], a[136:139], v[248:251]
buffer_load_dwordx4 a[4:7], v9, s[8:11], s41 offen offset:1024 sc1
v_mfma_f32_16x16x32_bf16 v[252:255], v[24:27], a[140:143], v[252:255]
s_waitcnt vmcnt(35)
v_mfma_f32_16x16x32_bf16 v[112:115], v[28:31], a[160:163], v[112:115]
ds_read_b64_tr_b16 v[24:25], v15 offset:27744
v_mfma_f32_16x16x32_bf16 v[116:119], v[28:31], a[164:167], v[116:119]
ds_read_b64_tr_b16 v[26:27], v15 offset:32352
v_mfma_f32_16x16x32_bf16 v[120:123], v[28:31], a[168:171], v[120:123]
v_mfma_f32_16x16x32_bf16 v[124:127], v[28:31], a[172:175], v[124:127]
s_waitcnt lgkmcnt(2)
v_mfma_f32_16x16x32_bf16 v[128:131], v[16:19], a[160:163], v[128:131]
ds_read_b64_tr_b16 v[28:29], v15 offset:27776
v_mfma_f32_16x16x32_bf16 v[132:135], v[16:19], a[164:167], v[132:135]
ds_read_b64_tr_b16 v[30:31], v15 offset:32384
v_mfma_f32_16x16x32_bf16 v[136:139], v[16:19], a[168:171], v[136:139]
buffer_load_dwordx4 a[8:11], v9, s[8:11], s41 offen offset:2048 sc1
s_add_u32 m0, s47, 81920
v_mfma_f32_16x16x32_bf16 v[140:143], v[16:19], a[172:175], v[140:143]
v_mfma_f32_16x16x32_bf16 v[144:147], v[20:23], a[160:163], v[144:147]
ds_read_b64_tr_b16 v[16:17], v15 offset:27808
v_mfma_f32_16x16x32_bf16 v[148:151], v[20:23], a[164:167], v[148:151]
ds_read_b64_tr_b16 v[18:19], v15 offset:32416
v_mfma_f32_16x16x32_bf16 v[152:155], v[20:23], a[168:171], v[152:155]
buffer_load_dwordx4 v14, s[48:51], s40 offen offset:0 lds
v_mfma_f32_16x16x32_bf16 v[156:159], v[20:23], a[172:175], v[156:159]
s_waitcnt lgkmcnt(2)
v_mfma_f32_16x16x32_bf16 v[160:163], v[24:27], a[160:163], v[160:163]
ds_read_b64_tr_b16 v[20:21], v15 offset:27840
v_mfma_f32_16x16x32_bf16 v[164:167], v[24:27], a[164:167], v[164:167]
ds_read_b64_tr_b16 v[22:23], v15 offset:32448
v_mfma_f32_16x16x32_bf16 v[168:171], v[24:27], a[168:171], v[168:171]
buffer_load_dwordx4 a[12:15], v9, s[8:11], s41 offen offset:3072 sc1
v_mfma_f32_16x16x32_bf16 v[172:175], v[24:27], a[172:175], v[172:175]
v_mfma_f32_16x16x32_bf16 v[176:179], v[28:31], a[160:163], v[176:179]
ds_read_b64_tr_b16 v[24:25], v15 offset:27872
v_mfma_f32_16x16x32_bf16 v[180:183], v[28:31], a[164:167], v[180:183]
ds_read_b64_tr_b16 v[26:27], v15 offset:32480
v_mfma_f32_16x16x32_bf16 v[184:187], v[28:31], a[168:171], v[184:187]
s_add_u32 s41, s68, 2
s_and_b32 s41, s41, 3
s_add_u32 s41, s41, s75
v_mfma_f32_16x16x32_bf16 v[188:191], v[28:31], a[172:175], v[188:191]
s_lshl_b32 s41, s41, 14
s_add_u32 s41, s41, s61
s_waitcnt lgkmcnt(2)
v_mfma_f32_16x16x32_bf16 v[192:195], v[16:19], a[160:163], v[192:195]
ds_read_b64_tr_b16 v[28:29], v15 offset:27904
s_add_u32 s41, s41, 8192
s_add_u32 m0, s47, 110592
v_mfma_f32_16x16x32_bf16 v[196:199], v[16:19], a[164:167], v[196:199]
ds_read_b64_tr_b16 v[30:31], v15 offset:32512
s_add_u32 s40, s68, 3
s_and_b32 s40, s40, 3
v_mfma_f32_16x16x32_bf16 v[200:203], v[16:19], a[168:171], v[200:203]
buffer_load_dwordx4 a[16:19], v9, s[8:11], s41 offen offset:0 sc1
s_add_u32 s40, s40, s75
s_mul_i32 s40, s40, 147456
v_mfma_f32_16x16x32_bf16 v[204:207], v[16:19], a[172:175], v[204:207]
v_add_u32 v15, 0x9000, v15
s_add_u32 s40, s40, s60
v_mfma_f32_16x16x32_bf16 v[208:211], v[20:23], a[160:163], v[208:211]
s_waitcnt vmcnt(27)
s_barrier
ds_read_b64_tr_b16 v[16:17], v15 offset:0
v_mfma_f32_16x16x32_bf16 v[212:215], v[20:23], a[164:167], v[212:215]
ds_read_b64_tr_b16 v[18:19], v15 offset:4608
v_mfma_f32_16x16x32_bf16 v[216:219], v[20:23], a[168:171], v[216:219]
buffer_load_dwordx4 v1, s[48:51], s40 offen offset:0 lds
v_mfma_f32_16x16x32_bf16 v[220:223], v[20:23], a[172:175], v[220:223]
s_waitcnt lgkmcnt(2)
v_mfma_f32_16x16x32_bf16 v[224:227], v[24:27], a[160:163], v[224:227]
ds_read_b64_tr_b16 v[20:21], v15 offset:32
v_mfma_f32_16x16x32_bf16 v[228:231], v[24:27], a[164:167], v[228:231]
ds_read_b64_tr_b16 v[22:23], v15 offset:4640
v_mfma_f32_16x16x32_bf16 v[232:235], v[24:27], a[168:171], v[232:235]
buffer_load_dwordx4 a[20:23], v9, s[8:11], s41 offen offset:1024 sc1
v_mfma_f32_16x16x32_bf16 v[236:239], v[24:27], a[172:175], v[236:239]
v_mfma_f32_16x16x32_bf16 v[240:243], v[28:31], a[160:163], v[240:243]
ds_read_b64_tr_b16 v[24:25], v15 offset:64
v_mfma_f32_16x16x32_bf16 v[244:247], v[28:31], a[164:167], v[244:247]
ds_read_b64_tr_b16 v[26:27], v15 offset:4672
v_mfma_f32_16x16x32_bf16 v[248:251], v[28:31], a[168:171], v[248:251]
v_mfma_f32_16x16x32_bf16 v[252:255], v[28:31], a[172:175], v[252:255]
mk_LS_W5:
s_waitcnt lgkmcnt(2)
v_mfma_f32_16x16x32_bf16 v[112:115], v[16:19], a[176:179], v[112:115]
ds_read_b64_tr_b16 v[28:29], v15 offset:96
v_mfma_f32_16x16x32_bf16 v[116:119], v[16:19], a[180:183], v[116:119]
ds_read_b64_tr_b16 v[30:31], v15 offset:4704
v_mfma_f32_16x16x32_bf16 v[120:123], v[16:19], a[184:187], v[120:123]
buffer_load_dwordx4 a[24:27], v9, s[8:11], s41 offen offset:2048 sc1
v_mfma_f32_16x16x32_bf16 v[124:127], v[16:19], a[188:191], v[124:127]
buffer_load_dwordx4 v2, s[48:51], s40 offen offset:1024 lds
v_mfma_f32_16x16x32_bf16 v[128:131], v[20:23], a[176:179], v[128:131]
ds_read_b64_tr_b16 v[16:17], v15 offset:128
v_mfma_f32_16x16x32_bf16 v[132:135], v[20:23], a[180:183], v[132:135]
ds_read_b64_tr_b16 v[18:19], v15 offset:4736
s_barrier
v_mfma_f32_16x16x32_bf16 v[136:139], v[20:23], a[184:187], v[136:139]
v_mfma_f32_16x16x32_bf16 v[140:143], v[20:23], a[188:191], v[140:143]
s_waitcnt lgkmcnt(2)
v_mfma_f32_16x16x32_bf16 v[144:147], v[24:27], a[176:179], v[144:147]
ds_read_b64_tr_b16 v[20:21], v15 offset:160
v_mfma_f32_16x16x32_bf16 v[148:151], v[24:27], a[180:183], v[148:151]
ds_read_b64_tr_b16 v[22:23], v15 offset:4768
v_mfma_f32_16x16x32_bf16 v[152:155], v[24:27], a[184:187], v[152:155]
buffer_load_dwordx4 a[28:31], v9, s[8:11], s41 offen offset:3072 sc1
v_mfma_f32_16x16x32_bf16 v[156:159], v[24:27], a[188:191], v[156:159]
v_mfma_f32_16x16x32_bf16 v[160:163], v[28:31], a[176:179], v[160:163]
ds_read_b64_tr_b16 v[24:25], v15 offset:192
v_mfma_f32_16x16x32_bf16 v[164:167], v[28:31], a[180:183], v[164:167]
ds_read_b64_tr_b16 v[26:27], v15 offset:4800
v_mfma_f32_16x16x32_bf16 v[168:171], v[28:31], a[184:187], v[168:171]
s_add_u32 s41, s68, 2
s_and_b32 s41, s41, 3
s_add_u32 s41, s41, s75
v_mfma_f32_16x16x32_bf16 v[172:175], v[28:31], a[188:191], v[172:175]
buffer_load_dwordx4 v3, s[48:51], s40 offen offset:2048 lds
s_lshl_b32 s41, s41, 14
s_waitcnt lgkmcnt(2)
v_mfma_f32_16x16x32_bf16 v[176:179], v[16:19], a[176:179], v[176:179]
ds_read_b64_tr_b16 v[28:29], v15 offset:224
s_add_u32 s41, s41, s61
s_add_u32 s41, s41, 12288
v_mfma_f32_16x16x32_bf16 v[180:183], v[16:19], a[180:183], v[180:183]
ds_read_b64_tr_b16 v[30:31], v15 offset:4832
v_mfma_f32_16x16x32_bf16 v[184:187], v[16:19], a[184:187], v[184:187]
buffer_load_dwordx4 a[32:35], v9, s[8:11], s41 offen offset:0 sc1
v_mfma_f32_16x16x32_bf16 v[188:191], v[16:19], a[188:191], v[188:191]
v_mfma_f32_16x16x32_bf16 v[192:195], v[20:23], a[176:179], v[192:195]
ds_read_b64_tr_b16 v[16:17], v15 offset:256
v_mfma_f32_16x16x32_bf16 v[196:199], v[20:23], a[180:183], v[196:199]
ds_read_b64_tr_b16 v[18:19], v15 offset:4864
v_mfma_f32_16x16x32_bf16 v[200:203], v[20:23], a[184:187], v[200:203]
v_mfma_f32_16x16x32_bf16 v[204:207], v[20:23], a[188:191], v[204:207]
s_waitcnt lgkmcnt(2)
v_mfma_f32_16x16x32_bf16 v[208:211], v[24:27], a[176:179], v[208:211]
ds_read_b64_tr_b16 v[20:21], v15 offset:9216
v_mfma_f32_16x16x32_bf16 v[212:215], v[24:27], a[180:183], v[212:215]
ds_read_b64_tr_b16 v[22:23], v15 offset:13824
v_mfma_f32_16x16x32_bf16 v[216:219], v[24:27], a[184:187], v[216:219]
buffer_load_dwordx4 a[36:39], v9, s[8:11], s41 offen offset:1024 sc1
v_mfma_f32_16x16x32_bf16 v[220:223], v[24:27], a[188:191], v[220:223]
v_mfma_f32_16x16x32_bf16 v[224:227], v[28:31], a[176:179], v[224:227]
ds_read_b64_tr_b16 v[24:25], v15 offset:9248
v_mfma_f32_16x16x32_bf16 v[228:231], v[28:31], a[180:183], v[228:231]
ds_read_b64_tr_b16 v[26:27], v15 offset:13856
v_mfma_f32_16x16x32_bf16 v[232:235], v[28:31], a[184:187], v[232:235]
buffer_load_dwordx4 v8, s[48:51], s40 offen offset:3072 lds
v_mfma_f32_16x16x32_bf16 v[236:239], v[28:31], a[188:191], v[236:239]
s_waitcnt lgkmcnt(2)
v_mfma_f32_16x16x32_bf16 v[240:243], v[16:19], a[176:179], v[240:243]
ds_read_b64_tr_b16 v[28:29], v15 offset:9280
v_mfma_f32_16x16x32_bf16 v[244:247], v[16:19], a[180:183], v[244:247]
ds_read_b64_tr_b16 v[30:31], v15 offset:13888
v_mfma_f32_16x16x32_bf16 v[248:251], v[16:19], a[184:187], v[248:251]
buffer_load_dwordx4 a[40:43], v9, s[8:11], s41 offen offset:2048 sc1
v_mfma_f32_16x16x32_bf16 v[252:255], v[16:19], a[188:191], v[252:255]
s_waitcnt vmcnt(36)
v_mfma_f32_16x16x32_bf16 v[112:115], v[20:23], a[192:195], v[112:115]
ds_read_b64_tr_b16 v[16:17], v15 offset:9312
v_mfma_f32_16x16x32_bf16 v[116:119], v[20:23], a[196:199], v[116:119]
ds_read_b64_tr_b16 v[18:19], v15 offset:13920
v_mfma_f32_16x16x32_bf16 v[120:123], v[20:23], a[200:203], v[120:123]
v_mfma_f32_16x16x32_bf16 v[124:127], v[20:23], a[204:207], v[124:127]
s_waitcnt lgkmcnt(2)
v_mfma_f32_16x16x32_bf16 v[128:131], v[24:27], a[192:195], v[128:131]
ds_read_b64_tr_b16 v[20:21], v15 offset:9344
s_add_u32 m0, s47, 114688
v_mfma_f32_16x16x32_bf16 v[132:135], v[24:27], a[196:199], v[132:135]
ds_read_b64_tr_b16 v[22:23], v15 offset:13952
v_mfma_f32_16x16x32_bf16 v[136:139], v[24:27], a[200:203], v[136:139]
buffer_load_dwordx4 a[44:47], v9, s[8:11], s41 offen offset:3072 sc1
v_mfma_f32_16x16x32_bf16 v[140:143], v[24:27], a[204:207], v[140:143]
buffer_load_dwordx4 v10, s[48:51], s40 offen offset:0 lds
v_mfma_f32_16x16x32_bf16 v[144:147], v[28:31], a[192:195], v[144:147]
ds_read_b64_tr_b16 v[24:25], v15 offset:9376
v_mfma_f32_16x16x32_bf16 v[148:151], v[28:31], a[196:199], v[148:151]
ds_read_b64_tr_b16 v[26:27], v15 offset:13984
v_mfma_f32_16x16x32_bf16 v[152:155], v[28:31], a[200:203], v[152:155]
s_add_u32 s41, s68, 3
s_and_b32 s41, s41, 3
s_add_u32 s41, s41, s75
v_mfma_f32_16x16x32_bf16 v[156:159], v[28:31], a[204:207], v[156:159]
s_lshl_b32 s41, s41, 14
s_add_u32 s41, s41, s61
s_waitcnt lgkmcnt(2)
v_mfma_f32_16x16x32_bf16 v[160:163], v[16:19], a[192:195], v[160:163]
ds_read_b64_tr_b16 v[28:29], v15 offset:9408
v_mfma_f32_16x16x32_bf16 v[164:167], v[16:19], a[196:199], v[164:167]
ds_read_b64_tr_b16 v[30:31], v15 offset:14016
v_mfma_f32_16x16x32_bf16 v[168:171], v[16:19], a[200:203], v[168:171]
buffer_load_dwordx4 a[48:51], v9, s[8:11], s41 offen offset:0 sc1
v_mfma_f32_16x16x32_bf16 v[172:175], v[16:19], a[204:207], v[172:175]
v_mfma_f32_16x16x32_bf16 v[176:179], v[20:23], a[192:195], v[176:179]
ds_read_b64_tr_b16 v[16:17], v15 offset:9440
v_mfma_f32_16x16x32_bf16 v[180:183], v[20:23], a[196:199], v[180:183]
ds_read_b64_tr_b16 v[18:19], v15 offset:14048
v_mfma_f32_16x16x32_bf16 v[184:187], v[20:23], a[200:203], v[184:187]
v_mfma_f32_16x16x32_bf16 v[188:191], v[20:23], a[204:207], v[188:191]
s_waitcnt lgkmcnt(2)
v_mfma_f32_16x16x32_bf16 v[192:195], v[24:27], a[192:195], v[192:195]
ds_read_b64_tr_b16 v[20:21], v15 offset:9472
v_mfma_f32_16x16x32_bf16 v[196:199], v[24:27], a[196:199], v[196:199]
ds_read_b64_tr_b16 v[22:23], v15 offset:14080
v_mfma_f32_16x16x32_bf16 v[200:203], v[24:27], a[200:203], v[200:203]
buffer_load_dwordx4 a[52:55], v9, s[8:11], s41 offen offset:1024 sc1
v_mfma_f32_16x16x32_bf16 v[204:207], v[24:27], a[204:207], v[204:207]
buffer_load_dwordx4 v11, s[48:51], s40 offen offset:1024 lds
v_mfma_f32_16x16x32_bf16 v[208:211], v[28:31], a[192:195], v[208:211]
ds_read_b64_tr_b16 v[24:25], v15 offset:18432
v_mfma_f32_16x16x32_bf16 v[212:215], v[28:31], a[196:199], v[212:215]
ds_read_b64_tr_b16 v[26:27], v15 offset:23040
v_mfma_f32_16x16x32_bf16 v[216:219], v[28:31], a[200:203], v[216:219]
v_mfma_f32_16x16x32_bf16 v[220:223], v[28:31], a[204:207], v[220:223]
s_waitcnt lgkmcnt(2)
v_mfma_f32_16x16x32_bf16 v[224:227], v[16:19], a[192:195], v[224:227]
ds_read_b64_tr_b16 v[28:29], v15 offset:18464
v_mfma_f32_16x16x32_bf16 v[228:231], v[16:19], a[196:199], v[228:231]
ds_read_b64_tr_b16 v[30:31], v15 offset:23072
v_mfma_f32_16x16x32_bf16 v[232:235], v[16:19], a[200:203], v[232:235]
buffer_load_dwordx4 a[56:59], v9, s[8:11], s41 offen offset:2048 sc1
v_mfma_f32_16x16x32_bf16 v[236:239], v[16:19], a[204:207], v[236:239]
v_mfma_f32_16x16x32_bf16 v[240:243], v[20:23], a[192:195], v[240:243]
ds_read_b64_tr_b16 v[16:17], v15 offset:18496
v_mfma_f32_16x16x32_bf16 v[244:247], v[20:23], a[196:199], v[244:247]
ds_read_b64_tr_b16 v[18:19], v15 offset:23104
v_mfma_f32_16x16x32_bf16 v[248:251], v[20:23], a[200:203], v[248:251]
v_mfma_f32_16x16x32_bf16 v[252:255], v[20:23], a[204:207], v[252:255]
buffer_load_dwordx4 v12, s[48:51], s40 offen offset:2048 lds
s_waitcnt lgkmcnt(2)
s_waitcnt vmcnt(37)
v_mfma_f32_16x16x32_bf16 v[112:115], v[24:27], a[208:211], v[112:115]
ds_read_b64_tr_b16 v[20:21], v15 offset:18528
v_mfma_f32_16x16x32_bf16 v[116:119], v[24:27], a[212:215], v[116:119]
ds_read_b64_tr_b16 v[22:23], v15 offset:23136
v_mfma_f32_16x16x32_bf16 v[120:123], v[24:27], a[216:219], v[120:123]
buffer_load_dwordx4 a[60:63], v9, s[8:11], s41 offen offset:3072 sc1
v_mfma_f32_16x16x32_bf16 v[124:127], v[24:27], a[220:223], v[124:127]
v_mfma_f32_16x16x32_bf16 v[128:131], v[28:31], a[208:211], v[128:131]
ds_read_b64_tr_b16 v[24:25], v15 offset:18560
v_mfma_f32_16x16x32_bf16 v[132:135], v[28:31], a[212:215], v[132:135]
ds_read_b64_tr_b16 v[26:27], v15 offset:23168
v_mfma_f32_16x16x32_bf16 v[136:139], v[28:31], a[216:219], v[136:139]
s_add_u32 s41, s68, 3
s_and_b32 s41, s41, 3
s_add_u32 s41, s41, s75
v_mfma_f32_16x16x32_bf16 v[140:143], v[28:31], a[220:223], v[140:143]
s_lshl_b32 s41, s41, 14
s_add_u32 s41, s41, s61
s_waitcnt lgkmcnt(2)
v_mfma_f32_16x16x32_bf16 v[144:147], v[16:19], a[208:211], v[144:147]
ds_read_b64_tr_b16 v[28:29], v15 offset:18592
s_add_u32 s41, s41, 4096
v_mfma_f32_16x16x32_bf16 v[148:151], v[16:19], a[212:215], v[148:151]
ds_read_b64_tr_b16 v[30:31], v15 offset:23200
v_mfma_f32_16x16x32_bf16 v[152:155], v[16:19], a[216:219], v[152:155]
buffer_load_dwordx4 a[64:67], v9, s[8:11], s41 offen offset:0 sc1
v_mfma_f32_16x16x32_bf16 v[156:159], v[16:19], a[220:223], v[156:159]
v_mfma_f32_16x16x32_bf16 v[160:163], v[20:23], a[208:211], v[160:163]
ds_read_b64_tr_b16 v[16:17], v15 offset:18624
v_mfma_f32_16x16x32_bf16 v[164:167], v[20:23], a[212:215], v[164:167]
ds_read_b64_tr_b16 v[18:19], v15 offset:23232
v_mfma_f32_16x16x32_bf16 v[168:171], v[20:23], a[216:219], v[168:171]
buffer_load_dwordx4 v13, s[48:51], s40 offen offset:3072 lds
v_mfma_f32_16x16x32_bf16 v[172:175], v[20:23], a[220:223], v[172:175]
s_waitcnt lgkmcnt(2)
v_mfma_f32_16x16x32_bf16 v[176:179], v[24:27], a[208:211], v[176:179]
ds_read_b64_tr_b16 v[20:21], v15 offset:18656
v_mfma_f32_16x16x32_bf16 v[180:183], v[24:27], a[212:215], v[180:183]
ds_read_b64_tr_b16 v[22:23], v15 offset:23264
v_mfma_f32_16x16x32_bf16 v[184:187], v[24:27], a[216:219], v[184:187]
buffer_load_dwordx4 a[68:71], v9, s[8:11], s41 offen offset:1024 sc1
v_mfma_f32_16x16x32_bf16 v[188:191], v[24:27], a[220:223], v[188:191]
v_mfma_f32_16x16x32_bf16 v[192:195], v[28:31], a[208:211], v[192:195]
ds_read_b64_tr_b16 v[24:25], v15 offset:18688
v_mfma_f32_16x16x32_bf16 v[196:199], v[28:31], a[212:215], v[196:199]
ds_read_b64_tr_b16 v[26:27], v15 offset:23296
v_mfma_f32_16x16x32_bf16 v[200:203], v[28:31], a[216:219], v[200:203]
v_mfma_f32_16x16x32_bf16 v[204:207], v[28:31], a[220:223], v[204:207]
s_waitcnt lgkmcnt(2)
v_mfma_f32_16x16x32_bf16 v[208:211], v[16:19], a[208:211], v[208:211]
ds_read_b64_tr_b16 v[28:29], v15 offset:27648
s_add_u32 m0, s47, 118784
v_mfma_f32_16x16x32_bf16 v[212:215], v[16:19], a[212:215], v[212:215]
ds_read_b64_tr_b16 v[30:31], v15 offset:32256
v_mfma_f32_16x16x32_bf16 v[216:219], v[16:19], a[216:219], v[216:219]
buffer_load_dwordx4 a[72:75], v9, s[8:11], s41 offen offset:2048 sc1
v_mfma_f32_16x16x32_bf16 v[220:223], v[16:19], a[220:223], v[220:223]
buffer_load_dwordx4 v14, s[48:51], s40 offen offset:0 lds
v_mfma_f32_16x16x32_bf16 v[224:227], v[20:23], a[208:211], v[224:227]
ds_read_b64_tr_b16 v[16:17], v15 offset:27680
v_mfma_f32_16x16x32_bf16 v[228:231], v[20:23], a[212:215], v[228:231]
ds_read_b64_tr_b16 v[18:19], v15 offset:32288
v_mfma_f32_16x16x32_bf16 v[232:235], v[20:23], a[216:219], v[232:235]
v_mfma_f32_16x16x32_bf16 v[236:239], v[20:23], a[220:223], v[236:239]
s_waitcnt lgkmcnt(2)
v_mfma_f32_16x16x32_bf16 v[240:243], v[24:27], a[208:211], v[240:243]
ds_read_b64_tr_b16 v[20:21], v15 offset:27712
v_mfma_f32_16x16x32_bf16 v[244:247], v[24:27], a[212:215], v[244:247]
ds_read_b64_tr_b16 v[22:23], v15 offset:32320
v_mfma_f32_16x16x32_bf16 v[248:251], v[24:27], a[216:219], v[248:251]
buffer_load_dwordx4 a[76:79], v9, s[8:11], s41 offen offset:3072 sc1
v_mfma_f32_16x16x32_bf16 v[252:255], v[24:27], a[220:223], v[252:255]
s_waitcnt vmcnt(38)
v_mfma_f32_16x16x32_bf16 v[112:115], v[28:31], a[224:227], v[112:115]
ds_read_b64_tr_b16 v[24:25], v15 offset:27744
v_mfma_f32_16x16x32_bf16 v[116:119], v[28:31], a[228:231], v[116:119]
ds_read_b64_tr_b16 v[26:27], v15 offset:32352
v_mfma_f32_16x16x32_bf16 v[120:123], v[28:31], a[232:235], v[120:123]
s_add_u32 s41, s68, 3
s_and_b32 s41, s41, 3
s_add_u32 s41, s41, s75
v_mfma_f32_16x16x32_bf16 v[124:127], v[28:31], a[236:239], v[124:127]
s_lshl_b32 s41, s41, 14
s_add_u32 s41, s41, s61
s_waitcnt lgkmcnt(2)
v_mfma_f32_16x16x32_bf16 v[128:131], v[16:19], a[224:227], v[128:131]
ds_read_b64_tr_b16 v[28:29], v15 offset:27776
s_add_u32 s41, s41, 8192
v_mfma_f32_16x16x32_bf16 v[132:135], v[16:19], a[228:231], v[132:135]
ds_read_b64_tr_b16 v[30:31], v15 offset:32384
v_mfma_f32_16x16x32_bf16 v[136:139], v[16:19], a[232:235], v[136:139]
buffer_load_dwordx4 a[80:83], v9, s[8:11], s41 offen offset:0 sc1
v_mfma_f32_16x16x32_bf16 v[140:143], v[16:19], a[236:239], v[140:143]
v_mfma_f32_16x16x32_bf16 v[144:147], v[20:23], a[224:227], v[144:147]
ds_read_b64_tr_b16 v[16:17], v15 offset:27808
v_mfma_f32_16x16x32_bf16 v[148:151], v[20:23], a[228:231], v[148:151]
ds_read_b64_tr_b16 v[18:19], v15 offset:32416
v_mfma_f32_16x16x32_bf16 v[152:155], v[20:23], a[232:235], v[152:155]
v_mfma_f32_16x16x32_bf16 v[156:159], v[20:23], a[236:239], v[156:159]
s_waitcnt lgkmcnt(2)
v_mfma_f32_16x16x32_bf16 v[160:163], v[24:27], a[224:227], v[160:163]
ds_read_b64_tr_b16 v[20:21], v15 offset:27840
v_mfma_f32_16x16x32_bf16 v[164:167], v[24:27], a[228:231], v[164:167]
ds_read_b64_tr_b16 v[22:23], v15 offset:32448
v_mfma_f32_16x16x32_bf16 v[168:171], v[24:27], a[232:235], v[168:171]
buffer_load_dwordx4 a[84:87], v9, s[8:11], s41 offen offset:1024 sc1
v_mfma_f32_16x16x32_bf16 v[172:175], v[24:27], a[236:239], v[172:175]
v_mfma_f32_16x16x32_bf16 v[176:179], v[28:31], a[224:227], v[176:179]
ds_read_b64_tr_b16 v[24:25], v15 offset:27872
v_mfma_f32_16x16x32_bf16 v[180:183], v[28:31], a[228:231], v[180:183]
ds_read_b64_tr_b16 v[26:27], v15 offset:32480
v_mfma_f32_16x16x32_bf16 v[184:187], v[28:31], a[232:235], v[184:187]
v_mfma_f32_16x16x32_bf16 v[188:191], v[28:31], a[236:239], v[188:191]
s_waitcnt lgkmcnt(2)
v_mfma_f32_16x16x32_bf16 v[192:195], v[16:19], a[224:227], v[192:195]
ds_read_b64_tr_b16 v[28:29], v15 offset:27904
v_mfma_f32_16x16x32_bf16 v[196:199], v[16:19], a[228:231], v[196:199]
ds_read_b64_tr_b16 v[30:31], v15 offset:32512
v_mfma_f32_16x16x32_bf16 v[200:203], v[16:19], a[232:235], v[200:203]
buffer_load_dwordx4 a[88:91], v9, s[8:11], s41 offen offset:2048 sc1
v_mfma_f32_16x16x32_bf16 v[204:207], v[16:19], a[236:239], v[204:207]
v_add_u32 v15, 0x9000, v15
v_mfma_f32_16x16x32_bf16 v[208:211], v[20:23], a[224:227], v[208:211]
s_waitcnt vmcnt(29)
s_barrier
ds_read_b64_tr_b16 v[16:17], v15 offset:0
v_mfma_f32_16x16x32_bf16 v[212:215], v[20:23], a[228:231], v[212:215]
ds_read_b64_tr_b16 v[18:19], v15 offset:4608
v_mfma_f32_16x16x32_bf16 v[216:219], v[20:23], a[232:235], v[216:219]
v_mfma_f32_16x16x32_bf16 v[220:223], v[20:23], a[236:239], v[220:223]
s_waitcnt lgkmcnt(2)
v_mfma_f32_16x16x32_bf16 v[224:227], v[24:27], a[224:227], v[224:227]
ds_read_b64_tr_b16 v[20:21], v15 offset:32
v_mfma_f32_16x16x32_bf16 v[228:231], v[24:27], a[228:231], v[228:231]
ds_read_b64_tr_b16 v[22:23], v15 offset:4640
v_mfma_f32_16x16x32_bf16 v[232:235], v[24:27], a[232:235], v[232:235]
buffer_load_dwordx4 a[92:95], v9, s[8:11], s41 offen offset:3072 sc1
v_mfma_f32_16x16x32_bf16 v[236:239], v[24:27], a[236:239], v[236:239]
v_mfma_f32_16x16x32_bf16 v[240:243], v[28:31], a[224:227], v[240:243]
ds_read_b64_tr_b16 v[24:25], v15 offset:64
v_mfma_f32_16x16x32_bf16 v[244:247], v[28:31], a[228:231], v[244:247]
ds_read_b64_tr_b16 v[26:27], v15 offset:4672
v_mfma_f32_16x16x32_bf16 v[248:251], v[28:31], a[232:235], v[248:251]
s_add_u32 s41, s68, 3
s_and_b32 s41, s41, 3
s_add_u32 s41, s41, s75
v_mfma_f32_16x16x32_bf16 v[252:255], v[28:31], a[236:239], v[252:255]
s_lshl_b32 s41, s41, 14
s_waitcnt lgkmcnt(2)
v_mfma_f32_16x16x32_bf16 v[112:115], v[16:19], a[240:243], v[112:115]
ds_read_b64_tr_b16 v[28:29], v15 offset:96
s_add_u32 s41, s41, s61
s_add_u32 s41, s41, 12288
v_mfma_f32_16x16x32_bf16 v[116:119], v[16:19], a[244:247], v[116:119]
ds_read_b64_tr_b16 v[30:31], v15 offset:4704
v_mfma_f32_16x16x32_bf16 v[120:123], v[16:19], a[248:251], v[120:123]
buffer_load_dwordx4 a[96:99], v9, s[8:11], s41 offen offset:0 sc1
v_mfma_f32_16x16x32_bf16 v[124:127], v[16:19], a[252:255], v[124:127]
v_mfma_f32_16x16x32_bf16 v[128:131], v[20:23], a[240:243], v[128:131]
ds_read_b64_tr_b16 v[16:17], v15 offset:128
v_mfma_f32_16x16x32_bf16 v[132:135], v[20:23], a[244:247], v[132:135]
ds_read_b64_tr_b16 v[18:19], v15 offset:4736
s_barrier
v_mfma_f32_16x16x32_bf16 v[136:139], v[20:23], a[248:251], v[136:139]
v_mfma_f32_16x16x32_bf16 v[140:143], v[20:23], a[252:255], v[140:143]
s_waitcnt lgkmcnt(2)
v_mfma_f32_16x16x32_bf16 v[144:147], v[24:27], a[240:243], v[144:147]
ds_read_b64_tr_b16 v[20:21], v15 offset:160
v_mfma_f32_16x16x32_bf16 v[148:151], v[24:27], a[244:247], v[148:151]
ds_read_b64_tr_b16 v[22:23], v15 offset:4768
v_mfma_f32_16x16x32_bf16 v[152:155], v[24:27], a[248:251], v[152:155]
buffer_load_dwordx4 a[100:103], v9, s[8:11], s41 offen offset:1024 sc1
v_mfma_f32_16x16x32_bf16 v[156:159], v[24:27], a[252:255], v[156:159]
v_mfma_f32_16x16x32_bf16 v[160:163], v[28:31], a[240:243], v[160:163]
ds_read_b64_tr_b16 v[24:25], v15 offset:192
v_mfma_f32_16x16x32_bf16 v[164:167], v[28:31], a[244:247], v[164:167]
ds_read_b64_tr_b16 v[26:27], v15 offset:4800
v_mfma_f32_16x16x32_bf16 v[168:171], v[28:31], a[248:251], v[168:171]
v_mfma_f32_16x16x32_bf16 v[172:175], v[28:31], a[252:255], v[172:175]
s_waitcnt lgkmcnt(2)
v_mfma_f32_16x16x32_bf16 v[176:179], v[16:19], a[240:243], v[176:179]
ds_read_b64_tr_b16 v[28:29], v15 offset:224
v_mfma_f32_16x16x32_bf16 v[180:183], v[16:19], a[244:247], v[180:183]
ds_read_b64_tr_b16 v[30:31], v15 offset:4832
v_mfma_f32_16x16x32_bf16 v[184:187], v[16:19], a[248:251], v[184:187]
buffer_load_dwordx4 a[104:107], v9, s[8:11], s41 offen offset:2048 sc1
v_mfma_f32_16x16x32_bf16 v[188:191], v[16:19], a[252:255], v[188:191]
v_mfma_f32_16x16x32_bf16 v[192:195], v[20:23], a[240:243], v[192:195]
ds_read_b64_tr_b16 v[16:17], v15 offset:256
v_mfma_f32_16x16x32_bf16 v[196:199], v[20:23], a[244:247], v[196:199]
ds_read_b64_tr_b16 v[18:19], v15 offset:4864
v_mfma_f32_16x16x32_bf16 v[200:203], v[20:23], a[248:251], v[200:203]
v_mfma_f32_16x16x32_bf16 v[204:207], v[20:23], a[252:255], v[204:207]
s_waitcnt lgkmcnt(2)
v_mfma_f32_16x16x32_bf16 v[208:211], v[24:27], a[240:243], v[208:211]
ds_read_b64_tr_b16 v[20:21], v15 offset:9216
v_mfma_f32_16x16x32_bf16 v[212:215], v[24:27], a[244:247], v[212:215]
ds_read_b64_tr_b16 v[22:23], v15 offset:13824
v_mfma_f32_16x16x32_bf16 v[216:219], v[24:27], a[248:251], v[216:219]
buffer_load_dwordx4 a[108:111], v9, s[8:11], s41 offen offset:3072 sc1
v_mfma_f32_16x16x32_bf16 v[220:223], v[24:27], a[252:255], v[220:223]
v_mfma_f32_16x16x32_bf16 v[224:227], v[28:31], a[240:243], v[224:227]
ds_read_b64_tr_b16 v[24:25], v15 offset:9248
v_mfma_f32_16x16x32_bf16 v[228:231], v[28:31], a[244:247], v[228:231]
ds_read_b64_tr_b16 v[26:27], v15 offset:13856
v_mfma_f32_16x16x32_bf16 v[232:235], v[28:31], a[248:251], v[232:235]
v_mfma_f32_16x16x32_bf16 v[236:239], v[28:31], a[252:255], v[236:239]
s_waitcnt lgkmcnt(2)
v_mfma_f32_16x16x32_bf16 v[240:243], v[16:19], a[240:243], v[240:243]
ds_read_b64_tr_b16 v[28:29], v15 offset:9280
v_mfma_f32_16x16x32_bf16 v[244:247], v[16:19], a[244:247], v[244:247]
ds_read_b64_tr_b16 v[30:31], v15 offset:13888
v_mfma_f32_16x16x32_bf16 v[248:251], v[16:19], a[248:251], v[248:251]
v_mfma_f32_16x16x32_bf16 v[252:255], v[16:19], a[252:255], v[252:255]
s_waitcnt vmcnt(33)
v_mfma_f32_16x16x32_bf16 v[112:115], v[20:23], a[0:3], v[112:115]
ds_read_b64_tr_b16 v[16:17], v15 offset:9312
v_mfma_f32_16x16x32_bf16 v[116:119], v[20:23], a[4:7], v[116:119]
ds_read_b64_tr_b16 v[18:19], v15 offset:13920
v_mfma_f32_16x16x32_bf16 v[120:123], v[20:23], a[8:11], v[120:123]
v_mfma_f32_16x16x32_bf16 v[124:127], v[20:23], a[12:15], v[124:127]
s_waitcnt lgkmcnt(2)
v_mfma_f32_16x16x32_bf16 v[128:131], v[24:27], a[0:3], v[128:131]
ds_read_b64_tr_b16 v[20:21], v15 offset:9344
v_mfma_f32_16x16x32_bf16 v[132:135], v[24:27], a[4:7], v[132:135]
ds_read_b64_tr_b16 v[22:23], v15 offset:13952
v_mfma_f32_16x16x32_bf16 v[136:139], v[24:27], a[8:11], v[136:139]
v_mfma_f32_16x16x32_bf16 v[140:143], v[24:27], a[12:15], v[140:143]
v_mfma_f32_16x16x32_bf16 v[144:147], v[28:31], a[0:3], v[144:147]
ds_read_b64_tr_b16 v[24:25], v15 offset:9376
v_mfma_f32_16x16x32_bf16 v[148:151], v[28:31], a[4:7], v[148:151]
ds_read_b64_tr_b16 v[26:27], v15 offset:13984
v_mfma_f32_16x16x32_bf16 v[152:155], v[28:31], a[8:11], v[152:155]
v_mfma_f32_16x16x32_bf16 v[156:159], v[28:31], a[12:15], v[156:159]
s_waitcnt lgkmcnt(2)
v_mfma_f32_16x16x32_bf16 v[160:163], v[16:19], a[0:3], v[160:163]
ds_read_b64_tr_b16 v[28:29], v15 offset:9408
v_mfma_f32_16x16x32_bf16 v[164:167], v[16:19], a[4:7], v[164:167]
ds_read_b64_tr_b16 v[30:31], v15 offset:14016
v_mfma_f32_16x16x32_bf16 v[168:171], v[16:19], a[8:11], v[168:171]
v_mfma_f32_16x16x32_bf16 v[172:175], v[16:19], a[12:15], v[172:175]
v_mfma_f32_16x16x32_bf16 v[176:179], v[20:23], a[0:3], v[176:179]
ds_read_b64_tr_b16 v[16:17], v15 offset:9440
v_mfma_f32_16x16x32_bf16 v[180:183], v[20:23], a[4:7], v[180:183]
ds_read_b64_tr_b16 v[18:19], v15 offset:14048
v_mfma_f32_16x16x32_bf16 v[184:187], v[20:23], a[8:11], v[184:187]
v_mfma_f32_16x16x32_bf16 v[188:191], v[20:23], a[12:15], v[188:191]
s_waitcnt lgkmcnt(2)
v_mfma_f32_16x16x32_bf16 v[192:195], v[24:27], a[0:3], v[192:195]
ds_read_b64_tr_b16 v[20:21], v15 offset:9472
v_mfma_f32_16x16x32_bf16 v[196:199], v[24:27], a[4:7], v[196:199]
ds_read_b64_tr_b16 v[22:23], v15 offset:14080
v_mfma_f32_16x16x32_bf16 v[200:203], v[24:27], a[8:11], v[200:203]
v_mfma_f32_16x16x32_bf16 v[204:207], v[24:27], a[12:15], v[204:207]
v_mfma_f32_16x16x32_bf16 v[208:211], v[28:31], a[0:3], v[208:211]
ds_read_b64_tr_b16 v[24:25], v15 offset:18432
v_mfma_f32_16x16x32_bf16 v[212:215], v[28:31], a[4:7], v[212:215]
ds_read_b64_tr_b16 v[26:27], v15 offset:23040
v_mfma_f32_16x16x32_bf16 v[216:219], v[28:31], a[8:11], v[216:219]
v_mfma_f32_16x16x32_bf16 v[220:223], v[28:31], a[12:15], v[220:223]
s_waitcnt lgkmcnt(2)
v_mfma_f32_16x16x32_bf16 v[224:227], v[16:19], a[0:3], v[224:227]
ds_read_b64_tr_b16 v[28:29], v15 offset:18464
v_mfma_f32_16x16x32_bf16 v[228:231], v[16:19], a[4:7], v[228:231]
ds_read_b64_tr_b16 v[30:31], v15 offset:23072
v_mfma_f32_16x16x32_bf16 v[232:235], v[16:19], a[8:11], v[232:235]
v_mfma_f32_16x16x32_bf16 v[236:239], v[16:19], a[12:15], v[236:239]
v_mfma_f32_16x16x32_bf16 v[240:243], v[20:23], a[0:3], v[240:243]
ds_read_b64_tr_b16 v[16:17], v15 offset:18496
v_mfma_f32_16x16x32_bf16 v[244:247], v[20:23], a[4:7], v[244:247]
ds_read_b64_tr_b16 v[18:19], v15 offset:23104
v_mfma_f32_16x16x32_bf16 v[248:251], v[20:23], a[8:11], v[248:251]
v_mfma_f32_16x16x32_bf16 v[252:255], v[20:23], a[12:15], v[252:255]
s_waitcnt lgkmcnt(2)
s_waitcnt vmcnt(27)
v_mfma_f32_16x16x32_bf16 v[112:115], v[24:27], a[16:19], v[112:115]
ds_read_b64_tr_b16 v[20:21], v15 offset:18528
v_mfma_f32_16x16x32_bf16 v[116:119], v[24:27], a[20:23], v[116:119]
ds_read_b64_tr_b16 v[22:23], v15 offset:23136
v_mfma_f32_16x16x32_bf16 v[120:123], v[24:27], a[24:27], v[120:123]
v_mfma_f32_16x16x32_bf16 v[124:127], v[24:27], a[28:31], v[124:127]
v_mfma_f32_16x16x32_bf16 v[128:131], v[28:31], a[16:19], v[128:131]
ds_read_b64_tr_b16 v[24:25], v15 offset:18560
v_mfma_f32_16x16x32_bf16 v[132:135], v[28:31], a[20:23], v[132:135]
ds_read_b64_tr_b16 v[26:27], v15 offset:23168
v_mfma_f32_16x16x32_bf16 v[136:139], v[28:31], a[24:27], v[136:139]
v_mfma_f32_16x16x32_bf16 v[140:143], v[28:31], a[28:31], v[140:143]
s_waitcnt lgkmcnt(2)
v_mfma_f32_16x16x32_bf16 v[144:147], v[16:19], a[16:19], v[144:147]
ds_read_b64_tr_b16 v[28:29], v15 offset:18592
v_mfma_f32_16x16x32_bf16 v[148:151], v[16:19], a[20:23], v[148:151]
ds_read_b64_tr_b16 v[30:31], v15 offset:23200
v_mfma_f32_16x16x32_bf16 v[152:155], v[16:19], a[24:27], v[152:155]
v_mfma_f32_16x16x32_bf16 v[156:159], v[16:19], a[28:31], v[156:159]
v_mfma_f32_16x16x32_bf16 v[160:163], v[20:23], a[16:19], v[160:163]
ds_read_b64_tr_b16 v[16:17], v15 offset:18624
v_mfma_f32_16x16x32_bf16 v[164:167], v[20:23], a[20:23], v[164:167]
ds_read_b64_tr_b16 v[18:19], v15 offset:23232
v_mfma_f32_16x16x32_bf16 v[168:171], v[20:23], a[24:27], v[168:171]
v_mfma_f32_16x16x32_bf16 v[172:175], v[20:23], a[28:31], v[172:175]
s_waitcnt lgkmcnt(2)
v_mfma_f32_16x16x32_bf16 v[176:179], v[24:27], a[16:19], v[176:179]
ds_read_b64_tr_b16 v[20:21], v15 offset:18656
v_mfma_f32_16x16x32_bf16 v[180:183], v[24:27], a[20:23], v[180:183]
ds_read_b64_tr_b16 v[22:23], v15 offset:23264
v_mfma_f32_16x16x32_bf16 v[184:187], v[24:27], a[24:27], v[184:187]
v_mfma_f32_16x16x32_bf16 v[188:191], v[24:27], a[28:31], v[188:191]
v_mfma_f32_16x16x32_bf16 v[192:195], v[28:31], a[16:19], v[192:195]
ds_read_b64_tr_b16 v[24:25], v15 offset:18688
v_mfma_f32_16x16x32_bf16 v[196:199], v[28:31], a[20:23], v[196:199]
ds_read_b64_tr_b16 v[26:27], v15 offset:23296
v_mfma_f32_16x16x32_bf16 v[200:203], v[28:31], a[24:27], v[200:203]
v_mfma_f32_16x16x32_bf16 v[204:207], v[28:31], a[28:31], v[204:207]
s_waitcnt lgkmcnt(2)
v_mfma_f32_16x16x32_bf16 v[208:211], v[16:19], a[16:19], v[208:211]
ds_read_b64_tr_b16 v[28:29], v15 offset:27648
v_mfma_f32_16x16x32_bf16 v[212:215], v[16:19], a[20:23], v[212:215]
ds_read_b64_tr_b16 v[30:31], v15 offset:32256
v_mfma_f32_16x16x32_bf16 v[216:219], v[16:19], a[24:27], v[216:219]
v_mfma_f32_16x16x32_bf16 v[220:223], v[16:19], a[28:31], v[220:223]
v_mfma_f32_16x16x32_bf16 v[224:227], v[20:23], a[16:19], v[224:227]
ds_read_b64_tr_b16 v[16:17], v15 offset:27680
v_mfma_f32_16x16x32_bf16 v[228:231], v[20:23], a[20:23], v[228:231]
ds_read_b64_tr_b16 v[18:19], v15 offset:32288
v_mfma_f32_16x16x32_bf16 v[232:235], v[20:23], a[24:27], v[232:235]
v_mfma_f32_16x16x32_bf16 v[236:239], v[20:23], a[28:31], v[236:239]
s_waitcnt lgkmcnt(2)
v_mfma_f32_16x16x32_bf16 v[240:243], v[24:27], a[16:19], v[240:243]
ds_read_b64_tr_b16 v[20:21], v15 offset:27712
v_mfma_f32_16x16x32_bf16 v[244:247], v[24:27], a[20:23], v[244:247]
ds_read_b64_tr_b16 v[22:23], v15 offset:32320
v_mfma_f32_16x16x32_bf16 v[248:251], v[24:27], a[24:27], v[248:251]
v_mfma_f32_16x16x32_bf16 v[252:255], v[24:27], a[28:31], v[252:255]
s_waitcnt vmcnt(21)
v_mfma_f32_16x16x32_bf16 v[112:115], v[28:31], a[32:35], v[112:115]
ds_read_b64_tr_b16 v[24:25], v15 offset:27744
v_mfma_f32_16x16x32_bf16 v[116:119], v[28:31], a[36:39], v[116:119]
ds_read_b64_tr_b16 v[26:27], v15 offset:32352
v_mfma_f32_16x16x32_bf16 v[120:123], v[28:31], a[40:43], v[120:123]
v_mfma_f32_16x16x32_bf16 v[124:127], v[28:31], a[44:47], v[124:127]
s_waitcnt lgkmcnt(2)
v_mfma_f32_16x16x32_bf16 v[128:131], v[16:19], a[32:35], v[128:131]
ds_read_b64_tr_b16 v[28:29], v15 offset:27776
v_mfma_f32_16x16x32_bf16 v[132:135], v[16:19], a[36:39], v[132:135]
ds_read_b64_tr_b16 v[30:31], v15 offset:32384
v_mfma_f32_16x16x32_bf16 v[136:139], v[16:19], a[40:43], v[136:139]
v_mfma_f32_16x16x32_bf16 v[140:143], v[16:19], a[44:47], v[140:143]
v_mfma_f32_16x16x32_bf16 v[144:147], v[20:23], a[32:35], v[144:147]
ds_read_b64_tr_b16 v[16:17], v15 offset:27808
v_mfma_f32_16x16x32_bf16 v[148:151], v[20:23], a[36:39], v[148:151]
ds_read_b64_tr_b16 v[18:19], v15 offset:32416
v_mfma_f32_16x16x32_bf16 v[152:155], v[20:23], a[40:43], v[152:155]
v_mfma_f32_16x16x32_bf16 v[156:159], v[20:23], a[44:47], v[156:159]
s_waitcnt lgkmcnt(2)
v_mfma_f32_16x16x32_bf16 v[160:163], v[24:27], a[32:35], v[160:163]
ds_read_b64_tr_b16 v[20:21], v15 offset:27840
v_mfma_f32_16x16x32_bf16 v[164:167], v[24:27], a[36:39], v[164:167]
ds_read_b64_tr_b16 v[22:23], v15 offset:32448
v_mfma_f32_16x16x32_bf16 v[168:171], v[24:27], a[40:43], v[168:171]
v_mfma_f32_16x16x32_bf16 v[172:175], v[24:27], a[44:47], v[172:175]
v_mfma_f32_16x16x32_bf16 v[176:179], v[28:31], a[32:35], v[176:179]
ds_read_b64_tr_b16 v[24:25], v15 offset:27872
v_mfma_f32_16x16x32_bf16 v[180:183], v[28:31], a[36:39], v[180:183]
ds_read_b64_tr_b16 v[26:27], v15 offset:32480
v_mfma_f32_16x16x32_bf16 v[184:187], v[28:31], a[40:43], v[184:187]
v_mfma_f32_16x16x32_bf16 v[188:191], v[28:31], a[44:47], v[188:191]
s_waitcnt lgkmcnt(2)
v_mfma_f32_16x16x32_bf16 v[192:195], v[16:19], a[32:35], v[192:195]
ds_read_b64_tr_b16 v[28:29], v15 offset:27904
v_mfma_f32_16x16x32_bf16 v[196:199], v[16:19], a[36:39], v[196:199]
ds_read_b64_tr_b16 v[30:31], v15 offset:32512
v_mfma_f32_16x16x32_bf16 v[200:203], v[16:19], a[40:43], v[200:203]
v_mfma_f32_16x16x32_bf16 v[204:207], v[16:19], a[44:47], v[204:207]
v_add_u32 v15, 0x9000, v15
v_mfma_f32_16x16x32_bf16 v[208:211], v[20:23], a[32:35], v[208:211]
s_waitcnt vmcnt(9)
s_barrier
ds_read_b64_tr_b16 v[16:17], v15 offset:0
v_mfma_f32_16x16x32_bf16 v[212:215], v[20:23], a[36:39], v[212:215]
ds_read_b64_tr_b16 v[18:19], v15 offset:4608
v_mfma_f32_16x16x32_bf16 v[216:219], v[20:23], a[40:43], v[216:219]
v_mfma_f32_16x16x32_bf16 v[220:223], v[20:23], a[44:47], v[220:223]
s_waitcnt lgkmcnt(2)
v_mfma_f32_16x16x32_bf16 v[224:227], v[24:27], a[32:35], v[224:227]
ds_read_b64_tr_b16 v[20:21], v15 offset:9216
v_mfma_f32_16x16x32_bf16 v[228:231], v[24:27], a[36:39], v[228:231]
ds_read_b64_tr_b16 v[22:23], v15 offset:13824
v_mfma_f32_16x16x32_bf16 v[232:235], v[24:27], a[40:43], v[232:235]
v_mfma_f32_16x16x32_bf16 v[236:239], v[24:27], a[44:47], v[236:239]
v_mfma_f32_16x16x32_bf16 v[240:243], v[28:31], a[32:35], v[240:243]
ds_read_b64_tr_b16 v[24:25], v15 offset:18432
v_mfma_f32_16x16x32_bf16 v[244:247], v[28:31], a[36:39], v[244:247]
ds_read_b64_tr_b16 v[26:27], v15 offset:23040
v_mfma_f32_16x16x32_bf16 v[248:251], v[28:31], a[40:43], v[248:251]
v_mfma_f32_16x16x32_bf16 v[252:255], v[28:31], a[44:47], v[252:255]
s_waitcnt lgkmcnt(2)
v_mfma_f32_16x16x32_bf16 v[112:115], v[16:19], a[48:51], v[112:115]
ds_read_b64_tr_b16 v[28:29], v15 offset:27648
v_mfma_f32_16x16x32_bf16 v[116:119], v[16:19], a[52:55], v[116:119]
ds_read_b64_tr_b16 v[30:31], v15 offset:32256
v_mfma_f32_16x16x32_bf16 v[120:123], v[16:19], a[56:59], v[120:123]
v_mfma_f32_16x16x32_bf16 v[124:127], v[16:19], a[60:63], v[124:127]
s_waitcnt vmcnt(8)
v_mfma_f32_16x16x32_bf16 v[112:115], v[20:23], a[64:67], v[112:115]
ds_read_b64_tr_b16 v[16:17], v15 offset:32
v_mfma_f32_16x16x32_bf16 v[116:119], v[20:23], a[68:71], v[116:119]
ds_read_b64_tr_b16 v[18:19], v15 offset:4640
s_barrier
v_mfma_f32_16x16x32_bf16 v[120:123], v[20:23], a[72:75], v[120:123]
v_mfma_f32_16x16x32_bf16 v[124:127], v[20:23], a[76:79], v[124:127]
s_waitcnt lgkmcnt(2)
s_waitcnt vmcnt(4)
v_mfma_f32_16x16x32_bf16 v[112:115], v[24:27], a[80:83], v[112:115]
ds_read_b64_tr_b16 v[20:21], v15 offset:9248
v_mfma_f32_16x16x32_bf16 v[116:119], v[24:27], a[84:87], v[116:119]
ds_read_b64_tr_b16 v[22:23], v15 offset:13856
v_mfma_f32_16x16x32_bf16 v[120:123], v[24:27], a[88:91], v[120:123]
v_mfma_f32_16x16x32_bf16 v[124:127], v[24:27], a[92:95], v[124:127]
s_waitcnt vmcnt(0)
v_mfma_f32_16x16x32_bf16 v[112:115], v[28:31], a[96:99], v[112:115]
ds_read_b64_tr_b16 v[24:25], v15 offset:18464
v_mfma_f32_16x16x32_bf16 v[116:119], v[28:31], a[100:103], v[116:119]
ds_read_b64_tr_b16 v[26:27], v15 offset:23072
v_mfma_f32_16x16x32_bf16 v[120:123], v[28:31], a[104:107], v[120:123]
v_mfma_f32_16x16x32_bf16 v[124:127], v[28:31], a[108:111], v[124:127]
s_add_u32 s42, s62, 0
s_waitcnt lgkmcnt(2)
v_mfma_f32_16x16x32_bf16 v[128:131], v[16:19], a[48:51], v[128:131]
ds_read_b64_tr_b16 v[28:29], v15 offset:27680
v_mfma_f32_16x16x32_bf16 v[132:135], v[16:19], a[52:55], v[132:135]
ds_read_b64_tr_b16 v[30:31], v15 offset:32288
v_mfma_f32_16x16x32_bf16 v[136:139], v[16:19], a[56:59], v[136:139]
v_mfma_f32_16x16x32_bf16 v[140:143], v[16:19], a[60:63], v[140:143]
v_mfma_f32_16x16x32_bf16 v[128:131], v[20:23], a[64:67], v[128:131]
ds_read_b64_tr_b16 v[16:17], v15 offset:64
v_cvt_pk_bf16_f32 v32, v112, v113
v_mfma_f32_16x16x32_bf16 v[132:135], v[20:23], a[68:71], v[132:135]
ds_read_b64_tr_b16 v[18:19], v15 offset:4672
v_cvt_pk_bf16_f32 v33, v114, v115
v_mfma_f32_16x16x32_bf16 v[136:139], v[20:23], a[72:75], v[136:139]
v_cvt_pk_bf16_f32 v34, v116, v117
v_cvt_pk_bf16_f32 v35, v118, v119
v_mfma_f32_16x16x32_bf16 v[140:143], v[20:23], a[76:79], v[140:143]
buffer_store_dwordx4 v[32:35], v9, s[8:11], s42 offen offset:0 sc1
s_waitcnt lgkmcnt(2)
v_mfma_f32_16x16x32_bf16 v[128:131], v[24:27], a[80:83], v[128:131]
ds_read_b64_tr_b16 v[20:21], v15 offset:9280
v_cvt_pk_bf16_f32 v36, v120, v121
v_mfma_f32_16x16x32_bf16 v[132:135], v[24:27], a[84:87], v[132:135]
ds_read_b64_tr_b16 v[22:23], v15 offset:13888
v_cvt_pk_bf16_f32 v37, v122, v123
v_mfma_f32_16x16x32_bf16 v[136:139], v[24:27], a[88:91], v[136:139]
v_cvt_pk_bf16_f32 v38, v124, v125
v_cvt_pk_bf16_f32 v39, v126, v127
v_mfma_f32_16x16x32_bf16 v[140:143], v[24:27], a[92:95], v[140:143]
buffer_store_dwordx4 v[36:39], v9, s[8:11], s42 offen offset:1024 sc1
v_mfma_f32_16x16x32_bf16 v[128:131], v[28:31], a[96:99], v[128:131]
ds_read_b64_tr_b16 v[24:25], v15 offset:18496
v_mfma_f32_16x16x32_bf16 v[132:135], v[28:31], a[100:103], v[132:135]
ds_read_b64_tr_b16 v[26:27], v15 offset:23104
v_mfma_f32_16x16x32_bf16 v[136:139], v[28:31], a[104:107], v[136:139]
v_mfma_f32_16x16x32_bf16 v[140:143], v[28:31], a[108:111], v[140:143]
s_waitcnt lgkmcnt(2)
v_mfma_f32_16x16x32_bf16 v[144:147], v[16:19], a[48:51], v[144:147]
ds_read_b64_tr_b16 v[28:29], v15 offset:27712
v_mfma_f32_16x16x32_bf16 v[148:151], v[16:19], a[52:55], v[148:151]
ds_read_b64_tr_b16 v[30:31], v15 offset:32320
v_mfma_f32_16x16x32_bf16 v[152:155], v[16:19], a[56:59], v[152:155]
v_mfma_f32_16x16x32_bf16 v[156:159], v[16:19], a[60:63], v[156:159]
v_mfma_f32_16x16x32_bf16 v[144:147], v[20:23], a[64:67], v[144:147]
ds_read_b64_tr_b16 v[16:17], v15 offset:96
v_cvt_pk_bf16_f32 v40, v128, v129
v_mfma_f32_16x16x32_bf16 v[148:151], v[20:23], a[68:71], v[148:151]
ds_read_b64_tr_b16 v[18:19], v15 offset:4704
v_cvt_pk_bf16_f32 v41, v130, v131
v_mfma_f32_16x16x32_bf16 v[152:155], v[20:23], a[72:75], v[152:155]
v_cvt_pk_bf16_f32 v42, v132, v133
v_cvt_pk_bf16_f32 v43, v134, v135
v_mfma_f32_16x16x32_bf16 v[156:159], v[20:23], a[76:79], v[156:159]
buffer_store_dwordx4 v[40:43], v9, s[8:11], s42 offen offset:2048 sc1
s_waitcnt lgkmcnt(2)
v_mfma_f32_16x16x32_bf16 v[144:147], v[24:27], a[80:83], v[144:147]
ds_read_b64_tr_b16 v[20:21], v15 offset:9312
v_cvt_pk_bf16_f32 v44, v136, v137
v_mfma_f32_16x16x32_bf16 v[148:151], v[24:27], a[84:87], v[148:151]
ds_read_b64_tr_b16 v[22:23], v15 offset:13920
v_cvt_pk_bf16_f32 v45, v138, v139
v_mfma_f32_16x16x32_bf16 v[152:155], v[24:27], a[88:91], v[152:155]
v_cvt_pk_bf16_f32 v46, v140, v141
v_cvt_pk_bf16_f32 v47, v142, v143
v_mfma_f32_16x16x32_bf16 v[156:159], v[24:27], a[92:95], v[156:159]
buffer_store_dwordx4 v[44:47], v9, s[8:11], s42 offen offset:3072 sc1
s_add_u32 s42, s62, 4096
v_mfma_f32_16x16x32_bf16 v[144:147], v[28:31], a[96:99], v[144:147]
ds_read_b64_tr_b16 v[24:25], v15 offset:18528
v_mfma_f32_16x16x32_bf16 v[148:151], v[28:31], a[100:103], v[148:151]
ds_read_b64_tr_b16 v[26:27], v15 offset:23136
v_mfma_f32_16x16x32_bf16 v[152:155], v[28:31], a[104:107], v[152:155]
v_mfma_f32_16x16x32_bf16 v[156:159], v[28:31], a[108:111], v[156:159]
s_waitcnt lgkmcnt(2)
v_mfma_f32_16x16x32_bf16 v[160:163], v[16:19], a[48:51], v[160:163]
ds_read_b64_tr_b16 v[28:29], v15 offset:27744
v_mfma_f32_16x16x32_bf16 v[164:167], v[16:19], a[52:55], v[164:167]
ds_read_b64_tr_b16 v[30:31], v15 offset:32352
v_mfma_f32_16x16x32_bf16 v[168:171], v[16:19], a[56:59], v[168:171]
v_mfma_f32_16x16x32_bf16 v[172:175], v[16:19], a[60:63], v[172:175]
v_mfma_f32_16x16x32_bf16 v[160:163], v[20:23], a[64:67], v[160:163]
ds_read_b64_tr_b16 v[16:17], v15 offset:128
v_cvt_pk_bf16_f32 v48, v144, v145
v_mfma_f32_16x16x32_bf16 v[164:167], v[20:23], a[68:71], v[164:167]
ds_read_b64_tr_b16 v[18:19], v15 offset:4736
v_cvt_pk_bf16_f32 v49, v146, v147
v_mfma_f32_16x16x32_bf16 v[168:171], v[20:23], a[72:75], v[168:171]
v_cvt_pk_bf16_f32 v50, v148, v149
v_cvt_pk_bf16_f32 v51, v150, v151
v_mfma_f32_16x16x32_bf16 v[172:175], v[20:23], a[76:79], v[172:175]
buffer_store_dwordx4 v[48:51], v9, s[8:11], s42 offen offset:0 sc1
s_waitcnt lgkmcnt(2)
v_mfma_f32_16x16x32_bf16 v[160:163], v[24:27], a[80:83], v[160:163]
ds_read_b64_tr_b16 v[20:21], v15 offset:9344
v_cvt_pk_bf16_f32 v52, v152, v153
v_mfma_f32_16x16x32_bf16 v[164:167], v[24:27], a[84:87], v[164:167]
ds_read_b64_tr_b16 v[22:23], v15 offset:13952
v_cvt_pk_bf16_f32 v53, v154, v155
v_mfma_f32_16x16x32_bf16 v[168:171], v[24:27], a[88:91], v[168:171]
v_cvt_pk_bf16_f32 v54, v156, v157
v_cvt_pk_bf16_f32 v55, v158, v159
v_mfma_f32_16x16x32_bf16 v[172:175], v[24:27], a[92:95], v[172:175]
buffer_store_dwordx4 v[52:55], v9, s[8:11], s42 offen offset:1024 sc1
v_mfma_f32_16x16x32_bf16 v[160:163], v[28:31], a[96:99], v[160:163]
ds_read_b64_tr_b16 v[24:25], v15 offset:18560
v_mfma_f32_16x16x32_bf16 v[164:167], v[28:31], a[100:103], v[164:167]
ds_read_b64_tr_b16 v[26:27], v15 offset:23168
v_mfma_f32_16x16x32_bf16 v[168:171], v[28:31], a[104:107], v[168:171]
v_mfma_f32_16x16x32_bf16 v[172:175], v[28:31], a[108:111], v[172:175]
s_waitcnt lgkmcnt(2)
v_mfma_f32_16x16x32_bf16 v[176:179], v[16:19], a[48:51], v[176:179]
ds_read_b64_tr_b16 v[28:29], v15 offset:27776
v_mfma_f32_16x16x32_bf16 v[180:183], v[16:19], a[52:55], v[180:183]
ds_read_b64_tr_b16 v[30:31], v15 offset:32384
v_mfma_f32_16x16x32_bf16 v[184:187], v[16:19], a[56:59], v[184:187]
v_mfma_f32_16x16x32_bf16 v[188:191], v[16:19], a[60:63], v[188:191]
v_mfma_f32_16x16x32_bf16 v[176:179], v[20:23], a[64:67], v[176:179]
ds_read_b64_tr_b16 v[16:17], v15 offset:160
v_cvt_pk_bf16_f32 v56, v160, v161
v_mfma_f32_16x16x32_bf16 v[180:183], v[20:23], a[68:71], v[180:183]
ds_read_b64_tr_b16 v[18:19], v15 offset:4768
v_cvt_pk_bf16_f32 v57, v162, v163
v_mfma_f32_16x16x32_bf16 v[184:187], v[20:23], a[72:75], v[184:187]
v_cvt_pk_bf16_f32 v58, v164, v165
v_cvt_pk_bf16_f32 v59, v166, v167
v_mfma_f32_16x16x32_bf16 v[188:191], v[20:23], a[76:79], v[188:191]
buffer_store_dwordx4 v[56:59], v9, s[8:11], s42 offen offset:2048 sc1
s_waitcnt lgkmcnt(2)
v_mfma_f32_16x16x32_bf16 v[176:179], v[24:27], a[80:83], v[176:179]
ds_read_b64_tr_b16 v[20:21], v15 offset:9376
v_cvt_pk_bf16_f32 v60, v168, v169
v_mfma_f32_16x16x32_bf16 v[180:183], v[24:27], a[84:87], v[180:183]
ds_read_b64_tr_b16 v[22:23], v15 offset:13984
v_cvt_pk_bf16_f32 v61, v170, v171
v_mfma_f32_16x16x32_bf16 v[184:187], v[24:27], a[88:91], v[184:187]
v_cvt_pk_bf16_f32 v62, v172, v173
v_cvt_pk_bf16_f32 v63, v174, v175
v_mfma_f32_16x16x32_bf16 v[188:191], v[24:27], a[92:95], v[188:191]
buffer_store_dwordx4 v[60:63], v9, s[8:11], s42 offen offset:3072 sc1
s_add_u32 s42, s62, 8192
v_mfma_f32_16x16x32_bf16 v[176:179], v[28:31], a[96:99], v[176:179]
ds_read_b64_tr_b16 v[24:25], v15 offset:18592
v_mfma_f32_16x16x32_bf16 v[180:183], v[28:31], a[100:103], v[180:183]
ds_read_b64_tr_b16 v[26:27], v15 offset:23200
v_mfma_f32_16x16x32_bf16 v[184:187], v[28:31], a[104:107], v[184:187]
v_mfma_f32_16x16x32_bf16 v[188:191], v[28:31], a[108:111], v[188:191]
s_waitcnt lgkmcnt(2)
v_mfma_f32_16x16x32_bf16 v[192:195], v[16:19], a[48:51], v[192:195]
ds_read_b64_tr_b16 v[28:29], v15 offset:27808
v_mfma_f32_16x16x32_bf16 v[196:199], v[16:19], a[52:55], v[196:199]
ds_read_b64_tr_b16 v[30:31], v15 offset:32416
v_mfma_f32_16x16x32_bf16 v[200:203], v[16:19], a[56:59], v[200:203]
v_mfma_f32_16x16x32_bf16 v[204:207], v[16:19], a[60:63], v[204:207]
v_mfma_f32_16x16x32_bf16 v[192:195], v[20:23], a[64:67], v[192:195]
ds_read_b64_tr_b16 v[16:17], v15 offset:192
v_cvt_pk_bf16_f32 v32, v176, v177
v_mfma_f32_16x16x32_bf16 v[196:199], v[20:23], a[68:71], v[196:199]
ds_read_b64_tr_b16 v[18:19], v15 offset:4800
v_cvt_pk_bf16_f32 v33, v178, v179
v_mfma_f32_16x16x32_bf16 v[200:203], v[20:23], a[72:75], v[200:203]
v_cvt_pk_bf16_f32 v34, v180, v181
v_cvt_pk_bf16_f32 v35, v182, v183
v_mfma_f32_16x16x32_bf16 v[204:207], v[20:23], a[76:79], v[204:207]
buffer_store_dwordx4 v[32:35], v9, s[8:11], s42 offen offset:0 sc1
s_waitcnt lgkmcnt(2)
v_mfma_f32_16x16x32_bf16 v[192:195], v[24:27], a[80:83], v[192:195]
ds_read_b64_tr_b16 v[20:21], v15 offset:9408
v_cvt_pk_bf16_f32 v36, v184, v185
v_mfma_f32_16x16x32_bf16 v[196:199], v[24:27], a[84:87], v[196:199]
ds_read_b64_tr_b16 v[22:23], v15 offset:14016
v_cvt_pk_bf16_f32 v37, v186, v187
v_mfma_f32_16x16x32_bf16 v[200:203], v[24:27], a[88:91], v[200:203]
v_cvt_pk_bf16_f32 v38, v188, v189
v_cvt_pk_bf16_f32 v39, v190, v191
v_mfma_f32_16x16x32_bf16 v[204:207], v[24:27], a[92:95], v[204:207]
buffer_store_dwordx4 v[36:39], v9, s[8:11], s42 offen offset:1024 sc1
v_mfma_f32_16x16x32_bf16 v[192:195], v[28:31], a[96:99], v[192:195]
ds_read_b64_tr_b16 v[24:25], v15 offset:18624
v_mfma_f32_16x16x32_bf16 v[196:199], v[28:31], a[100:103], v[196:199]
ds_read_b64_tr_b16 v[26:27], v15 offset:23232
v_mfma_f32_16x16x32_bf16 v[200:203], v[28:31], a[104:107], v[200:203]
v_mfma_f32_16x16x32_bf16 v[204:207], v[28:31], a[108:111], v[204:207]
s_waitcnt lgkmcnt(2)
v_mfma_f32_16x16x32_bf16 v[208:211], v[16:19], a[48:51], v[208:211]
ds_read_b64_tr_b16 v[28:29], v15 offset:27840
v_mfma_f32_16x16x32_bf16 v[212:215], v[16:19], a[52:55], v[212:215]
ds_read_b64_tr_b16 v[30:31], v15 offset:32448
v_mfma_f32_16x16x32_bf16 v[216:219], v[16:19], a[56:59], v[216:219]
v_mfma_f32_16x16x32_bf16 v[220:223], v[16:19], a[60:63], v[220:223]
v_mfma_f32_16x16x32_bf16 v[208:211], v[20:23], a[64:67], v[208:211]
ds_read_b64_tr_b16 v[16:17], v15 offset:224
v_cvt_pk_bf16_f32 v40, v192, v193
v_mfma_f32_16x16x32_bf16 v[212:215], v[20:23], a[68:71], v[212:215]
ds_read_b64_tr_b16 v[18:19], v15 offset:4832
v_cvt_pk_bf16_f32 v41, v194, v195
v_mfma_f32_16x16x32_bf16 v[216:219], v[20:23], a[72:75], v[216:219]
v_cvt_pk_bf16_f32 v42, v196, v197
v_cvt_pk_bf16_f32 v43, v198, v199
v_mfma_f32_16x16x32_bf16 v[220:223], v[20:23], a[76:79], v[220:223]
buffer_store_dwordx4 v[40:43], v9, s[8:11], s42 offen offset:2048 sc1
s_waitcnt lgkmcnt(2)
v_mfma_f32_16x16x32_bf16 v[208:211], v[24:27], a[80:83], v[208:211]
ds_read_b64_tr_b16 v[20:21], v15 offset:9440
v_cvt_pk_bf16_f32 v44, v200, v201
v_mfma_f32_16x16x32_bf16 v[212:215], v[24:27], a[84:87], v[212:215]
ds_read_b64_tr_b16 v[22:23], v15 offset:14048
v_cvt_pk_bf16_f32 v45, v202, v203
v_mfma_f32_16x16x32_bf16 v[216:219], v[24:27], a[88:91], v[216:219]
v_cvt_pk_bf16_f32 v46, v204, v205
v_cvt_pk_bf16_f32 v47, v206, v207
v_mfma_f32_16x16x32_bf16 v[220:223], v[24:27], a[92:95], v[220:223]
buffer_store_dwordx4 v[44:47], v9, s[8:11], s42 offen offset:3072 sc1
s_add_u32 s42, s62, 12288
v_mfma_f32_16x16x32_bf16 v[208:211], v[28:31], a[96:99], v[208:211]
ds_read_b64_tr_b16 v[24:25], v15 offset:18656
v_mfma_f32_16x16x32_bf16 v[212:215], v[28:31], a[100:103], v[212:215]
ds_read_b64_tr_b16 v[26:27], v15 offset:23264
v_mfma_f32_16x16x32_bf16 v[216:219], v[28:31], a[104:107], v[216:219]
v_mfma_f32_16x16x32_bf16 v[220:223], v[28:31], a[108:111], v[220:223]
s_waitcnt lgkmcnt(2)
v_mfma_f32_16x16x32_bf16 v[224:227], v[16:19], a[48:51], v[224:227]
ds_read_b64_tr_b16 v[28:29], v15 offset:27872
v_mfma_f32_16x16x32_bf16 v[228:231], v[16:19], a[52:55], v[228:231]
ds_read_b64_tr_b16 v[30:31], v15 offset:32480
v_mfma_f32_16x16x32_bf16 v[232:235], v[16:19], a[56:59], v[232:235]
v_mfma_f32_16x16x32_bf16 v[236:239], v[16:19], a[60:63], v[236:239]
v_mfma_f32_16x16x32_bf16 v[224:227], v[20:23], a[64:67], v[224:227]
ds_read_b64_tr_b16 v[16:17], v15 offset:256
v_cvt_pk_bf16_f32 v48, v208, v209
v_mfma_f32_16x16x32_bf16 v[228:231], v[20:23], a[68:71], v[228:231]
ds_read_b64_tr_b16 v[18:19], v15 offset:4864
v_cvt_pk_bf16_f32 v49, v210, v211
v_mfma_f32_16x16x32_bf16 v[232:235], v[20:23], a[72:75], v[232:235]
v_cvt_pk_bf16_f32 v50, v212, v213
v_cvt_pk_bf16_f32 v51, v214, v215
v_mfma_f32_16x16x32_bf16 v[236:239], v[20:23], a[76:79], v[236:239]
buffer_store_dwordx4 v[48:51], v9, s[8:11], s42 offen offset:0 sc1
s_waitcnt lgkmcnt(2)
v_mfma_f32_16x16x32_bf16 v[224:227], v[24:27], a[80:83], v[224:227]
ds_read_b64_tr_b16 v[20:21], v15 offset:9472
v_cvt_pk_bf16_f32 v52, v216, v217
v_mfma_f32_16x16x32_bf16 v[228:231], v[24:27], a[84:87], v[228:231]
ds_read_b64_tr_b16 v[22:23], v15 offset:14080
v_cvt_pk_bf16_f32 v53, v218, v219
v_mfma_f32_16x16x32_bf16 v[232:235], v[24:27], a[88:91], v[232:235]
v_cvt_pk_bf16_f32 v54, v220, v221
v_cvt_pk_bf16_f32 v55, v222, v223
v_mfma_f32_16x16x32_bf16 v[236:239], v[24:27], a[92:95], v[236:239]
buffer_store_dwordx4 v[52:55], v9, s[8:11], s42 offen offset:1024 sc1
v_mfma_f32_16x16x32_bf16 v[224:227], v[28:31], a[96:99], v[224:227]
ds_read_b64_tr_b16 v[24:25], v15 offset:18688
v_mfma_f32_16x16x32_bf16 v[228:231], v[28:31], a[100:103], v[228:231]
ds_read_b64_tr_b16 v[26:27], v15 offset:23296
v_mfma_f32_16x16x32_bf16 v[232:235], v[28:31], a[104:107], v[232:235]
v_mfma_f32_16x16x32_bf16 v[236:239], v[28:31], a[108:111], v[236:239]
s_waitcnt lgkmcnt(2)
v_mfma_f32_16x16x32_bf16 v[240:243], v[16:19], a[48:51], v[240:243]
ds_read_b64_tr_b16 v[28:29], v15 offset:27904
v_mfma_f32_16x16x32_bf16 v[244:247], v[16:19], a[52:55], v[244:247]
ds_read_b64_tr_b16 v[30:31], v15 offset:32512
v_mfma_f32_16x16x32_bf16 v[248:251], v[16:19], a[56:59], v[248:251]
v_mfma_f32_16x16x32_bf16 v[252:255], v[16:19], a[60:63], v[252:255]
v_mfma_f32_16x16x32_bf16 v[240:243], v[20:23], a[64:67], v[240:243]
v_cvt_pk_bf16_f32 v56, v224, v225
v_cvt_pk_bf16_f32 v57, v226, v227
v_mfma_f32_16x16x32_bf16 v[244:247], v[20:23], a[68:71], v[244:247]
v_cvt_pk_bf16_f32 v58, v228, v229
v_cvt_pk_bf16_f32 v59, v230, v231
v_mfma_f32_16x16x32_bf16 v[248:251], v[20:23], a[72:75], v[248:251]
buffer_store_dwordx4 v[56:59], v9, s[8:11], s42 offen offset:2048 sc1
v_mfma_f32_16x16x32_bf16 v[252:255], v[20:23], a[76:79], v[252:255]
v_cvt_pk_bf16_f32 v60, v232, v233
v_cvt_pk_bf16_f32 v61, v234, v235
s_waitcnt lgkmcnt(0)
v_mfma_f32_16x16x32_bf16 v[240:243], v[24:27], a[80:83], v[240:243]
v_cvt_pk_bf16_f32 v62, v236, v237
v_cvt_pk_bf16_f32 v63, v238, v239
v_mfma_f32_16x16x32_bf16 v[244:247], v[24:27], a[84:87], v[244:247]
buffer_store_dwordx4 v[60:63], v9, s[8:11], s42 offen offset:3072 sc1
s_add_u32 s42, s62, 16384
v_mfma_f32_16x16x32_bf16 v[248:251], v[24:27], a[88:91], v[248:251]
v_mfma_f32_16x16x32_bf16 v[252:255], v[24:27], a[92:95], v[252:255]
v_mfma_f32_16x16x32_bf16 v[240:243], v[28:31], a[96:99], v[240:243]
v_mfma_f32_16x16x32_bf16 v[244:247], v[28:31], a[100:103], v[244:247]
v_mfma_f32_16x16x32_bf16 v[248:251], v[28:31], a[104:107], v[248:251]
v_mfma_f32_16x16x32_bf16 v[252:255], v[28:31], a[108:111], v[252:255]
s_nop 4
v_cvt_pk_bf16_f32 v32, v240, v241
v_cvt_pk_bf16_f32 v33, v242, v243
v_cvt_pk_bf16_f32 v34, v244, v245
v_cvt_pk_bf16_f32 v35, v246, v247
buffer_store_dwordx4 v[32:35], v9, s[8:11], s42 offen offset:0 sc1
v_cvt_pk_bf16_f32 v36, v248, v249
v_cvt_pk_bf16_f32 v37, v250, v251
v_cvt_pk_bf16_f32 v38, v252, v253
v_cvt_pk_bf16_f32 v39, v254, v255
buffer_store_dwordx4 v[36:39], v9, s[8:11], s42 offen offset:1024 sc1
s_load_dwordx2 s[56:57], s[0:1], 72
s_and_b32 s20, s2, 7
s_lshr_b32 s21, s20, 1
s_and_b32 s22, s20, 1
s_lshl_b32 s23, s29, 2
s_add_u32 s23, s23, s68
s_lshl_b32 s24, s23, 2
s_add_u32 s24, s24, s21
s_mul_i32 s24, s24, 18432
s_lshl_b32 s25, s22, 10
s_add_u32 s24, s24, s25
s_lshl_b32 s25, s29, 8
s_lshl_b32 s26, s21, 6
s_add_u32 s25, s25, s26
s_lshl_b32 s26, s22, 5
s_add_u32 s25, s25, s26
s_mul_i32 s26, s68, 288
v_and_b32 v2, 15, v0
v_add_u32 v2, s25, v2
v_mul_u32_u24 v2, 1152, v2
v_lshrrev_b32 v3, 4, v0
v_lshl_add_u32 v2, v3, 3, v2
v_add_u32 v2, s26, v2
v_add_u32 v3, 18432, v2
s_lshl_b32 s20, s28, 5
s_add_u32 s21, s20, 128
s_lshr_b32 s22, s28, 1
s_mul_i32 s22, s22, 18432
s_and_b32 s23, s28, 1
s_lshl_b32 s23, s23, 2
s_add_u32 s22, s22, s23
s_add_u32 s22, s22, 256
s_lshl_b32 s25, s28, 11
s_add_u32 s25, s25, s24
s_lshl_b32 s26, s28, 2
s_add_u32 s26, s26, s24
s_add_u32 s26, s26, 16384
v_mov_b32 v133, 0x3f80
v_mov_b32 v134, 0x3f800000
buffer_load_dwordx2 v[124:125], v2, s[52:55], s20 offen
buffer_load_dwordx2 v[126:127], v3, s[52:55], s20 offen
buffer_load_dwordx2 v[128:129], v2, s[52:55], s21 offen
buffer_load_dwordx2 v[130:131], v3, s[52:55], s21 offen
buffer_load_dword v132, v2, s[52:55], s22 offen
buffer_load_dword v7, v6, s[8:11], s67 offen sc1
s_waitcnt vmcnt(6)
buffer_store_dword v5, v4, s[8:11], s65 offen sc1
s_waitcnt vmcnt(1)
v_cmp_eq_u32 vcc, s100, v7
s_nop 3
s_and_b32 s43, vcc_lo, 0xf0
s_cmp_eq_u32 s43, 0xf0
s_cbranch_scc0 mk_slowYS
mk_backYS:
s_add_u32 s27, s25, 59768832
buffer_load_dwordx4 v[16:19], v9, s[8:11], s27 offen sc1
s_add_u32 s27, s25, 62128128
buffer_load_dwordx4 v[20:23], v9, s[8:11], s27 offen sc1
s_add_u32 s27, s25, 64487424
buffer_load_dwordx4 v[24:27], v9, s[8:11], s27 offen sc1
s_add_u32 s27, s25, 66846720
buffer_load_dwordx4 v[28:31], v9, s[8:11], s27 offen sc1
s_add_u32 s27, s25, 59777024
buffer_load_dwordx4 v[48:51], v9, s[8:11], s27 offen sc1
s_add_u32 s27, s25, 62136320
buffer_load_dwordx4 v[52:55], v9, s[8:11], s27 offen sc1
s_add_u32 s27, s25, 64495616
buffer_load_dwordx4 v[56:59], v9, s[8:11], s27 offen sc1
s_add_u32 s27, s25, 66854912
buffer_load_dwordx4 v[60:63], v9, s[8:11], s27 offen sc1
s_add_u32 s27, s26, 59768832
buffer_load_dword v80, v9, s[8:11], s27 offen sc1
s_add_u32 s27, s26, 62128128
buffer_load_dword v81, v9, s[8:11], s27 offen sc1
s_add_u32 s27, s26, 64487424
buffer_load_dword v82, v9, s[8:11], s27 offen sc1
s_add_u32 s27, s26, 66846720
buffer_load_dword v83, v9, s[8:11], s27 offen sc1
v_lshlrev_b32 v156, 16, v124
v_and_b32 v157, 0xffff0000, v124
v_lshlrev_b32 v158, 16, v125
v_and_b32 v159, 0xffff0000, v125
v_lshlrev_b32 v160, 16, v126
v_and_b32 v161, 0xffff0000, v126
v_lshlrev_b32 v162, 16, v127
v_and_b32 v163, 0xffff0000, v127
v_lshlrev_b32 v164, 16, v128
v_and_b32 v165, 0xffff0000, v128
v_lshlrev_b32 v166, 16, v129
v_and_b32 v167, 0xffff0000, v129
v_lshlrev_b32 v168, 16, v130
v_and_b32 v169, 0xffff0000, v130
v_lshlrev_b32 v170, 16, v131
v_and_b32 v171, 0xffff0000, v131
v_lshlrev_b32 v172, 16, v132
v_and_b32 v173, 0xffff0000, v132
s_waitcnt vmcnt(8)
v_dot2_f32_bf16 v88, v16, v133, 0
v_dot2_f32_bf16 v89, v16, v134, 0
v_dot2_f32_bf16 v90, v17, v133, 0
v_dot2_f32_bf16 v91, v17, v134, 0
v_dot2_f32_bf16 v92, v18, v133, 0
v_dot2_f32_bf16 v93, v18, v134, 0
v_dot2_f32_bf16 v94, v19, v133, 0
v_dot2_f32_bf16 v95, v19, v134, 0
v_dot2_f32_bf16 v88, v20, v133, v88
v_dot2_f32_bf16 v89, v20, v134, v89
v_dot2_f32_bf16 v90, v21, v133, v90
v_dot2_f32_bf16 v91, v21, v134, v91
v_dot2_f32_bf16 v92, v22, v133, v92
v_dot2_f32_bf16 v93, v22, v134, v93
v_dot2_f32_bf16 v94, v23, v133, v94
v_dot2_f32_bf16 v95, v23, v134, v95
v_dot2_f32_bf16 v88, v24, v133, v88
v_dot2_f32_bf16 v89, v24, v134, v89
v_dot2_f32_bf16 v90, v25, v133, v90
v_dot2_f32_bf16 v91, v25, v134, v91
v_dot2_f32_bf16 v92, v26, v133, v92
v_dot2_f32_bf16 v93, v26, v134, v93
v_dot2_f32_bf16 v94, v27, v133, v94
v_dot2_f32_bf16 v95, v27, v134, v95
v_dot2_f32_bf16 v88, v28, v133, v88
v_dot2_f32_bf16 v89, v28, v134, v89
v_dot2_f32_bf16 v90, v29, v133, v90
v_dot2_f32_bf16 v91, v29, v134, v91
v_dot2_f32_bf16 v92, v30, v133, v92
v_dot2_f32_bf16 v93, v30, v134, v93
v_dot2_f32_bf16 v94, v31, v133, v94
v_dot2_f32_bf16 v95, v31, v134, v95
s_waitcnt vmcnt(4)
v_dot2_f32_bf16 v96, v48, v133, 0
v_dot2_f32_bf16 v97, v48, v134, 0
v_dot2_f32_bf16 v98, v49, v133, 0
v_dot2_f32_bf16 v99, v49, v134, 0
v_dot2_f32_bf16 v100, v50, v133, 0
v_dot2_f32_bf16 v101, v50, v134, 0
v_dot2_f32_bf16 v102, v51, v133, 0
v_dot2_f32_bf16 v103, v51, v134, 0
v_dot2_f32_bf16 v96, v52, v133, v96
v_dot2_f32_bf16 v97, v52, v134, v97
v_dot2_f32_bf16 v98, v53, v133, v98
v_dot2_f32_bf16 v99, v53, v134, v99
v_dot2_f32_bf16 v100, v54, v133, v100
v_dot2_f32_bf16 v101, v54, v134, v101
v_dot2_f32_bf16 v102, v55, v133, v102
v_dot2_f32_bf16 v103, v55, v134, v103
v_dot2_f32_bf16 v96, v56, v133, v96
v_dot2_f32_bf16 v97, v56, v134, v97
v_dot2_f32_bf16 v98, v57, v133, v98
v_dot2_f32_bf16 v99, v57, v134, v99
v_dot2_f32_bf16 v100, v58, v133, v100
v_dot2_f32_bf16 v101, v58, v134, v101
v_dot2_f32_bf16 v102, v59, v133, v102
v_dot2_f32_bf16 v103, v59, v134, v103
v_dot2_f32_bf16 v96, v60, v133, v96
v_dot2_f32_bf16 v97, v60, v134, v97
v_dot2_f32_bf16 v98, v61, v133, v98
v_dot2_f32_bf16 v99, v61, v134, v99
v_dot2_f32_bf16 v100, v62, v133, v100
v_dot2_f32_bf16 v101, v62, v134, v101
v_dot2_f32_bf16 v102, v63, v133, v102
v_dot2_f32_bf16 v103, v63, v134, v103
s_waitcnt vmcnt(0)
v_dot2_f32_bf16 v104, v80, v133, 0
v_dot2_f32_bf16 v105, v80, v134, 0
v_dot2_f32_bf16 v104, v81, v133, v104
v_dot2_f32_bf16 v105, v81, v134, v105
v_dot2_f32_bf16 v104, v82, v133, v104
v_dot2_f32_bf16 v105, v82, v134, v105
v_dot2_f32_bf16 v104, v83, v133, v104
v_dot2_f32_bf16 v105, v83, v134, v105
v_mul_f32 v136, 0xbfb8aa3b, v88
v_mul_f32 v137, 0xbfb8aa3b, v89
v_mul_f32 v138, 0xbfb8aa3b, v90
v_mul_f32 v139, 0xbfb8aa3b, v91
v_mul_f32 v140, 0xbfb8aa3b, v92
v_mul_f32 v141, 0xbfb8aa3b, v93
v_mul_f32 v142, 0xbfb8aa3b, v94
v_mul_f32 v143, 0xbfb8aa3b, v95
v_mul_f32 v144, 0xbfb8aa3b, v96
v_mul_f32 v145, 0xbfb8aa3b, v97
v_mul_f32 v146, 0xbfb8aa3b, v98
v_mul_f32 v147, 0xbfb8aa3b, v99
v_mul_f32 v148, 0xbfb8aa3b, v100
v_mul_f32 v149, 0xbfb8aa3b, v101
v_mul_f32 v150, 0xbfb8aa3b, v102
v_mul_f32 v151, 0xbfb8aa3b, v103
v_mul_f32 v152, 0xbfb8aa3b, v104
v_mul_f32 v153, 0xbfb8aa3b, v105
v_exp_f32 v136, v136
v_exp_f32 v137, v137
v_exp_f32 v138, v138
v_exp_f32 v139, v139
v_exp_f32 v140, v140
v_exp_f32 v141, v141
v_exp_f32 v142, v142
v_exp_f32 v143, v143
v_exp_f32 v144, v144
v_exp_f32 v145, v145
v_exp_f32 v146, v146
v_exp_f32 v147, v147
v_exp_f32 v148, v148
v_exp_f32 v149, v149
v_exp_f32 v150, v150
v_exp_f32 v151, v151
v_exp_f32 v152, v152
v_exp_f32 v153, v153
v_add_f32 v136, 1.0, v136
v_add_f32 v137, 1.0, v137
v_add_f32 v138, 1.0, v138
v_add_f32 v139, 1.0, v139
v_add_f32 v140, 1.0, v140
v_add_f32 v141, 1.0, v141
v_add_f32 v142, 1.0, v142
v_add_f32 v143, 1.0, v143
v_add_f32 v144, 1.0, v144
v_add_f32 v145, 1.0, v145
v_add_f32 v146, 1.0, v146
v_add_f32 v147, 1.0, v147
v_add_f32 v148, 1.0, v148
v_add_f32 v149, 1.0, v149
v_add_f32 v150, 1.0, v150
v_add_f32 v151, 1.0, v151
v_add_f32 v152, 1.0, v152
v_add_f32 v153, 1.0, v153
v_rcp_f32 v136, v136
v_rcp_f32 v137, v137
v_rcp_f32 v138, v138
v_rcp_f32 v139, v139
v_rcp_f32 v140, v140
v_rcp_f32 v141, v141
v_rcp_f32 v142, v142
v_rcp_f32 v143, v143
v_rcp_f32 v144, v144
v_rcp_f32 v145, v145
v_rcp_f32 v146, v146
v_rcp_f32 v147, v147
v_rcp_f32 v148, v148
v_rcp_f32 v149, v149
v_rcp_f32 v150, v150
v_rcp_f32 v151, v151
v_rcp_f32 v152, v152
v_rcp_f32 v153, v153
v_mul_f32 v88, v88, v136
v_mul_f32 v89, v89, v137
v_mul_f32 v90, v90, v138
v_mul_f32 v91, v91, v139
v_mul_f32 v92, v92, v140
v_mul_f32 v93, v93, v141
v_mul_f32 v94, v94, v142
v_mul_f32 v95, v95, v143
v_mul_f32 v96, v96, v144
v_mul_f32 v97, v97, v145
v_mul_f32 v98, v98, v146
v_mul_f32 v99, v99, v147
v_mul_f32 v100, v100, v148
v_mul_f32 v101, v101, v149
v_mul_f32 v102, v102, v150
v_mul_f32 v103, v103, v151
v_mul_f32 v104, v104, v152
v_mul_f32 v105, v105, v153
s_waitcnt lgkmcnt(0)
s_mov_b32 s58, 2359296
s_mov_b32 s59, 0x20000
s_mov_b32 s71, 0x20000
buffer_load_dword v7, v6, s[8:11], s67 offen sc1
s_sleep 3
buffer_load_dword v150, v6, s[8:11], s67 offen sc1
s_sleep 3
buffer_load_dword v151, v6, s[8:11], s67 offen sc1
mk_poll_SS:
s_waitcnt vmcnt(2)
v_cmp_eq_u32 vcc, s100, v7
s_sub_u32 s71, s71, 1
s_cbranch_scc1 mk_pollx_SS
s_nop 1
s_and_b32 s43, vcc_lo, 15
s_cmp_eq_u32 s43, 15
s_cbranch_scc1 mk_pollx_SS
buffer_load_dword v7, v6, s[8:11], s67 offen sc1
s_sleep 3
s_waitcnt vmcnt(2)
v_cmp_eq_u32 vcc, s100, v150
s_sub_u32 s71, s71, 1
s_cbranch_scc1 mk_pollx_SS
s_nop 1
s_and_b32 s43, vcc_lo, 15
s_cmp_eq_u32 s43, 15
s_cbranch_scc1 mk_pollx_SS
buffer_load_dword v150, v6, s[8:11], s67 offen sc1
s_sleep 3
s_waitcnt vmcnt(2)
v_cmp_eq_u32 vcc, s100, v151
s_sub_u32 s71, s71, 1
s_cbranch_scc1 mk_pollx_SS
s_nop 1
s_and_b32 s43, vcc_lo, 15
s_cmp_eq_u32 s43, 15
s_cbranch_scc1 mk_pollx_SS
buffer_load_dword v151, v6, s[8:11], s67 offen sc1
s_sleep 3
s_branch mk_poll_SS
mk_pollx_SS:
s_add_u32 s27, s25, 50331648
buffer_load_dwordx4 v[16:19], v9, s[8:11], s27 offen sc1
s_add_u32 s27, s25, 52690944
buffer_load_dwordx4 v[20:23], v9, s[8:11], s27 offen sc1
s_add_u32 s27, s25, 55050240
buffer_load_dwordx4 v[24:27], v9, s[8:11], s27 offen sc1
s_add_u32 s27, s25, 57409536
buffer_load_dwordx4 v[28:31], v9, s[8:11], s27 offen sc1
s_add_u32 s27, s25, 50339840
buffer_load_dwordx4 v[48:51], v9, s[8:11], s27 offen sc1
s_add_u32 s27, s25, 52699136
buffer_load_dwordx4 v[52:55], v9, s[8:11], s27 offen sc1
s_add_u32 s27, s25, 55058432
buffer_load_dwordx4 v[56:59], v9, s[8:11], s27 offen sc1
s_add_u32 s27, s25, 57417728
buffer_load_dwordx4 v[60:63], v9, s[8:11], s27 offen sc1
s_add_u32 s27, s26, 50331648
buffer_load_dword v80, v9, s[8:11], s27 offen sc1
s_add_u32 s27, s26, 52690944
buffer_load_dword v81, v9, s[8:11], s27 offen sc1
s_add_u32 s27, s26, 55050240
buffer_load_dword v82, v9, s[8:11], s27 offen sc1
s_add_u32 s27, s26, 57409536
buffer_load_dword v83, v9, s[8:11], s27 offen sc1
s_waitcnt vmcnt(8)
v_dot2_f32_bf16 v106, v16, v133, 0
v_dot2_f32_bf16 v107, v16, v134, 0
v_dot2_f32_bf16 v108, v17, v133, 0
v_dot2_f32_bf16 v109, v17, v134, 0
v_dot2_f32_bf16 v110, v18, v133, 0
v_dot2_f32_bf16 v111, v18, v134, 0
v_dot2_f32_bf16 v112, v19, v133, 0
v_dot2_f32_bf16 v113, v19, v134, 0
v_dot2_f32_bf16 v106, v20, v133, v106
v_dot2_f32_bf16 v107, v20, v134, v107
v_dot2_f32_bf16 v108, v21, v133, v108
v_dot2_f32_bf16 v109, v21, v134, v109
v_dot2_f32_bf16 v110, v22, v133, v110
v_dot2_f32_bf16 v111, v22, v134, v111
v_dot2_f32_bf16 v112, v23, v133, v112
v_dot2_f32_bf16 v113, v23, v134, v113
v_dot2_f32_bf16 v106, v24, v133, v106
v_dot2_f32_bf16 v107, v24, v134, v107
v_dot2_f32_bf16 v108, v25, v133, v108
v_dot2_f32_bf16 v109, v25, v134, v109
v_dot2_f32_bf16 v110, v26, v133, v110
v_dot2_f32_bf16 v111, v26, v134, v111
v_dot2_f32_bf16 v112, v27, v133, v112
v_dot2_f32_bf16 v113, v27, v134, v113
v_dot2_f32_bf16 v106, v28, v133, v106
v_dot2_f32_bf16 v107, v28, v134, v107
v_dot2_f32_bf16 v108, v29, v133, v108
v_dot2_f32_bf16 v109, v29, v134, v109
v_dot2_f32_bf16 v110, v30, v133, v110
v_dot2_f32_bf16 v111, v30, v134, v111
v_dot2_f32_bf16 v112, v31, v133, v112
v_dot2_f32_bf16 v113, v31, v134, v113
v_fma_f32 v156, v106, v88, v156
v_fma_f32 v157, v107, v89, v157
v_fma_f32 v158, v108, v90, v158
v_fma_f32 v159, v109, v91, v159
v_fma_f32 v160, v110, v92, v160
v_fma_f32 v161, v111, v93, v161
v_fma_f32 v162, v112, v94, v162
v_fma_f32 v163, v113, v95, v163
v_cvt_pk_bf16_f32 v176, v156, v157
v_cvt_pk_bf16_f32 v177, v158, v159
v_cvt_pk_bf16_f32 v178, v160, v161
v_cvt_pk_bf16_f32 v179, v162, v163
buffer_store_dwordx2 v[176:177], v2, s[56:59], s20 offen
buffer_store_dwordx2 v[178:179], v3, s[56:59], s20 offen
s_waitcnt vmcnt(6)
v_dot2_f32_bf16 v114, v48, v133, 0
v_dot2_f32_bf16 v115, v48, v134, 0
v_dot2_f32_bf16 v116, v49, v133, 0
v_dot2_f32_bf16 v117, v49, v134, 0
v_dot2_f32_bf16 v118, v50, v133, 0
v_dot2_f32_bf16 v119, v50, v134, 0
v_dot2_f32_bf16 v120, v51, v133, 0
v_dot2_f32_bf16 v121, v51, v134, 0
v_dot2_f32_bf16 v114, v52, v133, v114
v_dot2_f32_bf16 v115, v52, v134, v115
v_dot2_f32_bf16 v116, v53, v133, v116
v_dot2_f32_bf16 v117, v53, v134, v117
v_dot2_f32_bf16 v118, v54, v133, v118
v_dot2_f32_bf16 v119, v54, v134, v119
v_dot2_f32_bf16 v120, v55, v133, v120
v_dot2_f32_bf16 v121, v55, v134, v121
v_dot2_f32_bf16 v114, v56, v133, v114
v_dot2_f32_bf16 v115, v56, v134, v115
v_dot2_f32_bf16 v116, v57, v133, v116
v_dot2_f32_bf16 v117, v57, v134, v117
v_dot2_f32_bf16 v118, v58, v133, v118
v_dot2_f32_bf16 v119, v58, v134, v119
v_dot2_f32_bf16 v120, v59, v133, v120
v_dot2_f32_bf16 v121, v59, v134, v121
v_dot2_f32_bf16 v114, v60, v133, v114
v_dot2_f32_bf16 v115, v60, v134, v115
v_dot2_f32_bf16 v116, v61, v133, v116
v_dot2_f32_bf16 v117, v61, v134, v117
v_dot2_f32_bf16 v118, v62, v133, v118
v_dot2_f32_bf16 v119, v62, v134, v119
v_dot2_f32_bf16 v120, v63, v133, v120
v_dot2_f32_bf16 v121, v63, v134, v121
v_fma_f32 v164, v114, v96, v164
v_fma_f32 v165, v115, v97, v165
v_fma_f32 v166, v116, v98, v166
v_fma_f32 v167, v117, v99, v167
v_fma_f32 v168, v118, v100, v168
v_fma_f32 v169, v119, v101, v169
v_fma_f32 v170, v120, v102, v170
v_fma_f32 v171, v121, v103, v171
v_cvt_pk_bf16_f32 v180, v164, v165
v_cvt_pk_bf16_f32 v181, v166, v167
v_cvt_pk_bf16_f32 v182, v168, v169
v_cvt_pk_bf16_f32 v183, v170, v171
buffer_store_dwordx2 v[180:181], v2, s[56:59], s21 offen
buffer_store_dwordx2 v[182:183], v3, s[56:59], s21 offen
s_waitcnt vmcnt(4)
v_dot2_f32_bf16 v122, v80, v133, 0
v_dot2_f32_bf16 v123, v80, v134, 0
v_dot2_f32_bf16 v122, v81, v133, v122
v_dot2_f32_bf16 v123, v81, v134, v123
v_dot2_f32_bf16 v122, v82, v133, v122
v_dot2_f32_bf16 v123, v82, v134, v123
v_dot2_f32_bf16 v122, v83, v133, v122
v_dot2_f32_bf16 v123, v83, v134, v123
s_nop 1
v_fma_f32 v172, v122, v104, v172
v_fma_f32 v173, v123, v105, v173
v_cvt_pk_bf16_f32 v184, v172, v173
buffer_store_dword v184, v2, s[56:59], s22 offen
s_waitcnt vmcnt(0)
s_waitcnt vmcnt(0)
s_endpgm
mk_Y:
s_waitcnt lgkmcnt(1)
v_mfma_f32_16x16x32_bf16 v[128:131], v[16:19], v[192:195], 0
ds_read_b64_tr_b16 v[28:29], v33 offset:57344
v_mfma_f32_16x16x32_bf16 v[132:135], v[16:19], v[196:199], 0
ds_read_b64_tr_b16 v[30:31], v33 offset:61440
buffer_load_dword v43, v42, s[8:11], s66 offen sc1
v_mfma_f32_16x16x32_bf16 v[136:139], v[16:19], v[200:203], 0
buffer_load_dwordx4 v11, s[20:23], s40 offen offset:1024 lds
v_mfma_f32_16x16x32_bf16 v[140:143], v[16:19], v[204:207], 0
v_exp_f32 v96, v96
v_mfma_f32_16x16x32_bf16 a[0:3], v[20:23], v[176:179], a[0:3]
ds_read_b128 v[16:19], v6 offset:8192
v_mfma_f32_16x16x32_bf16 a[4:7], v[20:23], v[180:183], a[4:7]
v_exp_f32 v97, v97
v_mfma_f32_16x16x32_bf16 a[8:11], v[20:23], v[184:187], a[8:11]
v_exp_f32 v98, v98
v_mfma_f32_16x16x32_bf16 a[12:15], v[20:23], v[188:191], a[12:15]
v_exp_f32 v99, v99
s_waitcnt lgkmcnt(1)
v_mfma_f32_16x16x32_bf16 v[128:131], v[24:27], v[208:211], v[128:131]
ds_read_b64_tr_b16 v[20:21], v34 offset:57344
v_cvt_pk_bf16_f32 v160, v96, v97
v_mfma_f32_16x16x32_bf16 v[132:135], v[24:27], v[212:215], v[132:135]
ds_read_b64_tr_b16 v[22:23], v34 offset:61440
s_add_u32 m0, s46, 106496
v_cvt_pk_bf16_f32 v161, v98, v99
v_mfma_f32_16x16x32_bf16 v[136:139], v[24:27], v[216:219], v[136:139]
s_add_u32 s40, s35, 106496
v_exp_f32 v100, v100
v_mfma_f32_16x16x32_bf16 v[140:143], v[24:27], v[220:223], v[140:143]
v_exp_f32 v101, v101
v_mfma_f32_16x16x32_bf16 a[16:19], v[28:31], v[176:179], a[16:19]
ds_read_b128 v[24:27], v7 offset:8192
v_cvt_pk_bf16_f32 v164, v100, v101
v_mfma_f32_16x16x32_bf16 a[20:23], v[28:31], v[180:183], a[20:23]
buffer_load_dwordx4 v10, s[24:27], s40 offen lds
v_mfma_f32_16x16x32_bf16 a[24:27], v[28:31], v[184:187], a[24:27]
v_exp_f32 v102, v102
v_mfma_f32_16x16x32_bf16 a[28:31], v[28:31], v[188:191], a[28:31]
v_exp_f32 v103, v103
v_mfma_f32_16x16x32_bf16 a[128:131], a[144:147], v[176:179], a[128:131]
v_exp_f32 v104, v104
s_waitcnt lgkmcnt(1)
v_mfma_f32_16x16x32_bf16 v[128:131], v[16:19], v[224:227], v[128:131]
ds_read_b64_tr_b16 v[28:29], v35 offset:57344
v_cvt_pk_bf16_f32 v165, v102, v103
v_mfma_f32_16x16x32_bf16 v[132:135], v[16:19], v[228:231], v[132:135]
ds_read_b64_tr_b16 v[30:31], v35 offset:61440
v_mfma_f32_16x16x32_bf16 v[136:139], v[16:19], v[232:235], v[136:139]
v_exp_f32 v105, v105
v_mfma_f32_16x16x32_bf16 v[140:143], v[16:19], v[236:239], v[140:143]
v_exp_f32 v106, v106
v_mfma_f32_16x16x32_bf16 a[32:35], v[20:23], v[176:179], a[32:35]
ds_read_b128 v[16:19], v4 offset:12288
v_cvt_pk_bf16_f32 v168, v104, v105
v_mfma_f32_16x16x32_bf16 a[36:39], v[20:23], v[180:183], a[36:39]
v_exp_f32 v107, v107
v_mfma_f32_16x16x32_bf16 a[40:43], v[20:23], v[184:187], a[40:43]
v_exp_f32 v108, v108
v_mfma_f32_16x16x32_bf16 a[44:47], v[20:23], v[188:191], a[44:47]
buffer_load_dwordx4 v11, s[24:27], s40 offen offset:1024 lds
s_lshl_b32 s72, s28, 13
s_waitcnt lgkmcnt(1)
v_mfma_f32_16x16x32_bf16 v[128:131], v[24:27], v[240:243], v[128:131]
ds_read_b64_tr_b16 v[20:21], v36 offset:57344
s_add_u32 s72, s72, mk_LY_A9-mk_pc
v_lshl_add_u32 v56, v0, 7, s72
v_mfma_f32_16x16x32_bf16 v[132:135], v[24:27], v[244:247], v[132:135]
ds_read_b64_tr_b16 v[22:23], v36 offset:61440
v_min_u32 v56, mk_fin-mk_pc, v56
v_mfma_f32_16x16x32_bf16 v[136:139], v[24:27], v[248:251], v[136:139]
global_load_dword v57, v56, s[4:5]
v_mfma_f32_16x16x32_bf16 v[140:143], v[24:27], v[252:255], v[140:143]
v_exp_f32 v109, v109
v_mfma_f32_16x16x32_bf16 a[48:51], v[28:31], v[176:179], a[48:51]
ds_read_b128 v[24:27], v5 offset:12288
v_cvt_pk_bf16_f32 v169, v106, v107
v_mfma_f32_16x16x32_bf16 a[52:55], v[28:31], v[180:183], a[52:55]
v_exp_f32 v110, v110
v_mfma_f32_16x16x32_bf16 a[56:59], v[28:31], v[184:187], a[56:59]
v_exp_f32 v111, v111
v_mfma_f32_16x16x32_bf16 a[60:63], v[28:31], v[188:191], a[60:63]
v_exp_f32 v112, v112
v_mfma_f32_16x16x32_bf16 a[132:135], a[144:147], v[180:183], a[132:135]
v_exp_f32 v113, v113
s_waitcnt lgkmcnt(1)
v_mfma_f32_16x16x32_bf16 v[144:147], v[16:19], v[192:195], 0
ds_read_b64_tr_b16 v[28:29], v37 offset:57344
v_cvt_pk_bf16_f32 v172, v108, v109
v_mfma_f32_16x16x32_bf16 v[148:151], v[16:19], v[196:199], 0
ds_read_b64_tr_b16 v[30:31], v37 offset:61440
v_cvt_pk_bf16_f32 v173, v110, v111
v_mfma_f32_16x16x32_bf16 v[152:155], v[16:19], v[200:203], 0
v_exp_f32 v114, v114
v_mfma_f32_16x16x32_bf16 v[156:159], v[16:19], v[204:207], 0
v_exp_f32 v115, v115
v_mfma_f32_16x16x32_bf16 a[64:67], v[20:23], v[176:179], a[64:67]
ds_read_b128 v[16:19], v6 offset:12288
v_cvt_pk_bf16_f32 v162, v112, v113
v_mfma_f32_16x16x32_bf16 a[68:71], v[20:23], v[180:183], a[68:71]
v_exp_f32 v116, v116
v_mfma_f32_16x16x32_bf16 a[72:75], v[20:23], v[184:187], a[72:75]
v_exp_f32 v117, v117
v_mfma_f32_16x16x32_bf16 a[76:79], v[20:23], v[188:191], a[76:79]
v_exp_f32 v118, v118
s_waitcnt lgkmcnt(1)
v_mfma_f32_16x16x32_bf16 v[144:147], v[24:27], v[208:211], v[144:147]
ds_read_b64_tr_b16 v[20:21], v38 offset:57344
v_cvt_pk_bf16_f32 v163, v114, v115
v_mfma_f32_16x16x32_bf16 v[148:151], v[24:27], v[212:215], v[148:151]
ds_read_b64_tr_b16 v[22:23], v38 offset:61440
v_cvt_pk_bf16_f32 v166, v116, v117
v_mfma_f32_16x16x32_bf16 v[152:155], v[24:27], v[216:219], v[152:155]
v_exp_f32 v119, v119
v_mfma_f32_16x16x32_bf16 v[156:159], v[24:27], v[220:223], v[156:159]
v_exp_f32 v120, v120
v_mfma_f32_16x16x32_bf16 a[80:83], v[28:31], v[176:179], a[80:83]
ds_read_b128 v[24:27], v7 offset:12288
v_cvt_pk_bf16_f32 v167, v118, v119
v_mfma_f32_16x16x32_bf16 a[84:87], v[28:31], v[180:183], a[84:87]
v_exp_f32 v121, v121
v_mfma_f32_16x16x32_bf16 a[88:91], v[28:31], v[184:187], a[88:91]
v_exp_f32 v122, v122
v_mfma_f32_16x16x32_bf16 a[92:95], v[28:31], v[188:191], a[92:95]
v_exp_f32 v123, v123
v_mfma_f32_16x16x32_bf16 a[136:139], a[144:147], v[184:187], a[136:139]
v_exp_f32 v124, v124
s_waitcnt lgkmcnt(1)
v_mfma_f32_16x16x32_bf16 v[144:147], v[16:19], v[224:227], v[144:147]
ds_read_b64_tr_b16 v[28:29], v39 offset:57344
v_cvt_pk_bf16_f32 v170, v120, v121
v_mfma_f32_16x16x32_bf16 v[148:151], v[16:19], v[228:231], v[148:151]
ds_read_b64_tr_b16 v[30:31], v39 offset:61440
v_cvt_pk_bf16_f32 v171, v122, v123
v_mfma_f32_16x16x32_bf16 v[152:155], v[16:19], v[232:235], v[152:155]
v_exp_f32 v125, v125
v_mfma_f32_16x16x32_bf16 v[156:159], v[16:19], v[236:239], v[156:159]
v_exp_f32 v126, v126
v_mfma_f32_16x16x32_bf16 a[96:99], v[20:23], v[176:179], a[96:99]
s_waitcnt vmcnt(26)
s_barrier
ds_read_b128 v[16:19], v4 offset:16384
v_mfma_f32_16x16x32_bf16 a[100:103], v[20:23], v[180:183], a[100:103]
s_add_u32 m0, s46, 114688
s_add_u32 s40, s35, 114688
buffer_load_dwordx4 v10, s[24:27], s40 offen lds
v_mfma_f32_16x16x32_bf16 a[104:107], v[20:23], v[184:187], a[104:107]
v_exp_f32 v127, v127
v_mfma_f32_16x16x32_bf16 a[108:111], v[20:23], v[188:191], a[108:111]
v_cvt_pk_bf16_f32 v174, v124, v125
v_cvt_pk_bf16_f32 v175, v126, v127
s_waitcnt lgkmcnt(1)
v_mfma_f32_16x16x32_bf16 v[144:147], v[24:27], v[240:243], v[144:147]
ds_read_b64_tr_b16 v[20:21], v32 offset:0
v_mfma_f32_16x16x32_bf16 v[148:151], v[24:27], v[244:247], v[148:151]
ds_read_b64_tr_b16 v[22:23], v32 offset:4096
v_mfma_f32_16x16x32_bf16 v[152:155], v[24:27], v[248:251], v[152:155]
v_mfma_f32_16x16x32_bf16 v[156:159], v[24:27], v[252:255], v[156:159]
v_mfma_f32_16x16x32_bf16 a[112:115], v[28:31], v[176:179], a[112:115]
ds_read_b128 v[24:27], v5 offset:16384
v_mfma_f32_16x16x32_bf16 a[116:119], v[28:31], v[180:183], a[116:119]
v_mfma_f32_16x16x32_bf16 a[120:123], v[28:31], v[184:187], a[120:123]
v_mfma_f32_16x16x32_bf16 a[124:127], v[28:31], v[188:191], a[124:127]
v_mfma_f32_16x16x32_bf16 a[140:143], a[144:147], v[188:191], a[140:143]
mk_LY_A9:
s_waitcnt lgkmcnt(1)
v_mfma_f32_16x16x32_bf16 v[96:99], v[16:19], v[192:195], 0
ds_read_b64_tr_b16 v[28:29], v33 offset:0
v_mfma_f32_16x16x32_bf16 v[100:103], v[16:19], v[196:199], 0
ds_read_b64_tr_b16 v[30:31], v33 offset:4096
v_mfma_f32_16x16x32_bf16 v[104:107], v[16:19], v[200:203], 0
s_waitcnt vmcnt(5)
v_cmp_eq_u32 vcc, s100, v43
s_nop 3
s_and_b32 s43, vcc_lo, 0xff
s_cmp_eq_u32 s43, 0xff
s_cbranch_scc0 mk_slowH
mk_backH:
v_mfma_f32_16x16x32_bf16 v[108:111], v[16:19], v[204:207], 0
buffer_load_dwordx4 v11, s[24:27], s40 offen offset:1024 lds
s_add_u32 s41, s61, 0
v_mfma_f32_16x16x32_bf16 a[0:3], v[20:23], v[160:163], a[0:3]
ds_read_b128 v[16:19], v6 offset:16384
v_mfma_f32_16x16x32_bf16 a[4:7], v[20:23], v[164:167], a[4:7]
buffer_load_dwordx4 a[160:163], v9, s[8:11], s41 offen offset:0 sc1
v_mfma_f32_16x16x32_bf16 a[8:11], v[20:23], v[168:171], a[8:11]
v_exp_f32 v128, v128
v_mfma_f32_16x16x32_bf16 a[12:15], v[20:23], v[172:175], a[12:15]
v_exp_f32 v129, v129
s_waitcnt lgkmcnt(1)
v_mfma_f32_16x16x32_bf16 v[96:99], v[24:27], v[208:211], v[96:99]
ds_read_b64_tr_b16 v[20:21], v34 offset:0
v_cvt_pk_bf16_f32 v176, v128, v129
v_mfma_f32_16x16x32_bf16 v[100:103], v[24:27], v[212:215], v[100:103]
ds_read_b64_tr_b16 v[22:23], v34 offset:4096
v_mfma_f32_16x16x32_bf16 v[104:107], v[24:27], v[216:219], v[104:107]
v_exp_f32 v130, v130
v_mfma_f32_16x16x32_bf16 v[108:111], v[24:27], v[220:223], v[108:111]
v_exp_f32 v131, v131
v_mfma_f32_16x16x32_bf16 a[16:19], v[28:31], v[160:163], a[16:19]
ds_read_b128 v[24:27], v7 offset:16384
v_cvt_pk_bf16_f32 v177, v130, v131
v_mfma_f32_16x16x32_bf16 a[20:23], v[28:31], v[164:167], a[20:23]
v_exp_f32 v132, v132
v_mfma_f32_16x16x32_bf16 a[24:27], v[28:31], v[168:171], a[24:27]
v_exp_f32 v133, v133
v_mfma_f32_16x16x32_bf16 a[28:31], v[28:31], v[172:175], a[28:31]
v_exp_f32 v134, v134
v_mfma_f32_16x16x32_bf16 a[128:131], a[144:147], v[160:163], a[128:131]
buffer_load_dwordx4 a[164:167], v9, s[8:11], s41 offen offset:1024 sc1
s_waitcnt lgkmcnt(1)
v_mfma_f32_16x16x32_bf16 v[96:99], v[16:19], v[224:227], v[96:99]
ds_read_b64_tr_b16 v[28:29], v35 offset:0
v_cvt_pk_bf16_f32 v180, v132, v133
v_mfma_f32_16x16x32_bf16 v[100:103], v[16:19], v[228:231], v[100:103]
ds_read_b64_tr_b16 v[30:31], v35 offset:4096
v_mfma_f32_16x16x32_bf16 v[104:107], v[16:19], v[232:235], v[104:107]
v_exp_f32 v135, v135
v_mfma_f32_16x16x32_bf16 v[108:111], v[16:19], v[236:239], v[108:111]
v_exp_f32 v136, v136
v_mfma_f32_16x16x32_bf16 a[32:35], v[20:23], v[160:163], a[32:35]
ds_read_b128 v[16:19], v4 offset:20480
v_cvt_pk_bf16_f32 v181, v134, v135
v_mfma_f32_16x16x32_bf16 a[36:39], v[20:23], v[164:167], a[36:39]
v_exp_f32 v137, v137
v_mfma_f32_16x16x32_bf16 a[40:43], v[20:23], v[168:171], a[40:43]
v_exp_f32 v138, v138
v_mfma_f32_16x16x32_bf16 a[44:47], v[20:23], v[172:175], a[44:47]
v_exp_f32 v139, v139
s_waitcnt lgkmcnt(1)
v_mfma_f32_16x16x32_bf16 v[96:99], v[24:27], v[240:243], v[96:99]
ds_read_b64_tr_b16 v[20:21], v36 offset:0
v_cvt_pk_bf16_f32 v184, v136, v137
v_mfma_f32_16x16x32_bf16 v[100:103], v[24:27], v[244:247], v[100:103]
ds_read_b64_tr_b16 v[22:23], v36 offset:4096
v_cvt_pk_bf16_f32 v185, v138, v139
v_mfma_f32_16x16x32_bf16 v[104:107], v[24:27], v[248:251], v[104:107]
v_exp_f32 v140, v140
v_mfma_f32_16x16x32_bf16 v[108:111], v[24:27], v[252:255], v[108:111]
buffer_load_dwordx4 a[168:171], v9, s[8:11], s41 offen offset:2048 sc1
v_mfma_f32_16x16x32_bf16 a[48:51], v[28:31], v[160:163], a[48:51]
ds_read_b128 v[24:27], v5 offset:20480
v_mfma_f32_16x16x32_bf16 a[52:55], v[28:31], v[164:167], a[52:55]
v_exp_f32 v141, v141
v_mfma_f32_16x16x32_bf16 a[56:59], v[28:31], v[168:171], a[56:59]
v_exp_f32 v142, v142
v_mfma_f32_16x16x32_bf16 a[60:63], v[28:31], v[172:175], a[60:63]
v_exp_f32 v143, v143
v_mfma_f32_16x16x32_bf16 a[132:135], a[144:147], v[164:167], a[132:135]
v_exp_f32 v144, v144
s_waitcnt lgkmcnt(1)
v_mfma_f32_16x16x32_bf16 v[112:115], v[16:19], v[192:195], 0
ds_read_b64_tr_b16 v[28:29], v37 offset:0
v_cvt_pk_bf16_f32 v188, v140, v141
v_mfma_f32_16x16x32_bf16 v[116:119], v[16:19], v[196:199], 0
ds_read_b64_tr_b16 v[30:31], v37 offset:4096
v_cvt_pk_bf16_f32 v189, v142, v143
v_mfma_f32_16x16x32_bf16 v[120:123], v[16:19], v[200:203], 0
v_exp_f32 v145, v145
v_mfma_f32_16x16x32_bf16 v[124:127], v[16:19], v[204:207], 0
v_exp_f32 v146, v146
v_mfma_f32_16x16x32_bf16 a[64:67], v[20:23], v[160:163], a[64:67]
ds_read_b128 v[16:19], v6 offset:20480
v_cvt_pk_bf16_f32 v178, v144, v145
v_mfma_f32_16x16x32_bf16 a[68:71], v[20:23], v[164:167], a[68:71]
v_exp_f32 v147, v147
v_mfma_f32_16x16x32_bf16 a[72:75], v[20:23], v[168:171], a[72:75]
buffer_load_dwordx4 a[172:175], v9, s[8:11], s41 offen offset:3072 sc1
v_mfma_f32_16x16x32_bf16 a[76:79], v[20:23], v[172:175], a[76:79]
v_exp_f32 v148, v148
s_waitcnt lgkmcnt(1)
v_mfma_f32_16x16x32_bf16 v[112:115], v[24:27], v[208:211], v[112:115]
ds_read_b64_tr_b16 v[20:21], v38 offset:0
v_cvt_pk_bf16_f32 v179, v146, v147
v_mfma_f32_16x16x32_bf16 v[116:119], v[24:27], v[212:215], v[116:119]
ds_read_b64_tr_b16 v[22:23], v38 offset:4096
v_mfma_f32_16x16x32_bf16 v[120:123], v[24:27], v[216:219], v[120:123]
v_exp_f32 v149, v149
v_mfma_f32_16x16x32_bf16 v[124:127], v[24:27], v[220:223], v[124:127]
v_exp_f32 v150, v150
v_mfma_f32_16x16x32_bf16 a[80:83], v[28:31], v[160:163], a[80:83]
ds_read_b128 v[24:27], v7 offset:20480
v_cvt_pk_bf16_f32 v182, v148, v149
v_mfma_f32_16x16x32_bf16 a[84:87], v[28:31], v[164:167], a[84:87]
v_exp_f32 v151, v151
v_mfma_f32_16x16x32_bf16 a[88:91], v[28:31], v[168:171], a[88:91]
v_exp_f32 v152, v152
v_mfma_f32_16x16x32_bf16 a[92:95], v[28:31], v[172:175], a[92:95]
v_exp_f32 v153, v153
v_mfma_f32_16x16x32_bf16 a[136:139], a[144:147], v[168:171], a[136:139]
s_add_u32 s41, s61, 4096
v_exp_f32 v154, v154
s_waitcnt lgkmcnt(1)
v_mfma_f32_16x16x32_bf16 v[112:115], v[16:19], v[224:227], v[112:115]
ds_read_b64_tr_b16 v[28:29], v39 offset:0
v_cvt_pk_bf16_f32 v183, v150, v151
v_mfma_f32_16x16x32_bf16 v[116:119], v[16:19], v[228:231], v[116:119]
ds_read_b64_tr_b16 v[30:31], v39 offset:4096
v_cvt_pk_bf16_f32 v186, v152, v153
v_mfma_f32_16x16x32_bf16 v[120:123], v[16:19], v[232:235], v[120:123]
buffer_load_dwordx4 a[176:179], v9, s[8:11], s41 offen offset:0 sc1
v_mfma_f32_16x16x32_bf16 v[124:127], v[16:19], v[236:239], v[124:127]
v_exp_f32 v155, v155
v_mfma_f32_16x16x32_bf16 a[96:99], v[20:23], v[160:163], a[96:99]
s_barrier
ds_read_b128 v[16:19], v4 offset:24576
v_mfma_f32_16x16x32_bf16 a[100:103], v[20:23], v[164:167], a[100:103]
s_add_u32 m0, s46, 122880
s_add_u32 s40, s35, 122880
buffer_load_dwordx4 v10, s[24:27], s40 offen lds
v_mfma_f32_16x16x32_bf16 a[104:107], v[20:23], v[168:171], a[104:107]
v_exp_f32 v156, v156
v_mfma_f32_16x16x32_bf16 a[108:111], v[20:23], v[172:175], a[108:111]
v_exp_f32 v157, v157
s_waitcnt lgkmcnt(1)
v_mfma_f32_16x16x32_bf16 v[112:115], v[24:27], v[240:243], v[112:115]
ds_read_b64_tr_b16 v[20:21], v32 offset:8192
v_cvt_pk_bf16_f32 v187, v154, v155
v_mfma_f32_16x16x32_bf16 v[116:119], v[24:27], v[244:247], v[116:119]
ds_read_b64_tr_b16 v[22:23], v32 offset:12288
v_cvt_pk_bf16_f32 v190, v156, v157
v_mfma_f32_16x16x32_bf16 v[120:123], v[24:27], v[248:251], v[120:123]
v_exp_f32 v158, v158
v_mfma_f32_16x16x32_bf16 v[124:127], v[24:27], v[252:255], v[124:127]
v_exp_f32 v159, v159
v_mfma_f32_16x16x32_bf16 a[112:115], v[28:31], v[160:163], a[112:115]
ds_read_b128 v[24:27], v5 offset:24576
v_cvt_pk_bf16_f32 v191, v158, v159
v_mfma_f32_16x16x32_bf16 a[116:119], v[28:31], v[164:167], a[116:119]
buffer_load_dwordx4 a[180:183], v9, s[8:11], s41 offen offset:1024 sc1
v_mfma_f32_16x16x32_bf16 a[120:123], v[28:31], v[168:171], a[120:123]
v_mfma_f32_16x16x32_bf16 a[124:127], v[28:31], v[172:175], a[124:127]
v_mfma_f32_16x16x32_bf16 a[140:143], a[144:147], v[172:175], a[140:143]
s_waitcnt lgkmcnt(1)
v_mfma_f32_16x16x32_bf16 v[128:131], v[16:19], v[192:195], 0
ds_read_b64_tr_b16 v[28:29], v33 offset:8192
v_mfma_f32_16x16x32_bf16 v[132:135], v[16:19], v[196:199], 0
ds_read_b64_tr_b16 v[30:31], v33 offset:12288
v_mfma_f32_16x16x32_bf16 v[136:139], v[16:19], v[200:203], 0
buffer_load_dwordx4 v11, s[24:27], s40 offen offset:1024 lds
v_mfma_f32_16x16x32_bf16 v[140:143], v[16:19], v[204:207], 0
v_exp_f32 v96, v96
v_mfma_f32_16x16x32_bf16 a[0:3], v[20:23], v[176:179], a[0:3]
ds_read_b128 v[16:19], v6 offset:24576
v_mfma_f32_16x16x32_bf16 a[4:7], v[20:23], v[180:183], a[4:7]
v_exp_f32 v97, v97
v_mfma_f32_16x16x32_bf16 a[8:11], v[20:23], v[184:187], a[8:11]
v_exp_f32 v98, v98
v_mfma_f32_16x16x32_bf16 a[12:15], v[20:23], v[188:191], a[12:15]
v_exp_f32 v99, v99
s_waitcnt lgkmcnt(1)
v_mfma_f32_16x16x32_bf16 v[128:131], v[24:27], v[208:211], v[128:131]
ds_read_b64_tr_b16 v[20:21], v34 offset:8192
v_cvt_pk_bf16_f32 v160, v96, v97
v_mfma_f32_16x16x32_bf16 v[132:135], v[24:27], v[212:215], v[132:135]
ds_read_b64_tr_b16 v[22:23], v34 offset:12288
v_cvt_pk_bf16_f32 v161, v98, v99
v_mfma_f32_16x16x32_bf16 v[136:139], v[24:27], v[216:219], v[136:139]
buffer_load_dwordx4 a[184:187], v9, s[8:11], s41 offen offset:2048 sc1
v_mfma_f32_16x16x32_bf16 v[140:143], v[24:27], v[220:223], v[140:143]
v_exp_f32 v100, v100
v_mfma_f32_16x16x32_bf16 a[16:19], v[28:31], v[176:179], a[16:19]
ds_read_b128 v[24:27], v7 offset:24576
v_mfma_f32_16x16x32_bf16 a[20:23], v[28:31], v[180:183], a[20:23]
v_exp_f32 v101, v101
v_mfma_f32_16x16x32_bf16 a[24:27], v[28:31], v[184:187], a[24:27]
v_exp_f32 v102, v102
v_mfma_f32_16x16x32_bf16 a[28:31], v[28:31], v[188:191], a[28:31]
v_exp_f32 v103, v103
v_mfma_f32_16x16x32_bf16 a[128:131], a[144:147], v[176:179], a[128:131]
v_exp_f32 v104, v104
s_waitcnt lgkmcnt(1)
v_mfma_f32_16x16x32_bf16 v[128:131], v[16:19], v[224:227], v[128:131]
ds_read_b64_tr_b16 v[28:29], v35 offset:8192
v_cvt_pk_bf16_f32 v164, v100, v101
v_mfma_f32_16x16x32_bf16 v[132:135], v[16:19], v[228:231], v[132:135]
ds_read_b64_tr_b16 v[30:31], v35 offset:12288
v_cvt_pk_bf16_f32 v165, v102, v103
v_mfma_f32_16x16x32_bf16 v[136:139], v[16:19], v[232:235], v[136:139]
v_exp_f32 v105, v105
v_mfma_f32_16x16x32_bf16 v[140:143], v[16:19], v[236:239], v[140:143]
buffer_load_dwordx4 a[188:191], v9, s[8:11], s41 offen offset:3072 sc1
v_mfma_f32_16x16x32_bf16 a[32:35], v[20:23], v[176:179], a[32:35]
ds_read_b128 v[16:19], v4 offset:28672
v_cvt_pk_bf16_f32 v168, v104, v105
v_mfma_f32_16x16x32_bf16 a[36:39], v[20:23], v[180:183], a[36:39]
v_exp_f32 v106, v106
v_mfma_f32_16x16x32_bf16 a[40:43], v[20:23], v[184:187], a[40:43]
v_exp_f32 v107, v107
v_mfma_f32_16x16x32_bf16 a[44:47], v[20:23], v[188:191], a[44:47]
v_exp_f32 v108, v108
s_waitcnt lgkmcnt(1)
v_mfma_f32_16x16x32_bf16 v[128:131], v[24:27], v[240:243], v[128:131]
ds_read_b64_tr_b16 v[20:21], v36 offset:8192
v_cvt_pk_bf16_f32 v169, v106, v107
v_mfma_f32_16x16x32_bf16 v[132:135], v[24:27], v[244:247], v[132:135]
ds_read_b64_tr_b16 v[22:23], v36 offset:12288
v_mfma_f32_16x16x32_bf16 v[136:139], v[24:27], v[248:251], v[136:139]
v_exp_f32 v109, v109
v_mfma_f32_16x16x32_bf16 v[140:143], v[24:27], v[252:255], v[140:143]
v_exp_f32 v110, v110
v_mfma_f32_16x16x32_bf16 a[48:51], v[28:31], v[176:179], a[48:51]
ds_read_b128 v[24:27], v5 offset:28672
v_cvt_pk_bf16_f32 v172, v108, v109
v_mfma_f32_16x16x32_bf16 a[52:55], v[28:31], v[180:183], a[52:55]
s_add_u32 s41, s61, 8192
v_exp_f32 v111, v111
v_mfma_f32_16x16x32_bf16 a[56:59], v[28:31], v[184:187], a[56:59]
v_exp_f32 v112, v112
v_mfma_f32_16x16x32_bf16 a[60:63], v[28:31], v[188:191], a[60:63]
buffer_load_dwordx4 a[192:195], v9, s[8:11], s41 offen offset:0 sc1
v_mfma_f32_16x16x32_bf16 a[132:135], a[144:147], v[180:183], a[132:135]
v_exp_f32 v113, v113
s_waitcnt lgkmcnt(1)
v_mfma_f32_16x16x32_bf16 v[144:147], v[16:19], v[192:195], 0
ds_read_b64_tr_b16 v[28:29], v37 offset:8192
v_cvt_pk_bf16_f32 v173, v110, v111
v_mfma_f32_16x16x32_bf16 v[148:151], v[16:19], v[196:199], 0
ds_read_b64_tr_b16 v[30:31], v37 offset:12288
v_cvt_pk_bf16_f32 v162, v112, v113
v_mfma_f32_16x16x32_bf16 v[152:155], v[16:19], v[200:203], 0
v_exp_f32 v114, v114
v_mfma_f32_16x16x32_bf16 v[156:159], v[16:19], v[204:207], 0
v_exp_f32 v115, v115
v_mfma_f32_16x16x32_bf16 a[64:67], v[20:23], v[176:179], a[64:67]
ds_read_b128 v[16:19], v6 offset:28672
v_cvt_pk_bf16_f32 v163, v114, v115
v_mfma_f32_16x16x32_bf16 a[68:71], v[20:23], v[180:183], a[68:71]
v_exp_f32 v116, v116
v_mfma_f32_16x16x32_bf16 a[72:75], v[20:23], v[184:187], a[72:75]
v_exp_f32 v117, v117
v_mfma_f32_16x16x32_bf16 a[76:79], v[20:23], v[188:191], a[76:79]
v_exp_f32 v118, v118
s_waitcnt lgkmcnt(1)
v_mfma_f32_16x16x32_bf16 v[144:147], v[24:27], v[208:211], v[144:147]
ds_read_b64_tr_b16 v[20:21], v38 offset:8192
v_cvt_pk_bf16_f32 v166, v116, v117
v_mfma_f32_16x16x32_bf16 v[148:151], v[24:27], v[212:215], v[148:151]
ds_read_b64_tr_b16 v[22:23], v38 offset:12288
v_mfma_f32_16x16x32_bf16 v[152:155], v[24:27], v[216:219], v[152:155]
buffer_load_dwordx4 a[196:199], v9, s[8:11], s41 offen offset:1024 sc1
v_mfma_f32_16x16x32_bf16 v[156:159], v[24:27], v[220:223], v[156:159]
v_exp_f32 v119, v119
v_mfma_f32_16x16x32_bf16 a[80:83], v[28:31], v[176:179], a[80:83]
ds_read_b128 v[24:27], v7 offset:28672
v_cvt_pk_bf16_f32 v167, v118, v119
v_mfma_f32_16x16x32_bf16 a[84:87], v[28:31], v[180:183], a[84:87]
v_exp_f32 v120, v120
v_mfma_f32_16x16x32_bf16 a[88:91], v[28:31], v[184:187], a[88:91]
v_exp_f32 v121, v121
v_mfma_f32_16x16x32_bf16 a[92:95], v[28:31], v[188:191], a[92:95]
v_exp_f32 v122, v122
v_mfma_f32_16x16x32_bf16 a[136:139], a[144:147], v[184:187], a[136:139]
v_exp_f32 v123, v123
s_waitcnt lgkmcnt(1)
v_mfma_f32_16x16x32_bf16 v[144:147], v[16:19], v[224:227], v[144:147]
ds_read_b64_tr_b16 v[28:29], v39 offset:8192
v_cvt_pk_bf16_f32 v170, v120, v121
v_mfma_f32_16x16x32_bf16 v[148:151], v[16:19], v[228:231], v[148:151]
ds_read_b64_tr_b16 v[30:31], v39 offset:12288
v_cvt_pk_bf16_f32 v171, v122, v123
v_mfma_f32_16x16x32_bf16 v[152:155], v[16:19], v[232:235], v[152:155]
v_exp_f32 v124, v124
v_mfma_f32_16x16x32_bf16 v[156:159], v[16:19], v[236:239], v[156:159]
v_exp_f32 v125, v125
v_mfma_f32_16x16x32_bf16 a[96:99], v[20:23], v[176:179], a[96:99]
s_barrier
ds_read_b128 v[16:19], v4 offset:32768
v_mfma_f32_16x16x32_bf16 a[100:103], v[20:23], v[180:183], a[100:103]
buffer_load_dwordx4 a[200:203], v9, s[8:11], s41 offen offset:2048 sc1
v_mfma_f32_16x16x32_bf16 a[104:107], v[20:23], v[184:187], a[104:107]
v_exp_f32 v126, v126
v_mfma_f32_16x16x32_bf16 a[108:111], v[20:23], v[188:191], a[108:111]
v_exp_f32 v127, v127
s_waitcnt lgkmcnt(1)
v_mfma_f32_16x16x32_bf16 v[144:147], v[24:27], v[240:243], v[144:147]
ds_read_b64_tr_b16 v[20:21], v32 offset:16384
v_cvt_pk_bf16_f32 v174, v124, v125
v_mfma_f32_16x16x32_bf16 v[148:151], v[24:27], v[244:247], v[148:151]
ds_read_b64_tr_b16 v[22:23], v32 offset:20480
v_cvt_pk_bf16_f32 v175, v126, v127
v_mfma_f32_16x16x32_bf16 v[152:155], v[24:27], v[248:251], v[152:155]
v_mfma_f32_16x16x32_bf16 v[156:159], v[24:27], v[252:255], v[156:159]
v_mfma_f32_16x16x32_bf16 a[112:115], v[28:31], v[176:179], a[112:115]
ds_read_b128 v[24:27], v5 offset:32768
v_mfma_f32_16x16x32_bf16 a[116:119], v[28:31], v[180:183], a[116:119]
v_mfma_f32_16x16x32_bf16 a[120:123], v[28:31], v[184:187], a[120:123]
v_mfma_f32_16x16x32_bf16 a[124:127], v[28:31], v[188:191], a[124:127]
v_mfma_f32_16x16x32_bf16 a[140:143], a[144:147], v[188:191], a[140:143]
s_movk_i32 s72, 1152
s_mov_b32 s73, 238609295
s_waitcnt lgkmcnt(1)
v_mfma_f32_16x16x32_bf16 v[96:99], v[16:19], v[192:195], 0
ds_read_b64_tr_b16 v[28:29], v33 offset:16384
v_add_u32 v44, 0, v0
v_mfma_f32_16x16x32_bf16 v[100:103], v[16:19], v[196:199], 0
ds_read_b64_tr_b16 v[30:31], v33 offset:20480
v_mul_hi_u32 v45, v44, s73
v_mfma_f32_16x16x32_bf16 v[104:107], v[16:19], v[200:203], 0
buffer_load_dwordx4 a[204:207], v9, s[8:11], s41 offen offset:3072 sc1
v_mfma_f32_16x16x32_bf16 v[108:111], v[16:19], v[204:207], 0
v_exp_f32 v128, v128
v_mfma_f32_16x16x32_bf16 a[0:3], v[20:23], v[160:163], a[0:3]
ds_read_b128 v[16:19], v6 offset:32768
v_mul_u32_u24 v46, 18, v45
v_mfma_f32_16x16x32_bf16 a[4:7], v[20:23], v[164:167], a[4:7]
v_exp_f32 v129, v129
v_mfma_f32_16x16x32_bf16 a[8:11], v[20:23], v[168:171], a[8:11]
v_exp_f32 v130, v130
v_mfma_f32_16x16x32_bf16 a[12:15], v[20:23], v[172:175], a[12:15]
v_exp_f32 v131, v131
s_waitcnt lgkmcnt(1)
v_mfma_f32_16x16x32_bf16 v[96:99], v[24:27], v[208:211], v[96:99]
ds_read_b64_tr_b16 v[20:21], v34 offset:16384
v_sub_u32 v46, v44, v46
v_mfma_f32_16x16x32_bf16 v[100:103], v[24:27], v[212:215], v[100:103]
ds_read_b64_tr_b16 v[22:23], v34 offset:20480
v_mul_lo_u32 v45, v45, s72
v_mfma_f32_16x16x32_bf16 v[104:107], v[24:27], v[216:219], v[104:107]
s_add_u32 s41, s61, 12288
v_exp_f32 v132, v132
v_mfma_f32_16x16x32_bf16 v[108:111], v[24:27], v[220:223], v[108:111]
v_exp_f32 v133, v133
v_mfma_f32_16x16x32_bf16 a[16:19], v[28:31], v[160:163], a[16:19]
ds_read_b128 v[24:27], v7 offset:32768
v_lshl_add_u32 v45, v46, 4, v45
v_mfma_f32_16x16x32_bf16 a[20:23], v[28:31], v[164:167], a[20:23]
buffer_load_dwordx4 a[208:211], v9, s[8:11], s41 offen offset:0 sc1
v_mfma_f32_16x16x32_bf16 a[24:27], v[28:31], v[168:171], a[24:27]
v_exp_f32 v134, v134
v_mfma_f32_16x16x32_bf16 a[28:31], v[28:31], v[172:175], a[28:31]
v_exp_f32 v135, v135
v_mfma_f32_16x16x32_bf16 a[128:131], a[144:147], v[160:163], a[128:131]
v_exp_f32 v136, v136
s_waitcnt lgkmcnt(1)
v_mfma_f32_16x16x32_bf16 v[96:99], v[16:19], v[224:227], v[96:99]
ds_read_b64_tr_b16 v[28:29], v35 offset:16384
v_subrev_u32 v1, 0, v45
v_mfma_f32_16x16x32_bf16 v[100:103], v[16:19], v[228:231], v[100:103]
ds_read_b64_tr_b16 v[30:31], v35 offset:20480
v_add_u32 v44, 64, v0
v_mfma_f32_16x16x32_bf16 v[104:107], v[16:19], v[232:235], v[104:107]
v_exp_f32 v137, v137
v_mfma_f32_16x16x32_bf16 v[108:111], v[16:19], v[236:239], v[108:111]
v_exp_f32 v138, v138
v_mfma_f32_16x16x32_bf16 a[32:35], v[20:23], v[160:163], a[32:35]
ds_read_b128 v[16:19], v4 offset:36864
v_mul_hi_u32 v45, v44, s73
v_mfma_f32_16x16x32_bf16 a[36:39], v[20:23], v[164:167], a[36:39]
v_exp_f32 v139, v139
v_mfma_f32_16x16x32_bf16 a[40:43], v[20:23], v[168:171], a[40:43]
v_exp_f32 v140, v140
v_mfma_f32_16x16x32_bf16 a[44:47], v[20:23], v[172:175], a[44:47]
buffer_load_dwordx4 a[212:215], v9, s[8:11], s41 offen offset:1024 sc1
s_waitcnt lgkmcnt(1)
v_mfma_f32_16x16x32_bf16 v[96:99], v[24:27], v[240:243], v[96:99]
ds_read_b64_tr_b16 v[20:21], v36 offset:16384
v_mul_u32_u24 v46, 18, v45
v_mfma_f32_16x16x32_bf16 v[100:103], v[24:27], v[244:247], v[100:103]
ds_read_b64_tr_b16 v[22:23], v36 offset:20480
v_sub_u32 v46, v44, v46
v_mfma_f32_16x16x32_bf16 v[104:107], v[24:27], v[248:251], v[104:107]
v_exp_f32 v141, v141
v_mfma_f32_16x16x32_bf16 v[108:111], v[24:27], v[252:255], v[108:111]
v_exp_f32 v142, v142
v_mfma_f32_16x16x32_bf16 a[48:51], v[28:31], v[160:163], a[48:51]
ds_read_b128 v[24:27], v5 offset:36864
v_mul_lo_u32 v45, v45, s72
v_mfma_f32_16x16x32_bf16 a[52:55], v[28:31], v[164:167], a[52:55]
v_exp_f32 v143, v143
v_mfma_f32_16x16x32_bf16 a[56:59], v[28:31], v[168:171], a[56:59]
v_exp_f32 v144, v144
v_mfma_f32_16x16x32_bf16 a[60:63], v[28:31], v[172:175], a[60:63]
v_exp_f32 v145, v145
v_mfma_f32_16x16x32_bf16 a[132:135], a[144:147], v[164:167], a[132:135]
v_exp_f32 v146, v146
s_waitcnt lgkmcnt(1)
v_mfma_f32_16x16x32_bf16 v[112:115], v[16:19], v[192:195], 0
ds_read_b64_tr_b16 v[28:29], v37 offset:16384
v_lshl_add_u32 v45, v46, 4, v45
v_mfma_f32_16x16x32_bf16 v[116:119], v[16:19], v[196:199], 0
ds_read_b64_tr_b16 v[30:31], v37 offset:20480
v_subrev_u32 v2, 1024, v45
v_mfma_f32_16x16x32_bf16 v[120:123], v[16:19], v[200:203], 0
buffer_load_dwordx4 a[216:219], v9, s[8:11], s41 offen offset:2048 sc1
v_mfma_f32_16x16x32_bf16 v[124:127], v[16:19], v[204:207], 0
v_exp_f32 v147, v147
v_mfma_f32_16x16x32_bf16 a[64:67], v[20:23], v[160:163], a[64:67]
ds_read_b128 v[16:19], v6 offset:36864
v_add_u32 v44, 128, v0
v_mfma_f32_16x16x32_bf16 a[68:71], v[20:23], v[164:167], a[68:71]
v_exp_f32 v148, v148
v_mfma_f32_16x16x32_bf16 a[72:75], v[20:23], v[168:171], a[72:75]
v_exp_f32 v149, v149
v_mfma_f32_16x16x32_bf16 a[76:79], v[20:23], v[172:175], a[76:79]
v_exp_f32 v150, v150
s_waitcnt lgkmcnt(1)
v_mfma_f32_16x16x32_bf16 v[112:115], v[24:27], v[208:211], v[112:115]
ds_read_b64_tr_b16 v[20:21], v38 offset:16384
v_mul_hi_u32 v45, v44, s73
v_mfma_f32_16x16x32_bf16 v[116:119], v[24:27], v[212:215], v[116:119]
ds_read_b64_tr_b16 v[22:23], v38 offset:20480
v_mul_u32_u24 v46, 18, v45
v_mfma_f32_16x16x32_bf16 v[120:123], v[24:27], v[216:219], v[120:123]
v_exp_f32 v151, v151
v_mfma_f32_16x16x32_bf16 v[124:127], v[24:27], v[220:223], v[124:127]
v_exp_f32 v152, v152
v_mfma_f32_16x16x32_bf16 a[80:83], v[28:31], v[160:163], a[80:83]
ds_read_b128 v[24:27], v7 offset:36864
v_sub_u32 v46, v44, v46
v_mfma_f32_16x16x32_bf16 a[84:87], v[28:31], v[164:167], a[84:87]
v_exp_f32 v153, v153
v_mfma_f32_16x16x32_bf16 a[88:91], v[28:31], v[168:171], a[88:91]
buffer_load_dwordx4 a[220:223], v9, s[8:11], s41 offen offset:3072 sc1
v_mfma_f32_16x16x32_bf16 a[92:95], v[28:31], v[172:175], a[92:95]
v_exp_f32 v154, v154
v_mfma_f32_16x16x32_bf16 a[136:139], a[144:147], v[168:171], a[136:139]
v_exp_f32 v155, v155
s_waitcnt lgkmcnt(1)
v_mfma_f32_16x16x32_bf16 v[112:115], v[16:19], v[224:227], v[112:115]
ds_read_b64_tr_b16 v[28:29], v39 offset:16384
v_mul_lo_u32 v45, v45, s72
v_mfma_f32_16x16x32_bf16 v[116:119], v[16:19], v[228:231], v[116:119]
ds_read_b64_tr_b16 v[30:31], v39 offset:20480
v_lshl_add_u32 v45, v46, 4, v45
v_mfma_f32_16x16x32_bf16 v[120:123], v[16:19], v[232:235], v[120:123]
v_exp_f32 v156, v156
v_mfma_f32_16x16x32_bf16 v[124:127], v[16:19], v[236:239], v[124:127]
v_exp_f32 v157, v157
v_mfma_f32_16x16x32_bf16 a[96:99], v[20:23], v[160:163], a[96:99]
s_barrier
ds_read_b128 v[16:19], v4 offset:40960
v_mfma_f32_16x16x32_bf16 a[100:103], v[20:23], v[164:167], a[100:103]
v_subrev_u32 v3, 2048, v45
v_add_u32 v44, 192, v0
v_mfma_f32_16x16x32_bf16 a[104:107], v[20:23], v[168:171], a[104:107]
v_mul_hi_u32 v45, v44, s73
v_mul_u32_u24 v46, 18, v45
v_mfma_f32_16x16x32_bf16 a[108:111], v[20:23], v[172:175], a[108:111]
v_sub_u32 v46, v44, v46
v_mul_lo_u32 v45, v45, s72
s_waitcnt lgkmcnt(1)
v_mfma_f32_16x16x32_bf16 v[112:115], v[24:27], v[240:243], v[112:115]
ds_read_b64_tr_b16 v[20:21], v32 offset:24576
v_lshl_add_u32 v45, v46, 4, v45
s_add_u32 s41, s61, 16384
v_mfma_f32_16x16x32_bf16 v[116:119], v[24:27], v[244:247], v[116:119]
ds_read_b64_tr_b16 v[22:23], v32 offset:28672
v_subrev_u32 v8, 3072, v45
v_mfma_f32_16x16x32_bf16 v[120:123], v[24:27], v[248:251], v[120:123]
buffer_load_dwordx4 a[224:227], v9, s[8:11], s41 offen offset:0 sc1
v_mfma_f32_16x16x32_bf16 v[124:127], v[24:27], v[252:255], v[124:127]
v_add_u32 v44, 256, v0
v_mul_hi_u32 v45, v44, s73
v_mfma_f32_16x16x32_bf16 a[112:115], v[28:31], v[160:163], a[112:115]
ds_read_b128 v[24:27], v5 offset:40960
v_mul_u32_u24 v46, 18, v45
v_sub_u32 v46, v44, v46
v_mul_lo_u32 v45, v45, s72
v_lshl_add_u32 v45, v46, 4, v45
v_subrev_u32 v10, 0, v45
v_add_u32 v44, 320, v0
v_mul_hi_u32 v45, v44, s73
v_mul_u32_u24 v46, 18, v45
v_sub_u32 v46, v44, v46
v_mul_lo_u32 v45, v45, s72
v_lshl_add_u32 v45, v46, 4, v45
v_subrev_u32 v11, 1024, v45
v_add_u32 v44, 384, v0
v_mul_hi_u32 v45, v44, s73
v_mul_u32_u24 v46, 18, v45
v_sub_u32 v46, v44, v46
v_mul_lo_u32 v45, v45, s72
v_lshl_add_u32 v45, v46, 4, v45
v_subrev_u32 v12, 2048, v45
v_add_u32 v44, 448, v0
v_mul_hi_u32 v45, v44, s73
v_mul_u32_u24 v46, 18, v45
v_sub_u32 v46, v44, v46
v_mul_lo_u32 v45, v45, s72
v_lshl_add_u32 v45, v46, 4, v45
v_subrev_u32 v13, 3072, v45
v_add_u32 v44, 512, v0
v_mul_hi_u32 v45, v44, s73
v_mul_u32_u24 v46, 18, v45
v_sub_u32 v46, v44, v46
v_mul_lo_u32 v45, v45, s72
v_lshl_add_u32 v45, v46, 4, v45
v_subrev_u32 v14, 0, v45
v_lshrrev_b32 v44, 4, v0
v_and_b32 v45, 15, v0
v_lshrrev_b32 v46, 2, v45
v_and_b32 v47, 3, v45
v_lshl_add_u32 v44, v44, 2, v46
v_mul_u32_u24 v44, 288, v44
v_lshl_add_u32 v15, v47, 3, v44
v_mfma_f32_16x16x32_bf16 a[116:119], v[28:31], v[164:167], a[116:119]
v_cvt_pk_bf16_f32 v176, v128, v129
v_cvt_pk_bf16_f32 v177, v130, v131
v_mfma_f32_16x16x32_bf16 a[120:123], v[28:31], v[168:171], a[120:123]
v_exp_f32 v158, v158
v_mfma_f32_16x16x32_bf16 a[124:127], v[28:31], v[172:175], a[124:127]
v_exp_f32 v159, v159
v_cvt_pk_bf16_f32 v180, v132, v133
v_cvt_pk_bf16_f32 v181, v134, v135
v_cvt_pk_bf16_f32 v184, v136, v137
v_cvt_pk_bf16_f32 v185, v138, v139
v_cvt_pk_bf16_f32 v188, v140, v141
v_cvt_pk_bf16_f32 v189, v142, v143
v_cvt_pk_bf16_f32 v178, v144, v145
v_cvt_pk_bf16_f32 v179, v146, v147
v_cvt_pk_bf16_f32 v182, v148, v149
v_cvt_pk_bf16_f32 v183, v150, v151
v_cvt_pk_bf16_f32 v186, v152, v153
v_cvt_pk_bf16_f32 v187, v154, v155
v_cvt_pk_bf16_f32 v190, v156, v157
v_mfma_f32_16x16x32_bf16 a[140:143], a[144:147], v[172:175], a[140:143]
v_cvt_pk_bf16_f32 v191, v158, v159
s_waitcnt lgkmcnt(1)
v_mfma_f32_16x16x32_bf16 v[128:131], v[16:19], v[192:195], 0
ds_read_b64_tr_b16 v[28:29], v33 offset:24576
v_mfma_f32_16x16x32_bf16 v[132:135], v[16:19], v[196:199], 0
ds_read_b64_tr_b16 v[30:31], v33 offset:28672
v_mfma_f32_16x16x32_bf16 v[136:139], v[16:19], v[200:203], 0
v_exp_f32 v96, v96
v_mfma_f32_16x16x32_bf16 v[140:143], v[16:19], v[204:207], 0
v_exp_f32 v97, v97
v_mfma_f32_16x16x32_bf16 a[0:3], v[20:23], v[176:179], a[0:3]
ds_read_b128 v[16:19], v6 offset:40960
v_cvt_pk_bf16_f32 v160, v96, v97
v_mfma_f32_16x16x32_bf16 a[4:7], v[20:23], v[180:183], a[4:7]
buffer_load_dwordx4 a[228:231], v9, s[8:11], s41 offen offset:1024 sc1
v_mfma_f32_16x16x32_bf16 a[8:11], v[20:23], v[184:187], a[8:11]
v_exp_f32 v98, v98
v_mfma_f32_16x16x32_bf16 a[12:15], v[20:23], v[188:191], a[12:15]
v_exp_f32 v99, v99
s_waitcnt lgkmcnt(1)
v_mfma_f32_16x16x32_bf16 v[128:131], v[24:27], v[208:211], v[128:131]
ds_read_b64_tr_b16 v[20:21], v34 offset:24576
v_cvt_pk_bf16_f32 v161, v98, v99
v_mfma_f32_16x16x32_bf16 v[132:135], v[24:27], v[212:215], v[132:135]
ds_read_b64_tr_b16 v[22:23], v34 offset:28672
v_mfma_f32_16x16x32_bf16 v[136:139], v[24:27], v[216:219], v[136:139]
v_exp_f32 v100, v100
v_mfma_f32_16x16x32_bf16 v[140:143], v[24:27], v[220:223], v[140:143]
v_exp_f32 v101, v101
v_mfma_f32_16x16x32_bf16 a[16:19], v[28:31], v[176:179], a[16:19]
ds_read_b128 v[24:27], v7 offset:40960
v_cvt_pk_bf16_f32 v164, v100, v101
v_mfma_f32_16x16x32_bf16 a[20:23], v[28:31], v[180:183], a[20:23]
v_exp_f32 v102, v102
v_mfma_f32_16x16x32_bf16 a[24:27], v[28:31], v[184:187], a[24:27]
v_exp_f32 v103, v103
v_mfma_f32_16x16x32_bf16 a[28:31], v[28:31], v[188:191], a[28:31]
v_exp_f32 v104, v104
v_mfma_f32_16x16x32_bf16 a[128:131], a[144:147], v[176:179], a[128:131]
buffer_load_dwordx4 a[232:235], v9, s[8:11], s41 offen offset:2048 sc1
s_waitcnt lgkmcnt(1)
v_mfma_f32_16x16x32_bf16 v[128:131], v[16:19], v[224:227], v[128:131]
ds_read_b64_tr_b16 v[28:29], v35 offset:24576
v_cvt_pk_bf16_f32 v165, v102, v103
v_mfma_f32_16x16x32_bf16 v[132:135], v[16:19], v[228:231], v[132:135]
ds_read_b64_tr_b16 v[30:31], v35 offset:28672
v_mfma_f32_16x16x32_bf16 v[136:139], v[16:19], v[232:235], v[136:139]
v_exp_f32 v105, v105
v_mfma_f32_16x16x32_bf16 v[140:143], v[16:19], v[236:239], v[140:143]
v_exp_f32 v106, v106
v_mfma_f32_16x16x32_bf16 a[32:35], v[20:23], v[176:179], a[32:35]
ds_read_b128 v[16:19], v4 offset:45056
v_cvt_pk_bf16_f32 v168, v104, v105
v_mfma_f32_16x16x32_bf16 a[36:39], v[20:23], v[180:183], a[36:39]
v_exp_f32 v107, v107
v_mfma_f32_16x16x32_bf16 a[40:43], v[20:23], v[184:187], a[40:43]
v_exp_f32 v108, v108
v_mfma_f32_16x16x32_bf16 a[44:47], v[20:23], v[188:191], a[44:47]
v_exp_f32 v109, v109
s_waitcnt lgkmcnt(1)
v_mfma_f32_16x16x32_bf16 v[128:131], v[24:27], v[240:243], v[128:131]
ds_read_b64_tr_b16 v[20:21], v36 offset:24576
v_cvt_pk_bf16_f32 v169, v106, v107
v_mfma_f32_16x16x32_bf16 v[132:135], v[24:27], v[244:247], v[132:135]
ds_read_b64_tr_b16 v[22:23], v36 offset:28672
v_cvt_pk_bf16_f32 v172, v108, v109
v_mfma_f32_16x16x32_bf16 v[136:139], v[24:27], v[248:251], v[136:139]
v_exp_f32 v110, v110
v_mfma_f32_16x16x32_bf16 v[140:143], v[24:27], v[252:255], v[140:143]
buffer_load_dwordx4 a[236:239], v9, s[8:11], s41 offen offset:3072 sc1
v_mfma_f32_16x16x32_bf16 a[48:51], v[28:31], v[176:179], a[48:51]
ds_read_b128 v[24:27], v5 offset:45056
v_mfma_f32_16x16x32_bf16 a[52:55], v[28:31], v[180:183], a[52:55]
v_exp_f32 v111, v111
v_mfma_f32_16x16x32_bf16 a[56:59], v[28:31], v[184:187], a[56:59]
v_exp_f32 v112, v112
v_mfma_f32_16x16x32_bf16 a[60:63], v[28:31], v[188:191], a[60:63]
v_exp_f32 v113, v113
v_mfma_f32_16x16x32_bf16 a[132:135], a[144:147], v[180:183], a[132:135]
v_exp_f32 v114, v114
s_waitcnt lgkmcnt(1)
v_mfma_f32_16x16x32_bf16 v[144:147], v[16:19], v[192:195], 0
ds_read_b64_tr_b16 v[28:29], v37 offset:24576
v_cvt_pk_bf16_f32 v173, v110, v111
v_mfma_f32_16x16x32_bf16 v[148:151], v[16:19], v[196:199], 0
ds_read_b64_tr_b16 v[30:31], v37 offset:28672
v_cvt_pk_bf16_f32 v162, v112, v113
v_mfma_f32_16x16x32_bf16 v[152:155], v[16:19], v[200:203], 0
v_exp_f32 v115, v115
v_mfma_f32_16x16x32_bf16 v[156:159], v[16:19], v[204:207], 0
v_exp_f32 v116, v116
v_mfma_f32_16x16x32_bf16 a[64:67], v[20:23], v[176:179], a[64:67]
ds_read_b128 v[16:19], v6 offset:45056
s_add_u32 s41, s61, 20480
v_cvt_pk_bf16_f32 v163, v114, v115
v_mfma_f32_16x16x32_bf16 a[68:71], v[20:23], v[180:183], a[68:71]
v_exp_f32 v117, v117
v_mfma_f32_16x16x32_bf16 a[72:75], v[20:23], v[184:187], a[72:75]
buffer_load_dwordx4 a[240:243], v9, s[8:11], s41 offen offset:0 sc1
v_mfma_f32_16x16x32_bf16 a[76:79], v[20:23], v[188:191], a[76:79]
v_exp_f32 v118, v118
s_waitcnt lgkmcnt(1)
v_mfma_f32_16x16x32_bf16 v[144:147], v[24:27], v[208:211], v[144:147]
ds_read_b64_tr_b16 v[20:21], v38 offset:24576
v_cvt_pk_bf16_f32 v166, v116, v117
v_mfma_f32_16x16x32_bf16 v[148:151], v[24:27], v[212:215], v[148:151]
ds_read_b64_tr_b16 v[22:23], v38 offset:28672
v_mfma_f32_16x16x32_bf16 v[152:155], v[24:27], v[216:219], v[152:155]
v_exp_f32 v119, v119
v_mfma_f32_16x16x32_bf16 v[156:159], v[24:27], v[220:223], v[156:159]
v_exp_f32 v120, v120
v_mfma_f32_16x16x32_bf16 a[80:83], v[28:31], v[176:179], a[80:83]
ds_read_b128 v[24:27], v7 offset:45056
v_cvt_pk_bf16_f32 v167, v118, v119
v_mfma_f32_16x16x32_bf16 a[84:87], v[28:31], v[180:183], a[84:87]
v_exp_f32 v121, v121
v_mfma_f32_16x16x32_bf16 a[88:91], v[28:31], v[184:187], a[88:91]
v_exp_f32 v122, v122
v_mfma_f32_16x16x32_bf16 a[92:95], v[28:31], v[188:191], a[92:95]
v_exp_f32 v123, v123
v_mfma_f32_16x16x32_bf16 a[136:139], a[144:147], v[184:187], a[136:139]
v_exp_f32 v124, v124
s_waitcnt lgkmcnt(1)
v_mfma_f32_16x16x32_bf16 v[144:147], v[16:19], v[224:227], v[144:147]
ds_read_b64_tr_b16 v[28:29], v39 offset:24576
v_cvt_pk_bf16_f32 v170, v120, v121
v_mfma_f32_16x16x32_bf16 v[148:151], v[16:19], v[228:231], v[148:151]
ds_read_b64_tr_b16 v[30:31], v39 offset:28672
v_cvt_pk_bf16_f32 v171, v122, v123
v_mfma_f32_16x16x32_bf16 v[152:155], v[16:19], v[232:235], v[152:155]
buffer_load_dwordx4 a[244:247], v9, s[8:11], s41 offen offset:1024 sc1
v_mfma_f32_16x16x32_bf16 v[156:159], v[16:19], v[236:239], v[156:159]
v_exp_f32 v125, v125
v_mfma_f32_16x16x32_bf16 a[96:99], v[20:23], v[176:179], a[96:99]
s_barrier
ds_read_b128 v[16:19], v4 offset:49152
v_mfma_f32_16x16x32_bf16 a[100:103], v[20:23], v[180:183], a[100:103]
s_add_u32 m0, s47, 0
s_add_u32 s40, s60, 0
buffer_load_dwordx4 v1, s[48:51], s40 offen offset:0 lds
v_mfma_f32_16x16x32_bf16 a[104:107], v[20:23], v[184:187], a[104:107]
v_exp_f32 v126, v126
v_mfma_f32_16x16x32_bf16 a[108:111], v[20:23], v[188:191], a[108:111]
v_exp_f32 v127, v127
s_waitcnt lgkmcnt(1)
v_mfma_f32_16x16x32_bf16 v[144:147], v[24:27], v[240:243], v[144:147]
ds_read_b64_tr_b16 v[20:21], v32 offset:32768
v_cvt_pk_bf16_f32 v174, v124, v125
v_mfma_f32_16x16x32_bf16 v[148:151], v[24:27], v[244:247], v[148:151]
ds_read_b64_tr_b16 v[22:23], v32 offset:36864
v_cvt_pk_bf16_f32 v175, v126, v127
v_mfma_f32_16x16x32_bf16 v[152:155], v[24:27], v[248:251], v[152:155]
v_mfma_f32_16x16x32_bf16 v[156:159], v[24:27], v[252:255], v[156:159]
v_mfma_f32_16x16x32_bf16 a[112:115], v[28:31], v[176:179], a[112:115]
ds_read_b128 v[24:27], v5 offset:49152
v_mfma_f32_16x16x32_bf16 a[116:119], v[28:31], v[180:183], a[116:119]
buffer_load_dwordx4 a[248:251], v9, s[8:11], s41 offen offset:2048 sc1
v_mfma_f32_16x16x32_bf16 a[120:123], v[28:31], v[184:187], a[120:123]
v_mfma_f32_16x16x32_bf16 a[124:127], v[28:31], v[188:191], a[124:127]
v_mfma_f32_16x16x32_bf16 a[140:143], a[144:147], v[188:191], a[140:143]
s_waitcnt lgkmcnt(1)
v_mfma_f32_16x16x32_bf16 v[96:99], v[16:19], v[192:195], 0
ds_read_b64_tr_b16 v[28:29], v33 offset:32768
v_mfma_f32_16x16x32_bf16 v[100:103], v[16:19], v[196:199], 0
ds_read_b64_tr_b16 v[30:31], v33 offset:36864
v_mfma_f32_16x16x32_bf16 v[104:107], v[16:19], v[200:203], 0
buffer_load_dwordx4 v2, s[48:51], s40 offen offset:1024 lds
v_mfma_f32_16x16x32_bf16 v[108:111], v[16:19], v[204:207], 0
v_exp_f32 v128, v128
v_mfma_f32_16x16x32_bf16 a[0:3], v[20:23], v[160:163], a[0:3]
ds_read_b128 v[16:19], v6 offset:49152
v_mfma_f32_16x16x32_bf16 a[4:7], v[20:23], v[164:167], a[4:7]
v_exp_f32 v129, v129
v_mfma_f32_16x16x32_bf16 a[8:11], v[20:23], v[168:171], a[8:11]
v_exp_f32 v130, v130
v_mfma_f32_16x16x32_bf16 a[12:15], v[20:23], v[172:175], a[12:15]
v_exp_f32 v131, v131
s_waitcnt lgkmcnt(1)
v_mfma_f32_16x16x32_bf16 v[96:99], v[24:27], v[208:211], v[96:99]
ds_read_b64_tr_b16 v[20:21], v34 offset:32768
v_cvt_pk_bf16_f32 v176, v128, v129
v_mfma_f32_16x16x32_bf16 v[100:103], v[24:27], v[212:215], v[100:103]
ds_read_b64_tr_b16 v[22:23], v34 offset:36864
v_cvt_pk_bf16_f32 v177, v130, v131
v_mfma_f32_16x16x32_bf16 v[104:107], v[24:27], v[216:219], v[104:107]
buffer_load_dwordx4 a[252:255], v9, s[8:11], s41 offen offset:3072 sc1
v_mfma_f32_16x16x32_bf16 v[108:111], v[24:27], v[220:223], v[108:111]
v_exp_f32 v132, v132
v_mfma_f32_16x16x32_bf16 a[16:19], v[28:31], v[160:163], a[16:19]
ds_read_b128 v[24:27], v7 offset:49152
v_mfma_f32_16x16x32_bf16 a[20:23], v[28:31], v[164:167], a[20:23]
v_exp_f32 v133, v133
v_mfma_f32_16x16x32_bf16 a[24:27], v[28:31], v[168:171], a[24:27]
v_exp_f32 v134, v134
v_mfma_f32_16x16x32_bf16 a[28:31], v[28:31], v[172:175], a[28:31]
v_exp_f32 v135, v135
v_mfma_f32_16x16x32_bf16 a[128:131], a[144:147], v[160:163], a[128:131]
buffer_load_dwordx4 v3, s[48:51], s40 offen offset:2048 lds
s_waitcnt lgkmcnt(1)
v_mfma_f32_16x16x32_bf16 v[96:99], v[16:19], v[224:227], v[96:99]
ds_read_b64_tr_b16 v[28:29], v35 offset:32768
v_cvt_pk_bf16_f32 v180, v132, v133
v_mfma_f32_16x16x32_bf16 v[100:103], v[16:19], v[228:231], v[100:103]
ds_read_b64_tr_b16 v[30:31], v35 offset:36864
v_cvt_pk_bf16_f32 v181, v134, v135
v_mfma_f32_16x16x32_bf16 v[104:107], v[16:19], v[232:235], v[104:107]
v_exp_f32 v136, v136
v_mfma_f32_16x16x32_bf16 v[108:111], v[16:19], v[236:239], v[108:111]
v_exp_f32 v137, v137
v_mfma_f32_16x16x32_bf16 a[32:35], v[20:23], v[160:163], a[32:35]
ds_read_b128 v[16:19], v4 offset:53248
v_cvt_pk_bf16_f32 v184, v136, v137
v_mfma_f32_16x16x32_bf16 a[36:39], v[20:23], v[164:167], a[36:39]
v_exp_f32 v138, v138
v_mfma_f32_16x16x32_bf16 a[40:43], v[20:23], v[168:171], a[40:43]
v_exp_f32 v139, v139
v_mfma_f32_16x16x32_bf16 a[44:47], v[20:23], v[172:175], a[44:47]
s_lshl_b32 s72, s28, 13
v_exp_f32 v140, v140
s_waitcnt lgkmcnt(1)
v_mfma_f32_16x16x32_bf16 v[96:99], v[24:27], v[240:243], v[96:99]
ds_read_b64_tr_b16 v[20:21], v36 offset:32768
s_add_u32 s72, s72, mk_LY_W1-mk_pc
v_lshl_add_u32 v56, v0, 7, s72
v_mfma_f32_16x16x32_bf16 v[100:103], v[24:27], v[244:247], v[100:103]
ds_read_b64_tr_b16 v[22:23], v36 offset:36864
v_min_u32 v56, mk_fin-mk_pc, v56
v_mfma_f32_16x16x32_bf16 v[104:107], v[24:27], v[248:251], v[104:107]
global_load_dword v57, v56, s[4:5]
v_mfma_f32_16x16x32_bf16 v[108:111], v[24:27], v[252:255], v[108:111]
v_exp_f32 v141, v141
v_mfma_f32_16x16x32_bf16 a[48:51], v[28:31], v[160:163], a[48:51]
ds_read_b128 v[24:27], v5 offset:53248
v_cvt_pk_bf16_f32 v185, v138, v139
v_mfma_f32_16x16x32_bf16 a[52:55], v[28:31], v[164:167], a[52:55]
buffer_load_dwordx4 v8, s[48:51], s40 offen offset:3072 lds
v_mfma_f32_16x16x32_bf16 a[56:59], v[28:31], v[168:171], a[56:59]
v_exp_f32 v142, v142
v_mfma_f32_16x16x32_bf16 a[60:63], v[28:31], v[172:175], a[60:63]
v_exp_f32 v143, v143
v_mfma_f32_16x16x32_bf16 a[132:135], a[144:147], v[164:167], a[132:135]
v_exp_f32 v144, v144
s_waitcnt lgkmcnt(1)
v_mfma_f32_16x16x32_bf16 v[112:115], v[16:19], v[192:195], 0
ds_read_b64_tr_b16 v[28:29], v37 offset:32768
v_cvt_pk_bf16_f32 v188, v140, v141
v_mfma_f32_16x16x32_bf16 v[116:119], v[16:19], v[196:199], 0
ds_read_b64_tr_b16 v[30:31], v37 offset:36864
v_cvt_pk_bf16_f32 v189, v142, v143
v_mfma_f32_16x16x32_bf16 v[120:123], v[16:19], v[200:203], 0
v_exp_f32 v145, v145
v_mfma_f32_16x16x32_bf16 v[124:127], v[16:19], v[204:207], 0
v_exp_f32 v146, v146
v_mfma_f32_16x16x32_bf16 a[64:67], v[20:23], v[160:163], a[64:67]
ds_read_b128 v[16:19], v6 offset:53248
v_cvt_pk_bf16_f32 v178, v144, v145
v_mfma_f32_16x16x32_bf16 a[68:71], v[20:23], v[164:167], a[68:71]
v_exp_f32 v147, v147
v_mfma_f32_16x16x32_bf16 a[72:75], v[20:23], v[168:171], a[72:75]
v_exp_f32 v148, v148
v_mfma_f32_16x16x32_bf16 a[76:79], v[20:23], v[172:175], a[76:79]
s_add_u32 m0, s47, 4096
v_exp_f32 v149, v149
s_waitcnt lgkmcnt(1)
v_mfma_f32_16x16x32_bf16 v[112:115], v[24:27], v[208:211], v[112:115]
ds_read_b64_tr_b16 v[20:21], v38 offset:32768
v_cvt_pk_bf16_f32 v179, v146, v147
v_mfma_f32_16x16x32_bf16 v[116:119], v[24:27], v[212:215], v[116:119]
ds_read_b64_tr_b16 v[22:23], v38 offset:36864
v_cvt_pk_bf16_f32 v182, v148, v149
v_mfma_f32_16x16x32_bf16 v[120:123], v[24:27], v[216:219], v[120:123]
buffer_load_dwordx4 v10, s[48:51], s40 offen offset:0 lds
v_mfma_f32_16x16x32_bf16 v[124:127], v[24:27], v[220:223], v[124:127]
v_exp_f32 v150, v150
v_mfma_f32_16x16x32_bf16 a[80:83], v[28:31], v[160:163], a[80:83]
ds_read_b128 v[24:27], v7 offset:53248
v_mfma_f32_16x16x32_bf16 a[84:87], v[28:31], v[164:167], a[84:87]
v_exp_f32 v151, v151
v_mfma_f32_16x16x32_bf16 a[88:91], v[28:31], v[168:171], a[88:91]
v_exp_f32 v152, v152
v_mfma_f32_16x16x32_bf16 a[92:95], v[28:31], v[172:175], a[92:95]
v_exp_f32 v153, v153
v_mfma_f32_16x16x32_bf16 a[136:139], a[144:147], v[168:171], a[136:139]
v_exp_f32 v154, v154
s_waitcnt lgkmcnt(1)
v_mfma_f32_16x16x32_bf16 v[112:115], v[16:19], v[224:227], v[112:115]
ds_read_b64_tr_b16 v[28:29], v39 offset:32768
v_cvt_pk_bf16_f32 v183, v150, v151
v_mfma_f32_16x16x32_bf16 v[116:119], v[16:19], v[228:231], v[116:119]
ds_read_b64_tr_b16 v[30:31], v39 offset:36864
v_cvt_pk_bf16_f32 v186, v152, v153
v_mfma_f32_16x16x32_bf16 v[120:123], v[16:19], v[232:235], v[120:123]
v_exp_f32 v155, v155
v_mfma_f32_16x16x32_bf16 v[124:127], v[16:19], v[236:239], v[124:127]
v_exp_f32 v156, v156
v_mfma_f32_16x16x32_bf16 a[96:99], v[20:23], v[160:163], a[96:99]
s_waitcnt vmcnt(35)
s_barrier
ds_read_b128 v[16:19], v4 offset:57344
v_mfma_f32_16x16x32_bf16 a[100:103], v[20:23], v[164:167], a[100:103]
v_exp_f32 v157, v157
v_mfma_f32_16x16x32_bf16 a[104:107], v[20:23], v[168:171], a[104:107]
v_exp_f32 v158, v158
v_mfma_f32_16x16x32_bf16 a[108:111], v[20:23], v[172:175], a[108:111]
buffer_load_dwordx4 v11, s[48:51], s40 offen offset:1024 lds
s_waitcnt lgkmcnt(1)
v_mfma_f32_16x16x32_bf16 v[112:115], v[24:27], v[240:243], v[112:115]
ds_read_b64_tr_b16 v[20:21], v32 offset:40960
v_cvt_pk_bf16_f32 v187, v154, v155
v_mfma_f32_16x16x32_bf16 v[116:119], v[24:27], v[244:247], v[116:119]
ds_read_b64_tr_b16 v[22:23], v32 offset:45056
v_cvt_pk_bf16_f32 v190, v156, v157
v_mfma_f32_16x16x32_bf16 v[120:123], v[24:27], v[248:251], v[120:123]
v_exp_f32 v159, v159
v_mfma_f32_16x16x32_bf16 v[124:127], v[24:27], v[252:255], v[124:127]
v_cvt_pk_bf16_f32 v191, v158, v159
v_mfma_f32_16x16x32_bf16 a[112:115], v[28:31], v[160:163], a[112:115]
ds_read_b128 v[24:27], v5 offset:57344
v_mfma_f32_16x16x32_bf16 a[116:119], v[28:31], v[164:167], a[116:119]
v_mfma_f32_16x16x32_bf16 a[120:123], v[28:31], v[168:171], a[120:123]
v_mfma_f32_16x16x32_bf16 a[124:127], v[28:31], v[172:175], a[124:127]
v_mfma_f32_16x16x32_bf16 a[140:143], a[144:147], v[172:175], a[140:143]
s_waitcnt lgkmcnt(1)
v_mfma_f32_16x16x32_bf16 v[128:131], v[16:19], v[192:195], 0
ds_read_b64_tr_b16 v[28:29], v33 offset:40960
v_mfma_f32_16x16x32_bf16 v[132:135], v[16:19], v[196:199], 0
ds_read_b64_tr_b16 v[30:31], v33 offset:45056
v_mfma_f32_16x16x32_bf16 v[136:139], v[16:19], v[200:203], 0
v_exp_f32 v96, v96
v_mfma_f32_16x16x32_bf16 v[140:143], v[16:19], v[204:207], 0
v_exp_f32 v97, v97
v_mfma_f32_16x16x32_bf16 a[0:3], v[20:23], v[176:179], a[0:3]
ds_read_b128 v[16:19], v6 offset:57344
v_cvt_pk_bf16_f32 v160, v96, v97
v_mfma_f32_16x16x32_bf16 a[4:7], v[20:23], v[180:183], a[4:7]
buffer_load_dwordx4 v12, s[48:51], s40 offen offset:2048 lds
v_mfma_f32_16x16x32_bf16 a[8:11], v[20:23], v[184:187], a[8:11]
v_exp_f32 v98, v98
v_mfma_f32_16x16x32_bf16 a[12:15], v[20:23], v[188:191], a[12:15]
v_exp_f32 v99, v99
s_waitcnt lgkmcnt(1)
v_mfma_f32_16x16x32_bf16 v[128:131], v[24:27], v[208:211], v[128:131]
ds_read_b64_tr_b16 v[20:21], v34 offset:40960
v_cvt_pk_bf16_f32 v161, v98, v99
v_mfma_f32_16x16x32_bf16 v[132:135], v[24:27], v[212:215], v[132:135]
ds_read_b64_tr_b16 v[22:23], v34 offset:45056
v_mfma_f32_16x16x32_bf16 v[136:139], v[24:27], v[216:219], v[136:139]
v_exp_f32 v100, v100
v_mfma_f32_16x16x32_bf16 v[140:143], v[24:27], v[220:223], v[140:143]
v_exp_f32 v101, v101
v_mfma_f32_16x16x32_bf16 a[16:19], v[28:31], v[176:179], a[16:19]
ds_read_b128 v[24:27], v7 offset:57344
v_cvt_pk_bf16_f32 v164, v100, v101
v_mfma_f32_16x16x32_bf16 a[20:23], v[28:31], v[180:183], a[20:23]
v_exp_f32 v102, v102
v_mfma_f32_16x16x32_bf16 a[24:27], v[28:31], v[184:187], a[24:27]
v_exp_f32 v103, v103
v_mfma_f32_16x16x32_bf16 a[28:31], v[28:31], v[188:191], a[28:31]
v_exp_f32 v104, v104
v_mfma_f32_16x16x32_bf16 a[128:131], a[144:147], v[176:179], a[128:131]
v_exp_f32 v105, v105
s_waitcnt lgkmcnt(1)
v_mfma_f32_16x16x32_bf16 v[128:131], v[16:19], v[224:227], v[128:131]
ds_read_b64_tr_b16 v[28:29], v35 offset:40960
v_cvt_pk_bf16_f32 v165, v102, v103
v_mfma_f32_16x16x32_bf16 v[132:135], v[16:19], v[228:231], v[132:135]
ds_read_b64_tr_b16 v[30:31], v35 offset:45056
v_cvt_pk_bf16_f32 v168, v104, v105
v_mfma_f32_16x16x32_bf16 v[136:139], v[16:19], v[232:235], v[136:139]
buffer_load_dwordx4 v13, s[48:51], s40 offen offset:3072 lds
v_mfma_f32_16x16x32_bf16 v[140:143], v[16:19], v[236:239], v[140:143]
v_exp_f32 v106, v106
v_mfma_f32_16x16x32_bf16 a[32:35], v[20:23], v[176:179], a[32:35]
ds_read_b128 v[16:19], v4 offset:61440
v_mfma_f32_16x16x32_bf16 a[36:39], v[20:23], v[180:183], a[36:39]
v_exp_f32 v107, v107
v_mfma_f32_16x16x32_bf16 a[40:43], v[20:23], v[184:187], a[40:43]
v_exp_f32 v108, v108
v_mfma_f32_16x16x32_bf16 a[44:47], v[20:23], v[188:191], a[44:47]
v_exp_f32 v109, v109
s_waitcnt lgkmcnt(1)
v_mfma_f32_16x16x32_bf16 v[128:131], v[24:27], v[240:243], v[128:131]
ds_read_b64_tr_b16 v[20:21], v36 offset:40960
v_cvt_pk_bf16_f32 v169, v106, v107
v_mfma_f32_16x16x32_bf16 v[132:135], v[24:27], v[244:247], v[132:135]
ds_read_b64_tr_b16 v[22:23], v36 offset:45056
v_cvt_pk_bf16_f32 v172, v108, v109
v_mfma_f32_16x16x32_bf16 v[136:139], v[24:27], v[248:251], v[136:139]
v_exp_f32 v110, v110
v_mfma_f32_16x16x32_bf16 v[140:143], v[24:27], v[252:255], v[140:143]
v_exp_f32 v111, v111
v_mfma_f32_16x16x32_bf16 a[48:51], v[28:31], v[176:179], a[48:51]
ds_read_b128 v[24:27], v5 offset:61440
s_add_u32 m0, s47, 8192
v_cvt_pk_bf16_f32 v173, v110, v111
v_mfma_f32_16x16x32_bf16 a[52:55], v[28:31], v[180:183], a[52:55]
v_exp_f32 v112, v112
v_mfma_f32_16x16x32_bf16 a[56:59], v[28:31], v[184:187], a[56:59]
v_exp_f32 v113, v113
v_mfma_f32_16x16x32_bf16 a[60:63], v[28:31], v[188:191], a[60:63]
buffer_load_dwordx4 v14, s[48:51], s40 offen offset:0 lds
v_mfma_f32_16x16x32_bf16 a[132:135], a[144:147], v[180:183], a[132:135]
v_exp_f32 v114, v114
s_waitcnt lgkmcnt(1)
v_mfma_f32_16x16x32_bf16 v[144:147], v[16:19], v[192:195], 0
ds_read_b64_tr_b16 v[28:29], v37 offset:40960
v_cvt_pk_bf16_f32 v162, v112, v113
v_mfma_f32_16x16x32_bf16 v[148:151], v[16:19], v[196:199], 0
ds_read_b64_tr_b16 v[30:31], v37 offset:45056
v_mfma_f32_16x16x32_bf16 v[152:155], v[16:19], v[200:203], 0
v_exp_f32 v115, v115
v_mfma_f32_16x16x32_bf16 v[156:159], v[16:19], v[204:207], 0
v_exp_f32 v116, v116
v_mfma_f32_16x16x32_bf16 a[64:67], v[20:23], v[176:179], a[64:67]
ds_read_b128 v[16:19], v6 offset:61440
v_cvt_pk_bf16_f32 v163, v114, v115
v_mfma_f32_16x16x32_bf16 a[68:71], v[20:23], v[180:183], a[68:71]
v_exp_f32 v117, v117
v_mfma_f32_16x16x32_bf16 a[72:75], v[20:23], v[184:187], a[72:75]
v_exp_f32 v118, v118
v_mfma_f32_16x16x32_bf16 a[76:79], v[20:23], v[188:191], a[76:79]
v_exp_f32 v119, v119
s_waitcnt lgkmcnt(1)
v_mfma_f32_16x16x32_bf16 v[144:147], v[24:27], v[208:211], v[144:147]
ds_read_b64_tr_b16 v[20:21], v38 offset:40960
v_cvt_pk_bf16_f32 v166, v116, v117
v_mfma_f32_16x16x32_bf16 v[148:151], v[24:27], v[212:215], v[148:151]
ds_read_b64_tr_b16 v[22:23], v38 offset:45056
v_cvt_pk_bf16_f32 v167, v118, v119
v_mfma_f32_16x16x32_bf16 v[152:155], v[24:27], v[216:219], v[152:155]
v_exp_f32 v120, v120
v_mfma_f32_16x16x32_bf16 v[156:159], v[24:27], v[220:223], v[156:159]
v_exp_f32 v121, v121
v_mfma_f32_16x16x32_bf16 a[80:83], v[28:31], v[176:179], a[80:83]
ds_read_b128 v[24:27], v7 offset:61440
v_cvt_pk_bf16_f32 v170, v120, v121
v_mfma_f32_16x16x32_bf16 a[84:87], v[28:31], v[180:183], a[84:87]
v_exp_f32 v122, v122
v_mfma_f32_16x16x32_bf16 a[88:91], v[28:31], v[184:187], a[88:91]
v_exp_f32 v123, v123
v_mfma_f32_16x16x32_bf16 a[92:95], v[28:31], v[188:191], a[92:95]
v_exp_f32 v124, v124
v_mfma_f32_16x16x32_bf16 a[136:139], a[144:147], v[184:187], a[136:139]
v_exp_f32 v125, v125
s_waitcnt lgkmcnt(1)
v_mfma_f32_16x16x32_bf16 v[144:147], v[16:19], v[224:227], v[144:147]
ds_read_b64_tr_b16 v[28:29], v39 offset:40960
v_cvt_pk_bf16_f32 v171, v122, v123
v_mfma_f32_16x16x32_bf16 v[148:151], v[16:19], v[228:231], v[148:151]
ds_read_b64_tr_b16 v[30:31], v39 offset:45056
v_cvt_pk_bf16_f32 v174, v124, v125
v_mfma_f32_16x16x32_bf16 v[152:155], v[16:19], v[232:235], v[152:155]
v_exp_f32 v126, v126
v_mfma_f32_16x16x32_bf16 v[156:159], v[16:19], v[236:239], v[156:159]
v_exp_f32 v127, v127
v_mfma_f32_16x16x32_bf16 a[96:99], v[20:23], v[176:179], a[96:99]
s_waitcnt vmcnt(36)
s_barrier
ds_read_b64_tr_b16 v[16:17], v32 offset:49152
v_mfma_f32_16x16x32_bf16 a[100:103], v[20:23], v[180:183], a[100:103]
ds_read_b64_tr_b16 v[18:19], v32 offset:53248
v_cvt_pk_bf16_f32 v175, v126, v127
v_mfma_f32_16x16x32_bf16 a[104:107], v[20:23], v[184:187], a[104:107]
v_mfma_f32_16x16x32_bf16 a[108:111], v[20:23], v[188:191], a[108:111]
s_waitcnt lgkmcnt(2)
v_mfma_f32_16x16x32_bf16 v[144:147], v[24:27], v[240:243], v[144:147]
ds_read_b64_tr_b16 v[20:21], v33 offset:49152
v_mfma_f32_16x16x32_bf16 v[148:151], v[24:27], v[244:247], v[148:151]
ds_read_b64_tr_b16 v[22:23], v33 offset:53248
v_mfma_f32_16x16x32_bf16 v[152:155], v[24:27], v[248:251], v[152:155]
v_mfma_f32_16x16x32_bf16 v[156:159], v[24:27], v[252:255], v[156:159]
v_mfma_f32_16x16x32_bf16 a[112:115], v[28:31], v[176:179], a[112:115]
ds_read_b64_tr_b16 v[24:25], v34 offset:49152
v_mfma_f32_16x16x32_bf16 a[116:119], v[28:31], v[180:183], a[116:119]
ds_read_b64_tr_b16 v[26:27], v34 offset:53248
v_mfma_f32_16x16x32_bf16 a[120:123], v[28:31], v[184:187], a[120:123]
v_mfma_f32_16x16x32_bf16 a[124:127], v[28:31], v[188:191], a[124:127]
v_mfma_f32_16x16x32_bf16 a[140:143], a[144:147], v[188:191], a[140:143]
s_waitcnt lgkmcnt(2)
v_mfma_f32_16x16x32_bf16 a[0:3], v[16:19], v[160:163], a[0:3]
ds_read_b64_tr_b16 v[28:29], v35 offset:49152
v_mfma_f32_16x16x32_bf16 a[4:7], v[16:19], v[164:167], a[4:7]
ds_read_b64_tr_b16 v[30:31], v35 offset:53248
v_mfma_f32_16x16x32_bf16 a[8:11], v[16:19], v[168:171], a[8:11]
v_exp_f32 v128, v128
v_mfma_f32_16x16x32_bf16 a[12:15], v[16:19], v[172:175], a[12:15]
v_exp_f32 v129, v129
v_mfma_f32_16x16x32_bf16 a[16:19], v[20:23], v[160:163], a[16:19]
ds_read_b64_tr_b16 v[16:17], v36 offset:49152
v_cvt_pk_bf16_f32 v176, v128, v129
v_mfma_f32_16x16x32_bf16 a[20:23], v[20:23], v[164:167], a[20:23]
ds_read_b64_tr_b16 v[18:19], v36 offset:53248
v_mfma_f32_16x16x32_bf16 a[24:27], v[20:23], v[168:171], a[24:27]
v_exp_f32 v130, v130
v_mfma_f32_16x16x32_bf16 a[28:31], v[20:23], v[172:175], a[28:31]
v_exp_f32 v131, v131
v_mfma_f32_16x16x32_bf16 a[128:131], a[144:147], v[160:163], a[128:131]
v_exp_f32 v132, v132
s_waitcnt lgkmcnt(2)
v_mfma_f32_16x16x32_bf16 a[32:35], v[24:27], v[160:163], a[32:35]
ds_read_b64_tr_b16 v[20:21], v37 offset:49152
v_cvt_pk_bf16_f32 v177, v130, v131
v_mfma_f32_16x16x32_bf16 a[36:39], v[24:27], v[164:167], a[36:39]
ds_read_b64_tr_b16 v[22:23], v37 offset:53248
v_mfma_f32_16x16x32_bf16 a[40:43], v[24:27], v[168:171], a[40:43]
v_exp_f32 v133, v133
v_mfma_f32_16x16x32_bf16 a[44:47], v[24:27], v[172:175], a[44:47]
v_exp_f32 v134, v134
v_mfma_f32_16x16x32_bf16 a[48:51], v[28:31], v[160:163], a[48:51]
ds_read_b64_tr_b16 v[24:25], v38 offset:49152
v_cvt_pk_bf16_f32 v180, v132, v133
v_mfma_f32_16x16x32_bf16 a[52:55], v[28:31], v[164:167], a[52:55]
ds_read_b64_tr_b16 v[26:27], v38 offset:53248
v_mfma_f32_16x16x32_bf16 a[56:59], v[28:31], v[168:171], a[56:59]
v_exp_f32 v135, v135
v_mfma_f32_16x16x32_bf16 a[60:63], v[28:31], v[172:175], a[60:63]
v_exp_f32 v136, v136
v_mfma_f32_16x16x32_bf16 a[132:135], a[144:147], v[164:167], a[132:135]
v_exp_f32 v137, v137
s_waitcnt lgkmcnt(2)
v_mfma_f32_16x16x32_bf16 a[64:67], v[16:19], v[160:163], a[64:67]
ds_read_b64_tr_b16 v[28:29], v39 offset:49152
v_cvt_pk_bf16_f32 v181, v134, v135
v_mfma_f32_16x16x32_bf16 a[68:71], v[16:19], v[164:167], a[68:71]
ds_read_b64_tr_b16 v[30:31], v39 offset:53248
v_cvt_pk_bf16_f32 v184, v136, v137
v_mfma_f32_16x16x32_bf16 a[72:75], v[16:19], v[168:171], a[72:75]
v_exp_f32 v138, v138
v_mfma_f32_16x16x32_bf16 a[76:79], v[16:19], v[172:175], a[76:79]
v_exp_f32 v139, v139
v_mfma_f32_16x16x32_bf16 a[80:83], v[20:23], v[160:163], a[80:83]
s_waitcnt vmcnt(28)
s_barrier
ds_read_b64_tr_b16 v[16:17], v32 offset:57344
v_mfma_f32_16x16x32_bf16 a[84:87], v[20:23], v[164:167], a[84:87]
ds_read_b64_tr_b16 v[18:19], v32 offset:61440
s_add_u32 m0, s47, 36864
v_cvt_pk_bf16_f32 v185, v138, v139
v_mfma_f32_16x16x32_bf16 a[88:91], v[20:23], v[168:171], a[88:91]
s_add_u32 s40, s60, 147456
buffer_load_dwordx4 v1, s[48:51], s40 offen offset:0 lds
v_mfma_f32_16x16x32_bf16 a[92:95], v[20:23], v[172:175], a[92:95]
v_exp_f32 v140, v140
v_mfma_f32_16x16x32_bf16 a[136:139], a[144:147], v[168:171], a[136:139]
v_exp_f32 v141, v141
s_waitcnt lgkmcnt(2)
v_mfma_f32_16x16x32_bf16 a[96:99], v[24:27], v[160:163], a[96:99]
ds_read_b64_tr_b16 v[20:21], v33 offset:57344
v_cvt_pk_bf16_f32 v188, v140, v141
v_mfma_f32_16x16x32_bf16 a[100:103], v[24:27], v[164:167], a[100:103]
ds_read_b64_tr_b16 v[22:23], v33 offset:61440
v_mfma_f32_16x16x32_bf16 a[104:107], v[24:27], v[168:171], a[104:107]
v_exp_f32 v142, v142
v_mfma_f32_16x16x32_bf16 a[108:111], v[24:27], v[172:175], a[108:111]
v_exp_f32 v143, v143
v_mfma_f32_16x16x32_bf16 a[112:115], v[28:31], v[160:163], a[112:115]
ds_read_b64_tr_b16 v[24:25], v34 offset:57344
v_cvt_pk_bf16_f32 v189, v142, v143
v_mfma_f32_16x16x32_bf16 a[116:119], v[28:31], v[164:167], a[116:119]
ds_read_b64_tr_b16 v[26:27], v34 offset:61440
v_mfma_f32_16x16x32_bf16 a[120:123], v[28:31], v[168:171], a[120:123]
v_exp_f32 v144, v144
v_mfma_f32_16x16x32_bf16 a[124:127], v[28:31], v[172:175], a[124:127]
v_exp_f32 v145, v145
v_exp_f32 v146, v146
v_exp_f32 v147, v147
v_exp_f32 v148, v148
v_exp_f32 v149, v149
v_exp_f32 v150, v150
v_exp_f32 v151, v151
v_exp_f32 v152, v152
v_exp_f32 v153, v153
v_exp_f32 v154, v154
v_exp_f32 v155, v155
v_exp_f32 v156, v156
v_exp_f32 v157, v157
v_exp_f32 v158, v158
v_exp_f32 v159, v159
v_mfma_f32_16x16x32_bf16 a[140:143], a[144:147], v[172:175], a[140:143]
v_cvt_pk_bf16_f32 v178, v144, v145
v_cvt_pk_bf16_f32 v179, v146, v147
v_cvt_pk_bf16_f32 v182, v148, v149
v_cvt_pk_bf16_f32 v183, v150, v151
v_cvt_pk_bf16_f32 v186, v152, v153
v_cvt_pk_bf16_f32 v187, v154, v155
v_cvt_pk_bf16_f32 v190, v156, v157
v_cvt_pk_bf16_f32 v191, v158, v159
s_waitcnt lgkmcnt(2)
v_mfma_f32_16x16x32_bf16 a[128:131], a[144:147], v[176:179], a[128:131]
ds_read_b64_tr_b16 v[28:29], v35 offset:57344
s_add_u32 s42, s38, 0
v_mfma_f32_16x16x32_bf16 a[132:135], a[144:147], v[180:183], a[132:135]
ds_read_b64_tr_b16 v[30:31], v35 offset:61440
v_mfma_f32_16x16x32_bf16 a[136:139], a[144:147], v[184:187], a[136:139]
buffer_load_dwordx4 v2, s[48:51], s40 offen offset:1024 lds
v_mfma_f32_16x16x32_bf16 a[140:143], a[144:147], v[188:191], a[140:143]
v_mfma_f32_16x16x32_bf16 a[0:3], v[16:19], v[176:179], a[0:3]
v_mfma_f32_16x16x32_bf16 a[4:7], v[16:19], v[180:183], a[4:7]
v_mfma_f32_16x16x32_bf16 a[8:11], v[16:19], v[184:187], a[8:11]
v_mfma_f32_16x16x32_bf16 a[12:15], v[16:19], v[188:191], a[12:15]
v_mfma_f32_16x16x32_bf16 a[16:19], v[20:23], v[176:179], a[16:19]
ds_read_b64_tr_b16 v[16:17], v36 offset:57344
v_mfma_f32_16x16x32_bf16 a[20:23], v[20:23], v[180:183], a[20:23]
ds_read_b64_tr_b16 v[18:19], v36 offset:61440
v_accvgpr_read_b32 v4, a128
v_mfma_f32_16x16x32_bf16 a[24:27], v[20:23], v[184:187], a[24:27]
v_rcp_f32 v4, v4
v_mfma_f32_16x16x32_bf16 a[28:31], v[20:23], v[188:191], a[28:31]
v_accvgpr_read_b32 v5, a132
v_accvgpr_read_b32 v6, a136
s_waitcnt lgkmcnt(2)
v_mfma_f32_16x16x32_bf16 a[32:35], v[24:27], v[176:179], a[32:35]
ds_read_b64_tr_b16 v[20:21], v37 offset:57344
v_accvgpr_read_b32 v7, a140
v_mfma_f32_16x16x32_bf16 a[36:39], v[24:27], v[180:183], a[36:39]
ds_read_b64_tr_b16 v[22:23], v37 offset:61440
v_mfma_f32_16x16x32_bf16 a[40:43], v[24:27], v[184:187], a[40:43]
v_rcp_f32 v5, v5
v_mfma_f32_16x16x32_bf16 a[44:47], v[24:27], v[188:191], a[44:47]
buffer_load_dwordx4 v3, s[48:51], s40 offen offset:2048 lds
v_mfma_f32_16x16x32_bf16 a[48:51], v[28:31], v[176:179], a[48:51]
ds_read_b64_tr_b16 v[24:25], v38 offset:57344
v_accvgpr_read_b32 v40, a0
v_mfma_f32_16x16x32_bf16 a[52:55], v[28:31], v[180:183], a[52:55]
ds_read_b64_tr_b16 v[26:27], v38 offset:61440
v_accvgpr_read_b32 v41, a1
v_mfma_f32_16x16x32_bf16 a[56:59], v[28:31], v[184:187], a[56:59]
v_rcp_f32 v6, v6
v_mfma_f32_16x16x32_bf16 a[60:63], v[28:31], v[188:191], a[60:63]
v_rcp_f32 v7, v7
s_waitcnt lgkmcnt(2)
v_mfma_f32_16x16x32_bf16 a[64:67], v[16:19], v[176:179], a[64:67]
ds_read_b64_tr_b16 v[28:29], v39 offset:57344
v_accvgpr_read_b32 v42, a2
v_mfma_f32_16x16x32_bf16 a[68:71], v[16:19], v[180:183], a[68:71]
ds_read_b64_tr_b16 v[30:31], v39 offset:61440
v_accvgpr_read_b32 v43, a3
v_mfma_f32_16x16x32_bf16 a[72:75], v[16:19], v[184:187], a[72:75]
v_accvgpr_read_b32 v44, a16
v_accvgpr_read_b32 v45, a17
v_mfma_f32_16x16x32_bf16 a[76:79], v[16:19], v[188:191], a[76:79]
v_accvgpr_read_b32 v46, a18
v_accvgpr_read_b32 v47, a19
v_mfma_f32_16x16x32_bf16 a[80:83], v[20:23], v[176:179], a[80:83]
s_waitcnt vmcnt(3)
s_barrier
ds_read_b64_tr_b16 v[16:17], v15 offset:0
v_mfma_f32_16x16x32_bf16 a[84:87], v[20:23], v[180:183], a[84:87]
ds_read_b64_tr_b16 v[18:19], v15 offset:4608
v_mul_f32 v40, v40, v4
v_mfma_f32_16x16x32_bf16 a[88:91], v[20:23], v[184:187], a[88:91]
v_mul_f32 v41, v41, v4
v_mul_f32 v42, v42, v4
v_mfma_f32_16x16x32_bf16 a[92:95], v[20:23], v[188:191], a[92:95]
v_mul_f32 v43, v43, v4
v_mul_f32 v44, v44, v4
s_waitcnt lgkmcnt(2)
v_mfma_f32_16x16x32_bf16 a[96:99], v[24:27], v[176:179], a[96:99]
ds_read_b64_tr_b16 v[20:21], v15 offset:32
v_mul_f32 v45, v45, v4
v_mfma_f32_16x16x32_bf16 a[100:103], v[24:27], v[180:183], a[100:103]
ds_read_b64_tr_b16 v[22:23], v15 offset:4640
v_mul_f32 v46, v46, v4
v_mfma_f32_16x16x32_bf16 a[104:107], v[24:27], v[184:187], a[104:107]
buffer_load_dwordx4 v8, s[48:51], s40 offen offset:3072 lds
v_mfma_f32_16x16x32_bf16 a[108:111], v[24:27], v[188:191], a[108:111]
v_mul_f32 v47, v47, v4
v_cvt_pk_bf16_f32 v48, v40, v41
v_mfma_f32_16x16x32_bf16 a[112:115], v[28:31], v[176:179], a[112:115]
ds_read_b64_tr_b16 v[24:25], v15 offset:64
v_cvt_pk_bf16_f32 v49, v42, v43
v_mfma_f32_16x16x32_bf16 a[116:119], v[28:31], v[180:183], a[116:119]
ds_read_b64_tr_b16 v[26:27], v15 offset:4672
v_cvt_pk_bf16_f32 v50, v44, v45
v_mfma_f32_16x16x32_bf16 a[120:123], v[28:31], v[184:187], a[120:123]
v_cvt_pk_bf16_f32 v51, v46, v47
v_accvgpr_read_b32 v40, a4
s_add_u32 s41, s61, 24576
buffer_store_dwordx4 v[48:51], v9, s[8:11], s42 offen offset:0 sc1
v_accvgpr_read_b32 v41, a5
v_accvgpr_read_b32 v42, a6
v_accvgpr_read_b32 v43, a7
v_accvgpr_read_b32 v44, a20
v_accvgpr_read_b32 v45, a21
v_accvgpr_read_b32 v46, a22
v_accvgpr_read_b32 v47, a23
v_mul_f32 v40, v40, v5
v_mul_f32 v41, v41, v5
v_mul_f32 v42, v42, v5
v_mul_f32 v43, v43, v5
v_mul_f32 v44, v44, v5
v_mul_f32 v45, v45, v5
v_mul_f32 v46, v46, v5
v_mul_f32 v47, v47, v5
v_cvt_pk_bf16_f32 v52, v40, v41
v_cvt_pk_bf16_f32 v53, v42, v43
v_cvt_pk_bf16_f32 v54, v44, v45
v_cvt_pk_bf16_f32 v55, v46, v47
buffer_store_dwordx4 v[52:55], v9, s[8:11], s42 offen offset:1024 sc1
v_accvgpr_read_b32 v40, a8
v_accvgpr_read_b32 v41, a9
v_accvgpr_read_b32 v42, a10
v_accvgpr_read_b32 v43, a11
v_accvgpr_read_b32 v44, a24
v_accvgpr_read_b32 v45, a25
v_accvgpr_read_b32 v46, a26
v_accvgpr_read_b32 v47, a27
v_mul_f32 v40, v40, v6
v_mul_f32 v41, v41, v6
v_mul_f32 v42, v42, v6
v_mul_f32 v43, v43, v6
v_mul_f32 v44, v44, v6
v_mul_f32 v45, v45, v6
v_mul_f32 v46, v46, v6
v_mul_f32 v47, v47, v6
v_cvt_pk_bf16_f32 v56, v40, v41
v_cvt_pk_bf16_f32 v57, v42, v43
v_cvt_pk_bf16_f32 v58, v44, v45
v_cvt_pk_bf16_f32 v59, v46, v47
buffer_store_dwordx4 v[56:59], v9, s[8:11], s42 offen offset:2048 sc1
v_accvgpr_read_b32 v40, a12
v_accvgpr_read_b32 v41, a13
v_accvgpr_read_b32 v42, a14
v_accvgpr_read_b32 v43, a15
v_accvgpr_read_b32 v44, a28
v_accvgpr_read_b32 v45, a29
v_accvgpr_read_b32 v46, a30
v_accvgpr_read_b32 v47, a31
v_mul_f32 v40, v40, v7
v_mul_f32 v41, v41, v7
v_mul_f32 v42, v42, v7
v_mul_f32 v43, v43, v7
v_mul_f32 v44, v44, v7
v_mul_f32 v45, v45, v7
v_mul_f32 v46, v46, v7
v_mul_f32 v47, v47, v7
v_cvt_pk_bf16_f32 v60, v40, v41
v_cvt_pk_bf16_f32 v61, v42, v43
v_cvt_pk_bf16_f32 v62, v44, v45
v_cvt_pk_bf16_f32 v63, v46, v47
buffer_store_dwordx4 v[60:63], v9, s[8:11], s42 offen offset:3072 sc1
v_mfma_f32_16x16x32_bf16 a[124:127], v[28:31], v[188:191], a[124:127]
v_min3_f32 v40, v4, v5, v6
v_max3_f32 v41, v4, v5, v6
v_min_f32 v40, v40, v7
v_max_f32 v41, v41, v7
v_subrev_u32 v40, 0x30800000, v40
v_sub_u32 v41, 0x4e800000, v41
v_or_b32 v40, v40, v41
v_cmp_gt_i32 vcc, 0, v40
s_nop 4
s_cbranch_vccnz mk_fbY
mk_fbbackY:
s_add_u32 s42, s38, 4096
v_accvgpr_read_b32 v40, a32
v_accvgpr_read_b32 v41, a33
v_accvgpr_read_b32 v42, a34
v_accvgpr_read_b32 v43, a35
v_accvgpr_read_b32 v44, a48
v_accvgpr_read_b32 v45, a49
v_accvgpr_read_b32 v46, a50
v_accvgpr_read_b32 v47, a51
v_pk_mul_f32 v[40:41], v[40:41], v[4:5] op_sel_hi:[1,0]
v_pk_mul_f32 v[42:43], v[42:43], v[4:5] op_sel_hi:[1,0]
v_pk_mul_f32 v[44:45], v[44:45], v[4:5] op_sel_hi:[1,0]
v_pk_mul_f32 v[46:47], v[46:47], v[4:5] op_sel_hi:[1,0]
v_cvt_pk_bf16_f32 v64, v40, v41
v_cvt_pk_bf16_f32 v65, v42, v43
v_cvt_pk_bf16_f32 v66, v44, v45
v_cvt_pk_bf16_f32 v67, v46, v47
buffer_store_dwordx4 v[64:67], v9, s[8:11], s42 offen offset:0 sc1
v_accvgpr_read_b32 v32, a36
v_accvgpr_read_b32 v33, a37
v_accvgpr_read_b32 v34, a38
v_accvgpr_read_b32 v35, a39
v_accvgpr_read_b32 v36, a52
v_accvgpr_read_b32 v37, a53
v_accvgpr_read_b32 v38, a54
v_accvgpr_read_b32 v39, a55
v_pk_mul_f32 v[32:33], v[32:33], v[4:5] op_sel:[0,1] op_sel_hi:[1,1]
v_pk_mul_f32 v[34:35], v[34:35], v[4:5] op_sel:[0,1] op_sel_hi:[1,1]
v_pk_mul_f32 v[36:37], v[36:37], v[4:5] op_sel:[0,1] op_sel_hi:[1,1]
v_pk_mul_f32 v[38:39], v[38:39], v[4:5] op_sel:[0,1] op_sel_hi:[1,1]
v_cvt_pk_bf16_f32 v68, v32, v33
v_cvt_pk_bf16_f32 v69, v34, v35
v_cvt_pk_bf16_f32 v70, v36, v37
v_cvt_pk_bf16_f32 v71, v38, v39
buffer_store_dwordx4 v[68:71], v9, s[8:11], s42 offen offset:1024 sc1
v_accvgpr_read_b32 v40, a40
v_accvgpr_read_b32 v41, a41
v_accvgpr_read_b32 v42, a42
v_accvgpr_read_b32 v43, a43
v_accvgpr_read_b32 v44, a56
v_accvgpr_read_b32 v45, a57
v_accvgpr_read_b32 v46, a58
v_accvgpr_read_b32 v47, a59
v_pk_mul_f32 v[40:41], v[40:41], v[6:7] op_sel_hi:[1,0]
v_pk_mul_f32 v[42:43], v[42:43], v[6:7] op_sel_hi:[1,0]
v_pk_mul_f32 v[44:45], v[44:45], v[6:7] op_sel_hi:[1,0]
v_pk_mul_f32 v[46:47], v[46:47], v[6:7] op_sel_hi:[1,0]
v_cvt_pk_bf16_f32 v72, v40, v41
v_cvt_pk_bf16_f32 v73, v42, v43
v_cvt_pk_bf16_f32 v74, v44, v45
v_cvt_pk_bf16_f32 v75, v46, v47
buffer_store_dwordx4 v[72:75], v9, s[8:11], s42 offen offset:2048 sc1
v_accvgpr_read_b32 v32, a44
v_accvgpr_read_b32 v33, a45
v_accvgpr_read_b32 v34, a46
v_accvgpr_read_b32 v35, a47
v_accvgpr_read_b32 v36, a60
v_accvgpr_read_b32 v37, a61
v_accvgpr_read_b32 v38, a62
v_accvgpr_read_b32 v39, a63
v_pk_mul_f32 v[32:33], v[32:33], v[6:7] op_sel:[0,1] op_sel_hi:[1,1]
v_pk_mul_f32 v[34:35], v[34:35], v[6:7] op_sel:[0,1] op_sel_hi:[1,1]
v_pk_mul_f32 v[36:37], v[36:37], v[6:7] op_sel:[0,1] op_sel_hi:[1,1]
v_pk_mul_f32 v[38:39], v[38:39], v[6:7] op_sel:[0,1] op_sel_hi:[1,1]
v_cvt_pk_bf16_f32 v76, v32, v33
v_cvt_pk_bf16_f32 v77, v34, v35
v_cvt_pk_bf16_f32 v78, v36, v37
v_cvt_pk_bf16_f32 v79, v38, v39
buffer_store_dwordx4 v[76:79], v9, s[8:11], s42 offen offset:3072 sc1
s_add_u32 s42, s38, 8192
v_accvgpr_read_b32 v40, a64
v_accvgpr_read_b32 v41, a65
v_accvgpr_read_b32 v42, a66
v_accvgpr_read_b32 v43, a67
v_accvgpr_read_b32 v44, a80
v_accvgpr_read_b32 v45, a81
v_accvgpr_read_b32 v46, a82
v_accvgpr_read_b32 v47, a83
v_pk_mul_f32 v[40:41], v[40:41], v[4:5] op_sel_hi:[1,0]
v_pk_mul_f32 v[42:43], v[42:43], v[4:5] op_sel_hi:[1,0]
v_pk_mul_f32 v[44:45], v[44:45], v[4:5] op_sel_hi:[1,0]
v_pk_mul_f32 v[46:47], v[46:47], v[4:5] op_sel_hi:[1,0]
v_cvt_pk_bf16_f32 v80, v40, v41
v_cvt_pk_bf16_f32 v81, v42, v43
v_cvt_pk_bf16_f32 v82, v44, v45
v_cvt_pk_bf16_f32 v83, v46, v47
buffer_store_dwordx4 v[80:83], v9, s[8:11], s42 offen offset:0 sc1
v_accvgpr_read_b32 v32, a68
v_accvgpr_read_b32 v33, a69
v_accvgpr_read_b32 v34, a70
v_accvgpr_read_b32 v35, a71
v_accvgpr_read_b32 v36, a84
v_accvgpr_read_b32 v37, a85
v_accvgpr_read_b32 v38, a86
v_accvgpr_read_b32 v39, a87
v_pk_mul_f32 v[32:33], v[32:33], v[4:5] op_sel:[0,1] op_sel_hi:[1,1]
v_pk_mul_f32 v[34:35], v[34:35], v[4:5] op_sel:[0,1] op_sel_hi:[1,1]
v_pk_mul_f32 v[36:37], v[36:37], v[4:5] op_sel:[0,1] op_sel_hi:[1,1]
v_pk_mul_f32 v[38:39], v[38:39], v[4:5] op_sel:[0,1] op_sel_hi:[1,1]
v_cvt_pk_bf16_f32 v84, v32, v33
v_cvt_pk_bf16_f32 v85, v34, v35
v_cvt_pk_bf16_f32 v86, v36, v37
v_cvt_pk_bf16_f32 v87, v38, v39
buffer_store_dwordx4 v[84:87], v9, s[8:11], s42 offen offset:1024 sc1
v_accvgpr_read_b32 v40, a72
v_accvgpr_read_b32 v41, a73
v_accvgpr_read_b32 v42, a74
v_accvgpr_read_b32 v43, a75
v_accvgpr_read_b32 v44, a88
v_accvgpr_read_b32 v45, a89
v_accvgpr_read_b32 v46, a90
v_accvgpr_read_b32 v47, a91
v_pk_mul_f32 v[40:41], v[40:41], v[6:7] op_sel_hi:[1,0]
v_pk_mul_f32 v[42:43], v[42:43], v[6:7] op_sel_hi:[1,0]
v_pk_mul_f32 v[44:45], v[44:45], v[6:7] op_sel_hi:[1,0]
v_pk_mul_f32 v[46:47], v[46:47], v[6:7] op_sel_hi:[1,0]
v_cvt_pk_bf16_f32 v88, v40, v41
v_cvt_pk_bf16_f32 v89, v42, v43
v_cvt_pk_bf16_f32 v90, v44, v45
v_cvt_pk_bf16_f32 v91, v46, v47
buffer_store_dwordx4 v[88:91], v9, s[8:11], s42 offen offset:2048 sc1
v_accvgpr_read_b32 v32, a76
v_accvgpr_read_b32 v33, a77
v_accvgpr_read_b32 v34, a78
v_accvgpr_read_b32 v35, a79
v_accvgpr_read_b32 v36, a92
v_accvgpr_read_b32 v37, a93
v_accvgpr_read_b32 v38, a94
v_accvgpr_read_b32 v39, a95
v_pk_mul_f32 v[32:33], v[32:33], v[6:7] op_sel:[0,1] op_sel_hi:[1,1]
v_pk_mul_f32 v[34:35], v[34:35], v[6:7] op_sel:[0,1] op_sel_hi:[1,1]
v_pk_mul_f32 v[36:37], v[36:37], v[6:7] op_sel:[0,1] op_sel_hi:[1,1]
v_pk_mul_f32 v[38:39], v[38:39], v[6:7] op_sel:[0,1] op_sel_hi:[1,1]
v_cvt_pk_bf16_f32 v92, v32, v33
v_cvt_pk_bf16_f32 v93, v34, v35
v_cvt_pk_bf16_f32 v94, v36, v37
v_cvt_pk_bf16_f32 v95, v38, v39
buffer_store_dwordx4 v[92:95], v9, s[8:11], s42 offen offset:3072 sc1
s_add_u32 s42, s38, 12288
v_accvgpr_read_b32 v40, a96
v_accvgpr_read_b32 v41, a97
v_accvgpr_read_b32 v42, a98
v_accvgpr_read_b32 v43, a99
v_accvgpr_read_b32 v44, a112
v_accvgpr_read_b32 v45, a113
v_accvgpr_read_b32 v46, a114
v_accvgpr_read_b32 v47, a115
v_pk_mul_f32 v[40:41], v[40:41], v[4:5] op_sel_hi:[1,0]
v_pk_mul_f32 v[42:43], v[42:43], v[4:5] op_sel_hi:[1,0]
v_pk_mul_f32 v[44:45], v[44:45], v[4:5] op_sel_hi:[1,0]
v_pk_mul_f32 v[46:47], v[46:47], v[4:5] op_sel_hi:[1,0]
v_cvt_pk_bf16_f32 v96, v40, v41
v_cvt_pk_bf16_f32 v97, v42, v43
v_cvt_pk_bf16_f32 v98, v44, v45
v_cvt_pk_bf16_f32 v99, v46, v47
buffer_store_dwordx4 v[96:99], v9, s[8:11], s42 offen offset:0 sc1
v_accvgpr_read_b32 v32, a100
v_accvgpr_read_b32 v33, a101
v_accvgpr_read_b32 v34, a102
v_accvgpr_read_b32 v35, a103
v_accvgpr_read_b32 v36, a116
v_accvgpr_read_b32 v37, a117
v_accvgpr_read_b32 v38, a118
v_accvgpr_read_b32 v39, a119
v_pk_mul_f32 v[32:33], v[32:33], v[4:5] op_sel:[0,1] op_sel_hi:[1,1]
v_pk_mul_f32 v[34:35], v[34:35], v[4:5] op_sel:[0,1] op_sel_hi:[1,1]
v_pk_mul_f32 v[36:37], v[36:37], v[4:5] op_sel:[0,1] op_sel_hi:[1,1]
v_pk_mul_f32 v[38:39], v[38:39], v[4:5] op_sel:[0,1] op_sel_hi:[1,1]
v_cvt_pk_bf16_f32 v100, v32, v33
v_cvt_pk_bf16_f32 v101, v34, v35
v_cvt_pk_bf16_f32 v102, v36, v37
v_cvt_pk_bf16_f32 v103, v38, v39
buffer_store_dwordx4 v[100:103], v9, s[8:11], s42 offen offset:1024 sc1
v_accvgpr_read_b32 v40, a104
v_accvgpr_read_b32 v41, a105
v_accvgpr_read_b32 v42, a106
v_accvgpr_read_b32 v43, a107
v_accvgpr_read_b32 v44, a120
v_accvgpr_read_b32 v45, a121
v_accvgpr_read_b32 v46, a122
v_accvgpr_read_b32 v47, a123
v_pk_mul_f32 v[40:41], v[40:41], v[6:7] op_sel_hi:[1,0]
v_pk_mul_f32 v[42:43], v[42:43], v[6:7] op_sel_hi:[1,0]
v_pk_mul_f32 v[44:45], v[44:45], v[6:7] op_sel_hi:[1,0]
v_pk_mul_f32 v[46:47], v[46:47], v[6:7] op_sel_hi:[1,0]
v_cvt_pk_bf16_f32 v104, v40, v41
v_cvt_pk_bf16_f32 v105, v42, v43
v_cvt_pk_bf16_f32 v106, v44, v45
v_cvt_pk_bf16_f32 v107, v46, v47
buffer_store_dwordx4 v[104:107], v9, s[8:11], s42 offen offset:2048 sc1
v_accvgpr_read_b32 v32, a108
v_accvgpr_read_b32 v33, a109
v_accvgpr_read_b32 v34, a110
v_accvgpr_read_b32 v35, a111
v_accvgpr_read_b32 v36, a124
v_accvgpr_read_b32 v37, a125
v_accvgpr_read_b32 v38, a126
v_accvgpr_read_b32 v39, a127
v_pk_mul_f32 v[32:33], v[32:33], v[6:7] op_sel:[0,1] op_sel_hi:[1,1]
v_pk_mul_f32 v[34:35], v[34:35], v[6:7] op_sel:[0,1] op_sel_hi:[1,1]
v_pk_mul_f32 v[36:37], v[36:37], v[6:7] op_sel:[0,1] op_sel_hi:[1,1]
v_pk_mul_f32 v[38:39], v[38:39], v[6:7] op_sel:[0,1] op_sel_hi:[1,1]
v_cvt_pk_bf16_f32 v108, v32, v33
v_cvt_pk_bf16_f32 v109, v34, v35
v_cvt_pk_bf16_f32 v110, v36, v37
v_cvt_pk_bf16_f32 v111, v38, v39
buffer_store_dwordx4 v[108:111], v9, s[8:11], s42 offen offset:3072 sc1
v_mov_b32 v5, 268435456
v_cmp_eq_u32 vcc, 0, v0
s_nop 1
v_cndmask_b32 v4, v5, 0, vcc
v_lshlrev_b32 v6, 2, v0
v_cmp_gt_u32 vcc, 8, v0
s_nop 1
v_cndmask_b32 v6, v5, v6, vcc
v_mov_b32 v5, s100
s_waitcnt lgkmcnt(2)
v_mfma_f32_16x16x32_bf16 v[112:115], v[16:19], a[160:163], 0
ds_read_b64_tr_b16 v[28:29], v15 offset:96
v_mfma_f32_16x16x32_bf16 v[116:119], v[16:19], a[164:167], 0
ds_read_b64_tr_b16 v[30:31], v15 offset:4704
v_mfma_f32_16x16x32_bf16 v[120:123], v[16:19], a[168:171], 0
buffer_load_dwordx4 a[0:3], v9, s[8:11], s41 offen offset:0 sc1
v_mfma_f32_16x16x32_bf16 v[124:127], v[16:19], a[172:175], 0
v_mfma_f32_16x16x32_bf16 v[128:131], v[20:23], a[160:163], 0
ds_read_b64_tr_b16 v[16:17], v15 offset:128
s_add_u32 m0, s47, 40960
v_mfma_f32_16x16x32_bf16 v[132:135], v[20:23], a[164:167], 0
ds_read_b64_tr_b16 v[18:19], v15 offset:4736
s_barrier
v_mfma_f32_16x16x32_bf16 v[136:139], v[20:23], a[168:171], 0
v_mfma_f32_16x16x32_bf16 v[140:143], v[20:23], a[172:175], 0
buffer_load_dwordx4 v10, s[48:51], s40 offen offset:0 lds
s_waitcnt lgkmcnt(2)
v_mfma_f32_16x16x32_bf16 v[144:147], v[24:27], a[160:163], 0
ds_read_b64_tr_b16 v[20:21], v15 offset:160
v_mfma_f32_16x16x32_bf16 v[148:151], v[24:27], a[164:167], 0
ds_read_b64_tr_b16 v[22:23], v15 offset:4768
v_mfma_f32_16x16x32_bf16 v[152:155], v[24:27], a[168:171], 0
buffer_load_dwordx4 a[4:7], v9, s[8:11], s41 offen offset:1024 sc1
v_mfma_f32_16x16x32_bf16 v[156:159], v[24:27], a[172:175], 0
v_mfma_f32_16x16x32_bf16 v[160:163], v[28:31], a[160:163], 0
ds_read_b64_tr_b16 v[24:25], v15 offset:192
v_mfma_f32_16x16x32_bf16 v[164:167], v[28:31], a[164:167], 0
ds_read_b64_tr_b16 v[26:27], v15 offset:4800
v_mfma_f32_16x16x32_bf16 v[168:171], v[28:31], a[168:171], 0
buffer_load_dwordx4 a[8:11], v9, s[8:11], s41 offen offset:2048 sc1
v_mfma_f32_16x16x32_bf16 v[172:175], v[28:31], a[172:175], 0
s_waitcnt lgkmcnt(2)
v_mfma_f32_16x16x32_bf16 v[176:179], v[16:19], a[160:163], 0
ds_read_b64_tr_b16 v[28:29], v15 offset:224
v_mfma_f32_16x16x32_bf16 v[180:183], v[16:19], a[164:167], 0
ds_read_b64_tr_b16 v[30:31], v15 offset:4832
v_mfma_f32_16x16x32_bf16 v[184:187], v[16:19], a[168:171], 0
v_mfma_f32_16x16x32_bf16 v[188:191], v[16:19], a[172:175], 0
v_mfma_f32_16x16x32_bf16 v[192:195], v[20:23], a[160:163], 0
ds_read_b64_tr_b16 v[16:17], v15 offset:256
v_mfma_f32_16x16x32_bf16 v[196:199], v[20:23], a[164:167], 0
ds_read_b64_tr_b16 v[18:19], v15 offset:4864
v_mfma_f32_16x16x32_bf16 v[200:203], v[20:23], a[168:171], 0
buffer_load_dwordx4 v11, s[48:51], s40 offen offset:1024 lds
v_mfma_f32_16x16x32_bf16 v[204:207], v[20:23], a[172:175], 0
buffer_load_dwordx4 a[12:15], v9, s[8:11], s41 offen offset:3072 sc1
s_waitcnt lgkmcnt(2)
v_mfma_f32_16x16x32_bf16 v[208:211], v[24:27], a[160:163], 0
ds_read_b64_tr_b16 v[20:21], v15 offset:9216
v_mfma_f32_16x16x32_bf16 v[212:215], v[24:27], a[164:167], 0
ds_read_b64_tr_b16 v[22:23], v15 offset:13824
v_mfma_f32_16x16x32_bf16 v[216:219], v[24:27], a[168:171], 0
s_add_u32 s41, s61, 28672
v_mfma_f32_16x16x32_bf16 v[220:223], v[24:27], a[172:175], 0
v_mfma_f32_16x16x32_bf16 v[224:227], v[28:31], a[160:163], 0
ds_read_b64_tr_b16 v[24:25], v15 offset:9248
v_mfma_f32_16x16x32_bf16 v[228:231], v[28:31], a[164:167], 0
ds_read_b64_tr_b16 v[26:27], v15 offset:13856
v_mfma_f32_16x16x32_bf16 v[232:235], v[28:31], a[168:171], 0
buffer_load_dwordx4 a[16:19], v9, s[8:11], s41 offen offset:0 sc1
v_mfma_f32_16x16x32_bf16 v[236:239], v[28:31], a[172:175], 0
s_waitcnt lgkmcnt(2)
v_mfma_f32_16x16x32_bf16 v[240:243], v[16:19], a[160:163], 0
ds_read_b64_tr_b16 v[28:29], v15 offset:9280
v_mfma_f32_16x16x32_bf16 v[244:247], v[16:19], a[164:167], 0
ds_read_b64_tr_b16 v[30:31], v15 offset:13888
v_mfma_f32_16x16x32_bf16 v[248:251], v[16:19], a[168:171], 0
v_mfma_f32_16x16x32_bf16 v[252:255], v[16:19], a[172:175], 0
buffer_load_dwordx4 v12, s[48:51], s40 offen offset:2048 lds
v_mfma_f32_16x16x32_bf16 v[112:115], v[20:23], a[176:179], v[112:115]
ds_read_b64_tr_b16 v[16:17], v15 offset:9312
v_mfma_f32_16x16x32_bf16 v[116:119], v[20:23], a[180:183], v[116:119]
ds_read_b64_tr_b16 v[18:19], v15 offset:13920
v_mfma_f32_16x16x32_bf16 v[120:123], v[20:23], a[184:187], v[120:123]
buffer_load_dwordx4 a[20:23], v9, s[8:11], s41 offen offset:1024 sc1
v_mfma_f32_16x16x32_bf16 v[124:127], v[20:23], a[188:191], v[124:127]
s_waitcnt lgkmcnt(2)
v_mfma_f32_16x16x32_bf16 v[128:131], v[24:27], a[176:179], v[128:131]
ds_read_b64_tr_b16 v[20:21], v15 offset:9344
v_mfma_f32_16x16x32_bf16 v[132:135], v[24:27], a[180:183], v[132:135]
ds_read_b64_tr_b16 v[22:23], v15 offset:13952
v_mfma_f32_16x16x32_bf16 v[136:139], v[24:27], a[184:187], v[136:139]
buffer_load_dwordx4 a[24:27], v9, s[8:11], s41 offen offset:2048 sc1
v_mfma_f32_16x16x32_bf16 v[140:143], v[24:27], a[188:191], v[140:143]
v_mfma_f32_16x16x32_bf16 v[144:147], v[28:31], a[176:179], v[144:147]
ds_read_b64_tr_b16 v[24:25], v15 offset:9376
v_mfma_f32_16x16x32_bf16 v[148:151], v[28:31], a[180:183], v[148:151]
ds_read_b64_tr_b16 v[26:27], v15 offset:13984
v_mfma_f32_16x16x32_bf16 v[152:155], v[28:31], a[184:187], v[152:155]
v_mfma_f32_16x16x32_bf16 v[156:159], v[28:31], a[188:191], v[156:159]
s_waitcnt lgkmcnt(2)
v_mfma_f32_16x16x32_bf16 v[160:163], v[16:19], a[176:179], v[160:163]
ds_read_b64_tr_b16 v[28:29], v15 offset:9408
v_mfma_f32_16x16x32_bf16 v[164:167], v[16:19], a[180:183], v[164:167]
ds_read_b64_tr_b16 v[30:31], v15 offset:14016
v_mfma_f32_16x16x32_bf16 v[168:171], v[16:19], a[184:187], v[168:171]
buffer_load_dwordx4 v13, s[48:51], s40 offen offset:3072 lds
v_mfma_f32_16x16x32_bf16 v[172:175], v[16:19], a[188:191], v[172:175]
buffer_load_dwordx4 a[28:31], v9, s[8:11], s41 offen offset:3072 sc1
v_mfma_f32_16x16x32_bf16 v[176:179], v[20:23], a[176:179], v[176:179]
ds_read_b64_tr_b16 v[16:17], v15 offset:9440
v_mfma_f32_16x16x32_bf16 v[180:183], v[20:23], a[180:183], v[180:183]
ds_read_b64_tr_b16 v[18:19], v15 offset:14048
v_mfma_f32_16x16x32_bf16 v[184:187], v[20:23], a[184:187], v[184:187]
s_add_u32 s41, s61, 32768
v_mfma_f32_16x16x32_bf16 v[188:191], v[20:23], a[188:191], v[188:191]
s_waitcnt lgkmcnt(2)
v_mfma_f32_16x16x32_bf16 v[192:195], v[24:27], a[176:179], v[192:195]
ds_read_b64_tr_b16 v[20:21], v15 offset:9472
v_mfma_f32_16x16x32_bf16 v[196:199], v[24:27], a[180:183], v[196:199]
ds_read_b64_tr_b16 v[22:23], v15 offset:14080
v_mfma_f32_16x16x32_bf16 v[200:203], v[24:27], a[184:187], v[200:203]
buffer_load_dwordx4 a[32:35], v9, s[8:11], s41 offen offset:0 sc1
v_mfma_f32_16x16x32_bf16 v[204:207], v[24:27], a[188:191], v[204:207]
v_mfma_f32_16x16x32_bf16 v[208:211], v[28:31], a[176:179], v[208:211]
ds_read_b64_tr_b16 v[24:25], v15 offset:18432
s_add_u32 m0, s47, 45056
v_mfma_f32_16x16x32_bf16 v[212:215], v[28:31], a[180:183], v[212:215]
ds_read_b64_tr_b16 v[26:27], v15 offset:23040
v_mfma_f32_16x16x32_bf16 v[216:219], v[28:31], a[184:187], v[216:219]
v_mfma_f32_16x16x32_bf16 v[220:223], v[28:31], a[188:191], v[220:223]
buffer_load_dwordx4 v14, s[48:51], s40 offen offset:0 lds
s_waitcnt lgkmcnt(2)
v_mfma_f32_16x16x32_bf16 v[224:227], v[16:19], a[176:179], v[224:227]
ds_read_b64_tr_b16 v[28:29], v15 offset:18464
v_mfma_f32_16x16x32_bf16 v[228:231], v[16:19], a[180:183], v[228:231]
ds_read_b64_tr_b16 v[30:31], v15 offset:23072
v_mfma_f32_16x16x32_bf16 v[232:235], v[16:19], a[184:187], v[232:235]
buffer_load_dwordx4 a[36:39], v9, s[8:11], s41 offen offset:1024 sc1
v_mfma_f32_16x16x32_bf16 v[236:239], v[16:19], a[188:191], v[236:239]
v_mfma_f32_16x16x32_bf16 v[240:243], v[20:23], a[176:179], v[240:243]
ds_read_b64_tr_b16 v[16:17], v15 offset:18496
v_mfma_f32_16x16x32_bf16 v[244:247], v[20:23], a[180:183], v[244:247]
ds_read_b64_tr_b16 v[18:19], v15 offset:23104
s_waitcnt vmcnt(15)
buffer_store_dword v5, v4, s[8:11], s64 offen sc1
v_mfma_f32_16x16x32_bf16 v[248:251], v[20:23], a[184:187], v[248:251]
buffer_load_dwordx4 a[40:43], v9, s[8:11], s41 offen offset:2048 sc1
v_mfma_f32_16x16x32_bf16 v[252:255], v[20:23], a[188:191], v[252:255]
s_waitcnt lgkmcnt(2)
v_mfma_f32_16x16x32_bf16 v[112:115], v[24:27], a[192:195], v[112:115]
ds_read_b64_tr_b16 v[20:21], v15 offset:18528
v_mfma_f32_16x16x32_bf16 v[116:119], v[24:27], a[196:199], v[116:119]
ds_read_b64_tr_b16 v[22:23], v15 offset:23136
v_mfma_f32_16x16x32_bf16 v[120:123], v[24:27], a[200:203], v[120:123]
s_add_u32 m0, s47, 73728
s_add_u32 s40, s60, 294912
v_mfma_f32_16x16x32_bf16 v[124:127], v[24:27], a[204:207], v[124:127]
v_mfma_f32_16x16x32_bf16 v[128:131], v[28:31], a[192:195], v[128:131]
ds_read_b64_tr_b16 v[24:25], v15 offset:18560
v_mfma_f32_16x16x32_bf16 v[132:135], v[28:31], a[196:199], v[132:135]
ds_read_b64_tr_b16 v[26:27], v15 offset:23168
v_mfma_f32_16x16x32_bf16 v[136:139], v[28:31], a[200:203], v[136:139]
buffer_load_dwordx4 v1, s[48:51], s40 offen offset:0 lds
v_mfma_f32_16x16x32_bf16 v[140:143], v[28:31], a[204:207], v[140:143]
buffer_load_dwordx4 a[44:47], v9, s[8:11], s41 offen offset:3072 sc1
s_waitcnt lgkmcnt(2)
v_mfma_f32_16x16x32_bf16 v[144:147], v[16:19], a[192:195], v[144:147]
ds_read_b64_tr_b16 v[28:29], v15 offset:18592
v_mfma_f32_16x16x32_bf16 v[148:151], v[16:19], a[196:199], v[148:151]
ds_read_b64_tr_b16 v[30:31], v15 offset:23200
v_mfma_f32_16x16x32_bf16 v[152:155], v[16:19], a[200:203], v[152:155]
s_add_u32 s41, s61, 36864
v_mfma_f32_16x16x32_bf16 v[156:159], v[16:19], a[204:207], v[156:159]
v_mfma_f32_16x16x32_bf16 v[160:163], v[20:23], a[192:195], v[160:163]
ds_read_b64_tr_b16 v[16:17], v15 offset:18624
v_mfma_f32_16x16x32_bf16 v[164:167], v[20:23], a[196:199], v[164:167]
ds_read_b64_tr_b16 v[18:19], v15 offset:23232
v_mfma_f32_16x16x32_bf16 v[168:171], v[20:23], a[200:203], v[168:171]
buffer_load_dwordx4 a[48:51], v9, s[8:11], s41 offen offset:0 sc1
v_mfma_f32_16x16x32_bf16 v[172:175], v[20:23], a[204:207], v[172:175]
s_waitcnt lgkmcnt(2)
v_mfma_f32_16x16x32_bf16 v[176:179], v[24:27], a[192:195], v[176:179]
ds_read_b64_tr_b16 v[20:21], v15 offset:18656
v_mfma_f32_16x16x32_bf16 v[180:183], v[24:27], a[196:199], v[180:183]
ds_read_b64_tr_b16 v[22:23], v15 offset:23264
v_mfma_f32_16x16x32_bf16 v[184:187], v[24:27], a[200:203], v[184:187]
v_mfma_f32_16x16x32_bf16 v[188:191], v[24:27], a[204:207], v[188:191]
buffer_load_dwordx4 v2, s[48:51], s40 offen offset:1024 lds
v_mfma_f32_16x16x32_bf16 v[192:195], v[28:31], a[192:195], v[192:195]
ds_read_b64_tr_b16 v[24:25], v15 offset:18688
v_mfma_f32_16x16x32_bf16 v[196:199], v[28:31], a[196:199], v[196:199]
ds_read_b64_tr_b16 v[26:27], v15 offset:23296
v_mfma_f32_16x16x32_bf16 v[200:203], v[28:31], a[200:203], v[200:203]
buffer_load_dwordx4 a[52:55], v9, s[8:11], s41 offen offset:1024 sc1
v_mfma_f32_16x16x32_bf16 v[204:207], v[28:31], a[204:207], v[204:207]
s_waitcnt lgkmcnt(2)
v_mfma_f32_16x16x32_bf16 v[208:211], v[16:19], a[192:195], v[208:211]
ds_read_b64_tr_b16 v[28:29], v15 offset:27648
v_mfma_f32_16x16x32_bf16 v[212:215], v[16:19], a[196:199], v[212:215]
ds_read_b64_tr_b16 v[30:31], v15 offset:32256
v_mfma_f32_16x16x32_bf16 v[216:219], v[16:19], a[200:203], v[216:219]
buffer_load_dwordx4 a[56:59], v9, s[8:11], s41 offen offset:2048 sc1
v_mfma_f32_16x16x32_bf16 v[220:223], v[16:19], a[204:207], v[220:223]
v_mfma_f32_16x16x32_bf16 v[224:227], v[20:23], a[192:195], v[224:227]
ds_read_b64_tr_b16 v[16:17], v15 offset:27680
v_mfma_f32_16x16x32_bf16 v[228:231], v[20:23], a[196:199], v[228:231]
ds_read_b64_tr_b16 v[18:19], v15 offset:32288
v_mfma_f32_16x16x32_bf16 v[232:235], v[20:23], a[200:203], v[232:235]
v_mfma_f32_16x16x32_bf16 v[236:239], v[20:23], a[204:207], v[236:239]
s_waitcnt lgkmcnt(2)
v_mfma_f32_16x16x32_bf16 v[240:243], v[24:27], a[192:195], v[240:243]
ds_read_b64_tr_b16 v[20:21], v15 offset:27712
v_mfma_f32_16x16x32_bf16 v[244:247], v[24:27], a[196:199], v[244:247]
ds_read_b64_tr_b16 v[22:23], v15 offset:32320
v_mfma_f32_16x16x32_bf16 v[248:251], v[24:27], a[200:203], v[248:251]
buffer_load_dwordx4 v3, s[48:51], s40 offen offset:2048 lds
v_mfma_f32_16x16x32_bf16 v[252:255], v[24:27], a[204:207], v[252:255]
buffer_load_dwordx4 a[60:63], v9, s[8:11], s41 offen offset:3072 sc1
v_mfma_f32_16x16x32_bf16 v[112:115], v[28:31], a[208:211], v[112:115]
ds_read_b64_tr_b16 v[24:25], v15 offset:27744
v_mfma_f32_16x16x32_bf16 v[116:119], v[28:31], a[212:215], v[116:119]
ds_read_b64_tr_b16 v[26:27], v15 offset:32352
v_mfma_f32_16x16x32_bf16 v[120:123], v[28:31], a[216:219], v[120:123]
s_add_u32 s41, s61, 40960
v_mfma_f32_16x16x32_bf16 v[124:127], v[28:31], a[220:223], v[124:127]
s_waitcnt lgkmcnt(2)
v_mfma_f32_16x16x32_bf16 v[128:131], v[16:19], a[208:211], v[128:131]
ds_read_b64_tr_b16 v[28:29], v15 offset:27776
v_mfma_f32_16x16x32_bf16 v[132:135], v[16:19], a[212:215], v[132:135]
ds_read_b64_tr_b16 v[30:31], v15 offset:32384
v_mfma_f32_16x16x32_bf16 v[136:139], v[16:19], a[216:219], v[136:139]
buffer_load_dwordx4 a[64:67], v9, s[8:11], s41 offen offset:0 sc1
v_mfma_f32_16x16x32_bf16 v[140:143], v[16:19], a[220:223], v[140:143]
v_mfma_f32_16x16x32_bf16 v[144:147], v[20:23], a[208:211], v[144:147]
ds_read_b64_tr_b16 v[16:17], v15 offset:27808
v_mfma_f32_16x16x32_bf16 v[148:151], v[20:23], a[212:215], v[148:151]
ds_read_b64_tr_b16 v[18:19], v15 offset:32416
v_mfma_f32_16x16x32_bf16 v[152:155], v[20:23], a[216:219], v[152:155]
v_mfma_f32_16x16x32_bf16 v[156:159], v[20:23], a[220:223], v[156:159]
buffer_load_dwordx4 v8, s[48:51], s40 offen offset:3072 lds
s_waitcnt lgkmcnt(2)
v_mfma_f32_16x16x32_bf16 v[160:163], v[24:27], a[208:211], v[160:163]
ds_read_b64_tr_b16 v[20:21], v15 offset:27840
v_mfma_f32_16x16x32_bf16 v[164:167], v[24:27], a[212:215], v[164:167]
ds_read_b64_tr_b16 v[22:23], v15 offset:32448
v_mfma_f32_16x16x32_bf16 v[168:171], v[24:27], a[216:219], v[168:171]
buffer_load_dwordx4 a[68:71], v9, s[8:11], s41 offen offset:1024 sc1
v_mfma_f32_16x16x32_bf16 v[172:175], v[24:27], a[220:223], v[172:175]
v_mfma_f32_16x16x32_bf16 v[176:179], v[28:31], a[208:211], v[176:179]
ds_read_b64_tr_b16 v[24:25], v15 offset:27872
v_mfma_f32_16x16x32_bf16 v[180:183], v[28:31], a[212:215], v[180:183]
ds_read_b64_tr_b16 v[26:27], v15 offset:32480
v_mfma_f32_16x16x32_bf16 v[184:187], v[28:31], a[216:219], v[184:187]
buffer_load_dwordx4 a[72:75], v9, s[8:11], s41 offen offset:2048 sc1
v_mfma_f32_16x16x32_bf16 v[188:191], v[28:31], a[220:223], v[188:191]
s_waitcnt lgkmcnt(2)
v_mfma_f32_16x16x32_bf16 v[192:195], v[16:19], a[208:211], v[192:195]
ds_read_b64_tr_b16 v[28:29], v15 offset:27904
v_mfma_f32_16x16x32_bf16 v[196:199], v[16:19], a[212:215], v[196:199]
ds_read_b64_tr_b16 v[30:31], v15 offset:32512
v_mfma_f32_16x16x32_bf16 v[200:203], v[16:19], a[216:219], v[200:203]
s_add_u32 m0, s47, 77824
v_mfma_f32_16x16x32_bf16 v[204:207], v[16:19], a[220:223], v[204:207]
v_add_u32 v15, 0x9000, v15
v_mfma_f32_16x16x32_bf16 v[208:211], v[20:23], a[208:211], v[208:211]
s_waitcnt vmcnt(15)
s_barrier
ds_read_b64_tr_b16 v[16:17], v15 offset:0
v_mfma_f32_16x16x32_bf16 v[212:215], v[20:23], a[212:215], v[212:215]
ds_read_b64_tr_b16 v[18:19], v15 offset:4608
v_mfma_f32_16x16x32_bf16 v[216:219], v[20:23], a[216:219], v[216:219]
buffer_load_dwordx4 v10, s[48:51], s40 offen offset:0 lds
v_mfma_f32_16x16x32_bf16 v[220:223], v[20:23], a[220:223], v[220:223]
buffer_load_dwordx4 a[76:79], v9, s[8:11], s41 offen offset:3072 sc1
s_waitcnt lgkmcnt(2)
v_mfma_f32_16x16x32_bf16 v[224:227], v[24:27], a[208:211], v[224:227]
ds_read_b64_tr_b16 v[20:21], v15 offset:32
v_mfma_f32_16x16x32_bf16 v[228:231], v[24:27], a[212:215], v[228:231]
ds_read_b64_tr_b16 v[22:23], v15 offset:4640
v_mfma_f32_16x16x32_bf16 v[232:235], v[24:27], a[216:219], v[232:235]
s_add_u32 s41, s61, 45056
v_mfma_f32_16x16x32_bf16 v[236:239], v[24:27], a[220:223], v[236:239]
v_mfma_f32_16x16x32_bf16 v[240:243], v[28:31], a[208:211], v[240:243]
ds_read_b64_tr_b16 v[24:25], v15 offset:64
v_mfma_f32_16x16x32_bf16 v[244:247], v[28:31], a[212:215], v[244:247]
ds_read_b64_tr_b16 v[26:27], v15 offset:4672
v_mfma_f32_16x16x32_bf16 v[248:251], v[28:31], a[216:219], v[248:251]
buffer_load_dwordx4 a[80:83], v9, s[8:11], s41 offen offset:0 sc1
v_mfma_f32_16x16x32_bf16 v[252:255], v[28:31], a[220:223], v[252:255]
mk_LY_W1:
s_waitcnt lgkmcnt(2)
v_mfma_f32_16x16x32_bf16 v[112:115], v[16:19], a[224:227], v[112:115]
ds_read_b64_tr_b16 v[28:29], v15 offset:96
v_mfma_f32_16x16x32_bf16 v[116:119], v[16:19], a[228:231], v[116:119]
ds_read_b64_tr_b16 v[30:31], v15 offset:4704
v_mfma_f32_16x16x32_bf16 v[120:123], v[16:19], a[232:235], v[120:123]
v_mfma_f32_16x16x32_bf16 v[124:127], v[16:19], a[236:239], v[124:127]
buffer_load_dwordx4 v11, s[48:51], s40 offen offset:1024 lds
v_mfma_f32_16x16x32_bf16 v[128:131], v[20:23], a[224:227], v[128:131]
ds_read_b64_tr_b16 v[16:17], v15 offset:128
v_mfma_f32_16x16x32_bf16 v[132:135], v[20:23], a[228:231], v[132:135]
ds_read_b64_tr_b16 v[18:19], v15 offset:4736
s_barrier
v_mfma_f32_16x16x32_bf16 v[136:139], v[20:23], a[232:235], v[136:139]
buffer_load_dwordx4 a[84:87], v9, s[8:11], s41 offen offset:1024 sc1
v_mfma_f32_16x16x32_bf16 v[140:143], v[20:23], a[236:239], v[140:143]
s_waitcnt lgkmcnt(2)
v_mfma_f32_16x16x32_bf16 v[144:147], v[24:27], a[224:227], v[144:147]
ds_read_b64_tr_b16 v[20:21], v15 offset:160
v_mfma_f32_16x16x32_bf16 v[148:151], v[24:27], a[228:231], v[148:151]
ds_read_b64_tr_b16 v[22:23], v15 offset:4768
v_mfma_f32_16x16x32_bf16 v[152:155], v[24:27], a[232:235], v[152:155]
buffer_load_dwordx4 a[88:91], v9, s[8:11], s41 offen offset:2048 sc1
v_mfma_f32_16x16x32_bf16 v[156:159], v[24:27], a[236:239], v[156:159]
v_mfma_f32_16x16x32_bf16 v[160:163], v[28:31], a[224:227], v[160:163]
ds_read_b64_tr_b16 v[24:25], v15 offset:192
v_mfma_f32_16x16x32_bf16 v[164:167], v[28:31], a[228:231], v[164:167]
ds_read_b64_tr_b16 v[26:27], v15 offset:4800
v_mfma_f32_16x16x32_bf16 v[168:171], v[28:31], a[232:235], v[168:171]
v_mfma_f32_16x16x32_bf16 v[172:175], v[28:31], a[236:239], v[172:175]
s_waitcnt lgkmcnt(2)
v_mfma_f32_16x16x32_bf16 v[176:179], v[16:19], a[224:227], v[176:179]
ds_read_b64_tr_b16 v[28:29], v15 offset:224
v_mfma_f32_16x16x32_bf16 v[180:183], v[16:19], a[228:231], v[180:183]
ds_read_b64_tr_b16 v[30:31], v15 offset:4832
v_mfma_f32_16x16x32_bf16 v[184:187], v[16:19], a[232:235], v[184:187]
buffer_load_dwordx4 v12, s[48:51], s40 offen offset:2048 lds
v_mfma_f32_16x16x32_bf16 v[188:191], v[16:19], a[236:239], v[188:191]
buffer_load_dwordx4 a[92:95], v9, s[8:11], s41 offen offset:3072 sc1
v_mfma_f32_16x16x32_bf16 v[192:195], v[20:23], a[224:227], v[192:195]
ds_read_b64_tr_b16 v[16:17], v15 offset:256
v_mfma_f32_16x16x32_bf16 v[196:199], v[20:23], a[228:231], v[196:199]
ds_read_b64_tr_b16 v[18:19], v15 offset:4864
v_mfma_f32_16x16x32_bf16 v[200:203], v[20:23], a[232:235], v[200:203]
s_add_u32 s41, s61, 49152
v_mfma_f32_16x16x32_bf16 v[204:207], v[20:23], a[236:239], v[204:207]
s_waitcnt lgkmcnt(2)
v_mfma_f32_16x16x32_bf16 v[208:211], v[24:27], a[224:227], v[208:211]
ds_read_b64_tr_b16 v[20:21], v15 offset:9216
v_mfma_f32_16x16x32_bf16 v[212:215], v[24:27], a[228:231], v[212:215]
ds_read_b64_tr_b16 v[22:23], v15 offset:13824
v_mfma_f32_16x16x32_bf16 v[216:219], v[24:27], a[232:235], v[216:219]
buffer_load_dwordx4 a[96:99], v9, s[8:11], s41 offen offset:0 sc1
v_mfma_f32_16x16x32_bf16 v[220:223], v[24:27], a[236:239], v[220:223]
v_mfma_f32_16x16x32_bf16 v[224:227], v[28:31], a[224:227], v[224:227]
ds_read_b64_tr_b16 v[24:25], v15 offset:9248
v_mfma_f32_16x16x32_bf16 v[228:231], v[28:31], a[228:231], v[228:231]
ds_read_b64_tr_b16 v[26:27], v15 offset:13856
v_mfma_f32_16x16x32_bf16 v[232:235], v[28:31], a[232:235], v[232:235]
v_mfma_f32_16x16x32_bf16 v[236:239], v[28:31], a[236:239], v[236:239]
buffer_load_dwordx4 v13, s[48:51], s40 offen offset:3072 lds
s_waitcnt lgkmcnt(2)
v_mfma_f32_16x16x32_bf16 v[240:243], v[16:19], a[224:227], v[240:243]
ds_read_b64_tr_b16 v[28:29], v15 offset:9280
v_mfma_f32_16x16x32_bf16 v[244:247], v[16:19], a[228:231], v[244:247]
ds_read_b64_tr_b16 v[30:31], v15 offset:13888
v_mfma_f32_16x16x32_bf16 v[248:251], v[16:19], a[232:235], v[248:251]
buffer_load_dwordx4 a[100:103], v9, s[8:11], s41 offen offset:1024 sc1
v_mfma_f32_16x16x32_bf16 v[252:255], v[16:19], a[236:239], v[252:255]
v_mfma_f32_16x16x32_bf16 v[112:115], v[20:23], a[240:243], v[112:115]
ds_read_b64_tr_b16 v[16:17], v15 offset:9312
v_mfma_f32_16x16x32_bf16 v[116:119], v[20:23], a[244:247], v[116:119]
ds_read_b64_tr_b16 v[18:19], v15 offset:13920
v_mfma_f32_16x16x32_bf16 v[120:123], v[20:23], a[248:251], v[120:123]
buffer_load_dwordx4 a[104:107], v9, s[8:11], s41 offen offset:2048 sc1
v_mfma_f32_16x16x32_bf16 v[124:127], v[20:23], a[252:255], v[124:127]
s_waitcnt lgkmcnt(2)
v_mfma_f32_16x16x32_bf16 v[128:131], v[24:27], a[240:243], v[128:131]
ds_read_b64_tr_b16 v[20:21], v15 offset:9344
v_mfma_f32_16x16x32_bf16 v[132:135], v[24:27], a[244:247], v[132:135]
ds_read_b64_tr_b16 v[22:23], v15 offset:13952
v_mfma_f32_16x16x32_bf16 v[136:139], v[24:27], a[248:251], v[136:139]
s_add_u32 m0, s47, 81920
v_mfma_f32_16x16x32_bf16 v[140:143], v[24:27], a[252:255], v[140:143]
v_mfma_f32_16x16x32_bf16 v[144:147], v[28:31], a[240:243], v[144:147]
ds_read_b64_tr_b16 v[24:25], v15 offset:9376
v_mfma_f32_16x16x32_bf16 v[148:151], v[28:31], a[244:247], v[148:151]
ds_read_b64_tr_b16 v[26:27], v15 offset:13984
v_mfma_f32_16x16x32_bf16 v[152:155], v[28:31], a[248:251], v[152:155]
buffer_load_dwordx4 v14, s[48:51], s40 offen offset:0 lds
v_mfma_f32_16x16x32_bf16 v[156:159], v[28:31], a[252:255], v[156:159]
buffer_load_dwordx4 a[108:111], v9, s[8:11], s41 offen offset:3072 sc1
s_waitcnt lgkmcnt(2)
v_mfma_f32_16x16x32_bf16 v[160:163], v[16:19], a[240:243], v[160:163]
ds_read_b64_tr_b16 v[28:29], v15 offset:9408
v_mfma_f32_16x16x32_bf16 v[164:167], v[16:19], a[244:247], v[164:167]
ds_read_b64_tr_b16 v[30:31], v15 offset:14016
v_mfma_f32_16x16x32_bf16 v[168:171], v[16:19], a[248:251], v[168:171]
s_add_u32 s41, s61, 53248
v_mfma_f32_16x16x32_bf16 v[172:175], v[16:19], a[252:255], v[172:175]
v_mfma_f32_16x16x32_bf16 v[176:179], v[20:23], a[240:243], v[176:179]
ds_read_b64_tr_b16 v[16:17], v15 offset:9440
v_mfma_f32_16x16x32_bf16 v[180:183], v[20:23], a[244:247], v[180:183]
ds_read_b64_tr_b16 v[18:19], v15 offset:14048
v_mfma_f32_16x16x32_bf16 v[184:187], v[20:23], a[248:251], v[184:187]
buffer_load_dwordx4 a[112:115], v9, s[8:11], s41 offen offset:0 sc1
v_mfma_f32_16x16x32_bf16 v[188:191], v[20:23], a[252:255], v[188:191]
s_waitcnt lgkmcnt(2)
v_mfma_f32_16x16x32_bf16 v[192:195], v[24:27], a[240:243], v[192:195]
ds_read_b64_tr_b16 v[20:21], v15 offset:9472
s_add_u32 m0, s47, 110592
s_add_u32 s40, s60, 442368
v_mfma_f32_16x16x32_bf16 v[196:199], v[24:27], a[244:247], v[196:199]
ds_read_b64_tr_b16 v[22:23], v15 offset:14080
v_mfma_f32_16x16x32_bf16 v[200:203], v[24:27], a[248:251], v[200:203]
v_mfma_f32_16x16x32_bf16 v[204:207], v[24:27], a[252:255], v[204:207]
buffer_load_dwordx4 v1, s[48:51], s40 offen offset:0 lds
v_mfma_f32_16x16x32_bf16 v[208:211], v[28:31], a[240:243], v[208:211]
ds_read_b64_tr_b16 v[24:25], v15 offset:18432
v_mfma_f32_16x16x32_bf16 v[212:215], v[28:31], a[244:247], v[212:215]
ds_read_b64_tr_b16 v[26:27], v15 offset:23040
v_mfma_f32_16x16x32_bf16 v[216:219], v[28:31], a[248:251], v[216:219]
buffer_load_dwordx4 a[116:119], v9, s[8:11], s41 offen offset:1024 sc1
v_mfma_f32_16x16x32_bf16 v[220:223], v[28:31], a[252:255], v[220:223]
s_waitcnt lgkmcnt(2)
v_mfma_f32_16x16x32_bf16 v[224:227], v[16:19], a[240:243], v[224:227]
ds_read_b64_tr_b16 v[28:29], v15 offset:18464
v_mfma_f32_16x16x32_bf16 v[228:231], v[16:19], a[244:247], v[228:231]
ds_read_b64_tr_b16 v[30:31], v15 offset:23072
v_mfma_f32_16x16x32_bf16 v[232:235], v[16:19], a[248:251], v[232:235]
buffer_load_dwordx4 a[120:123], v9, s[8:11], s41 offen offset:2048 sc1
v_mfma_f32_16x16x32_bf16 v[236:239], v[16:19], a[252:255], v[236:239]
v_mfma_f32_16x16x32_bf16 v[240:243], v[20:23], a[240:243], v[240:243]
ds_read_b64_tr_b16 v[16:17], v15 offset:18496
v_mfma_f32_16x16x32_bf16 v[244:247], v[20:23], a[244:247], v[244:247]
ds_read_b64_tr_b16 v[18:19], v15 offset:23104
v_mfma_f32_16x16x32_bf16 v[248:251], v[20:23], a[248:251], v[248:251]
v_mfma_f32_16x16x32_bf16 v[252:255], v[20:23], a[252:255], v[252:255]
s_waitcnt lgkmcnt(2)
v_mfma_f32_16x16x32_bf16 v[112:115], v[24:27], a[0:3], v[112:115]
ds_read_b64_tr_b16 v[20:21], v15 offset:18528
v_mfma_f32_16x16x32_bf16 v[116:119], v[24:27], a[4:7], v[116:119]
ds_read_b64_tr_b16 v[22:23], v15 offset:23136
v_mfma_f32_16x16x32_bf16 v[120:123], v[24:27], a[8:11], v[120:123]
buffer_load_dwordx4 v2, s[48:51], s40 offen offset:1024 lds
v_mfma_f32_16x16x32_bf16 v[124:127], v[24:27], a[12:15], v[124:127]
buffer_load_dwordx4 a[124:127], v9, s[8:11], s41 offen offset:3072 sc1
v_mfma_f32_16x16x32_bf16 v[128:131], v[28:31], a[0:3], v[128:131]
ds_read_b64_tr_b16 v[24:25], v15 offset:18560
v_mfma_f32_16x16x32_bf16 v[132:135], v[28:31], a[4:7], v[132:135]
ds_read_b64_tr_b16 v[26:27], v15 offset:23168
v_mfma_f32_16x16x32_bf16 v[136:139], v[28:31], a[8:11], v[136:139]
s_add_u32 s41, s61, 57344
v_mfma_f32_16x16x32_bf16 v[140:143], v[28:31], a[12:15], v[140:143]
s_waitcnt lgkmcnt(2)
v_mfma_f32_16x16x32_bf16 v[144:147], v[16:19], a[0:3], v[144:147]
ds_read_b64_tr_b16 v[28:29], v15 offset:18592
v_mfma_f32_16x16x32_bf16 v[148:151], v[16:19], a[4:7], v[148:151]
ds_read_b64_tr_b16 v[30:31], v15 offset:23200
v_mfma_f32_16x16x32_bf16 v[152:155], v[16:19], a[8:11], v[152:155]
buffer_load_dwordx4 a[128:131], v9, s[8:11], s41 offen offset:0 sc1
v_mfma_f32_16x16x32_bf16 v[156:159], v[16:19], a[12:15], v[156:159]
v_mfma_f32_16x16x32_bf16 v[160:163], v[20:23], a[0:3], v[160:163]
ds_read_b64_tr_b16 v[16:17], v15 offset:18624
v_mfma_f32_16x16x32_bf16 v[164:167], v[20:23], a[4:7], v[164:167]
ds_read_b64_tr_b16 v[18:19], v15 offset:23232
v_mfma_f32_16x16x32_bf16 v[168:171], v[20:23], a[8:11], v[168:171]
v_mfma_f32_16x16x32_bf16 v[172:175], v[20:23], a[12:15], v[172:175]
buffer_load_dwordx4 v3, s[48:51], s40 offen offset:2048 lds
s_waitcnt lgkmcnt(2)
v_mfma_f32_16x16x32_bf16 v[176:179], v[24:27], a[0:3], v[176:179]
ds_read_b64_tr_b16 v[20:21], v15 offset:18656
v_mfma_f32_16x16x32_bf16 v[180:183], v[24:27], a[4:7], v[180:183]
ds_read_b64_tr_b16 v[22:23], v15 offset:23264
v_mfma_f32_16x16x32_bf16 v[184:187], v[24:27], a[8:11], v[184:187]
buffer_load_dwordx4 a[132:135], v9, s[8:11], s41 offen offset:1024 sc1
v_mfma_f32_16x16x32_bf16 v[188:191], v[24:27], a[12:15], v[188:191]
v_mfma_f32_16x16x32_bf16 v[192:195], v[28:31], a[0:3], v[192:195]
ds_read_b64_tr_b16 v[24:25], v15 offset:18688
v_mfma_f32_16x16x32_bf16 v[196:199], v[28:31], a[4:7], v[196:199]
ds_read_b64_tr_b16 v[26:27], v15 offset:23296
v_mfma_f32_16x16x32_bf16 v[200:203], v[28:31], a[8:11], v[200:203]
buffer_load_dwordx4 a[136:139], v9, s[8:11], s41 offen offset:2048 sc1
v_mfma_f32_16x16x32_bf16 v[204:207], v[28:31], a[12:15], v[204:207]
s_waitcnt lgkmcnt(2)
v_mfma_f32_16x16x32_bf16 v[208:211], v[16:19], a[0:3], v[208:211]
ds_read_b64_tr_b16 v[28:29], v15 offset:27648
v_mfma_f32_16x16x32_bf16 v[212:215], v[16:19], a[4:7], v[212:215]
ds_read_b64_tr_b16 v[30:31], v15 offset:32256
v_mfma_f32_16x16x32_bf16 v[216:219], v[16:19], a[8:11], v[216:219]
v_mfma_f32_16x16x32_bf16 v[220:223], v[16:19], a[12:15], v[220:223]
v_mfma_f32_16x16x32_bf16 v[224:227], v[20:23], a[0:3], v[224:227]
ds_read_b64_tr_b16 v[16:17], v15 offset:27680
v_mfma_f32_16x16x32_bf16 v[228:231], v[20:23], a[4:7], v[228:231]
ds_read_b64_tr_b16 v[18:19], v15 offset:32288
v_mfma_f32_16x16x32_bf16 v[232:235], v[20:23], a[8:11], v[232:235]
buffer_load_dwordx4 v8, s[48:51], s40 offen offset:3072 lds
v_mfma_f32_16x16x32_bf16 v[236:239], v[20:23], a[12:15], v[236:239]
buffer_load_dwordx4 a[140:143], v9, s[8:11], s41 offen offset:3072 sc1
s_waitcnt lgkmcnt(2)
v_mfma_f32_16x16x32_bf16 v[240:243], v[24:27], a[0:3], v[240:243]
ds_read_b64_tr_b16 v[20:21], v15 offset:27712
v_mfma_f32_16x16x32_bf16 v[244:247], v[24:27], a[4:7], v[244:247]
ds_read_b64_tr_b16 v[22:23], v15 offset:32320
v_mfma_f32_16x16x32_bf16 v[248:251], v[24:27], a[8:11], v[248:251]
s_add_u32 s41, s61, 61440
v_mfma_f32_16x16x32_bf16 v[252:255], v[24:27], a[12:15], v[252:255]
v_mfma_f32_16x16x32_bf16 v[112:115], v[28:31], a[16:19], v[112:115]
ds_read_b64_tr_b16 v[24:25], v15 offset:27744
v_mfma_f32_16x16x32_bf16 v[116:119], v[28:31], a[20:23], v[116:119]
ds_read_b64_tr_b16 v[26:27], v15 offset:32352
v_mfma_f32_16x16x32_bf16 v[120:123], v[28:31], a[24:27], v[120:123]
buffer_load_dwordx4 a[160:163], v9, s[8:11], s41 offen offset:0 sc1
v_mfma_f32_16x16x32_bf16 v[124:127], v[28:31], a[28:31], v[124:127]
s_waitcnt lgkmcnt(2)
v_mfma_f32_16x16x32_bf16 v[128:131], v[16:19], a[16:19], v[128:131]
ds_read_b64_tr_b16 v[28:29], v15 offset:27776
s_add_u32 m0, s47, 114688
v_mfma_f32_16x16x32_bf16 v[132:135], v[16:19], a[20:23], v[132:135]
ds_read_b64_tr_b16 v[30:31], v15 offset:32384
v_mfma_f32_16x16x32_bf16 v[136:139], v[16:19], a[24:27], v[136:139]
v_mfma_f32_16x16x32_bf16 v[140:143], v[16:19], a[28:31], v[140:143]
buffer_load_dwordx4 v10, s[48:51], s40 offen offset:0 lds
v_mfma_f32_16x16x32_bf16 v[144:147], v[20:23], a[16:19], v[144:147]
ds_read_b64_tr_b16 v[16:17], v15 offset:27808
v_mfma_f32_16x16x32_bf16 v[148:151], v[20:23], a[20:23], v[148:151]
ds_read_b64_tr_b16 v[18:19], v15 offset:32416
v_mfma_f32_16x16x32_bf16 v[152:155], v[20:23], a[24:27], v[152:155]
buffer_load_dwordx4 a[164:167], v9, s[8:11], s41 offen offset:1024 sc1
v_mfma_f32_16x16x32_bf16 v[156:159], v[20:23], a[28:31], v[156:159]
s_waitcnt lgkmcnt(2)
v_mfma_f32_16x16x32_bf16 v[160:163], v[24:27], a[16:19], v[160:163]
ds_read_b64_tr_b16 v[20:21], v15 offset:27840
v_mfma_f32_16x16x32_bf16 v[164:167], v[24:27], a[20:23], v[164:167]
ds_read_b64_tr_b16 v[22:23], v15 offset:32448
v_mfma_f32_16x16x32_bf16 v[168:171], v[24:27], a[24:27], v[168:171]
v_mfma_f32_16x16x32_bf16 v[172:175], v[24:27], a[28:31], v[172:175]
v_mfma_f32_16x16x32_bf16 v[176:179], v[28:31], a[16:19], v[176:179]
ds_read_b64_tr_b16 v[24:25], v15 offset:27872
v_mfma_f32_16x16x32_bf16 v[180:183], v[28:31], a[20:23], v[180:183]
ds_read_b64_tr_b16 v[26:27], v15 offset:32480
v_mfma_f32_16x16x32_bf16 v[184:187], v[28:31], a[24:27], v[184:187]
buffer_load_dwordx4 a[168:171], v9, s[8:11], s41 offen offset:2048 sc1
v_mfma_f32_16x16x32_bf16 v[188:191], v[28:31], a[28:31], v[188:191]
s_waitcnt lgkmcnt(2)
v_mfma_f32_16x16x32_bf16 v[192:195], v[16:19], a[16:19], v[192:195]
ds_read_b64_tr_b16 v[28:29], v15 offset:27904
v_mfma_f32_16x16x32_bf16 v[196:199], v[16:19], a[20:23], v[196:199]
ds_read_b64_tr_b16 v[30:31], v15 offset:32512
v_mfma_f32_16x16x32_bf16 v[200:203], v[16:19], a[24:27], v[200:203]
buffer_load_dwordx4 v11, s[48:51], s40 offen offset:1024 lds
v_mfma_f32_16x16x32_bf16 v[204:207], v[16:19], a[28:31], v[204:207]
v_add_u32 v15, 0x9000, v15
v_mfma_f32_16x16x32_bf16 v[208:211], v[20:23], a[16:19], v[208:211]
s_waitcnt vmcnt(18)
s_barrier
ds_read_b64_tr_b16 v[16:17], v15 offset:0
v_mfma_f32_16x16x32_bf16 v[212:215], v[20:23], a[20:23], v[212:215]
ds_read_b64_tr_b16 v[18:19], v15 offset:4608
v_mfma_f32_16x16x32_bf16 v[216:219], v[20:23], a[24:27], v[216:219]
buffer_load_dwordx4 a[172:175], v9, s[8:11], s41 offen offset:3072 sc1
v_mfma_f32_16x16x32_bf16 v[220:223], v[20:23], a[28:31], v[220:223]
s_waitcnt lgkmcnt(2)
v_mfma_f32_16x16x32_bf16 v[224:227], v[24:27], a[16:19], v[224:227]
ds_read_b64_tr_b16 v[20:21], v15 offset:32
v_mfma_f32_16x16x32_bf16 v[228:231], v[24:27], a[20:23], v[228:231]
ds_read_b64_tr_b16 v[22:23], v15 offset:4640
v_mfma_f32_16x16x32_bf16 v[232:235], v[24:27], a[24:27], v[232:235]
s_add_u32 s41, s61, 65536
v_mfma_f32_16x16x32_bf16 v[236:239], v[24:27], a[28:31], v[236:239]
v_mfma_f32_16x16x32_bf16 v[240:243], v[28:31], a[16:19], v[240:243]
ds_read_b64_tr_b16 v[24:25], v15 offset:64
v_mfma_f32_16x16x32_bf16 v[244:247], v[28:31], a[20:23], v[244:247]
ds_read_b64_tr_b16 v[26:27], v15 offset:4672
v_mfma_f32_16x16x32_bf16 v[248:251], v[28:31], a[24:27], v[248:251]
buffer_load_dwordx4 a[176:179], v9, s[8:11], s41 offen offset:0 sc1
v_mfma_f32_16x16x32_bf16 v[252:255], v[28:31], a[28:31], v[252:255]
buffer_load_dwordx4 v12, s[48:51], s40 offen offset:2048 lds
s_waitcnt lgkmcnt(2)
v_mfma_f32_16x16x32_bf16 v[112:115], v[16:19], a[32:35], v[112:115]
ds_read_b64_tr_b16 v[28:29], v15 offset:96
v_mfma_f32_16x16x32_bf16 v[116:119], v[16:19], a[36:39], v[116:119]
ds_read_b64_tr_b16 v[30:31], v15 offset:4704
v_mfma_f32_16x16x32_bf16 v[120:123], v[16:19], a[40:43], v[120:123]
v_mfma_f32_16x16x32_bf16 v[124:127], v[16:19], a[44:47], v[124:127]
v_mfma_f32_16x16x32_bf16 v[128:131], v[20:23], a[32:35], v[128:131]
ds_read_b64_tr_b16 v[16:17], v15 offset:128
v_mfma_f32_16x16x32_bf16 v[132:135], v[20:23], a[36:39], v[132:135]
ds_read_b64_tr_b16 v[18:19], v15 offset:4736
s_barrier
v_mfma_f32_16x16x32_bf16 v[136:139], v[20:23], a[40:43], v[136:139]
buffer_load_dwordx4 a[180:183], v9, s[8:11], s41 offen offset:1024 sc1
v_mfma_f32_16x16x32_bf16 v[140:143], v[20:23], a[44:47], v[140:143]
s_waitcnt lgkmcnt(2)
v_mfma_f32_16x16x32_bf16 v[144:147], v[24:27], a[32:35], v[144:147]
ds_read_b64_tr_b16 v[20:21], v15 offset:160
v_mfma_f32_16x16x32_bf16 v[148:151], v[24:27], a[36:39], v[148:151]
ds_read_b64_tr_b16 v[22:23], v15 offset:4768
v_mfma_f32_16x16x32_bf16 v[152:155], v[24:27], a[40:43], v[152:155]
v_mfma_f32_16x16x32_bf16 v[156:159], v[24:27], a[44:47], v[156:159]
v_mfma_f32_16x16x32_bf16 v[160:163], v[28:31], a[32:35], v[160:163]
ds_read_b64_tr_b16 v[24:25], v15 offset:192
v_mfma_f32_16x16x32_bf16 v[164:167], v[28:31], a[36:39], v[164:167]
ds_read_b64_tr_b16 v[26:27], v15 offset:4800
v_mfma_f32_16x16x32_bf16 v[168:171], v[28:31], a[40:43], v[168:171]
buffer_load_dwordx4 a[184:187], v9, s[8:11], s41 offen offset:2048 sc1
v_mfma_f32_16x16x32_bf16 v[172:175], v[28:31], a[44:47], v[172:175]
buffer_load_dwordx4 v13, s[48:51], s40 offen offset:3072 lds
s_waitcnt lgkmcnt(2)
v_mfma_f32_16x16x32_bf16 v[176:179], v[16:19], a[32:35], v[176:179]
ds_read_b64_tr_b16 v[28:29], v15 offset:224
v_mfma_f32_16x16x32_bf16 v[180:183], v[16:19], a[36:39], v[180:183]
ds_read_b64_tr_b16 v[30:31], v15 offset:4832
v_mfma_f32_16x16x32_bf16 v[184:187], v[16:19], a[40:43], v[184:187]
v_mfma_f32_16x16x32_bf16 v[188:191], v[16:19], a[44:47], v[188:191]
v_mfma_f32_16x16x32_bf16 v[192:195], v[20:23], a[32:35], v[192:195]
ds_read_b64_tr_b16 v[16:17], v15 offset:256
v_mfma_f32_16x16x32_bf16 v[196:199], v[20:23], a[36:39], v[196:199]
ds_read_b64_tr_b16 v[18:19], v15 offset:4864
v_mfma_f32_16x16x32_bf16 v[200:203], v[20:23], a[40:43], v[200:203]
buffer_load_dwordx4 a[188:191], v9, s[8:11], s41 offen offset:3072 sc1
v_mfma_f32_16x16x32_bf16 v[204:207], v[20:23], a[44:47], v[204:207]
s_waitcnt lgkmcnt(2)
v_mfma_f32_16x16x32_bf16 v[208:211], v[24:27], a[32:35], v[208:211]
ds_read_b64_tr_b16 v[20:21], v15 offset:9216
s_add_u32 m0, s47, 118784
v_mfma_f32_16x16x32_bf16 v[212:215], v[24:27], a[36:39], v[212:215]
ds_read_b64_tr_b16 v[22:23], v15 offset:13824
v_mfma_f32_16x16x32_bf16 v[216:219], v[24:27], a[40:43], v[216:219]
s_add_u32 s41, s61, 69632
v_mfma_f32_16x16x32_bf16 v[220:223], v[24:27], a[44:47], v[220:223]
buffer_load_dwordx4 v14, s[48:51], s40 offen offset:0 lds
v_mfma_f32_16x16x32_bf16 v[224:227], v[28:31], a[32:35], v[224:227]
ds_read_b64_tr_b16 v[24:25], v15 offset:9248
v_mfma_f32_16x16x32_bf16 v[228:231], v[28:31], a[36:39], v[228:231]
ds_read_b64_tr_b16 v[26:27], v15 offset:13856
v_mfma_f32_16x16x32_bf16 v[232:235], v[28:31], a[40:43], v[232:235]
buffer_load_dwordx4 a[192:195], v9, s[8:11], s41 offen offset:0 sc1
v_mfma_f32_16x16x32_bf16 v[236:239], v[28:31], a[44:47], v[236:239]
s_waitcnt lgkmcnt(2)
v_mfma_f32_16x16x32_bf16 v[240:243], v[16:19], a[32:35], v[240:243]
ds_read_b64_tr_b16 v[28:29], v15 offset:9280
v_mfma_f32_16x16x32_bf16 v[244:247], v[16:19], a[36:39], v[244:247]
ds_read_b64_tr_b16 v[30:31], v15 offset:13888
v_mfma_f32_16x16x32_bf16 v[248:251], v[16:19], a[40:43], v[248:251]
v_mfma_f32_16x16x32_bf16 v[252:255], v[16:19], a[44:47], v[252:255]
v_mfma_f32_16x16x32_bf16 v[112:115], v[20:23], a[48:51], v[112:115]
ds_read_b64_tr_b16 v[16:17], v15 offset:9312
v_mfma_f32_16x16x32_bf16 v[116:119], v[20:23], a[52:55], v[116:119]
ds_read_b64_tr_b16 v[18:19], v15 offset:13920
v_mfma_f32_16x16x32_bf16 v[120:123], v[20:23], a[56:59], v[120:123]
buffer_load_dwordx4 a[196:199], v9, s[8:11], s41 offen offset:1024 sc1
s_add_u32 m0, s47, 0
s_add_u32 s40, s60, 589824
v_mfma_f32_16x16x32_bf16 v[124:127], v[20:23], a[60:63], v[124:127]
s_waitcnt lgkmcnt(2)
v_mfma_f32_16x16x32_bf16 v[128:131], v[24:27], a[48:51], v[128:131]
ds_read_b64_tr_b16 v[20:21], v15 offset:9344
v_mfma_f32_16x16x32_bf16 v[132:135], v[24:27], a[52:55], v[132:135]
ds_read_b64_tr_b16 v[22:23], v15 offset:13952
v_mfma_f32_16x16x32_bf16 v[136:139], v[24:27], a[56:59], v[136:139]
buffer_load_dwordx4 v1, s[48:51], s40 offen offset:0 lds
v_mfma_f32_16x16x32_bf16 v[140:143], v[24:27], a[60:63], v[140:143]
v_mfma_f32_16x16x32_bf16 v[144:147], v[28:31], a[48:51], v[144:147]
ds_read_b64_tr_b16 v[24:25], v15 offset:9376
v_mfma_f32_16x16x32_bf16 v[148:151], v[28:31], a[52:55], v[148:151]
ds_read_b64_tr_b16 v[26:27], v15 offset:13984
v_mfma_f32_16x16x32_bf16 v[152:155], v[28:31], a[56:59], v[152:155]
buffer_load_dwordx4 a[200:203], v9, s[8:11], s41 offen offset:2048 sc1
v_mfma_f32_16x16x32_bf16 v[156:159], v[28:31], a[60:63], v[156:159]
s_waitcnt lgkmcnt(2)
v_mfma_f32_16x16x32_bf16 v[160:163], v[16:19], a[48:51], v[160:163]
ds_read_b64_tr_b16 v[28:29], v15 offset:9408
v_mfma_f32_16x16x32_bf16 v[164:167], v[16:19], a[52:55], v[164:167]
ds_read_b64_tr_b16 v[30:31], v15 offset:14016
v_mfma_f32_16x16x32_bf16 v[168:171], v[16:19], a[56:59], v[168:171]
v_mfma_f32_16x16x32_bf16 v[172:175], v[16:19], a[60:63], v[172:175]
v_mfma_f32_16x16x32_bf16 v[176:179], v[20:23], a[48:51], v[176:179]
ds_read_b64_tr_b16 v[16:17], v15 offset:9440
v_mfma_f32_16x16x32_bf16 v[180:183], v[20:23], a[52:55], v[180:183]
ds_read_b64_tr_b16 v[18:19], v15 offset:14048
v_mfma_f32_16x16x32_bf16 v[184:187], v[20:23], a[56:59], v[184:187]
buffer_load_dwordx4 a[204:207], v9, s[8:11], s41 offen offset:3072 sc1
v_mfma_f32_16x16x32_bf16 v[188:191], v[20:23], a[60:63], v[188:191]
buffer_load_dwordx4 v2, s[48:51], s40 offen offset:1024 lds
s_waitcnt lgkmcnt(2)
v_mfma_f32_16x16x32_bf16 v[192:195], v[24:27], a[48:51], v[192:195]
ds_read_b64_tr_b16 v[20:21], v15 offset:9472
v_mfma_f32_16x16x32_bf16 v[196:199], v[24:27], a[52:55], v[196:199]
ds_read_b64_tr_b16 v[22:23], v15 offset:14080
v_mfma_f32_16x16x32_bf16 v[200:203], v[24:27], a[56:59], v[200:203]
s_add_u32 s41, s61, 73728
v_mfma_f32_16x16x32_bf16 v[204:207], v[24:27], a[60:63], v[204:207]
v_mfma_f32_16x16x32_bf16 v[208:211], v[28:31], a[48:51], v[208:211]
ds_read_b64_tr_b16 v[24:25], v15 offset:18432
v_mfma_f32_16x16x32_bf16 v[212:215], v[28:31], a[52:55], v[212:215]
ds_read_b64_tr_b16 v[26:27], v15 offset:23040
v_mfma_f32_16x16x32_bf16 v[216:219], v[28:31], a[56:59], v[216:219]
buffer_load_dwordx4 a[208:211], v9, s[8:11], s41 offen offset:0 sc1
v_mfma_f32_16x16x32_bf16 v[220:223], v[28:31], a[60:63], v[220:223]
s_waitcnt lgkmcnt(2)
v_mfma_f32_16x16x32_bf16 v[224:227], v[16:19], a[48:51], v[224:227]
ds_read_b64_tr_b16 v[28:29], v15 offset:18464
v_mfma_f32_16x16x32_bf16 v[228:231], v[16:19], a[52:55], v[228:231]
ds_read_b64_tr_b16 v[30:31], v15 offset:23072
v_mfma_f32_16x16x32_bf16 v[232:235], v[16:19], a[56:59], v[232:235]
v_mfma_f32_16x16x32_bf16 v[236:239], v[16:19], a[60:63], v[236:239]
v_mfma_f32_16x16x32_bf16 v[240:243], v[20:23], a[48:51], v[240:243]
ds_read_b64_tr_b16 v[16:17], v15 offset:18496
v_mfma_f32_16x16x32_bf16 v[244:247], v[20:23], a[52:55], v[244:247]
ds_read_b64_tr_b16 v[18:19], v15 offset:23104
v_mfma_f32_16x16x32_bf16 v[248:251], v[20:23], a[56:59], v[248:251]
buffer_load_dwordx4 a[212:215], v9, s[8:11], s41 offen offset:1024 sc1
v_mfma_f32_16x16x32_bf16 v[252:255], v[20:23], a[60:63], v[252:255]
buffer_load_dwordx4 v3, s[48:51], s40 offen offset:2048 lds
s_waitcnt lgkmcnt(2)
v_mfma_f32_16x16x32_bf16 v[112:115], v[24:27], a[64:67], v[112:115]
ds_read_b64_tr_b16 v[20:21], v15 offset:18528
v_mfma_f32_16x16x32_bf16 v[116:119], v[24:27], a[68:71], v[116:119]
ds_read_b64_tr_b16 v[22:23], v15 offset:23136
v_mfma_f32_16x16x32_bf16 v[120:123], v[24:27], a[72:75], v[120:123]
v_mfma_f32_16x16x32_bf16 v[124:127], v[24:27], a[76:79], v[124:127]
v_mfma_f32_16x16x32_bf16 v[128:131], v[28:31], a[64:67], v[128:131]
ds_read_b64_tr_b16 v[24:25], v15 offset:18560
v_mfma_f32_16x16x32_bf16 v[132:135], v[28:31], a[68:71], v[132:135]
ds_read_b64_tr_b16 v[26:27], v15 offset:23168
v_mfma_f32_16x16x32_bf16 v[136:139], v[28:31], a[72:75], v[136:139]
buffer_load_dwordx4 a[216:219], v9, s[8:11], s41 offen offset:2048 sc1
v_mfma_f32_16x16x32_bf16 v[140:143], v[28:31], a[76:79], v[140:143]
s_waitcnt lgkmcnt(2)
v_mfma_f32_16x16x32_bf16 v[144:147], v[16:19], a[64:67], v[144:147]
ds_read_b64_tr_b16 v[28:29], v15 offset:18592
v_mfma_f32_16x16x32_bf16 v[148:151], v[16:19], a[68:71], v[148:151]
ds_read_b64_tr_b16 v[30:31], v15 offset:23200
v_mfma_f32_16x16x32_bf16 v[152:155], v[16:19], a[72:75], v[152:155]
v_mfma_f32_16x16x32_bf16 v[156:159], v[16:19], a[76:79], v[156:159]
buffer_load_dwordx4 v8, s[48:51], s40 offen offset:3072 lds
v_mfma_f32_16x16x32_bf16 v[160:163], v[20:23], a[64:67], v[160:163]
ds_read_b64_tr_b16 v[16:17], v15 offset:18624
v_mfma_f32_16x16x32_bf16 v[164:167], v[20:23], a[68:71], v[164:167]
ds_read_b64_tr_b16 v[18:19], v15 offset:23232
v_mfma_f32_16x16x32_bf16 v[168:171], v[20:23], a[72:75], v[168:171]
buffer_load_dwordx4 a[220:223], v9, s[8:11], s41 offen offset:3072 sc1
v_mfma_f32_16x16x32_bf16 v[172:175], v[20:23], a[76:79], v[172:175]
s_waitcnt lgkmcnt(2)
v_mfma_f32_16x16x32_bf16 v[176:179], v[24:27], a[64:67], v[176:179]
ds_read_b64_tr_b16 v[20:21], v15 offset:18656
v_mfma_f32_16x16x32_bf16 v[180:183], v[24:27], a[68:71], v[180:183]
ds_read_b64_tr_b16 v[22:23], v15 offset:23264
v_mfma_f32_16x16x32_bf16 v[184:187], v[24:27], a[72:75], v[184:187]
s_add_u32 s41, s61, 77824
v_mfma_f32_16x16x32_bf16 v[188:191], v[24:27], a[76:79], v[188:191]
v_mfma_f32_16x16x32_bf16 v[192:195], v[28:31], a[64:67], v[192:195]
ds_read_b64_tr_b16 v[24:25], v15 offset:18688
v_mfma_f32_16x16x32_bf16 v[196:199], v[28:31], a[68:71], v[196:199]
ds_read_b64_tr_b16 v[26:27], v15 offset:23296
v_mfma_f32_16x16x32_bf16 v[200:203], v[28:31], a[72:75], v[200:203]
buffer_load_dwordx4 a[224:227], v9, s[8:11], s41 offen offset:0 sc1
s_add_u32 m0, s47, 4096
v_mfma_f32_16x16x32_bf16 v[204:207], v[28:31], a[76:79], v[204:207]
s_waitcnt lgkmcnt(2)
v_mfma_f32_16x16x32_bf16 v[208:211], v[16:19], a[64:67], v[208:211]
ds_read_b64_tr_b16 v[28:29], v15 offset:27648
v_mfma_f32_16x16x32_bf16 v[212:215], v[16:19], a[68:71], v[212:215]
ds_read_b64_tr_b16 v[30:31], v15 offset:32256
v_mfma_f32_16x16x32_bf16 v[216:219], v[16:19], a[72:75], v[216:219]
buffer_load_dwordx4 v10, s[48:51], s40 offen offset:0 lds
v_mfma_f32_16x16x32_bf16 v[220:223], v[16:19], a[76:79], v[220:223]
v_mfma_f32_16x16x32_bf16 v[224:227], v[20:23], a[64:67], v[224:227]
ds_read_b64_tr_b16 v[16:17], v15 offset:27680
v_mfma_f32_16x16x32_bf16 v[228:231], v[20:23], a[68:71], v[228:231]
ds_read_b64_tr_b16 v[18:19], v15 offset:32288
v_mfma_f32_16x16x32_bf16 v[232:235], v[20:23], a[72:75], v[232:235]
buffer_load_dwordx4 a[228:231], v9, s[8:11], s41 offen offset:1024 sc1
v_mfma_f32_16x16x32_bf16 v[236:239], v[20:23], a[76:79], v[236:239]
s_waitcnt lgkmcnt(2)
v_mfma_f32_16x16x32_bf16 v[240:243], v[24:27], a[64:67], v[240:243]
ds_read_b64_tr_b16 v[20:21], v15 offset:27712
v_mfma_f32_16x16x32_bf16 v[244:247], v[24:27], a[68:71], v[244:247]
ds_read_b64_tr_b16 v[22:23], v15 offset:32320
v_mfma_f32_16x16x32_bf16 v[248:251], v[24:27], a[72:75], v[248:251]
v_mfma_f32_16x16x32_bf16 v[252:255], v[24:27], a[76:79], v[252:255]
v_mfma_f32_16x16x32_bf16 v[112:115], v[28:31], a[80:83], v[112:115]
ds_read_b64_tr_b16 v[24:25], v15 offset:27744
v_mfma_f32_16x16x32_bf16 v[116:119], v[28:31], a[84:87], v[116:119]
ds_read_b64_tr_b16 v[26:27], v15 offset:32352
v_mfma_f32_16x16x32_bf16 v[120:123], v[28:31], a[88:91], v[120:123]
buffer_load_dwordx4 a[232:235], v9, s[8:11], s41 offen offset:2048 sc1
v_mfma_f32_16x16x32_bf16 v[124:127], v[28:31], a[92:95], v[124:127]
buffer_load_dwordx4 v11, s[48:51], s40 offen offset:1024 lds
s_waitcnt lgkmcnt(2)
v_mfma_f32_16x16x32_bf16 v[128:131], v[16:19], a[80:83], v[128:131]
ds_read_b64_tr_b16 v[28:29], v15 offset:27776
v_mfma_f32_16x16x32_bf16 v[132:135], v[16:19], a[84:87], v[132:135]
ds_read_b64_tr_b16 v[30:31], v15 offset:32384
v_mfma_f32_16x16x32_bf16 v[136:139], v[16:19], a[88:91], v[136:139]
v_mfma_f32_16x16x32_bf16 v[140:143], v[16:19], a[92:95], v[140:143]
v_mfma_f32_16x16x32_bf16 v[144:147], v[20:23], a[80:83], v[144:147]
ds_read_b64_tr_b16 v[16:17], v15 offset:27808
v_mfma_f32_16x16x32_bf16 v[148:151], v[20:23], a[84:87], v[148:151]
ds_read_b64_tr_b16 v[18:19], v15 offset:32416
v_mfma_f32_16x16x32_bf16 v[152:155], v[20:23], a[88:91], v[152:155]
buffer_load_dwordx4 a[236:239], v9, s[8:11], s41 offen offset:3072 sc1
v_mfma_f32_16x16x32_bf16 v[156:159], v[20:23], a[92:95], v[156:159]
s_waitcnt lgkmcnt(2)
v_mfma_f32_16x16x32_bf16 v[160:163], v[24:27], a[80:83], v[160:163]
ds_read_b64_tr_b16 v[20:21], v15 offset:27840
v_mfma_f32_16x16x32_bf16 v[164:167], v[24:27], a[84:87], v[164:167]
ds_read_b64_tr_b16 v[22:23], v15 offset:32448
v_mfma_f32_16x16x32_bf16 v[168:171], v[24:27], a[88:91], v[168:171]
s_add_u32 s41, s61, 81920
v_mfma_f32_16x16x32_bf16 v[172:175], v[24:27], a[92:95], v[172:175]
v_mfma_f32_16x16x32_bf16 v[176:179], v[28:31], a[80:83], v[176:179]
ds_read_b64_tr_b16 v[24:25], v15 offset:27872
v_mfma_f32_16x16x32_bf16 v[180:183], v[28:31], a[84:87], v[180:183]
ds_read_b64_tr_b16 v[26:27], v15 offset:32480
v_mfma_f32_16x16x32_bf16 v[184:187], v[28:31], a[88:91], v[184:187]
buffer_load_dwordx4 a[240:243], v9, s[8:11], s41 offen offset:0 sc1
v_mfma_f32_16x16x32_bf16 v[188:191], v[28:31], a[92:95], v[188:191]
buffer_load_dwordx4 v12, s[48:51], s40 offen offset:2048 lds
s_waitcnt lgkmcnt(2)
v_mfma_f32_16x16x32_bf16 v[192:195], v[16:19], a[80:83], v[192:195]
ds_read_b64_tr_b16 v[28:29], v15 offset:27904
v_mfma_f32_16x16x32_bf16 v[196:199], v[16:19], a[84:87], v[196:199]
ds_read_b64_tr_b16 v[30:31], v15 offset:32512
v_mfma_f32_16x16x32_bf16 v[200:203], v[16:19], a[88:91], v[200:203]
v_mfma_f32_16x16x32_bf16 v[204:207], v[16:19], a[92:95], v[204:207]
v_add_u32 v15, 0x9000, v15
v_mfma_f32_16x16x32_bf16 v[208:211], v[20:23], a[80:83], v[208:211]
s_waitcnt vmcnt(20)
s_barrier
ds_read_b64_tr_b16 v[16:17], v15 offset:0
v_mfma_f32_16x16x32_bf16 v[212:215], v[20:23], a[84:87], v[212:215]
ds_read_b64_tr_b16 v[18:19], v15 offset:4608
v_mfma_f32_16x16x32_bf16 v[216:219], v[20:23], a[88:91], v[216:219]
buffer_load_dwordx4 a[244:247], v9, s[8:11], s41 offen offset:1024 sc1
v_mfma_f32_16x16x32_bf16 v[220:223], v[20:23], a[92:95], v[220:223]
s_waitcnt lgkmcnt(2)
v_mfma_f32_16x16x32_bf16 v[224:227], v[24:27], a[80:83], v[224:227]
ds_read_b64_tr_b16 v[20:21], v15 offset:32
v_mfma_f32_16x16x32_bf16 v[228:231], v[24:27], a[84:87], v[228:231]
ds_read_b64_tr_b16 v[22:23], v15 offset:4640
v_mfma_f32_16x16x32_bf16 v[232:235], v[24:27], a[88:91], v[232:235]
v_mfma_f32_16x16x32_bf16 v[236:239], v[24:27], a[92:95], v[236:239]
buffer_load_dwordx4 v13, s[48:51], s40 offen offset:3072 lds
v_mfma_f32_16x16x32_bf16 v[240:243], v[28:31], a[80:83], v[240:243]
ds_read_b64_tr_b16 v[24:25], v15 offset:64
v_mfma_f32_16x16x32_bf16 v[244:247], v[28:31], a[84:87], v[244:247]
ds_read_b64_tr_b16 v[26:27], v15 offset:4672
v_mfma_f32_16x16x32_bf16 v[248:251], v[28:31], a[88:91], v[248:251]
buffer_load_dwordx4 a[248:251], v9, s[8:11], s41 offen offset:2048 sc1
v_mfma_f32_16x16x32_bf16 v[252:255], v[28:31], a[92:95], v[252:255]
s_waitcnt lgkmcnt(2)
v_mfma_f32_16x16x32_bf16 v[112:115], v[16:19], a[96:99], v[112:115]
ds_read_b64_tr_b16 v[28:29], v15 offset:96
v_mfma_f32_16x16x32_bf16 v[116:119], v[16:19], a[100:103], v[116:119]
ds_read_b64_tr_b16 v[30:31], v15 offset:4704
v_mfma_f32_16x16x32_bf16 v[120:123], v[16:19], a[104:107], v[120:123]
v_mfma_f32_16x16x32_bf16 v[124:127], v[16:19], a[108:111], v[124:127]
v_mfma_f32_16x16x32_bf16 v[128:131], v[20:23], a[96:99], v[128:131]
ds_read_b64_tr_b16 v[16:17], v15 offset:128
v_mfma_f32_16x16x32_bf16 v[132:135], v[20:23], a[100:103], v[132:135]
ds_read_b64_tr_b16 v[18:19], v15 offset:4736
s_barrier
v_mfma_f32_16x16x32_bf16 v[136:139], v[20:23], a[104:107], v[136:139]
buffer_load_dwordx4 a[252:255], v9, s[8:11], s41 offen offset:3072 sc1
s_add_u32 m0, s47, 8192
v_mfma_f32_16x16x32_bf16 v[140:143], v[20:23], a[108:111], v[140:143]
s_waitcnt lgkmcnt(2)
v_mfma_f32_16x16x32_bf16 v[144:147], v[24:27], a[96:99], v[144:147]
ds_read_b64_tr_b16 v[20:21], v15 offset:160
v_mfma_f32_16x16x32_bf16 v[148:151], v[24:27], a[100:103], v[148:151]
ds_read_b64_tr_b16 v[22:23], v15 offset:4768
v_mfma_f32_16x16x32_bf16 v[152:155], v[24:27], a[104:107], v[152:155]
buffer_load_dwordx4 v14, s[48:51], s40 offen offset:0 lds
s_add_u32 s41, s61, 86016
v_mfma_f32_16x16x32_bf16 v[156:159], v[24:27], a[108:111], v[156:159]
v_mfma_f32_16x16x32_bf16 v[160:163], v[28:31], a[96:99], v[160:163]
ds_read_b64_tr_b16 v[24:25], v15 offset:192
v_mfma_f32_16x16x32_bf16 v[164:167], v[28:31], a[100:103], v[164:167]
ds_read_b64_tr_b16 v[26:27], v15 offset:4800
v_mfma_f32_16x16x32_bf16 v[168:171], v[28:31], a[104:107], v[168:171]
buffer_load_dwordx4 a[0:3], v9, s[8:11], s41 offen offset:0 sc1
v_mfma_f32_16x16x32_bf16 v[172:175], v[28:31], a[108:111], v[172:175]
s_waitcnt lgkmcnt(2)
v_mfma_f32_16x16x32_bf16 v[176:179], v[16:19], a[96:99], v[176:179]
ds_read_b64_tr_b16 v[28:29], v15 offset:224
v_mfma_f32_16x16x32_bf16 v[180:183], v[16:19], a[100:103], v[180:183]
ds_read_b64_tr_b16 v[30:31], v15 offset:4832
v_mfma_f32_16x16x32_bf16 v[184:187], v[16:19], a[104:107], v[184:187]
v_mfma_f32_16x16x32_bf16 v[188:191], v[16:19], a[108:111], v[188:191]
v_mfma_f32_16x16x32_bf16 v[192:195], v[20:23], a[96:99], v[192:195]
ds_read_b64_tr_b16 v[16:17], v15 offset:256
s_add_u32 m0, s47, 36864
s_add_u32 s40, s60, 737280
v_mfma_f32_16x16x32_bf16 v[196:199], v[20:23], a[100:103], v[196:199]
ds_read_b64_tr_b16 v[18:19], v15 offset:4864
v_mfma_f32_16x16x32_bf16 v[200:203], v[20:23], a[104:107], v[200:203]
buffer_load_dwordx4 a[4:7], v9, s[8:11], s41 offen offset:1024 sc1
v_mfma_f32_16x16x32_bf16 v[204:207], v[20:23], a[108:111], v[204:207]
buffer_load_dwordx4 v1, s[48:51], s40 offen offset:0 lds
s_lshl_b32 s72, s28, 13
s_waitcnt lgkmcnt(2)
v_mfma_f32_16x16x32_bf16 v[208:211], v[24:27], a[96:99], v[208:211]
ds_read_b64_tr_b16 v[20:21], v15 offset:9216
s_add_u32 s72, s72, mk_LY_W5-mk_pc
v_lshl_add_u32 v46, v0, 7, s72
v_mfma_f32_16x16x32_bf16 v[212:215], v[24:27], a[100:103], v[212:215]
ds_read_b64_tr_b16 v[22:23], v15 offset:13824
v_min_u32 v46, mk_fin-mk_pc, v46
v_mfma_f32_16x16x32_bf16 v[216:219], v[24:27], a[104:107], v[216:219]
global_load_dword v47, v46, s[4:5]
v_mfma_f32_16x16x32_bf16 v[220:223], v[24:27], a[108:111], v[220:223]
v_mfma_f32_16x16x32_bf16 v[224:227], v[28:31], a[96:99], v[224:227]
ds_read_b64_tr_b16 v[24:25], v15 offset:9248
v_mfma_f32_16x16x32_bf16 v[228:231], v[28:31], a[100:103], v[228:231]
ds_read_b64_tr_b16 v[26:27], v15 offset:13856
v_mfma_f32_16x16x32_bf16 v[232:235], v[28:31], a[104:107], v[232:235]
buffer_load_dwordx4 a[8:11], v9, s[8:11], s41 offen offset:2048 sc1
v_mfma_f32_16x16x32_bf16 v[236:239], v[28:31], a[108:111], v[236:239]
s_waitcnt lgkmcnt(2)
v_mfma_f32_16x16x32_bf16 v[240:243], v[16:19], a[96:99], v[240:243]
ds_read_b64_tr_b16 v[28:29], v15 offset:9280
v_mfma_f32_16x16x32_bf16 v[244:247], v[16:19], a[100:103], v[244:247]
ds_read_b64_tr_b16 v[30:31], v15 offset:13888
v_mfma_f32_16x16x32_bf16 v[248:251], v[16:19], a[104:107], v[248:251]
v_mfma_f32_16x16x32_bf16 v[252:255], v[16:19], a[108:111], v[252:255]
v_mfma_f32_16x16x32_bf16 v[112:115], v[20:23], a[112:115], v[112:115]
ds_read_b64_tr_b16 v[16:17], v15 offset:9312
v_mfma_f32_16x16x32_bf16 v[116:119], v[20:23], a[116:119], v[116:119]
ds_read_b64_tr_b16 v[18:19], v15 offset:13920
v_mfma_f32_16x16x32_bf16 v[120:123], v[20:23], a[120:123], v[120:123]
buffer_load_dwordx4 a[12:15], v9, s[8:11], s41 offen offset:3072 sc1
v_mfma_f32_16x16x32_bf16 v[124:127], v[20:23], a[124:127], v[124:127]
buffer_load_dwordx4 v2, s[48:51], s40 offen offset:1024 lds
s_waitcnt lgkmcnt(2)
v_mfma_f32_16x16x32_bf16 v[128:131], v[24:27], a[112:115], v[128:131]
ds_read_b64_tr_b16 v[20:21], v15 offset:9344
v_mfma_f32_16x16x32_bf16 v[132:135], v[24:27], a[116:119], v[132:135]
ds_read_b64_tr_b16 v[22:23], v15 offset:13952
v_mfma_f32_16x16x32_bf16 v[136:139], v[24:27], a[120:123], v[136:139]
s_add_u32 s41, s61, 90112
v_mfma_f32_16x16x32_bf16 v[140:143], v[24:27], a[124:127], v[140:143]
v_mfma_f32_16x16x32_bf16 v[144:147], v[28:31], a[112:115], v[144:147]
ds_read_b64_tr_b16 v[24:25], v15 offset:9376
v_mfma_f32_16x16x32_bf16 v[148:151], v[28:31], a[116:119], v[148:151]
ds_read_b64_tr_b16 v[26:27], v15 offset:13984
v_mfma_f32_16x16x32_bf16 v[152:155], v[28:31], a[120:123], v[152:155]
buffer_load_dwordx4 a[16:19], v9, s[8:11], s41 offen offset:0 sc1
v_mfma_f32_16x16x32_bf16 v[156:159], v[28:31], a[124:127], v[156:159]
s_waitcnt lgkmcnt(2)
v_mfma_f32_16x16x32_bf16 v[160:163], v[16:19], a[112:115], v[160:163]
ds_read_b64_tr_b16 v[28:29], v15 offset:9408
v_mfma_f32_16x16x32_bf16 v[164:167], v[16:19], a[116:119], v[164:167]
ds_read_b64_tr_b16 v[30:31], v15 offset:14016
v_mfma_f32_16x16x32_bf16 v[168:171], v[16:19], a[120:123], v[168:171]
v_mfma_f32_16x16x32_bf16 v[172:175], v[16:19], a[124:127], v[172:175]
buffer_load_dwordx4 v3, s[48:51], s40 offen offset:2048 lds
v_mfma_f32_16x16x32_bf16 v[176:179], v[20:23], a[112:115], v[176:179]
ds_read_b64_tr_b16 v[16:17], v15 offset:9440
v_mfma_f32_16x16x32_bf16 v[180:183], v[20:23], a[116:119], v[180:183]
ds_read_b64_tr_b16 v[18:19], v15 offset:14048
v_mfma_f32_16x16x32_bf16 v[184:187], v[20:23], a[120:123], v[184:187]
buffer_load_dwordx4 a[20:23], v9, s[8:11], s41 offen offset:1024 sc1
v_mfma_f32_16x16x32_bf16 v[188:191], v[20:23], a[124:127], v[188:191]
s_waitcnt lgkmcnt(2)
v_mfma_f32_16x16x32_bf16 v[192:195], v[24:27], a[112:115], v[192:195]
ds_read_b64_tr_b16 v[20:21], v15 offset:9472
v_mfma_f32_16x16x32_bf16 v[196:199], v[24:27], a[116:119], v[196:199]
ds_read_b64_tr_b16 v[22:23], v15 offset:14080
v_mfma_f32_16x16x32_bf16 v[200:203], v[24:27], a[120:123], v[200:203]
v_mfma_f32_16x16x32_bf16 v[204:207], v[24:27], a[124:127], v[204:207]
v_mfma_f32_16x16x32_bf16 v[208:211], v[28:31], a[112:115], v[208:211]
ds_read_b64_tr_b16 v[24:25], v15 offset:18432
v_mfma_f32_16x16x32_bf16 v[212:215], v[28:31], a[116:119], v[212:215]
ds_read_b64_tr_b16 v[26:27], v15 offset:23040
v_mfma_f32_16x16x32_bf16 v[216:219], v[28:31], a[120:123], v[216:219]
buffer_load_dwordx4 a[24:27], v9, s[8:11], s41 offen offset:2048 sc1
v_mfma_f32_16x16x32_bf16 v[220:223], v[28:31], a[124:127], v[220:223]
s_waitcnt lgkmcnt(2)
v_mfma_f32_16x16x32_bf16 v[224:227], v[16:19], a[112:115], v[224:227]
ds_read_b64_tr_b16 v[28:29], v15 offset:18464
v_mfma_f32_16x16x32_bf16 v[228:231], v[16:19], a[116:119], v[228:231]
ds_read_b64_tr_b16 v[30:31], v15 offset:23072
v_mfma_f32_16x16x32_bf16 v[232:235], v[16:19], a[120:123], v[232:235]
buffer_load_dwordx4 v8, s[48:51], s40 offen offset:3072 lds
v_mfma_f32_16x16x32_bf16 v[236:239], v[16:19], a[124:127], v[236:239]
v_mfma_f32_16x16x32_bf16 v[240:243], v[20:23], a[112:115], v[240:243]
ds_read_b64_tr_b16 v[16:17], v15 offset:18496
v_mfma_f32_16x16x32_bf16 v[244:247], v[20:23], a[116:119], v[244:247]
ds_read_b64_tr_b16 v[18:19], v15 offset:23104
v_mfma_f32_16x16x32_bf16 v[248:251], v[20:23], a[120:123], v[248:251]
buffer_load_dwordx4 a[28:31], v9, s[8:11], s41 offen offset:3072 sc1
v_mfma_f32_16x16x32_bf16 v[252:255], v[20:23], a[124:127], v[252:255]
s_waitcnt lgkmcnt(2)
v_mfma_f32_16x16x32_bf16 v[112:115], v[24:27], a[128:131], v[112:115]
ds_read_b64_tr_b16 v[20:21], v15 offset:18528
v_mfma_f32_16x16x32_bf16 v[116:119], v[24:27], a[132:135], v[116:119]
ds_read_b64_tr_b16 v[22:23], v15 offset:23136
v_mfma_f32_16x16x32_bf16 v[120:123], v[24:27], a[136:139], v[120:123]
s_add_u32 s41, s61, 94208
v_mfma_f32_16x16x32_bf16 v[124:127], v[24:27], a[140:143], v[124:127]
v_mfma_f32_16x16x32_bf16 v[128:131], v[28:31], a[128:131], v[128:131]
ds_read_b64_tr_b16 v[24:25], v15 offset:18560
s_add_u32 m0, s47, 40960
v_mfma_f32_16x16x32_bf16 v[132:135], v[28:31], a[132:135], v[132:135]
ds_read_b64_tr_b16 v[26:27], v15 offset:23168
v_mfma_f32_16x16x32_bf16 v[136:139], v[28:31], a[136:139], v[136:139]
buffer_load_dwordx4 a[32:35], v9, s[8:11], s41 offen offset:0 sc1
v_mfma_f32_16x16x32_bf16 v[140:143], v[28:31], a[140:143], v[140:143]
buffer_load_dwordx4 v10, s[48:51], s40 offen offset:0 lds
s_waitcnt lgkmcnt(2)
v_mfma_f32_16x16x32_bf16 v[144:147], v[16:19], a[128:131], v[144:147]
ds_read_b64_tr_b16 v[28:29], v15 offset:18592
v_mfma_f32_16x16x32_bf16 v[148:151], v[16:19], a[132:135], v[148:151]
ds_read_b64_tr_b16 v[30:31], v15 offset:23200
v_mfma_f32_16x16x32_bf16 v[152:155], v[16:19], a[136:139], v[152:155]
v_mfma_f32_16x16x32_bf16 v[156:159], v[16:19], a[140:143], v[156:159]
v_mfma_f32_16x16x32_bf16 v[160:163], v[20:23], a[128:131], v[160:163]
ds_read_b64_tr_b16 v[16:17], v15 offset:18624
v_mfma_f32_16x16x32_bf16 v[164:167], v[20:23], a[132:135], v[164:167]
ds_read_b64_tr_b16 v[18:19], v15 offset:23232
v_mfma_f32_16x16x32_bf16 v[168:171], v[20:23], a[136:139], v[168:171]
buffer_load_dwordx4 a[36:39], v9, s[8:11], s41 offen offset:1024 sc1
v_mfma_f32_16x16x32_bf16 v[172:175], v[20:23], a[140:143], v[172:175]
s_waitcnt lgkmcnt(2)
v_mfma_f32_16x16x32_bf16 v[176:179], v[24:27], a[128:131], v[176:179]
ds_read_b64_tr_b16 v[20:21], v15 offset:18656
v_mfma_f32_16x16x32_bf16 v[180:183], v[24:27], a[132:135], v[180:183]
ds_read_b64_tr_b16 v[22:23], v15 offset:23264
v_mfma_f32_16x16x32_bf16 v[184:187], v[24:27], a[136:139], v[184:187]
v_mfma_f32_16x16x32_bf16 v[188:191], v[24:27], a[140:143], v[188:191]
v_mfma_f32_16x16x32_bf16 v[192:195], v[28:31], a[128:131], v[192:195]
ds_read_b64_tr_b16 v[24:25], v15 offset:18688
v_mfma_f32_16x16x32_bf16 v[196:199], v[28:31], a[132:135], v[196:199]
ds_read_b64_tr_b16 v[26:27], v15 offset:23296
v_mfma_f32_16x16x32_bf16 v[200:203], v[28:31], a[136:139], v[200:203]
buffer_load_dwordx4 a[40:43], v9, s[8:11], s41 offen offset:2048 sc1
v_mfma_f32_16x16x32_bf16 v[204:207], v[28:31], a[140:143], v[204:207]
buffer_load_dwordx4 v11, s[48:51], s40 offen offset:1024 lds
s_waitcnt lgkmcnt(2)
v_mfma_f32_16x16x32_bf16 v[208:211], v[16:19], a[128:131], v[208:211]
ds_read_b64_tr_b16 v[28:29], v15 offset:27648
v_mfma_f32_16x16x32_bf16 v[212:215], v[16:19], a[132:135], v[212:215]
ds_read_b64_tr_b16 v[30:31], v15 offset:32256
v_mfma_f32_16x16x32_bf16 v[216:219], v[16:19], a[136:139], v[216:219]
v_mfma_f32_16x16x32_bf16 v[220:223], v[16:19], a[140:143], v[220:223]
v_mfma_f32_16x16x32_bf16 v[224:227], v[20:23], a[128:131], v[224:227]
ds_read_b64_tr_b16 v[16:17], v15 offset:27680
v_mfma_f32_16x16x32_bf16 v[228:231], v[20:23], a[132:135], v[228:231]
ds_read_b64_tr_b16 v[18:19], v15 offset:32288
v_mfma_f32_16x16x32_bf16 v[232:235], v[20:23], a[136:139], v[232:235]
buffer_load_dwordx4 a[44:47], v9, s[8:11], s41 offen offset:3072 sc1
v_mfma_f32_16x16x32_bf16 v[236:239], v[20:23], a[140:143], v[236:239]
s_waitcnt lgkmcnt(2)
v_mfma_f32_16x16x32_bf16 v[240:243], v[24:27], a[128:131], v[240:243]
ds_read_b64_tr_b16 v[20:21], v15 offset:27712
v_mfma_f32_16x16x32_bf16 v[244:247], v[24:27], a[132:135], v[244:247]
ds_read_b64_tr_b16 v[22:23], v15 offset:32320
v_mfma_f32_16x16x32_bf16 v[248:251], v[24:27], a[136:139], v[248:251]
s_add_u32 s41, s61, 98304
v_mfma_f32_16x16x32_bf16 v[252:255], v[24:27], a[140:143], v[252:255]
buffer_load_dwordx4 v12, s[48:51], s40 offen offset:2048 lds
v_mfma_f32_16x16x32_bf16 v[112:115], v[28:31], a[160:163], v[112:115]
ds_read_b64_tr_b16 v[24:25], v15 offset:27744
v_mfma_f32_16x16x32_bf16 v[116:119], v[28:31], a[164:167], v[116:119]
ds_read_b64_tr_b16 v[26:27], v15 offset:32352
v_mfma_f32_16x16x32_bf16 v[120:123], v[28:31], a[168:171], v[120:123]
buffer_load_dwordx4 a[48:51], v9, s[8:11], s41 offen offset:0 sc1
v_mfma_f32_16x16x32_bf16 v[124:127], v[28:31], a[172:175], v[124:127]
s_waitcnt lgkmcnt(2)
v_mfma_f32_16x16x32_bf16 v[128:131], v[16:19], a[160:163], v[128:131]
ds_read_b64_tr_b16 v[28:29], v15 offset:27776
v_mfma_f32_16x16x32_bf16 v[132:135], v[16:19], a[164:167], v[132:135]
ds_read_b64_tr_b16 v[30:31], v15 offset:32384
v_mfma_f32_16x16x32_bf16 v[136:139], v[16:19], a[168:171], v[136:139]
v_mfma_f32_16x16x32_bf16 v[140:143], v[16:19], a[172:175], v[140:143]
v_mfma_f32_16x16x32_bf16 v[144:147], v[20:23], a[160:163], v[144:147]
ds_read_b64_tr_b16 v[16:17], v15 offset:27808
v_mfma_f32_16x16x32_bf16 v[148:151], v[20:23], a[164:167], v[148:151]
ds_read_b64_tr_b16 v[18:19], v15 offset:32416
v_mfma_f32_16x16x32_bf16 v[152:155], v[20:23], a[168:171], v[152:155]
buffer_load_dwordx4 a[52:55], v9, s[8:11], s41 offen offset:1024 sc1
v_mfma_f32_16x16x32_bf16 v[156:159], v[20:23], a[172:175], v[156:159]
s_waitcnt lgkmcnt(2)
v_mfma_f32_16x16x32_bf16 v[160:163], v[24:27], a[160:163], v[160:163]
ds_read_b64_tr_b16 v[20:21], v15 offset:27840
v_mfma_f32_16x16x32_bf16 v[164:167], v[24:27], a[164:167], v[164:167]
ds_read_b64_tr_b16 v[22:23], v15 offset:32448
v_mfma_f32_16x16x32_bf16 v[168:171], v[24:27], a[168:171], v[168:171]
buffer_load_dwordx4 v13, s[48:51], s40 offen offset:3072 lds
v_mfma_f32_16x16x32_bf16 v[172:175], v[24:27], a[172:175], v[172:175]
v_mfma_f32_16x16x32_bf16 v[176:179], v[28:31], a[160:163], v[176:179]
ds_read_b64_tr_b16 v[24:25], v15 offset:27872
v_mfma_f32_16x16x32_bf16 v[180:183], v[28:31], a[164:167], v[180:183]
ds_read_b64_tr_b16 v[26:27], v15 offset:32480
v_mfma_f32_16x16x32_bf16 v[184:187], v[28:31], a[168:171], v[184:187]
buffer_load_dwordx4 a[56:59], v9, s[8:11], s41 offen offset:2048 sc1
v_mfma_f32_16x16x32_bf16 v[188:191], v[28:31], a[172:175], v[188:191]
s_waitcnt lgkmcnt(2)
v_mfma_f32_16x16x32_bf16 v[192:195], v[16:19], a[160:163], v[192:195]
ds_read_b64_tr_b16 v[28:29], v15 offset:27904
v_mfma_f32_16x16x32_bf16 v[196:199], v[16:19], a[164:167], v[196:199]
ds_read_b64_tr_b16 v[30:31], v15 offset:32512
v_mfma_f32_16x16x32_bf16 v[200:203], v[16:19], a[168:171], v[200:203]
v_mfma_f32_16x16x32_bf16 v[204:207], v[16:19], a[172:175], v[204:207]
v_add_u32 v15, 0xfffe5000, v15
v_mfma_f32_16x16x32_bf16 v[208:211], v[20:23], a[160:163], v[208:211]
s_waitcnt vmcnt(24)
s_barrier
ds_read_b64_tr_b16 v[16:17], v15 offset:0
v_mfma_f32_16x16x32_bf16 v[212:215], v[20:23], a[164:167], v[212:215]
ds_read_b64_tr_b16 v[18:19], v15 offset:4608
s_add_u32 m0, s47, 45056
v_mfma_f32_16x16x32_bf16 v[216:219], v[20:23], a[168:171], v[216:219]
buffer_load_dwordx4 a[60:63], v9, s[8:11], s41 offen offset:3072 sc1
v_mfma_f32_16x16x32_bf16 v[220:223], v[20:23], a[172:175], v[220:223]
buffer_load_dwordx4 v14, s[48:51], s40 offen offset:0 lds
s_waitcnt lgkmcnt(2)
v_mfma_f32_16x16x32_bf16 v[224:227], v[24:27], a[160:163], v[224:227]
ds_read_b64_tr_b16 v[20:21], v15 offset:32
v_mfma_f32_16x16x32_bf16 v[228:231], v[24:27], a[164:167], v[228:231]
ds_read_b64_tr_b16 v[22:23], v15 offset:4640
v_mfma_f32_16x16x32_bf16 v[232:235], v[24:27], a[168:171], v[232:235]
s_add_u32 s41, s61, 102400
v_mfma_f32_16x16x32_bf16 v[236:239], v[24:27], a[172:175], v[236:239]
v_mfma_f32_16x16x32_bf16 v[240:243], v[28:31], a[160:163], v[240:243]
ds_read_b64_tr_b16 v[24:25], v15 offset:64
v_mfma_f32_16x16x32_bf16 v[244:247], v[28:31], a[164:167], v[244:247]
ds_read_b64_tr_b16 v[26:27], v15 offset:4672
v_mfma_f32_16x16x32_bf16 v[248:251], v[28:31], a[168:171], v[248:251]
buffer_load_dwordx4 a[64:67], v9, s[8:11], s41 offen offset:0 sc1
v_mfma_f32_16x16x32_bf16 v[252:255], v[28:31], a[172:175], v[252:255]
s_waitcnt lgkmcnt(2)
v_mfma_f32_16x16x32_bf16 v[112:115], v[16:19], a[176:179], v[112:115]
ds_read_b64_tr_b16 v[28:29], v15 offset:96
v_mfma_f32_16x16x32_bf16 v[116:119], v[16:19], a[180:183], v[116:119]
ds_read_b64_tr_b16 v[30:31], v15 offset:4704
v_mfma_f32_16x16x32_bf16 v[120:123], v[16:19], a[184:187], v[120:123]
s_add_u32 m0, s47, 73728
s_add_u32 s40, s60, 884736
v_mfma_f32_16x16x32_bf16 v[124:127], v[16:19], a[188:191], v[124:127]
v_mfma_f32_16x16x32_bf16 v[128:131], v[20:23], a[176:179], v[128:131]
ds_read_b64_tr_b16 v[16:17], v15 offset:128
v_mfma_f32_16x16x32_bf16 v[132:135], v[20:23], a[180:183], v[132:135]
ds_read_b64_tr_b16 v[18:19], v15 offset:4736
s_barrier
v_mfma_f32_16x16x32_bf16 v[136:139], v[20:23], a[184:187], v[136:139]
buffer_load_dwordx4 a[68:71], v9, s[8:11], s41 offen offset:1024 sc1
v_mfma_f32_16x16x32_bf16 v[140:143], v[20:23], a[188:191], v[140:143]
buffer_load_dwordx4 v1, s[48:51], s40 offen offset:0 lds
s_waitcnt lgkmcnt(2)
v_mfma_f32_16x16x32_bf16 v[144:147], v[24:27], a[176:179], v[144:147]
ds_read_b64_tr_b16 v[20:21], v15 offset:160
v_mfma_f32_16x16x32_bf16 v[148:151], v[24:27], a[180:183], v[148:151]
ds_read_b64_tr_b16 v[22:23], v15 offset:4768
v_mfma_f32_16x16x32_bf16 v[152:155], v[24:27], a[184:187], v[152:155]
v_mfma_f32_16x16x32_bf16 v[156:159], v[24:27], a[188:191], v[156:159]
v_mfma_f32_16x16x32_bf16 v[160:163], v[28:31], a[176:179], v[160:163]
ds_read_b64_tr_b16 v[24:25], v15 offset:192
v_mfma_f32_16x16x32_bf16 v[164:167], v[28:31], a[180:183], v[164:167]
ds_read_b64_tr_b16 v[26:27], v15 offset:4800
v_mfma_f32_16x16x32_bf16 v[168:171], v[28:31], a[184:187], v[168:171]
buffer_load_dwordx4 a[72:75], v9, s[8:11], s41 offen offset:2048 sc1
v_mfma_f32_16x16x32_bf16 v[172:175], v[28:31], a[188:191], v[172:175]
s_waitcnt lgkmcnt(2)
v_mfma_f32_16x16x32_bf16 v[176:179], v[16:19], a[176:179], v[176:179]
ds_read_b64_tr_b16 v[28:29], v15 offset:224
v_mfma_f32_16x16x32_bf16 v[180:183], v[16:19], a[180:183], v[180:183]
ds_read_b64_tr_b16 v[30:31], v15 offset:4832
v_mfma_f32_16x16x32_bf16 v[184:187], v[16:19], a[184:187], v[184:187]
v_mfma_f32_16x16x32_bf16 v[188:191], v[16:19], a[188:191], v[188:191]
buffer_load_dwordx4 v2, s[48:51], s40 offen offset:1024 lds
v_mfma_f32_16x16x32_bf16 v[192:195], v[20:23], a[176:179], v[192:195]
ds_read_b64_tr_b16 v[16:17], v15 offset:256
v_mfma_f32_16x16x32_bf16 v[196:199], v[20:23], a[180:183], v[196:199]
ds_read_b64_tr_b16 v[18:19], v15 offset:4864
v_mfma_f32_16x16x32_bf16 v[200:203], v[20:23], a[184:187], v[200:203]
buffer_load_dwordx4 a[76:79], v9, s[8:11], s41 offen offset:3072 sc1
v_mfma_f32_16x16x32_bf16 v[204:207], v[20:23], a[188:191], v[204:207]
s_waitcnt lgkmcnt(2)
v_mfma_f32_16x16x32_bf16 v[208:211], v[24:27], a[176:179], v[208:211]
ds_read_b64_tr_b16 v[20:21], v15 offset:9216
v_mfma_f32_16x16x32_bf16 v[212:215], v[24:27], a[180:183], v[212:215]
ds_read_b64_tr_b16 v[22:23], v15 offset:13824
v_mfma_f32_16x16x32_bf16 v[216:219], v[24:27], a[184:187], v[216:219]
s_add_u32 s41, s61, 106496
v_mfma_f32_16x16x32_bf16 v[220:223], v[24:27], a[188:191], v[220:223]
v_mfma_f32_16x16x32_bf16 v[224:227], v[28:31], a[176:179], v[224:227]
ds_read_b64_tr_b16 v[24:25], v15 offset:9248
v_mfma_f32_16x16x32_bf16 v[228:231], v[28:31], a[180:183], v[228:231]
ds_read_b64_tr_b16 v[26:27], v15 offset:13856
v_mfma_f32_16x16x32_bf16 v[232:235], v[28:31], a[184:187], v[232:235]
buffer_load_dwordx4 a[80:83], v9, s[8:11], s41 offen offset:0 sc1
v_mfma_f32_16x16x32_bf16 v[236:239], v[28:31], a[188:191], v[236:239]
s_waitcnt lgkmcnt(2)
v_mfma_f32_16x16x32_bf16 v[240:243], v[16:19], a[176:179], v[240:243]
ds_read_b64_tr_b16 v[28:29], v15 offset:9280
v_mfma_f32_16x16x32_bf16 v[244:247], v[16:19], a[180:183], v[244:247]
ds_read_b64_tr_b16 v[30:31], v15 offset:13888
v_mfma_f32_16x16x32_bf16 v[248:251], v[16:19], a[184:187], v[248:251]
buffer_load_dwordx4 v3, s[48:51], s40 offen offset:2048 lds
v_mfma_f32_16x16x32_bf16 v[252:255], v[16:19], a[188:191], v[252:255]
v_mfma_f32_16x16x32_bf16 v[112:115], v[20:23], a[192:195], v[112:115]
ds_read_b64_tr_b16 v[16:17], v15 offset:9312
v_mfma_f32_16x16x32_bf16 v[116:119], v[20:23], a[196:199], v[116:119]
ds_read_b64_tr_b16 v[18:19], v15 offset:13920
v_mfma_f32_16x16x32_bf16 v[120:123], v[20:23], a[200:203], v[120:123]
buffer_load_dwordx4 a[84:87], v9, s[8:11], s41 offen offset:1024 sc1
v_mfma_f32_16x16x32_bf16 v[124:127], v[20:23], a[204:207], v[124:127]
s_waitcnt lgkmcnt(2)
v_mfma_f32_16x16x32_bf16 v[128:131], v[24:27], a[192:195], v[128:131]
ds_read_b64_tr_b16 v[20:21], v15 offset:9344
v_mfma_f32_16x16x32_bf16 v[132:135], v[24:27], a[196:199], v[132:135]
ds_read_b64_tr_b16 v[22:23], v15 offset:13952
v_mfma_f32_16x16x32_bf16 v[136:139], v[24:27], a[200:203], v[136:139]
v_mfma_f32_16x16x32_bf16 v[140:143], v[24:27], a[204:207], v[140:143]
v_mfma_f32_16x16x32_bf16 v[144:147], v[28:31], a[192:195], v[144:147]
ds_read_b64_tr_b16 v[24:25], v15 offset:9376
v_mfma_f32_16x16x32_bf16 v[148:151], v[28:31], a[196:199], v[148:151]
ds_read_b64_tr_b16 v[26:27], v15 offset:13984
v_mfma_f32_16x16x32_bf16 v[152:155], v[28:31], a[200:203], v[152:155]
buffer_load_dwordx4 a[88:91], v9, s[8:11], s41 offen offset:2048 sc1
v_mfma_f32_16x16x32_bf16 v[156:159], v[28:31], a[204:207], v[156:159]
buffer_load_dwordx4 v8, s[48:51], s40 offen offset:3072 lds
s_waitcnt lgkmcnt(2)
v_mfma_f32_16x16x32_bf16 v[160:163], v[16:19], a[192:195], v[160:163]
ds_read_b64_tr_b16 v[28:29], v15 offset:9408
v_mfma_f32_16x16x32_bf16 v[164:167], v[16:19], a[196:199], v[164:167]
ds_read_b64_tr_b16 v[30:31], v15 offset:14016
v_mfma_f32_16x16x32_bf16 v[168:171], v[16:19], a[200:203], v[168:171]
v_mfma_f32_16x16x32_bf16 v[172:175], v[16:19], a[204:207], v[172:175]
v_mfma_f32_16x16x32_bf16 v[176:179], v[20:23], a[192:195], v[176:179]
ds_read_b64_tr_b16 v[16:17], v15 offset:9440
v_mfma_f32_16x16x32_bf16 v[180:183], v[20:23], a[196:199], v[180:183]
ds_read_b64_tr_b16 v[18:19], v15 offset:14048
v_mfma_f32_16x16x32_bf16 v[184:187], v[20:23], a[200:203], v[184:187]
buffer_load_dwordx4 a[92:95], v9, s[8:11], s41 offen offset:3072 sc1
v_mfma_f32_16x16x32_bf16 v[188:191], v[20:23], a[204:207], v[188:191]
s_waitcnt lgkmcnt(2)
v_mfma_f32_16x16x32_bf16 v[192:195], v[24:27], a[192:195], v[192:195]
ds_read_b64_tr_b16 v[20:21], v15 offset:9472
v_mfma_f32_16x16x32_bf16 v[196:199], v[24:27], a[196:199], v[196:199]
ds_read_b64_tr_b16 v[22:23], v15 offset:14080
v_mfma_f32_16x16x32_bf16 v[200:203], v[24:27], a[200:203], v[200:203]
s_add_u32 s41, s61, 110592
s_add_u32 m0, s47, 77824
v_mfma_f32_16x16x32_bf16 v[204:207], v[24:27], a[204:207], v[204:207]
v_mfma_f32_16x16x32_bf16 v[208:211], v[28:31], a[192:195], v[208:211]
ds_read_b64_tr_b16 v[24:25], v15 offset:18432
v_mfma_f32_16x16x32_bf16 v[212:215], v[28:31], a[196:199], v[212:215]
ds_read_b64_tr_b16 v[26:27], v15 offset:23040
v_mfma_f32_16x16x32_bf16 v[216:219], v[28:31], a[200:203], v[216:219]
buffer_load_dwordx4 a[96:99], v9, s[8:11], s41 offen offset:0 sc1
v_mfma_f32_16x16x32_bf16 v[220:223], v[28:31], a[204:207], v[220:223]
buffer_load_dwordx4 v10, s[48:51], s40 offen offset:0 lds
s_waitcnt lgkmcnt(2)
v_mfma_f32_16x16x32_bf16 v[224:227], v[16:19], a[192:195], v[224:227]
ds_read_b64_tr_b16 v[28:29], v15 offset:18464
v_mfma_f32_16x16x32_bf16 v[228:231], v[16:19], a[196:199], v[228:231]
ds_read_b64_tr_b16 v[30:31], v15 offset:23072
v_mfma_f32_16x16x32_bf16 v[232:235], v[16:19], a[200:203], v[232:235]
v_mfma_f32_16x16x32_bf16 v[236:239], v[16:19], a[204:207], v[236:239]
v_mfma_f32_16x16x32_bf16 v[240:243], v[20:23], a[192:195], v[240:243]
ds_read_b64_tr_b16 v[16:17], v15 offset:18496
v_mfma_f32_16x16x32_bf16 v[244:247], v[20:23], a[196:199], v[244:247]
ds_read_b64_tr_b16 v[18:19], v15 offset:23104
v_mfma_f32_16x16x32_bf16 v[248:251], v[20:23], a[200:203], v[248:251]
buffer_load_dwordx4 a[100:103], v9, s[8:11], s41 offen offset:1024 sc1
v_mfma_f32_16x16x32_bf16 v[252:255], v[20:23], a[204:207], v[252:255]
s_waitcnt lgkmcnt(2)
v_mfma_f32_16x16x32_bf16 v[112:115], v[24:27], a[208:211], v[112:115]
ds_read_b64_tr_b16 v[20:21], v15 offset:18528
v_mfma_f32_16x16x32_bf16 v[116:119], v[24:27], a[212:215], v[116:119]
ds_read_b64_tr_b16 v[22:23], v15 offset:23136
v_mfma_f32_16x16x32_bf16 v[120:123], v[24:27], a[216:219], v[120:123]
v_mfma_f32_16x16x32_bf16 v[124:127], v[24:27], a[220:223], v[124:127]
buffer_load_dwordx4 v11, s[48:51], s40 offen offset:1024 lds
v_mfma_f32_16x16x32_bf16 v[128:131], v[28:31], a[208:211], v[128:131]
ds_read_b64_tr_b16 v[24:25], v15 offset:18560
v_mfma_f32_16x16x32_bf16 v[132:135], v[28:31], a[212:215], v[132:135]
ds_read_b64_tr_b16 v[26:27], v15 offset:23168
v_mfma_f32_16x16x32_bf16 v[136:139], v[28:31], a[216:219], v[136:139]
buffer_load_dwordx4 a[104:107], v9, s[8:11], s41 offen offset:2048 sc1
v_mfma_f32_16x16x32_bf16 v[140:143], v[28:31], a[220:223], v[140:143]
s_waitcnt lgkmcnt(2)
v_mfma_f32_16x16x32_bf16 v[144:147], v[16:19], a[208:211], v[144:147]
ds_read_b64_tr_b16 v[28:29], v15 offset:18592
v_mfma_f32_16x16x32_bf16 v[148:151], v[16:19], a[212:215], v[148:151]
ds_read_b64_tr_b16 v[30:31], v15 offset:23200
v_mfma_f32_16x16x32_bf16 v[152:155], v[16:19], a[216:219], v[152:155]
v_mfma_f32_16x16x32_bf16 v[156:159], v[16:19], a[220:223], v[156:159]
v_mfma_f32_16x16x32_bf16 v[160:163], v[20:23], a[208:211], v[160:163]
ds_read_b64_tr_b16 v[16:17], v15 offset:18624
v_mfma_f32_16x16x32_bf16 v[164:167], v[20:23], a[212:215], v[164:167]
ds_read_b64_tr_b16 v[18:19], v15 offset:23232
v_mfma_f32_16x16x32_bf16 v[168:171], v[20:23], a[216:219], v[168:171]
buffer_load_dwordx4 a[108:111], v9, s[8:11], s41 offen offset:3072 sc1
v_mfma_f32_16x16x32_bf16 v[172:175], v[20:23], a[220:223], v[172:175]
s_waitcnt lgkmcnt(2)
v_mfma_f32_16x16x32_bf16 v[176:179], v[24:27], a[208:211], v[176:179]
ds_read_b64_tr_b16 v[20:21], v15 offset:18656
v_mfma_f32_16x16x32_bf16 v[180:183], v[24:27], a[212:215], v[180:183]
ds_read_b64_tr_b16 v[22:23], v15 offset:23264
v_mfma_f32_16x16x32_bf16 v[184:187], v[24:27], a[216:219], v[184:187]
buffer_load_dwordx4 v12, s[48:51], s40 offen offset:2048 lds
s_add_u32 s41, s61, 114688
v_mfma_f32_16x16x32_bf16 v[188:191], v[24:27], a[220:223], v[188:191]
v_mfma_f32_16x16x32_bf16 v[192:195], v[28:31], a[208:211], v[192:195]
ds_read_b64_tr_b16 v[24:25], v15 offset:18688
v_mfma_f32_16x16x32_bf16 v[196:199], v[28:31], a[212:215], v[196:199]
ds_read_b64_tr_b16 v[26:27], v15 offset:23296
v_mfma_f32_16x16x32_bf16 v[200:203], v[28:31], a[216:219], v[200:203]
buffer_load_dwordx4 a[112:115], v9, s[8:11], s41 offen offset:0 sc1
v_mfma_f32_16x16x32_bf16 v[204:207], v[28:31], a[220:223], v[204:207]
s_waitcnt lgkmcnt(2)
v_mfma_f32_16x16x32_bf16 v[208:211], v[16:19], a[208:211], v[208:211]
ds_read_b64_tr_b16 v[28:29], v15 offset:27648
v_mfma_f32_16x16x32_bf16 v[212:215], v[16:19], a[212:215], v[212:215]
ds_read_b64_tr_b16 v[30:31], v15 offset:32256
v_mfma_f32_16x16x32_bf16 v[216:219], v[16:19], a[216:219], v[216:219]
v_mfma_f32_16x16x32_bf16 v[220:223], v[16:19], a[220:223], v[220:223]
v_mfma_f32_16x16x32_bf16 v[224:227], v[20:23], a[208:211], v[224:227]
ds_read_b64_tr_b16 v[16:17], v15 offset:27680
v_mfma_f32_16x16x32_bf16 v[228:231], v[20:23], a[212:215], v[228:231]
ds_read_b64_tr_b16 v[18:19], v15 offset:32288
v_mfma_f32_16x16x32_bf16 v[232:235], v[20:23], a[216:219], v[232:235]
buffer_load_dwordx4 a[116:119], v9, s[8:11], s41 offen offset:1024 sc1
v_mfma_f32_16x16x32_bf16 v[236:239], v[20:23], a[220:223], v[236:239]
buffer_load_dwordx4 v13, s[48:51], s40 offen offset:3072 lds
s_waitcnt lgkmcnt(2)
v_mfma_f32_16x16x32_bf16 v[240:243], v[24:27], a[208:211], v[240:243]
ds_read_b64_tr_b16 v[20:21], v15 offset:27712
v_mfma_f32_16x16x32_bf16 v[244:247], v[24:27], a[212:215], v[244:247]
ds_read_b64_tr_b16 v[22:23], v15 offset:32320
v_mfma_f32_16x16x32_bf16 v[248:251], v[24:27], a[216:219], v[248:251]
v_mfma_f32_16x16x32_bf16 v[252:255], v[24:27], a[220:223], v[252:255]
v_mfma_f32_16x16x32_bf16 v[112:115], v[28:31], a[224:227], v[112:115]
ds_read_b64_tr_b16 v[24:25], v15 offset:27744
v_mfma_f32_16x16x32_bf16 v[116:119], v[28:31], a[228:231], v[116:119]
ds_read_b64_tr_b16 v[26:27], v15 offset:32352
v_mfma_f32_16x16x32_bf16 v[120:123], v[28:31], a[232:235], v[120:123]
buffer_load_dwordx4 a[120:123], v9, s[8:11], s41 offen offset:2048 sc1
v_mfma_f32_16x16x32_bf16 v[124:127], v[28:31], a[236:239], v[124:127]
s_waitcnt lgkmcnt(2)
v_mfma_f32_16x16x32_bf16 v[128:131], v[16:19], a[224:227], v[128:131]
ds_read_b64_tr_b16 v[28:29], v15 offset:27776
v_mfma_f32_16x16x32_bf16 v[132:135], v[16:19], a[228:231], v[132:135]
ds_read_b64_tr_b16 v[30:31], v15 offset:32384
v_mfma_f32_16x16x32_bf16 v[136:139], v[16:19], a[232:235], v[136:139]
s_add_u32 m0, s47, 81920
v_mfma_f32_16x16x32_bf16 v[140:143], v[16:19], a[236:239], v[140:143]
v_mfma_f32_16x16x32_bf16 v[144:147], v[20:23], a[224:227], v[144:147]
ds_read_b64_tr_b16 v[16:17], v15 offset:27808
v_mfma_f32_16x16x32_bf16 v[148:151], v[20:23], a[228:231], v[148:151]
ds_read_b64_tr_b16 v[18:19], v15 offset:32416
v_mfma_f32_16x16x32_bf16 v[152:155], v[20:23], a[232:235], v[152:155]
buffer_load_dwordx4 a[124:127], v9, s[8:11], s41 offen offset:3072 sc1
v_mfma_f32_16x16x32_bf16 v[156:159], v[20:23], a[236:239], v[156:159]
buffer_load_dwordx4 v14, s[48:51], s40 offen offset:0 lds
s_waitcnt lgkmcnt(2)
v_mfma_f32_16x16x32_bf16 v[160:163], v[24:27], a[224:227], v[160:163]
ds_read_b64_tr_b16 v[20:21], v15 offset:27840
v_mfma_f32_16x16x32_bf16 v[164:167], v[24:27], a[228:231], v[164:167]
ds_read_b64_tr_b16 v[22:23], v15 offset:32448
v_mfma_f32_16x16x32_bf16 v[168:171], v[24:27], a[232:235], v[168:171]
s_add_u32 s41, s61, 118784
v_mfma_f32_16x16x32_bf16 v[172:175], v[24:27], a[236:239], v[172:175]
v_mfma_f32_16x16x32_bf16 v[176:179], v[28:31], a[224:227], v[176:179]
ds_read_b64_tr_b16 v[24:25], v15 offset:27872
v_mfma_f32_16x16x32_bf16 v[180:183], v[28:31], a[228:231], v[180:183]
ds_read_b64_tr_b16 v[26:27], v15 offset:32480
v_mfma_f32_16x16x32_bf16 v[184:187], v[28:31], a[232:235], v[184:187]
buffer_load_dwordx4 a[128:131], v9, s[8:11], s41 offen offset:0 sc1
v_mfma_f32_16x16x32_bf16 v[188:191], v[28:31], a[236:239], v[188:191]
s_waitcnt lgkmcnt(2)
v_mfma_f32_16x16x32_bf16 v[192:195], v[16:19], a[224:227], v[192:195]
ds_read_b64_tr_b16 v[28:29], v15 offset:27904
s_add_u32 m0, s47, 110592
s_add_u32 s40, s60, 1032192
v_mfma_f32_16x16x32_bf16 v[196:199], v[16:19], a[228:231], v[196:199]
ds_read_b64_tr_b16 v[30:31], v15 offset:32512
v_mfma_f32_16x16x32_bf16 v[200:203], v[16:19], a[232:235], v[200:203]
v_mfma_f32_16x16x32_bf16 v[204:207], v[16:19], a[236:239], v[204:207]
v_add_u32 v15, 0x9000, v15
v_mfma_f32_16x16x32_bf16 v[208:211], v[20:23], a[224:227], v[208:211]
s_waitcnt vmcnt(26)
s_barrier
ds_read_b64_tr_b16 v[16:17], v15 offset:0
v_mfma_f32_16x16x32_bf16 v[212:215], v[20:23], a[228:231], v[212:215]
ds_read_b64_tr_b16 v[18:19], v15 offset:4608
v_mfma_f32_16x16x32_bf16 v[216:219], v[20:23], a[232:235], v[216:219]
buffer_load_dwordx4 v1, s[48:51], s40 offen offset:0 lds
v_mfma_f32_16x16x32_bf16 v[220:223], v[20:23], a[236:239], v[220:223]
buffer_load_dwordx4 a[132:135], v9, s[8:11], s41 offen offset:1024 sc1
s_waitcnt lgkmcnt(2)
v_mfma_f32_16x16x32_bf16 v[224:227], v[24:27], a[224:227], v[224:227]
ds_read_b64_tr_b16 v[20:21], v15 offset:32
v_mfma_f32_16x16x32_bf16 v[228:231], v[24:27], a[228:231], v[228:231]
ds_read_b64_tr_b16 v[22:23], v15 offset:4640
v_mfma_f32_16x16x32_bf16 v[232:235], v[24:27], a[232:235], v[232:235]
v_mfma_f32_16x16x32_bf16 v[236:239], v[24:27], a[236:239], v[236:239]
v_mfma_f32_16x16x32_bf16 v[240:243], v[28:31], a[224:227], v[240:243]
ds_read_b64_tr_b16 v[24:25], v15 offset:64
v_mfma_f32_16x16x32_bf16 v[244:247], v[28:31], a[228:231], v[244:247]
ds_read_b64_tr_b16 v[26:27], v15 offset:4672
v_mfma_f32_16x16x32_bf16 v[248:251], v[28:31], a[232:235], v[248:251]
buffer_load_dwordx4 a[136:139], v9, s[8:11], s41 offen offset:2048 sc1
v_mfma_f32_16x16x32_bf16 v[252:255], v[28:31], a[236:239], v[252:255]
mk_LY_W5:
s_waitcnt lgkmcnt(2)
v_mfma_f32_16x16x32_bf16 v[112:115], v[16:19], a[240:243], v[112:115]
ds_read_b64_tr_b16 v[28:29], v15 offset:96
v_mfma_f32_16x16x32_bf16 v[116:119], v[16:19], a[244:247], v[116:119]
ds_read_b64_tr_b16 v[30:31], v15 offset:4704
v_mfma_f32_16x16x32_bf16 v[120:123], v[16:19], a[248:251], v[120:123]
buffer_load_dwordx4 v2, s[48:51], s40 offen offset:1024 lds
v_mfma_f32_16x16x32_bf16 v[124:127], v[16:19], a[252:255], v[124:127]
v_mfma_f32_16x16x32_bf16 v[128:131], v[20:23], a[240:243], v[128:131]
ds_read_b64_tr_b16 v[16:17], v15 offset:128
v_mfma_f32_16x16x32_bf16 v[132:135], v[20:23], a[244:247], v[132:135]
ds_read_b64_tr_b16 v[18:19], v15 offset:4736
s_barrier
v_mfma_f32_16x16x32_bf16 v[136:139], v[20:23], a[248:251], v[136:139]
buffer_load_dwordx4 a[140:143], v9, s[8:11], s41 offen offset:3072 sc1
v_mfma_f32_16x16x32_bf16 v[140:143], v[20:23], a[252:255], v[140:143]
s_waitcnt lgkmcnt(2)
v_mfma_f32_16x16x32_bf16 v[144:147], v[24:27], a[240:243], v[144:147]
ds_read_b64_tr_b16 v[20:21], v15 offset:160
v_mfma_f32_16x16x32_bf16 v[148:151], v[24:27], a[244:247], v[148:151]
ds_read_b64_tr_b16 v[22:23], v15 offset:4768
v_mfma_f32_16x16x32_bf16 v[152:155], v[24:27], a[248:251], v[152:155]
s_add_u32 s41, s61, 122880
v_mfma_f32_16x16x32_bf16 v[156:159], v[24:27], a[252:255], v[156:159]
v_mfma_f32_16x16x32_bf16 v[160:163], v[28:31], a[240:243], v[160:163]
ds_read_b64_tr_b16 v[24:25], v15 offset:192
v_mfma_f32_16x16x32_bf16 v[164:167], v[28:31], a[244:247], v[164:167]
ds_read_b64_tr_b16 v[26:27], v15 offset:4800
v_mfma_f32_16x16x32_bf16 v[168:171], v[28:31], a[248:251], v[168:171]
buffer_load_dwordx4 a[160:163], v9, s[8:11], s41 offen offset:0 sc1
v_mfma_f32_16x16x32_bf16 v[172:175], v[28:31], a[252:255], v[172:175]
buffer_load_dwordx4 v3, s[48:51], s40 offen offset:2048 lds
s_waitcnt lgkmcnt(2)
v_mfma_f32_16x16x32_bf16 v[176:179], v[16:19], a[240:243], v[176:179]
ds_read_b64_tr_b16 v[28:29], v15 offset:224
v_mfma_f32_16x16x32_bf16 v[180:183], v[16:19], a[244:247], v[180:183]
ds_read_b64_tr_b16 v[30:31], v15 offset:4832
v_mfma_f32_16x16x32_bf16 v[184:187], v[16:19], a[248:251], v[184:187]
v_mfma_f32_16x16x32_bf16 v[188:191], v[16:19], a[252:255], v[188:191]
v_mfma_f32_16x16x32_bf16 v[192:195], v[20:23], a[240:243], v[192:195]
ds_read_b64_tr_b16 v[16:17], v15 offset:256
v_mfma_f32_16x16x32_bf16 v[196:199], v[20:23], a[244:247], v[196:199]
ds_read_b64_tr_b16 v[18:19], v15 offset:4864
v_mfma_f32_16x16x32_bf16 v[200:203], v[20:23], a[248:251], v[200:203]
buffer_load_dwordx4 a[164:167], v9, s[8:11], s41 offen offset:1024 sc1
v_mfma_f32_16x16x32_bf16 v[204:207], v[20:23], a[252:255], v[204:207]
s_waitcnt lgkmcnt(2)
v_mfma_f32_16x16x32_bf16 v[208:211], v[24:27], a[240:243], v[208:211]
ds_read_b64_tr_b16 v[20:21], v15 offset:9216
v_mfma_f32_16x16x32_bf16 v[212:215], v[24:27], a[244:247], v[212:215]
ds_read_b64_tr_b16 v[22:23], v15 offset:13824
v_mfma_f32_16x16x32_bf16 v[216:219], v[24:27], a[248:251], v[216:219]
v_mfma_f32_16x16x32_bf16 v[220:223], v[24:27], a[252:255], v[220:223]
v_mfma_f32_16x16x32_bf16 v[224:227], v[28:31], a[240:243], v[224:227]
ds_read_b64_tr_b16 v[24:25], v15 offset:9248
v_mfma_f32_16x16x32_bf16 v[228:231], v[28:31], a[244:247], v[228:231]
ds_read_b64_tr_b16 v[26:27], v15 offset:13856
v_mfma_f32_16x16x32_bf16 v[232:235], v[28:31], a[248:251], v[232:235]
buffer_load_dwordx4 a[168:171], v9, s[8:11], s41 offen offset:2048 sc1
v_mfma_f32_16x16x32_bf16 v[236:239], v[28:31], a[252:255], v[236:239]
buffer_load_dwordx4 v8, s[48:51], s40 offen offset:3072 lds
s_waitcnt lgkmcnt(2)
v_mfma_f32_16x16x32_bf16 v[240:243], v[16:19], a[240:243], v[240:243]
ds_read_b64_tr_b16 v[28:29], v15 offset:9280
v_mfma_f32_16x16x32_bf16 v[244:247], v[16:19], a[244:247], v[244:247]
ds_read_b64_tr_b16 v[30:31], v15 offset:13888
v_mfma_f32_16x16x32_bf16 v[248:251], v[16:19], a[248:251], v[248:251]
v_mfma_f32_16x16x32_bf16 v[252:255], v[16:19], a[252:255], v[252:255]
v_mfma_f32_16x16x32_bf16 v[112:115], v[20:23], a[0:3], v[112:115]
ds_read_b64_tr_b16 v[16:17], v15 offset:9312
v_mfma_f32_16x16x32_bf16 v[116:119], v[20:23], a[4:7], v[116:119]
ds_read_b64_tr_b16 v[18:19], v15 offset:13920
v_mfma_f32_16x16x32_bf16 v[120:123], v[20:23], a[8:11], v[120:123]
buffer_load_dwordx4 a[172:175], v9, s[8:11], s41 offen offset:3072 sc1
v_mfma_f32_16x16x32_bf16 v[124:127], v[20:23], a[12:15], v[124:127]
s_waitcnt lgkmcnt(2)
v_mfma_f32_16x16x32_bf16 v[128:131], v[24:27], a[0:3], v[128:131]
ds_read_b64_tr_b16 v[20:21], v15 offset:9344
s_add_u32 m0, s47, 114688
v_mfma_f32_16x16x32_bf16 v[132:135], v[24:27], a[4:7], v[132:135]
ds_read_b64_tr_b16 v[22:23], v15 offset:13952
v_mfma_f32_16x16x32_bf16 v[136:139], v[24:27], a[8:11], v[136:139]
s_add_u32 s41, s61, 126976
v_mfma_f32_16x16x32_bf16 v[140:143], v[24:27], a[12:15], v[140:143]
buffer_load_dwordx4 v10, s[48:51], s40 offen offset:0 lds
v_mfma_f32_16x16x32_bf16 v[144:147], v[28:31], a[0:3], v[144:147]
ds_read_b64_tr_b16 v[24:25], v15 offset:9376
v_mfma_f32_16x16x32_bf16 v[148:151], v[28:31], a[4:7], v[148:151]
ds_read_b64_tr_b16 v[26:27], v15 offset:13984
v_mfma_f32_16x16x32_bf16 v[152:155], v[28:31], a[8:11], v[152:155]
buffer_load_dwordx4 a[176:179], v9, s[8:11], s41 offen offset:0 sc1
v_mfma_f32_16x16x32_bf16 v[156:159], v[28:31], a[12:15], v[156:159]
s_waitcnt lgkmcnt(2)
v_mfma_f32_16x16x32_bf16 v[160:163], v[16:19], a[0:3], v[160:163]
ds_read_b64_tr_b16 v[28:29], v15 offset:9408
v_mfma_f32_16x16x32_bf16 v[164:167], v[16:19], a[4:7], v[164:167]
ds_read_b64_tr_b16 v[30:31], v15 offset:14016
v_mfma_f32_16x16x32_bf16 v[168:171], v[16:19], a[8:11], v[168:171]
v_mfma_f32_16x16x32_bf16 v[172:175], v[16:19], a[12:15], v[172:175]
v_mfma_f32_16x16x32_bf16 v[176:179], v[20:23], a[0:3], v[176:179]
ds_read_b64_tr_b16 v[16:17], v15 offset:9440
v_mfma_f32_16x16x32_bf16 v[180:183], v[20:23], a[4:7], v[180:183]
ds_read_b64_tr_b16 v[18:19], v15 offset:14048
v_mfma_f32_16x16x32_bf16 v[184:187], v[20:23], a[8:11], v[184:187]
buffer_load_dwordx4 a[180:183], v9, s[8:11], s41 offen offset:1024 sc1
v_mfma_f32_16x16x32_bf16 v[188:191], v[20:23], a[12:15], v[188:191]
s_waitcnt lgkmcnt(2)
v_mfma_f32_16x16x32_bf16 v[192:195], v[24:27], a[0:3], v[192:195]
ds_read_b64_tr_b16 v[20:21], v15 offset:9472
v_mfma_f32_16x16x32_bf16 v[196:199], v[24:27], a[4:7], v[196:199]
ds_read_b64_tr_b16 v[22:23], v15 offset:14080
v_mfma_f32_16x16x32_bf16 v[200:203], v[24:27], a[8:11], v[200:203]
buffer_load_dwordx4 v11, s[48:51], s40 offen offset:1024 lds
v_mfma_f32_16x16x32_bf16 v[204:207], v[24:27], a[12:15], v[204:207]
v_mfma_f32_16x16x32_bf16 v[208:211], v[28:31], a[0:3], v[208:211]
ds_read_b64_tr_b16 v[24:25], v15 offset:18432
v_mfma_f32_16x16x32_bf16 v[212:215], v[28:31], a[4:7], v[212:215]
ds_read_b64_tr_b16 v[26:27], v15 offset:23040
v_mfma_f32_16x16x32_bf16 v[216:219], v[28:31], a[8:11], v[216:219]
buffer_load_dwordx4 a[184:187], v9, s[8:11], s41 offen offset:2048 sc1
v_mfma_f32_16x16x32_bf16 v[220:223], v[28:31], a[12:15], v[220:223]
s_waitcnt lgkmcnt(2)
v_mfma_f32_16x16x32_bf16 v[224:227], v[16:19], a[0:3], v[224:227]
ds_read_b64_tr_b16 v[28:29], v15 offset:18464
v_mfma_f32_16x16x32_bf16 v[228:231], v[16:19], a[4:7], v[228:231]
ds_read_b64_tr_b16 v[30:31], v15 offset:23072
v_mfma_f32_16x16x32_bf16 v[232:235], v[16:19], a[8:11], v[232:235]
v_mfma_f32_16x16x32_bf16 v[236:239], v[16:19], a[12:15], v[236:239]
v_mfma_f32_16x16x32_bf16 v[240:243], v[20:23], a[0:3], v[240:243]
ds_read_b64_tr_b16 v[16:17], v15 offset:18496
v_mfma_f32_16x16x32_bf16 v[244:247], v[20:23], a[4:7], v[244:247]
ds_read_b64_tr_b16 v[18:19], v15 offset:23104
v_mfma_f32_16x16x32_bf16 v[248:251], v[20:23], a[8:11], v[248:251]
buffer_load_dwordx4 a[188:191], v9, s[8:11], s41 offen offset:3072 sc1
v_mfma_f32_16x16x32_bf16 v[252:255], v[20:23], a[12:15], v[252:255]
buffer_load_dwordx4 v12, s[48:51], s40 offen offset:2048 lds
s_waitcnt lgkmcnt(2)
v_mfma_f32_16x16x32_bf16 v[112:115], v[24:27], a[16:19], v[112:115]
ds_read_b64_tr_b16 v[20:21], v15 offset:18528
v_mfma_f32_16x16x32_bf16 v[116:119], v[24:27], a[20:23], v[116:119]
ds_read_b64_tr_b16 v[22:23], v15 offset:23136
v_mfma_f32_16x16x32_bf16 v[120:123], v[24:27], a[24:27], v[120:123]
s_add_u32 s41, s74, 0
v_mfma_f32_16x16x32_bf16 v[124:127], v[24:27], a[28:31], v[124:127]
v_mfma_f32_16x16x32_bf16 v[128:131], v[28:31], a[16:19], v[128:131]
ds_read_b64_tr_b16 v[24:25], v15 offset:18560
v_mfma_f32_16x16x32_bf16 v[132:135], v[28:31], a[20:23], v[132:135]
ds_read_b64_tr_b16 v[26:27], v15 offset:23168
v_mfma_f32_16x16x32_bf16 v[136:139], v[28:31], a[24:27], v[136:139]
buffer_load_dwordx4 a[192:195], v9, s[8:11], s41 offen offset:0 sc1
v_mfma_f32_16x16x32_bf16 v[140:143], v[28:31], a[28:31], v[140:143]
s_waitcnt lgkmcnt(2)
v_mfma_f32_16x16x32_bf16 v[144:147], v[16:19], a[16:19], v[144:147]
ds_read_b64_tr_b16 v[28:29], v15 offset:18592
v_mfma_f32_16x16x32_bf16 v[148:151], v[16:19], a[20:23], v[148:151]
ds_read_b64_tr_b16 v[30:31], v15 offset:23200
v_mfma_f32_16x16x32_bf16 v[152:155], v[16:19], a[24:27], v[152:155]
v_mfma_f32_16x16x32_bf16 v[156:159], v[16:19], a[28:31], v[156:159]
v_mfma_f32_16x16x32_bf16 v[160:163], v[20:23], a[16:19], v[160:163]
ds_read_b64_tr_b16 v[16:17], v15 offset:18624
v_mfma_f32_16x16x32_bf16 v[164:167], v[20:23], a[20:23], v[164:167]
ds_read_b64_tr_b16 v[18:19], v15 offset:23232
v_mfma_f32_16x16x32_bf16 v[168:171], v[20:23], a[24:27], v[168:171]
buffer_load_dwordx4 a[196:199], v9, s[8:11], s41 offen offset:1024 sc1
v_mfma_f32_16x16x32_bf16 v[172:175], v[20:23], a[28:31], v[172:175]
buffer_load_dwordx4 v13, s[48:51], s40 offen offset:3072 lds
s_waitcnt lgkmcnt(2)
v_mfma_f32_16x16x32_bf16 v[176:179], v[24:27], a[16:19], v[176:179]
ds_read_b64_tr_b16 v[20:21], v15 offset:18656
v_mfma_f32_16x16x32_bf16 v[180:183], v[24:27], a[20:23], v[180:183]
ds_read_b64_tr_b16 v[22:23], v15 offset:23264
v_mfma_f32_16x16x32_bf16 v[184:187], v[24:27], a[24:27], v[184:187]
v_mfma_f32_16x16x32_bf16 v[188:191], v[24:27], a[28:31], v[188:191]
v_mfma_f32_16x16x32_bf16 v[192:195], v[28:31], a[16:19], v[192:195]
ds_read_b64_tr_b16 v[24:25], v15 offset:18688
v_mfma_f32_16x16x32_bf16 v[196:199], v[28:31], a[20:23], v[196:199]
ds_read_b64_tr_b16 v[26:27], v15 offset:23296
v_mfma_f32_16x16x32_bf16 v[200:203], v[28:31], a[24:27], v[200:203]
buffer_load_dwordx4 a[200:203], v9, s[8:11], s41 offen offset:2048 sc1
v_mfma_f32_16x16x32_bf16 v[204:207], v[28:31], a[28:31], v[204:207]
s_waitcnt lgkmcnt(2)
v_mfma_f32_16x16x32_bf16 v[208:211], v[16:19], a[16:19], v[208:211]
ds_read_b64_tr_b16 v[28:29], v15 offset:27648
s_add_u32 m0, s47, 118784
v_mfma_f32_16x16x32_bf16 v[212:215], v[16:19], a[20:23], v[212:215]
ds_read_b64_tr_b16 v[30:31], v15 offset:32256
v_mfma_f32_16x16x32_bf16 v[216:219], v[16:19], a[24:27], v[216:219]
v_mfma_f32_16x16x32_bf16 v[220:223], v[16:19], a[28:31], v[220:223]
buffer_load_dwordx4 v14, s[48:51], s40 offen offset:0 lds
v_mfma_f32_16x16x32_bf16 v[224:227], v[20:23], a[16:19], v[224:227]
ds_read_b64_tr_b16 v[16:17], v15 offset:27680
v_mfma_f32_16x16x32_bf16 v[228:231], v[20:23], a[20:23], v[228:231]
ds_read_b64_tr_b16 v[18:19], v15 offset:32288
v_mfma_f32_16x16x32_bf16 v[232:235], v[20:23], a[24:27], v[232:235]
buffer_load_dwordx4 a[204:207], v9, s[8:11], s41 offen offset:3072 sc1
v_mfma_f32_16x16x32_bf16 v[236:239], v[20:23], a[28:31], v[236:239]
s_waitcnt lgkmcnt(2)
v_mfma_f32_16x16x32_bf16 v[240:243], v[24:27], a[16:19], v[240:243]
ds_read_b64_tr_b16 v[20:21], v15 offset:27712
v_mfma_f32_16x16x32_bf16 v[244:247], v[24:27], a[20:23], v[244:247]
ds_read_b64_tr_b16 v[22:23], v15 offset:32320
v_mfma_f32_16x16x32_bf16 v[248:251], v[24:27], a[24:27], v[248:251]
s_add_u32 s41, s74, 4096
v_mfma_f32_16x16x32_bf16 v[252:255], v[24:27], a[28:31], v[252:255]
v_mfma_f32_16x16x32_bf16 v[112:115], v[28:31], a[32:35], v[112:115]
ds_read_b64_tr_b16 v[24:25], v15 offset:27744
v_mfma_f32_16x16x32_bf16 v[116:119], v[28:31], a[36:39], v[116:119]
ds_read_b64_tr_b16 v[26:27], v15 offset:32352
v_mfma_f32_16x16x32_bf16 v[120:123], v[28:31], a[40:43], v[120:123]
buffer_load_dwordx4 a[208:211], v9, s[8:11], s41 offen offset:0 sc1
s_add_u32 m0, s47, 0
s_mov_b32 s40, s75
v_mfma_f32_16x16x32_bf16 v[124:127], v[28:31], a[44:47], v[124:127]
s_waitcnt lgkmcnt(2)
v_mfma_f32_16x16x32_bf16 v[128:131], v[16:19], a[32:35], v[128:131]
ds_read_b64_tr_b16 v[28:29], v15 offset:27776
v_mfma_f32_16x16x32_bf16 v[132:135], v[16:19], a[36:39], v[132:135]
ds_read_b64_tr_b16 v[30:31], v15 offset:32384
v_mfma_f32_16x16x32_bf16 v[136:139], v[16:19], a[40:43], v[136:139]
buffer_load_dwordx4 v1, s[48:51], s40 offen offset:0 lds
v_mfma_f32_16x16x32_bf16 v[140:143], v[16:19], a[44:47], v[140:143]
v_mfma_f32_16x16x32_bf16 v[144:147], v[20:23], a[32:35], v[144:147]
ds_read_b64_tr_b16 v[16:17], v15 offset:27808
v_mfma_f32_16x16x32_bf16 v[148:151], v[20:23], a[36:39], v[148:151]
ds_read_b64_tr_b16 v[18:19], v15 offset:32416
v_mfma_f32_16x16x32_bf16 v[152:155], v[20:23], a[40:43], v[152:155]
buffer_load_dwordx4 a[212:215], v9, s[8:11], s41 offen offset:1024 sc1
v_mfma_f32_16x16x32_bf16 v[156:159], v[20:23], a[44:47], v[156:159]
s_waitcnt lgkmcnt(2)
v_mfma_f32_16x16x32_bf16 v[160:163], v[24:27], a[32:35], v[160:163]
ds_read_b64_tr_b16 v[20:21], v15 offset:27840
v_mfma_f32_16x16x32_bf16 v[164:167], v[24:27], a[36:39], v[164:167]
ds_read_b64_tr_b16 v[22:23], v15 offset:32448
v_mfma_f32_16x16x32_bf16 v[168:171], v[24:27], a[40:43], v[168:171]
v_mfma_f32_16x16x32_bf16 v[172:175], v[24:27], a[44:47], v[172:175]
v_mfma_f32_16x16x32_bf16 v[176:179], v[28:31], a[32:35], v[176:179]
ds_read_b64_tr_b16 v[24:25], v15 offset:27872
v_mfma_f32_16x16x32_bf16 v[180:183], v[28:31], a[36:39], v[180:183]
ds_read_b64_tr_b16 v[26:27], v15 offset:32480
v_mfma_f32_16x16x32_bf16 v[184:187], v[28:31], a[40:43], v[184:187]
buffer_load_dwordx4 a[216:219], v9, s[8:11], s41 offen offset:2048 sc1
v_mfma_f32_16x16x32_bf16 v[188:191], v[28:31], a[44:47], v[188:191]
buffer_load_dwordx4 v2, s[48:51], s40 offen offset:1024 lds
s_waitcnt lgkmcnt(2)
v_mfma_f32_16x16x32_bf16 v[192:195], v[16:19], a[32:35], v[192:195]
ds_read_b64_tr_b16 v[28:29], v15 offset:27904
v_mfma_f32_16x16x32_bf16 v[196:199], v[16:19], a[36:39], v[196:199]
ds_read_b64_tr_b16 v[30:31], v15 offset:32512
v_mfma_f32_16x16x32_bf16 v[200:203], v[16:19], a[40:43], v[200:203]
v_mfma_f32_16x16x32_bf16 v[204:207], v[16:19], a[44:47], v[204:207]
v_add_u32 v15, 0x9000, v15
v_mfma_f32_16x16x32_bf16 v[208:211], v[20:23], a[32:35], v[208:211]
s_waitcnt vmcnt(30)
s_barrier
ds_read_b64_tr_b16 v[16:17], v15 offset:0
v_mfma_f32_16x16x32_bf16 v[212:215], v[20:23], a[36:39], v[212:215]
ds_read_b64_tr_b16 v[18:19], v15 offset:4608
v_mfma_f32_16x16x32_bf16 v[216:219], v[20:23], a[40:43], v[216:219]
buffer_load_dwordx4 a[220:223], v9, s[8:11], s41 offen offset:3072 sc1
v_mfma_f32_16x16x32_bf16 v[220:223], v[20:23], a[44:47], v[220:223]
s_waitcnt lgkmcnt(2)
v_mfma_f32_16x16x32_bf16 v[224:227], v[24:27], a[32:35], v[224:227]
ds_read_b64_tr_b16 v[20:21], v15 offset:32
v_mfma_f32_16x16x32_bf16 v[228:231], v[24:27], a[36:39], v[228:231]
ds_read_b64_tr_b16 v[22:23], v15 offset:4640
v_mfma_f32_16x16x32_bf16 v[232:235], v[24:27], a[40:43], v[232:235]
s_add_u32 s41, s74, 8192
v_mfma_f32_16x16x32_bf16 v[236:239], v[24:27], a[44:47], v[236:239]
v_mfma_f32_16x16x32_bf16 v[240:243], v[28:31], a[32:35], v[240:243]
ds_read_b64_tr_b16 v[24:25], v15 offset:64
v_mfma_f32_16x16x32_bf16 v[244:247], v[28:31], a[36:39], v[244:247]
ds_read_b64_tr_b16 v[26:27], v15 offset:4672
v_mfma_f32_16x16x32_bf16 v[248:251], v[28:31], a[40:43], v[248:251]
buffer_load_dwordx4 a[224:227], v9, s[8:11], s41 offen offset:0 sc1
v_mfma_f32_16x16x32_bf16 v[252:255], v[28:31], a[44:47], v[252:255]
buffer_load_dwordx4 v3, s[48:51], s40 offen offset:2048 lds
s_waitcnt lgkmcnt(2)
v_mfma_f32_16x16x32_bf16 v[112:115], v[16:19], a[48:51], v[112:115]
ds_read_b64_tr_b16 v[28:29], v15 offset:96
v_mfma_f32_16x16x32_bf16 v[116:119], v[16:19], a[52:55], v[116:119]
ds_read_b64_tr_b16 v[30:31], v15 offset:4704
v_mfma_f32_16x16x32_bf16 v[120:123], v[16:19], a[56:59], v[120:123]
v_mfma_f32_16x16x32_bf16 v[124:127], v[16:19], a[60:63], v[124:127]
v_mfma_f32_16x16x32_bf16 v[128:131], v[20:23], a[48:51], v[128:131]
ds_read_b64_tr_b16 v[16:17], v15 offset:128
v_mfma_f32_16x16x32_bf16 v[132:135], v[20:23], a[52:55], v[132:135]
ds_read_b64_tr_b16 v[18:19], v15 offset:4736
s_barrier
v_mfma_f32_16x16x32_bf16 v[136:139], v[20:23], a[56:59], v[136:139]
buffer_load_dwordx4 a[228:231], v9, s[8:11], s41 offen offset:1024 sc1
v_mfma_f32_16x16x32_bf16 v[140:143], v[20:23], a[60:63], v[140:143]
s_waitcnt lgkmcnt(2)
v_mfma_f32_16x16x32_bf16 v[144:147], v[24:27], a[48:51], v[144:147]
ds_read_b64_tr_b16 v[20:21], v15 offset:160
v_mfma_f32_16x16x32_bf16 v[148:151], v[24:27], a[52:55], v[148:151]
ds_read_b64_tr_b16 v[22:23], v15 offset:4768
v_mfma_f32_16x16x32_bf16 v[152:155], v[24:27], a[56:59], v[152:155]
v_mfma_f32_16x16x32_bf16 v[156:159], v[24:27], a[60:63], v[156:159]
buffer_load_dwordx4 v8, s[48:51], s40 offen offset:3072 lds
v_mfma_f32_16x16x32_bf16 v[160:163], v[28:31], a[48:51], v[160:163]
ds_read_b64_tr_b16 v[24:25], v15 offset:192
v_mfma_f32_16x16x32_bf16 v[164:167], v[28:31], a[52:55], v[164:167]
ds_read_b64_tr_b16 v[26:27], v15 offset:4800
v_mfma_f32_16x16x32_bf16 v[168:171], v[28:31], a[56:59], v[168:171]
buffer_load_dwordx4 a[232:235], v9, s[8:11], s41 offen offset:2048 sc1
v_mfma_f32_16x16x32_bf16 v[172:175], v[28:31], a[60:63], v[172:175]
s_waitcnt lgkmcnt(2)
v_mfma_f32_16x16x32_bf16 v[176:179], v[16:19], a[48:51], v[176:179]
ds_read_b64_tr_b16 v[28:29], v15 offset:224
v_mfma_f32_16x16x32_bf16 v[180:183], v[16:19], a[52:55], v[180:183]
ds_read_b64_tr_b16 v[30:31], v15 offset:4832
v_mfma_f32_16x16x32_bf16 v[184:187], v[16:19], a[56:59], v[184:187]
v_mfma_f32_16x16x32_bf16 v[188:191], v[16:19], a[60:63], v[188:191]
v_mfma_f32_16x16x32_bf16 v[192:195], v[20:23], a[48:51], v[192:195]
ds_read_b64_tr_b16 v[16:17], v15 offset:256
v_mfma_f32_16x16x32_bf16 v[196:199], v[20:23], a[52:55], v[196:199]
ds_read_b64_tr_b16 v[18:19], v15 offset:4864
v_mfma_f32_16x16x32_bf16 v[200:203], v[20:23], a[56:59], v[200:203]
buffer_load_dwordx4 a[236:239], v9, s[8:11], s41 offen offset:3072 sc1
s_add_u32 m0, s47, 4096
v_mfma_f32_16x16x32_bf16 v[204:207], v[20:23], a[60:63], v[204:207]
s_waitcnt lgkmcnt(2)
v_mfma_f32_16x16x32_bf16 v[208:211], v[24:27], a[48:51], v[208:211]
ds_read_b64_tr_b16 v[20:21], v15 offset:9216
v_mfma_f32_16x16x32_bf16 v[212:215], v[24:27], a[52:55], v[212:215]
ds_read_b64_tr_b16 v[22:23], v15 offset:13824
v_mfma_f32_16x16x32_bf16 v[216:219], v[24:27], a[56:59], v[216:219]
buffer_load_dwordx4 v10, s[48:51], s40 offen offset:0 lds
s_add_u32 s41, s74, 12288
v_mfma_f32_16x16x32_bf16 v[220:223], v[24:27], a[60:63], v[220:223]
v_mfma_f32_16x16x32_bf16 v[224:227], v[28:31], a[48:51], v[224:227]
ds_read_b64_tr_b16 v[24:25], v15 offset:9248
v_mfma_f32_16x16x32_bf16 v[228:231], v[28:31], a[52:55], v[228:231]
ds_read_b64_tr_b16 v[26:27], v15 offset:13856
v_mfma_f32_16x16x32_bf16 v[232:235], v[28:31], a[56:59], v[232:235]
buffer_load_dwordx4 a[240:243], v9, s[8:11], s41 offen offset:0 sc1
v_mfma_f32_16x16x32_bf16 v[236:239], v[28:31], a[60:63], v[236:239]
s_waitcnt lgkmcnt(2)
v_mfma_f32_16x16x32_bf16 v[240:243], v[16:19], a[48:51], v[240:243]
ds_read_b64_tr_b16 v[28:29], v15 offset:9280
v_mfma_f32_16x16x32_bf16 v[244:247], v[16:19], a[52:55], v[244:247]
ds_read_b64_tr_b16 v[30:31], v15 offset:13888
v_mfma_f32_16x16x32_bf16 v[248:251], v[16:19], a[56:59], v[248:251]
v_mfma_f32_16x16x32_bf16 v[252:255], v[16:19], a[60:63], v[252:255]
v_mfma_f32_16x16x32_bf16 v[112:115], v[20:23], a[64:67], v[112:115]
ds_read_b64_tr_b16 v[16:17], v15 offset:9312
v_mfma_f32_16x16x32_bf16 v[116:119], v[20:23], a[68:71], v[116:119]
ds_read_b64_tr_b16 v[18:19], v15 offset:13920
v_mfma_f32_16x16x32_bf16 v[120:123], v[20:23], a[72:75], v[120:123]
buffer_load_dwordx4 a[244:247], v9, s[8:11], s41 offen offset:1024 sc1
v_mfma_f32_16x16x32_bf16 v[124:127], v[20:23], a[76:79], v[124:127]
buffer_load_dwordx4 v11, s[48:51], s40 offen offset:1024 lds
s_waitcnt lgkmcnt(2)
v_mfma_f32_16x16x32_bf16 v[128:131], v[24:27], a[64:67], v[128:131]
ds_read_b64_tr_b16 v[20:21], v15 offset:9344
v_mfma_f32_16x16x32_bf16 v[132:135], v[24:27], a[68:71], v[132:135]
ds_read_b64_tr_b16 v[22:23], v15 offset:13952
v_mfma_f32_16x16x32_bf16 v[136:139], v[24:27], a[72:75], v[136:139]
v_mfma_f32_16x16x32_bf16 v[140:143], v[24:27], a[76:79], v[140:143]
v_mfma_f32_16x16x32_bf16 v[144:147], v[28:31], a[64:67], v[144:147]
ds_read_b64_tr_b16 v[24:25], v15 offset:9376
v_mfma_f32_16x16x32_bf16 v[148:151], v[28:31], a[68:71], v[148:151]
ds_read_b64_tr_b16 v[26:27], v15 offset:13984
v_mfma_f32_16x16x32_bf16 v[152:155], v[28:31], a[72:75], v[152:155]
buffer_load_dwordx4 a[248:251], v9, s[8:11], s41 offen offset:2048 sc1
v_mfma_f32_16x16x32_bf16 v[156:159], v[28:31], a[76:79], v[156:159]
s_waitcnt lgkmcnt(2)
v_mfma_f32_16x16x32_bf16 v[160:163], v[16:19], a[64:67], v[160:163]
ds_read_b64_tr_b16 v[28:29], v15 offset:9408
v_mfma_f32_16x16x32_bf16 v[164:167], v[16:19], a[68:71], v[164:167]
ds_read_b64_tr_b16 v[30:31], v15 offset:14016
v_mfma_f32_16x16x32_bf16 v[168:171], v[16:19], a[72:75], v[168:171]
v_mfma_f32_16x16x32_bf16 v[172:175], v[16:19], a[76:79], v[172:175]
v_mfma_f32_16x16x32_bf16 v[176:179], v[20:23], a[64:67], v[176:179]
ds_read_b64_tr_b16 v[16:17], v15 offset:9440
v_mfma_f32_16x16x32_bf16 v[180:183], v[20:23], a[68:71], v[180:183]
ds_read_b64_tr_b16 v[18:19], v15 offset:14048
v_mfma_f32_16x16x32_bf16 v[184:187], v[20:23], a[72:75], v[184:187]
buffer_load_dwordx4 a[252:255], v9, s[8:11], s41 offen offset:3072 sc1
v_mfma_f32_16x16x32_bf16 v[188:191], v[20:23], a[76:79], v[188:191]
buffer_load_dwordx4 v12, s[48:51], s40 offen offset:2048 lds
s_waitcnt lgkmcnt(2)
v_mfma_f32_16x16x32_bf16 v[192:195], v[24:27], a[64:67], v[192:195]
ds_read_b64_tr_b16 v[20:21], v15 offset:9472
v_mfma_f32_16x16x32_bf16 v[196:199], v[24:27], a[68:71], v[196:199]
ds_read_b64_tr_b16 v[22:23], v15 offset:14080
v_mfma_f32_16x16x32_bf16 v[200:203], v[24:27], a[72:75], v[200:203]
v_mfma_f32_16x16x32_bf16 v[204:207], v[24:27], a[76:79], v[204:207]
v_mfma_f32_16x16x32_bf16 v[208:211], v[28:31], a[64:67], v[208:211]
ds_read_b64_tr_b16 v[24:25], v15 offset:18432
v_mfma_f32_16x16x32_bf16 v[212:215], v[28:31], a[68:71], v[212:215]
ds_read_b64_tr_b16 v[26:27], v15 offset:23040
v_mfma_f32_16x16x32_bf16 v[216:219], v[28:31], a[72:75], v[216:219]
v_mfma_f32_16x16x32_bf16 v[220:223], v[28:31], a[76:79], v[220:223]
s_waitcnt lgkmcnt(2)
v_mfma_f32_16x16x32_bf16 v[224:227], v[16:19], a[64:67], v[224:227]
ds_read_b64_tr_b16 v[28:29], v15 offset:18464
v_mfma_f32_16x16x32_bf16 v[228:231], v[16:19], a[68:71], v[228:231]
ds_read_b64_tr_b16 v[30:31], v15 offset:23072
v_mfma_f32_16x16x32_bf16 v[232:235], v[16:19], a[72:75], v[232:235]
v_mfma_f32_16x16x32_bf16 v[236:239], v[16:19], a[76:79], v[236:239]
buffer_load_dwordx4 v13, s[48:51], s40 offen offset:3072 lds
v_mfma_f32_16x16x32_bf16 v[240:243], v[20:23], a[64:67], v[240:243]
ds_read_b64_tr_b16 v[16:17], v15 offset:18496
v_mfma_f32_16x16x32_bf16 v[244:247], v[20:23], a[68:71], v[244:247]
ds_read_b64_tr_b16 v[18:19], v15 offset:23104
v_mfma_f32_16x16x32_bf16 v[248:251], v[20:23], a[72:75], v[248:251]
v_mfma_f32_16x16x32_bf16 v[252:255], v[20:23], a[76:79], v[252:255]
s_waitcnt lgkmcnt(2)
v_mfma_f32_16x16x32_bf16 v[112:115], v[24:27], a[80:83], v[112:115]
ds_read_b64_tr_b16 v[20:21], v15 offset:18528
v_mfma_f32_16x16x32_bf16 v[116:119], v[24:27], a[84:87], v[116:119]
ds_read_b64_tr_b16 v[22:23], v15 offset:23136
v_mfma_f32_16x16x32_bf16 v[120:123], v[24:27], a[88:91], v[120:123]
v_mfma_f32_16x16x32_bf16 v[124:127], v[24:27], a[92:95], v[124:127]
v_mfma_f32_16x16x32_bf16 v[128:131], v[28:31], a[80:83], v[128:131]
ds_read_b64_tr_b16 v[24:25], v15 offset:18560
v_mfma_f32_16x16x32_bf16 v[132:135], v[28:31], a[84:87], v[132:135]
ds_read_b64_tr_b16 v[26:27], v15 offset:23168
v_mfma_f32_16x16x32_bf16 v[136:139], v[28:31], a[88:91], v[136:139]
s_add_u32 m0, s47, 8192
v_mfma_f32_16x16x32_bf16 v[140:143], v[28:31], a[92:95], v[140:143]
s_waitcnt lgkmcnt(2)
v_mfma_f32_16x16x32_bf16 v[144:147], v[16:19], a[80:83], v[144:147]
ds_read_b64_tr_b16 v[28:29], v15 offset:18592
v_mfma_f32_16x16x32_bf16 v[148:151], v[16:19], a[84:87], v[148:151]
ds_read_b64_tr_b16 v[30:31], v15 offset:23200
v_mfma_f32_16x16x32_bf16 v[152:155], v[16:19], a[88:91], v[152:155]
buffer_load_dwordx4 v14, s[48:51], s40 offen offset:0 lds
v_mfma_f32_16x16x32_bf16 v[156:159], v[16:19], a[92:95], v[156:159]
v_mfma_f32_16x16x32_bf16 v[160:163], v[20:23], a[80:83], v[160:163]
ds_read_b64_tr_b16 v[16:17], v15 offset:18624
v_mfma_f32_16x16x32_bf16 v[164:167], v[20:23], a[84:87], v[164:167]
ds_read_b64_tr_b16 v[18:19], v15 offset:23232
v_mfma_f32_16x16x32_bf16 v[168:171], v[20:23], a[88:91], v[168:171]
v_mfma_f32_16x16x32_bf16 v[172:175], v[20:23], a[92:95], v[172:175]
s_waitcnt lgkmcnt(2)
v_mfma_f32_16x16x32_bf16 v[176:179], v[24:27], a[80:83], v[176:179]
ds_read_b64_tr_b16 v[20:21], v15 offset:18656
v_mfma_f32_16x16x32_bf16 v[180:183], v[24:27], a[84:87], v[180:183]
ds_read_b64_tr_b16 v[22:23], v15 offset:23264
v_mfma_f32_16x16x32_bf16 v[184:187], v[24:27], a[88:91], v[184:187]
v_mfma_f32_16x16x32_bf16 v[188:191], v[24:27], a[92:95], v[188:191]
v_mfma_f32_16x16x32_bf16 v[192:195], v[28:31], a[80:83], v[192:195]
ds_read_b64_tr_b16 v[24:25], v15 offset:18688
v_mfma_f32_16x16x32_bf16 v[196:199], v[28:31], a[84:87], v[196:199]
ds_read_b64_tr_b16 v[26:27], v15 offset:23296
v_mfma_f32_16x16x32_bf16 v[200:203], v[28:31], a[88:91], v[200:203]
v_mfma_f32_16x16x32_bf16 v[204:207], v[28:31], a[92:95], v[204:207]
s_waitcnt lgkmcnt(2)
v_mfma_f32_16x16x32_bf16 v[208:211], v[16:19], a[80:83], v[208:211]
ds_read_b64_tr_b16 v[28:29], v15 offset:27648
v_mfma_f32_16x16x32_bf16 v[212:215], v[16:19], a[84:87], v[212:215]
ds_read_b64_tr_b16 v[30:31], v15 offset:32256
v_mfma_f32_16x16x32_bf16 v[216:219], v[16:19], a[88:91], v[216:219]
v_mfma_f32_16x16x32_bf16 v[220:223], v[16:19], a[92:95], v[220:223]
v_mfma_f32_16x16x32_bf16 v[224:227], v[20:23], a[80:83], v[224:227]
ds_read_b64_tr_b16 v[16:17], v15 offset:27680
v_mfma_f32_16x16x32_bf16 v[228:231], v[20:23], a[84:87], v[228:231]
ds_read_b64_tr_b16 v[18:19], v15 offset:32288
v_mfma_f32_16x16x32_bf16 v[232:235], v[20:23], a[88:91], v[232:235]
v_mfma_f32_16x16x32_bf16 v[236:239], v[20:23], a[92:95], v[236:239]
s_waitcnt lgkmcnt(2)
v_mfma_f32_16x16x32_bf16 v[240:243], v[24:27], a[80:83], v[240:243]
ds_read_b64_tr_b16 v[20:21], v15 offset:27712
v_mfma_f32_16x16x32_bf16 v[244:247], v[24:27], a[84:87], v[244:247]
ds_read_b64_tr_b16 v[22:23], v15 offset:32320
v_mfma_f32_16x16x32_bf16 v[248:251], v[24:27], a[88:91], v[248:251]
v_mfma_f32_16x16x32_bf16 v[252:255], v[24:27], a[92:95], v[252:255]
v_mfma_f32_16x16x32_bf16 v[112:115], v[28:31], a[96:99], v[112:115]
ds_read_b64_tr_b16 v[24:25], v15 offset:27744
v_mfma_f32_16x16x32_bf16 v[116:119], v[28:31], a[100:103], v[116:119]
ds_read_b64_tr_b16 v[26:27], v15 offset:32352
v_mfma_f32_16x16x32_bf16 v[120:123], v[28:31], a[104:107], v[120:123]
v_mfma_f32_16x16x32_bf16 v[124:127], v[28:31], a[108:111], v[124:127]
s_waitcnt lgkmcnt(2)
v_mfma_f32_16x16x32_bf16 v[128:131], v[16:19], a[96:99], v[128:131]
ds_read_b64_tr_b16 v[28:29], v15 offset:27776
v_mfma_f32_16x16x32_bf16 v[132:135], v[16:19], a[100:103], v[132:135]
ds_read_b64_tr_b16 v[30:31], v15 offset:32384
v_mfma_f32_16x16x32_bf16 v[136:139], v[16:19], a[104:107], v[136:139]
v_mfma_f32_16x16x32_bf16 v[140:143], v[16:19], a[108:111], v[140:143]
v_mfma_f32_16x16x32_bf16 v[144:147], v[20:23], a[96:99], v[144:147]
ds_read_b64_tr_b16 v[16:17], v15 offset:27808
v_mfma_f32_16x16x32_bf16 v[148:151], v[20:23], a[100:103], v[148:151]
ds_read_b64_tr_b16 v[18:19], v15 offset:32416
v_mfma_f32_16x16x32_bf16 v[152:155], v[20:23], a[104:107], v[152:155]
v_mfma_f32_16x16x32_bf16 v[156:159], v[20:23], a[108:111], v[156:159]
s_waitcnt lgkmcnt(2)
v_mfma_f32_16x16x32_bf16 v[160:163], v[24:27], a[96:99], v[160:163]
ds_read_b64_tr_b16 v[20:21], v15 offset:27840
v_mfma_f32_16x16x32_bf16 v[164:167], v[24:27], a[100:103], v[164:167]
ds_read_b64_tr_b16 v[22:23], v15 offset:32448
v_mfma_f32_16x16x32_bf16 v[168:171], v[24:27], a[104:107], v[168:171]
v_mfma_f32_16x16x32_bf16 v[172:175], v[24:27], a[108:111], v[172:175]
v_mfma_f32_16x16x32_bf16 v[176:179], v[28:31], a[96:99], v[176:179]
ds_read_b64_tr_b16 v[24:25], v15 offset:27872
v_mfma_f32_16x16x32_bf16 v[180:183], v[28:31], a[100:103], v[180:183]
ds_read_b64_tr_b16 v[26:27], v15 offset:32480
v_mfma_f32_16x16x32_bf16 v[184:187], v[28:31], a[104:107], v[184:187]
v_mfma_f32_16x16x32_bf16 v[188:191], v[28:31], a[108:111], v[188:191]
s_waitcnt lgkmcnt(2)
v_mfma_f32_16x16x32_bf16 v[192:195], v[16:19], a[96:99], v[192:195]
ds_read_b64_tr_b16 v[28:29], v15 offset:27904
v_mfma_f32_16x16x32_bf16 v[196:199], v[16:19], a[100:103], v[196:199]
ds_read_b64_tr_b16 v[30:31], v15 offset:32512
v_mfma_f32_16x16x32_bf16 v[200:203], v[16:19], a[104:107], v[200:203]
v_mfma_f32_16x16x32_bf16 v[204:207], v[16:19], a[108:111], v[204:207]
v_add_u32 v15, 0x9000, v15
v_mfma_f32_16x16x32_bf16 v[208:211], v[20:23], a[96:99], v[208:211]
s_waitcnt vmcnt(22)
s_barrier
ds_read_b64_tr_b16 v[16:17], v15 offset:0
v_mfma_f32_16x16x32_bf16 v[212:215], v[20:23], a[100:103], v[212:215]
ds_read_b64_tr_b16 v[18:19], v15 offset:4608
v_mfma_f32_16x16x32_bf16 v[216:219], v[20:23], a[104:107], v[216:219]
v_mfma_f32_16x16x32_bf16 v[220:223], v[20:23], a[108:111], v[220:223]
s_waitcnt lgkmcnt(2)
v_mfma_f32_16x16x32_bf16 v[224:227], v[24:27], a[96:99], v[224:227]
ds_read_b64_tr_b16 v[20:21], v15 offset:32
v_mfma_f32_16x16x32_bf16 v[228:231], v[24:27], a[100:103], v[228:231]
ds_read_b64_tr_b16 v[22:23], v15 offset:4640
v_mfma_f32_16x16x32_bf16 v[232:235], v[24:27], a[104:107], v[232:235]
v_mfma_f32_16x16x32_bf16 v[236:239], v[24:27], a[108:111], v[236:239]
v_mfma_f32_16x16x32_bf16 v[240:243], v[28:31], a[96:99], v[240:243]
ds_read_b64_tr_b16 v[24:25], v15 offset:64
v_mfma_f32_16x16x32_bf16 v[244:247], v[28:31], a[100:103], v[244:247]
ds_read_b64_tr_b16 v[26:27], v15 offset:4672
v_mfma_f32_16x16x32_bf16 v[248:251], v[28:31], a[104:107], v[248:251]
v_mfma_f32_16x16x32_bf16 v[252:255], v[28:31], a[108:111], v[252:255]
s_waitcnt lgkmcnt(2)
v_mfma_f32_16x16x32_bf16 v[112:115], v[16:19], a[112:115], v[112:115]
ds_read_b64_tr_b16 v[28:29], v15 offset:96
v_mfma_f32_16x16x32_bf16 v[116:119], v[16:19], a[116:119], v[116:119]
ds_read_b64_tr_b16 v[30:31], v15 offset:4704
v_mfma_f32_16x16x32_bf16 v[120:123], v[16:19], a[120:123], v[120:123]
v_mfma_f32_16x16x32_bf16 v[124:127], v[16:19], a[124:127], v[124:127]
v_mfma_f32_16x16x32_bf16 v[128:131], v[20:23], a[112:115], v[128:131]
ds_read_b64_tr_b16 v[16:17], v15 offset:128
v_mfma_f32_16x16x32_bf16 v[132:135], v[20:23], a[116:119], v[132:135]
ds_read_b64_tr_b16 v[18:19], v15 offset:4736
s_barrier
v_mfma_f32_16x16x32_bf16 v[136:139], v[20:23], a[120:123], v[136:139]
v_mfma_f32_16x16x32_bf16 v[140:143], v[20:23], a[124:127], v[140:143]
s_waitcnt lgkmcnt(2)
v_mfma_f32_16x16x32_bf16 v[144:147], v[24:27], a[112:115], v[144:147]
ds_read_b64_tr_b16 v[20:21], v15 offset:160
v_mfma_f32_16x16x32_bf16 v[148:151], v[24:27], a[116:119], v[148:151]
ds_read_b64_tr_b16 v[22:23], v15 offset:4768
v_mfma_f32_16x16x32_bf16 v[152:155], v[24:27], a[120:123], v[152:155]
v_mfma_f32_16x16x32_bf16 v[156:159], v[24:27], a[124:127], v[156:159]
v_mfma_f32_16x16x32_bf16 v[160:163], v[28:31], a[112:115], v[160:163]
ds_read_b64_tr_b16 v[24:25], v15 offset:192
v_mfma_f32_16x16x32_bf16 v[164:167], v[28:31], a[116:119], v[164:167]
ds_read_b64_tr_b16 v[26:27], v15 offset:4800
v_mfma_f32_16x16x32_bf16 v[168:171], v[28:31], a[120:123], v[168:171]
v_mfma_f32_16x16x32_bf16 v[172:175], v[28:31], a[124:127], v[172:175]
s_waitcnt lgkmcnt(2)
v_mfma_f32_16x16x32_bf16 v[176:179], v[16:19], a[112:115], v[176:179]
ds_read_b64_tr_b16 v[28:29], v15 offset:224
v_mfma_f32_16x16x32_bf16 v[180:183], v[16:19], a[116:119], v[180:183]
ds_read_b64_tr_b16 v[30:31], v15 offset:4832
v_mfma_f32_16x16x32_bf16 v[184:187], v[16:19], a[120:123], v[184:187]
v_mfma_f32_16x16x32_bf16 v[188:191], v[16:19], a[124:127], v[188:191]
v_mfma_f32_16x16x32_bf16 v[192:195], v[20:23], a[112:115], v[192:195]
ds_read_b64_tr_b16 v[16:17], v15 offset:256
v_mfma_f32_16x16x32_bf16 v[196:199], v[20:23], a[116:119], v[196:199]
ds_read_b64_tr_b16 v[18:19], v15 offset:4864
v_mfma_f32_16x16x32_bf16 v[200:203], v[20:23], a[120:123], v[200:203]
v_mfma_f32_16x16x32_bf16 v[204:207], v[20:23], a[124:127], v[204:207]
s_waitcnt lgkmcnt(2)
v_mfma_f32_16x16x32_bf16 v[208:211], v[24:27], a[112:115], v[208:211]
ds_read_b64_tr_b16 v[20:21], v15 offset:9216
v_mfma_f32_16x16x32_bf16 v[212:215], v[24:27], a[116:119], v[212:215]
ds_read_b64_tr_b16 v[22:23], v15 offset:13824
v_mfma_f32_16x16x32_bf16 v[216:219], v[24:27], a[120:123], v[216:219]
v_mfma_f32_16x16x32_bf16 v[220:223], v[24:27], a[124:127], v[220:223]
v_mfma_f32_16x16x32_bf16 v[224:227], v[28:31], a[112:115], v[224:227]
ds_read_b64_tr_b16 v[24:25], v15 offset:9248
v_mfma_f32_16x16x32_bf16 v[228:231], v[28:31], a[116:119], v[228:231]
ds_read_b64_tr_b16 v[26:27], v15 offset:13856
v_mfma_f32_16x16x32_bf16 v[232:235], v[28:31], a[120:123], v[232:235]
v_mfma_f32_16x16x32_bf16 v[236:239], v[28:31], a[124:127], v[236:239]
s_waitcnt lgkmcnt(2)
v_mfma_f32_16x16x32_bf16 v[240:243], v[16:19], a[112:115], v[240:243]
ds_read_b64_tr_b16 v[28:29], v15 offset:9280
v_mfma_f32_16x16x32_bf16 v[244:247], v[16:19], a[116:119], v[244:247]
ds_read_b64_tr_b16 v[30:31], v15 offset:13888
v_mfma_f32_16x16x32_bf16 v[248:251], v[16:19], a[120:123], v[248:251]
v_mfma_f32_16x16x32_bf16 v[252:255], v[16:19], a[124:127], v[252:255]
v_mfma_f32_16x16x32_bf16 v[112:115], v[20:23], a[128:131], v[112:115]
ds_read_b64_tr_b16 v[16:17], v15 offset:9312
v_mfma_f32_16x16x32_bf16 v[116:119], v[20:23], a[132:135], v[116:119]
ds_read_b64_tr_b16 v[18:19], v15 offset:13920
v_mfma_f32_16x16x32_bf16 v[120:123], v[20:23], a[136:139], v[120:123]
v_mfma_f32_16x16x32_bf16 v[124:127], v[20:23], a[140:143], v[124:127]
s_waitcnt lgkmcnt(2)
v_mfma_f32_16x16x32_bf16 v[128:131], v[24:27], a[128:131], v[128:131]
ds_read_b64_tr_b16 v[20:21], v15 offset:9344
v_mfma_f32_16x16x32_bf16 v[132:135], v[24:27], a[132:135], v[132:135]
ds_read_b64_tr_b16 v[22:23], v15 offset:13952
v_mfma_f32_16x16x32_bf16 v[136:139], v[24:27], a[136:139], v[136:139]
v_mfma_f32_16x16x32_bf16 v[140:143], v[24:27], a[140:143], v[140:143]
v_mfma_f32_16x16x32_bf16 v[144:147], v[28:31], a[128:131], v[144:147]
ds_read_b64_tr_b16 v[24:25], v15 offset:9376
v_mfma_f32_16x16x32_bf16 v[148:151], v[28:31], a[132:135], v[148:151]
ds_read_b64_tr_b16 v[26:27], v15 offset:13984
v_mfma_f32_16x16x32_bf16 v[152:155], v[28:31], a[136:139], v[152:155]
v_mfma_f32_16x16x32_bf16 v[156:159], v[28:31], a[140:143], v[156:159]
s_waitcnt lgkmcnt(2)
v_mfma_f32_16x16x32_bf16 v[160:163], v[16:19], a[128:131], v[160:163]
ds_read_b64_tr_b16 v[28:29], v15 offset:9408
v_mfma_f32_16x16x32_bf16 v[164:167], v[16:19], a[132:135], v[164:167]
ds_read_b64_tr_b16 v[30:31], v15 offset:14016
v_mfma_f32_16x16x32_bf16 v[168:171], v[16:19], a[136:139], v[168:171]
v_mfma_f32_16x16x32_bf16 v[172:175], v[16:19], a[140:143], v[172:175]
v_mfma_f32_16x16x32_bf16 v[176:179], v[20:23], a[128:131], v[176:179]
ds_read_b64_tr_b16 v[16:17], v15 offset:9440
v_mfma_f32_16x16x32_bf16 v[180:183], v[20:23], a[132:135], v[180:183]
ds_read_b64_tr_b16 v[18:19], v15 offset:14048
v_mfma_f32_16x16x32_bf16 v[184:187], v[20:23], a[136:139], v[184:187]
v_mfma_f32_16x16x32_bf16 v[188:191], v[20:23], a[140:143], v[188:191]
s_waitcnt lgkmcnt(2)
v_mfma_f32_16x16x32_bf16 v[192:195], v[24:27], a[128:131], v[192:195]
ds_read_b64_tr_b16 v[20:21], v15 offset:9472
v_mfma_f32_16x16x32_bf16 v[196:199], v[24:27], a[132:135], v[196:199]
ds_read_b64_tr_b16 v[22:23], v15 offset:14080
v_mfma_f32_16x16x32_bf16 v[200:203], v[24:27], a[136:139], v[200:203]
v_mfma_f32_16x16x32_bf16 v[204:207], v[24:27], a[140:143], v[204:207]
v_mfma_f32_16x16x32_bf16 v[208:211], v[28:31], a[128:131], v[208:211]
ds_read_b64_tr_b16 v[24:25], v15 offset:18432
v_mfma_f32_16x16x32_bf16 v[212:215], v[28:31], a[132:135], v[212:215]
ds_read_b64_tr_b16 v[26:27], v15 offset:23040
v_mfma_f32_16x16x32_bf16 v[216:219], v[28:31], a[136:139], v[216:219]
v_mfma_f32_16x16x32_bf16 v[220:223], v[28:31], a[140:143], v[220:223]
s_waitcnt lgkmcnt(2)
v_mfma_f32_16x16x32_bf16 v[224:227], v[16:19], a[128:131], v[224:227]
ds_read_b64_tr_b16 v[28:29], v15 offset:18464
v_mfma_f32_16x16x32_bf16 v[228:231], v[16:19], a[132:135], v[228:231]
ds_read_b64_tr_b16 v[30:31], v15 offset:23072
v_mfma_f32_16x16x32_bf16 v[232:235], v[16:19], a[136:139], v[232:235]
v_mfma_f32_16x16x32_bf16 v[236:239], v[16:19], a[140:143], v[236:239]
v_mfma_f32_16x16x32_bf16 v[240:243], v[20:23], a[128:131], v[240:243]
ds_read_b64_tr_b16 v[16:17], v15 offset:18496
v_mfma_f32_16x16x32_bf16 v[244:247], v[20:23], a[132:135], v[244:247]
ds_read_b64_tr_b16 v[18:19], v15 offset:23104
v_mfma_f32_16x16x32_bf16 v[248:251], v[20:23], a[136:139], v[248:251]
v_mfma_f32_16x16x32_bf16 v[252:255], v[20:23], a[140:143], v[252:255]
s_waitcnt lgkmcnt(2)
v_mfma_f32_16x16x32_bf16 v[112:115], v[24:27], a[160:163], v[112:115]
ds_read_b64_tr_b16 v[20:21], v15 offset:18528
v_mfma_f32_16x16x32_bf16 v[116:119], v[24:27], a[164:167], v[116:119]
ds_read_b64_tr_b16 v[22:23], v15 offset:23136
v_mfma_f32_16x16x32_bf16 v[120:123], v[24:27], a[168:171], v[120:123]
v_mfma_f32_16x16x32_bf16 v[124:127], v[24:27], a[172:175], v[124:127]
v_mfma_f32_16x16x32_bf16 v[128:131], v[28:31], a[160:163], v[128:131]
ds_read_b64_tr_b16 v[24:25], v15 offset:18560
v_mfma_f32_16x16x32_bf16 v[132:135], v[28:31], a[164:167], v[132:135]
ds_read_b64_tr_b16 v[26:27], v15 offset:23168
v_mfma_f32_16x16x32_bf16 v[136:139], v[28:31], a[168:171], v[136:139]
v_mfma_f32_16x16x32_bf16 v[140:143], v[28:31], a[172:175], v[140:143]
s_waitcnt lgkmcnt(2)
v_mfma_f32_16x16x32_bf16 v[144:147], v[16:19], a[160:163], v[144:147]
ds_read_b64_tr_b16 v[28:29], v15 offset:18592
v_mfma_f32_16x16x32_bf16 v[148:151], v[16:19], a[164:167], v[148:151]
ds_read_b64_tr_b16 v[30:31], v15 offset:23200
v_mfma_f32_16x16x32_bf16 v[152:155], v[16:19], a[168:171], v[152:155]
v_mfma_f32_16x16x32_bf16 v[156:159], v[16:19], a[172:175], v[156:159]
v_mfma_f32_16x16x32_bf16 v[160:163], v[20:23], a[160:163], v[160:163]
ds_read_b64_tr_b16 v[16:17], v15 offset:18624
v_mfma_f32_16x16x32_bf16 v[164:167], v[20:23], a[164:167], v[164:167]
ds_read_b64_tr_b16 v[18:19], v15 offset:23232
v_mfma_f32_16x16x32_bf16 v[168:171], v[20:23], a[168:171], v[168:171]
v_mfma_f32_16x16x32_bf16 v[172:175], v[20:23], a[172:175], v[172:175]
s_waitcnt lgkmcnt(2)
v_mfma_f32_16x16x32_bf16 v[176:179], v[24:27], a[160:163], v[176:179]
ds_read_b64_tr_b16 v[20:21], v15 offset:18656
v_mfma_f32_16x16x32_bf16 v[180:183], v[24:27], a[164:167], v[180:183]
ds_read_b64_tr_b16 v[22:23], v15 offset:23264
v_mfma_f32_16x16x32_bf16 v[184:187], v[24:27], a[168:171], v[184:187]
v_mfma_f32_16x16x32_bf16 v[188:191], v[24:27], a[172:175], v[188:191]
v_mfma_f32_16x16x32_bf16 v[192:195], v[28:31], a[160:163], v[192:195]
ds_read_b64_tr_b16 v[24:25], v15 offset:18688
v_mfma_f32_16x16x32_bf16 v[196:199], v[28:31], a[164:167], v[196:199]
ds_read_b64_tr_b16 v[26:27], v15 offset:23296
v_mfma_f32_16x16x32_bf16 v[200:203], v[28:31], a[168:171], v[200:203]
v_mfma_f32_16x16x32_bf16 v[204:207], v[28:31], a[172:175], v[204:207]
s_waitcnt lgkmcnt(2)
v_mfma_f32_16x16x32_bf16 v[208:211], v[16:19], a[160:163], v[208:211]
ds_read_b64_tr_b16 v[28:29], v15 offset:27648
v_mfma_f32_16x16x32_bf16 v[212:215], v[16:19], a[164:167], v[212:215]
ds_read_b64_tr_b16 v[30:31], v15 offset:32256
v_mfma_f32_16x16x32_bf16 v[216:219], v[16:19], a[168:171], v[216:219]
v_mfma_f32_16x16x32_bf16 v[220:223], v[16:19], a[172:175], v[220:223]
v_mfma_f32_16x16x32_bf16 v[224:227], v[20:23], a[160:163], v[224:227]
ds_read_b64_tr_b16 v[16:17], v15 offset:27680
v_mfma_f32_16x16x32_bf16 v[228:231], v[20:23], a[164:167], v[228:231]
ds_read_b64_tr_b16 v[18:19], v15 offset:32288
v_mfma_f32_16x16x32_bf16 v[232:235], v[20:23], a[168:171], v[232:235]
v_mfma_f32_16x16x32_bf16 v[236:239], v[20:23], a[172:175], v[236:239]
s_waitcnt lgkmcnt(2)
v_mfma_f32_16x16x32_bf16 v[240:243], v[24:27], a[160:163], v[240:243]
ds_read_b64_tr_b16 v[20:21], v15 offset:27712
v_mfma_f32_16x16x32_bf16 v[244:247], v[24:27], a[164:167], v[244:247]
ds_read_b64_tr_b16 v[22:23], v15 offset:32320
v_mfma_f32_16x16x32_bf16 v[248:251], v[24:27], a[168:171], v[248:251]
v_mfma_f32_16x16x32_bf16 v[252:255], v[24:27], a[172:175], v[252:255]
v_mfma_f32_16x16x32_bf16 v[112:115], v[28:31], a[176:179], v[112:115]
ds_read_b64_tr_b16 v[24:25], v15 offset:27744
v_mfma_f32_16x16x32_bf16 v[116:119], v[28:31], a[180:183], v[116:119]
ds_read_b64_tr_b16 v[26:27], v15 offset:32352
v_mfma_f32_16x16x32_bf16 v[120:123], v[28:31], a[184:187], v[120:123]
v_mfma_f32_16x16x32_bf16 v[124:127], v[28:31], a[188:191], v[124:127]
s_waitcnt lgkmcnt(2)
v_mfma_f32_16x16x32_bf16 v[128:131], v[16:19], a[176:179], v[128:131]
ds_read_b64_tr_b16 v[28:29], v15 offset:27776
v_mfma_f32_16x16x32_bf16 v[132:135], v[16:19], a[180:183], v[132:135]
ds_read_b64_tr_b16 v[30:31], v15 offset:32384
v_mfma_f32_16x16x32_bf16 v[136:139], v[16:19], a[184:187], v[136:139]
v_mfma_f32_16x16x32_bf16 v[140:143], v[16:19], a[188:191], v[140:143]
v_mfma_f32_16x16x32_bf16 v[144:147], v[20:23], a[176:179], v[144:147]
ds_read_b64_tr_b16 v[16:17], v15 offset:27808
v_mfma_f32_16x16x32_bf16 v[148:151], v[20:23], a[180:183], v[148:151]
ds_read_b64_tr_b16 v[18:19], v15 offset:32416
v_mfma_f32_16x16x32_bf16 v[152:155], v[20:23], a[184:187], v[152:155]
v_mfma_f32_16x16x32_bf16 v[156:159], v[20:23], a[188:191], v[156:159]
s_waitcnt lgkmcnt(2)
v_mfma_f32_16x16x32_bf16 v[160:163], v[24:27], a[176:179], v[160:163]
ds_read_b64_tr_b16 v[20:21], v15 offset:27840
v_mfma_f32_16x16x32_bf16 v[164:167], v[24:27], a[180:183], v[164:167]
ds_read_b64_tr_b16 v[22:23], v15 offset:32448
v_mfma_f32_16x16x32_bf16 v[168:171], v[24:27], a[184:187], v[168:171]
v_mfma_f32_16x16x32_bf16 v[172:175], v[24:27], a[188:191], v[172:175]
v_mfma_f32_16x16x32_bf16 v[176:179], v[28:31], a[176:179], v[176:179]
ds_read_b64_tr_b16 v[24:25], v15 offset:27872
v_mfma_f32_16x16x32_bf16 v[180:183], v[28:31], a[180:183], v[180:183]
ds_read_b64_tr_b16 v[26:27], v15 offset:32480
v_mfma_f32_16x16x32_bf16 v[184:187], v[28:31], a[184:187], v[184:187]
v_mfma_f32_16x16x32_bf16 v[188:191], v[28:31], a[188:191], v[188:191]
s_waitcnt lgkmcnt(2)
v_mfma_f32_16x16x32_bf16 v[192:195], v[16:19], a[176:179], v[192:195]
ds_read_b64_tr_b16 v[28:29], v15 offset:27904
v_mfma_f32_16x16x32_bf16 v[196:199], v[16:19], a[180:183], v[196:199]
ds_read_b64_tr_b16 v[30:31], v15 offset:32512
v_mfma_f32_16x16x32_bf16 v[200:203], v[16:19], a[184:187], v[200:203]
v_mfma_f32_16x16x32_bf16 v[204:207], v[16:19], a[188:191], v[204:207]
v_add_u32 v15, 0xfffe5000, v15
v_mfma_f32_16x16x32_bf16 v[208:211], v[20:23], a[176:179], v[208:211]
s_waitcnt vmcnt(0)
s_barrier
ds_read_b64_tr_b16 v[16:17], v15 offset:0
v_mfma_f32_16x16x32_bf16 v[212:215], v[20:23], a[180:183], v[212:215]
ds_read_b64_tr_b16 v[18:19], v15 offset:4608
v_mfma_f32_16x16x32_bf16 v[216:219], v[20:23], a[184:187], v[216:219]
v_mfma_f32_16x16x32_bf16 v[220:223], v[20:23], a[188:191], v[220:223]
s_waitcnt lgkmcnt(2)
v_mfma_f32_16x16x32_bf16 v[224:227], v[24:27], a[176:179], v[224:227]
ds_read_b64_tr_b16 v[20:21], v15 offset:9216
v_mfma_f32_16x16x32_bf16 v[228:231], v[24:27], a[180:183], v[228:231]
ds_read_b64_tr_b16 v[22:23], v15 offset:13824
v_mfma_f32_16x16x32_bf16 v[232:235], v[24:27], a[184:187], v[232:235]
v_mfma_f32_16x16x32_bf16 v[236:239], v[24:27], a[188:191], v[236:239]
v_mfma_f32_16x16x32_bf16 v[240:243], v[28:31], a[176:179], v[240:243]
ds_read_b64_tr_b16 v[24:25], v15 offset:18432
v_mfma_f32_16x16x32_bf16 v[244:247], v[28:31], a[180:183], v[244:247]
ds_read_b64_tr_b16 v[26:27], v15 offset:23040
v_mfma_f32_16x16x32_bf16 v[248:251], v[28:31], a[184:187], v[248:251]
v_mfma_f32_16x16x32_bf16 v[252:255], v[28:31], a[188:191], v[252:255]
s_waitcnt lgkmcnt(2)
v_mfma_f32_16x16x32_bf16 v[112:115], v[16:19], a[192:195], v[112:115]
ds_read_b64_tr_b16 v[28:29], v15 offset:27648
v_mfma_f32_16x16x32_bf16 v[116:119], v[16:19], a[196:199], v[116:119]
ds_read_b64_tr_b16 v[30:31], v15 offset:32256
v_mfma_f32_16x16x32_bf16 v[120:123], v[16:19], a[200:203], v[120:123]
v_mfma_f32_16x16x32_bf16 v[124:127], v[16:19], a[204:207], v[124:127]
v_mfma_f32_16x16x32_bf16 v[112:115], v[20:23], a[208:211], v[112:115]
ds_read_b64_tr_b16 v[16:17], v15 offset:32
v_mfma_f32_16x16x32_bf16 v[116:119], v[20:23], a[212:215], v[116:119]
ds_read_b64_tr_b16 v[18:19], v15 offset:4640
s_barrier
v_mfma_f32_16x16x32_bf16 v[120:123], v[20:23], a[216:219], v[120:123]
v_mfma_f32_16x16x32_bf16 v[124:127], v[20:23], a[220:223], v[124:127]
s_waitcnt lgkmcnt(2)
v_mfma_f32_16x16x32_bf16 v[112:115], v[24:27], a[224:227], v[112:115]
ds_read_b64_tr_b16 v[20:21], v15 offset:9248
v_mfma_f32_16x16x32_bf16 v[116:119], v[24:27], a[228:231], v[116:119]
ds_read_b64_tr_b16 v[22:23], v15 offset:13856
v_mfma_f32_16x16x32_bf16 v[120:123], v[24:27], a[232:235], v[120:123]
v_mfma_f32_16x16x32_bf16 v[124:127], v[24:27], a[236:239], v[124:127]
v_mfma_f32_16x16x32_bf16 v[112:115], v[28:31], a[240:243], v[112:115]
ds_read_b64_tr_b16 v[24:25], v15 offset:18464
v_mfma_f32_16x16x32_bf16 v[116:119], v[28:31], a[244:247], v[116:119]
ds_read_b64_tr_b16 v[26:27], v15 offset:23072
v_mfma_f32_16x16x32_bf16 v[120:123], v[28:31], a[248:251], v[120:123]
v_mfma_f32_16x16x32_bf16 v[124:127], v[28:31], a[252:255], v[124:127]
s_add_u32 s42, s62, 0
s_waitcnt lgkmcnt(2)
v_mfma_f32_16x16x32_bf16 v[128:131], v[16:19], a[192:195], v[128:131]
ds_read_b64_tr_b16 v[28:29], v15 offset:27680
v_mfma_f32_16x16x32_bf16 v[132:135], v[16:19], a[196:199], v[132:135]
ds_read_b64_tr_b16 v[30:31], v15 offset:32288
v_mfma_f32_16x16x32_bf16 v[136:139], v[16:19], a[200:203], v[136:139]
v_mfma_f32_16x16x32_bf16 v[140:143], v[16:19], a[204:207], v[140:143]
v_mfma_f32_16x16x32_bf16 v[128:131], v[20:23], a[208:211], v[128:131]
ds_read_b64_tr_b16 v[16:17], v15 offset:64
v_cvt_pk_bf16_f32 v32, v112, v113
v_mfma_f32_16x16x32_bf16 v[132:135], v[20:23], a[212:215], v[132:135]
ds_read_b64_tr_b16 v[18:19], v15 offset:4672
v_cvt_pk_bf16_f32 v33, v114, v115
v_mfma_f32_16x16x32_bf16 v[136:139], v[20:23], a[216:219], v[136:139]
v_cvt_pk_bf16_f32 v34, v116, v117
v_cvt_pk_bf16_f32 v35, v118, v119
v_mfma_f32_16x16x32_bf16 v[140:143], v[20:23], a[220:223], v[140:143]
buffer_store_dwordx4 v[32:35], v9, s[8:11], s42 offen offset:0 sc1
s_waitcnt lgkmcnt(2)
v_mfma_f32_16x16x32_bf16 v[128:131], v[24:27], a[224:227], v[128:131]
ds_read_b64_tr_b16 v[20:21], v15 offset:9280
v_cvt_pk_bf16_f32 v36, v120, v121
v_mfma_f32_16x16x32_bf16 v[132:135], v[24:27], a[228:231], v[132:135]
ds_read_b64_tr_b16 v[22:23], v15 offset:13888
v_cvt_pk_bf16_f32 v37, v122, v123
v_mfma_f32_16x16x32_bf16 v[136:139], v[24:27], a[232:235], v[136:139]
v_cvt_pk_bf16_f32 v38, v124, v125
v_cvt_pk_bf16_f32 v39, v126, v127
v_mfma_f32_16x16x32_bf16 v[140:143], v[24:27], a[236:239], v[140:143]
buffer_store_dwordx4 v[36:39], v9, s[8:11], s42 offen offset:1024 sc1
v_mfma_f32_16x16x32_bf16 v[128:131], v[28:31], a[240:243], v[128:131]
ds_read_b64_tr_b16 v[24:25], v15 offset:18496
v_mfma_f32_16x16x32_bf16 v[132:135], v[28:31], a[244:247], v[132:135]
ds_read_b64_tr_b16 v[26:27], v15 offset:23104
v_mfma_f32_16x16x32_bf16 v[136:139], v[28:31], a[248:251], v[136:139]
v_mfma_f32_16x16x32_bf16 v[140:143], v[28:31], a[252:255], v[140:143]
s_waitcnt lgkmcnt(2)
v_mfma_f32_16x16x32_bf16 v[144:147], v[16:19], a[192:195], v[144:147]
ds_read_b64_tr_b16 v[28:29], v15 offset:27712
v_mfma_f32_16x16x32_bf16 v[148:151], v[16:19], a[196:199], v[148:151]
ds_read_b64_tr_b16 v[30:31], v15 offset:32320
v_mfma_f32_16x16x32_bf16 v[152:155], v[16:19], a[200:203], v[152:155]
v_mfma_f32_16x16x32_bf16 v[156:159], v[16:19], a[204:207], v[156:159]
v_mfma_f32_16x16x32_bf16 v[144:147], v[20:23], a[208:211], v[144:147]
ds_read_b64_tr_b16 v[16:17], v15 offset:96
v_cvt_pk_bf16_f32 v40, v128, v129
v_mfma_f32_16x16x32_bf16 v[148:151], v[20:23], a[212:215], v[148:151]
ds_read_b64_tr_b16 v[18:19], v15 offset:4704
v_cvt_pk_bf16_f32 v41, v130, v131
v_mfma_f32_16x16x32_bf16 v[152:155], v[20:23], a[216:219], v[152:155]
v_cvt_pk_bf16_f32 v42, v132, v133
v_cvt_pk_bf16_f32 v43, v134, v135
v_mfma_f32_16x16x32_bf16 v[156:159], v[20:23], a[220:223], v[156:159]
buffer_store_dwordx4 v[40:43], v9, s[8:11], s42 offen offset:2048 sc1
s_waitcnt lgkmcnt(2)
v_mfma_f32_16x16x32_bf16 v[144:147], v[24:27], a[224:227], v[144:147]
ds_read_b64_tr_b16 v[20:21], v15 offset:9312
v_cvt_pk_bf16_f32 v44, v136, v137
v_mfma_f32_16x16x32_bf16 v[148:151], v[24:27], a[228:231], v[148:151]
ds_read_b64_tr_b16 v[22:23], v15 offset:13920
v_cvt_pk_bf16_f32 v45, v138, v139
v_mfma_f32_16x16x32_bf16 v[152:155], v[24:27], a[232:235], v[152:155]
v_cvt_pk_bf16_f32 v46, v140, v141
v_cvt_pk_bf16_f32 v47, v142, v143
v_mfma_f32_16x16x32_bf16 v[156:159], v[24:27], a[236:239], v[156:159]
buffer_store_dwordx4 v[44:47], v9, s[8:11], s42 offen offset:3072 sc1
s_add_u32 s42, s62, 4096
v_mfma_f32_16x16x32_bf16 v[144:147], v[28:31], a[240:243], v[144:147]
ds_read_b64_tr_b16 v[24:25], v15 offset:18528
v_mfma_f32_16x16x32_bf16 v[148:151], v[28:31], a[244:247], v[148:151]
ds_read_b64_tr_b16 v[26:27], v15 offset:23136
v_mfma_f32_16x16x32_bf16 v[152:155], v[28:31], a[248:251], v[152:155]
v_mfma_f32_16x16x32_bf16 v[156:159], v[28:31], a[252:255], v[156:159]
s_waitcnt lgkmcnt(2)
v_mfma_f32_16x16x32_bf16 v[160:163], v[16:19], a[192:195], v[160:163]
ds_read_b64_tr_b16 v[28:29], v15 offset:27744
v_mfma_f32_16x16x32_bf16 v[164:167], v[16:19], a[196:199], v[164:167]
ds_read_b64_tr_b16 v[30:31], v15 offset:32352
v_mfma_f32_16x16x32_bf16 v[168:171], v[16:19], a[200:203], v[168:171]
v_mfma_f32_16x16x32_bf16 v[172:175], v[16:19], a[204:207], v[172:175]
v_mfma_f32_16x16x32_bf16 v[160:163], v[20:23], a[208:211], v[160:163]
ds_read_b64_tr_b16 v[16:17], v15 offset:128
v_cvt_pk_bf16_f32 v48, v144, v145
v_mfma_f32_16x16x32_bf16 v[164:167], v[20:23], a[212:215], v[164:167]
ds_read_b64_tr_b16 v[18:19], v15 offset:4736
v_cvt_pk_bf16_f32 v49, v146, v147
v_mfma_f32_16x16x32_bf16 v[168:171], v[20:23], a[216:219], v[168:171]
v_cvt_pk_bf16_f32 v50, v148, v149
v_cvt_pk_bf16_f32 v51, v150, v151
v_mfma_f32_16x16x32_bf16 v[172:175], v[20:23], a[220:223], v[172:175]
buffer_store_dwordx4 v[48:51], v9, s[8:11], s42 offen offset:0 sc1
s_waitcnt lgkmcnt(2)
v_mfma_f32_16x16x32_bf16 v[160:163], v[24:27], a[224:227], v[160:163]
ds_read_b64_tr_b16 v[20:21], v15 offset:9344
v_cvt_pk_bf16_f32 v52, v152, v153
v_mfma_f32_16x16x32_bf16 v[164:167], v[24:27], a[228:231], v[164:167]
ds_read_b64_tr_b16 v[22:23], v15 offset:13952
v_cvt_pk_bf16_f32 v53, v154, v155
v_mfma_f32_16x16x32_bf16 v[168:171], v[24:27], a[232:235], v[168:171]
v_cvt_pk_bf16_f32 v54, v156, v157
v_cvt_pk_bf16_f32 v55, v158, v159
v_mfma_f32_16x16x32_bf16 v[172:175], v[24:27], a[236:239], v[172:175]
buffer_store_dwordx4 v[52:55], v9, s[8:11], s42 offen offset:1024 sc1
v_mfma_f32_16x16x32_bf16 v[160:163], v[28:31], a[240:243], v[160:163]
ds_read_b64_tr_b16 v[24:25], v15 offset:18560
v_mfma_f32_16x16x32_bf16 v[164:167], v[28:31], a[244:247], v[164:167]
ds_read_b64_tr_b16 v[26:27], v15 offset:23168
v_mfma_f32_16x16x32_bf16 v[168:171], v[28:31], a[248:251], v[168:171]
v_mfma_f32_16x16x32_bf16 v[172:175], v[28:31], a[252:255], v[172:175]
s_waitcnt lgkmcnt(2)
v_mfma_f32_16x16x32_bf16 v[176:179], v[16:19], a[192:195], v[176:179]
ds_read_b64_tr_b16 v[28:29], v15 offset:27776
v_mfma_f32_16x16x32_bf16 v[180:183], v[16:19], a[196:199], v[180:183]
ds_read_b64_tr_b16 v[30:31], v15 offset:32384
v_mfma_f32_16x16x32_bf16 v[184:187], v[16:19], a[200:203], v[184:187]
v_mfma_f32_16x16x32_bf16 v[188:191], v[16:19], a[204:207], v[188:191]
v_mfma_f32_16x16x32_bf16 v[176:179], v[20:23], a[208:211], v[176:179]
ds_read_b64_tr_b16 v[16:17], v15 offset:160
v_cvt_pk_bf16_f32 v56, v160, v161
v_mfma_f32_16x16x32_bf16 v[180:183], v[20:23], a[212:215], v[180:183]
ds_read_b64_tr_b16 v[18:19], v15 offset:4768
v_cvt_pk_bf16_f32 v57, v162, v163
v_mfma_f32_16x16x32_bf16 v[184:187], v[20:23], a[216:219], v[184:187]
v_cvt_pk_bf16_f32 v58, v164, v165
v_cvt_pk_bf16_f32 v59, v166, v167
v_mfma_f32_16x16x32_bf16 v[188:191], v[20:23], a[220:223], v[188:191]
buffer_store_dwordx4 v[56:59], v9, s[8:11], s42 offen offset:2048 sc1
s_waitcnt lgkmcnt(2)
v_mfma_f32_16x16x32_bf16 v[176:179], v[24:27], a[224:227], v[176:179]
ds_read_b64_tr_b16 v[20:21], v15 offset:9376
v_cvt_pk_bf16_f32 v60, v168, v169
v_mfma_f32_16x16x32_bf16 v[180:183], v[24:27], a[228:231], v[180:183]
ds_read_b64_tr_b16 v[22:23], v15 offset:13984
v_cvt_pk_bf16_f32 v61, v170, v171
v_mfma_f32_16x16x32_bf16 v[184:187], v[24:27], a[232:235], v[184:187]
v_cvt_pk_bf16_f32 v62, v172, v173
v_cvt_pk_bf16_f32 v63, v174, v175
v_mfma_f32_16x16x32_bf16 v[188:191], v[24:27], a[236:239], v[188:191]
buffer_store_dwordx4 v[60:63], v9, s[8:11], s42 offen offset:3072 sc1
s_add_u32 s42, s62, 8192
v_mfma_f32_16x16x32_bf16 v[176:179], v[28:31], a[240:243], v[176:179]
ds_read_b64_tr_b16 v[24:25], v15 offset:18592
v_mfma_f32_16x16x32_bf16 v[180:183], v[28:31], a[244:247], v[180:183]
ds_read_b64_tr_b16 v[26:27], v15 offset:23200
v_mfma_f32_16x16x32_bf16 v[184:187], v[28:31], a[248:251], v[184:187]
v_mfma_f32_16x16x32_bf16 v[188:191], v[28:31], a[252:255], v[188:191]
s_waitcnt lgkmcnt(2)
v_mfma_f32_16x16x32_bf16 v[192:195], v[16:19], a[192:195], v[192:195]
ds_read_b64_tr_b16 v[28:29], v15 offset:27808
v_mfma_f32_16x16x32_bf16 v[196:199], v[16:19], a[196:199], v[196:199]
ds_read_b64_tr_b16 v[30:31], v15 offset:32416
v_mfma_f32_16x16x32_bf16 v[200:203], v[16:19], a[200:203], v[200:203]
v_mfma_f32_16x16x32_bf16 v[204:207], v[16:19], a[204:207], v[204:207]
v_mfma_f32_16x16x32_bf16 v[192:195], v[20:23], a[208:211], v[192:195]
ds_read_b64_tr_b16 v[16:17], v15 offset:192
v_cvt_pk_bf16_f32 v32, v176, v177
v_mfma_f32_16x16x32_bf16 v[196:199], v[20:23], a[212:215], v[196:199]
ds_read_b64_tr_b16 v[18:19], v15 offset:4800
v_cvt_pk_bf16_f32 v33, v178, v179
v_mfma_f32_16x16x32_bf16 v[200:203], v[20:23], a[216:219], v[200:203]
v_cvt_pk_bf16_f32 v34, v180, v181
v_cvt_pk_bf16_f32 v35, v182, v183
v_mfma_f32_16x16x32_bf16 v[204:207], v[20:23], a[220:223], v[204:207]
buffer_store_dwordx4 v[32:35], v9, s[8:11], s42 offen offset:0 sc1
s_waitcnt lgkmcnt(2)
v_mfma_f32_16x16x32_bf16 v[192:195], v[24:27], a[224:227], v[192:195]
ds_read_b64_tr_b16 v[20:21], v15 offset:9408
v_cvt_pk_bf16_f32 v36, v184, v185
v_mfma_f32_16x16x32_bf16 v[196:199], v[24:27], a[228:231], v[196:199]
ds_read_b64_tr_b16 v[22:23], v15 offset:14016
v_cvt_pk_bf16_f32 v37, v186, v187
v_mfma_f32_16x16x32_bf16 v[200:203], v[24:27], a[232:235], v[200:203]
v_cvt_pk_bf16_f32 v38, v188, v189
v_cvt_pk_bf16_f32 v39, v190, v191
v_mfma_f32_16x16x32_bf16 v[204:207], v[24:27], a[236:239], v[204:207]
buffer_store_dwordx4 v[36:39], v9, s[8:11], s42 offen offset:1024 sc1
v_mfma_f32_16x16x32_bf16 v[192:195], v[28:31], a[240:243], v[192:195]
ds_read_b64_tr_b16 v[24:25], v15 offset:18624
v_mfma_f32_16x16x32_bf16 v[196:199], v[28:31], a[244:247], v[196:199]
ds_read_b64_tr_b16 v[26:27], v15 offset:23232
v_mfma_f32_16x16x32_bf16 v[200:203], v[28:31], a[248:251], v[200:203]
v_mfma_f32_16x16x32_bf16 v[204:207], v[28:31], a[252:255], v[204:207]
s_waitcnt lgkmcnt(2)
v_mfma_f32_16x16x32_bf16 v[208:211], v[16:19], a[192:195], v[208:211]
ds_read_b64_tr_b16 v[28:29], v15 offset:27840
v_mfma_f32_16x16x32_bf16 v[212:215], v[16:19], a[196:199], v[212:215]
ds_read_b64_tr_b16 v[30:31], v15 offset:32448
v_mfma_f32_16x16x32_bf16 v[216:219], v[16:19], a[200:203], v[216:219]
v_mfma_f32_16x16x32_bf16 v[220:223], v[16:19], a[204:207], v[220:223]
v_mfma_f32_16x16x32_bf16 v[208:211], v[20:23], a[208:211], v[208:211]
ds_read_b64_tr_b16 v[16:17], v15 offset:224
v_cvt_pk_bf16_f32 v40, v192, v193
v_mfma_f32_16x16x32_bf16 v[212:215], v[20:23], a[212:215], v[212:215]
ds_read_b64_tr_b16 v[18:19], v15 offset:4832
v_cvt_pk_bf16_f32 v41, v194, v195
v_mfma_f32_16x16x32_bf16 v[216:219], v[20:23], a[216:219], v[216:219]
v_cvt_pk_bf16_f32 v42, v196, v197
v_cvt_pk_bf16_f32 v43, v198, v199
v_mfma_f32_16x16x32_bf16 v[220:223], v[20:23], a[220:223], v[220:223]
buffer_store_dwordx4 v[40:43], v9, s[8:11], s42 offen offset:2048 sc1
s_waitcnt lgkmcnt(2)
v_mfma_f32_16x16x32_bf16 v[208:211], v[24:27], a[224:227], v[208:211]
ds_read_b64_tr_b16 v[20:21], v15 offset:9440
v_cvt_pk_bf16_f32 v44, v200, v201
v_mfma_f32_16x16x32_bf16 v[212:215], v[24:27], a[228:231], v[212:215]
ds_read_b64_tr_b16 v[22:23], v15 offset:14048
v_cvt_pk_bf16_f32 v45, v202, v203
v_mfma_f32_16x16x32_bf16 v[216:219], v[24:27], a[232:235], v[216:219]
v_cvt_pk_bf16_f32 v46, v204, v205
v_cvt_pk_bf16_f32 v47, v206, v207
v_mfma_f32_16x16x32_bf16 v[220:223], v[24:27], a[236:239], v[220:223]
buffer_store_dwordx4 v[44:47], v9, s[8:11], s42 offen offset:3072 sc1
s_add_u32 s42, s62, 12288
v_mfma_f32_16x16x32_bf16 v[208:211], v[28:31], a[240:243], v[208:211]
ds_read_b64_tr_b16 v[24:25], v15 offset:18656
v_mfma_f32_16x16x32_bf16 v[212:215], v[28:31], a[244:247], v[212:215]
ds_read_b64_tr_b16 v[26:27], v15 offset:23264
v_mfma_f32_16x16x32_bf16 v[216:219], v[28:31], a[248:251], v[216:219]
v_mfma_f32_16x16x32_bf16 v[220:223], v[28:31], a[252:255], v[220:223]
s_waitcnt lgkmcnt(2)
v_mfma_f32_16x16x32_bf16 v[224:227], v[16:19], a[192:195], v[224:227]
ds_read_b64_tr_b16 v[28:29], v15 offset:27872
v_mfma_f32_16x16x32_bf16 v[228:231], v[16:19], a[196:199], v[228:231]
ds_read_b64_tr_b16 v[30:31], v15 offset:32480
v_mfma_f32_16x16x32_bf16 v[232:235], v[16:19], a[200:203], v[232:235]
v_mfma_f32_16x16x32_bf16 v[236:239], v[16:19], a[204:207], v[236:239]
v_mfma_f32_16x16x32_bf16 v[224:227], v[20:23], a[208:211], v[224:227]
ds_read_b64_tr_b16 v[16:17], v15 offset:256
v_cvt_pk_bf16_f32 v48, v208, v209
v_mfma_f32_16x16x32_bf16 v[228:231], v[20:23], a[212:215], v[228:231]
ds_read_b64_tr_b16 v[18:19], v15 offset:4864
v_cvt_pk_bf16_f32 v49, v210, v211
v_mfma_f32_16x16x32_bf16 v[232:235], v[20:23], a[216:219], v[232:235]
v_cvt_pk_bf16_f32 v50, v212, v213
v_cvt_pk_bf16_f32 v51, v214, v215
v_mfma_f32_16x16x32_bf16 v[236:239], v[20:23], a[220:223], v[236:239]
buffer_store_dwordx4 v[48:51], v9, s[8:11], s42 offen offset:0 sc1
s_waitcnt lgkmcnt(2)
v_mfma_f32_16x16x32_bf16 v[224:227], v[24:27], a[224:227], v[224:227]
ds_read_b64_tr_b16 v[20:21], v15 offset:9472
v_cvt_pk_bf16_f32 v52, v216, v217
v_mfma_f32_16x16x32_bf16 v[228:231], v[24:27], a[228:231], v[228:231]
ds_read_b64_tr_b16 v[22:23], v15 offset:14080
v_cvt_pk_bf16_f32 v53, v218, v219
v_mfma_f32_16x16x32_bf16 v[232:235], v[24:27], a[232:235], v[232:235]
v_cvt_pk_bf16_f32 v54, v220, v221
v_cvt_pk_bf16_f32 v55, v222, v223
v_mfma_f32_16x16x32_bf16 v[236:239], v[24:27], a[236:239], v[236:239]
buffer_store_dwordx4 v[52:55], v9, s[8:11], s42 offen offset:1024 sc1
v_mfma_f32_16x16x32_bf16 v[224:227], v[28:31], a[240:243], v[224:227]
ds_read_b64_tr_b16 v[24:25], v15 offset:18688
v_mfma_f32_16x16x32_bf16 v[228:231], v[28:31], a[244:247], v[228:231]
ds_read_b64_tr_b16 v[26:27], v15 offset:23296
v_mfma_f32_16x16x32_bf16 v[232:235], v[28:31], a[248:251], v[232:235]
v_mfma_f32_16x16x32_bf16 v[236:239], v[28:31], a[252:255], v[236:239]
s_waitcnt lgkmcnt(2)
v_mfma_f32_16x16x32_bf16 v[240:243], v[16:19], a[192:195], v[240:243]
ds_read_b64_tr_b16 v[28:29], v15 offset:27904
v_mfma_f32_16x16x32_bf16 v[244:247], v[16:19], a[196:199], v[244:247]
ds_read_b64_tr_b16 v[30:31], v15 offset:32512
v_mfma_f32_16x16x32_bf16 v[248:251], v[16:19], a[200:203], v[248:251]
v_mfma_f32_16x16x32_bf16 v[252:255], v[16:19], a[204:207], v[252:255]
v_mfma_f32_16x16x32_bf16 v[240:243], v[20:23], a[208:211], v[240:243]
v_cvt_pk_bf16_f32 v56, v224, v225
v_cvt_pk_bf16_f32 v57, v226, v227
v_mfma_f32_16x16x32_bf16 v[244:247], v[20:23], a[212:215], v[244:247]
v_cvt_pk_bf16_f32 v58, v228, v229
v_cvt_pk_bf16_f32 v59, v230, v231
v_mfma_f32_16x16x32_bf16 v[248:251], v[20:23], a[216:219], v[248:251]
buffer_store_dwordx4 v[56:59], v9, s[8:11], s42 offen offset:2048 sc1
v_mfma_f32_16x16x32_bf16 v[252:255], v[20:23], a[220:223], v[252:255]
v_cvt_pk_bf16_f32 v60, v232, v233
v_cvt_pk_bf16_f32 v61, v234, v235
s_waitcnt lgkmcnt(0)
v_mfma_f32_16x16x32_bf16 v[240:243], v[24:27], a[224:227], v[240:243]
v_cvt_pk_bf16_f32 v62, v236, v237
v_cvt_pk_bf16_f32 v63, v238, v239
v_mfma_f32_16x16x32_bf16 v[244:247], v[24:27], a[228:231], v[244:247]
buffer_store_dwordx4 v[60:63], v9, s[8:11], s42 offen offset:3072 sc1
s_add_u32 s42, s62, 16384
v_mfma_f32_16x16x32_bf16 v[248:251], v[24:27], a[232:235], v[248:251]
v_mfma_f32_16x16x32_bf16 v[252:255], v[24:27], a[236:239], v[252:255]
v_mfma_f32_16x16x32_bf16 v[240:243], v[28:31], a[240:243], v[240:243]
v_mfma_f32_16x16x32_bf16 v[244:247], v[28:31], a[244:247], v[244:247]
v_mfma_f32_16x16x32_bf16 v[248:251], v[28:31], a[248:251], v[248:251]
v_mfma_f32_16x16x32_bf16 v[252:255], v[28:31], a[252:255], v[252:255]
s_nop 4
v_cvt_pk_bf16_f32 v32, v240, v241
v_cvt_pk_bf16_f32 v33, v242, v243
v_cvt_pk_bf16_f32 v34, v244, v245
v_cvt_pk_bf16_f32 v35, v246, v247
buffer_store_dwordx4 v[32:35], v9, s[8:11], s42 offen offset:0 sc1
v_cvt_pk_bf16_f32 v36, v248, v249
v_cvt_pk_bf16_f32 v37, v250, v251
v_cvt_pk_bf16_f32 v38, v252, v253
v_cvt_pk_bf16_f32 v39, v254, v255
buffer_store_dwordx4 v[36:39], v9, s[8:11], s42 offen offset:1024 sc1
s_load_dwordx2 s[56:57], s[0:1], 72
s_and_b32 s20, s2, 7
s_lshr_b32 s21, s20, 1
s_and_b32 s22, s20, 1
s_lshl_b32 s23, s29, 2
s_add_u32 s23, s23, s68
s_lshl_b32 s24, s23, 2
s_add_u32 s24, s24, s21
s_mul_i32 s24, s24, 18432
s_lshl_b32 s25, s22, 10
s_add_u32 s24, s24, s25
s_lshl_b32 s25, s29, 8
s_lshl_b32 s26, s21, 6
s_add_u32 s25, s25, s26
s_lshl_b32 s26, s22, 5
s_add_u32 s25, s25, s26
s_mul_i32 s26, s68, 288
v_and_b32 v2, 15, v0
v_add_u32 v2, s25, v2
v_mul_u32_u24 v2, 1152, v2
v_lshrrev_b32 v3, 4, v0
v_lshl_add_u32 v2, v3, 3, v2
v_add_u32 v2, s26, v2
v_add_u32 v3, 18432, v2
s_lshl_b32 s20, s28, 5
s_add_u32 s21, s20, 128
s_lshr_b32 s22, s28, 1
s_mul_i32 s22, s22, 18432
s_and_b32 s23, s28, 1
s_lshl_b32 s23, s23, 2
s_add_u32 s22, s22, s23
s_add_u32 s22, s22, 256
s_lshl_b32 s25, s28, 11
s_add_u32 s25, s25, s24
s_lshl_b32 s26, s28, 2
s_add_u32 s26, s26, s24
s_add_u32 s26, s26, 16384
v_mov_b32 v133, 0x3f80
v_mov_b32 v134, 0x3f800000
buffer_load_dwordx2 v[124:125], v2, s[52:55], s20 offen
buffer_load_dwordx2 v[126:127], v3, s[52:55], s20 offen
buffer_load_dwordx2 v[128:129], v2, s[52:55], s21 offen
buffer_load_dwordx2 v[130:131], v3, s[52:55], s21 offen
buffer_load_dword v132, v2, s[52:55], s22 offen
buffer_load_dword v7, v6, s[8:11], s67 offen sc1
s_waitcnt vmcnt(6)
buffer_store_dword v5, v4, s[8:11], s65 offen sc1
s_waitcnt vmcnt(1)
v_cmp_eq_u32 vcc, s100, v7
s_nop 3
s_and_b32 s43, vcc_lo, 0xf0
s_cmp_eq_u32 s43, 0xf0
s_cbranch_scc0 mk_slowYY
mk_backYY:
s_add_u32 s27, s25, 59768832
buffer_load_dwordx4 v[16:19], v9, s[8:11], s27 offen sc1
s_add_u32 s27, s25, 62128128
buffer_load_dwordx4 v[20:23], v9, s[8:11], s27 offen sc1
s_add_u32 s27, s25, 64487424
buffer_load_dwordx4 v[24:27], v9, s[8:11], s27 offen sc1
s_add_u32 s27, s25, 66846720
buffer_load_dwordx4 v[28:31], v9, s[8:11], s27 offen sc1
s_add_u32 s27, s25, 59777024
buffer_load_dwordx4 v[48:51], v9, s[8:11], s27 offen sc1
s_add_u32 s27, s25, 62136320
buffer_load_dwordx4 v[52:55], v9, s[8:11], s27 offen sc1
s_add_u32 s27, s25, 64495616
buffer_load_dwordx4 v[56:59], v9, s[8:11], s27 offen sc1
s_add_u32 s27, s25, 66854912
buffer_load_dwordx4 v[60:63], v9, s[8:11], s27 offen sc1
s_add_u32 s27, s26, 59768832
buffer_load_dword v80, v9, s[8:11], s27 offen sc1
s_add_u32 s27, s26, 62128128
buffer_load_dword v81, v9, s[8:11], s27 offen sc1
s_add_u32 s27, s26, 64487424
buffer_load_dword v82, v9, s[8:11], s27 offen sc1
s_add_u32 s27, s26, 66846720
buffer_load_dword v83, v9, s[8:11], s27 offen sc1
v_lshlrev_b32 v156, 16, v124
v_and_b32 v157, 0xffff0000, v124
v_lshlrev_b32 v158, 16, v125
v_and_b32 v159, 0xffff0000, v125
v_lshlrev_b32 v160, 16, v126
v_and_b32 v161, 0xffff0000, v126
v_lshlrev_b32 v162, 16, v127
v_and_b32 v163, 0xffff0000, v127
v_lshlrev_b32 v164, 16, v128
v_and_b32 v165, 0xffff0000, v128
v_lshlrev_b32 v166, 16, v129
v_and_b32 v167, 0xffff0000, v129
v_lshlrev_b32 v168, 16, v130
v_and_b32 v169, 0xffff0000, v130
v_lshlrev_b32 v170, 16, v131
v_and_b32 v171, 0xffff0000, v131
v_lshlrev_b32 v172, 16, v132
v_and_b32 v173, 0xffff0000, v132
s_waitcnt vmcnt(8)
v_dot2_f32_bf16 v88, v16, v133, 0
v_dot2_f32_bf16 v89, v16, v134, 0
v_dot2_f32_bf16 v90, v17, v133, 0
v_dot2_f32_bf16 v91, v17, v134, 0
v_dot2_f32_bf16 v92, v18, v133, 0
v_dot2_f32_bf16 v93, v18, v134, 0
v_dot2_f32_bf16 v94, v19, v133, 0
v_dot2_f32_bf16 v95, v19, v134, 0
v_dot2_f32_bf16 v88, v20, v133, v88
v_dot2_f32_bf16 v89, v20, v134, v89
v_dot2_f32_bf16 v90, v21, v133, v90
v_dot2_f32_bf16 v91, v21, v134, v91
v_dot2_f32_bf16 v92, v22, v133, v92
v_dot2_f32_bf16 v93, v22, v134, v93
v_dot2_f32_bf16 v94, v23, v133, v94
v_dot2_f32_bf16 v95, v23, v134, v95
v_dot2_f32_bf16 v88, v24, v133, v88
v_dot2_f32_bf16 v89, v24, v134, v89
v_dot2_f32_bf16 v90, v25, v133, v90
v_dot2_f32_bf16 v91, v25, v134, v91
v_dot2_f32_bf16 v92, v26, v133, v92
v_dot2_f32_bf16 v93, v26, v134, v93
v_dot2_f32_bf16 v94, v27, v133, v94
v_dot2_f32_bf16 v95, v27, v134, v95
v_dot2_f32_bf16 v88, v28, v133, v88
v_dot2_f32_bf16 v89, v28, v134, v89
v_dot2_f32_bf16 v90, v29, v133, v90
v_dot2_f32_bf16 v91, v29, v134, v91
v_dot2_f32_bf16 v92, v30, v133, v92
v_dot2_f32_bf16 v93, v30, v134, v93
v_dot2_f32_bf16 v94, v31, v133, v94
v_dot2_f32_bf16 v95, v31, v134, v95
s_waitcnt vmcnt(4)
v_dot2_f32_bf16 v96, v48, v133, 0
v_dot2_f32_bf16 v97, v48, v134, 0
v_dot2_f32_bf16 v98, v49, v133, 0
v_dot2_f32_bf16 v99, v49, v134, 0
v_dot2_f32_bf16 v100, v50, v133, 0
v_dot2_f32_bf16 v101, v50, v134, 0
v_dot2_f32_bf16 v102, v51, v133, 0
v_dot2_f32_bf16 v103, v51, v134, 0
v_dot2_f32_bf16 v96, v52, v133, v96
v_dot2_f32_bf16 v97, v52, v134, v97
v_dot2_f32_bf16 v98, v53, v133, v98
v_dot2_f32_bf16 v99, v53, v134, v99
v_dot2_f32_bf16 v100, v54, v133, v100
v_dot2_f32_bf16 v101, v54, v134, v101
v_dot2_f32_bf16 v102, v55, v133, v102
v_dot2_f32_bf16 v103, v55, v134, v103
v_dot2_f32_bf16 v96, v56, v133, v96
v_dot2_f32_bf16 v97, v56, v134, v97
v_dot2_f32_bf16 v98, v57, v133, v98
v_dot2_f32_bf16 v99, v57, v134, v99
v_dot2_f32_bf16 v100, v58, v133, v100
v_dot2_f32_bf16 v101, v58, v134, v101
v_dot2_f32_bf16 v102, v59, v133, v102
v_dot2_f32_bf16 v103, v59, v134, v103
v_dot2_f32_bf16 v96, v60, v133, v96
v_dot2_f32_bf16 v97, v60, v134, v97
v_dot2_f32_bf16 v98, v61, v133, v98
v_dot2_f32_bf16 v99, v61, v134, v99
v_dot2_f32_bf16 v100, v62, v133, v100
v_dot2_f32_bf16 v101, v62, v134, v101
v_dot2_f32_bf16 v102, v63, v133, v102
v_dot2_f32_bf16 v103, v63, v134, v103
s_waitcnt vmcnt(0)
v_dot2_f32_bf16 v104, v80, v133, 0
v_dot2_f32_bf16 v105, v80, v134, 0
v_dot2_f32_bf16 v104, v81, v133, v104
v_dot2_f32_bf16 v105, v81, v134, v105
v_dot2_f32_bf16 v104, v82, v133, v104
v_dot2_f32_bf16 v105, v82, v134, v105
v_dot2_f32_bf16 v104, v83, v133, v104
v_dot2_f32_bf16 v105, v83, v134, v105
v_mul_f32 v136, 0xbfb8aa3b, v88
v_mul_f32 v137, 0xbfb8aa3b, v89
v_mul_f32 v138, 0xbfb8aa3b, v90
v_mul_f32 v139, 0xbfb8aa3b, v91
v_mul_f32 v140, 0xbfb8aa3b, v92
v_mul_f32 v141, 0xbfb8aa3b, v93
v_mul_f32 v142, 0xbfb8aa3b, v94
v_mul_f32 v143, 0xbfb8aa3b, v95
v_mul_f32 v144, 0xbfb8aa3b, v96
v_mul_f32 v145, 0xbfb8aa3b, v97
v_mul_f32 v146, 0xbfb8aa3b, v98
v_mul_f32 v147, 0xbfb8aa3b, v99
v_mul_f32 v148, 0xbfb8aa3b, v100
v_mul_f32 v149, 0xbfb8aa3b, v101
v_mul_f32 v150, 0xbfb8aa3b, v102
v_mul_f32 v151, 0xbfb8aa3b, v103
v_mul_f32 v152, 0xbfb8aa3b, v104
v_mul_f32 v153, 0xbfb8aa3b, v105
v_exp_f32 v136, v136
v_exp_f32 v137, v137
v_exp_f32 v138, v138
v_exp_f32 v139, v139
v_exp_f32 v140, v140
v_exp_f32 v141, v141
v_exp_f32 v142, v142
v_exp_f32 v143, v143
v_exp_f32 v144, v144
v_exp_f32 v145, v145
v_exp_f32 v146, v146
v_exp_f32 v147, v147
v_exp_f32 v148, v148
v_exp_f32 v149, v149
v_exp_f32 v150, v150
v_exp_f32 v151, v151
v_exp_f32 v152, v152
v_exp_f32 v153, v153
v_add_f32 v136, 1.0, v136
v_add_f32 v137, 1.0, v137
v_add_f32 v138, 1.0, v138
v_add_f32 v139, 1.0, v139
v_add_f32 v140, 1.0, v140
v_add_f32 v141, 1.0, v141
v_add_f32 v142, 1.0, v142
v_add_f32 v143, 1.0, v143
v_add_f32 v144, 1.0, v144
v_add_f32 v145, 1.0, v145
v_add_f32 v146, 1.0, v146
v_add_f32 v147, 1.0, v147
v_add_f32 v148, 1.0, v148
v_add_f32 v149, 1.0, v149
v_add_f32 v150, 1.0, v150
v_add_f32 v151, 1.0, v151
v_add_f32 v152, 1.0, v152
v_add_f32 v153, 1.0, v153
v_rcp_f32 v136, v136
v_rcp_f32 v137, v137
v_rcp_f32 v138, v138
v_rcp_f32 v139, v139
v_rcp_f32 v140, v140
v_rcp_f32 v141, v141
v_rcp_f32 v142, v142
v_rcp_f32 v143, v143
v_rcp_f32 v144, v144
v_rcp_f32 v145, v145
v_rcp_f32 v146, v146
v_rcp_f32 v147, v147
v_rcp_f32 v148, v148
v_rcp_f32 v149, v149
v_rcp_f32 v150, v150
v_rcp_f32 v151, v151
v_rcp_f32 v152, v152
v_rcp_f32 v153, v153
v_mul_f32 v88, v88, v136
v_mul_f32 v89, v89, v137
v_mul_f32 v90, v90, v138
v_mul_f32 v91, v91, v139
v_mul_f32 v92, v92, v140
v_mul_f32 v93, v93, v141
v_mul_f32 v94, v94, v142
v_mul_f32 v95, v95, v143
v_mul_f32 v96, v96, v144
v_mul_f32 v97, v97, v145
v_mul_f32 v98, v98, v146
v_mul_f32 v99, v99, v147
v_mul_f32 v100, v100, v148
v_mul_f32 v101, v101, v149
v_mul_f32 v102, v102, v150
v_mul_f32 v103, v103, v151
v_mul_f32 v104, v104, v152
v_mul_f32 v105, v105, v153
s_waitcnt lgkmcnt(0)
s_mov_b32 s58, 2359296
s_mov_b32 s59, 0x20000
s_mov_b32 s71, 0x20000
buffer_load_dword v7, v6, s[8:11], s67 offen sc1
s_sleep 3
buffer_load_dword v150, v6, s[8:11], s67 offen sc1
s_sleep 3
buffer_load_dword v151, v6, s[8:11], s67 offen sc1
mk_poll_SY:
s_waitcnt vmcnt(2)
v_cmp_eq_u32 vcc, s100, v7
s_sub_u32 s71, s71, 1
s_cbranch_scc1 mk_pollx_SY
s_nop 1
s_and_b32 s43, vcc_lo, 15
s_cmp_eq_u32 s43, 15
s_cbranch_scc1 mk_pollx_SY
buffer_load_dword v7, v6, s[8:11], s67 offen sc1
s_sleep 3
s_waitcnt vmcnt(2)
v_cmp_eq_u32 vcc, s100, v150
s_sub_u32 s71, s71, 1
s_cbranch_scc1 mk_pollx_SY
s_nop 1
s_and_b32 s43, vcc_lo, 15
s_cmp_eq_u32 s43, 15
s_cbranch_scc1 mk_pollx_SY
buffer_load_dword v150, v6, s[8:11], s67 offen sc1
s_sleep 3
s_waitcnt vmcnt(2)
v_cmp_eq_u32 vcc, s100, v151
s_sub_u32 s71, s71, 1
s_cbranch_scc1 mk_pollx_SY
s_nop 1
s_and_b32 s43, vcc_lo, 15
s_cmp_eq_u32 s43, 15
s_cbranch_scc1 mk_pollx_SY
buffer_load_dword v151, v6, s[8:11], s67 offen sc1
s_sleep 3
s_branch mk_poll_SY
mk_pollx_SY:
s_add_u32 s27, s25, 50331648
buffer_load_dwordx4 v[16:19], v9, s[8:11], s27 offen sc1
s_add_u32 s27, s25, 52690944
buffer_load_dwordx4 v[20:23], v9, s[8:11], s27 offen sc1
s_add_u32 s27, s25, 55050240
buffer_load_dwordx4 v[24:27], v9, s[8:11], s27 offen sc1
s_add_u32 s27, s25, 57409536
buffer_load_dwordx4 v[28:31], v9, s[8:11], s27 offen sc1
s_add_u32 s27, s25, 50339840
buffer_load_dwordx4 v[48:51], v9, s[8:11], s27 offen sc1
s_add_u32 s27, s25, 52699136
buffer_load_dwordx4 v[52:55], v9, s[8:11], s27 offen sc1
s_add_u32 s27, s25, 55058432
buffer_load_dwordx4 v[56:59], v9, s[8:11], s27 offen sc1
s_add_u32 s27, s25, 57417728
buffer_load_dwordx4 v[60:63], v9, s[8:11], s27 offen sc1
s_add_u32 s27, s26, 50331648
buffer_load_dword v80, v9, s[8:11], s27 offen sc1
s_add_u32 s27, s26, 52690944
buffer_load_dword v81, v9, s[8:11], s27 offen sc1
s_add_u32 s27, s26, 55050240
buffer_load_dword v82, v9, s[8:11], s27 offen sc1
s_add_u32 s27, s26, 57409536
buffer_load_dword v83, v9, s[8:11], s27 offen sc1
s_waitcnt vmcnt(8)
v_dot2_f32_bf16 v106, v16, v133, 0
v_dot2_f32_bf16 v107, v16, v134, 0
v_dot2_f32_bf16 v108, v17, v133, 0
v_dot2_f32_bf16 v109, v17, v134, 0
v_dot2_f32_bf16 v110, v18, v133, 0
v_dot2_f32_bf16 v111, v18, v134, 0
v_dot2_f32_bf16 v112, v19, v133, 0
v_dot2_f32_bf16 v113, v19, v134, 0
v_dot2_f32_bf16 v106, v20, v133, v106
v_dot2_f32_bf16 v107, v20, v134, v107
v_dot2_f32_bf16 v108, v21, v133, v108
v_dot2_f32_bf16 v109, v21, v134, v109
v_dot2_f32_bf16 v110, v22, v133, v110
v_dot2_f32_bf16 v111, v22, v134, v111
v_dot2_f32_bf16 v112, v23, v133, v112
v_dot2_f32_bf16 v113, v23, v134, v113
v_dot2_f32_bf16 v106, v24, v133, v106
v_dot2_f32_bf16 v107, v24, v134, v107
v_dot2_f32_bf16 v108, v25, v133, v108
v_dot2_f32_bf16 v109, v25, v134, v109
v_dot2_f32_bf16 v110, v26, v133, v110
v_dot2_f32_bf16 v111, v26, v134, v111
v_dot2_f32_bf16 v112, v27, v133, v112
v_dot2_f32_bf16 v113, v27, v134, v113
v_dot2_f32_bf16 v106, v28, v133, v106
v_dot2_f32_bf16 v107, v28, v134, v107
v_dot2_f32_bf16 v108, v29, v133, v108
v_dot2_f32_bf16 v109, v29, v134, v109
v_dot2_f32_bf16 v110, v30, v133, v110
v_dot2_f32_bf16 v111, v30, v134, v111
v_dot2_f32_bf16 v112, v31, v133, v112
v_dot2_f32_bf16 v113, v31, v134, v113
v_fma_f32 v156, v106, v88, v156
v_fma_f32 v157, v107, v89, v157
v_fma_f32 v158, v108, v90, v158
v_fma_f32 v159, v109, v91, v159
v_fma_f32 v160, v110, v92, v160
v_fma_f32 v161, v111, v93, v161
v_fma_f32 v162, v112, v94, v162
v_fma_f32 v163, v113, v95, v163
v_cvt_pk_bf16_f32 v176, v156, v157
v_cvt_pk_bf16_f32 v177, v158, v159
v_cvt_pk_bf16_f32 v178, v160, v161
v_cvt_pk_bf16_f32 v179, v162, v163
buffer_store_dwordx2 v[176:177], v2, s[56:59], s20 offen
buffer_store_dwordx2 v[178:179], v3, s[56:59], s20 offen
s_waitcnt vmcnt(6)
v_dot2_f32_bf16 v114, v48, v133, 0
v_dot2_f32_bf16 v115, v48, v134, 0
v_dot2_f32_bf16 v116, v49, v133, 0
v_dot2_f32_bf16 v117, v49, v134, 0
v_dot2_f32_bf16 v118, v50, v133, 0
v_dot2_f32_bf16 v119, v50, v134, 0
v_dot2_f32_bf16 v120, v51, v133, 0
v_dot2_f32_bf16 v121, v51, v134, 0
v_dot2_f32_bf16 v114, v52, v133, v114
v_dot2_f32_bf16 v115, v52, v134, v115
v_dot2_f32_bf16 v116, v53, v133, v116
v_dot2_f32_bf16 v117, v53, v134, v117
v_dot2_f32_bf16 v118, v54, v133, v118
v_dot2_f32_bf16 v119, v54, v134, v119
v_dot2_f32_bf16 v120, v55, v133, v120
v_dot2_f32_bf16 v121, v55, v134, v121
v_dot2_f32_bf16 v114, v56, v133, v114
v_dot2_f32_bf16 v115, v56, v134, v115
v_dot2_f32_bf16 v116, v57, v133, v116
v_dot2_f32_bf16 v117, v57, v134, v117
v_dot2_f32_bf16 v118, v58, v133, v118
v_dot2_f32_bf16 v119, v58, v134, v119
v_dot2_f32_bf16 v120, v59, v133, v120
v_dot2_f32_bf16 v121, v59, v134, v121
v_dot2_f32_bf16 v114, v60, v133, v114
v_dot2_f32_bf16 v115, v60, v134, v115
v_dot2_f32_bf16 v116, v61, v133, v116
v_dot2_f32_bf16 v117, v61, v134, v117
v_dot2_f32_bf16 v118, v62, v133, v118
v_dot2_f32_bf16 v119, v62, v134, v119
v_dot2_f32_bf16 v120, v63, v133, v120
v_dot2_f32_bf16 v121, v63, v134, v121
v_fma_f32 v164, v114, v96, v164
v_fma_f32 v165, v115, v97, v165
v_fma_f32 v166, v116, v98, v166
v_fma_f32 v167, v117, v99, v167
v_fma_f32 v168, v118, v100, v168
v_fma_f32 v169, v119, v101, v169
v_fma_f32 v170, v120, v102, v170
v_fma_f32 v171, v121, v103, v171
v_cvt_pk_bf16_f32 v180, v164, v165
v_cvt_pk_bf16_f32 v181, v166, v167
v_cvt_pk_bf16_f32 v182, v168, v169
v_cvt_pk_bf16_f32 v183, v170, v171
buffer_store_dwordx2 v[180:181], v2, s[56:59], s21 offen
buffer_store_dwordx2 v[182:183], v3, s[56:59], s21 offen
s_waitcnt vmcnt(4)
v_dot2_f32_bf16 v122, v80, v133, 0
v_dot2_f32_bf16 v123, v80, v134, 0
v_dot2_f32_bf16 v122, v81, v133, v122
v_dot2_f32_bf16 v123, v81, v134, v123
v_dot2_f32_bf16 v122, v82, v133, v122
v_dot2_f32_bf16 v123, v82, v134, v123
v_dot2_f32_bf16 v122, v83, v133, v122
v_dot2_f32_bf16 v123, v83, v134, v123
s_nop 1
v_fma_f32 v172, v122, v104, v172
v_fma_f32 v173, v123, v105, v173
v_cvt_pk_bf16_f32 v184, v172, v173
buffer_store_dword v184, v2, s[56:59], s22 offen
s_waitcnt vmcnt(0)
s_waitcnt vmcnt(0)
s_endpgm
mk_slowN:
s_mov_b32 s71, 0x40000
mk_noncea:
global_load_dword v97, v96, s[6:7] sc1
s_waitcnt vmcnt(0)
v_readfirstlane_b32 s100, v97
s_sub_u32 s71, s71, 1
s_cbranch_scc1 mk_noncexa
s_nop 2
s_cmp_lg_u32 s100, 0
s_cbranch_scc1 mk_noncexa
s_sleep 1
s_branch mk_noncea
mk_noncexa:
s_branch mk_backN
mk_w23:
s_movk_i32 s72, 9216
v_mul_lo_u32 v176, v0, s72
s_mul_i32 s43, s29, 72
s_and_b32 s72, s28, 1
s_mul_i32 s72, s72, 36
s_add_u32 s43, s43, s72
s_mul_i32 s43, s43, 9216
s_lshl_b32 s72, s30, 8
s_add_u32 s43, s43, s72
buffer_load_dword v7, v176, s[12:15], s43 offen
buffer_load_dword v177, v176, s[56:59], s43 offen
s_sub_u32 s73, s46, 4096
s_barrier
s_add_u32 m0, s73, 98304
s_add_u32 s40, s32, 0
buffer_load_dwordx4 v181, s[56:59], s40 offen lds
s_add_u32 m0, s46, 98304
s_nop 0
buffer_load_dwordx4 v181, s[12:15], s40 offen lds
s_add_u32 m0, s73, 99328
s_add_u32 s40, s32, 73728
buffer_load_dwordx4 v181, s[56:59], s40 offen lds
s_add_u32 m0, s46, 99328
s_nop 0
buffer_load_dwordx4 v181, s[12:15], s40 offen lds
s_add_u32 m0, s73, 106496
s_add_u32 s40, s32, 294912
buffer_load_dwordx4 v181, s[56:59], s40 offen lds
s_add_u32 m0, s46, 106496
s_nop 0
buffer_load_dwordx4 v181, s[12:15], s40 offen lds
s_add_u32 m0, s73, 107520
s_add_u32 s40, s32, 368640
buffer_load_dwordx4 v181, s[56:59], s40 offen lds
s_add_u32 m0, s46, 107520
s_nop 0
buffer_load_dwordx4 v181, s[12:15], s40 offen lds
s_add_u32 m0, s73, 114688
s_add_u32 s40, s32, 589824
buffer_load_dwordx4 v181, s[56:59], s40 offen lds
s_add_u32 m0, s46, 114688
s_nop 0
buffer_load_dwordx4 v181, s[12:15], s40 offen lds
s_add_u32 m0, s73, 115712
s_add_u32 s40, s32, 663552
buffer_load_dwordx4 v181, s[56:59], s40 offen lds
s_add_u32 m0, s46, 115712
s_nop 0
buffer_load_dwordx4 v181, s[12:15], s40 offen lds
s_mov_b32 s71, 0x40000
mk_nonceb:
global_load_dword v97, v96, s[6:7] sc1
s_waitcnt vmcnt(0)
v_readfirstlane_b32 s100, v97
s_sub_u32 s71, s71, 1
s_cbranch_scc1 mk_noncexb
s_nop 2
s_cmp_lg_u32 s100, 0
s_cbranch_scc1 mk_noncexb
s_sleep 1
s_branch mk_nonceb
mk_noncexb:
s_branch mk_join
mk_fbS:
s_mov_b32 s71, m0
s_waitcnt vmcnt(0) lgkmcnt(0)
s_sub_u32 s72, s35, s46
v_and_b32 v88, 15, v0
v_lshrrev_b32 v89, 4, v0
v_lshlrev_b32 v96, 8, v88
v_lshl_add_u32 v96, v89, 4, v96
v_lshrrev_b32 v90, 2, v88
v_lshl_add_u32 v90, v89, 2, v90
v_and_b32 v91, 3, v88
v_lshlrev_b32 v91, 3, v91
v_lshl_add_u32 v97, v90, 8, v91
s_lshl_b32 s43, s28, 12
s_add_u32 s43, s43, 147456
v_add_u32 v97, s43, v97
s_mov_b32 m0, s43
v_mov_b32 v80, 0xff800000
v_mov_b32 v84, 0
v_mov_b32 v81, 0xff800000
v_mov_b32 v85, 0
v_mov_b32 v82, 0xff800000
v_mov_b32 v86, 0
v_mov_b32 v83, 0xff800000
v_mov_b32 v87, 0
s_mov_b32 s73, 0
mk_fbS_p1:
s_lshl_b32 s43, s73, 12
s_add_u32 s43, s43, s72
buffer_load_dwordx4 v[112:115], v96, s[20:23], s43 offen offset:0
buffer_load_dwordx4 v[116:119], v96, s[20:23], s43 offen offset:64
buffer_load_dwordx4 v[120:123], v96, s[20:23], s43 offen offset:128
buffer_load_dwordx4 v[124:127], v96, s[20:23], s43 offen offset:192
s_waitcnt vmcnt(0)
v_mfma_f32_16x16x32_bf16 v[144:147], v[112:115], v[192:195], 0
v_mfma_f32_16x16x32_bf16 v[148:151], v[112:115], v[196:199], 0
v_mfma_f32_16x16x32_bf16 v[152:155], v[112:115], v[200:203], 0
v_mfma_f32_16x16x32_bf16 v[156:159], v[112:115], v[204:207], 0
v_mfma_f32_16x16x32_bf16 v[144:147], v[116:119], v[208:211], v[144:147]
v_mfma_f32_16x16x32_bf16 v[148:151], v[116:119], v[212:215], v[148:151]
v_mfma_f32_16x16x32_bf16 v[152:155], v[116:119], v[216:219], v[152:155]
v_mfma_f32_16x16x32_bf16 v[156:159], v[116:119], v[220:223], v[156:159]
v_mfma_f32_16x16x32_bf16 v[144:147], v[120:123], v[224:227], v[144:147]
v_mfma_f32_16x16x32_bf16 v[148:151], v[120:123], v[228:231], v[148:151]
v_mfma_f32_16x16x32_bf16 v[152:155], v[120:123], v[232:235], v[152:155]
v_mfma_f32_16x16x32_bf16 v[156:159], v[120:123], v[236:239], v[156:159]
v_mfma_f32_16x16x32_bf16 v[144:147], v[124:127], v[240:243], v[144:147]
v_mfma_f32_16x16x32_bf16 v[148:151], v[124:127], v[244:247], v[148:151]
v_mfma_f32_16x16x32_bf16 v[152:155], v[124:127], v[248:251], v[152:155]
v_mfma_f32_16x16x32_bf16 v[156:159], v[124:127], v[252:255], v[156:159]
s_nop 15
v_max3_f32 v80, v80, v144, v145
v_max3_f32 v80, v80, v146, v147
v_max3_f32 v81, v81, v148, v149
v_max3_f32 v81, v81, v150, v151
v_max3_f32 v82, v82, v152, v153
v_max3_f32 v82, v82, v154, v155
v_max3_f32 v83, v83, v156, v157
v_max3_f32 v83, v83, v158, v159
s_add_u32 s73, s73, 1
s_cmp_lt_u32 s73, 32
s_nop 7
s_cbranch_scc1 mk_fbS_p1
v_mov_b32 v88, v80
s_nop 1
v_permlane32_swap_b32 v80, v88
s_nop 1
v_max_f32 v80, v80, v88
v_mov_b32 v88, v80
s_nop 1
v_permlane16_swap_b32 v80, v88
s_nop 1
v_max_f32 v80, v80, v88
v_mov_b32 v88, v81
s_nop 1
v_permlane32_swap_b32 v81, v88
s_nop 1
v_max_f32 v81, v81, v88
v_mov_b32 v88, v81
s_nop 1
v_permlane16_swap_b32 v81, v88
s_nop 1
v_max_f32 v81, v81, v88
v_mov_b32 v88, v82
s_nop 1
v_permlane32_swap_b32 v82, v88
s_nop 1
v_max_f32 v82, v82, v88
v_mov_b32 v88, v82
s_nop 1
v_permlane16_swap_b32 v82, v88
s_nop 1
v_max_f32 v82, v82, v88
v_mov_b32 v88, v83
s_nop 1
v_permlane32_swap_b32 v83, v88
s_nop 1
v_max_f32 v83, v83, v88
v_mov_b32 v88, v83
s_nop 1
v_permlane16_swap_b32 v83, v88
s_nop 1
v_max_f32 v83, v83, v88
v_mov_b32 v88, 0
v_accvgpr_write_b32 a0, v88
v_accvgpr_write_b32 a1, v88
v_accvgpr_write_b32 a2, v88
v_accvgpr_write_b32 a3, v88
v_accvgpr_write_b32 a4, v88
v_accvgpr_write_b32 a5, v88
v_accvgpr_write_b32 a6, v88
v_accvgpr_write_b32 a7, v88
v_accvgpr_write_b32 a8, v88
v_accvgpr_write_b32 a9, v88
v_accvgpr_write_b32 a10, v88
v_accvgpr_write_b32 a11, v88
v_accvgpr_write_b32 a12, v88
v_accvgpr_write_b32 a13, v88
v_accvgpr_write_b32 a14, v88
v_accvgpr_write_b32 a15, v88
v_accvgpr_write_b32 a16, v88
v_accvgpr_write_b32 a17, v88
v_accvgpr_write_b32 a18, v88
v_accvgpr_write_b32 a19, v88
v_accvgpr_write_b32 a20, v88
v_accvgpr_write_b32 a21, v88
v_accvgpr_write_b32 a22, v88
v_accvgpr_write_b32 a23, v88
v_accvgpr_write_b32 a24, v88
v_accvgpr_write_b32 a25, v88
v_accvgpr_write_b32 a26, v88
v_accvgpr_write_b32 a27, v88
v_accvgpr_write_b32 a28, v88
v_accvgpr_write_b32 a29, v88
v_accvgpr_write_b32 a30, v88
v_accvgpr_write_b32 a31, v88
v_accvgpr_write_b32 a32, v88
v_accvgpr_write_b32 a33, v88
v_accvgpr_write_b32 a34, v88
v_accvgpr_write_b32 a35, v88
v_accvgpr_write_b32 a36, v88
v_accvgpr_write_b32 a37, v88
v_accvgpr_write_b32 a38, v88
v_accvgpr_write_b32 a39, v88
v_accvgpr_write_b32 a40, v88
v_accvgpr_write_b32 a41, v88
v_accvgpr_write_b32 a42, v88
v_accvgpr_write_b32 a43, v88
v_accvgpr_write_b32 a44, v88
v_accvgpr_write_b32 a45, v88
v_accvgpr_write_b32 a46, v88
v_accvgpr_write_b32 a47, v88
v_accvgpr_write_b32 a48, v88
v_accvgpr_write_b32 a49, v88
v_accvgpr_write_b32 a50, v88
v_accvgpr_write_b32 a51, v88
v_accvgpr_write_b32 a52, v88
v_accvgpr_write_b32 a53, v88
v_accvgpr_write_b32 a54, v88
v_accvgpr_write_b32 a55, v88
v_accvgpr_write_b32 a56, v88
v_accvgpr_write_b32 a57, v88
v_accvgpr_write_b32 a58, v88
v_accvgpr_write_b32 a59, v88
v_accvgpr_write_b32 a60, v88
v_accvgpr_write_b32 a61, v88
v_accvgpr_write_b32 a62, v88
v_accvgpr_write_b32 a63, v88
v_accvgpr_write_b32 a64, v88
v_accvgpr_write_b32 a65, v88
v_accvgpr_write_b32 a66, v88
v_accvgpr_write_b32 a67, v88
v_accvgpr_write_b32 a68, v88
v_accvgpr_write_b32 a69, v88
v_accvgpr_write_b32 a70, v88
v_accvgpr_write_b32 a71, v88
v_accvgpr_write_b32 a72, v88
v_accvgpr_write_b32 a73, v88
v_accvgpr_write_b32 a74, v88
v_accvgpr_write_b32 a75, v88
v_accvgpr_write_b32 a76, v88
v_accvgpr_write_b32 a77, v88
v_accvgpr_write_b32 a78, v88
v_accvgpr_write_b32 a79, v88
v_accvgpr_write_b32 a80, v88
v_accvgpr_write_b32 a81, v88
v_accvgpr_write_b32 a82, v88
v_accvgpr_write_b32 a83, v88
v_accvgpr_write_b32 a84, v88
v_accvgpr_write_b32 a85, v88
v_accvgpr_write_b32 a86, v88
v_accvgpr_write_b32 a87, v88
v_accvgpr_write_b32 a88, v88
v_accvgpr_write_b32 a89, v88
v_accvgpr_write_b32 a90, v88
v_accvgpr_write_b32 a91, v88
v_accvgpr_write_b32 a92, v88
v_accvgpr_write_b32 a93, v88
v_accvgpr_write_b32 a94, v88
v_accvgpr_write_b32 a95, v88
v_accvgpr_write_b32 a96, v88
v_accvgpr_write_b32 a97, v88
v_accvgpr_write_b32 a98, v88
v_accvgpr_write_b32 a99, v88
v_accvgpr_write_b32 a100, v88
v_accvgpr_write_b32 a101, v88
v_accvgpr_write_b32 a102, v88
v_accvgpr_write_b32 a103, v88
v_accvgpr_write_b32 a104, v88
v_accvgpr_write_b32 a105, v88
v_accvgpr_write_b32 a106, v88
v_accvgpr_write_b32 a107, v88
v_accvgpr_write_b32 a108, v88
v_accvgpr_write_b32 a109, v88
v_accvgpr_write_b32 a110, v88
v_accvgpr_write_b32 a111, v88
v_accvgpr_write_b32 a112, v88
v_accvgpr_write_b32 a113, v88
v_accvgpr_write_b32 a114, v88
v_accvgpr_write_b32 a115, v88
v_accvgpr_write_b32 a116, v88
v_accvgpr_write_b32 a117, v88
v_accvgpr_write_b32 a118, v88
v_accvgpr_write_b32 a119, v88
v_accvgpr_write_b32 a120, v88
v_accvgpr_write_b32 a121, v88
v_accvgpr_write_b32 a122, v88
v_accvgpr_write_b32 a123, v88
v_accvgpr_write_b32 a124, v88
v_accvgpr_write_b32 a125, v88
v_accvgpr_write_b32 a126, v88
v_accvgpr_write_b32 a127, v88
s_mov_b32 s73, 0
mk_fbS_p2:
s_lshl_b32 s43, s73, 13
s_add_u32 s43, s43, s72
s_add_u32 s70, s43, 4096
buffer_load_dwordx4 v[112:115], v96, s[20:23], s43 offen offset:0
buffer_load_dwordx4 v[116:119], v96, s[20:23], s43 offen offset:64
buffer_load_dwordx4 v[120:123], v96, s[20:23], s43 offen offset:128
buffer_load_dwordx4 v[124:127], v96, s[20:23], s43 offen offset:192
buffer_load_dwordx4 v[128:131], v96, s[20:23], s70 offen offset:0
buffer_load_dwordx4 v[132:135], v96, s[20:23], s70 offen offset:64
buffer_load_dwordx4 v[136:139], v96, s[20:23], s70 offen offset:128
buffer_load_dwordx4 v[140:143], v96, s[20:23], s70 offen offset:192
buffer_load_dwordx4 v9, s[24:27], s43 offen offset:0 lds
buffer_load_dwordx4 v9, s[24:27], s43 offen offset:1024 lds
buffer_load_dwordx4 v9, s[24:27], s43 offen offset:2048 lds
buffer_load_dwordx4 v9, s[24:27], s43 offen offset:3072 lds
s_waitcnt vmcnt(0)
ds_read_b64_tr_b16 v[48:49], v97 offset:0
ds_read_b64_tr_b16 v[52:53], v97 offset:32
ds_read_b64_tr_b16 v[56:57], v97 offset:64
ds_read_b64_tr_b16 v[60:61], v97 offset:96
ds_read_b64_tr_b16 v[64:65], v97 offset:128
ds_read_b64_tr_b16 v[68:69], v97 offset:160
ds_read_b64_tr_b16 v[72:73], v97 offset:192
ds_read_b64_tr_b16 v[76:77], v97 offset:224
s_waitcnt lgkmcnt(0)
buffer_load_dwordx4 v9, s[24:27], s70 offen offset:0 lds
buffer_load_dwordx4 v9, s[24:27], s70 offen offset:1024 lds
buffer_load_dwordx4 v9, s[24:27], s70 offen offset:2048 lds
buffer_load_dwordx4 v9, s[24:27], s70 offen offset:3072 lds
v_mfma_f32_16x16x32_bf16 v[144:147], v[112:115], v[192:195], 0
v_mfma_f32_16x16x32_bf16 v[148:151], v[112:115], v[196:199], 0
v_mfma_f32_16x16x32_bf16 v[152:155], v[112:115], v[200:203], 0
v_mfma_f32_16x16x32_bf16 v[156:159], v[112:115], v[204:207], 0
v_mfma_f32_16x16x32_bf16 v[144:147], v[116:119], v[208:211], v[144:147]
v_mfma_f32_16x16x32_bf16 v[148:151], v[116:119], v[212:215], v[148:151]
v_mfma_f32_16x16x32_bf16 v[152:155], v[116:119], v[216:219], v[152:155]
v_mfma_f32_16x16x32_bf16 v[156:159], v[116:119], v[220:223], v[156:159]
v_mfma_f32_16x16x32_bf16 v[144:147], v[120:123], v[224:227], v[144:147]
v_mfma_f32_16x16x32_bf16 v[148:151], v[120:123], v[228:231], v[148:151]
v_mfma_f32_16x16x32_bf16 v[152:155], v[120:123], v[232:235], v[152:155]
v_mfma_f32_16x16x32_bf16 v[156:159], v[120:123], v[236:239], v[156:159]
v_mfma_f32_16x16x32_bf16 v[144:147], v[124:127], v[240:243], v[144:147]
v_mfma_f32_16x16x32_bf16 v[148:151], v[124:127], v[244:247], v[148:151]
v_mfma_f32_16x16x32_bf16 v[152:155], v[124:127], v[248:251], v[152:155]
v_mfma_f32_16x16x32_bf16 v[156:159], v[124:127], v[252:255], v[156:159]
v_mfma_f32_16x16x32_bf16 v[160:163], v[128:131], v[192:195], 0
v_mfma_f32_16x16x32_bf16 v[164:167], v[128:131], v[196:199], 0
v_mfma_f32_16x16x32_bf16 v[168:171], v[128:131], v[200:203], 0
v_mfma_f32_16x16x32_bf16 v[172:175], v[128:131], v[204:207], 0
v_mfma_f32_16x16x32_bf16 v[160:163], v[132:135], v[208:211], v[160:163]
v_mfma_f32_16x16x32_bf16 v[164:167], v[132:135], v[212:215], v[164:167]
v_mfma_f32_16x16x32_bf16 v[168:171], v[132:135], v[216:219], v[168:171]
v_mfma_f32_16x16x32_bf16 v[172:175], v[132:135], v[220:223], v[172:175]
v_mfma_f32_16x16x32_bf16 v[160:163], v[136:139], v[224:227], v[160:163]
v_mfma_f32_16x16x32_bf16 v[164:167], v[136:139], v[228:231], v[164:167]
v_mfma_f32_16x16x32_bf16 v[168:171], v[136:139], v[232:235], v[168:171]
v_mfma_f32_16x16x32_bf16 v[172:175], v[136:139], v[236:239], v[172:175]
v_mfma_f32_16x16x32_bf16 v[160:163], v[140:143], v[240:243], v[160:163]
v_mfma_f32_16x16x32_bf16 v[164:167], v[140:143], v[244:247], v[164:167]
v_mfma_f32_16x16x32_bf16 v[168:171], v[140:143], v[248:251], v[168:171]
v_mfma_f32_16x16x32_bf16 v[172:175], v[140:143], v[252:255], v[172:175]
s_waitcnt vmcnt(0)
ds_read_b64_tr_b16 v[50:51], v97 offset:0
ds_read_b64_tr_b16 v[54:55], v97 offset:32
ds_read_b64_tr_b16 v[58:59], v97 offset:64
ds_read_b64_tr_b16 v[62:63], v97 offset:96
ds_read_b64_tr_b16 v[66:67], v97 offset:128
ds_read_b64_tr_b16 v[70:71], v97 offset:160
ds_read_b64_tr_b16 v[74:75], v97 offset:192
ds_read_b64_tr_b16 v[78:79], v97 offset:224
s_nop 15
v_sub_f32 v144, v144, v80
v_sub_f32 v145, v145, v80
v_sub_f32 v146, v146, v80
v_sub_f32 v147, v147, v80
v_exp_f32 v144, v144
v_exp_f32 v145, v145
v_exp_f32 v146, v146
v_exp_f32 v147, v147
s_nop 0
v_add_f32 v84, v84, v144
v_add_f32 v84, v84, v145
v_add_f32 v84, v84, v146
v_add_f32 v84, v84, v147
v_cvt_pk_bf16_f32 v176, v144, v145
v_cvt_pk_bf16_f32 v177, v146, v147
v_sub_f32 v148, v148, v81
v_sub_f32 v149, v149, v81
v_sub_f32 v150, v150, v81
v_sub_f32 v151, v151, v81
v_exp_f32 v148, v148
v_exp_f32 v149, v149
v_exp_f32 v150, v150
v_exp_f32 v151, v151
s_nop 0
v_add_f32 v85, v85, v148
v_add_f32 v85, v85, v149
v_add_f32 v85, v85, v150
v_add_f32 v85, v85, v151
v_cvt_pk_bf16_f32 v180, v148, v149
v_cvt_pk_bf16_f32 v181, v150, v151
v_sub_f32 v152, v152, v82
v_sub_f32 v153, v153, v82
v_sub_f32 v154, v154, v82
v_sub_f32 v155, v155, v82
v_exp_f32 v152, v152
v_exp_f32 v153, v153
v_exp_f32 v154, v154
v_exp_f32 v155, v155
s_nop 0
v_add_f32 v86, v86, v152
v_add_f32 v86, v86, v153
v_add_f32 v86, v86, v154
v_add_f32 v86, v86, v155
v_cvt_pk_bf16_f32 v184, v152, v153
v_cvt_pk_bf16_f32 v185, v154, v155
v_sub_f32 v156, v156, v83
v_sub_f32 v157, v157, v83
v_sub_f32 v158, v158, v83
v_sub_f32 v159, v159, v83
v_exp_f32 v156, v156
v_exp_f32 v157, v157
v_exp_f32 v158, v158
v_exp_f32 v159, v159
s_nop 0
v_add_f32 v87, v87, v156
v_add_f32 v87, v87, v157
v_add_f32 v87, v87, v158
v_add_f32 v87, v87, v159
v_cvt_pk_bf16_f32 v188, v156, v157
v_cvt_pk_bf16_f32 v189, v158, v159
v_sub_f32 v160, v160, v80
v_sub_f32 v161, v161, v80
v_sub_f32 v162, v162, v80
v_sub_f32 v163, v163, v80
v_exp_f32 v160, v160
v_exp_f32 v161, v161
v_exp_f32 v162, v162
v_exp_f32 v163, v163
s_nop 0
v_add_f32 v84, v84, v160
v_add_f32 v84, v84, v161
v_add_f32 v84, v84, v162
v_add_f32 v84, v84, v163
v_cvt_pk_bf16_f32 v178, v160, v161
v_cvt_pk_bf16_f32 v179, v162, v163
v_sub_f32 v164, v164, v81
v_sub_f32 v165, v165, v81
v_sub_f32 v166, v166, v81
v_sub_f32 v167, v167, v81
v_exp_f32 v164, v164
v_exp_f32 v165, v165
v_exp_f32 v166, v166
v_exp_f32 v167, v167
s_nop 0
v_add_f32 v85, v85, v164
v_add_f32 v85, v85, v165
v_add_f32 v85, v85, v166
v_add_f32 v85, v85, v167
v_cvt_pk_bf16_f32 v182, v164, v165
v_cvt_pk_bf16_f32 v183, v166, v167
v_sub_f32 v168, v168, v82
v_sub_f32 v169, v169, v82
v_sub_f32 v170, v170, v82
v_sub_f32 v171, v171, v82
v_exp_f32 v168, v168
v_exp_f32 v169, v169
v_exp_f32 v170, v170
v_exp_f32 v171, v171
s_nop 0
v_add_f32 v86, v86, v168
v_add_f32 v86, v86, v169
v_add_f32 v86, v86, v170
v_add_f32 v86, v86, v171
v_cvt_pk_bf16_f32 v186, v168, v169
v_cvt_pk_bf16_f32 v187, v170, v171
v_sub_f32 v172, v172, v83
v_sub_f32 v173, v173, v83
v_sub_f32 v174, v174, v83
v_sub_f32 v175, v175, v83
v_exp_f32 v172, v172
v_exp_f32 v173, v173
v_exp_f32 v174, v174
v_exp_f32 v175, v175
s_nop 0
v_add_f32 v87, v87, v172
v_add_f32 v87, v87, v173
v_add_f32 v87, v87, v174
v_add_f32 v87, v87, v175
v_cvt_pk_bf16_f32 v190, v172, v173
v_cvt_pk_bf16_f32 v191, v174, v175
s_waitcnt lgkmcnt(0)
s_nop 1
v_mfma_f32_16x16x32_bf16 a[0:3], v[48:51], v[176:179], a[0:3]
v_mfma_f32_16x16x32_bf16 a[4:7], v[48:51], v[180:183], a[4:7]
v_mfma_f32_16x16x32_bf16 a[8:11], v[48:51], v[184:187], a[8:11]
v_mfma_f32_16x16x32_bf16 a[12:15], v[48:51], v[188:191], a[12:15]
v_mfma_f32_16x16x32_bf16 a[16:19], v[52:55], v[176:179], a[16:19]
v_mfma_f32_16x16x32_bf16 a[20:23], v[52:55], v[180:183], a[20:23]
v_mfma_f32_16x16x32_bf16 a[24:27], v[52:55], v[184:187], a[24:27]
v_mfma_f32_16x16x32_bf16 a[28:31], v[52:55], v[188:191], a[28:31]
v_mfma_f32_16x16x32_bf16 a[32:35], v[56:59], v[176:179], a[32:35]
v_mfma_f32_16x16x32_bf16 a[36:39], v[56:59], v[180:183], a[36:39]
v_mfma_f32_16x16x32_bf16 a[40:43], v[56:59], v[184:187], a[40:43]
v_mfma_f32_16x16x32_bf16 a[44:47], v[56:59], v[188:191], a[44:47]
v_mfma_f32_16x16x32_bf16 a[48:51], v[60:63], v[176:179], a[48:51]
v_mfma_f32_16x16x32_bf16 a[52:55], v[60:63], v[180:183], a[52:55]
v_mfma_f32_16x16x32_bf16 a[56:59], v[60:63], v[184:187], a[56:59]
v_mfma_f32_16x16x32_bf16 a[60:63], v[60:63], v[188:191], a[60:63]
v_mfma_f32_16x16x32_bf16 a[64:67], v[64:67], v[176:179], a[64:67]
v_mfma_f32_16x16x32_bf16 a[68:71], v[64:67], v[180:183], a[68:71]
v_mfma_f32_16x16x32_bf16 a[72:75], v[64:67], v[184:187], a[72:75]
v_mfma_f32_16x16x32_bf16 a[76:79], v[64:67], v[188:191], a[76:79]
v_mfma_f32_16x16x32_bf16 a[80:83], v[68:71], v[176:179], a[80:83]
v_mfma_f32_16x16x32_bf16 a[84:87], v[68:71], v[180:183], a[84:87]
v_mfma_f32_16x16x32_bf16 a[88:91], v[68:71], v[184:187], a[88:91]
v_mfma_f32_16x16x32_bf16 a[92:95], v[68:71], v[188:191], a[92:95]
v_mfma_f32_16x16x32_bf16 a[96:99], v[72:75], v[176:179], a[96:99]
v_mfma_f32_16x16x32_bf16 a[100:103], v[72:75], v[180:183], a[100:103]
v_mfma_f32_16x16x32_bf16 a[104:107], v[72:75], v[184:187], a[104:107]
v_mfma_f32_16x16x32_bf16 a[108:111], v[72:75], v[188:191], a[108:111]
v_mfma_f32_16x16x32_bf16 a[112:115], v[76:79], v[176:179], a[112:115]
v_mfma_f32_16x16x32_bf16 a[116:119], v[76:79], v[180:183], a[116:119]
v_mfma_f32_16x16x32_bf16 a[120:123], v[76:79], v[184:187], a[120:123]
v_mfma_f32_16x16x32_bf16 a[124:127], v[76:79], v[188:191], a[124:127]
s_add_u32 s73, s73, 1
s_cmp_lt_u32 s73, 16
s_nop 15
s_cbranch_scc1 mk_fbS_p2
v_mov_b32 v88, v84
s_nop 1
v_permlane32_swap_b32 v84, v88
s_nop 1
v_add_f32 v84, v84, v88
v_mov_b32 v88, v84
s_nop 1
v_permlane16_swap_b32 v84, v88
s_nop 1
v_add_f32 v84, v84, v88
v_mov_b32 v88, v85
s_nop 1
v_permlane32_swap_b32 v85, v88
s_nop 1
v_add_f32 v85, v85, v88
v_mov_b32 v88, v85
s_nop 1
v_permlane16_swap_b32 v85, v88
s_nop 1
v_add_f32 v85, v85, v88
v_mov_b32 v88, v86
s_nop 1
v_permlane32_swap_b32 v86, v88
s_nop 1
v_add_f32 v86, v86, v88
v_mov_b32 v88, v86
s_nop 1
v_permlane16_swap_b32 v86, v88
s_nop 1
v_add_f32 v86, v86, v88
v_mov_b32 v88, v87
s_nop 1
v_permlane32_swap_b32 v87, v88
s_nop 1
v_add_f32 v87, v87, v88
v_mov_b32 v88, v87
s_nop 1
v_permlane16_swap_b32 v87, v88
s_nop 1
v_add_f32 v87, v87, v88
v_rcp_f32 v4, v84
v_rcp_f32 v5, v85
v_rcp_f32 v6, v86
v_rcp_f32 v7, v87
s_nop 7
v_accvgpr_read_b32 v40, a0
v_accvgpr_read_b32 v41, a1
v_accvgpr_read_b32 v42, a2
v_accvgpr_read_b32 v43, a3
v_accvgpr_read_b32 v44, a16
v_accvgpr_read_b32 v45, a17
v_accvgpr_read_b32 v46, a18
v_accvgpr_read_b32 v47, a19
v_mul_f32 v40, v40, v4
v_mul_f32 v41, v41, v4
v_mul_f32 v42, v42, v4
v_mul_f32 v43, v43, v4
v_mul_f32 v44, v44, v4
v_mul_f32 v45, v45, v4
v_mul_f32 v46, v46, v4
v_mul_f32 v47, v47, v4
v_cvt_pk_bf16_f32 v48, v40, v41
v_cvt_pk_bf16_f32 v49, v42, v43
v_cvt_pk_bf16_f32 v50, v44, v45
v_cvt_pk_bf16_f32 v51, v46, v47
v_accvgpr_read_b32 v40, a4
v_accvgpr_read_b32 v41, a5
v_accvgpr_read_b32 v42, a6
v_accvgpr_read_b32 v43, a7
v_accvgpr_read_b32 v44, a20
v_accvgpr_read_b32 v45, a21
v_accvgpr_read_b32 v46, a22
v_accvgpr_read_b32 v47, a23
v_mul_f32 v40, v40, v5
v_mul_f32 v41, v41, v5
v_mul_f32 v42, v42, v5
v_mul_f32 v43, v43, v5
v_mul_f32 v44, v44, v5
v_mul_f32 v45, v45, v5
v_mul_f32 v46, v46, v5
v_mul_f32 v47, v47, v5
v_cvt_pk_bf16_f32 v52, v40, v41
v_cvt_pk_bf16_f32 v53, v42, v43
v_cvt_pk_bf16_f32 v54, v44, v45
v_cvt_pk_bf16_f32 v55, v46, v47
v_accvgpr_read_b32 v40, a8
v_accvgpr_read_b32 v41, a9
v_accvgpr_read_b32 v42, a10
v_accvgpr_read_b32 v43, a11
v_accvgpr_read_b32 v44, a24
v_accvgpr_read_b32 v45, a25
v_accvgpr_read_b32 v46, a26
v_accvgpr_read_b32 v47, a27
v_mul_f32 v40, v40, v6
v_mul_f32 v41, v41, v6
v_mul_f32 v42, v42, v6
v_mul_f32 v43, v43, v6
v_mul_f32 v44, v44, v6
v_mul_f32 v45, v45, v6
v_mul_f32 v46, v46, v6
v_mul_f32 v47, v47, v6
v_cvt_pk_bf16_f32 v56, v40, v41
v_cvt_pk_bf16_f32 v57, v42, v43
v_cvt_pk_bf16_f32 v58, v44, v45
v_cvt_pk_bf16_f32 v59, v46, v47
v_accvgpr_read_b32 v40, a12
v_accvgpr_read_b32 v41, a13
v_accvgpr_read_b32 v42, a14
v_accvgpr_read_b32 v43, a15
v_accvgpr_read_b32 v44, a28
v_accvgpr_read_b32 v45, a29
v_accvgpr_read_b32 v46, a30
v_accvgpr_read_b32 v47, a31
v_mul_f32 v40, v40, v7
v_mul_f32 v41, v41, v7
v_mul_f32 v42, v42, v7
v_mul_f32 v43, v43, v7
v_mul_f32 v44, v44, v7
v_mul_f32 v45, v45, v7
v_mul_f32 v46, v46, v7
v_mul_f32 v47, v47, v7
v_cvt_pk_bf16_f32 v60, v40, v41
v_cvt_pk_bf16_f32 v61, v42, v43
v_cvt_pk_bf16_f32 v62, v44, v45
v_cvt_pk_bf16_f32 v63, v46, v47
s_mov_b32 m0, s71
s_branch mk_fbbackS
mk_slowO2:
s_mov_b32 s71, 0x40000
mk_poll_O2:
buffer_load_dword v7, v6, s[8:11], s66 offen sc1
s_waitcnt vmcnt(0)
v_cmp_eq_u32 vcc, s100, v7
s_sub_u32 s71, s71, 1
s_cbranch_scc1 mk_pollx_O2
s_nop 1
s_and_b32 s43, vcc_lo, s73
s_cmp_eq_u32 s43, s73
s_cbranch_scc1 mk_pollx_O2
s_sleep 1
s_branch mk_poll_O2
mk_pollx_O2:
s_branch mk_backO2
mk_slowYS:
s_mov_b32 s71, 0x40000
mk_poll_YS:
buffer_load_dword v7, v6, s[8:11], s67 offen sc1
s_waitcnt vmcnt(0)
v_cmp_eq_u32 vcc, s100, v7
s_sub_u32 s71, s71, 1
s_cbranch_scc1 mk_pollx_YS
s_nop 1
s_and_b32 s43, vcc_lo, 240
s_cmp_eq_u32 s43, 240
s_cbranch_scc1 mk_pollx_YS
s_sleep 1
s_branch mk_poll_YS
mk_pollx_YS:
s_branch mk_backYS
mk_fbY:
s_mov_b32 s71, m0
s_waitcnt vmcnt(0) lgkmcnt(0)
s_sub_u32 s72, s35, s46
v_and_b32 v88, 15, v0
v_lshrrev_b32 v89, 4, v0
v_lshlrev_b32 v96, 8, v88
v_lshl_add_u32 v96, v89, 4, v96
v_lshrrev_b32 v90, 2, v88
v_lshl_add_u32 v90, v89, 2, v90
v_and_b32 v91, 3, v88
v_lshlrev_b32 v91, 3, v91
v_lshl_add_u32 v97, v90, 8, v91
s_lshl_b32 s43, s28, 12
s_add_u32 s43, s43, 147456
v_add_u32 v97, s43, v97
s_mov_b32 m0, s43
v_mov_b32 v80, 0xff800000
v_mov_b32 v84, 0
v_mov_b32 v81, 0xff800000
v_mov_b32 v85, 0
v_mov_b32 v82, 0xff800000
v_mov_b32 v86, 0
v_mov_b32 v83, 0xff800000
v_mov_b32 v87, 0
s_mov_b32 s73, 0
mk_fbY_p1:
s_lshl_b32 s43, s73, 12
s_add_u32 s43, s43, s72
buffer_load_dwordx4 v[112:115], v96, s[20:23], s43 offen offset:0
buffer_load_dwordx4 v[116:119], v96, s[20:23], s43 offen offset:64
buffer_load_dwordx4 v[120:123], v96, s[20:23], s43 offen offset:128
buffer_load_dwordx4 v[124:127], v96, s[20:23], s43 offen offset:192
s_waitcnt vmcnt(0)
v_mfma_f32_16x16x32_bf16 v[144:147], v[112:115], v[192:195], 0
v_mfma_f32_16x16x32_bf16 v[148:151], v[112:115], v[196:199], 0
v_mfma_f32_16x16x32_bf16 v[152:155], v[112:115], v[200:203], 0
v_mfma_f32_16x16x32_bf16 v[156:159], v[112:115], v[204:207], 0
v_mfma_f32_16x16x32_bf16 v[144:147], v[116:119], v[208:211], v[144:147]
v_mfma_f32_16x16x32_bf16 v[148:151], v[116:119], v[212:215], v[148:151]
v_mfma_f32_16x16x32_bf16 v[152:155], v[116:119], v[216:219], v[152:155]
v_mfma_f32_16x16x32_bf16 v[156:159], v[116:119], v[220:223], v[156:159]
v_mfma_f32_16x16x32_bf16 v[144:147], v[120:123], v[224:227], v[144:147]
v_mfma_f32_16x16x32_bf16 v[148:151], v[120:123], v[228:231], v[148:151]
v_mfma_f32_16x16x32_bf16 v[152:155], v[120:123], v[232:235], v[152:155]
v_mfma_f32_16x16x32_bf16 v[156:159], v[120:123], v[236:239], v[156:159]
v_mfma_f32_16x16x32_bf16 v[144:147], v[124:127], v[240:243], v[144:147]
v_mfma_f32_16x16x32_bf16 v[148:151], v[124:127], v[244:247], v[148:151]
v_mfma_f32_16x16x32_bf16 v[152:155], v[124:127], v[248:251], v[152:155]
v_mfma_f32_16x16x32_bf16 v[156:159], v[124:127], v[252:255], v[156:159]
s_nop 15
v_max3_f32 v80, v80, v144, v145
v_max3_f32 v80, v80, v146, v147
v_max3_f32 v81, v81, v148, v149
v_max3_f32 v81, v81, v150, v151
v_max3_f32 v82, v82, v152, v153
v_max3_f32 v82, v82, v154, v155
v_max3_f32 v83, v83, v156, v157
v_max3_f32 v83, v83, v158, v159
s_add_u32 s73, s73, 1
s_cmp_lt_u32 s73, 32
s_nop 7
s_cbranch_scc1 mk_fbY_p1
v_mov_b32 v88, v80
s_nop 1
v_permlane32_swap_b32 v80, v88
s_nop 1
v_max_f32 v80, v80, v88
v_mov_b32 v88, v80
s_nop 1
v_permlane16_swap_b32 v80, v88
s_nop 1
v_max_f32 v80, v80, v88
v_mov_b32 v88, v81
s_nop 1
v_permlane32_swap_b32 v81, v88
s_nop 1
v_max_f32 v81, v81, v88
v_mov_b32 v88, v81
s_nop 1
v_permlane16_swap_b32 v81, v88
s_nop 1
v_max_f32 v81, v81, v88
v_mov_b32 v88, v82
s_nop 1
v_permlane32_swap_b32 v82, v88
s_nop 1
v_max_f32 v82, v82, v88
v_mov_b32 v88, v82
s_nop 1
v_permlane16_swap_b32 v82, v88
s_nop 1
v_max_f32 v82, v82, v88
v_mov_b32 v88, v83
s_nop 1
v_permlane32_swap_b32 v83, v88
s_nop 1
v_max_f32 v83, v83, v88
v_mov_b32 v88, v83
s_nop 1
v_permlane16_swap_b32 v83, v88
s_nop 1
v_max_f32 v83, v83, v88
v_mov_b32 v88, 0
v_accvgpr_write_b32 a0, v88
v_accvgpr_write_b32 a1, v88
v_accvgpr_write_b32 a2, v88
v_accvgpr_write_b32 a3, v88
v_accvgpr_write_b32 a4, v88
v_accvgpr_write_b32 a5, v88
v_accvgpr_write_b32 a6, v88
v_accvgpr_write_b32 a7, v88
v_accvgpr_write_b32 a8, v88
v_accvgpr_write_b32 a9, v88
v_accvgpr_write_b32 a10, v88
v_accvgpr_write_b32 a11, v88
v_accvgpr_write_b32 a12, v88
v_accvgpr_write_b32 a13, v88
v_accvgpr_write_b32 a14, v88
v_accvgpr_write_b32 a15, v88
v_accvgpr_write_b32 a16, v88
v_accvgpr_write_b32 a17, v88
v_accvgpr_write_b32 a18, v88
v_accvgpr_write_b32 a19, v88
v_accvgpr_write_b32 a20, v88
v_accvgpr_write_b32 a21, v88
v_accvgpr_write_b32 a22, v88
v_accvgpr_write_b32 a23, v88
v_accvgpr_write_b32 a24, v88
v_accvgpr_write_b32 a25, v88
v_accvgpr_write_b32 a26, v88
v_accvgpr_write_b32 a27, v88
v_accvgpr_write_b32 a28, v88
v_accvgpr_write_b32 a29, v88
v_accvgpr_write_b32 a30, v88
v_accvgpr_write_b32 a31, v88
v_accvgpr_write_b32 a32, v88
v_accvgpr_write_b32 a33, v88
v_accvgpr_write_b32 a34, v88
v_accvgpr_write_b32 a35, v88
v_accvgpr_write_b32 a36, v88
v_accvgpr_write_b32 a37, v88
v_accvgpr_write_b32 a38, v88
v_accvgpr_write_b32 a39, v88
v_accvgpr_write_b32 a40, v88
v_accvgpr_write_b32 a41, v88
v_accvgpr_write_b32 a42, v88
v_accvgpr_write_b32 a43, v88
v_accvgpr_write_b32 a44, v88
v_accvgpr_write_b32 a45, v88
v_accvgpr_write_b32 a46, v88
v_accvgpr_write_b32 a47, v88
v_accvgpr_write_b32 a48, v88
v_accvgpr_write_b32 a49, v88
v_accvgpr_write_b32 a50, v88
v_accvgpr_write_b32 a51, v88
v_accvgpr_write_b32 a52, v88
v_accvgpr_write_b32 a53, v88
v_accvgpr_write_b32 a54, v88
v_accvgpr_write_b32 a55, v88
v_accvgpr_write_b32 a56, v88
v_accvgpr_write_b32 a57, v88
v_accvgpr_write_b32 a58, v88
v_accvgpr_write_b32 a59, v88
v_accvgpr_write_b32 a60, v88
v_accvgpr_write_b32 a61, v88
v_accvgpr_write_b32 a62, v88
v_accvgpr_write_b32 a63, v88
v_accvgpr_write_b32 a64, v88
v_accvgpr_write_b32 a65, v88
v_accvgpr_write_b32 a66, v88
v_accvgpr_write_b32 a67, v88
v_accvgpr_write_b32 a68, v88
v_accvgpr_write_b32 a69, v88
v_accvgpr_write_b32 a70, v88
v_accvgpr_write_b32 a71, v88
v_accvgpr_write_b32 a72, v88
v_accvgpr_write_b32 a73, v88
v_accvgpr_write_b32 a74, v88
v_accvgpr_write_b32 a75, v88
v_accvgpr_write_b32 a76, v88
v_accvgpr_write_b32 a77, v88
v_accvgpr_write_b32 a78, v88
v_accvgpr_write_b32 a79, v88
v_accvgpr_write_b32 a80, v88
v_accvgpr_write_b32 a81, v88
v_accvgpr_write_b32 a82, v88
v_accvgpr_write_b32 a83, v88
v_accvgpr_write_b32 a84, v88
v_accvgpr_write_b32 a85, v88
v_accvgpr_write_b32 a86, v88
v_accvgpr_write_b32 a87, v88
v_accvgpr_write_b32 a88, v88
v_accvgpr_write_b32 a89, v88
v_accvgpr_write_b32 a90, v88
v_accvgpr_write_b32 a91, v88
v_accvgpr_write_b32 a92, v88
v_accvgpr_write_b32 a93, v88
v_accvgpr_write_b32 a94, v88
v_accvgpr_write_b32 a95, v88
v_accvgpr_write_b32 a96, v88
v_accvgpr_write_b32 a97, v88
v_accvgpr_write_b32 a98, v88
v_accvgpr_write_b32 a99, v88
v_accvgpr_write_b32 a100, v88
v_accvgpr_write_b32 a101, v88
v_accvgpr_write_b32 a102, v88
v_accvgpr_write_b32 a103, v88
v_accvgpr_write_b32 a104, v88
v_accvgpr_write_b32 a105, v88
v_accvgpr_write_b32 a106, v88
v_accvgpr_write_b32 a107, v88
v_accvgpr_write_b32 a108, v88
v_accvgpr_write_b32 a109, v88
v_accvgpr_write_b32 a110, v88
v_accvgpr_write_b32 a111, v88
v_accvgpr_write_b32 a112, v88
v_accvgpr_write_b32 a113, v88
v_accvgpr_write_b32 a114, v88
v_accvgpr_write_b32 a115, v88
v_accvgpr_write_b32 a116, v88
v_accvgpr_write_b32 a117, v88
v_accvgpr_write_b32 a118, v88
v_accvgpr_write_b32 a119, v88
v_accvgpr_write_b32 a120, v88
v_accvgpr_write_b32 a121, v88
v_accvgpr_write_b32 a122, v88
v_accvgpr_write_b32 a123, v88
v_accvgpr_write_b32 a124, v88
v_accvgpr_write_b32 a125, v88
v_accvgpr_write_b32 a126, v88
v_accvgpr_write_b32 a127, v88
s_mov_b32 s73, 0
mk_fbY_p2:
s_lshl_b32 s43, s73, 13
s_add_u32 s43, s43, s72
s_add_u32 s70, s43, 4096
buffer_load_dwordx4 v[112:115], v96, s[20:23], s43 offen offset:0
buffer_load_dwordx4 v[116:119], v96, s[20:23], s43 offen offset:64
buffer_load_dwordx4 v[120:123], v96, s[20:23], s43 offen offset:128
buffer_load_dwordx4 v[124:127], v96, s[20:23], s43 offen offset:192
buffer_load_dwordx4 v[128:131], v96, s[20:23], s70 offen offset:0
buffer_load_dwordx4 v[132:135], v96, s[20:23], s70 offen offset:64
buffer_load_dwordx4 v[136:139], v96, s[20:23], s70 offen offset:128
buffer_load_dwordx4 v[140:143], v96, s[20:23], s70 offen offset:192
buffer_load_dwordx4 v9, s[24:27], s43 offen offset:0 lds
buffer_load_dwordx4 v9, s[24:27], s43 offen offset:1024 lds
buffer_load_dwordx4 v9, s[24:27], s43 offen offset:2048 lds
buffer_load_dwordx4 v9, s[24:27], s43 offen offset:3072 lds
s_waitcnt vmcnt(0)
ds_read_b64_tr_b16 v[48:49], v97 offset:0
ds_read_b64_tr_b16 v[52:53], v97 offset:32
ds_read_b64_tr_b16 v[56:57], v97 offset:64
ds_read_b64_tr_b16 v[60:61], v97 offset:96
ds_read_b64_tr_b16 v[64:65], v97 offset:128
ds_read_b64_tr_b16 v[68:69], v97 offset:160
ds_read_b64_tr_b16 v[72:73], v97 offset:192
ds_read_b64_tr_b16 v[76:77], v97 offset:224
s_waitcnt lgkmcnt(0)
buffer_load_dwordx4 v9, s[24:27], s70 offen offset:0 lds
buffer_load_dwordx4 v9, s[24:27], s70 offen offset:1024 lds
buffer_load_dwordx4 v9, s[24:27], s70 offen offset:2048 lds
buffer_load_dwordx4 v9, s[24:27], s70 offen offset:3072 lds
v_mfma_f32_16x16x32_bf16 v[144:147], v[112:115], v[192:195], 0
v_mfma_f32_16x16x32_bf16 v[148:151], v[112:115], v[196:199], 0
v_mfma_f32_16x16x32_bf16 v[152:155], v[112:115], v[200:203], 0
v_mfma_f32_16x16x32_bf16 v[156:159], v[112:115], v[204:207], 0
v_mfma_f32_16x16x32_bf16 v[144:147], v[116:119], v[208:211], v[144:147]
v_mfma_f32_16x16x32_bf16 v[148:151], v[116:119], v[212:215], v[148:151]
v_mfma_f32_16x16x32_bf16 v[152:155], v[116:119], v[216:219], v[152:155]
v_mfma_f32_16x16x32_bf16 v[156:159], v[116:119], v[220:223], v[156:159]
v_mfma_f32_16x16x32_bf16 v[144:147], v[120:123], v[224:227], v[144:147]
v_mfma_f32_16x16x32_bf16 v[148:151], v[120:123], v[228:231], v[148:151]
v_mfma_f32_16x16x32_bf16 v[152:155], v[120:123], v[232:235], v[152:155]
v_mfma_f32_16x16x32_bf16 v[156:159], v[120:123], v[236:239], v[156:159]
v_mfma_f32_16x16x32_bf16 v[144:147], v[124:127], v[240:243], v[144:147]
v_mfma_f32_16x16x32_bf16 v[148:151], v[124:127], v[244:247], v[148:151]
v_mfma_f32_16x16x32_bf16 v[152:155], v[124:127], v[248:251], v[152:155]
v_mfma_f32_16x16x32_bf16 v[156:159], v[124:127], v[252:255], v[156:159]
v_mfma_f32_16x16x32_bf16 v[160:163], v[128:131], v[192:195], 0
v_mfma_f32_16x16x32_bf16 v[164:167], v[128:131], v[196:199], 0
v_mfma_f32_16x16x32_bf16 v[168:171], v[128:131], v[200:203], 0
v_mfma_f32_16x16x32_bf16 v[172:175], v[128:131], v[204:207], 0
v_mfma_f32_16x16x32_bf16 v[160:163], v[132:135], v[208:211], v[160:163]
v_mfma_f32_16x16x32_bf16 v[164:167], v[132:135], v[212:215], v[164:167]
v_mfma_f32_16x16x32_bf16 v[168:171], v[132:135], v[216:219], v[168:171]
v_mfma_f32_16x16x32_bf16 v[172:175], v[132:135], v[220:223], v[172:175]
v_mfma_f32_16x16x32_bf16 v[160:163], v[136:139], v[224:227], v[160:163]
v_mfma_f32_16x16x32_bf16 v[164:167], v[136:139], v[228:231], v[164:167]
v_mfma_f32_16x16x32_bf16 v[168:171], v[136:139], v[232:235], v[168:171]
v_mfma_f32_16x16x32_bf16 v[172:175], v[136:139], v[236:239], v[172:175]
v_mfma_f32_16x16x32_bf16 v[160:163], v[140:143], v[240:243], v[160:163]
v_mfma_f32_16x16x32_bf16 v[164:167], v[140:143], v[244:247], v[164:167]
v_mfma_f32_16x16x32_bf16 v[168:171], v[140:143], v[248:251], v[168:171]
v_mfma_f32_16x16x32_bf16 v[172:175], v[140:143], v[252:255], v[172:175]
s_waitcnt vmcnt(0)
ds_read_b64_tr_b16 v[50:51], v97 offset:0
ds_read_b64_tr_b16 v[54:55], v97 offset:32
ds_read_b64_tr_b16 v[58:59], v97 offset:64
ds_read_b64_tr_b16 v[62:63], v97 offset:96
ds_read_b64_tr_b16 v[66:67], v97 offset:128
ds_read_b64_tr_b16 v[70:71], v97 offset:160
ds_read_b64_tr_b16 v[74:75], v97 offset:192
ds_read_b64_tr_b16 v[78:79], v97 offset:224
s_nop 15
v_sub_f32 v144, v144, v80
v_sub_f32 v145, v145, v80
v_sub_f32 v146, v146, v80
v_sub_f32 v147, v147, v80
v_exp_f32 v144, v144
v_exp_f32 v145, v145
v_exp_f32 v146, v146
v_exp_f32 v147, v147
s_nop 0
v_add_f32 v84, v84, v144
v_add_f32 v84, v84, v145
v_add_f32 v84, v84, v146
v_add_f32 v84, v84, v147
v_cvt_pk_bf16_f32 v176, v144, v145
v_cvt_pk_bf16_f32 v177, v146, v147
v_sub_f32 v148, v148, v81
v_sub_f32 v149, v149, v81
v_sub_f32 v150, v150, v81
v_sub_f32 v151, v151, v81
v_exp_f32 v148, v148
v_exp_f32 v149, v149
v_exp_f32 v150, v150
v_exp_f32 v151, v151
s_nop 0
v_add_f32 v85, v85, v148
v_add_f32 v85, v85, v149
v_add_f32 v85, v85, v150
v_add_f32 v85, v85, v151
v_cvt_pk_bf16_f32 v180, v148, v149
v_cvt_pk_bf16_f32 v181, v150, v151
v_sub_f32 v152, v152, v82
v_sub_f32 v153, v153, v82
v_sub_f32 v154, v154, v82
v_sub_f32 v155, v155, v82
v_exp_f32 v152, v152
v_exp_f32 v153, v153
v_exp_f32 v154, v154
v_exp_f32 v155, v155
s_nop 0
v_add_f32 v86, v86, v152
v_add_f32 v86, v86, v153
v_add_f32 v86, v86, v154
v_add_f32 v86, v86, v155
v_cvt_pk_bf16_f32 v184, v152, v153
v_cvt_pk_bf16_f32 v185, v154, v155
v_sub_f32 v156, v156, v83
v_sub_f32 v157, v157, v83
v_sub_f32 v158, v158, v83
v_sub_f32 v159, v159, v83
v_exp_f32 v156, v156
v_exp_f32 v157, v157
v_exp_f32 v158, v158
v_exp_f32 v159, v159
s_nop 0
v_add_f32 v87, v87, v156
v_add_f32 v87, v87, v157
v_add_f32 v87, v87, v158
v_add_f32 v87, v87, v159
v_cvt_pk_bf16_f32 v188, v156, v157
v_cvt_pk_bf16_f32 v189, v158, v159
v_sub_f32 v160, v160, v80
v_sub_f32 v161, v161, v80
v_sub_f32 v162, v162, v80
v_sub_f32 v163, v163, v80
v_exp_f32 v160, v160
v_exp_f32 v161, v161
v_exp_f32 v162, v162
v_exp_f32 v163, v163
s_nop 0
v_add_f32 v84, v84, v160
v_add_f32 v84, v84, v161
v_add_f32 v84, v84, v162
v_add_f32 v84, v84, v163
v_cvt_pk_bf16_f32 v178, v160, v161
v_cvt_pk_bf16_f32 v179, v162, v163
v_sub_f32 v164, v164, v81
v_sub_f32 v165, v165, v81
v_sub_f32 v166, v166, v81
v_sub_f32 v167, v167, v81
v_exp_f32 v164, v164
v_exp_f32 v165, v165
v_exp_f32 v166, v166
v_exp_f32 v167, v167
s_nop 0
v_add_f32 v85, v85, v164
v_add_f32 v85, v85, v165
v_add_f32 v85, v85, v166
v_add_f32 v85, v85, v167
v_cvt_pk_bf16_f32 v182, v164, v165
v_cvt_pk_bf16_f32 v183, v166, v167
v_sub_f32 v168, v168, v82
v_sub_f32 v169, v169, v82
v_sub_f32 v170, v170, v82
v_sub_f32 v171, v171, v82
v_exp_f32 v168, v168
v_exp_f32 v169, v169
v_exp_f32 v170, v170
v_exp_f32 v171, v171
s_nop 0
v_add_f32 v86, v86, v168
v_add_f32 v86, v86, v169
v_add_f32 v86, v86, v170
v_add_f32 v86, v86, v171
v_cvt_pk_bf16_f32 v186, v168, v169
v_cvt_pk_bf16_f32 v187, v170, v171
v_sub_f32 v172, v172, v83
v_sub_f32 v173, v173, v83
v_sub_f32 v174, v174, v83
v_sub_f32 v175, v175, v83
v_exp_f32 v172, v172
v_exp_f32 v173, v173
v_exp_f32 v174, v174
v_exp_f32 v175, v175
s_nop 0
v_add_f32 v87, v87, v172
v_add_f32 v87, v87, v173
v_add_f32 v87, v87, v174
v_add_f32 v87, v87, v175
v_cvt_pk_bf16_f32 v190, v172, v173
v_cvt_pk_bf16_f32 v191, v174, v175
s_waitcnt lgkmcnt(0)
s_nop 1
v_mfma_f32_16x16x32_bf16 a[0:3], v[48:51], v[176:179], a[0:3]
v_mfma_f32_16x16x32_bf16 a[4:7], v[48:51], v[180:183], a[4:7]
v_mfma_f32_16x16x32_bf16 a[8:11], v[48:51], v[184:187], a[8:11]
v_mfma_f32_16x16x32_bf16 a[12:15], v[48:51], v[188:191], a[12:15]
v_mfma_f32_16x16x32_bf16 a[16:19], v[52:55], v[176:179], a[16:19]
v_mfma_f32_16x16x32_bf16 a[20:23], v[52:55], v[180:183], a[20:23]
v_mfma_f32_16x16x32_bf16 a[24:27], v[52:55], v[184:187], a[24:27]
v_mfma_f32_16x16x32_bf16 a[28:31], v[52:55], v[188:191], a[28:31]
v_mfma_f32_16x16x32_bf16 a[32:35], v[56:59], v[176:179], a[32:35]
v_mfma_f32_16x16x32_bf16 a[36:39], v[56:59], v[180:183], a[36:39]
v_mfma_f32_16x16x32_bf16 a[40:43], v[56:59], v[184:187], a[40:43]
v_mfma_f32_16x16x32_bf16 a[44:47], v[56:59], v[188:191], a[44:47]
v_mfma_f32_16x16x32_bf16 a[48:51], v[60:63], v[176:179], a[48:51]
v_mfma_f32_16x16x32_bf16 a[52:55], v[60:63], v[180:183], a[52:55]
v_mfma_f32_16x16x32_bf16 a[56:59], v[60:63], v[184:187], a[56:59]
v_mfma_f32_16x16x32_bf16 a[60:63], v[60:63], v[188:191], a[60:63]
v_mfma_f32_16x16x32_bf16 a[64:67], v[64:67], v[176:179], a[64:67]
v_mfma_f32_16x16x32_bf16 a[68:71], v[64:67], v[180:183], a[68:71]
v_mfma_f32_16x16x32_bf16 a[72:75], v[64:67], v[184:187], a[72:75]
v_mfma_f32_16x16x32_bf16 a[76:79], v[64:67], v[188:191], a[76:79]
v_mfma_f32_16x16x32_bf16 a[80:83], v[68:71], v[176:179], a[80:83]
v_mfma_f32_16x16x32_bf16 a[84:87], v[68:71], v[180:183], a[84:87]
v_mfma_f32_16x16x32_bf16 a[88:91], v[68:71], v[184:187], a[88:91]
v_mfma_f32_16x16x32_bf16 a[92:95], v[68:71], v[188:191], a[92:95]
v_mfma_f32_16x16x32_bf16 a[96:99], v[72:75], v[176:179], a[96:99]
v_mfma_f32_16x16x32_bf16 a[100:103], v[72:75], v[180:183], a[100:103]
v_mfma_f32_16x16x32_bf16 a[104:107], v[72:75], v[184:187], a[104:107]
v_mfma_f32_16x16x32_bf16 a[108:111], v[72:75], v[188:191], a[108:111]
v_mfma_f32_16x16x32_bf16 a[112:115], v[76:79], v[176:179], a[112:115]
v_mfma_f32_16x16x32_bf16 a[116:119], v[76:79], v[180:183], a[116:119]
v_mfma_f32_16x16x32_bf16 a[120:123], v[76:79], v[184:187], a[120:123]
v_mfma_f32_16x16x32_bf16 a[124:127], v[76:79], v[188:191], a[124:127]
s_add_u32 s73, s73, 1
s_cmp_lt_u32 s73, 16
s_nop 15
s_cbranch_scc1 mk_fbY_p2
v_mov_b32 v88, v84
s_nop 1
v_permlane32_swap_b32 v84, v88
s_nop 1
v_add_f32 v84, v84, v88
v_mov_b32 v88, v84
s_nop 1
v_permlane16_swap_b32 v84, v88
s_nop 1
v_add_f32 v84, v84, v88
v_mov_b32 v88, v85
s_nop 1
v_permlane32_swap_b32 v85, v88
s_nop 1
v_add_f32 v85, v85, v88
v_mov_b32 v88, v85
s_nop 1
v_permlane16_swap_b32 v85, v88
s_nop 1
v_add_f32 v85, v85, v88
v_mov_b32 v88, v86
s_nop 1
v_permlane32_swap_b32 v86, v88
s_nop 1
v_add_f32 v86, v86, v88
v_mov_b32 v88, v86
s_nop 1
v_permlane16_swap_b32 v86, v88
s_nop 1
v_add_f32 v86, v86, v88
v_mov_b32 v88, v87
s_nop 1
v_permlane32_swap_b32 v87, v88
s_nop 1
v_add_f32 v87, v87, v88
v_mov_b32 v88, v87
s_nop 1
v_permlane16_swap_b32 v87, v88
s_nop 1
v_add_f32 v87, v87, v88
v_rcp_f32 v4, v84
v_rcp_f32 v5, v85
v_rcp_f32 v6, v86
v_rcp_f32 v7, v87
s_nop 7
s_add_u32 s42, s38, 0
v_accvgpr_read_b32 v40, a0
v_accvgpr_read_b32 v41, a1
v_accvgpr_read_b32 v42, a2
v_accvgpr_read_b32 v43, a3
v_accvgpr_read_b32 v44, a16
v_accvgpr_read_b32 v45, a17
v_accvgpr_read_b32 v46, a18
v_accvgpr_read_b32 v47, a19
v_mul_f32 v40, v40, v4
v_mul_f32 v41, v41, v4
v_mul_f32 v42, v42, v4
v_mul_f32 v43, v43, v4
v_mul_f32 v44, v44, v4
v_mul_f32 v45, v45, v4
v_mul_f32 v46, v46, v4
v_mul_f32 v47, v47, v4
v_cvt_pk_bf16_f32 v48, v40, v41
v_cvt_pk_bf16_f32 v49, v42, v43
v_cvt_pk_bf16_f32 v50, v44, v45
v_cvt_pk_bf16_f32 v51, v46, v47
buffer_store_dwordx4 v[48:51], v9, s[8:11], s42 offen offset:0 sc1
v_accvgpr_read_b32 v40, a4
v_accvgpr_read_b32 v41, a5
v_accvgpr_read_b32 v42, a6
v_accvgpr_read_b32 v43, a7
v_accvgpr_read_b32 v44, a20
v_accvgpr_read_b32 v45, a21
v_accvgpr_read_b32 v46, a22
v_accvgpr_read_b32 v47, a23
v_mul_f32 v40, v40, v5
v_mul_f32 v41, v41, v5
v_mul_f32 v42, v42, v5
v_mul_f32 v43, v43, v5
v_mul_f32 v44, v44, v5
v_mul_f32 v45, v45, v5
v_mul_f32 v46, v46, v5
v_mul_f32 v47, v47, v5
v_cvt_pk_bf16_f32 v52, v40, v41
v_cvt_pk_bf16_f32 v53, v42, v43
v_cvt_pk_bf16_f32 v54, v44, v45
v_cvt_pk_bf16_f32 v55, v46, v47
buffer_store_dwordx4 v[52:55], v9, s[8:11], s42 offen offset:1024 sc1
v_accvgpr_read_b32 v40, a8
v_accvgpr_read_b32 v41, a9
v_accvgpr_read_b32 v42, a10
v_accvgpr_read_b32 v43, a11
v_accvgpr_read_b32 v44, a24
v_accvgpr_read_b32 v45, a25
v_accvgpr_read_b32 v46, a26
v_accvgpr_read_b32 v47, a27
v_mul_f32 v40, v40, v6
v_mul_f32 v41, v41, v6
v_mul_f32 v42, v42, v6
v_mul_f32 v43, v43, v6
v_mul_f32 v44, v44, v6
v_mul_f32 v45, v45, v6
v_mul_f32 v46, v46, v6
v_mul_f32 v47, v47, v6
v_cvt_pk_bf16_f32 v56, v40, v41
v_cvt_pk_bf16_f32 v57, v42, v43
v_cvt_pk_bf16_f32 v58, v44, v45
v_cvt_pk_bf16_f32 v59, v46, v47
buffer_store_dwordx4 v[56:59], v9, s[8:11], s42 offen offset:2048 sc1
v_accvgpr_read_b32 v40, a12
v_accvgpr_read_b32 v41, a13
v_accvgpr_read_b32 v42, a14
v_accvgpr_read_b32 v43, a15
v_accvgpr_read_b32 v44, a28
v_accvgpr_read_b32 v45, a29
v_accvgpr_read_b32 v46, a30
v_accvgpr_read_b32 v47, a31
v_mul_f32 v40, v40, v7
v_mul_f32 v41, v41, v7
v_mul_f32 v42, v42, v7
v_mul_f32 v43, v43, v7
v_mul_f32 v44, v44, v7
v_mul_f32 v45, v45, v7
v_mul_f32 v46, v46, v7
v_mul_f32 v47, v47, v7
v_cvt_pk_bf16_f32 v60, v40, v41
v_cvt_pk_bf16_f32 v61, v42, v43
v_cvt_pk_bf16_f32 v62, v44, v45
v_cvt_pk_bf16_f32 v63, v46, v47
buffer_store_dwordx4 v[60:63], v9, s[8:11], s42 offen offset:3072 sc1
s_mov_b32 m0, s71
s_branch mk_fbbackY
mk_slowH:
s_mov_b32 s71, 0x40000
mk_poll_H:
buffer_load_dword v43, v42, s[8:11], s66 offen sc1
s_waitcnt vmcnt(0)
v_cmp_eq_u32 vcc, s100, v43
s_sub_u32 s71, s71, 1
s_cbranch_scc1 mk_pollx_H
s_nop 1
s_and_b32 s43, vcc_lo, 255
s_cmp_eq_u32 s43, 255
s_cbranch_scc1 mk_pollx_H
s_sleep 1
s_branch mk_poll_H
mk_pollx_H:
s_branch mk_backH
mk_slowYY:
s_mov_b32 s71, 0x40000
mk_poll_YY:
buffer_load_dword v7, v6, s[8:11], s67 offen sc1
s_waitcnt vmcnt(0)
v_cmp_eq_u32 vcc, s100, v7
s_sub_u32 s71, s71, 1
s_cbranch_scc1 mk_pollx_YY
s_nop 1
s_and_b32 s43, vcc_lo, 240
s_cmp_eq_u32 s43, 240
s_cbranch_scc1 mk_pollx_YY
s_sleep 1
s_branch mk_poll_YY
mk_pollx_YY:
s_branch mk_backYY
mk_fin:
mk_end:
s_endpgm
.section .rodata,"a"
.p2align 6
.amdhsa_kernel recurrent_scan__sliding_block_cached__geglu_ffn__prompt_kernel
  .amdhsa_next_free_vgpr 512
  .amdhsa_next_free_sgpr 102
  .amdhsa_accum_offset 256
  .amdhsa_group_segment_fixed_size 0
  .amdhsa_kernarg_size 96
  .amdhsa_user_sgpr_count 2
  .amdhsa_user_sgpr_kernarg_segment_ptr 1
  .amdhsa_system_sgpr_workgroup_id_x 1
.end_amdhsa_kernel
```
